```python
import torch

def _softmax(x, axis=-1):
    return torch.softmax(x, dim=axis)
def _gelu(x):
    return torch.nn.functional.gelu(x, approximate="tanh")
def _silu(x):
    return torch.nn.functional.silu(x)
def _sigmoid(x):
    return torch.sigmoid(x)
def _layernorm(x, axis=-1, eps=1e-5):
    m = x.mean(dim=axis, keepdim=True)
    v = x.var(dim=axis, keepdim=True, unbiased=False)
    return (x - m) / torch.sqrt(v + eps)
def _scatter_add(tgt, idx, src, axis=0):
    return tgt.clone().index_add_(axis, idx, src)
def _segment_sum(src, seg, n):
    out = torch.zeros((n,) + src.shape[1:], dtype=src.dtype)
    return out.index_add_(0, seg, src)
def _pad(x, pw):
    flat = tuple(v for pair in reversed(pw) for v in pair)
    return torch.nn.functional.pad(x, flat)

kernel_name = 'standalone__hybrid_graph_tf_graphgps__graph'

def setup_inputs():

    _w = (lambda a: (lambda t: t.to(torch.bfloat16) if t.is_floating_point() else t)(torch.as_tensor(a)))
    N, deg, D = 10000, 16, 256
    E = N * deg
    src = (lambda lo, hi, *s: torch.randint(lo, hi, s))(0, N, E).to(torch.int64)
    dst = (lambda lo, hi, *s: torch.randint(lo, hi, s))(0, N, E).to(torch.int64)
    deg_cnt = torch.bincount(dst, minlength=N).to(float) + 1.0
    sc = 1.0 / float(D) ** 0.5
    return {
        "x": _w((lambda *s: torch.randn(*s, dtype=torch.bfloat16) * 0.05)(N, D)),
        "src": _w(src),
        "dst": _w(dst),
        "deg_inv": _w((1.0 / deg_cnt).to(float)),
        "w_msg": _w((lambda *s: torch.randn(*s, dtype=torch.bfloat16) * 0.2)(D, D) * sc),
        "wq": _w((lambda *s: torch.randn(*s, dtype=torch.bfloat16) * 1.6)(D, D) * sc),
        "wk": _w((lambda *s: torch.randn(*s, dtype=torch.bfloat16) * 1.6)(D, D) * sc),
        "wv": _w((lambda *s: torch.randn(*s, dtype=torch.bfloat16) * 0.2)(D, D) * sc),
        "w_out": _w((lambda *s: torch.randn(*s, dtype=torch.bfloat16) * 0.2)(D, D) * sc),
    }

def reference(x, src, dst, deg_inv, w_msg, wq, wk, wv, w_out):
    N, D = x.shape[0], x.shape[1]
    h = _layernorm(x, axis=-1)
    m_e = torch.einsum('nd,de->ne', h, w_msg)
    h_local = _segment_sum(m_e[src], dst, N) * deg_inv[:, None]
    q = torch.einsum('nd,de->ne', h, wq)
    k = torch.einsum('nd,de->ne', h, wk)
    v = torch.einsum('nd,de->ne', h, wv)
    logits = torch.einsum('id,jd->ij', q, k) / (float(D) ** 0.5)
    attn = _softmax(logits, axis=-1)
    h_global = torch.einsum('ij,jd->id', attn, v)
    y = torch.einsum('nd,de->ne', h_local + h_global, w_out)
    return x + y
```

```asm
; @launch kernel=k1_kernel grid=(249,1,1) block=(512,1,1) lds=163840
; @launch kernel=k2_kernel grid=(256,1,1) block=(256,1,1) lds=163840
; @launch kernel=k3_kernel grid=(256,1,1) block=(512,1,1) lds=90112
.amdgcn_target "amdgcn-amd-amdhsa--gfx950"
.text
.globl k1_kernel
.p2align 8
.type k1_kernel,@function
k1_kernel:
s_getpc_b64 s[56:57]
s_load_dwordx16 s[16:31], s[0:1], 0
s_load_dwordx8 s[32:39], s[0:1], 64
s_cmp_ge_u32 s2, 249
s_cbranch_scc1 L1_end
v_lshrrev_b32 v1, 6, v0
v_and_b32 v2, 63, v0
s_lshr_b32 s3, s2, 3
v_readfirstlane_b32 s60, v1
s_mul_i32 s5, s3, 8
s_add_u32 s5, s5, s60
s_and_b32 s56, s56, 0xffffff00
s_mov_b32 s58, L3_end-k1_kernel
s_mov_b32 s59, 0x00020000
s_and_b32 s6, s5, 15
s_lshl_b32 s6, s6, 13
v_lshlrev_b32 v10, 7, v2
buffer_load_dword v255, v10, s[56:59], s6 offen
v_and_b32 v3, 15, v2
v_lshrrev_b32 v4, 4, v2
s_and_b32 s62, s3, 7
s_sub_u32 s4, s2, 40
s_cmp_lt_u32 s2, 40
s_cbranch_scc1 L1_notq
s_mov_b32 s61, 0
v_lshlrev_b32 v16, 4, v2
s_mul_i32 s63, s60, 6144
s_mul_i32 s6, s4, 24576
s_mul_i32 s7, s60, 3072
s_add_u32 s64, s6, s7
s_add_u32 s65, s64, 4096
s_lshl_b32 s7, s60, 6
v_lshrrev_b32 v5, 2, v2
v_and_b32 v6, 3, v2
v_lshrrev_b32 v7, 5, v2
v_lshlrev_b32 v7, 1, v7
v_xor_b32 v6, v6, v7
v_lshl_add_u32 v5, v5, 9, s7
v_lshl_add_u32 v17, v6, 4, v5
v_add_u32 v18, 0x1c00, v17
s_xor_b32 s6, s62, 0
s_lshl_b32 s66, s6, 14
s_xor_b32 s6, s62, 1
s_lshl_b32 s67, s6, 14
s_xor_b32 s6, s62, 2
s_lshl_b32 s68, s6, 14
s_xor_b32 s6, s62, 3
s_lshl_b32 s69, s6, 14
s_xor_b32 s6, s62, 4
s_lshl_b32 s70, s6, 14
s_xor_b32 s6, s62, 5
s_lshl_b32 s71, s6, 14
s_xor_b32 s6, s62, 6
s_lshl_b32 s72, s6, 14
s_xor_b32 s6, s62, 7
s_lshl_b32 s73, s6, 14
s_waitcnt lgkmcnt(0)
s_add_u32 s40, s16, 0x0
s_addc_u32 s41, s17, 0
s_mov_b32 s42, 0x4e2000
s_mov_b32 s43, 0x00020000
s_add_u32 s44, s26, 0x0
s_addc_u32 s45, s27, 0
s_mov_b32 s46, 0x20000
s_mov_b32 s47, 0x00020000
buffer_load_dwordx4 v[40:43], v16, s[40:43], s64 offen offset:0
buffer_load_dwordx4 v[44:47], v16, s[40:43], s64 offen offset:1024
buffer_load_dwordx4 v[48:51], v16, s[40:43], s64 offen offset:2048
s_add_u32 m0, s63, 0x0
s_nop 0
buffer_load_dwordx4 v17, s[44:47], s66 offen offset:0 lds
buffer_load_dwordx4 v18, s[44:47], s66 offen offset:1024 lds
s_add_u32 m0, s63, 0x800
s_nop 0
buffer_load_dwordx4 v17, s[44:47], s67 offen offset:0 lds
buffer_load_dwordx4 v18, s[44:47], s67 offen offset:1024 lds
v_bfe_u32 v5, v2, 2, 3
v_xor_b32 v5, s62, v5
v_and_b32 v6, 3, v2
v_lshlrev_b32 v7, 10, v5
v_lshl_add_u32 v7, v6, 8, v7
v_add_u32 v7, 0xc000, v7
v_and_b32 v5, 1, v5
v_lshl_or_b32 v6, v5, 2, v6
v_lshrrev_b32 v5, 5, v2
s_mul_i32 s6, s60, 6
v_add3_u32 v8, v5, s6, 0
v_lshrrev_b32 v9, 4, v8
v_lshl_add_u32 v9, v9, 13, v7
v_and_b32 v8, 15, v8
v_xor_b32 v8, v8, v6
v_lshl_add_u32 v36, v8, 4, v9
v_add3_u32 v8, v5, s6, 2
v_lshrrev_b32 v9, 4, v8
v_lshl_add_u32 v9, v9, 13, v7
v_and_b32 v8, 15, v8
v_xor_b32 v8, v8, v6
v_lshl_add_u32 v37, v8, 4, v9
v_add3_u32 v8, v5, s6, 4
v_lshrrev_b32 v9, 4, v8
v_lshl_add_u32 v9, v9, 13, v7
v_and_b32 v8, 15, v8
v_xor_b32 v8, v8, v6
v_lshl_add_u32 v38, v8, 4, v9
v_xor_b32 v5, v3, v4
v_lshlrev_b32 v5, 4, v5
v_lshl_add_u32 v5, v4, 8, v5
v_add_u32 v31, 0xc000, v5
v_xor_b32 v32, 64, v31
v_lshrrev_b32 v5, 2, v3
v_and_b32 v6, 3, v3
v_and_b32 v7, 1, v4
v_lshlrev_b32 v7, 1, v7
v_lshl_add_u32 v8, v4, 3, v5
v_lshlrev_b32 v8, 6, v8
v_add_u32 v8, s63, v8
v_and_b32 v9, 1, v6
v_lshl_add_u32 v8, v9, 3, v8
v_lshrrev_b32 v6, 1, v6
v_xor_b32 v6, v6, v7
v_xor_b32 v9, 0, v6
v_lshl_add_u32 v25, v9, 4, v8
v_xor_b32 v9, 2, v6
v_lshl_add_u32 v26, v9, 4, v8
v_lshrrev_b32 v5, 3, v2
v_and_b32 v6, 7, v2
v_lshrrev_b32 v7, 1, v5
v_xor_b32 v6, v6, v7
v_and_b32 v7, 4, v5
v_add_u32 v5, v5, v7
s_mul_i32 s6, s60, 16384
v_lshl_add_u32 v5, v5, 9, s6
v_lshl_add_u32 v21, v6, 4, v5
v_xor_b32 v6, 4, v6
v_lshl_add_u32 v22, v6, 4, v5
v_add_u32 v22, 0x1c00, v22
s_lshr_b32 s7, s62, 1
s_xor_b32 s6, s7, 0
s_lshl_b32 s74, s6, 7
s_add_u32 s75, s74, 2048
s_xor_b32 s6, s7, 1
s_lshl_b32 s76, s6, 7
s_add_u32 s77, s76, 2048
s_xor_b32 s6, s7, 2
s_lshl_b32 s78, s6, 7
s_add_u32 s79, s78, 2048
s_xor_b32 s6, s7, 3
s_lshl_b32 s80, s6, 7
s_add_u32 s81, s80, 2048
s_and_b32 s6, s62, 1
s_lshl_b32 s6, s6, 2
v_lshrrev_b32 v5, 1, v3
v_xor_b32 v5, v5, v4
v_xor_b32 v5, s6, v5
v_lshl_add_u32 v6, v3, 7, s63
v_lshl_add_u32 v29, v5, 4, v6
v_xor_b32 v30, 64, v29
s_mul_i32 s6, s60, 1
s_xor_b32 s6, s6, s62
s_lshl_b32 s6, s6, 10
s_add_u32 s6, s6, 0x12000
v_lshrrev_b32 v5, 1, v4
v_and_b32 v6, 1, v4
v_lshl_add_u32 v5, v5, 8, s6
v_lshl_add_u32 v5, v6, 3, v5
v_lshl_add_u32 v33, v3, 4, v5
v_xor_b32 v34, 0x400, v33
v_add_u32 v35, 0x12000, v16
s_mul_i32 s6, s4, 24576
s_mul_i32 s7, s60, 1024
s_add_u32 s82, s6, s7
s_add_u32 s83, s82, 8192
s_add_u32 s84, s82, 16384
s_mov_b32 s86, 0x3db8aa3b
s_mov_b32 s87, 0x3db8aa3b
s_mov_b32 s88, 0x3727c5ac
s_mov_b32 s89, 0x3b800000
s_mov_b32 s90, 0xffff0000
s_add_u32 s48, s28, 0x0
s_addc_u32 s49, s29, 0
s_mov_b32 s50, 0x20000
s_mov_b32 s51, 0x00020000
s_add_u32 s52, s38, 0x0
s_addc_u32 s53, s39, 0
s_mov_b32 s54, 0x4e4000
s_mov_b32 s55, 0x00020000
s_add_u32 s56, s38, 0x6800000
s_addc_u32 s57, s39, 0
s_mov_b32 s58, 0x4e4000
s_mov_b32 s59, 0x00020000
v_lshlrev_b32 v5, 4, v4
s_lshr_b32 s6, s66, 8
buffer_load_dwordx4 v[172:175], v5, s[48:51], s6 offen
s_lshr_b32 s6, s67, 8
buffer_load_dwordx4 v[176:179], v5, s[48:51], s6 offen
s_lshr_b32 s6, s68, 8
buffer_load_dwordx4 v[180:183], v5, s[48:51], s6 offen
s_lshr_b32 s6, s69, 8
buffer_load_dwordx4 v[184:187], v5, s[48:51], s6 offen
s_lshr_b32 s6, s70, 8
buffer_load_dwordx4 v[188:191], v5, s[48:51], s6 offen
s_lshr_b32 s6, s71, 8
buffer_load_dwordx4 v[192:195], v5, s[48:51], s6 offen
s_lshr_b32 s6, s72, 8
buffer_load_dwordx4 v[196:199], v5, s[48:51], s6 offen
s_lshr_b32 s6, s73, 8
buffer_load_dwordx4 v[200:203], v5, s[48:51], s6 offen
s_waitcnt vmcnt(14)
v_lshlrev_b32 v76, 16, v40
v_and_b32 v77, s90, v40
v_lshlrev_b32 v78, 16, v41
v_and_b32 v79, s90, v41
v_lshlrev_b32 v80, 16, v42
v_and_b32 v81, s90, v42
v_lshlrev_b32 v82, 16, v43
v_and_b32 v83, s90, v43
v_pk_add_f32 v[100:101], v[76:77], v[78:79]
v_pk_mul_f32 v[102:103], v[76:77], v[76:77]
v_pk_add_f32 v[40:41], v[80:81], v[82:83]
v_pk_fma_f32 v[102:103], v[78:79], v[78:79], v[102:103]
v_pk_add_f32 v[100:101], v[100:101], v[40:41]
v_pk_fma_f32 v[102:103], v[80:81], v[80:81], v[102:103]
v_add_f32 v100, v100, v101
v_pk_fma_f32 v[102:103], v[82:83], v[82:83], v[102:103]
v_add_f32 v102, v102, v103
s_waitcnt vmcnt(13)
v_lshlrev_b32 v84, 16, v44
v_and_b32 v85, s90, v44
v_lshlrev_b32 v86, 16, v45
v_and_b32 v87, s90, v45
v_lshlrev_b32 v88, 16, v46
v_and_b32 v89, s90, v46
v_lshlrev_b32 v90, 16, v47
v_and_b32 v91, s90, v47
v_pk_add_f32 v[104:105], v[84:85], v[86:87]
v_pk_mul_f32 v[106:107], v[84:85], v[84:85]
v_pk_add_f32 v[44:45], v[88:89], v[90:91]
v_pk_fma_f32 v[106:107], v[86:87], v[86:87], v[106:107]
v_pk_add_f32 v[104:105], v[104:105], v[44:45]
v_pk_fma_f32 v[106:107], v[88:89], v[88:89], v[106:107]
v_add_f32 v104, v104, v105
v_pk_fma_f32 v[106:107], v[90:91], v[90:91], v[106:107]
v_add_f32 v106, v106, v107
s_waitcnt vmcnt(12)
v_lshlrev_b32 v92, 16, v48
v_and_b32 v93, s90, v48
v_lshlrev_b32 v94, 16, v49
v_and_b32 v95, s90, v49
v_lshlrev_b32 v96, 16, v50
v_and_b32 v97, s90, v50
v_lshlrev_b32 v98, 16, v51
v_and_b32 v99, s90, v51
v_pk_add_f32 v[108:109], v[92:93], v[94:95]
v_pk_mul_f32 v[110:111], v[92:93], v[92:93]
v_pk_add_f32 v[48:49], v[96:97], v[98:99]
v_pk_fma_f32 v[110:111], v[94:95], v[94:95], v[110:111]
v_pk_add_f32 v[108:109], v[108:109], v[48:49]
v_pk_fma_f32 v[110:111], v[96:97], v[96:97], v[110:111]
v_add_f32 v108, v108, v109
v_pk_fma_f32 v[110:111], v[98:99], v[98:99], v[110:111]
v_add_f32 v110, v110, v111
v_permlane16_swap_b32 v100, v102
v_permlane16_swap_b32 v104, v106
v_permlane16_swap_b32 v108, v110
v_add_f32 v100, v100, v102
v_add_f32 v104, v104, v106
v_add_f32 v108, v108, v110
v_add_f32_dpp v101, v100, v100 row_ror:8 row_mask:0xf bank_mask:0x3
v_add_f32_dpp v101, v104, v104 row_ror:8 row_mask:0xf bank_mask:0xc
v_add_f32_dpp v109, v108, v108 row_ror:8 row_mask:0xf bank_mask:0xf
s_nop 0
v_add_f32_dpp v102, v101, v101 row_half_mirror row_mask:0xf bank_mask:0x5
v_add_f32_dpp v102, v109, v109 row_half_mirror row_mask:0xf bank_mask:0xa
s_nop 1
v_add_f32_dpp v102, v102, v102 quad_perm:[1,0,3,2] row_mask:0xf bank_mask:0xf
s_nop 1
v_add_f32_dpp v102, v102, v102 quad_perm:[2,3,0,1] row_mask:0xf bank_mask:0xf
v_mov_b32 v103, v102
s_nop 1
v_permlane16_swap_b32 v103, v102
v_mul_f32 v103, s89, v103
v_mul_f32 v102, s89, v102
v_fma_f32 v102, -v103, v103, v102
v_max_f32 v102, 0, v102
v_cvt_pk_bf16_f32 v102, v102, v102
v_and_b32 v102, s90, v102
v_add_f32 v102, s88, v102
v_cvt_pk_bf16_f32 v102, v102, v102
v_and_b32 v102, s90, v102
v_sqrt_f32 v102, v102
s_nop 0
v_cvt_pk_bf16_f32 v102, v102, v102
v_and_b32 v102, s90, v102
v_rcp_f32 v102, v102
s_nop 0
v_mul_f32 v103, -v103, v102
s_nop 1
v_mov_b64_dpp v[100:101], v[102:103] row_newbcast:0 row_mask:0xf bank_mask:0xf
v_mov_b64_dpp v[104:105], v[102:103] row_newbcast:8 row_mask:0xf bank_mask:0xf
v_mov_b64_dpp v[108:109], v[102:103] row_newbcast:4 row_mask:0xf bank_mask:0xf
v_fma_f32 v76, v76, v100, v101
v_fma_f32 v77, v77, v100, v101
v_fma_f32 v78, v78, v100, v101
v_fma_f32 v79, v79, v100, v101
v_fma_f32 v80, v80, v100, v101
v_fma_f32 v81, v81, v100, v101
v_fma_f32 v82, v82, v100, v101
v_fma_f32 v83, v83, v100, v101
v_cvt_pk_bf16_f32 v40, v76, v77
v_cvt_pk_bf16_f32 v41, v78, v79
v_cvt_pk_bf16_f32 v42, v80, v81
v_cvt_pk_bf16_f32 v43, v82, v83
ds_write_b128 v36, v[40:43]
v_fma_f32 v84, v84, v104, v105
v_fma_f32 v85, v85, v104, v105
v_fma_f32 v86, v86, v104, v105
v_fma_f32 v87, v87, v104, v105
v_fma_f32 v88, v88, v104, v105
v_fma_f32 v89, v89, v104, v105
v_fma_f32 v90, v90, v104, v105
v_fma_f32 v91, v91, v104, v105
v_cvt_pk_bf16_f32 v44, v84, v85
v_cvt_pk_bf16_f32 v45, v86, v87
v_cvt_pk_bf16_f32 v46, v88, v89
v_cvt_pk_bf16_f32 v47, v90, v91
ds_write_b128 v37, v[44:47]
v_fma_f32 v92, v92, v108, v109
v_fma_f32 v93, v93, v108, v109
v_fma_f32 v94, v94, v108, v109
v_fma_f32 v95, v95, v108, v109
v_fma_f32 v96, v96, v108, v109
v_fma_f32 v97, v97, v108, v109
v_fma_f32 v98, v98, v108, v109
v_fma_f32 v99, v99, v108, v109
v_cvt_pk_bf16_f32 v48, v92, v93
v_cvt_pk_bf16_f32 v49, v94, v95
v_cvt_pk_bf16_f32 v50, v96, v97
v_cvt_pk_bf16_f32 v51, v98, v99
ds_write_b128 v38, v[48:51]
s_add_u32 m0, s63, 0x1000
s_nop 0
buffer_load_dwordx4 v17, s[44:47], s68 offen offset:0 lds
buffer_load_dwordx4 v18, s[44:47], s68 offen offset:1024 lds
s_waitcnt vmcnt(12)
ds_read_b64_tr_b16 v[100:101], v25 offset:0
ds_read_b64_tr_b16 v[102:103], v25 offset:256
ds_read_b64_tr_b16 v[104:105], v26 offset:0
ds_read_b64_tr_b16 v[106:107], v26 offset:256
s_waitcnt lgkmcnt(4)
s_barrier
ds_read_b128 v[124:127], v31 offset:0
ds_read_b128 v[128:131], v31 offset:8192
ds_read_b128 v[132:135], v31 offset:16384
ds_read_b128 v[136:139], v32 offset:1024
s_waitcnt vmcnt(10)
ds_read_b64_tr_b16 v[108:109], v25 offset:2048
ds_read_b64_tr_b16 v[110:111], v25 offset:2304
s_waitcnt lgkmcnt(5)
v_mfma_f32_16x16x32_bf16 v[52:55], v[100:103], v[124:127], 0
ds_read_b128 v[140:143], v32 offset:9216
s_waitcnt lgkmcnt(5)
v_mfma_f32_16x16x32_bf16 v[56:59], v[100:103], v[128:131], 0
ds_read_b128 v[144:147], v32 offset:17408
s_waitcnt lgkmcnt(5)
v_mfma_f32_16x16x32_bf16 v[60:63], v[100:103], v[132:135], 0
ds_read_b64_tr_b16 v[112:113], v26 offset:2048
ds_read_b64_tr_b16 v[114:115], v26 offset:2304
v_mfma_f32_16x16x32_bf16 v[64:67], v[104:107], v[124:127], 0
s_add_u32 m0, s63, 0x0
s_nop 0
buffer_load_dwordx4 v17, s[44:47], s69 offen offset:0 lds
buffer_load_dwordx4 v18, s[44:47], s69 offen offset:1024 lds
v_mfma_f32_16x16x32_bf16 v[68:71], v[104:107], v[128:131], 0
v_and_b32 v5, 31, v2
v_lshrrev_b32 v6, 5, v2
v_mfma_f32_16x16x32_bf16 v[72:75], v[104:107], v[132:135], 0
ds_read_b128 v[148:151], v31 offset:2048
s_waitcnt vmcnt(2)
ds_read_b64_tr_b16 v[116:117], v25 offset:4096
ds_read_b64_tr_b16 v[118:119], v25 offset:4352
s_waitcnt lgkmcnt(7)
v_mfma_f32_16x16x32_bf16 v[52:55], v[108:111], v[136:139], v[52:55]
ds_read_b128 v[152:155], v31 offset:10240
s_lshr_b32 s6, s64, 9
s_waitcnt lgkmcnt(7)
v_mfma_f32_16x16x32_bf16 v[56:59], v[108:111], v[140:143], v[56:59]
ds_read_b128 v[156:159], v31 offset:18432
v_cmp_eq_u32 vcc, 0, v5
s_waitcnt lgkmcnt(7)
v_mfma_f32_16x16x32_bf16 v[60:63], v[108:111], v[144:147], v[60:63]
ds_read_b64_tr_b16 v[120:121], v26 offset:4096
ds_read_b64_tr_b16 v[122:123], v26 offset:4352
s_waitcnt lgkmcnt(7)
v_mfma_f32_16x16x32_bf16 v[64:67], v[112:115], v[136:139], v[64:67]
s_add_u32 m0, s63, 0x800
s_nop 0
buffer_load_dwordx4 v17, s[44:47], s70 offen offset:0 lds
buffer_load_dwordx4 v18, s[44:47], s70 offen offset:1024 lds
v_mfma_f32_16x16x32_bf16 v[68:71], v[112:115], v[140:143], v[68:71]
s_sub_u32 s6, 10000, s6
v_mov_b32 v7, 0x7fffffff
v_mfma_f32_16x16x32_bf16 v[72:75], v[112:115], v[144:147], v[72:75]
ds_read_b128 v[160:163], v32 offset:3072
s_waitcnt vmcnt(2)
ds_read_b64_tr_b16 v[100:101], v25 offset:0
ds_read_b64_tr_b16 v[102:103], v25 offset:256
s_waitcnt lgkmcnt(7)
v_mfma_f32_16x16x32_bf16 v[52:55], v[116:119], v[148:151], v[52:55]
ds_read_b128 v[164:167], v32 offset:11264
v_cndmask_b32 v6, v7, v6, vcc
s_waitcnt lgkmcnt(7)
v_mfma_f32_16x16x32_bf16 v[56:59], v[116:119], v[152:155], v[56:59]
ds_read_b128 v[168:171], v32 offset:19456
v_cmp_gt_i32 vcc, s6, v6
s_waitcnt lgkmcnt(7)
v_mfma_f32_16x16x32_bf16 v[60:63], v[116:119], v[156:159], v[60:63]
ds_read_b64_tr_b16 v[104:105], v26 offset:0
ds_read_b64_tr_b16 v[106:107], v26 offset:256
s_waitcnt lgkmcnt(7)
v_mfma_f32_16x16x32_bf16 v[64:67], v[120:123], v[148:151], v[64:67]
s_add_u32 m0, s63, 0x1000
s_nop 0
buffer_load_dwordx4 v17, s[44:47], s71 offen offset:0 lds
buffer_load_dwordx4 v18, s[44:47], s71 offen offset:1024 lds
v_mfma_f32_16x16x32_bf16 v[68:71], v[120:123], v[152:155], v[68:71]
v_and_b32 v5, s90, v40
v_or_b32 v5, 0x3f80, v5
v_mfma_f32_16x16x32_bf16 v[72:75], v[120:123], v[156:159], v[72:75]
ds_read_b128 v[124:127], v31 offset:4096
s_waitcnt vmcnt(2)
ds_read_b64_tr_b16 v[108:109], v25 offset:2048
ds_read_b64_tr_b16 v[110:111], v25 offset:2304
s_waitcnt lgkmcnt(7)
v_mfma_f32_16x16x32_bf16 v[52:55], v[100:103], v[160:163], v[52:55]
ds_read_b128 v[128:131], v31 offset:12288
s_sub_u32 s6, s6, 2
s_waitcnt lgkmcnt(7)
v_mfma_f32_16x16x32_bf16 v[56:59], v[100:103], v[164:167], v[56:59]
ds_read_b128 v[132:135], v31 offset:20480
v_cndmask_b32 v40, v40, v5, vcc
s_waitcnt lgkmcnt(7)
v_mfma_f32_16x16x32_bf16 v[60:63], v[100:103], v[168:171], v[60:63]
ds_read_b64_tr_b16 v[112:113], v26 offset:2048
ds_read_b64_tr_b16 v[114:115], v26 offset:2304
s_waitcnt lgkmcnt(7)
v_mfma_f32_16x16x32_bf16 v[64:67], v[104:107], v[160:163], v[64:67]
s_add_u32 m0, s63, 0x0
s_nop 0
buffer_load_dwordx4 v17, s[44:47], s72 offen offset:0 lds
buffer_load_dwordx4 v18, s[44:47], s72 offen offset:1024 lds
v_mfma_f32_16x16x32_bf16 v[68:71], v[104:107], v[164:167], v[68:71]
v_cmp_gt_i32 vcc, s6, v6
v_and_b32 v5, s90, v44
v_mfma_f32_16x16x32_bf16 v[72:75], v[104:107], v[168:171], v[72:75]
ds_read_b128 v[136:139], v32 offset:5120
s_waitcnt vmcnt(2)
ds_read_b64_tr_b16 v[116:117], v25 offset:4096
ds_read_b64_tr_b16 v[118:119], v25 offset:4352
s_waitcnt lgkmcnt(7)
v_mfma_f32_16x16x32_bf16 v[52:55], v[108:111], v[124:127], v[52:55]
ds_read_b128 v[140:143], v32 offset:13312
v_or_b32 v5, 0x3f80, v5
s_waitcnt lgkmcnt(7)
v_mfma_f32_16x16x32_bf16 v[56:59], v[108:111], v[128:131], v[56:59]
ds_read_b128 v[144:147], v32 offset:21504
s_sub_u32 s6, s6, 2
s_waitcnt lgkmcnt(7)
v_mfma_f32_16x16x32_bf16 v[60:63], v[108:111], v[132:135], v[60:63]
ds_read_b64_tr_b16 v[120:121], v26 offset:4096
ds_read_b64_tr_b16 v[122:123], v26 offset:4352
s_waitcnt lgkmcnt(7)
v_mfma_f32_16x16x32_bf16 v[64:67], v[112:115], v[124:127], v[64:67]
s_add_u32 m0, s63, 0x800
s_nop 0
buffer_load_dwordx4 v17, s[44:47], s73 offen offset:0 lds
buffer_load_dwordx4 v18, s[44:47], s73 offen offset:1024 lds
v_mfma_f32_16x16x32_bf16 v[68:71], v[112:115], v[128:131], v[68:71]
v_cndmask_b32 v44, v44, v5, vcc
v_cmp_gt_i32 vcc, s6, v6
v_mfma_f32_16x16x32_bf16 v[72:75], v[112:115], v[132:135], v[72:75]
ds_read_b128 v[148:151], v31 offset:6144
s_waitcnt vmcnt(2)
ds_read_b64_tr_b16 v[100:101], v25 offset:0
ds_read_b64_tr_b16 v[102:103], v25 offset:256
s_waitcnt lgkmcnt(7)
v_mfma_f32_16x16x32_bf16 v[52:55], v[116:119], v[136:139], v[52:55]
ds_read_b128 v[152:155], v31 offset:14336
v_and_b32 v5, s90, v48
s_waitcnt lgkmcnt(7)
v_mfma_f32_16x16x32_bf16 v[56:59], v[116:119], v[140:143], v[56:59]
ds_read_b128 v[156:159], v31 offset:22528
v_or_b32 v5, 0x3f80, v5
s_waitcnt lgkmcnt(7)
v_mfma_f32_16x16x32_bf16 v[60:63], v[116:119], v[144:147], v[60:63]
ds_read_b64_tr_b16 v[104:105], v26 offset:0
ds_read_b64_tr_b16 v[106:107], v26 offset:256
s_waitcnt lgkmcnt(7)
v_mfma_f32_16x16x32_bf16 v[64:67], v[120:123], v[136:139], v[64:67]
s_add_u32 m0, s63, 0x1000
s_nop 0
buffer_load_dwordx4 v21, s[48:51], s74 offen offset:0 lds
buffer_load_dwordx4 v22, s[48:51], s74 offen offset:1024 lds
v_mfma_f32_16x16x32_bf16 v[68:71], v[120:123], v[140:143], v[68:71]
s_sub_u32 s6, s6, 2
v_cndmask_b32 v48, v48, v5, vcc
v_mfma_f32_16x16x32_bf16 v[72:75], v[120:123], v[144:147], v[72:75]
ds_read_b128 v[160:163], v32 offset:7168
s_waitcnt vmcnt(2)
ds_read_b64_tr_b16 v[108:109], v25 offset:2048
ds_read_b64_tr_b16 v[110:111], v25 offset:2304
s_waitcnt lgkmcnt(7)
v_mfma_f32_16x16x32_bf16 v[52:55], v[100:103], v[148:151], v[52:55]
ds_read_b128 v[164:167], v32 offset:15360
s_waitcnt lgkmcnt(7)
v_mfma_f32_16x16x32_bf16 v[56:59], v[100:103], v[152:155], v[56:59]
ds_read_b128 v[168:171], v32 offset:23552
s_waitcnt lgkmcnt(7)
v_mfma_f32_16x16x32_bf16 v[60:63], v[100:103], v[156:159], v[60:63]
ds_read_b64_tr_b16 v[112:113], v26 offset:2048
ds_read_b64_tr_b16 v[114:115], v26 offset:2304
s_waitcnt lgkmcnt(7)
v_mfma_f32_16x16x32_bf16 v[64:67], v[104:107], v[148:151], v[64:67]
s_add_u32 m0, s63, 0x0
s_nop 0
buffer_load_dwordx4 v21, s[48:51], s75 offen offset:0 lds
buffer_load_dwordx4 v22, s[48:51], s75 offen offset:1024 lds
v_mfma_f32_16x16x32_bf16 v[68:71], v[104:107], v[152:155], v[68:71]
v_mfma_f32_16x16x32_bf16 v[72:75], v[104:107], v[156:159], v[72:75]
s_waitcnt lgkmcnt(4)
v_mfma_f32_16x16x32_bf16 v[52:55], v[108:111], v[160:163], v[52:55]
s_waitcnt lgkmcnt(3)
v_mfma_f32_16x16x32_bf16 v[56:59], v[108:111], v[164:167], v[56:59]
s_waitcnt lgkmcnt(2)
v_mfma_f32_16x16x32_bf16 v[60:63], v[108:111], v[168:171], v[60:63]
s_waitcnt lgkmcnt(0)
v_mfma_f32_16x16x32_bf16 v[64:67], v[112:115], v[160:163], v[64:67]
s_nop 1
v_cvt_pk_bf16_f32 v52, v52, v53
v_cvt_pk_bf16_f32 v53, v54, v55
ds_write_b64 v33, v[52:53] offset:0
s_add_u32 m0, s63, 0x800
s_nop 0
buffer_load_dwordx4 v21, s[48:51], s76 offen offset:0 lds
buffer_load_dwordx4 v22, s[48:51], s76 offen offset:1024 lds
v_mfma_f32_16x16x32_bf16 v[68:71], v[112:115], v[164:167], v[68:71]
v_cvt_pk_bf16_f32 v56, v56, v57
v_cvt_pk_bf16_f32 v57, v58, v59
ds_write_b64 v33, v[56:57] offset:8192
v_mfma_f32_16x16x32_bf16 v[72:75], v[112:115], v[168:171], v[72:75]
v_cvt_pk_bf16_f32 v60, v60, v61
v_cvt_pk_bf16_f32 v61, v62, v63
ds_write_b64 v33, v[60:61] offset:16384
v_cvt_pk_bf16_f32 v64, v64, v65
v_cvt_pk_bf16_f32 v65, v66, v67
ds_write_b64 v33, v[64:65] offset:512
v_cvt_pk_bf16_f32 v68, v68, v69
v_cvt_pk_bf16_f32 v69, v70, v71
ds_write_b64 v33, v[68:69] offset:8704
v_cvt_pk_bf16_f32 v72, v72, v73
v_cvt_pk_bf16_f32 v73, v74, v75
ds_write_b64 v33, v[72:73] offset:16896
s_waitcnt vmcnt(4)
ds_read_b128 v[116:119], v29 offset:4096
ds_read_b128 v[120:123], v30 offset:4096
s_waitcnt lgkmcnt(2)
s_barrier
ds_read_b128 v[124:127], v35 offset:0
ds_read_b128 v[128:131], v35 offset:8192
ds_read_b128 v[132:135], v35 offset:16384
ds_read_b128 v[136:139], v35 offset:1024
s_waitcnt lgkmcnt(3)
v_mfma_f32_16x16x32_bf16 v[76:79], v[116:119], v[124:127], 0
ds_read_b128 v[140:143], v35 offset:9216
s_waitcnt lgkmcnt(3)
v_mfma_f32_16x16x32_bf16 v[84:87], v[116:119], v[128:131], 0
ds_read_b128 v[144:147], v35 offset:17408
s_waitcnt lgkmcnt(3)
v_mfma_f32_16x16x32_bf16 v[92:95], v[116:119], v[132:135], 0
v_mfma_f32_16x16x32_bf16 v[204:207], v[172:175], v[124:127], 0
v_mfma_f32_16x16x32_bf16 v[208:211], v[172:175], v[128:131], 0
v_mfma_f32_16x16x32_bf16 v[212:215], v[172:175], v[132:135], 0
s_waitcnt vmcnt(2)
ds_read_b128 v[100:103], v29 offset:0
s_waitcnt lgkmcnt(3)
v_mfma_f32_16x16x32_bf16 v[76:79], v[120:123], v[136:139], v[76:79]
s_add_u32 m0, s63, 0x1000
s_nop 0
buffer_load_dwordx4 v21, s[48:51], s77 offen offset:0 lds
buffer_load_dwordx4 v22, s[48:51], s77 offen offset:1024 lds
s_waitcnt lgkmcnt(2)
v_mfma_f32_16x16x32_bf16 v[84:87], v[120:123], v[140:143], v[84:87]
s_waitcnt lgkmcnt(1)
v_mfma_f32_16x16x32_bf16 v[92:95], v[120:123], v[144:147], v[92:95]
ds_read_b128 v[104:107], v30 offset:0
v_mfma_f32_16x16x32_bf16 v[204:207], v[176:179], v[136:139], v[204:207]
v_mfma_f32_16x16x32_bf16 v[208:211], v[176:179], v[140:143], v[208:211]
v_mfma_f32_16x16x32_bf16 v[212:215], v[176:179], v[144:147], v[212:215]
ds_read_b128 v[148:151], v35 offset:2048
s_waitcnt vmcnt(2)
ds_read_b128 v[108:111], v29 offset:2048
s_waitcnt lgkmcnt(3)
v_mfma_f32_16x16x32_bf16 v[80:83], v[100:103], v[124:127], 0
ds_read_b128 v[152:155], v35 offset:10240
v_mfma_f32_16x16x32_bf16 v[88:91], v[100:103], v[128:131], 0
ds_read_b128 v[156:159], v35 offset:18432
v_mfma_f32_16x16x32_bf16 v[96:99], v[100:103], v[132:135], 0
s_waitcnt lgkmcnt(4)
v_mfma_f32_16x16x32_bf16 v[80:83], v[104:107], v[136:139], v[80:83]
s_add_u32 m0, s63, 0x0
s_nop 0
buffer_load_dwordx4 v21, s[48:51], s78 offen offset:0 lds
buffer_load_dwordx4 v22, s[48:51], s78 offen offset:1024 lds
v_mfma_f32_16x16x32_bf16 v[88:91], v[104:107], v[140:143], v[88:91]
v_mfma_f32_16x16x32_bf16 v[96:99], v[104:107], v[144:147], v[96:99]
ds_read_b128 v[160:163], v35 offset:3072
ds_read_b128 v[112:115], v30 offset:2048
s_waitcnt lgkmcnt(4)
v_mfma_f32_16x16x32_bf16 v[76:79], v[108:111], v[148:151], v[76:79]
ds_read_b128 v[164:167], v35 offset:11264
s_waitcnt lgkmcnt(4)
v_mfma_f32_16x16x32_bf16 v[84:87], v[108:111], v[152:155], v[84:87]
ds_read_b128 v[168:171], v35 offset:19456
s_waitcnt lgkmcnt(4)
v_mfma_f32_16x16x32_bf16 v[92:95], v[108:111], v[156:159], v[92:95]
v_mfma_f32_16x16x32_bf16 v[204:207], v[180:183], v[148:151], v[204:207]
v_mfma_f32_16x16x32_bf16 v[208:211], v[180:183], v[152:155], v[208:211]
v_mfma_f32_16x16x32_bf16 v[212:215], v[180:183], v[156:159], v[212:215]
s_waitcnt vmcnt(2)
ds_read_b128 v[116:119], v29 offset:4096
s_waitcnt lgkmcnt(3)
v_mfma_f32_16x16x32_bf16 v[76:79], v[112:115], v[160:163], v[76:79]
s_add_u32 m0, s63, 0x800
s_nop 0
buffer_load_dwordx4 v21, s[48:51], s79 offen offset:0 lds
buffer_load_dwordx4 v22, s[48:51], s79 offen offset:1024 lds
s_waitcnt lgkmcnt(2)
v_mfma_f32_16x16x32_bf16 v[84:87], v[112:115], v[164:167], v[84:87]
s_waitcnt lgkmcnt(1)
v_mfma_f32_16x16x32_bf16 v[92:95], v[112:115], v[168:171], v[92:95]
ds_read_b128 v[120:123], v30 offset:4096
v_mfma_f32_16x16x32_bf16 v[204:207], v[184:187], v[160:163], v[204:207]
v_mfma_f32_16x16x32_bf16 v[208:211], v[184:187], v[164:167], v[208:211]
v_mfma_f32_16x16x32_bf16 v[212:215], v[184:187], v[168:171], v[212:215]
ds_read_b128 v[124:127], v35 offset:4096
s_waitcnt vmcnt(2)
ds_read_b128 v[100:103], v29 offset:0
s_waitcnt lgkmcnt(3)
v_mfma_f32_16x16x32_bf16 v[80:83], v[116:119], v[148:151], v[80:83]
ds_read_b128 v[128:131], v35 offset:12288
v_mfma_f32_16x16x32_bf16 v[88:91], v[116:119], v[152:155], v[88:91]
ds_read_b128 v[132:135], v35 offset:20480
v_mfma_f32_16x16x32_bf16 v[96:99], v[116:119], v[156:159], v[96:99]
s_waitcnt lgkmcnt(4)
v_mfma_f32_16x16x32_bf16 v[80:83], v[120:123], v[160:163], v[80:83]
s_add_u32 m0, s63, 0x1000
s_nop 0
buffer_load_dwordx4 v21, s[48:51], s80 offen offset:0 lds
buffer_load_dwordx4 v22, s[48:51], s80 offen offset:1024 lds
v_mfma_f32_16x16x32_bf16 v[88:91], v[120:123], v[164:167], v[88:91]
v_mfma_f32_16x16x32_bf16 v[96:99], v[120:123], v[168:171], v[96:99]
ds_read_b128 v[136:139], v35 offset:5120
ds_read_b128 v[104:107], v30 offset:0
s_waitcnt lgkmcnt(4)
v_mfma_f32_16x16x32_bf16 v[76:79], v[100:103], v[124:127], v[76:79]
ds_read_b128 v[140:143], v35 offset:13312
s_waitcnt lgkmcnt(4)
v_mfma_f32_16x16x32_bf16 v[84:87], v[100:103], v[128:131], v[84:87]
ds_read_b128 v[144:147], v35 offset:21504
s_waitcnt lgkmcnt(4)
v_mfma_f32_16x16x32_bf16 v[92:95], v[100:103], v[132:135], v[92:95]
v_mfma_f32_16x16x32_bf16 v[204:207], v[188:191], v[124:127], v[204:207]
v_mfma_f32_16x16x32_bf16 v[208:211], v[188:191], v[128:131], v[208:211]
v_mfma_f32_16x16x32_bf16 v[212:215], v[188:191], v[132:135], v[212:215]
s_waitcnt vmcnt(2)
ds_read_b128 v[108:111], v29 offset:2048
s_waitcnt lgkmcnt(3)
v_mfma_f32_16x16x32_bf16 v[76:79], v[104:107], v[136:139], v[76:79]
s_add_u32 m0, s63, 0x0
s_nop 0
buffer_load_dwordx4 v21, s[48:51], s81 offen offset:0 lds
buffer_load_dwordx4 v22, s[48:51], s81 offen offset:1024 lds
s_waitcnt lgkmcnt(2)
v_mfma_f32_16x16x32_bf16 v[84:87], v[104:107], v[140:143], v[84:87]
buffer_store_dwordx4 v[40:43], v16, s[56:59], s64 offen offset:0 sc1
buffer_store_dwordx4 v[44:47], v16, s[56:59], s64 offen offset:1024 sc1
s_waitcnt lgkmcnt(1)
v_mfma_f32_16x16x32_bf16 v[92:95], v[104:107], v[144:147], v[92:95]
ds_read_b128 v[112:115], v30 offset:2048
buffer_store_dwordx4 v[48:51], v16, s[56:59], s64 offen offset:2048 sc1
v_mfma_f32_16x16x32_bf16 v[204:207], v[192:195], v[136:139], v[204:207]
v_mfma_f32_16x16x32_bf16 v[208:211], v[192:195], v[140:143], v[208:211]
v_mfma_f32_16x16x32_bf16 v[212:215], v[192:195], v[144:147], v[212:215]
ds_read_b128 v[148:151], v35 offset:6144
s_waitcnt vmcnt(5)
ds_read_b128 v[116:119], v29 offset:4096
s_waitcnt lgkmcnt(3)
v_mfma_f32_16x16x32_bf16 v[80:83], v[108:111], v[124:127], v[80:83]
ds_read_b128 v[152:155], v35 offset:14336
v_mfma_f32_16x16x32_bf16 v[88:91], v[108:111], v[128:131], v[88:91]
ds_read_b128 v[156:159], v35 offset:22528
v_mfma_f32_16x16x32_bf16 v[96:99], v[108:111], v[132:135], v[96:99]
s_waitcnt lgkmcnt(4)
v_mfma_f32_16x16x32_bf16 v[80:83], v[112:115], v[136:139], v[80:83]
v_mfma_f32_16x16x32_bf16 v[88:91], v[112:115], v[140:143], v[88:91]
v_mfma_f32_16x16x32_bf16 v[96:99], v[112:115], v[144:147], v[96:99]
ds_read_b128 v[160:163], v35 offset:7168
ds_read_b128 v[120:123], v30 offset:4096
s_waitcnt lgkmcnt(4)
v_mfma_f32_16x16x32_bf16 v[76:79], v[116:119], v[148:151], v[76:79]
ds_read_b128 v[164:167], v35 offset:15360
s_waitcnt lgkmcnt(4)
v_mfma_f32_16x16x32_bf16 v[84:87], v[116:119], v[152:155], v[84:87]
ds_read_b128 v[168:171], v35 offset:23552
s_waitcnt lgkmcnt(4)
v_mfma_f32_16x16x32_bf16 v[92:95], v[116:119], v[156:159], v[92:95]
v_mfma_f32_16x16x32_bf16 v[204:207], v[196:199], v[148:151], v[204:207]
v_mfma_f32_16x16x32_bf16 v[208:211], v[196:199], v[152:155], v[208:211]
v_mfma_f32_16x16x32_bf16 v[212:215], v[196:199], v[156:159], v[212:215]
s_waitcnt vmcnt(3)
ds_read_b128 v[100:103], v29 offset:0
s_waitcnt lgkmcnt(3)
v_mfma_f32_16x16x32_bf16 v[76:79], v[120:123], v[160:163], v[76:79]
s_waitcnt lgkmcnt(2)
v_mfma_f32_16x16x32_bf16 v[84:87], v[120:123], v[164:167], v[84:87]
s_waitcnt lgkmcnt(1)
v_mfma_f32_16x16x32_bf16 v[92:95], v[120:123], v[168:171], v[92:95]
ds_read_b128 v[104:107], v30 offset:0
v_mfma_f32_16x16x32_bf16 v[204:207], v[200:203], v[160:163], v[204:207]
v_mfma_f32_16x16x32_bf16 v[208:211], v[200:203], v[164:167], v[208:211]
v_mfma_f32_16x16x32_bf16 v[212:215], v[200:203], v[168:171], v[212:215]
s_waitcnt lgkmcnt(1)
v_mfma_f32_16x16x32_bf16 v[80:83], v[100:103], v[148:151], v[80:83]
s_nop 3
v_mul_f32 v204, -v204, s86
v_mfma_f32_16x16x32_bf16 v[88:91], v[100:103], v[152:155], v[88:91]
v_mul_f32 v208, -v208, s86
v_mfma_f32_16x16x32_bf16 v[96:99], v[100:103], v[156:159], v[96:99]
v_mul_f32 v212, -v212, s86
s_waitcnt lgkmcnt(0)
v_mfma_f32_16x16x32_bf16 v[80:83], v[104:107], v[160:163], v[80:83]
v_mfma_f32_16x16x32_bf16 v[88:91], v[104:107], v[164:167], v[88:91]
v_mfma_f32_16x16x32_bf16 v[96:99], v[104:107], v[168:171], v[96:99]
v_fma_f32 v76, v76, s86, v204
v_fma_f32 v77, v77, s86, v204
v_fma_f32 v78, v78, s86, v204
v_fma_f32 v79, v79, s86, v204
s_nop 1
v_fma_f32 v80, v80, s86, v204
v_fma_f32 v81, v81, s86, v204
v_fma_f32 v82, v82, s86, v204
v_fma_f32 v83, v83, s86, v204
v_cvt_pk_bf16_f32 v76, v76, v77
v_cvt_pk_bf16_f32 v77, v78, v79
v_cvt_pk_bf16_f32 v78, v80, v81
v_cvt_pk_bf16_f32 v79, v82, v83
buffer_store_dwordx4 v[76:79], v16, s[52:55], s82 offen offset:0 sc1
v_fma_f32 v84, v84, s86, v208
v_fma_f32 v85, v85, s86, v208
v_fma_f32 v86, v86, s86, v208
v_fma_f32 v87, v87, s86, v208
v_fma_f32 v88, v88, s86, v208
v_fma_f32 v89, v89, s86, v208
v_fma_f32 v90, v90, s86, v208
v_fma_f32 v91, v91, s86, v208
v_cvt_pk_bf16_f32 v84, v84, v85
v_cvt_pk_bf16_f32 v85, v86, v87
v_cvt_pk_bf16_f32 v86, v88, v89
v_cvt_pk_bf16_f32 v87, v90, v91
buffer_store_dwordx4 v[84:87], v16, s[52:55], s83 offen offset:0 sc1
v_fma_f32 v92, v92, s86, v212
v_fma_f32 v93, v93, s86, v212
v_fma_f32 v94, v94, s86, v212
v_fma_f32 v95, v95, s86, v212
v_fma_f32 v96, v96, s86, v212
v_fma_f32 v97, v97, s86, v212
v_fma_f32 v98, v98, s86, v212
v_fma_f32 v99, v99, s86, v212
v_cvt_pk_bf16_f32 v92, v92, v93
v_cvt_pk_bf16_f32 v93, v94, v95
v_cvt_pk_bf16_f32 v94, v96, v97
v_cvt_pk_bf16_f32 v95, v98, v99
buffer_store_dwordx4 v[92:95], v16, s[52:55], s84 offen offset:0 sc1
s_branch L1_fin
L1_notq:
s_sub_u32 s4, s2, 32
s_cmp_lt_u32 s2, 32
s_cbranch_scc1 L1_edge
s_mov_b32 s61, 1
v_lshlrev_b32 v16, 4, v2
s_mul_i32 s63, s60, 6144
s_and_b32 s6, s4, 3
s_lshl_b32 s6, s6, 6
s_mul_i32 s7, s60, 8
s_add_u32 s6, s6, s7
v_lshrrev_b32 v5, 5, v2
v_and_b32 v6, 31, v2
v_lshlrev_b32 v6, 4, v6
v_mov_b32 v176, v6
s_cmp_ge_u32 s4, 4
s_cselect_b64 vcc, -1, 0
v_add3_u32 v7, v5, s6, 0
v_and_b32 v8, 0x80, v7
v_bfe_u32 v9, v7, 2, 1
v_lshl_or_b32 v8, v9, 6, v8
v_bfe_u32 v9, v7, 4, 1
v_lshl_or_b32 v8, v9, 5, v8
v_and_b32 v9, 3, v7
v_lshl_or_b32 v8, v9, 3, v8
v_bfe_u32 v9, v7, 5, 2
v_lshl_or_b32 v8, v9, 1, v8
v_bfe_u32 v9, v7, 3, 1
v_or_b32 v8, v9, v8
v_cndmask_b32 v8, v8, v7, vcc
v_lshl_add_u32 v40, v8, 9, v6
v_add3_u32 v7, v5, s6, 2
v_and_b32 v8, 0x80, v7
v_bfe_u32 v9, v7, 2, 1
v_lshl_or_b32 v8, v9, 6, v8
v_bfe_u32 v9, v7, 4, 1
v_lshl_or_b32 v8, v9, 5, v8
v_and_b32 v9, 3, v7
v_lshl_or_b32 v8, v9, 3, v8
v_bfe_u32 v9, v7, 5, 2
v_lshl_or_b32 v8, v9, 1, v8
v_bfe_u32 v9, v7, 3, 1
v_or_b32 v8, v9, v8
v_cndmask_b32 v8, v8, v7, vcc
v_lshl_add_u32 v44, v8, 9, v6
v_add3_u32 v7, v5, s6, 4
v_and_b32 v8, 0x80, v7
v_bfe_u32 v9, v7, 2, 1
v_lshl_or_b32 v8, v9, 6, v8
v_bfe_u32 v9, v7, 4, 1
v_lshl_or_b32 v8, v9, 5, v8
v_and_b32 v9, 3, v7
v_lshl_or_b32 v8, v9, 3, v8
v_bfe_u32 v9, v7, 5, 2
v_lshl_or_b32 v8, v9, 1, v8
v_bfe_u32 v9, v7, 3, 1
v_or_b32 v8, v9, v8
v_cndmask_b32 v8, v8, v7, vcc
v_lshl_add_u32 v48, v8, 9, v6
v_add3_u32 v7, v5, s6, 6
v_and_b32 v8, 0x80, v7
v_bfe_u32 v9, v7, 2, 1
v_lshl_or_b32 v8, v9, 6, v8
v_bfe_u32 v9, v7, 4, 1
v_lshl_or_b32 v8, v9, 5, v8
v_and_b32 v9, 3, v7
v_lshl_or_b32 v8, v9, 3, v8
v_bfe_u32 v9, v7, 5, 2
v_lshl_or_b32 v8, v9, 1, v8
v_bfe_u32 v9, v7, 3, 1
v_or_b32 v8, v9, v8
v_cndmask_b32 v8, v8, v7, vcc
v_lshl_add_u32 v52, v8, 9, v6
s_lshl_b32 s7, s60, 6
v_lshrrev_b32 v5, 2, v2
v_and_b32 v6, 3, v2
v_lshrrev_b32 v7, 5, v2
v_lshlrev_b32 v7, 1, v7
v_xor_b32 v6, v6, v7
v_lshl_add_u32 v5, v5, 9, s7
v_lshl_add_u32 v17, v6, 4, v5
v_add_u32 v18, 0x1c00, v17
s_xor_b32 s6, s62, 0
s_lshl_b32 s66, s6, 14
s_xor_b32 s6, s62, 1
s_lshl_b32 s67, s6, 14
s_xor_b32 s6, s62, 2
s_lshl_b32 s68, s6, 14
s_xor_b32 s6, s62, 3
s_lshl_b32 s69, s6, 14
s_xor_b32 s6, s62, 4
s_lshl_b32 s70, s6, 14
s_xor_b32 s6, s62, 5
s_lshl_b32 s71, s6, 14
s_xor_b32 s6, s62, 6
s_lshl_b32 s72, s6, 14
s_xor_b32 s6, s62, 7
s_lshl_b32 s73, s6, 14
s_waitcnt lgkmcnt(0)
s_cmp_ge_u32 s4, 4
s_cselect_b32 s6, s30, s24
s_cselect_b32 s7, s31, s25
s_add_u32 s40, s6, 0x0
s_addc_u32 s41, s7, 0
s_mov_b32 s42, 0x20000
s_mov_b32 s43, 0x00020000
s_add_u32 s44, s32, 0x0
s_addc_u32 s45, s33, 0
s_mov_b32 s46, 0x20000
s_mov_b32 s47, 0x00020000
buffer_load_dwordx4 v[40:43], v40, s[40:43], 0 offen
buffer_load_dwordx4 v[44:47], v44, s[40:43], 0 offen
buffer_load_dwordx4 v[48:51], v48, s[40:43], 0 offen
buffer_load_dwordx4 v[52:55], v52, s[40:43], 0 offen
buffer_load_dwordx4 v[176:179], v176, s[40:43], 0 offen
s_add_u32 m0, s63, 0x0
s_nop 0
buffer_load_dwordx4 v17, s[44:47], s66 offen offset:0 lds
buffer_load_dwordx4 v18, s[44:47], s66 offen offset:1024 lds
s_add_u32 m0, s63, 0x800
s_nop 0
buffer_load_dwordx4 v17, s[44:47], s67 offen offset:0 lds
buffer_load_dwordx4 v18, s[44:47], s67 offen offset:1024 lds
v_bfe_u32 v5, v2, 2, 3
v_xor_b32 v5, s62, v5
v_and_b32 v6, 3, v2
v_lshlrev_b32 v7, 10, v5
v_lshl_add_u32 v7, v6, 8, v7
v_add_u32 v7, 0xc000, v7
v_and_b32 v5, 1, v5
v_lshl_or_b32 v6, v5, 2, v6
v_lshrrev_b32 v5, 5, v2
s_mul_i32 s6, s60, 8
v_add3_u32 v8, v5, s6, 0
v_lshrrev_b32 v9, 4, v8
v_lshl_add_u32 v9, v9, 13, v7
v_and_b32 v8, 15, v8
v_xor_b32 v8, v8, v6
v_lshl_add_u32 v36, v8, 4, v9
v_add3_u32 v8, v5, s6, 2
v_lshrrev_b32 v9, 4, v8
v_lshl_add_u32 v9, v9, 13, v7
v_and_b32 v8, 15, v8
v_xor_b32 v8, v8, v6
v_lshl_add_u32 v37, v8, 4, v9
v_add3_u32 v8, v5, s6, 4
v_lshrrev_b32 v9, 4, v8
v_lshl_add_u32 v9, v9, 13, v7
v_and_b32 v8, 15, v8
v_xor_b32 v8, v8, v6
v_lshl_add_u32 v38, v8, 4, v9
v_add3_u32 v8, v5, s6, 6
v_lshrrev_b32 v9, 4, v8
v_lshl_add_u32 v9, v9, 13, v7
v_and_b32 v8, 15, v8
v_xor_b32 v8, v8, v6
v_lshl_add_u32 v39, v8, 4, v9
v_xor_b32 v5, v3, v4
v_lshlrev_b32 v5, 4, v5
v_lshl_add_u32 v5, v4, 8, v5
v_add_u32 v31, 0xc000, v5
v_xor_b32 v32, 64, v31
v_lshrrev_b32 v5, 2, v3
v_and_b32 v6, 3, v3
v_and_b32 v7, 1, v4
v_lshlrev_b32 v7, 1, v7
v_lshl_add_u32 v8, v4, 3, v5
v_lshlrev_b32 v8, 6, v8
v_add_u32 v8, s63, v8
v_xor_b32 v6, v6, v7
v_xor_b32 v9, 0, v6
v_lshl_add_u32 v25, v9, 4, v8
v_add_u32 v26, 8, v25
s_lshr_b32 s6, s4, 2
s_lshl_b32 s6, s6, 17
s_and_b32 s7, s4, 3
s_lshl_b32 s7, s7, 12
s_add_u32 s6, s6, s7
s_mul_i32 s7, s60, 16384
s_add_u32 s82, s6, s7
s_add_u32 s83, s82, 16384
s_add_u32 s52, s38, 0x1000000
s_addc_u32 s53, s39, 0
s_mov_b32 s54, 0x40000
s_mov_b32 s55, 0x00020000
s_mov_b32 s90, 0xffff0000
s_waitcnt vmcnt(4)
v_lshlrev_b32 v180, 16, v176
v_and_b32 v181, s90, v176
v_lshlrev_b32 v182, 16, v177
v_and_b32 v183, s90, v177
v_lshlrev_b32 v184, 16, v178
v_and_b32 v185, s90, v178
v_lshlrev_b32 v186, 16, v179
v_and_b32 v187, s90, v179
v_lshlrev_b32 v176, 16, v40
v_and_b32 v177, s90, v40
v_sub_f32 v176, v176, v180
v_sub_f32 v177, v177, v181
v_cvt_pk_bf16_f32 v40, v176, v177
v_lshlrev_b32 v176, 16, v41
v_and_b32 v177, s90, v41
v_sub_f32 v176, v176, v182
v_sub_f32 v177, v177, v183
v_cvt_pk_bf16_f32 v41, v176, v177
v_lshlrev_b32 v176, 16, v42
v_and_b32 v177, s90, v42
v_sub_f32 v176, v176, v184
v_sub_f32 v177, v177, v185
v_cvt_pk_bf16_f32 v42, v176, v177
v_lshlrev_b32 v176, 16, v43
v_and_b32 v177, s90, v43
v_sub_f32 v176, v176, v186
v_sub_f32 v177, v177, v187
v_cvt_pk_bf16_f32 v43, v176, v177
v_lshlrev_b32 v176, 16, v44
v_and_b32 v177, s90, v44
v_sub_f32 v176, v176, v180
v_sub_f32 v177, v177, v181
v_cvt_pk_bf16_f32 v44, v176, v177
v_lshlrev_b32 v176, 16, v45
v_and_b32 v177, s90, v45
v_sub_f32 v176, v176, v182
v_sub_f32 v177, v177, v183
v_cvt_pk_bf16_f32 v45, v176, v177
v_lshlrev_b32 v176, 16, v46
v_and_b32 v177, s90, v46
v_sub_f32 v176, v176, v184
v_sub_f32 v177, v177, v185
v_cvt_pk_bf16_f32 v46, v176, v177
v_lshlrev_b32 v176, 16, v47
v_and_b32 v177, s90, v47
v_sub_f32 v176, v176, v186
v_sub_f32 v177, v177, v187
v_cvt_pk_bf16_f32 v47, v176, v177
v_lshlrev_b32 v176, 16, v48
v_and_b32 v177, s90, v48
v_sub_f32 v176, v176, v180
v_sub_f32 v177, v177, v181
v_cvt_pk_bf16_f32 v48, v176, v177
v_lshlrev_b32 v176, 16, v49
v_and_b32 v177, s90, v49
v_sub_f32 v176, v176, v182
v_sub_f32 v177, v177, v183
v_cvt_pk_bf16_f32 v49, v176, v177
v_lshlrev_b32 v176, 16, v50
v_and_b32 v177, s90, v50
v_sub_f32 v176, v176, v184
v_sub_f32 v177, v177, v185
v_cvt_pk_bf16_f32 v50, v176, v177
v_lshlrev_b32 v176, 16, v51
v_and_b32 v177, s90, v51
v_sub_f32 v176, v176, v186
v_sub_f32 v177, v177, v187
v_cvt_pk_bf16_f32 v51, v176, v177
v_lshlrev_b32 v176, 16, v52
v_and_b32 v177, s90, v52
v_sub_f32 v176, v176, v180
v_sub_f32 v177, v177, v181
v_cvt_pk_bf16_f32 v52, v176, v177
v_lshlrev_b32 v176, 16, v53
v_and_b32 v177, s90, v53
v_sub_f32 v176, v176, v182
v_sub_f32 v177, v177, v183
v_cvt_pk_bf16_f32 v53, v176, v177
v_lshlrev_b32 v176, 16, v54
v_and_b32 v177, s90, v54
v_sub_f32 v176, v176, v184
v_sub_f32 v177, v177, v185
v_cvt_pk_bf16_f32 v54, v176, v177
v_lshlrev_b32 v176, 16, v55
v_and_b32 v177, s90, v55
v_sub_f32 v176, v176, v186
v_sub_f32 v177, v177, v187
v_cvt_pk_bf16_f32 v55, v176, v177
ds_write_b128 v36, v[40:43]
ds_write_b128 v37, v[44:47]
ds_write_b128 v38, v[48:51]
ds_write_b128 v39, v[52:55]
s_add_u32 m0, s63, 0x1000
s_nop 0
buffer_load_dwordx4 v17, s[44:47], s68 offen offset:0 lds
buffer_load_dwordx4 v18, s[44:47], s68 offen offset:1024 lds
s_waitcnt vmcnt(4)
ds_read_b64_tr_b16 v[88:89], v25 offset:0
ds_read_b64_tr_b16 v[90:91], v25 offset:256
ds_read_b64_tr_b16 v[92:93], v26 offset:0
ds_read_b64_tr_b16 v[94:95], v26 offset:256
s_waitcnt lgkmcnt(4)
s_barrier
ds_read_b128 v[112:115], v31 offset:0
ds_read_b128 v[116:119], v31 offset:8192
ds_read_b128 v[120:123], v31 offset:16384
ds_read_b128 v[124:127], v31 offset:24576
ds_read_b128 v[128:131], v32 offset:1024
s_waitcnt vmcnt(2)
ds_read_b64_tr_b16 v[96:97], v25 offset:2048
ds_read_b64_tr_b16 v[98:99], v25 offset:2304
s_waitcnt lgkmcnt(6)
v_mfma_f32_16x16x32_bf16 v[56:59], v[112:115], v[88:91], 0
ds_read_b128 v[132:135], v32 offset:9216
s_waitcnt lgkmcnt(6)
v_mfma_f32_16x16x32_bf16 v[60:63], v[116:119], v[88:91], 0
ds_read_b128 v[136:139], v32 offset:17408
s_waitcnt lgkmcnt(6)
v_mfma_f32_16x16x32_bf16 v[64:67], v[120:123], v[88:91], 0
ds_read_b128 v[140:143], v32 offset:25600
s_waitcnt lgkmcnt(6)
v_mfma_f32_16x16x32_bf16 v[68:71], v[124:127], v[88:91], 0
ds_read_b64_tr_b16 v[100:101], v26 offset:2048
ds_read_b64_tr_b16 v[102:103], v26 offset:2304
v_mfma_f32_16x16x32_bf16 v[72:75], v[112:115], v[92:95], 0
s_add_u32 m0, s63, 0x0
s_nop 0
buffer_load_dwordx4 v17, s[44:47], s69 offen offset:0 lds
buffer_load_dwordx4 v18, s[44:47], s69 offen offset:1024 lds
v_mfma_f32_16x16x32_bf16 v[76:79], v[116:119], v[92:95], 0
v_mfma_f32_16x16x32_bf16 v[80:83], v[120:123], v[92:95], 0
v_mfma_f32_16x16x32_bf16 v[84:87], v[124:127], v[92:95], 0
ds_read_b128 v[144:147], v31 offset:2048
s_waitcnt vmcnt(2)
ds_read_b64_tr_b16 v[104:105], v25 offset:4096
ds_read_b64_tr_b16 v[106:107], v25 offset:4352
s_waitcnt lgkmcnt(8)
v_mfma_f32_16x16x32_bf16 v[56:59], v[128:131], v[96:99], v[56:59]
ds_read_b128 v[148:151], v31 offset:10240
s_waitcnt lgkmcnt(8)
v_mfma_f32_16x16x32_bf16 v[60:63], v[132:135], v[96:99], v[60:63]
ds_read_b128 v[152:155], v31 offset:18432
s_waitcnt lgkmcnt(8)
v_mfma_f32_16x16x32_bf16 v[64:67], v[136:139], v[96:99], v[64:67]
ds_read_b128 v[156:159], v31 offset:26624
s_waitcnt lgkmcnt(8)
v_mfma_f32_16x16x32_bf16 v[68:71], v[140:143], v[96:99], v[68:71]
ds_read_b64_tr_b16 v[108:109], v26 offset:4096
ds_read_b64_tr_b16 v[110:111], v26 offset:4352
s_waitcnt lgkmcnt(8)
v_mfma_f32_16x16x32_bf16 v[72:75], v[128:131], v[100:103], v[72:75]
s_add_u32 m0, s63, 0x800
s_nop 0
buffer_load_dwordx4 v17, s[44:47], s70 offen offset:0 lds
buffer_load_dwordx4 v18, s[44:47], s70 offen offset:1024 lds
v_mfma_f32_16x16x32_bf16 v[76:79], v[132:135], v[100:103], v[76:79]
v_mfma_f32_16x16x32_bf16 v[80:83], v[136:139], v[100:103], v[80:83]
v_mfma_f32_16x16x32_bf16 v[84:87], v[140:143], v[100:103], v[84:87]
ds_read_b128 v[160:163], v32 offset:3072
s_waitcnt vmcnt(2)
ds_read_b64_tr_b16 v[88:89], v25 offset:0
ds_read_b64_tr_b16 v[90:91], v25 offset:256
s_waitcnt lgkmcnt(8)
v_mfma_f32_16x16x32_bf16 v[56:59], v[144:147], v[104:107], v[56:59]
ds_read_b128 v[164:167], v32 offset:11264
s_waitcnt lgkmcnt(8)
v_mfma_f32_16x16x32_bf16 v[60:63], v[148:151], v[104:107], v[60:63]
ds_read_b128 v[168:171], v32 offset:19456
s_waitcnt lgkmcnt(8)
v_mfma_f32_16x16x32_bf16 v[64:67], v[152:155], v[104:107], v[64:67]
ds_read_b128 v[172:175], v32 offset:27648
s_waitcnt lgkmcnt(8)
v_mfma_f32_16x16x32_bf16 v[68:71], v[156:159], v[104:107], v[68:71]
ds_read_b64_tr_b16 v[92:93], v26 offset:0
ds_read_b64_tr_b16 v[94:95], v26 offset:256
s_waitcnt lgkmcnt(8)
v_mfma_f32_16x16x32_bf16 v[72:75], v[144:147], v[108:111], v[72:75]
s_add_u32 m0, s63, 0x1000
s_nop 0
buffer_load_dwordx4 v17, s[44:47], s71 offen offset:0 lds
buffer_load_dwordx4 v18, s[44:47], s71 offen offset:1024 lds
v_mfma_f32_16x16x32_bf16 v[76:79], v[148:151], v[108:111], v[76:79]
v_mfma_f32_16x16x32_bf16 v[80:83], v[152:155], v[108:111], v[80:83]
v_mfma_f32_16x16x32_bf16 v[84:87], v[156:159], v[108:111], v[84:87]
ds_read_b128 v[112:115], v31 offset:4096
s_waitcnt vmcnt(2)
ds_read_b64_tr_b16 v[96:97], v25 offset:2048
ds_read_b64_tr_b16 v[98:99], v25 offset:2304
s_waitcnt lgkmcnt(8)
v_mfma_f32_16x16x32_bf16 v[56:59], v[160:163], v[88:91], v[56:59]
ds_read_b128 v[116:119], v31 offset:12288
s_waitcnt lgkmcnt(8)
v_mfma_f32_16x16x32_bf16 v[60:63], v[164:167], v[88:91], v[60:63]
ds_read_b128 v[120:123], v31 offset:20480
s_waitcnt lgkmcnt(8)
v_mfma_f32_16x16x32_bf16 v[64:67], v[168:171], v[88:91], v[64:67]
ds_read_b128 v[124:127], v31 offset:28672
s_waitcnt lgkmcnt(8)
v_mfma_f32_16x16x32_bf16 v[68:71], v[172:175], v[88:91], v[68:71]
ds_read_b64_tr_b16 v[100:101], v26 offset:2048
ds_read_b64_tr_b16 v[102:103], v26 offset:2304
s_waitcnt lgkmcnt(8)
v_mfma_f32_16x16x32_bf16 v[72:75], v[160:163], v[92:95], v[72:75]
s_add_u32 m0, s63, 0x0
s_nop 0
buffer_load_dwordx4 v17, s[44:47], s72 offen offset:0 lds
buffer_load_dwordx4 v18, s[44:47], s72 offen offset:1024 lds
v_mfma_f32_16x16x32_bf16 v[76:79], v[164:167], v[92:95], v[76:79]
v_mfma_f32_16x16x32_bf16 v[80:83], v[168:171], v[92:95], v[80:83]
v_mfma_f32_16x16x32_bf16 v[84:87], v[172:175], v[92:95], v[84:87]
ds_read_b128 v[128:131], v32 offset:5120
s_waitcnt vmcnt(2)
ds_read_b64_tr_b16 v[104:105], v25 offset:4096
ds_read_b64_tr_b16 v[106:107], v25 offset:4352
s_waitcnt lgkmcnt(8)
v_mfma_f32_16x16x32_bf16 v[56:59], v[112:115], v[96:99], v[56:59]
ds_read_b128 v[132:135], v32 offset:13312
s_waitcnt lgkmcnt(8)
v_mfma_f32_16x16x32_bf16 v[60:63], v[116:119], v[96:99], v[60:63]
ds_read_b128 v[136:139], v32 offset:21504
s_waitcnt lgkmcnt(8)
v_mfma_f32_16x16x32_bf16 v[64:67], v[120:123], v[96:99], v[64:67]
ds_read_b128 v[140:143], v32 offset:29696
s_waitcnt lgkmcnt(8)
v_mfma_f32_16x16x32_bf16 v[68:71], v[124:127], v[96:99], v[68:71]
ds_read_b64_tr_b16 v[108:109], v26 offset:4096
ds_read_b64_tr_b16 v[110:111], v26 offset:4352
s_waitcnt lgkmcnt(8)
v_mfma_f32_16x16x32_bf16 v[72:75], v[112:115], v[100:103], v[72:75]
s_add_u32 m0, s63, 0x800
s_nop 0
buffer_load_dwordx4 v17, s[44:47], s73 offen offset:0 lds
buffer_load_dwordx4 v18, s[44:47], s73 offen offset:1024 lds
v_mfma_f32_16x16x32_bf16 v[76:79], v[116:119], v[100:103], v[76:79]
v_mfma_f32_16x16x32_bf16 v[80:83], v[120:123], v[100:103], v[80:83]
v_mfma_f32_16x16x32_bf16 v[84:87], v[124:127], v[100:103], v[84:87]
ds_read_b128 v[144:147], v31 offset:6144
s_waitcnt vmcnt(2)
ds_read_b64_tr_b16 v[88:89], v25 offset:0
ds_read_b64_tr_b16 v[90:91], v25 offset:256
s_waitcnt lgkmcnt(8)
v_mfma_f32_16x16x32_bf16 v[56:59], v[128:131], v[104:107], v[56:59]
ds_read_b128 v[148:151], v31 offset:14336
s_waitcnt lgkmcnt(8)
v_mfma_f32_16x16x32_bf16 v[60:63], v[132:135], v[104:107], v[60:63]
ds_read_b128 v[152:155], v31 offset:22528
s_waitcnt lgkmcnt(8)
v_mfma_f32_16x16x32_bf16 v[64:67], v[136:139], v[104:107], v[64:67]
ds_read_b128 v[156:159], v31 offset:30720
s_waitcnt lgkmcnt(8)
v_mfma_f32_16x16x32_bf16 v[68:71], v[140:143], v[104:107], v[68:71]
ds_read_b64_tr_b16 v[92:93], v26 offset:0
ds_read_b64_tr_b16 v[94:95], v26 offset:256
s_waitcnt lgkmcnt(8)
v_mfma_f32_16x16x32_bf16 v[72:75], v[128:131], v[108:111], v[72:75]
v_mfma_f32_16x16x32_bf16 v[76:79], v[132:135], v[108:111], v[76:79]
v_mfma_f32_16x16x32_bf16 v[80:83], v[136:139], v[108:111], v[80:83]
v_mfma_f32_16x16x32_bf16 v[84:87], v[140:143], v[108:111], v[84:87]
ds_read_b128 v[160:163], v32 offset:7168
s_waitcnt vmcnt(0)
ds_read_b64_tr_b16 v[96:97], v25 offset:2048
ds_read_b64_tr_b16 v[98:99], v25 offset:2304
s_waitcnt lgkmcnt(8)
v_mfma_f32_16x16x32_bf16 v[56:59], v[144:147], v[88:91], v[56:59]
ds_read_b128 v[164:167], v32 offset:15360
s_waitcnt lgkmcnt(8)
v_mfma_f32_16x16x32_bf16 v[60:63], v[148:151], v[88:91], v[60:63]
ds_read_b128 v[168:171], v32 offset:23552
s_waitcnt lgkmcnt(8)
v_mfma_f32_16x16x32_bf16 v[64:67], v[152:155], v[88:91], v[64:67]
ds_read_b128 v[172:175], v32 offset:31744
s_waitcnt lgkmcnt(8)
v_mfma_f32_16x16x32_bf16 v[68:71], v[156:159], v[88:91], v[68:71]
ds_read_b64_tr_b16 v[100:101], v26 offset:2048
ds_read_b64_tr_b16 v[102:103], v26 offset:2304
s_waitcnt lgkmcnt(8)
v_mfma_f32_16x16x32_bf16 v[72:75], v[144:147], v[92:95], v[72:75]
v_mfma_f32_16x16x32_bf16 v[76:79], v[148:151], v[92:95], v[76:79]
v_mfma_f32_16x16x32_bf16 v[80:83], v[152:155], v[92:95], v[80:83]
v_mfma_f32_16x16x32_bf16 v[84:87], v[156:159], v[92:95], v[84:87]
s_waitcnt lgkmcnt(5)
v_mfma_f32_16x16x32_bf16 v[56:59], v[160:163], v[96:99], v[56:59]
s_waitcnt lgkmcnt(4)
v_mfma_f32_16x16x32_bf16 v[60:63], v[164:167], v[96:99], v[60:63]
s_waitcnt lgkmcnt(3)
v_mfma_f32_16x16x32_bf16 v[64:67], v[168:171], v[96:99], v[64:67]
s_waitcnt lgkmcnt(2)
v_mfma_f32_16x16x32_bf16 v[68:71], v[172:175], v[96:99], v[68:71]
s_waitcnt lgkmcnt(0)
v_mfma_f32_16x16x32_bf16 v[72:75], v[160:163], v[100:103], v[72:75]
v_cvt_pk_bf16_f32 v56, v56, v57
v_cvt_pk_bf16_f32 v57, v58, v59
v_cvt_pk_bf16_f32 v58, v60, v61
v_cvt_pk_bf16_f32 v59, v62, v63
buffer_store_dwordx4 v[56:59], v16, s[52:55], s82 offen offset:0 sc1
v_mfma_f32_16x16x32_bf16 v[76:79], v[164:167], v[100:103], v[76:79]
v_mfma_f32_16x16x32_bf16 v[80:83], v[168:171], v[100:103], v[80:83]
v_cvt_pk_bf16_f32 v64, v64, v65
v_cvt_pk_bf16_f32 v65, v66, v67
v_cvt_pk_bf16_f32 v66, v68, v69
v_cvt_pk_bf16_f32 v67, v70, v71
buffer_store_dwordx4 v[64:67], v16, s[52:55], s82 offen offset:2048 sc1
v_mfma_f32_16x16x32_bf16 v[84:87], v[172:175], v[100:103], v[84:87]
v_cvt_pk_bf16_f32 v72, v72, v73
v_cvt_pk_bf16_f32 v73, v74, v75
v_cvt_pk_bf16_f32 v74, v76, v77
v_cvt_pk_bf16_f32 v75, v78, v79
buffer_store_dwordx4 v[72:75], v16, s[52:55], s82 offen offset:1024 sc1
v_cvt_pk_bf16_f32 v80, v80, v81
v_cvt_pk_bf16_f32 v81, v82, v83
s_nop 0
v_cvt_pk_bf16_f32 v82, v84, v85
v_cvt_pk_bf16_f32 v83, v86, v87
buffer_store_dwordx4 v[80:83], v16, s[52:55], s82 offen offset:3072 sc1
s_branch L1_fin
L1_edge:
s_mov_b32 s61, 4
s_mov_b32 s4, s2
s_mul_i32 s6, s4, 20000
v_lshlrev_b32 v5, 4, v0
v_lshlrev_b32 v6, 2, v2
v_add_u32 v6, 0x10000, v6
v_mov_b32 v7, 0
ds_write_b32 v6, v7
s_mov_b32 s66, 0
s_mov_b32 s67, 8192
s_mov_b32 s68, 16384
s_waitcnt lgkmcnt(0)
s_add_u32 s40, s20, 0x0
s_addc_u32 s41, s21, 0
s_add_u32 s40, s40, s6
s_addc_u32 s41, s41, 0
s_mov_b32 s42, 0x4e20
s_mov_b32 s43, 0x00020000
s_add_u32 s44, s18, 0x0
s_addc_u32 s45, s19, 0
s_add_u32 s44, s44, s6
s_addc_u32 s45, s45, 0
s_mov_b32 s46, 0x4e20
s_mov_b32 s47, 0x00020000
buffer_load_dwordx4 v[16:19], v5, s[40:43], s66 offen
buffer_load_dwordx4 v[20:23], v5, s[40:43], s67 offen
buffer_load_dwordx4 v[24:27], v5, s[40:43], s68 offen
buffer_load_dwordx4 v[28:31], v5, s[44:47], s66 offen
buffer_load_dwordx4 v[32:35], v5, s[44:47], s67 offen
buffer_load_dwordx4 v[36:39], v5, s[44:47], s68 offen
s_add_u32 s48, s38, 0x8000000
s_addc_u32 s49, s39, 0
s_mov_b32 s50, 0x2800000
s_mov_b32 s51, 0x00020000
s_add_u32 s52, s38, 0x7800000
s_addc_u32 s53, s39, 0
s_mov_b32 s54, 0x2000
s_mov_b32 s55, 0x00020000
s_mov_b32 s9, 6679
s_mov_b32 s10, 4294967139
s_mov_b32 s11, 0x10000
v_mov_b32 v7, 1
v_cmp_gt_u32 vcc, 0xe2, v0
s_mov_b64 s[12:13], vcc
s_barrier
s_waitcnt vmcnt(5)
v_mul_u32_u24 v40, s9, v16
v_lshrrev_b32 v40, 20, v40
v_lshl_add_u32 v52, v40, 2, s11
ds_add_rtn_u32 v52, v52, v7
v_mad_i32_i24 v16, v40, s10, v16
v_mul_u32_u24 v41, s9, v17
v_lshrrev_b32 v41, 20, v41
v_lshl_add_u32 v53, v41, 2, s11
ds_add_rtn_u32 v53, v53, v7
v_mad_i32_i24 v17, v41, s10, v17
v_mul_u32_u24 v42, s9, v18
v_lshrrev_b32 v42, 20, v42
v_lshl_add_u32 v54, v42, 2, s11
ds_add_rtn_u32 v54, v54, v7
v_mad_i32_i24 v18, v42, s10, v18
v_mul_u32_u24 v43, s9, v19
v_lshrrev_b32 v43, 20, v43
v_lshl_add_u32 v55, v43, 2, s11
ds_add_rtn_u32 v55, v55, v7
v_mad_i32_i24 v19, v43, s10, v19
s_waitcnt vmcnt(4)
v_mul_u32_u24 v44, s9, v20
v_lshrrev_b32 v44, 20, v44
v_lshl_add_u32 v56, v44, 2, s11
ds_add_rtn_u32 v56, v56, v7
v_mad_i32_i24 v20, v44, s10, v20
v_mul_u32_u24 v45, s9, v21
v_lshrrev_b32 v45, 20, v45
v_lshl_add_u32 v57, v45, 2, s11
ds_add_rtn_u32 v57, v57, v7
v_mad_i32_i24 v21, v45, s10, v21
v_mul_u32_u24 v46, s9, v22
v_lshrrev_b32 v46, 20, v46
v_lshl_add_u32 v58, v46, 2, s11
ds_add_rtn_u32 v58, v58, v7
v_mad_i32_i24 v22, v46, s10, v22
v_mul_u32_u24 v47, s9, v23
v_lshrrev_b32 v47, 20, v47
v_lshl_add_u32 v59, v47, 2, s11
ds_add_rtn_u32 v59, v59, v7
v_mad_i32_i24 v23, v47, s10, v23
s_waitcnt vmcnt(3)
s_mov_b64 exec, s[12:13]
v_mul_u32_u24 v48, s9, v24
v_lshrrev_b32 v48, 20, v48
v_lshl_add_u32 v60, v48, 2, s11
ds_add_rtn_u32 v60, v60, v7
v_mad_i32_i24 v24, v48, s10, v24
v_mul_u32_u24 v49, s9, v25
v_lshrrev_b32 v49, 20, v49
v_lshl_add_u32 v61, v49, 2, s11
ds_add_rtn_u32 v61, v61, v7
v_mad_i32_i24 v25, v49, s10, v25
v_mul_u32_u24 v50, s9, v26
v_lshrrev_b32 v50, 20, v50
v_lshl_add_u32 v62, v50, 2, s11
ds_add_rtn_u32 v62, v62, v7
v_mad_i32_i24 v26, v50, s10, v26
v_mul_u32_u24 v51, s9, v27
v_lshrrev_b32 v51, 20, v51
v_lshl_add_u32 v63, v51, 2, s11
ds_add_rtn_u32 v63, v63, v7
v_mad_i32_i24 v27, v51, s10, v27
s_mov_b64 exec, -1
s_waitcnt vmcnt(2) lgkmcnt(4)
v_and_b32 v8, 0x7f, v52
v_lshl_or_b32 v28, v16, 18, v28
v_lshlrev_b32 v8, 2, v8
v_lshl_add_u32 v8, v40, 9, v8
ds_write_b32 v8, v28
v_and_b32 v8, 0x7f, v53
v_lshl_or_b32 v29, v17, 18, v29
v_lshlrev_b32 v8, 2, v8
v_lshl_add_u32 v8, v41, 9, v8
ds_write_b32 v8, v29
v_and_b32 v8, 0x7f, v54
v_lshl_or_b32 v30, v18, 18, v30
v_lshlrev_b32 v8, 2, v8
v_lshl_add_u32 v8, v42, 9, v8
ds_write_b32 v8, v30
v_and_b32 v8, 0x7f, v55
v_lshl_or_b32 v31, v19, 18, v31
v_lshlrev_b32 v8, 2, v8
v_lshl_add_u32 v8, v43, 9, v8
ds_write_b32 v8, v31
s_waitcnt vmcnt(1) lgkmcnt(4)
v_and_b32 v8, 0x7f, v56
v_lshl_or_b32 v32, v20, 18, v32
v_lshlrev_b32 v8, 2, v8
v_lshl_add_u32 v8, v44, 9, v8
ds_write_b32 v8, v32
v_and_b32 v8, 0x7f, v57
v_lshl_or_b32 v33, v21, 18, v33
v_lshlrev_b32 v8, 2, v8
v_lshl_add_u32 v8, v45, 9, v8
ds_write_b32 v8, v33
v_and_b32 v8, 0x7f, v58
v_lshl_or_b32 v34, v22, 18, v34
v_lshlrev_b32 v8, 2, v8
v_lshl_add_u32 v8, v46, 9, v8
ds_write_b32 v8, v34
v_and_b32 v8, 0x7f, v59
v_lshl_or_b32 v35, v23, 18, v35
v_lshlrev_b32 v8, 2, v8
v_lshl_add_u32 v8, v47, 9, v8
ds_write_b32 v8, v35
s_waitcnt vmcnt(0) lgkmcnt(8)
s_mov_b64 exec, s[12:13]
v_and_b32 v8, 0x7f, v60
v_lshl_or_b32 v36, v24, 18, v36
v_lshlrev_b32 v8, 2, v8
v_lshl_add_u32 v8, v48, 9, v8
ds_write_b32 v8, v36
v_and_b32 v8, 0x7f, v61
v_lshl_or_b32 v37, v25, 18, v37
v_lshlrev_b32 v8, 2, v8
v_lshl_add_u32 v8, v49, 9, v8
ds_write_b32 v8, v37
v_and_b32 v8, 0x7f, v62
v_lshl_or_b32 v38, v26, 18, v38
v_lshlrev_b32 v8, 2, v8
v_lshl_add_u32 v8, v50, 9, v8
ds_write_b32 v8, v38
v_and_b32 v8, 0x7f, v63
v_lshl_or_b32 v39, v27, 18, v39
v_lshlrev_b32 v8, 2, v8
v_lshl_add_u32 v8, v51, 9, v8
ds_write_b32 v8, v39
s_mov_b64 exec, -1
s_waitcnt lgkmcnt(0)
s_barrier
ds_read_b32 v8, v6
s_mul_i32 s6, s60, 4096
v_lshlrev_b32 v10, 4, v2
v_add_u32 v9, s6, v10
ds_read_b128 v[64:67], v9 offset:0
ds_read_b128 v[68:71], v9 offset:1024
ds_read_b128 v[72:75], v9 offset:2048
ds_read_b128 v[76:79], v9 offset:3072
v_lshrrev_b32 v11, 5, v2
v_mul_u32_u24 v11, 0x9fe00, v11
v_add_u32 v10, v10, v11
s_mul_i32 s6, s60, 5242880
s_mul_i32 s7, s4, 20480
s_add_u32 s6, s6, s7
v_lshlrev_b32 v9, 7, v2
s_lshl_b32 s8, s4, 2
s_cmp_eq_u32 s60, 0
s_cselect_b32 s8, s8, 0x7fff0000
s_waitcnt lgkmcnt(4)
buffer_store_dword v8, v9, s[52:55], s8 offen
v_cmp_lt_u32 vcc, 0x80, v8
s_cbranch_vccnz L1_eslow
s_waitcnt lgkmcnt(3)
buffer_store_dwordx4 v[64:67], v10, s[48:51], s6 offen
s_add_u32 s6, s6, 1310720
s_waitcnt lgkmcnt(2)
buffer_store_dwordx4 v[68:71], v10, s[48:51], s6 offen
s_add_u32 s6, s6, 1310720
s_waitcnt lgkmcnt(1)
buffer_store_dwordx4 v[72:75], v10, s[48:51], s6 offen
s_add_u32 s6, s6, 1310720
s_waitcnt lgkmcnt(0)
buffer_store_dwordx4 v[76:79], v10, s[48:51], s6 offen
s_add_u32 s6, s6, 1310720
s_branch L1_fin
L1_eslow:
s_mov_b32 s9, 655360
v_mul_u32_u24 v40, s9, v40
v_lshl_add_u32 v40, v52, 2, v40
v_mul_u32_u24 v41, s9, v41
v_lshl_add_u32 v41, v53, 2, v41
v_mul_u32_u24 v42, s9, v42
v_lshl_add_u32 v42, v54, 2, v42
v_mul_u32_u24 v43, s9, v43
v_lshl_add_u32 v43, v55, 2, v43
v_mul_u32_u24 v44, s9, v44
v_lshl_add_u32 v44, v56, 2, v44
v_mul_u32_u24 v45, s9, v45
v_lshl_add_u32 v45, v57, 2, v45
v_mul_u32_u24 v46, s9, v46
v_lshl_add_u32 v46, v58, 2, v46
v_mul_u32_u24 v47, s9, v47
v_lshl_add_u32 v47, v59, 2, v47
v_mul_u32_u24 v48, s9, v48
v_lshl_add_u32 v48, v60, 2, v48
v_mul_u32_u24 v49, s9, v49
v_lshl_add_u32 v49, v61, 2, v49
v_mul_u32_u24 v50, s9, v50
v_lshl_add_u32 v50, v62, 2, v50
v_mul_u32_u24 v51, s9, v51
v_lshl_add_u32 v51, v63, 2, v51
buffer_store_dword v28, v40, s[48:51], s7 offen
buffer_store_dword v29, v41, s[48:51], s7 offen
buffer_store_dword v30, v42, s[48:51], s7 offen
buffer_store_dword v31, v43, s[48:51], s7 offen
buffer_store_dword v32, v44, s[48:51], s7 offen
buffer_store_dword v33, v45, s[48:51], s7 offen
buffer_store_dword v34, v46, s[48:51], s7 offen
buffer_store_dword v35, v47, s[48:51], s7 offen
s_mov_b64 exec, s[12:13]
buffer_store_dword v36, v48, s[48:51], s7 offen
buffer_store_dword v37, v49, s[48:51], s7 offen
buffer_store_dword v38, v50, s[48:51], s7 offen
buffer_store_dword v39, v51, s[48:51], s7 offen
s_mov_b64 exec, -1
L1_fin:
L1_end:
s_endpgm
.globl k2_kernel
.p2align 8
.type k2_kernel,@function
k2_kernel:
s_load_dwordx2 s[4:5], s[0:1], 88
s_and_b32 s35, s2, 7
s_lshr_b32 s37, s2, 3
s_cmp_ge_u32 s37, 30
s_cbranch_scc1 LE_start
s_mul_i32 s38, s37, 52
s_lshr_b32 s38, s38, 8
s_mul_i32 s39, s38, 5
s_sub_u32 s39, s37, s39
s_mov_b32 s37, s38
s_mul_i32 s38, s35, 5
s_add_u32 s38, s38, s39
v_lshrrev_b32 v1, 6, v0
v_and_b32 v252, 63, v0
v_lshlrev_b32 v252, 4, v252
v_readfirstlane_b32 s34, v1
s_mov_b32 s50, 0xe1a06800
s_mov_b32 s51, 0x4e608d04
s_mul_i32 s39, s37, 9
s_lshr_b64 s[50:51], s[50:51], s39
s_and_b32 s39, s50, 0x1ff
s_bfe_u32 s49, s50, 0x90009
s_sub_u32 s29, s49, s39
s_lshl_b32 s50, s37, 2
s_lshr_b32 s59, 0x544444, s50
s_and_b32 s59, s59, 15
s_sub_u32 s31, s29, s59
s_lshr_b32 s31, s31, 1
s_sub_u32 s31, s31, 1
s_lshl_b32 s39, s39, 14
s_lshl_b32 s49, s49, 14
s_add_u32 s28, s39, 0x4000
s_cmp_eq_u32 s37, 5
s_cselect_b32 s33, 0xff800000, 0
s_mov_b32 s32, 0xffff
v_and_b32 v2, 63, v0
v_bfe_u32 v3, v2, 3, 2
v_bfe_u32 v4, v2, 2, 1
v_lshlrev_b32 v251, 12, v3
v_lshl_or_b32 v251, v4, 9, v251
v_lshl_or_b32 v251, v1, 7, v251
v_lshrrev_b32 v4, 5, v2
v_lshl_or_b32 v251, v4, 6, v251
v_and_b32 v3, 2, v3
v_and_b32 v4, 3, v2
v_xor_b32 v3, v3, v4
v_lshl_or_b32 v251, v3, 4, v251
s_cmp_eq_u32 s38, 39
s_cbranch_scc1 LT_disp
s_lshl_b32 s30, s34, 12
s_mov_b32 m0, s30
s_waitcnt lgkmcnt(0)
s_add_u32 s12, s4, 0x6800000
s_addc_u32 s13, s5, 0
s_mov_b32 s14, s49
s_mov_b32 s15, 0x00020000
buffer_load_dwordx4 v251, s[12:15], s39 offen offset:0 lds
buffer_load_dwordx4 v251, s[12:15], s39 offen offset:1024 lds
buffer_load_dwordx4 v251, s[12:15], s39 offen offset:2048 lds
buffer_load_dwordx4 v251, s[12:15], s39 offen offset:3072 lds
s_add_u32 m0, s30, 0x4000
s_nop 0
buffer_load_dwordx4 v251, s[12:15], s28 offen offset:0 lds
buffer_load_dwordx4 v251, s[12:15], s28 offen offset:1024 lds
s_add_u32 s8, s4, 0x0
s_addc_u32 s9, s5, 0
s_mov_b32 s10, 0x4e4000
s_mov_b32 s11, 0x00020000
s_mul_i32 s35, s37, 0x600000
s_add_u32 s20, s4, 0x2000000
s_addc_u32 s21, s5, 0
s_add_u32 s20, s20, s35
s_addc_u32 s21, s21, 0
s_mov_b32 s22, 0x4e4000
s_mov_b32 s23, 0x00020000
s_add_u32 s24, s4, 0x6000000
s_addc_u32 s25, s5, 0
s_mov_b32 s26, 0x9c800
s_mov_b32 s27, 0x00020000
s_lshl_b32 s35, s38, 4
s_lshl_b32 s41, s34, 2
s_add_u32 s35, s35, s41
s_lshl_b32 s40, s35, 13
s_lshl_b32 s48, s35, 10
s_lshl_b32 s35, s37, 3
s_add_u32 s48, s48, s35
s_add_u32 s41, s40, 8192
s_add_u32 s42, s40, 16384
s_add_u32 s43, s40, 24576
s_add_u32 s44, s40, 4096
s_add_u32 s45, s41, 4096
s_add_u32 s46, s42, 4096
s_add_u32 s47, s43, 4096
s_mov_b32 s52, 0x71800000
s_mov_b32 s53, 0x0d800000
v_mov_b32 v208, 0
v_mov_b32 v209, 0
v_mov_b32 v210, 0
v_mov_b32 v211, 0
buffer_load_dwordx4 v[0:3], v252, s[8:11], s40 offen offset:0
buffer_load_dwordx4 v[32:35], v252, s[8:11], s41 offen offset:0
v_mfma_f32_32x32x16_bf16 a[0:15], v[208:211], v[208:211], 0
buffer_load_dwordx4 v[64:67], v252, s[8:11], s42 offen offset:0
buffer_load_dwordx4 v[96:99], v252, s[8:11], s43 offen offset:0
v_mfma_f32_32x32x16_bf16 a[16:31], v[208:211], v[208:211], 0
buffer_load_dwordx4 v[4:7], v252, s[8:11], s40 offen offset:1024
buffer_load_dwordx4 v[36:39], v252, s[8:11], s41 offen offset:1024
v_mfma_f32_32x32x16_bf16 a[32:47], v[208:211], v[208:211], 0
buffer_load_dwordx4 v[68:71], v252, s[8:11], s42 offen offset:1024
buffer_load_dwordx4 v[100:103], v252, s[8:11], s43 offen offset:1024
v_mfma_f32_32x32x16_bf16 a[48:63], v[208:211], v[208:211], 0
buffer_load_dwordx4 v[8:11], v252, s[8:11], s40 offen offset:2048
buffer_load_dwordx4 v[40:43], v252, s[8:11], s41 offen offset:2048
v_mfma_f32_32x32x16_bf16 a[64:79], v[208:211], v[208:211], 0
buffer_load_dwordx4 v[72:75], v252, s[8:11], s42 offen offset:2048
buffer_load_dwordx4 v[104:107], v252, s[8:11], s43 offen offset:2048
v_mfma_f32_32x32x16_bf16 a[80:95], v[208:211], v[208:211], 0
buffer_load_dwordx4 v[12:15], v252, s[8:11], s40 offen offset:3072
buffer_load_dwordx4 v[44:47], v252, s[8:11], s41 offen offset:3072
v_mfma_f32_32x32x16_bf16 a[96:111], v[208:211], v[208:211], 0
buffer_load_dwordx4 v[76:79], v252, s[8:11], s42 offen offset:3072
buffer_load_dwordx4 v[108:111], v252, s[8:11], s43 offen offset:3072
v_mfma_f32_32x32x16_bf16 a[112:127], v[208:211], v[208:211], 0
buffer_load_dwordx4 v[16:19], v252, s[8:11], s44 offen offset:0
buffer_load_dwordx4 v[48:51], v252, s[8:11], s45 offen offset:0
v_mfma_f32_32x32x16_bf16 a[128:143], v[208:211], v[208:211], 0
buffer_load_dwordx4 v[80:83], v252, s[8:11], s46 offen offset:0
buffer_load_dwordx4 v[112:115], v252, s[8:11], s47 offen offset:0
v_mfma_f32_32x32x16_bf16 a[144:159], v[208:211], v[208:211], 0
buffer_load_dwordx4 v[20:23], v252, s[8:11], s44 offen offset:1024
buffer_load_dwordx4 v[52:55], v252, s[8:11], s45 offen offset:1024
v_mfma_f32_32x32x16_bf16 a[160:175], v[208:211], v[208:211], 0
buffer_load_dwordx4 v[84:87], v252, s[8:11], s46 offen offset:1024
buffer_load_dwordx4 v[116:119], v252, s[8:11], s47 offen offset:1024
v_mfma_f32_32x32x16_bf16 a[176:191], v[208:211], v[208:211], 0
buffer_load_dwordx4 v[24:27], v252, s[8:11], s44 offen offset:2048
buffer_load_dwordx4 v[56:59], v252, s[8:11], s45 offen offset:2048
v_mfma_f32_32x32x16_bf16 a[192:207], v[208:211], v[208:211], 0
buffer_load_dwordx4 v[88:91], v252, s[8:11], s46 offen offset:2048
buffer_load_dwordx4 v[120:123], v252, s[8:11], s47 offen offset:2048
v_mfma_f32_32x32x16_bf16 a[208:223], v[208:211], v[208:211], 0
buffer_load_dwordx4 v[28:31], v252, s[8:11], s44 offen offset:3072
buffer_load_dwordx4 v[60:63], v252, s[8:11], s45 offen offset:3072
v_mfma_f32_32x32x16_bf16 a[224:239], v[208:211], v[208:211], 0
buffer_load_dwordx4 v[92:95], v252, s[8:11], s46 offen offset:3072
buffer_load_dwordx4 v[124:127], v252, s[8:11], s47 offen offset:3072
v_mfma_f32_32x32x16_bf16 a[240:255], v[208:211], v[208:211], 0
v_bfe_u32 v248, v252, 4, 3
v_lshlrev_b32 v248, 6, v248
v_bfe_u32 v253, v252, 7, 1
v_lshl_or_b32 v248, v253, 10, v248
v_bfe_u32 v253, v252, 8, 2
v_lshl_or_b32 v248, v253, 4, v248
v_bfe_u32 v253, v252, 6, 1
v_lshlrev_b32 v253, 5, v253
v_xor_b32 v248, v248, v253
v_and_b32 v249, 0x1c0, v252
v_bfe_u32 v253, v252, 9, 1
v_lshl_or_b32 v249, v253, 10, v249
v_bfe_u32 v253, v252, 8, 1
v_lshl_or_b32 v249, v253, 5, v249
v_bfe_u32 v253, v252, 4, 2
v_lshl_or_b32 v249, v253, 3, v249
v_xor_b32 v250, 32, v249
s_waitcnt vmcnt(32)
s_barrier
ds_read_b128 v[224:227], v248 offset:0
ds_read_b128 v[228:231], v248 offset:512
ds_read_b128 v[232:235], v248 offset:2048
ds_read_b128 v[236:239], v248 offset:2560
s_waitcnt lgkmcnt(2)
s_waitcnt vmcnt(24)
v_mfma_f32_16x16x32_bf16 v[160:163], v[224:227], v[0:3], 0
ds_read_b128 v[240:243], v248 offset:16384
v_mfma_f32_16x16x32_bf16 v[160:163], v[228:231], v[4:7], v[160:163]
buffer_load_dwordx4 v251, s[12:15], s28 offen offset:2048 lds
v_mfma_f32_16x16x32_bf16 v[164:167], v[224:227], v[32:35], 0
v_mfma_f32_16x16x32_bf16 v[164:167], v[228:231], v[36:39], v[164:167]
buffer_load_dwordx4 v251, s[12:15], s28 offen offset:3072 lds
v_mfma_f32_16x16x32_bf16 v[168:171], v[224:227], v[64:67], 0
ds_read_b128 v[244:247], v248 offset:16896
v_mfma_f32_16x16x32_bf16 v[168:171], v[228:231], v[68:71], v[168:171]
s_add_u32 s28, s28, 0x4000
s_add_u32 m0, s30, 0x8000
s_nop 0
v_mfma_f32_16x16x32_bf16 v[172:175], v[224:227], v[96:99], 0
v_mfma_f32_16x16x32_bf16 v[172:175], v[228:231], v[100:103], v[172:175]
s_waitcnt lgkmcnt(2)
buffer_load_dwordx4 v251, s[12:15], s28 offen offset:0 lds
v_mfma_f32_16x16x32_bf16 v[176:179], v[232:235], v[0:3], 0
ds_read_b128 v[224:227], v248 offset:4096
v_mfma_f32_16x16x32_bf16 v[176:179], v[236:239], v[4:7], v[176:179]
buffer_load_dwordx4 v251, s[12:15], s28 offen offset:1024 lds
v_mfma_f32_16x16x32_bf16 v[180:183], v[232:235], v[32:35], 0
v_mfma_f32_16x16x32_bf16 v[180:183], v[236:239], v[36:39], v[180:183]
v_mfma_f32_16x16x32_bf16 v[184:187], v[232:235], v[64:67], 0
ds_read_b128 v[228:231], v248 offset:4608
v_mfma_f32_16x16x32_bf16 v[184:187], v[236:239], v[68:71], v[184:187]
v_mfma_f32_16x16x32_bf16 v[188:191], v[232:235], v[96:99], 0
v_mfma_f32_16x16x32_bf16 v[188:191], v[236:239], v[100:103], v[188:191]
s_waitcnt lgkmcnt(2)
v_mfma_f32_16x16x32_bf16 v[192:195], v[240:243], v[0:3], 0
ds_read_b128 v[232:235], v248 offset:6144
v_mfma_f32_16x16x32_bf16 v[192:195], v[244:247], v[4:7], v[192:195]
v_mfma_f32_16x16x32_bf16 v[196:199], v[240:243], v[32:35], 0
v_mfma_f32_16x16x32_bf16 v[196:199], v[244:247], v[36:39], v[196:199]
v_mfma_f32_16x16x32_bf16 v[200:203], v[240:243], v[64:67], 0
ds_read_b128 v[236:239], v248 offset:6656
v_mfma_f32_16x16x32_bf16 v[200:203], v[244:247], v[68:71], v[200:203]
v_mfma_f32_16x16x32_bf16 v[204:207], v[240:243], v[96:99], 0
v_mfma_f32_16x16x32_bf16 v[204:207], v[244:247], v[100:103], v[204:207]
s_waitcnt lgkmcnt(2)
s_waitcnt vmcnt(20)
v_mfma_f32_16x16x32_bf16 v[160:163], v[224:227], v[8:11], v[160:163]
ds_read_b128 v[240:243], v248 offset:20480
v_mfma_f32_16x16x32_bf16 v[160:163], v[228:231], v[12:15], v[160:163]
buffer_load_dwordx4 v251, s[12:15], s28 offen offset:2048 lds
v_mfma_f32_16x16x32_bf16 v[164:167], v[224:227], v[40:43], v[164:167]
v_mfma_f32_16x16x32_bf16 v[164:167], v[228:231], v[44:47], v[164:167]
buffer_load_dwordx4 v251, s[12:15], s28 offen offset:3072 lds
v_mfma_f32_16x16x32_bf16 v[168:171], v[224:227], v[72:75], v[168:171]
ds_read_b128 v[244:247], v248 offset:20992
v_mfma_f32_16x16x32_bf16 v[168:171], v[228:231], v[76:79], v[168:171]
s_add_u32 s28, s28, 0x4000
s_add_u32 m0, s30, 0xc000
s_nop 0
v_mfma_f32_16x16x32_bf16 v[172:175], v[224:227], v[104:107], v[172:175]
v_mfma_f32_16x16x32_bf16 v[172:175], v[228:231], v[108:111], v[172:175]
s_waitcnt lgkmcnt(2)
buffer_load_dwordx4 v251, s[12:15], s28 offen offset:0 lds
v_mfma_f32_16x16x32_bf16 v[176:179], v[232:235], v[8:11], v[176:179]
ds_read_b128 v[224:227], v248 offset:8192
v_mfma_f32_16x16x32_bf16 v[176:179], v[236:239], v[12:15], v[176:179]
buffer_load_dwordx4 v251, s[12:15], s28 offen offset:1024 lds
v_mfma_f32_16x16x32_bf16 v[180:183], v[232:235], v[40:43], v[180:183]
v_mfma_f32_16x16x32_bf16 v[180:183], v[236:239], v[44:47], v[180:183]
v_mfma_f32_16x16x32_bf16 v[184:187], v[232:235], v[72:75], v[184:187]
ds_read_b128 v[228:231], v248 offset:8704
v_mfma_f32_16x16x32_bf16 v[184:187], v[236:239], v[76:79], v[184:187]
v_mfma_f32_16x16x32_bf16 v[188:191], v[232:235], v[104:107], v[188:191]
v_mfma_f32_16x16x32_bf16 v[188:191], v[236:239], v[108:111], v[188:191]
s_waitcnt lgkmcnt(2)
v_mfma_f32_16x16x32_bf16 v[192:195], v[240:243], v[8:11], v[192:195]
ds_read_b128 v[232:235], v248 offset:10240
v_mfma_f32_16x16x32_bf16 v[192:195], v[244:247], v[12:15], v[192:195]
v_mfma_f32_16x16x32_bf16 v[196:199], v[240:243], v[40:43], v[196:199]
v_mfma_f32_16x16x32_bf16 v[196:199], v[244:247], v[44:47], v[196:199]
v_mfma_f32_16x16x32_bf16 v[200:203], v[240:243], v[72:75], v[200:203]
ds_read_b128 v[236:239], v248 offset:10752
v_mfma_f32_16x16x32_bf16 v[200:203], v[244:247], v[76:79], v[200:203]
v_mfma_f32_16x16x32_bf16 v[204:207], v[240:243], v[104:107], v[204:207]
v_mfma_f32_16x16x32_bf16 v[204:207], v[244:247], v[108:111], v[204:207]
s_waitcnt lgkmcnt(2)
s_waitcnt vmcnt(16)
v_mfma_f32_16x16x32_bf16 v[160:163], v[224:227], v[16:19], v[160:163]
ds_read_b128 v[240:243], v248 offset:24576
v_mfma_f32_16x16x32_bf16 v[160:163], v[228:231], v[20:23], v[160:163]
buffer_load_dwordx4 v251, s[12:15], s28 offen offset:2048 lds
v_mfma_f32_16x16x32_bf16 v[164:167], v[224:227], v[48:51], v[164:167]
v_mfma_f32_16x16x32_bf16 v[164:167], v[228:231], v[52:55], v[164:167]
buffer_load_dwordx4 v251, s[12:15], s28 offen offset:3072 lds
v_mfma_f32_16x16x32_bf16 v[168:171], v[224:227], v[80:83], v[168:171]
ds_read_b128 v[244:247], v248 offset:25088
v_mfma_f32_16x16x32_bf16 v[168:171], v[228:231], v[84:87], v[168:171]
s_add_u32 s28, s28, 0x4000
s_add_u32 m0, s30, 0x10000
s_nop 0
v_mfma_f32_16x16x32_bf16 v[172:175], v[224:227], v[112:115], v[172:175]
v_mfma_f32_16x16x32_bf16 v[172:175], v[228:231], v[116:119], v[172:175]
s_waitcnt lgkmcnt(2)
buffer_load_dwordx4 v251, s[12:15], s28 offen offset:0 lds
v_mfma_f32_16x16x32_bf16 v[176:179], v[232:235], v[16:19], v[176:179]
ds_read_b128 v[224:227], v248 offset:12288
v_mfma_f32_16x16x32_bf16 v[176:179], v[236:239], v[20:23], v[176:179]
buffer_load_dwordx4 v251, s[12:15], s28 offen offset:1024 lds
v_mfma_f32_16x16x32_bf16 v[180:183], v[232:235], v[48:51], v[180:183]
v_mfma_f32_16x16x32_bf16 v[180:183], v[236:239], v[52:55], v[180:183]
v_mfma_f32_16x16x32_bf16 v[184:187], v[232:235], v[80:83], v[184:187]
ds_read_b128 v[228:231], v248 offset:12800
v_mfma_f32_16x16x32_bf16 v[184:187], v[236:239], v[84:87], v[184:187]
v_mfma_f32_16x16x32_bf16 v[188:191], v[232:235], v[112:115], v[188:191]
v_mfma_f32_16x16x32_bf16 v[188:191], v[236:239], v[116:119], v[188:191]
s_waitcnt lgkmcnt(2)
v_mfma_f32_16x16x32_bf16 v[192:195], v[240:243], v[16:19], v[192:195]
ds_read_b128 v[232:235], v248 offset:14336
v_mfma_f32_16x16x32_bf16 v[192:195], v[244:247], v[20:23], v[192:195]
v_mfma_f32_16x16x32_bf16 v[196:199], v[240:243], v[48:51], v[196:199]
v_mfma_f32_16x16x32_bf16 v[196:199], v[244:247], v[52:55], v[196:199]
v_mfma_f32_16x16x32_bf16 v[200:203], v[240:243], v[80:83], v[200:203]
ds_read_b128 v[236:239], v248 offset:14848
v_mfma_f32_16x16x32_bf16 v[200:203], v[244:247], v[84:87], v[200:203]
v_mfma_f32_16x16x32_bf16 v[204:207], v[240:243], v[112:115], v[204:207]
v_mfma_f32_16x16x32_bf16 v[204:207], v[244:247], v[116:119], v[204:207]
s_waitcnt lgkmcnt(2)
s_waitcnt vmcnt(12)
v_mfma_f32_16x16x32_bf16 v[160:163], v[224:227], v[24:27], v[160:163]
ds_read_b128 v[240:243], v248 offset:28672
v_mfma_f32_16x16x32_bf16 v[160:163], v[228:231], v[28:31], v[160:163]
buffer_load_dwordx4 v251, s[12:15], s28 offen offset:2048 lds
v_mfma_f32_16x16x32_bf16 v[164:167], v[224:227], v[56:59], v[164:167]
v_mfma_f32_16x16x32_bf16 v[164:167], v[228:231], v[60:63], v[164:167]
buffer_load_dwordx4 v251, s[12:15], s28 offen offset:3072 lds
v_mfma_f32_16x16x32_bf16 v[168:171], v[224:227], v[88:91], v[168:171]
ds_read_b128 v[244:247], v248 offset:29184
v_mfma_f32_16x16x32_bf16 v[168:171], v[228:231], v[92:95], v[168:171]
s_add_u32 s28, s28, 0x4000
s_xor_b32 s30, s30, 0x10000
v_mfma_f32_16x16x32_bf16 v[172:175], v[224:227], v[120:123], v[172:175]
v_mfma_f32_16x16x32_bf16 v[172:175], v[228:231], v[124:127], v[172:175]
s_waitcnt lgkmcnt(2)
v_mfma_f32_16x16x32_bf16 v[176:179], v[232:235], v[24:27], v[176:179]
v_mfma_f32_16x16x32_bf16 v[176:179], v[236:239], v[28:31], v[176:179]
v_mfma_f32_16x16x32_bf16 v[180:183], v[232:235], v[56:59], v[180:183]
v_mfma_f32_16x16x32_bf16 v[180:183], v[236:239], v[60:63], v[180:183]
v_mfma_f32_16x16x32_bf16 v[184:187], v[232:235], v[88:91], v[184:187]
v_mfma_f32_16x16x32_bf16 v[184:187], v[236:239], v[92:95], v[184:187]
v_mfma_f32_16x16x32_bf16 v[188:191], v[232:235], v[120:123], v[188:191]
v_mfma_f32_16x16x32_bf16 v[188:191], v[236:239], v[124:127], v[188:191]
s_waitcnt lgkmcnt(0)
v_mfma_f32_16x16x32_bf16 v[192:195], v[240:243], v[24:27], v[192:195]
v_mfma_f32_16x16x32_bf16 v[192:195], v[244:247], v[28:31], v[192:195]
v_mfma_f32_16x16x32_bf16 v[196:199], v[240:243], v[56:59], v[196:199]
v_mfma_f32_16x16x32_bf16 v[196:199], v[244:247], v[60:63], v[196:199]
v_mfma_f32_16x16x32_bf16 v[200:203], v[240:243], v[88:91], v[200:203]
v_mfma_f32_16x16x32_bf16 v[200:203], v[244:247], v[92:95], v[200:203]
v_mfma_f32_16x16x32_bf16 v[204:207], v[240:243], v[120:123], v[204:207]
v_mfma_f32_16x16x32_bf16 v[204:207], v[244:247], v[124:127], v[204:207]
s_nop 3
v_max3_f32 v224, v160, v161, v162
v_max3_f32 v225, v164, v165, v166
v_max3_f32 v226, v168, v169, v170
v_max3_f32 v227, v172, v173, v174
v_max3_f32 v224, v224, v163, v176
v_max3_f32 v225, v225, v167, v180
v_max3_f32 v226, v226, v171, v184
v_max3_f32 v227, v227, v175, v188
v_max3_f32 v224, v224, v177, v178
v_max3_f32 v225, v225, v181, v182
v_max3_f32 v226, v226, v185, v186
v_max3_f32 v227, v227, v189, v190
v_max_f32 v224, v224, v179
v_max_f32 v225, v225, v183
v_max_f32 v226, v226, v187
v_max_f32 v227, v227, v191
v_mov_b32 v228, v224
v_mov_b32 v229, v225
v_mov_b32 v230, v226
v_mov_b32 v231, v227
v_permlane32_swap_b32 v224, v228
v_permlane32_swap_b32 v225, v229
v_permlane32_swap_b32 v226, v230
v_permlane32_swap_b32 v227, v231
v_max_f32 v224, v224, v228
v_max_f32 v225, v225, v229
v_max_f32 v226, v226, v230
v_max_f32 v227, v227, v231
v_mov_b32 v228, v224
v_mov_b32 v229, v225
v_mov_b32 v230, v226
v_mov_b32 v231, v227
v_permlane16_swap_b32 v224, v228
v_permlane16_swap_b32 v225, v229
v_permlane16_swap_b32 v226, v230
v_permlane16_swap_b32 v227, v231
v_max_f32 v224, v224, v228
v_max_f32 v225, v225, v229
v_max_f32 v226, v226, v230
v_max_f32 v227, v227, v231
s_waitcnt vmcnt(8)
s_barrier
ds_read_b128 v[232:235], v248 offset:18432
ds_read_b128 v[236:239], v248 offset:18944
ds_read_b128 v[240:243], v248 offset:22528
ds_read_b128 v[244:247], v248 offset:23040
v_cvt_pk_bf16_f32 v228, -v224, -v224
v_cvt_pk_bf16_f32 v229, -v225, -v225
v_cvt_pk_bf16_f32 v230, -v226, -v226
v_cvt_pk_bf16_f32 v231, -v227, -v227
v_lshlrev_b32 v253, 2, v252
v_lshlrev_b32 v147, 16, v228
v_lshlrev_b32 v151, 16, v229
v_lshlrev_b32 v155, 16, v230
v_lshlrev_b32 v159, 16, v231
s_mov_b64 exec, 0xffff
v_bfi_b32 v0, s32, v228, v0
v_bfi_b32 v32, s32, v229, v32
v_bfi_b32 v64, s32, v230, v64
v_bfi_b32 v96, s32, v231, v96
v_xor_b32 v224, 0x80000000, v147
v_xor_b32 v225, 0x80000000, v151
v_xor_b32 v226, 0x80000000, v155
v_xor_b32 v227, 0x80000000, v159
buffer_store_dword v224, v253, s[24:27], s48 offen offset:0 sc1
buffer_store_dword v225, v253, s[24:27], s48 offen offset:1024 sc1
buffer_store_dword v226, v253, s[24:27], s48 offen offset:2048 sc1
buffer_store_dword v227, v253, s[24:27], s48 offen offset:3072 sc1
s_mov_b64 exec, -1
s_waitcnt lgkmcnt(2)
v_mfma_f32_16x16x32_bf16 v[208:211], v[232:235], v[0:3], 0
ds_read_b128 v[224:227], v248 offset:26624
v_add_f32 v192, v192, v147
v_add_f32 v193, v193, v147
v_add_f32 v194, v194, v147
v_mfma_f32_16x16x32_bf16 v[208:211], v[236:239], v[4:7], v[208:211]
v_add_f32 v195, v195, v147
v_exp_f32 v192, v192
v_mfma_f32_16x16x32_bf16 v[212:215], v[232:235], v[32:35], 0
v_exp_f32 v193, v193
v_exp_f32 v194, v194
v_mfma_f32_16x16x32_bf16 v[212:215], v[236:239], v[36:39], v[212:215]
v_exp_f32 v195, v195
v_add_f32 v196, v196, v151
v_add_f32 v197, v197, v151
v_mfma_f32_16x16x32_bf16 v[216:219], v[232:235], v[64:67], 0
ds_read_b128 v[228:231], v248 offset:27136
v_cvt_pk_bf16_f32 v144, v192, v193
v_cvt_pk_bf16_f32 v145, v194, v195
v_add_f32 v198, v198, v151
v_mfma_f32_16x16x32_bf16 v[216:219], v[236:239], v[68:71], v[216:219]
v_add_f32 v199, v199, v151
v_exp_f32 v196, v196
v_mfma_f32_16x16x32_bf16 v[220:223], v[232:235], v[96:99], 0
v_exp_f32 v197, v197
v_exp_f32 v198, v198
v_mfma_f32_16x16x32_bf16 v[220:223], v[236:239], v[100:103], v[220:223]
s_waitcnt lgkmcnt(2)
v_exp_f32 v199, v199
v_cvt_pk_bf16_f32 v148, v196, v197
v_mfma_f32_16x16x32_bf16 v[208:211], v[240:243], v[8:11], v[208:211]
ds_read_b128 v[232:235], v248 offset:30720
v_cvt_pk_bf16_f32 v149, v198, v199
v_add_f32 v200, v200, v155
v_add_f32 v201, v201, v155
v_mfma_f32_16x16x32_bf16 v[208:211], v[244:247], v[12:15], v[208:211]
v_add_f32 v202, v202, v155
v_add_f32 v203, v203, v155
v_exp_f32 v200, v200
v_mfma_f32_16x16x32_bf16 v[212:215], v[240:243], v[40:43], v[212:215]
v_exp_f32 v201, v201
v_exp_f32 v202, v202
v_mfma_f32_16x16x32_bf16 v[212:215], v[244:247], v[44:47], v[212:215]
v_exp_f32 v203, v203
v_add_f32 v204, v204, v159
v_add_f32 v205, v205, v159
v_mfma_f32_16x16x32_bf16 v[216:219], v[240:243], v[72:75], v[216:219]
ds_read_b128 v[236:239], v248 offset:31232
v_cvt_pk_bf16_f32 v152, v200, v201
v_cvt_pk_bf16_f32 v153, v202, v203
v_add_f32 v206, v206, v159
v_mfma_f32_16x16x32_bf16 v[216:219], v[244:247], v[76:79], v[216:219]
v_add_f32 v207, v207, v159
v_exp_f32 v204, v204
v_mfma_f32_16x16x32_bf16 v[220:223], v[240:243], v[104:107], v[220:223]
v_exp_f32 v205, v205
v_exp_f32 v206, v206
v_mfma_f32_16x16x32_bf16 v[220:223], v[244:247], v[108:111], v[220:223]
s_waitcnt lgkmcnt(2)
v_exp_f32 v207, v207
v_cvt_pk_bf16_f32 v156, v204, v205
v_mfma_f32_16x16x32_bf16 v[208:211], v[224:227], v[16:19], v[208:211]
ds_read_b128 v[240:243], v248 offset:32768
v_cvt_pk_bf16_f32 v157, v206, v207
v_add_f32 v160, v160, v147
v_add_f32 v161, v161, v147
v_mfma_f32_16x16x32_bf16 v[208:211], v[228:231], v[20:23], v[208:211]
v_add_f32 v162, v162, v147
v_add_f32 v163, v163, v147
v_exp_f32 v160, v160
v_mfma_f32_16x16x32_bf16 v[212:215], v[224:227], v[48:51], v[212:215]
v_exp_f32 v161, v161
v_exp_f32 v162, v162
v_mfma_f32_16x16x32_bf16 v[212:215], v[228:231], v[52:55], v[212:215]
v_exp_f32 v163, v163
v_add_f32 v164, v164, v151
v_add_f32 v165, v165, v151
v_mfma_f32_16x16x32_bf16 v[216:219], v[224:227], v[80:83], v[216:219]
ds_read_b128 v[244:247], v248 offset:33280
v_cvt_pk_bf16_f32 v128, v160, v161
v_cvt_pk_bf16_f32 v129, v162, v163
v_add_f32 v166, v166, v151
v_mfma_f32_16x16x32_bf16 v[216:219], v[228:231], v[84:87], v[216:219]
v_add_f32 v167, v167, v151
v_exp_f32 v164, v164
v_mfma_f32_16x16x32_bf16 v[220:223], v[224:227], v[112:115], v[220:223]
v_exp_f32 v165, v165
v_exp_f32 v166, v166
v_mfma_f32_16x16x32_bf16 v[220:223], v[228:231], v[116:119], v[220:223]
s_waitcnt lgkmcnt(2)
v_exp_f32 v167, v167
v_cvt_pk_bf16_f32 v132, v164, v165
v_mfma_f32_16x16x32_bf16 v[208:211], v[232:235], v[24:27], v[208:211]
ds_read_b128 v[224:227], v248 offset:36864
v_cvt_pk_bf16_f32 v133, v166, v167
v_add_f32 v168, v168, v155
v_add_f32 v169, v169, v155
v_mfma_f32_16x16x32_bf16 v[208:211], v[236:239], v[28:31], v[208:211]
v_add_f32 v170, v170, v155
v_add_f32 v171, v171, v155
v_exp_f32 v168, v168
v_mfma_f32_16x16x32_bf16 v[212:215], v[232:235], v[56:59], v[212:215]
v_exp_f32 v169, v169
v_exp_f32 v170, v170
v_mfma_f32_16x16x32_bf16 v[212:215], v[236:239], v[60:63], v[212:215]
v_exp_f32 v171, v171
v_add_f32 v172, v172, v159
v_add_f32 v173, v173, v159
v_mfma_f32_16x16x32_bf16 v[216:219], v[232:235], v[88:91], v[216:219]
ds_read_b128 v[228:231], v248 offset:37376
v_cvt_pk_bf16_f32 v136, v168, v169
v_cvt_pk_bf16_f32 v137, v170, v171
v_add_f32 v174, v174, v159
v_mfma_f32_16x16x32_bf16 v[216:219], v[236:239], v[92:95], v[216:219]
v_add_f32 v175, v175, v159
v_exp_f32 v172, v172
v_mfma_f32_16x16x32_bf16 v[220:223], v[232:235], v[120:123], v[220:223]
v_exp_f32 v173, v173
v_exp_f32 v174, v174
v_mfma_f32_16x16x32_bf16 v[220:223], v[236:239], v[124:127], v[220:223]
s_waitcnt lgkmcnt(2)
v_exp_f32 v175, v175
v_cvt_pk_bf16_f32 v140, v172, v173
v_mfma_f32_16x16x32_bf16 v[192:195], v[240:243], v[0:3], 0
ds_read_b128 v[232:235], v248 offset:40960
v_cvt_pk_bf16_f32 v141, v174, v175
v_add_f32 v176, v176, v147
v_add_f32 v177, v177, v147
v_mfma_f32_16x16x32_bf16 v[192:195], v[244:247], v[4:7], v[192:195]
v_add_f32 v178, v178, v147
v_add_f32 v179, v179, v147
v_exp_f32 v176, v176
v_mfma_f32_16x16x32_bf16 v[196:199], v[240:243], v[32:35], 0
v_exp_f32 v177, v177
v_exp_f32 v178, v178
v_mfma_f32_16x16x32_bf16 v[196:199], v[244:247], v[36:39], v[196:199]
v_exp_f32 v179, v179
v_add_f32 v180, v180, v151
v_add_f32 v181, v181, v151
v_mfma_f32_16x16x32_bf16 v[200:203], v[240:243], v[64:67], 0
ds_read_b128 v[236:239], v248 offset:41472
v_cvt_pk_bf16_f32 v130, v176, v177
v_cvt_pk_bf16_f32 v131, v178, v179
v_add_f32 v182, v182, v151
v_mfma_f32_16x16x32_bf16 v[200:203], v[244:247], v[68:71], v[200:203]
v_add_f32 v183, v183, v151
v_exp_f32 v180, v180
v_mfma_f32_16x16x32_bf16 v[204:207], v[240:243], v[96:99], 0
v_exp_f32 v181, v181
v_exp_f32 v182, v182
v_mfma_f32_16x16x32_bf16 v[204:207], v[244:247], v[100:103], v[204:207]
s_waitcnt lgkmcnt(2)
v_exp_f32 v183, v183
v_cvt_pk_bf16_f32 v134, v180, v181
v_mfma_f32_16x16x32_bf16 v[192:195], v[224:227], v[8:11], v[192:195]
ds_read_b128 v[240:243], v248 offset:45056
v_cvt_pk_bf16_f32 v135, v182, v183
v_add_f32 v184, v184, v155
v_add_f32 v185, v185, v155
v_mfma_f32_16x16x32_bf16 v[192:195], v[228:231], v[12:15], v[192:195]
v_add_f32 v186, v186, v155
v_add_f32 v187, v187, v155
v_exp_f32 v184, v184
v_mfma_f32_16x16x32_bf16 v[196:199], v[224:227], v[40:43], v[196:199]
v_exp_f32 v185, v185
v_exp_f32 v186, v186
v_mfma_f32_16x16x32_bf16 v[196:199], v[228:231], v[44:47], v[196:199]
v_exp_f32 v187, v187
v_add_f32 v188, v188, v159
v_add_f32 v189, v189, v159
v_mfma_f32_16x16x32_bf16 v[200:203], v[224:227], v[72:75], v[200:203]
ds_read_b128 v[244:247], v248 offset:45568
v_cvt_pk_bf16_f32 v138, v184, v185
v_cvt_pk_bf16_f32 v139, v186, v187
v_add_f32 v190, v190, v159
v_mfma_f32_16x16x32_bf16 v[200:203], v[228:231], v[76:79], v[200:203]
v_add_f32 v191, v191, v159
v_exp_f32 v188, v188
v_mfma_f32_16x16x32_bf16 v[204:207], v[224:227], v[104:107], v[204:207]
v_exp_f32 v189, v189
v_exp_f32 v190, v190
v_mfma_f32_16x16x32_bf16 v[204:207], v[228:231], v[108:111], v[204:207]
s_waitcnt lgkmcnt(2)
v_exp_f32 v191, v191
v_cvt_pk_bf16_f32 v142, v188, v189
v_mfma_f32_16x16x32_bf16 v[192:195], v[232:235], v[16:19], v[192:195]
ds_read_b64_tr_b16 v[224:225], v249 offset:0
v_cvt_pk_bf16_f32 v143, v190, v191
v_exp_f32 v208, v208
v_mfma_f32_16x16x32_bf16 v[192:195], v[236:239], v[20:23], v[192:195]
v_exp_f32 v209, v209
v_exp_f32 v210, v210
v_mfma_f32_16x16x32_bf16 v[196:199], v[232:235], v[48:51], v[196:199]
ds_read_b64_tr_b16 v[226:227], v249 offset:2048
v_exp_f32 v211, v211
v_cvt_pk_bf16_f32 v146, v208, v209
v_mfma_f32_16x16x32_bf16 v[196:199], v[236:239], v[52:55], v[196:199]
v_cvt_pk_bf16_f32 v147, v210, v211
v_exp_f32 v212, v212
v_mfma_f32_16x16x32_bf16 v[200:203], v[232:235], v[80:83], v[200:203]
ds_read_b64_tr_b16 v[228:229], v249 offset:16384
v_exp_f32 v213, v213
v_mfma_f32_16x16x32_bf16 v[200:203], v[236:239], v[84:87], v[200:203]
v_exp_f32 v214, v214
v_exp_f32 v215, v215
v_mfma_f32_16x16x32_bf16 v[204:207], v[232:235], v[112:115], v[204:207]
ds_read_b64_tr_b16 v[230:231], v249 offset:18432
v_cvt_pk_bf16_f32 v150, v212, v213
v_cvt_pk_bf16_f32 v151, v214, v215
v_mfma_f32_16x16x32_bf16 v[204:207], v[236:239], v[116:119], v[204:207]
s_waitcnt lgkmcnt(4)
v_exp_f32 v216, v216
v_mfma_f32_16x16x32_bf16 v[192:195], v[240:243], v[24:27], v[192:195]
ds_read_b64_tr_b16 v[232:233], v250 offset:0
v_exp_f32 v217, v217
v_mfma_f32_16x16x32_bf16 v[192:195], v[244:247], v[28:31], v[192:195]
v_exp_f32 v218, v218
v_exp_f32 v219, v219
v_mfma_f32_16x16x32_bf16 v[196:199], v[240:243], v[56:59], v[196:199]
ds_read_b64_tr_b16 v[234:235], v250 offset:2048
v_cvt_pk_bf16_f32 v154, v216, v217
v_cvt_pk_bf16_f32 v155, v218, v219
v_mfma_f32_16x16x32_bf16 v[196:199], v[244:247], v[60:63], v[196:199]
v_exp_f32 v220, v220
v_exp_f32 v221, v221
v_mfma_f32_16x16x32_bf16 v[200:203], v[240:243], v[88:91], v[200:203]
ds_read_b64_tr_b16 v[236:237], v250 offset:16384
v_exp_f32 v222, v222
v_cvt_pk_bf16_f32 v158, v220, v221
v_mfma_f32_16x16x32_bf16 v[200:203], v[244:247], v[92:95], v[200:203]
v_exp_f32 v223, v223
v_mfma_f32_16x16x32_bf16 v[204:207], v[240:243], v[120:123], v[204:207]
ds_read_b64_tr_b16 v[238:239], v250 offset:18432
v_cvt_pk_bf16_f32 v159, v222, v223
v_mfma_f32_16x16x32_bf16 v[204:207], v[244:247], v[124:127], v[204:207]
.p2align 6
L2_loop:
s_waitcnt lgkmcnt(4)
v_mfma_f32_16x16x32_bf16 a[0:3], v[224:227], v[128:131], a[0:3]
ds_read_b64_tr_b16 v[240:241], v249 offset:512
v_mfma_f32_16x16x32_bf16 a[0:3], v[228:231], v[144:147], a[0:3]
v_mfma_f32_16x16x32_bf16 a[4:7], v[224:227], v[132:135], a[4:7]
ds_read_b64_tr_b16 v[242:243], v249 offset:2560
v_mfma_f32_16x16x32_bf16 a[4:7], v[228:231], v[148:151], a[4:7]
v_exp_f32 v192, v192
v_mfma_f32_16x16x32_bf16 a[8:11], v[224:227], v[136:139], a[8:11]
ds_read_b64_tr_b16 v[244:245], v249 offset:16896
v_mfma_f32_16x16x32_bf16 a[8:11], v[228:231], v[152:155], a[8:11]
v_exp_f32 v193, v193
v_mfma_f32_16x16x32_bf16 a[12:15], v[224:227], v[140:143], a[12:15]
ds_read_b64_tr_b16 v[246:247], v249 offset:18944
v_cvt_pk_bf16_f32 v160, v192, v193
v_mfma_f32_16x16x32_bf16 a[12:15], v[228:231], v[156:159], a[12:15]
s_waitcnt lgkmcnt(4)
v_mfma_f32_16x16x32_bf16 a[16:19], v[232:235], v[128:131], a[16:19]
ds_read_b64_tr_b16 v[176:177], v250 offset:512
v_mfma_f32_16x16x32_bf16 a[16:19], v[236:239], v[144:147], a[16:19]
v_exp_f32 v194, v194
v_mfma_f32_16x16x32_bf16 a[20:23], v[232:235], v[132:135], a[20:23]
ds_read_b64_tr_b16 v[178:179], v250 offset:2560
v_mfma_f32_16x16x32_bf16 a[20:23], v[236:239], v[148:151], a[20:23]
v_exp_f32 v195, v195
v_mfma_f32_16x16x32_bf16 a[24:27], v[232:235], v[136:139], a[24:27]
ds_read_b64_tr_b16 v[180:181], v250 offset:16896
v_cvt_pk_bf16_f32 v161, v194, v195
v_mfma_f32_16x16x32_bf16 a[24:27], v[236:239], v[152:155], a[24:27]
v_exp_f32 v196, v196
v_mfma_f32_16x16x32_bf16 a[28:31], v[232:235], v[140:143], a[28:31]
ds_read_b64_tr_b16 v[182:183], v250 offset:18944
v_mfma_f32_16x16x32_bf16 a[28:31], v[236:239], v[156:159], a[28:31]
s_waitcnt lgkmcnt(4)
v_mfma_f32_16x16x32_bf16 a[32:35], v[240:243], v[128:131], a[32:35]
ds_read_b128 v[224:227], v248 offset:34816
v_mfma_f32_16x16x32_bf16 a[32:35], v[244:247], v[144:147], a[32:35]
v_exp_f32 v197, v197
v_mfma_f32_16x16x32_bf16 a[36:39], v[240:243], v[132:135], a[36:39]
v_exp_f32 v198, v198
v_mfma_f32_16x16x32_bf16 a[36:39], v[244:247], v[148:151], a[36:39]
v_exp_f32 v199, v199
v_mfma_f32_16x16x32_bf16 a[40:43], v[240:243], v[136:139], a[40:43]
ds_read_b128 v[228:231], v248 offset:35328
v_cvt_pk_bf16_f32 v164, v196, v197
v_mfma_f32_16x16x32_bf16 a[40:43], v[244:247], v[152:155], a[40:43]
v_cvt_pk_bf16_f32 v165, v198, v199
v_mfma_f32_16x16x32_bf16 a[44:47], v[240:243], v[140:143], a[44:47]
v_exp_f32 v200, v200
v_mfma_f32_16x16x32_bf16 a[44:47], v[244:247], v[156:159], a[44:47]
s_waitcnt lgkmcnt(2)
v_mfma_f32_16x16x32_bf16 a[48:51], v[176:179], v[128:131], a[48:51]
ds_read_b128 v[232:235], v248 offset:38912
v_mfma_f32_16x16x32_bf16 a[48:51], v[180:183], v[144:147], a[48:51]
v_exp_f32 v201, v201
v_mfma_f32_16x16x32_bf16 a[52:55], v[176:179], v[132:135], a[52:55]
v_exp_f32 v202, v202
v_mfma_f32_16x16x32_bf16 a[52:55], v[180:183], v[148:151], a[52:55]
v_exp_f32 v203, v203
v_mfma_f32_16x16x32_bf16 a[56:59], v[176:179], v[136:139], a[56:59]
ds_read_b128 v[236:239], v248 offset:39424
v_cvt_pk_bf16_f32 v168, v200, v201
v_mfma_f32_16x16x32_bf16 a[56:59], v[180:183], v[152:155], a[56:59]
v_cvt_pk_bf16_f32 v169, v202, v203
v_mfma_f32_16x16x32_bf16 a[60:63], v[176:179], v[140:143], a[60:63]
v_exp_f32 v204, v204
v_mfma_f32_16x16x32_bf16 a[60:63], v[180:183], v[156:159], a[60:63]
s_waitcnt lgkmcnt(2)
v_mfma_f32_16x16x32_bf16 v[208:211], v[224:227], v[0:3], 0
ds_read_b128 v[240:243], v248 offset:43008
v_mfma_f32_16x16x32_bf16 v[208:211], v[228:231], v[4:7], v[208:211]
v_exp_f32 v205, v205
v_mfma_f32_16x16x32_bf16 v[212:215], v[224:227], v[32:35], 0
v_exp_f32 v206, v206
v_mfma_f32_16x16x32_bf16 v[212:215], v[228:231], v[36:39], v[212:215]
v_exp_f32 v207, v207
v_mfma_f32_16x16x32_bf16 v[216:219], v[224:227], v[64:67], 0
ds_read_b128 v[244:247], v248 offset:43520
v_cvt_pk_bf16_f32 v172, v204, v205
v_mfma_f32_16x16x32_bf16 v[216:219], v[228:231], v[68:71], v[216:219]
v_cvt_pk_bf16_f32 v173, v206, v207
v_mfma_f32_16x16x32_bf16 v[220:223], v[224:227], v[96:99], 0
v_mfma_f32_16x16x32_bf16 v[220:223], v[228:231], v[100:103], v[220:223]
s_waitcnt lgkmcnt(2)
v_mfma_f32_16x16x32_bf16 v[208:211], v[232:235], v[8:11], v[208:211]
ds_read_b128 v[176:179], v248 offset:47104
v_mfma_f32_16x16x32_bf16 v[208:211], v[236:239], v[12:15], v[208:211]
v_mfma_f32_16x16x32_bf16 v[212:215], v[232:235], v[40:43], v[212:215]
v_mfma_f32_16x16x32_bf16 v[212:215], v[236:239], v[44:47], v[212:215]
v_mfma_f32_16x16x32_bf16 v[216:219], v[232:235], v[72:75], v[216:219]
ds_read_b128 v[180:183], v248 offset:47616
v_mfma_f32_16x16x32_bf16 v[216:219], v[236:239], v[76:79], v[216:219]
v_mfma_f32_16x16x32_bf16 v[220:223], v[232:235], v[104:107], v[220:223]
v_mfma_f32_16x16x32_bf16 v[220:223], v[236:239], v[108:111], v[220:223]
s_waitcnt lgkmcnt(2)
v_mfma_f32_16x16x32_bf16 v[208:211], v[240:243], v[16:19], v[208:211]
ds_read_b64_tr_b16 v[224:225], v249 offset:4096
v_mfma_f32_16x16x32_bf16 v[208:211], v[244:247], v[20:23], v[208:211]
v_mfma_f32_16x16x32_bf16 v[212:215], v[240:243], v[48:51], v[212:215]
ds_read_b64_tr_b16 v[226:227], v249 offset:6144
v_mfma_f32_16x16x32_bf16 v[212:215], v[244:247], v[52:55], v[212:215]
v_mfma_f32_16x16x32_bf16 v[216:219], v[240:243], v[80:83], v[216:219]
ds_read_b64_tr_b16 v[228:229], v249 offset:20480
v_mfma_f32_16x16x32_bf16 v[216:219], v[244:247], v[84:87], v[216:219]
v_mfma_f32_16x16x32_bf16 v[220:223], v[240:243], v[112:115], v[220:223]
ds_read_b64_tr_b16 v[230:231], v249 offset:22528
v_mfma_f32_16x16x32_bf16 v[220:223], v[244:247], v[116:119], v[220:223]
s_waitcnt lgkmcnt(4)
v_mfma_f32_16x16x32_bf16 v[208:211], v[176:179], v[24:27], v[208:211]
ds_read_b64_tr_b16 v[232:233], v250 offset:4096
v_mfma_f32_16x16x32_bf16 v[208:211], v[180:183], v[28:31], v[208:211]
v_mfma_f32_16x16x32_bf16 v[212:215], v[176:179], v[56:59], v[212:215]
ds_read_b64_tr_b16 v[234:235], v250 offset:6144
v_mfma_f32_16x16x32_bf16 v[212:215], v[180:183], v[60:63], v[212:215]
v_mfma_f32_16x16x32_bf16 v[216:219], v[176:179], v[88:91], v[216:219]
ds_read_b64_tr_b16 v[236:237], v250 offset:20480
v_mfma_f32_16x16x32_bf16 v[216:219], v[180:183], v[92:95], v[216:219]
v_mfma_f32_16x16x32_bf16 v[220:223], v[176:179], v[120:123], v[220:223]
ds_read_b64_tr_b16 v[238:239], v250 offset:22528
v_mfma_f32_16x16x32_bf16 v[220:223], v[180:183], v[124:127], v[220:223]
s_waitcnt lgkmcnt(4)
v_mfma_f32_16x16x32_bf16 a[64:67], v[224:227], v[128:131], a[64:67]
ds_read_b64_tr_b16 v[240:241], v249 offset:4608
v_mfma_f32_16x16x32_bf16 a[64:67], v[228:231], v[144:147], a[64:67]
v_mfma_f32_16x16x32_bf16 a[68:71], v[224:227], v[132:135], a[68:71]
ds_read_b64_tr_b16 v[242:243], v249 offset:6656
v_mfma_f32_16x16x32_bf16 a[68:71], v[228:231], v[148:151], a[68:71]
v_exp_f32 v208, v208
v_mfma_f32_16x16x32_bf16 a[72:75], v[224:227], v[136:139], a[72:75]
ds_read_b64_tr_b16 v[244:245], v249 offset:20992
v_mfma_f32_16x16x32_bf16 a[72:75], v[228:231], v[152:155], a[72:75]
v_exp_f32 v209, v209
v_mfma_f32_16x16x32_bf16 a[76:79], v[224:227], v[140:143], a[76:79]
ds_read_b64_tr_b16 v[246:247], v249 offset:23040
v_cvt_pk_bf16_f32 v162, v208, v209
v_mfma_f32_16x16x32_bf16 a[76:79], v[228:231], v[156:159], a[76:79]
s_waitcnt lgkmcnt(4)
s_waitcnt vmcnt(0)
s_barrier
s_add_u32 m0, s30, 0x4000
v_mfma_f32_16x16x32_bf16 a[80:83], v[232:235], v[128:131], a[80:83]
ds_read_b64_tr_b16 v[224:225], v250 offset:4608
v_mfma_f32_16x16x32_bf16 a[80:83], v[236:239], v[144:147], a[80:83]
buffer_load_dwordx4 v251, s[12:15], s28 offen offset:0 lds
v_mfma_f32_16x16x32_bf16 a[84:87], v[232:235], v[132:135], a[84:87]
ds_read_b64_tr_b16 v[226:227], v250 offset:6656
v_mfma_f32_16x16x32_bf16 a[84:87], v[236:239], v[148:151], a[84:87]
v_exp_f32 v210, v210
v_mfma_f32_16x16x32_bf16 a[88:91], v[232:235], v[136:139], a[88:91]
ds_read_b64_tr_b16 v[228:229], v250 offset:20992
v_mfma_f32_16x16x32_bf16 a[88:91], v[236:239], v[152:155], a[88:91]
v_exp_f32 v211, v211
v_mfma_f32_16x16x32_bf16 a[92:95], v[232:235], v[140:143], a[92:95]
ds_read_b64_tr_b16 v[230:231], v250 offset:23040
v_cvt_pk_bf16_f32 v163, v210, v211
v_mfma_f32_16x16x32_bf16 a[92:95], v[236:239], v[156:159], a[92:95]
s_waitcnt lgkmcnt(4)
v_mfma_f32_16x16x32_bf16 a[96:99], v[240:243], v[128:131], a[96:99]
ds_read_b128 v[232:235], v248 offset:49152
v_mfma_f32_16x16x32_bf16 a[96:99], v[244:247], v[144:147], a[96:99]
buffer_load_dwordx4 v251, s[12:15], s28 offen offset:1024 lds
v_mfma_f32_16x16x32_bf16 a[100:103], v[240:243], v[132:135], a[100:103]
v_exp_f32 v212, v212
v_mfma_f32_16x16x32_bf16 a[100:103], v[244:247], v[148:151], a[100:103]
v_exp_f32 v213, v213
v_mfma_f32_16x16x32_bf16 a[104:107], v[240:243], v[136:139], a[104:107]
ds_read_b128 v[236:239], v248 offset:49664
v_cvt_pk_bf16_f32 v166, v212, v213
v_mfma_f32_16x16x32_bf16 a[104:107], v[244:247], v[152:155], a[104:107]
v_exp_f32 v214, v214
v_mfma_f32_16x16x32_bf16 a[108:111], v[240:243], v[140:143], a[108:111]
v_exp_f32 v215, v215
v_mfma_f32_16x16x32_bf16 a[108:111], v[244:247], v[156:159], a[108:111]
s_waitcnt lgkmcnt(2)
v_cvt_pk_bf16_f32 v167, v214, v215
v_mfma_f32_16x16x32_bf16 a[112:115], v[224:227], v[128:131], a[112:115]
ds_read_b128 v[240:243], v248 offset:53248
v_mfma_f32_16x16x32_bf16 a[112:115], v[228:231], v[144:147], a[112:115]
buffer_load_dwordx4 v251, s[12:15], s28 offen offset:2048 lds
v_mfma_f32_16x16x32_bf16 a[116:119], v[224:227], v[132:135], a[116:119]
v_exp_f32 v216, v216
v_mfma_f32_16x16x32_bf16 a[116:119], v[228:231], v[148:151], a[116:119]
v_exp_f32 v217, v217
v_mfma_f32_16x16x32_bf16 a[120:123], v[224:227], v[136:139], a[120:123]
ds_read_b128 v[244:247], v248 offset:53760
v_cvt_pk_bf16_f32 v170, v216, v217
v_mfma_f32_16x16x32_bf16 a[120:123], v[228:231], v[152:155], a[120:123]
v_exp_f32 v218, v218
v_mfma_f32_16x16x32_bf16 a[124:127], v[224:227], v[140:143], a[124:127]
v_exp_f32 v219, v219
v_mfma_f32_16x16x32_bf16 a[124:127], v[228:231], v[156:159], a[124:127]
s_waitcnt lgkmcnt(2)
v_cvt_pk_bf16_f32 v171, v218, v219
v_mfma_f32_16x16x32_bf16 v[192:195], v[232:235], v[0:3], 0
ds_read_b128 v[224:227], v248 offset:57344
v_mfma_f32_16x16x32_bf16 v[192:195], v[236:239], v[4:7], v[192:195]
buffer_load_dwordx4 v251, s[12:15], s28 offen offset:3072 lds
v_mfma_f32_16x16x32_bf16 v[196:199], v[232:235], v[32:35], 0
v_exp_f32 v220, v220
v_mfma_f32_16x16x32_bf16 v[196:199], v[236:239], v[36:39], v[196:199]
s_add_u32 s28, s28, 0x4000
v_mfma_f32_16x16x32_bf16 v[200:203], v[232:235], v[64:67], 0
ds_read_b128 v[228:231], v248 offset:57856
v_mfma_f32_16x16x32_bf16 v[200:203], v[236:239], v[68:71], v[200:203]
v_exp_f32 v221, v221
v_mfma_f32_16x16x32_bf16 v[204:207], v[232:235], v[96:99], 0
v_exp_f32 v222, v222
v_mfma_f32_16x16x32_bf16 v[204:207], v[236:239], v[100:103], v[204:207]
s_waitcnt lgkmcnt(2)
s_add_u32 m0, s30, 0x8000
v_mfma_f32_16x16x32_bf16 v[192:195], v[240:243], v[8:11], v[192:195]
ds_read_b128 v[232:235], v248 offset:61440
v_cvt_pk_bf16_f32 v174, v220, v221
v_mfma_f32_16x16x32_bf16 v[192:195], v[244:247], v[12:15], v[192:195]
buffer_load_dwordx4 v251, s[12:15], s28 offen offset:0 lds
v_mfma_f32_16x16x32_bf16 v[196:199], v[240:243], v[40:43], v[196:199]
v_exp_f32 v223, v223
v_mfma_f32_16x16x32_bf16 v[196:199], v[244:247], v[44:47], v[196:199]
v_mfma_f32_16x16x32_bf16 v[200:203], v[240:243], v[72:75], v[200:203]
ds_read_b128 v[236:239], v248 offset:61952
v_cvt_pk_bf16_f32 v175, v222, v223
v_mfma_f32_16x16x32_bf16 v[200:203], v[244:247], v[76:79], v[200:203]
v_mfma_f32_16x16x32_bf16 v[204:207], v[240:243], v[104:107], v[204:207]
v_mfma_f32_16x16x32_bf16 v[204:207], v[244:247], v[108:111], v[204:207]
s_waitcnt lgkmcnt(2)
v_mfma_f32_16x16x32_bf16 v[192:195], v[224:227], v[16:19], v[192:195]
ds_read_b64_tr_b16 v[240:241], v249 offset:8192
v_mfma_f32_16x16x32_bf16 v[192:195], v[228:231], v[20:23], v[192:195]
buffer_load_dwordx4 v251, s[12:15], s28 offen offset:1024 lds
v_mfma_f32_16x16x32_bf16 v[196:199], v[224:227], v[48:51], v[196:199]
ds_read_b64_tr_b16 v[242:243], v249 offset:10240
v_mfma_f32_16x16x32_bf16 v[196:199], v[228:231], v[52:55], v[196:199]
v_mfma_f32_16x16x32_bf16 v[200:203], v[224:227], v[80:83], v[200:203]
ds_read_b64_tr_b16 v[244:245], v249 offset:24576
v_mfma_f32_16x16x32_bf16 v[200:203], v[228:231], v[84:87], v[200:203]
v_mfma_f32_16x16x32_bf16 v[204:207], v[224:227], v[112:115], v[204:207]
ds_read_b64_tr_b16 v[246:247], v249 offset:26624
v_mfma_f32_16x16x32_bf16 v[204:207], v[228:231], v[116:119], v[204:207]
s_waitcnt lgkmcnt(4)
v_mfma_f32_16x16x32_bf16 v[192:195], v[232:235], v[24:27], v[192:195]
ds_read_b64_tr_b16 v[224:225], v250 offset:8192
v_mfma_f32_16x16x32_bf16 v[192:195], v[236:239], v[28:31], v[192:195]
buffer_load_dwordx4 v251, s[12:15], s28 offen offset:2048 lds
v_mfma_f32_16x16x32_bf16 v[196:199], v[232:235], v[56:59], v[196:199]
ds_read_b64_tr_b16 v[226:227], v250 offset:10240
v_mfma_f32_16x16x32_bf16 v[196:199], v[236:239], v[60:63], v[196:199]
v_mfma_f32_16x16x32_bf16 v[200:203], v[232:235], v[88:91], v[200:203]
ds_read_b64_tr_b16 v[228:229], v250 offset:24576
v_mfma_f32_16x16x32_bf16 v[200:203], v[236:239], v[92:95], v[200:203]
v_mfma_f32_16x16x32_bf16 v[204:207], v[232:235], v[120:123], v[204:207]
ds_read_b64_tr_b16 v[230:231], v250 offset:26624
v_mfma_f32_16x16x32_bf16 v[204:207], v[236:239], v[124:127], v[204:207]
s_waitcnt lgkmcnt(4)
v_mfma_f32_16x16x32_bf16 a[128:131], v[240:243], v[128:131], a[128:131]
ds_read_b64_tr_b16 v[232:233], v249 offset:8704
v_mfma_f32_16x16x32_bf16 a[128:131], v[244:247], v[144:147], a[128:131]
buffer_load_dwordx4 v251, s[12:15], s28 offen offset:3072 lds
v_mfma_f32_16x16x32_bf16 a[132:135], v[240:243], v[132:135], a[132:135]
ds_read_b64_tr_b16 v[234:235], v249 offset:10752
v_mfma_f32_16x16x32_bf16 a[132:135], v[244:247], v[148:151], a[132:135]
s_add_u32 s28, s28, 0x4000
v_mfma_f32_16x16x32_bf16 a[136:139], v[240:243], v[136:139], a[136:139]
ds_read_b64_tr_b16 v[236:237], v249 offset:25088
v_mfma_f32_16x16x32_bf16 a[136:139], v[244:247], v[152:155], a[136:139]
v_exp_f32 v192, v192
v_mfma_f32_16x16x32_bf16 a[140:143], v[240:243], v[140:143], a[140:143]
ds_read_b64_tr_b16 v[238:239], v249 offset:27136
v_mfma_f32_16x16x32_bf16 a[140:143], v[244:247], v[156:159], a[140:143]
s_waitcnt lgkmcnt(4)
v_mfma_f32_16x16x32_bf16 a[144:147], v[224:227], v[128:131], a[144:147]
ds_read_b64_tr_b16 v[240:241], v250 offset:8704
v_mfma_f32_16x16x32_bf16 a[144:147], v[228:231], v[144:147], a[144:147]
v_exp_f32 v193, v193
v_mfma_f32_16x16x32_bf16 a[148:151], v[224:227], v[132:135], a[148:151]
ds_read_b64_tr_b16 v[242:243], v250 offset:10752
v_cvt_pk_bf16_f32 v176, v192, v193
v_mfma_f32_16x16x32_bf16 a[148:151], v[228:231], v[148:151], a[148:151]
v_exp_f32 v194, v194
v_mfma_f32_16x16x32_bf16 a[152:155], v[224:227], v[136:139], a[152:155]
ds_read_b64_tr_b16 v[244:245], v250 offset:25088
v_mfma_f32_16x16x32_bf16 a[152:155], v[228:231], v[152:155], a[152:155]
v_exp_f32 v195, v195
v_mfma_f32_16x16x32_bf16 a[156:159], v[224:227], v[140:143], a[156:159]
ds_read_b64_tr_b16 v[246:247], v250 offset:27136
v_cvt_pk_bf16_f32 v177, v194, v195
v_mfma_f32_16x16x32_bf16 a[156:159], v[228:231], v[156:159], a[156:159]
s_waitcnt lgkmcnt(4)
v_mfma_f32_16x16x32_bf16 a[160:163], v[232:235], v[128:131], a[160:163]
ds_read_b128 v[224:227], v248 offset:51200
v_mfma_f32_16x16x32_bf16 a[160:163], v[236:239], v[144:147], a[160:163]
v_exp_f32 v196, v196
v_mfma_f32_16x16x32_bf16 a[164:167], v[232:235], v[132:135], a[164:167]
v_exp_f32 v197, v197
v_mfma_f32_16x16x32_bf16 a[164:167], v[236:239], v[148:151], a[164:167]
v_exp_f32 v198, v198
v_mfma_f32_16x16x32_bf16 a[168:171], v[232:235], v[136:139], a[168:171]
ds_read_b128 v[228:231], v248 offset:51712
v_cvt_pk_bf16_f32 v180, v196, v197
v_mfma_f32_16x16x32_bf16 a[168:171], v[236:239], v[152:155], a[168:171]
v_exp_f32 v199, v199
v_mfma_f32_16x16x32_bf16 a[172:175], v[232:235], v[140:143], a[172:175]
v_exp_f32 v200, v200
v_mfma_f32_16x16x32_bf16 a[172:175], v[236:239], v[156:159], a[172:175]
s_waitcnt lgkmcnt(2)
v_cvt_pk_bf16_f32 v181, v198, v199
v_mfma_f32_16x16x32_bf16 a[176:179], v[240:243], v[128:131], a[176:179]
ds_read_b128 v[232:235], v248 offset:55296
v_mfma_f32_16x16x32_bf16 a[176:179], v[244:247], v[144:147], a[176:179]
v_exp_f32 v201, v201
v_mfma_f32_16x16x32_bf16 a[180:183], v[240:243], v[132:135], a[180:183]
v_exp_f32 v202, v202
v_mfma_f32_16x16x32_bf16 a[180:183], v[244:247], v[148:151], a[180:183]
v_exp_f32 v203, v203
v_mfma_f32_16x16x32_bf16 a[184:187], v[240:243], v[136:139], a[184:187]
ds_read_b128 v[236:239], v248 offset:55808
v_cvt_pk_bf16_f32 v184, v200, v201
v_mfma_f32_16x16x32_bf16 a[184:187], v[244:247], v[152:155], a[184:187]
v_cvt_pk_bf16_f32 v185, v202, v203
v_mfma_f32_16x16x32_bf16 a[188:191], v[240:243], v[140:143], a[188:191]
v_exp_f32 v204, v204
v_mfma_f32_16x16x32_bf16 a[188:191], v[244:247], v[156:159], a[188:191]
s_waitcnt lgkmcnt(2)
v_mfma_f32_16x16x32_bf16 v[208:211], v[224:227], v[0:3], 0
ds_read_b128 v[240:243], v248 offset:59392
v_mfma_f32_16x16x32_bf16 v[208:211], v[228:231], v[4:7], v[208:211]
v_exp_f32 v205, v205
v_mfma_f32_16x16x32_bf16 v[212:215], v[224:227], v[32:35], 0
v_exp_f32 v206, v206
v_mfma_f32_16x16x32_bf16 v[212:215], v[228:231], v[36:39], v[212:215]
v_exp_f32 v207, v207
v_mfma_f32_16x16x32_bf16 v[216:219], v[224:227], v[64:67], 0
ds_read_b128 v[244:247], v248 offset:59904
v_cvt_pk_bf16_f32 v188, v204, v205
v_mfma_f32_16x16x32_bf16 v[216:219], v[228:231], v[68:71], v[216:219]
v_cvt_pk_bf16_f32 v189, v206, v207
v_mfma_f32_16x16x32_bf16 v[220:223], v[224:227], v[96:99], 0
v_mfma_f32_16x16x32_bf16 v[220:223], v[228:231], v[100:103], v[220:223]
s_waitcnt lgkmcnt(2)
v_mfma_f32_16x16x32_bf16 v[208:211], v[232:235], v[8:11], v[208:211]
ds_read_b128 v[224:227], v248 offset:63488
v_mfma_f32_16x16x32_bf16 v[208:211], v[236:239], v[12:15], v[208:211]
v_mfma_f32_16x16x32_bf16 v[212:215], v[232:235], v[40:43], v[212:215]
v_mfma_f32_16x16x32_bf16 v[212:215], v[236:239], v[44:47], v[212:215]
v_mfma_f32_16x16x32_bf16 v[216:219], v[232:235], v[72:75], v[216:219]
ds_read_b128 v[228:231], v248 offset:64000
v_mfma_f32_16x16x32_bf16 v[216:219], v[236:239], v[76:79], v[216:219]
v_mfma_f32_16x16x32_bf16 v[220:223], v[232:235], v[104:107], v[220:223]
v_mfma_f32_16x16x32_bf16 v[220:223], v[236:239], v[108:111], v[220:223]
s_waitcnt lgkmcnt(2)
v_mfma_f32_16x16x32_bf16 v[208:211], v[240:243], v[16:19], v[208:211]
ds_read_b64_tr_b16 v[232:233], v249 offset:12288
v_mfma_f32_16x16x32_bf16 v[208:211], v[244:247], v[20:23], v[208:211]
v_mfma_f32_16x16x32_bf16 v[212:215], v[240:243], v[48:51], v[212:215]
ds_read_b64_tr_b16 v[234:235], v249 offset:14336
v_mfma_f32_16x16x32_bf16 v[212:215], v[244:247], v[52:55], v[212:215]
v_mfma_f32_16x16x32_bf16 v[216:219], v[240:243], v[80:83], v[216:219]
ds_read_b64_tr_b16 v[236:237], v249 offset:28672
v_mfma_f32_16x16x32_bf16 v[216:219], v[244:247], v[84:87], v[216:219]
v_mfma_f32_16x16x32_bf16 v[220:223], v[240:243], v[112:115], v[220:223]
ds_read_b64_tr_b16 v[238:239], v249 offset:30720
v_mfma_f32_16x16x32_bf16 v[220:223], v[244:247], v[116:119], v[220:223]
s_waitcnt lgkmcnt(4)
v_mfma_f32_16x16x32_bf16 v[208:211], v[224:227], v[24:27], v[208:211]
ds_read_b64_tr_b16 v[240:241], v250 offset:12288
v_mfma_f32_16x16x32_bf16 v[208:211], v[228:231], v[28:31], v[208:211]
v_mfma_f32_16x16x32_bf16 v[212:215], v[224:227], v[56:59], v[212:215]
ds_read_b64_tr_b16 v[242:243], v250 offset:14336
v_mfma_f32_16x16x32_bf16 v[212:215], v[228:231], v[60:63], v[212:215]
v_mfma_f32_16x16x32_bf16 v[216:219], v[224:227], v[88:91], v[216:219]
ds_read_b64_tr_b16 v[244:245], v250 offset:28672
v_mfma_f32_16x16x32_bf16 v[216:219], v[228:231], v[92:95], v[216:219]
v_mfma_f32_16x16x32_bf16 v[220:223], v[224:227], v[120:123], v[220:223]
ds_read_b64_tr_b16 v[246:247], v250 offset:30720
v_xor_b32 v248, 0x10000, v248
v_mfma_f32_16x16x32_bf16 v[220:223], v[228:231], v[124:127], v[220:223]
s_waitcnt lgkmcnt(4)
v_mfma_f32_16x16x32_bf16 a[192:195], v[232:235], v[128:131], a[192:195]
ds_read_b64_tr_b16 v[224:225], v249 offset:12800
v_mfma_f32_16x16x32_bf16 a[192:195], v[236:239], v[144:147], a[192:195]
v_mfma_f32_16x16x32_bf16 a[196:199], v[232:235], v[132:135], a[196:199]
ds_read_b64_tr_b16 v[226:227], v249 offset:14848
v_mfma_f32_16x16x32_bf16 a[196:199], v[236:239], v[148:151], a[196:199]
v_exp_f32 v208, v208
v_mfma_f32_16x16x32_bf16 a[200:203], v[232:235], v[136:139], a[200:203]
ds_read_b64_tr_b16 v[228:229], v249 offset:29184
v_mfma_f32_16x16x32_bf16 a[200:203], v[236:239], v[152:155], a[200:203]
v_exp_f32 v209, v209
v_mfma_f32_16x16x32_bf16 a[204:207], v[232:235], v[140:143], a[204:207]
ds_read_b64_tr_b16 v[230:231], v249 offset:31232
v_cvt_pk_bf16_f32 v178, v208, v209
v_mfma_f32_16x16x32_bf16 a[204:207], v[236:239], v[156:159], a[204:207]
s_waitcnt lgkmcnt(4)
v_mfma_f32_16x16x32_bf16 a[208:211], v[240:243], v[128:131], a[208:211]
ds_read_b64_tr_b16 v[232:233], v250 offset:12800
v_mfma_f32_16x16x32_bf16 a[208:211], v[244:247], v[144:147], a[208:211]
v_exp_f32 v210, v210
v_mfma_f32_16x16x32_bf16 a[212:215], v[240:243], v[132:135], a[212:215]
ds_read_b64_tr_b16 v[234:235], v250 offset:14848
v_mfma_f32_16x16x32_bf16 a[212:215], v[244:247], v[148:151], a[212:215]
v_exp_f32 v211, v211
v_mfma_f32_16x16x32_bf16 a[216:219], v[240:243], v[136:139], a[216:219]
ds_read_b64_tr_b16 v[236:237], v250 offset:29184
v_cvt_pk_bf16_f32 v179, v210, v211
v_mfma_f32_16x16x32_bf16 a[216:219], v[244:247], v[152:155], a[216:219]
v_exp_f32 v212, v212
v_mfma_f32_16x16x32_bf16 a[220:223], v[240:243], v[140:143], a[220:223]
ds_read_b64_tr_b16 v[238:239], v250 offset:31232
v_mfma_f32_16x16x32_bf16 a[220:223], v[244:247], v[156:159], a[220:223]
s_waitcnt lgkmcnt(4)
v_mfma_f32_16x16x32_bf16 a[224:227], v[224:227], v[128:131], a[224:227]
ds_read_b128 v[240:243], v248 offset:0
v_mfma_f32_16x16x32_bf16 a[224:227], v[228:231], v[144:147], a[224:227]
v_exp_f32 v213, v213
v_mfma_f32_16x16x32_bf16 a[228:231], v[224:227], v[132:135], a[228:231]
v_exp_f32 v214, v214
v_mfma_f32_16x16x32_bf16 a[228:231], v[228:231], v[148:151], a[228:231]
v_exp_f32 v215, v215
v_mfma_f32_16x16x32_bf16 a[232:235], v[224:227], v[136:139], a[232:235]
ds_read_b128 v[244:247], v248 offset:512
v_cvt_pk_bf16_f32 v182, v212, v213
v_mfma_f32_16x16x32_bf16 a[232:235], v[228:231], v[152:155], a[232:235]
v_cvt_pk_bf16_f32 v183, v214, v215
v_mfma_f32_16x16x32_bf16 a[236:239], v[224:227], v[140:143], a[236:239]
v_exp_f32 v216, v216
v_mfma_f32_16x16x32_bf16 a[236:239], v[228:231], v[156:159], a[236:239]
s_waitcnt lgkmcnt(2)
v_mfma_f32_16x16x32_bf16 a[240:243], v[232:235], v[128:131], a[240:243]
ds_read_b128 v[224:227], v248 offset:4096
v_mfma_f32_16x16x32_bf16 a[240:243], v[236:239], v[144:147], a[240:243]
v_exp_f32 v217, v217
v_mfma_f32_16x16x32_bf16 a[244:247], v[232:235], v[132:135], a[244:247]
v_exp_f32 v218, v218
v_mfma_f32_16x16x32_bf16 a[244:247], v[236:239], v[148:151], a[244:247]
v_exp_f32 v219, v219
v_mfma_f32_16x16x32_bf16 a[248:251], v[232:235], v[136:139], a[248:251]
ds_read_b128 v[228:231], v248 offset:4608
v_cvt_pk_bf16_f32 v186, v216, v217
v_mfma_f32_16x16x32_bf16 a[248:251], v[236:239], v[152:155], a[248:251]
v_cvt_pk_bf16_f32 v187, v218, v219
v_mfma_f32_16x16x32_bf16 a[252:255], v[232:235], v[140:143], a[252:255]
v_exp_f32 v220, v220
v_mfma_f32_16x16x32_bf16 a[252:255], v[236:239], v[156:159], a[252:255]
s_waitcnt lgkmcnt(2)
v_mfma_f32_16x16x32_bf16 v[192:195], v[240:243], v[0:3], 0
ds_read_b128 v[232:235], v248 offset:8192
v_mfma_f32_16x16x32_bf16 v[192:195], v[244:247], v[4:7], v[192:195]
v_exp_f32 v221, v221
v_mfma_f32_16x16x32_bf16 v[196:199], v[240:243], v[32:35], 0
v_exp_f32 v222, v222
v_mfma_f32_16x16x32_bf16 v[196:199], v[244:247], v[36:39], v[196:199]
v_exp_f32 v223, v223
v_mfma_f32_16x16x32_bf16 v[200:203], v[240:243], v[64:67], 0
ds_read_b128 v[236:239], v248 offset:8704
v_cvt_pk_bf16_f32 v190, v220, v221
v_mfma_f32_16x16x32_bf16 v[200:203], v[244:247], v[68:71], v[200:203]
v_cvt_pk_bf16_f32 v191, v222, v223
v_mfma_f32_16x16x32_bf16 v[204:207], v[240:243], v[96:99], 0
v_mfma_f32_16x16x32_bf16 v[204:207], v[244:247], v[100:103], v[204:207]
s_waitcnt lgkmcnt(2)
v_mfma_f32_16x16x32_bf16 v[192:195], v[224:227], v[8:11], v[192:195]
ds_read_b128 v[240:243], v248 offset:12288
v_mfma_f32_16x16x32_bf16 v[192:195], v[228:231], v[12:15], v[192:195]
v_mfma_f32_16x16x32_bf16 v[196:199], v[224:227], v[40:43], v[196:199]
v_mfma_f32_16x16x32_bf16 v[196:199], v[228:231], v[44:47], v[196:199]
v_mfma_f32_16x16x32_bf16 v[200:203], v[224:227], v[72:75], v[200:203]
ds_read_b128 v[244:247], v248 offset:12800
v_mfma_f32_16x16x32_bf16 v[200:203], v[228:231], v[76:79], v[200:203]
v_mfma_f32_16x16x32_bf16 v[204:207], v[224:227], v[104:107], v[204:207]
v_mfma_f32_16x16x32_bf16 v[204:207], v[228:231], v[108:111], v[204:207]
s_waitcnt lgkmcnt(2)
v_mfma_f32_16x16x32_bf16 v[192:195], v[232:235], v[16:19], v[192:195]
ds_read_b64_tr_b16 v[224:225], v249 offset:32768
v_mfma_f32_16x16x32_bf16 v[192:195], v[236:239], v[20:23], v[192:195]
v_mfma_f32_16x16x32_bf16 v[196:199], v[232:235], v[48:51], v[196:199]
ds_read_b64_tr_b16 v[226:227], v249 offset:34816
v_mfma_f32_16x16x32_bf16 v[196:199], v[236:239], v[52:55], v[196:199]
v_mfma_f32_16x16x32_bf16 v[200:203], v[232:235], v[80:83], v[200:203]
ds_read_b64_tr_b16 v[228:229], v249 offset:49152
v_mfma_f32_16x16x32_bf16 v[200:203], v[236:239], v[84:87], v[200:203]
v_mfma_f32_16x16x32_bf16 v[204:207], v[232:235], v[112:115], v[204:207]
ds_read_b64_tr_b16 v[230:231], v249 offset:51200
v_mfma_f32_16x16x32_bf16 v[204:207], v[236:239], v[116:119], v[204:207]
s_waitcnt lgkmcnt(4)
v_mfma_f32_16x16x32_bf16 v[192:195], v[240:243], v[24:27], v[192:195]
ds_read_b64_tr_b16 v[232:233], v250 offset:32768
v_mfma_f32_16x16x32_bf16 v[192:195], v[244:247], v[28:31], v[192:195]
v_mfma_f32_16x16x32_bf16 v[196:199], v[240:243], v[56:59], v[196:199]
ds_read_b64_tr_b16 v[234:235], v250 offset:34816
v_mfma_f32_16x16x32_bf16 v[196:199], v[244:247], v[60:63], v[196:199]
v_mfma_f32_16x16x32_bf16 v[200:203], v[240:243], v[88:91], v[200:203]
ds_read_b64_tr_b16 v[236:237], v250 offset:49152
v_mfma_f32_16x16x32_bf16 v[200:203], v[244:247], v[92:95], v[200:203]
s_sub_u32 s31, s31, 1
v_mfma_f32_16x16x32_bf16 v[204:207], v[240:243], v[120:123], v[204:207]
ds_read_b64_tr_b16 v[238:239], v250 offset:51200
v_mfma_f32_16x16x32_bf16 v[204:207], v[244:247], v[124:127], v[204:207]
s_waitcnt lgkmcnt(4)
v_mfma_f32_16x16x32_bf16 a[0:3], v[224:227], v[160:163], a[0:3]
ds_read_b64_tr_b16 v[240:241], v249 offset:33280
v_mfma_f32_16x16x32_bf16 a[0:3], v[228:231], v[176:179], a[0:3]
v_mfma_f32_16x16x32_bf16 a[4:7], v[224:227], v[164:167], a[4:7]
ds_read_b64_tr_b16 v[242:243], v249 offset:35328
v_mfma_f32_16x16x32_bf16 a[4:7], v[228:231], v[180:183], a[4:7]
v_exp_f32 v192, v192
v_mfma_f32_16x16x32_bf16 a[8:11], v[224:227], v[168:171], a[8:11]
ds_read_b64_tr_b16 v[244:245], v249 offset:49664
v_mfma_f32_16x16x32_bf16 a[8:11], v[228:231], v[184:187], a[8:11]
v_exp_f32 v193, v193
v_mfma_f32_16x16x32_bf16 a[12:15], v[224:227], v[172:175], a[12:15]
ds_read_b64_tr_b16 v[246:247], v249 offset:51712
v_cvt_pk_bf16_f32 v128, v192, v193
v_mfma_f32_16x16x32_bf16 a[12:15], v[228:231], v[188:191], a[12:15]
s_waitcnt lgkmcnt(4)
v_mfma_f32_16x16x32_bf16 a[16:19], v[232:235], v[160:163], a[16:19]
ds_read_b64_tr_b16 v[144:145], v250 offset:33280
v_mfma_f32_16x16x32_bf16 a[16:19], v[236:239], v[176:179], a[16:19]
v_exp_f32 v194, v194
v_mfma_f32_16x16x32_bf16 a[20:23], v[232:235], v[164:167], a[20:23]
ds_read_b64_tr_b16 v[146:147], v250 offset:35328
v_mfma_f32_16x16x32_bf16 a[20:23], v[236:239], v[180:183], a[20:23]
v_exp_f32 v195, v195
v_mfma_f32_16x16x32_bf16 a[24:27], v[232:235], v[168:171], a[24:27]
ds_read_b64_tr_b16 v[148:149], v250 offset:49664
v_cvt_pk_bf16_f32 v129, v194, v195
v_mfma_f32_16x16x32_bf16 a[24:27], v[236:239], v[184:187], a[24:27]
v_exp_f32 v196, v196
v_mfma_f32_16x16x32_bf16 a[28:31], v[232:235], v[172:175], a[28:31]
ds_read_b64_tr_b16 v[150:151], v250 offset:51712
v_mfma_f32_16x16x32_bf16 a[28:31], v[236:239], v[188:191], a[28:31]
s_waitcnt lgkmcnt(4)
v_mfma_f32_16x16x32_bf16 a[32:35], v[240:243], v[160:163], a[32:35]
ds_read_b128 v[224:227], v248 offset:2048
v_mfma_f32_16x16x32_bf16 a[32:35], v[244:247], v[176:179], a[32:35]
v_exp_f32 v197, v197
v_mfma_f32_16x16x32_bf16 a[36:39], v[240:243], v[164:167], a[36:39]
v_exp_f32 v198, v198
v_mfma_f32_16x16x32_bf16 a[36:39], v[244:247], v[180:183], a[36:39]
v_exp_f32 v199, v199
v_mfma_f32_16x16x32_bf16 a[40:43], v[240:243], v[168:171], a[40:43]
ds_read_b128 v[228:231], v248 offset:2560
v_cvt_pk_bf16_f32 v132, v196, v197
v_mfma_f32_16x16x32_bf16 a[40:43], v[244:247], v[184:187], a[40:43]
v_cvt_pk_bf16_f32 v133, v198, v199
v_mfma_f32_16x16x32_bf16 a[44:47], v[240:243], v[172:175], a[44:47]
v_exp_f32 v200, v200
v_mfma_f32_16x16x32_bf16 a[44:47], v[244:247], v[188:191], a[44:47]
s_waitcnt lgkmcnt(2)
v_mfma_f32_16x16x32_bf16 a[48:51], v[144:147], v[160:163], a[48:51]
ds_read_b128 v[232:235], v248 offset:6144
v_mfma_f32_16x16x32_bf16 a[48:51], v[148:151], v[176:179], a[48:51]
v_exp_f32 v201, v201
v_mfma_f32_16x16x32_bf16 a[52:55], v[144:147], v[164:167], a[52:55]
v_exp_f32 v202, v202
v_mfma_f32_16x16x32_bf16 a[52:55], v[148:151], v[180:183], a[52:55]
v_exp_f32 v203, v203
v_mfma_f32_16x16x32_bf16 a[56:59], v[144:147], v[168:171], a[56:59]
ds_read_b128 v[236:239], v248 offset:6656
v_cvt_pk_bf16_f32 v136, v200, v201
v_mfma_f32_16x16x32_bf16 a[56:59], v[148:151], v[184:187], a[56:59]
v_cvt_pk_bf16_f32 v137, v202, v203
v_mfma_f32_16x16x32_bf16 a[60:63], v[144:147], v[172:175], a[60:63]
v_exp_f32 v204, v204
v_mfma_f32_16x16x32_bf16 a[60:63], v[148:151], v[188:191], a[60:63]
s_waitcnt lgkmcnt(2)
v_mfma_f32_16x16x32_bf16 v[208:211], v[224:227], v[0:3], 0
ds_read_b128 v[240:243], v248 offset:10240
v_mfma_f32_16x16x32_bf16 v[208:211], v[228:231], v[4:7], v[208:211]
v_exp_f32 v205, v205
v_mfma_f32_16x16x32_bf16 v[212:215], v[224:227], v[32:35], 0
v_exp_f32 v206, v206
v_mfma_f32_16x16x32_bf16 v[212:215], v[228:231], v[36:39], v[212:215]
v_exp_f32 v207, v207
v_mfma_f32_16x16x32_bf16 v[216:219], v[224:227], v[64:67], 0
ds_read_b128 v[244:247], v248 offset:10752
v_cvt_pk_bf16_f32 v140, v204, v205
v_mfma_f32_16x16x32_bf16 v[216:219], v[228:231], v[68:71], v[216:219]
v_cvt_pk_bf16_f32 v141, v206, v207
v_mfma_f32_16x16x32_bf16 v[220:223], v[224:227], v[96:99], 0
v_mfma_f32_16x16x32_bf16 v[220:223], v[228:231], v[100:103], v[220:223]
s_waitcnt lgkmcnt(2)
v_mfma_f32_16x16x32_bf16 v[208:211], v[232:235], v[8:11], v[208:211]
ds_read_b128 v[144:147], v248 offset:14336
v_mfma_f32_16x16x32_bf16 v[208:211], v[236:239], v[12:15], v[208:211]
v_mfma_f32_16x16x32_bf16 v[212:215], v[232:235], v[40:43], v[212:215]
v_mfma_f32_16x16x32_bf16 v[212:215], v[236:239], v[44:47], v[212:215]
v_mfma_f32_16x16x32_bf16 v[216:219], v[232:235], v[72:75], v[216:219]
ds_read_b128 v[148:151], v248 offset:14848
v_mfma_f32_16x16x32_bf16 v[216:219], v[236:239], v[76:79], v[216:219]
v_mfma_f32_16x16x32_bf16 v[220:223], v[232:235], v[104:107], v[220:223]
v_mfma_f32_16x16x32_bf16 v[220:223], v[236:239], v[108:111], v[220:223]
s_waitcnt lgkmcnt(2)
v_mfma_f32_16x16x32_bf16 v[208:211], v[240:243], v[16:19], v[208:211]
ds_read_b64_tr_b16 v[224:225], v249 offset:36864
v_mfma_f32_16x16x32_bf16 v[208:211], v[244:247], v[20:23], v[208:211]
v_mfma_f32_16x16x32_bf16 v[212:215], v[240:243], v[48:51], v[212:215]
ds_read_b64_tr_b16 v[226:227], v249 offset:38912
v_mfma_f32_16x16x32_bf16 v[212:215], v[244:247], v[52:55], v[212:215]
v_mfma_f32_16x16x32_bf16 v[216:219], v[240:243], v[80:83], v[216:219]
ds_read_b64_tr_b16 v[228:229], v249 offset:53248
v_mfma_f32_16x16x32_bf16 v[216:219], v[244:247], v[84:87], v[216:219]
v_mfma_f32_16x16x32_bf16 v[220:223], v[240:243], v[112:115], v[220:223]
ds_read_b64_tr_b16 v[230:231], v249 offset:55296
v_mfma_f32_16x16x32_bf16 v[220:223], v[244:247], v[116:119], v[220:223]
s_waitcnt lgkmcnt(4)
v_mfma_f32_16x16x32_bf16 v[208:211], v[144:147], v[24:27], v[208:211]
ds_read_b64_tr_b16 v[232:233], v250 offset:36864
v_mfma_f32_16x16x32_bf16 v[208:211], v[148:151], v[28:31], v[208:211]
v_mfma_f32_16x16x32_bf16 v[212:215], v[144:147], v[56:59], v[212:215]
ds_read_b64_tr_b16 v[234:235], v250 offset:38912
v_mfma_f32_16x16x32_bf16 v[212:215], v[148:151], v[60:63], v[212:215]
v_mfma_f32_16x16x32_bf16 v[216:219], v[144:147], v[88:91], v[216:219]
ds_read_b64_tr_b16 v[236:237], v250 offset:53248
v_mfma_f32_16x16x32_bf16 v[216:219], v[148:151], v[92:95], v[216:219]
v_mfma_f32_16x16x32_bf16 v[220:223], v[144:147], v[120:123], v[220:223]
ds_read_b64_tr_b16 v[238:239], v250 offset:55296
v_mfma_f32_16x16x32_bf16 v[220:223], v[148:151], v[124:127], v[220:223]
s_waitcnt lgkmcnt(4)
v_mfma_f32_16x16x32_bf16 a[64:67], v[224:227], v[160:163], a[64:67]
ds_read_b64_tr_b16 v[240:241], v249 offset:37376
v_mfma_f32_16x16x32_bf16 a[64:67], v[228:231], v[176:179], a[64:67]
v_mfma_f32_16x16x32_bf16 a[68:71], v[224:227], v[164:167], a[68:71]
ds_read_b64_tr_b16 v[242:243], v249 offset:39424
v_mfma_f32_16x16x32_bf16 a[68:71], v[228:231], v[180:183], a[68:71]
v_exp_f32 v208, v208
v_mfma_f32_16x16x32_bf16 a[72:75], v[224:227], v[168:171], a[72:75]
ds_read_b64_tr_b16 v[244:245], v249 offset:53760
v_mfma_f32_16x16x32_bf16 a[72:75], v[228:231], v[184:187], a[72:75]
v_exp_f32 v209, v209
v_mfma_f32_16x16x32_bf16 a[76:79], v[224:227], v[172:175], a[76:79]
ds_read_b64_tr_b16 v[246:247], v249 offset:55808
v_cvt_pk_bf16_f32 v130, v208, v209
v_mfma_f32_16x16x32_bf16 a[76:79], v[228:231], v[188:191], a[76:79]
s_waitcnt lgkmcnt(4)
s_waitcnt vmcnt(0)
s_barrier
s_add_u32 m0, s30, 0xc000
v_mfma_f32_16x16x32_bf16 a[80:83], v[232:235], v[160:163], a[80:83]
ds_read_b64_tr_b16 v[224:225], v250 offset:37376
v_mfma_f32_16x16x32_bf16 a[80:83], v[236:239], v[176:179], a[80:83]
buffer_load_dwordx4 v251, s[12:15], s28 offen offset:0 lds
v_mfma_f32_16x16x32_bf16 a[84:87], v[232:235], v[164:167], a[84:87]
ds_read_b64_tr_b16 v[226:227], v250 offset:39424
v_mfma_f32_16x16x32_bf16 a[84:87], v[236:239], v[180:183], a[84:87]
v_exp_f32 v210, v210
v_mfma_f32_16x16x32_bf16 a[88:91], v[232:235], v[168:171], a[88:91]
ds_read_b64_tr_b16 v[228:229], v250 offset:53760
v_mfma_f32_16x16x32_bf16 a[88:91], v[236:239], v[184:187], a[88:91]
v_exp_f32 v211, v211
v_mfma_f32_16x16x32_bf16 a[92:95], v[232:235], v[172:175], a[92:95]
ds_read_b64_tr_b16 v[230:231], v250 offset:55808
v_cvt_pk_bf16_f32 v131, v210, v211
v_mfma_f32_16x16x32_bf16 a[92:95], v[236:239], v[188:191], a[92:95]
s_waitcnt lgkmcnt(4)
v_mfma_f32_16x16x32_bf16 a[96:99], v[240:243], v[160:163], a[96:99]
ds_read_b128 v[232:235], v248 offset:16384
v_mfma_f32_16x16x32_bf16 a[96:99], v[244:247], v[176:179], a[96:99]
buffer_load_dwordx4 v251, s[12:15], s28 offen offset:1024 lds
v_mfma_f32_16x16x32_bf16 a[100:103], v[240:243], v[164:167], a[100:103]
v_exp_f32 v212, v212
v_mfma_f32_16x16x32_bf16 a[100:103], v[244:247], v[180:183], a[100:103]
v_exp_f32 v213, v213
v_mfma_f32_16x16x32_bf16 a[104:107], v[240:243], v[168:171], a[104:107]
ds_read_b128 v[236:239], v248 offset:16896
v_cvt_pk_bf16_f32 v134, v212, v213
v_mfma_f32_16x16x32_bf16 a[104:107], v[244:247], v[184:187], a[104:107]
v_exp_f32 v214, v214
v_mfma_f32_16x16x32_bf16 a[108:111], v[240:243], v[172:175], a[108:111]
v_exp_f32 v215, v215
v_mfma_f32_16x16x32_bf16 a[108:111], v[244:247], v[188:191], a[108:111]
s_waitcnt lgkmcnt(2)
v_cvt_pk_bf16_f32 v135, v214, v215
v_mfma_f32_16x16x32_bf16 a[112:115], v[224:227], v[160:163], a[112:115]
ds_read_b128 v[240:243], v248 offset:20480
v_mfma_f32_16x16x32_bf16 a[112:115], v[228:231], v[176:179], a[112:115]
buffer_load_dwordx4 v251, s[12:15], s28 offen offset:2048 lds
v_mfma_f32_16x16x32_bf16 a[116:119], v[224:227], v[164:167], a[116:119]
v_exp_f32 v216, v216
v_mfma_f32_16x16x32_bf16 a[116:119], v[228:231], v[180:183], a[116:119]
v_exp_f32 v217, v217
v_mfma_f32_16x16x32_bf16 a[120:123], v[224:227], v[168:171], a[120:123]
ds_read_b128 v[244:247], v248 offset:20992
v_cvt_pk_bf16_f32 v138, v216, v217
v_mfma_f32_16x16x32_bf16 a[120:123], v[228:231], v[184:187], a[120:123]
v_exp_f32 v218, v218
v_mfma_f32_16x16x32_bf16 a[124:127], v[224:227], v[172:175], a[124:127]
v_exp_f32 v219, v219
v_mfma_f32_16x16x32_bf16 a[124:127], v[228:231], v[188:191], a[124:127]
s_waitcnt lgkmcnt(2)
v_cvt_pk_bf16_f32 v139, v218, v219
v_mfma_f32_16x16x32_bf16 v[192:195], v[232:235], v[0:3], 0
ds_read_b128 v[224:227], v248 offset:24576
v_mfma_f32_16x16x32_bf16 v[192:195], v[236:239], v[4:7], v[192:195]
buffer_load_dwordx4 v251, s[12:15], s28 offen offset:3072 lds
v_mfma_f32_16x16x32_bf16 v[196:199], v[232:235], v[32:35], 0
s_xor_b32 s30, s30, 0x10000
v_mfma_f32_16x16x32_bf16 v[196:199], v[236:239], v[36:39], v[196:199]
s_add_u32 s28, s28, 0x4000
v_mfma_f32_16x16x32_bf16 v[200:203], v[232:235], v[64:67], 0
ds_read_b128 v[228:231], v248 offset:25088
v_mfma_f32_16x16x32_bf16 v[200:203], v[236:239], v[68:71], v[200:203]
v_exp_f32 v220, v220
v_mfma_f32_16x16x32_bf16 v[204:207], v[232:235], v[96:99], 0
v_exp_f32 v221, v221
v_mfma_f32_16x16x32_bf16 v[204:207], v[236:239], v[100:103], v[204:207]
s_waitcnt lgkmcnt(2)
s_add_u32 m0, s30, 0x0
v_mfma_f32_16x16x32_bf16 v[192:195], v[240:243], v[8:11], v[192:195]
ds_read_b128 v[232:235], v248 offset:28672
v_cvt_pk_bf16_f32 v142, v220, v221
v_mfma_f32_16x16x32_bf16 v[192:195], v[244:247], v[12:15], v[192:195]
buffer_load_dwordx4 v251, s[12:15], s28 offen offset:0 lds
v_mfma_f32_16x16x32_bf16 v[196:199], v[240:243], v[40:43], v[196:199]
v_exp_f32 v222, v222
v_mfma_f32_16x16x32_bf16 v[196:199], v[244:247], v[44:47], v[196:199]
v_exp_f32 v223, v223
v_mfma_f32_16x16x32_bf16 v[200:203], v[240:243], v[72:75], v[200:203]
ds_read_b128 v[236:239], v248 offset:29184
v_cvt_pk_bf16_f32 v143, v222, v223
v_mfma_f32_16x16x32_bf16 v[200:203], v[244:247], v[76:79], v[200:203]
v_mfma_f32_16x16x32_bf16 v[204:207], v[240:243], v[104:107], v[204:207]
v_mfma_f32_16x16x32_bf16 v[204:207], v[244:247], v[108:111], v[204:207]
s_waitcnt lgkmcnt(2)
v_mfma_f32_16x16x32_bf16 v[192:195], v[224:227], v[16:19], v[192:195]
ds_read_b64_tr_b16 v[240:241], v249 offset:40960
v_mfma_f32_16x16x32_bf16 v[192:195], v[228:231], v[20:23], v[192:195]
buffer_load_dwordx4 v251, s[12:15], s28 offen offset:1024 lds
v_mfma_f32_16x16x32_bf16 v[196:199], v[224:227], v[48:51], v[196:199]
ds_read_b64_tr_b16 v[242:243], v249 offset:43008
v_mfma_f32_16x16x32_bf16 v[196:199], v[228:231], v[52:55], v[196:199]
v_mfma_f32_16x16x32_bf16 v[200:203], v[224:227], v[80:83], v[200:203]
ds_read_b64_tr_b16 v[244:245], v249 offset:57344
v_mfma_f32_16x16x32_bf16 v[200:203], v[228:231], v[84:87], v[200:203]
v_mfma_f32_16x16x32_bf16 v[204:207], v[224:227], v[112:115], v[204:207]
ds_read_b64_tr_b16 v[246:247], v249 offset:59392
v_mfma_f32_16x16x32_bf16 v[204:207], v[228:231], v[116:119], v[204:207]
s_waitcnt lgkmcnt(4)
v_mfma_f32_16x16x32_bf16 v[192:195], v[232:235], v[24:27], v[192:195]
ds_read_b64_tr_b16 v[224:225], v250 offset:40960
v_mfma_f32_16x16x32_bf16 v[192:195], v[236:239], v[28:31], v[192:195]
buffer_load_dwordx4 v251, s[12:15], s28 offen offset:2048 lds
v_mfma_f32_16x16x32_bf16 v[196:199], v[232:235], v[56:59], v[196:199]
ds_read_b64_tr_b16 v[226:227], v250 offset:43008
v_mfma_f32_16x16x32_bf16 v[196:199], v[236:239], v[60:63], v[196:199]
v_mfma_f32_16x16x32_bf16 v[200:203], v[232:235], v[88:91], v[200:203]
ds_read_b64_tr_b16 v[228:229], v250 offset:57344
v_mfma_f32_16x16x32_bf16 v[200:203], v[236:239], v[92:95], v[200:203]
v_mfma_f32_16x16x32_bf16 v[204:207], v[232:235], v[120:123], v[204:207]
ds_read_b64_tr_b16 v[230:231], v250 offset:59392
v_mfma_f32_16x16x32_bf16 v[204:207], v[236:239], v[124:127], v[204:207]
s_waitcnt lgkmcnt(4)
v_mfma_f32_16x16x32_bf16 a[128:131], v[240:243], v[160:163], a[128:131]
ds_read_b64_tr_b16 v[232:233], v249 offset:41472
v_mfma_f32_16x16x32_bf16 a[128:131], v[244:247], v[176:179], a[128:131]
buffer_load_dwordx4 v251, s[12:15], s28 offen offset:3072 lds
v_mfma_f32_16x16x32_bf16 a[132:135], v[240:243], v[164:167], a[132:135]
ds_read_b64_tr_b16 v[234:235], v249 offset:43520
v_mfma_f32_16x16x32_bf16 a[132:135], v[244:247], v[180:183], a[132:135]
s_add_u32 s28, s28, 0x4000
v_mfma_f32_16x16x32_bf16 a[136:139], v[240:243], v[168:171], a[136:139]
ds_read_b64_tr_b16 v[236:237], v249 offset:57856
v_mfma_f32_16x16x32_bf16 a[136:139], v[244:247], v[184:187], a[136:139]
v_exp_f32 v192, v192
v_mfma_f32_16x16x32_bf16 a[140:143], v[240:243], v[172:175], a[140:143]
ds_read_b64_tr_b16 v[238:239], v249 offset:59904
v_mfma_f32_16x16x32_bf16 a[140:143], v[244:247], v[188:191], a[140:143]
s_waitcnt lgkmcnt(4)
v_mfma_f32_16x16x32_bf16 a[144:147], v[224:227], v[160:163], a[144:147]
ds_read_b64_tr_b16 v[240:241], v250 offset:41472
v_mfma_f32_16x16x32_bf16 a[144:147], v[228:231], v[176:179], a[144:147]
v_exp_f32 v193, v193
v_mfma_f32_16x16x32_bf16 a[148:151], v[224:227], v[164:167], a[148:151]
ds_read_b64_tr_b16 v[242:243], v250 offset:43520
v_cvt_pk_bf16_f32 v144, v192, v193
v_mfma_f32_16x16x32_bf16 a[148:151], v[228:231], v[180:183], a[148:151]
v_exp_f32 v194, v194
v_mfma_f32_16x16x32_bf16 a[152:155], v[224:227], v[168:171], a[152:155]
ds_read_b64_tr_b16 v[244:245], v250 offset:57856
v_mfma_f32_16x16x32_bf16 a[152:155], v[228:231], v[184:187], a[152:155]
v_exp_f32 v195, v195
v_mfma_f32_16x16x32_bf16 a[156:159], v[224:227], v[172:175], a[156:159]
ds_read_b64_tr_b16 v[246:247], v250 offset:59904
v_cvt_pk_bf16_f32 v145, v194, v195
v_mfma_f32_16x16x32_bf16 a[156:159], v[228:231], v[188:191], a[156:159]
s_waitcnt lgkmcnt(4)
v_mfma_f32_16x16x32_bf16 a[160:163], v[232:235], v[160:163], a[160:163]
ds_read_b128 v[224:227], v248 offset:18432
v_mfma_f32_16x16x32_bf16 a[160:163], v[236:239], v[176:179], a[160:163]
v_exp_f32 v196, v196
v_mfma_f32_16x16x32_bf16 a[164:167], v[232:235], v[164:167], a[164:167]
v_exp_f32 v197, v197
v_mfma_f32_16x16x32_bf16 a[164:167], v[236:239], v[180:183], a[164:167]
v_exp_f32 v198, v198
v_mfma_f32_16x16x32_bf16 a[168:171], v[232:235], v[168:171], a[168:171]
ds_read_b128 v[228:231], v248 offset:18944
v_cvt_pk_bf16_f32 v148, v196, v197
v_mfma_f32_16x16x32_bf16 a[168:171], v[236:239], v[184:187], a[168:171]
v_exp_f32 v199, v199
v_mfma_f32_16x16x32_bf16 a[172:175], v[232:235], v[172:175], a[172:175]
v_exp_f32 v200, v200
v_mfma_f32_16x16x32_bf16 a[172:175], v[236:239], v[188:191], a[172:175]
s_waitcnt lgkmcnt(2)
v_cvt_pk_bf16_f32 v149, v198, v199
v_mfma_f32_16x16x32_bf16 a[176:179], v[240:243], v[160:163], a[176:179]
ds_read_b128 v[232:235], v248 offset:22528
v_mfma_f32_16x16x32_bf16 a[176:179], v[244:247], v[176:179], a[176:179]
v_exp_f32 v201, v201
v_mfma_f32_16x16x32_bf16 a[180:183], v[240:243], v[164:167], a[180:183]
v_exp_f32 v202, v202
v_mfma_f32_16x16x32_bf16 a[180:183], v[244:247], v[180:183], a[180:183]
v_exp_f32 v203, v203
v_mfma_f32_16x16x32_bf16 a[184:187], v[240:243], v[168:171], a[184:187]
ds_read_b128 v[236:239], v248 offset:23040
v_cvt_pk_bf16_f32 v152, v200, v201
v_mfma_f32_16x16x32_bf16 a[184:187], v[244:247], v[184:187], a[184:187]
v_cvt_pk_bf16_f32 v153, v202, v203
v_mfma_f32_16x16x32_bf16 a[188:191], v[240:243], v[172:175], a[188:191]
v_exp_f32 v204, v204
v_mfma_f32_16x16x32_bf16 a[188:191], v[244:247], v[188:191], a[188:191]
s_waitcnt lgkmcnt(2)
v_mfma_f32_16x16x32_bf16 v[208:211], v[224:227], v[0:3], 0
ds_read_b128 v[240:243], v248 offset:26624
v_mfma_f32_16x16x32_bf16 v[208:211], v[228:231], v[4:7], v[208:211]
v_exp_f32 v205, v205
v_mfma_f32_16x16x32_bf16 v[212:215], v[224:227], v[32:35], 0
v_exp_f32 v206, v206
v_mfma_f32_16x16x32_bf16 v[212:215], v[228:231], v[36:39], v[212:215]
v_exp_f32 v207, v207
v_mfma_f32_16x16x32_bf16 v[216:219], v[224:227], v[64:67], 0
ds_read_b128 v[244:247], v248 offset:27136
v_cvt_pk_bf16_f32 v156, v204, v205
v_mfma_f32_16x16x32_bf16 v[216:219], v[228:231], v[68:71], v[216:219]
v_cvt_pk_bf16_f32 v157, v206, v207
v_mfma_f32_16x16x32_bf16 v[220:223], v[224:227], v[96:99], 0
v_mfma_f32_16x16x32_bf16 v[220:223], v[228:231], v[100:103], v[220:223]
s_waitcnt lgkmcnt(2)
v_mfma_f32_16x16x32_bf16 v[208:211], v[232:235], v[8:11], v[208:211]
ds_read_b128 v[224:227], v248 offset:30720
v_mfma_f32_16x16x32_bf16 v[208:211], v[236:239], v[12:15], v[208:211]
v_mfma_f32_16x16x32_bf16 v[212:215], v[232:235], v[40:43], v[212:215]
v_mfma_f32_16x16x32_bf16 v[212:215], v[236:239], v[44:47], v[212:215]
v_mfma_f32_16x16x32_bf16 v[216:219], v[232:235], v[72:75], v[216:219]
ds_read_b128 v[228:231], v248 offset:31232
v_mfma_f32_16x16x32_bf16 v[216:219], v[236:239], v[76:79], v[216:219]
v_mfma_f32_16x16x32_bf16 v[220:223], v[232:235], v[104:107], v[220:223]
v_mfma_f32_16x16x32_bf16 v[220:223], v[236:239], v[108:111], v[220:223]
s_waitcnt lgkmcnt(2)
v_mfma_f32_16x16x32_bf16 v[208:211], v[240:243], v[16:19], v[208:211]
ds_read_b64_tr_b16 v[232:233], v249 offset:45056
v_mfma_f32_16x16x32_bf16 v[208:211], v[244:247], v[20:23], v[208:211]
v_mfma_f32_16x16x32_bf16 v[212:215], v[240:243], v[48:51], v[212:215]
ds_read_b64_tr_b16 v[234:235], v249 offset:47104
v_mfma_f32_16x16x32_bf16 v[212:215], v[244:247], v[52:55], v[212:215]
v_mfma_f32_16x16x32_bf16 v[216:219], v[240:243], v[80:83], v[216:219]
ds_read_b64_tr_b16 v[236:237], v249 offset:61440
v_mfma_f32_16x16x32_bf16 v[216:219], v[244:247], v[84:87], v[216:219]
v_mfma_f32_16x16x32_bf16 v[220:223], v[240:243], v[112:115], v[220:223]
ds_read_b64_tr_b16 v[238:239], v249 offset:63488
v_mfma_f32_16x16x32_bf16 v[220:223], v[244:247], v[116:119], v[220:223]
s_waitcnt lgkmcnt(4)
v_mfma_f32_16x16x32_bf16 v[208:211], v[224:227], v[24:27], v[208:211]
ds_read_b64_tr_b16 v[240:241], v250 offset:45056
v_mfma_f32_16x16x32_bf16 v[208:211], v[228:231], v[28:31], v[208:211]
v_mfma_f32_16x16x32_bf16 v[212:215], v[224:227], v[56:59], v[212:215]
ds_read_b64_tr_b16 v[242:243], v250 offset:47104
v_mfma_f32_16x16x32_bf16 v[212:215], v[228:231], v[60:63], v[212:215]
v_mfma_f32_16x16x32_bf16 v[216:219], v[224:227], v[88:91], v[216:219]
ds_read_b64_tr_b16 v[244:245], v250 offset:61440
v_mfma_f32_16x16x32_bf16 v[216:219], v[228:231], v[92:95], v[216:219]
v_mfma_f32_16x16x32_bf16 v[220:223], v[224:227], v[120:123], v[220:223]
ds_read_b64_tr_b16 v[246:247], v250 offset:63488
v_mfma_f32_16x16x32_bf16 v[220:223], v[228:231], v[124:127], v[220:223]
s_waitcnt lgkmcnt(4)
v_mfma_f32_16x16x32_bf16 a[192:195], v[232:235], v[160:163], a[192:195]
ds_read_b64_tr_b16 v[224:225], v249 offset:45568
v_mfma_f32_16x16x32_bf16 a[192:195], v[236:239], v[176:179], a[192:195]
v_mfma_f32_16x16x32_bf16 a[196:199], v[232:235], v[164:167], a[196:199]
ds_read_b64_tr_b16 v[226:227], v249 offset:47616
v_mfma_f32_16x16x32_bf16 a[196:199], v[236:239], v[180:183], a[196:199]
v_exp_f32 v208, v208
v_mfma_f32_16x16x32_bf16 a[200:203], v[232:235], v[168:171], a[200:203]
ds_read_b64_tr_b16 v[228:229], v249 offset:61952
v_mfma_f32_16x16x32_bf16 a[200:203], v[236:239], v[184:187], a[200:203]
v_exp_f32 v209, v209
v_mfma_f32_16x16x32_bf16 a[204:207], v[232:235], v[172:175], a[204:207]
ds_read_b64_tr_b16 v[230:231], v249 offset:64000
v_cvt_pk_bf16_f32 v146, v208, v209
v_mfma_f32_16x16x32_bf16 a[204:207], v[236:239], v[188:191], a[204:207]
s_waitcnt lgkmcnt(4)
v_mfma_f32_16x16x32_bf16 a[208:211], v[240:243], v[160:163], a[208:211]
ds_read_b64_tr_b16 v[232:233], v250 offset:45568
v_mfma_f32_16x16x32_bf16 a[208:211], v[244:247], v[176:179], a[208:211]
v_exp_f32 v210, v210
v_mfma_f32_16x16x32_bf16 a[212:215], v[240:243], v[164:167], a[212:215]
ds_read_b64_tr_b16 v[234:235], v250 offset:47616
v_mfma_f32_16x16x32_bf16 a[212:215], v[244:247], v[180:183], a[212:215]
v_exp_f32 v211, v211
v_mfma_f32_16x16x32_bf16 a[216:219], v[240:243], v[168:171], a[216:219]
ds_read_b64_tr_b16 v[236:237], v250 offset:61952
v_cvt_pk_bf16_f32 v147, v210, v211
v_mfma_f32_16x16x32_bf16 a[216:219], v[244:247], v[184:187], a[216:219]
v_exp_f32 v212, v212
v_mfma_f32_16x16x32_bf16 a[220:223], v[240:243], v[172:175], a[220:223]
ds_read_b64_tr_b16 v[238:239], v250 offset:64000
v_mfma_f32_16x16x32_bf16 a[220:223], v[244:247], v[188:191], a[220:223]
s_waitcnt lgkmcnt(4)
v_mfma_f32_16x16x32_bf16 a[224:227], v[224:227], v[160:163], a[224:227]
ds_read_b128 v[240:243], v248 offset:32768
v_mfma_f32_16x16x32_bf16 a[224:227], v[228:231], v[176:179], a[224:227]
v_exp_f32 v213, v213
v_mfma_f32_16x16x32_bf16 a[228:231], v[224:227], v[164:167], a[228:231]
v_exp_f32 v214, v214
v_mfma_f32_16x16x32_bf16 a[228:231], v[228:231], v[180:183], a[228:231]
v_exp_f32 v215, v215
v_mfma_f32_16x16x32_bf16 a[232:235], v[224:227], v[168:171], a[232:235]
ds_read_b128 v[244:247], v248 offset:33280
v_cvt_pk_bf16_f32 v150, v212, v213
v_mfma_f32_16x16x32_bf16 a[232:235], v[228:231], v[184:187], a[232:235]
v_cvt_pk_bf16_f32 v151, v214, v215
v_mfma_f32_16x16x32_bf16 a[236:239], v[224:227], v[172:175], a[236:239]
v_exp_f32 v216, v216
v_mfma_f32_16x16x32_bf16 a[236:239], v[228:231], v[188:191], a[236:239]
s_waitcnt lgkmcnt(2)
v_mfma_f32_16x16x32_bf16 a[240:243], v[232:235], v[160:163], a[240:243]
ds_read_b128 v[224:227], v248 offset:36864
v_mfma_f32_16x16x32_bf16 a[240:243], v[236:239], v[176:179], a[240:243]
v_exp_f32 v217, v217
v_mfma_f32_16x16x32_bf16 a[244:247], v[232:235], v[164:167], a[244:247]
v_exp_f32 v218, v218
v_mfma_f32_16x16x32_bf16 a[244:247], v[236:239], v[180:183], a[244:247]
v_exp_f32 v219, v219
v_mfma_f32_16x16x32_bf16 a[248:251], v[232:235], v[168:171], a[248:251]
ds_read_b128 v[228:231], v248 offset:37376
v_cvt_pk_bf16_f32 v154, v216, v217
v_mfma_f32_16x16x32_bf16 a[248:251], v[236:239], v[184:187], a[248:251]
v_cvt_pk_bf16_f32 v155, v218, v219
v_mfma_f32_16x16x32_bf16 a[252:255], v[232:235], v[172:175], a[252:255]
v_exp_f32 v220, v220
v_mfma_f32_16x16x32_bf16 a[252:255], v[236:239], v[188:191], a[252:255]
s_waitcnt lgkmcnt(2)
v_mfma_f32_16x16x32_bf16 v[192:195], v[240:243], v[0:3], 0
ds_read_b128 v[232:235], v248 offset:40960
v_mfma_f32_16x16x32_bf16 v[192:195], v[244:247], v[4:7], v[192:195]
v_xor_b32 v249, 0x10000, v249
v_mfma_f32_16x16x32_bf16 v[196:199], v[240:243], v[32:35], 0
v_exp_f32 v221, v221
v_mfma_f32_16x16x32_bf16 v[196:199], v[244:247], v[36:39], v[196:199]
v_xor_b32 v250, 0x10000, v250
v_cvt_pk_bf16_f32 v158, v220, v221
v_mfma_f32_16x16x32_bf16 v[200:203], v[240:243], v[64:67], 0
ds_read_b128 v[236:239], v248 offset:41472
v_mfma_f32_16x16x32_bf16 v[200:203], v[244:247], v[68:71], v[200:203]
v_exp_f32 v222, v222
v_mfma_f32_16x16x32_bf16 v[204:207], v[240:243], v[96:99], 0
v_exp_f32 v223, v223
v_mfma_f32_16x16x32_bf16 v[204:207], v[244:247], v[100:103], v[204:207]
s_waitcnt lgkmcnt(2)
v_cvt_pk_bf16_f32 v159, v222, v223
v_mfma_f32_16x16x32_bf16 v[192:195], v[224:227], v[8:11], v[192:195]
ds_read_b128 v[240:243], v248 offset:45056
v_mfma_f32_16x16x32_bf16 v[192:195], v[228:231], v[12:15], v[192:195]
v_mfma_f32_16x16x32_bf16 v[196:199], v[224:227], v[40:43], v[196:199]
v_mfma_f32_16x16x32_bf16 v[196:199], v[228:231], v[44:47], v[196:199]
v_mfma_f32_16x16x32_bf16 v[200:203], v[224:227], v[72:75], v[200:203]
ds_read_b128 v[244:247], v248 offset:45568
v_mfma_f32_16x16x32_bf16 v[200:203], v[228:231], v[76:79], v[200:203]
v_mfma_f32_16x16x32_bf16 v[204:207], v[224:227], v[104:107], v[204:207]
v_mfma_f32_16x16x32_bf16 v[204:207], v[228:231], v[108:111], v[204:207]
s_waitcnt lgkmcnt(2)
v_mfma_f32_16x16x32_bf16 v[192:195], v[232:235], v[16:19], v[192:195]
ds_read_b64_tr_b16 v[224:225], v249 offset:0
v_mfma_f32_16x16x32_bf16 v[192:195], v[236:239], v[20:23], v[192:195]
v_mfma_f32_16x16x32_bf16 v[196:199], v[232:235], v[48:51], v[196:199]
ds_read_b64_tr_b16 v[226:227], v249 offset:2048
v_mfma_f32_16x16x32_bf16 v[196:199], v[236:239], v[52:55], v[196:199]
v_mfma_f32_16x16x32_bf16 v[200:203], v[232:235], v[80:83], v[200:203]
ds_read_b64_tr_b16 v[228:229], v249 offset:16384
v_mfma_f32_16x16x32_bf16 v[200:203], v[236:239], v[84:87], v[200:203]
v_mfma_f32_16x16x32_bf16 v[204:207], v[232:235], v[112:115], v[204:207]
ds_read_b64_tr_b16 v[230:231], v249 offset:18432
v_mfma_f32_16x16x32_bf16 v[204:207], v[236:239], v[116:119], v[204:207]
s_waitcnt lgkmcnt(4)
v_mfma_f32_16x16x32_bf16 v[192:195], v[240:243], v[24:27], v[192:195]
ds_read_b64_tr_b16 v[232:233], v250 offset:0
v_mfma_f32_16x16x32_bf16 v[192:195], v[244:247], v[28:31], v[192:195]
v_mfma_f32_16x16x32_bf16 v[196:199], v[240:243], v[56:59], v[196:199]
ds_read_b64_tr_b16 v[234:235], v250 offset:2048
v_mfma_f32_16x16x32_bf16 v[196:199], v[244:247], v[60:63], v[196:199]
v_mfma_f32_16x16x32_bf16 v[200:203], v[240:243], v[88:91], v[200:203]
ds_read_b64_tr_b16 v[236:237], v250 offset:16384
v_mfma_f32_16x16x32_bf16 v[200:203], v[244:247], v[92:95], v[200:203]
s_sub_u32 s31, s31, 1
v_mfma_f32_16x16x32_bf16 v[204:207], v[240:243], v[120:123], v[204:207]
ds_read_b64_tr_b16 v[238:239], v250 offset:18432
v_mfma_f32_16x16x32_bf16 v[204:207], v[244:247], v[124:127], v[204:207]
s_cbranch_scc0 L2_loop
L2_tail_0:
s_cmp_eq_u32 s59, 5
s_cbranch_scc1 L2_tail_0_5
L2_tail_0_4:
s_waitcnt lgkmcnt(4)
v_mfma_f32_16x16x32_bf16 a[0:3], v[224:227], v[128:131], a[0:3]
ds_read_b128 v[240:243], v248 offset:34816
v_mfma_f32_16x16x32_bf16 a[0:3], v[228:231], v[144:147], a[0:3]
v_mfma_f32_16x16x32_bf16 a[4:7], v[224:227], v[132:135], a[4:7]
v_mfma_f32_16x16x32_bf16 a[4:7], v[228:231], v[148:151], a[4:7]
v_exp_f32 v192, v192
v_mfma_f32_16x16x32_bf16 a[8:11], v[224:227], v[136:139], a[8:11]
ds_read_b128 v[244:247], v248 offset:35328
v_mfma_f32_16x16x32_bf16 a[8:11], v[228:231], v[152:155], a[8:11]
v_exp_f32 v193, v193
v_mfma_f32_16x16x32_bf16 a[12:15], v[224:227], v[140:143], a[12:15]
v_exp_f32 v194, v194
v_mfma_f32_16x16x32_bf16 a[12:15], v[228:231], v[156:159], a[12:15]
s_waitcnt lgkmcnt(2)
v_cvt_pk_bf16_f32 v160, v192, v193
v_mfma_f32_16x16x32_bf16 a[16:19], v[232:235], v[128:131], a[16:19]
ds_read_b128 v[224:227], v248 offset:38912
v_mfma_f32_16x16x32_bf16 a[16:19], v[236:239], v[144:147], a[16:19]
v_exp_f32 v195, v195
v_mfma_f32_16x16x32_bf16 a[20:23], v[232:235], v[132:135], a[20:23]
v_exp_f32 v196, v196
v_mfma_f32_16x16x32_bf16 a[20:23], v[236:239], v[148:151], a[20:23]
v_exp_f32 v197, v197
v_mfma_f32_16x16x32_bf16 a[24:27], v[232:235], v[136:139], a[24:27]
ds_read_b128 v[228:231], v248 offset:39424
v_cvt_pk_bf16_f32 v161, v194, v195
v_mfma_f32_16x16x32_bf16 a[24:27], v[236:239], v[152:155], a[24:27]
v_exp_f32 v198, v198
v_mfma_f32_16x16x32_bf16 a[28:31], v[232:235], v[140:143], a[28:31]
v_exp_f32 v199, v199
v_mfma_f32_16x16x32_bf16 a[28:31], v[236:239], v[156:159], a[28:31]
s_waitcnt lgkmcnt(2)
v_cvt_pk_bf16_f32 v164, v196, v197
v_mfma_f32_16x16x32_bf16 v[208:211], v[240:243], v[0:3], 0
ds_read_b128 v[232:235], v248 offset:43008
v_cvt_pk_bf16_f32 v165, v198, v199
v_mfma_f32_16x16x32_bf16 v[208:211], v[244:247], v[4:7], v[208:211]
v_exp_f32 v200, v200
v_mfma_f32_16x16x32_bf16 v[212:215], v[240:243], v[32:35], 0
v_exp_f32 v201, v201
v_mfma_f32_16x16x32_bf16 v[212:215], v[244:247], v[36:39], v[212:215]
v_exp_f32 v202, v202
v_mfma_f32_16x16x32_bf16 v[216:219], v[240:243], v[64:67], 0
ds_read_b128 v[236:239], v248 offset:43520
v_cvt_pk_bf16_f32 v168, v200, v201
v_mfma_f32_16x16x32_bf16 v[216:219], v[244:247], v[68:71], v[216:219]
v_exp_f32 v203, v203
v_mfma_f32_16x16x32_bf16 v[220:223], v[240:243], v[96:99], 0
v_exp_f32 v204, v204
v_mfma_f32_16x16x32_bf16 v[220:223], v[244:247], v[100:103], v[220:223]
s_waitcnt lgkmcnt(2)
v_cvt_pk_bf16_f32 v169, v202, v203
v_mfma_f32_16x16x32_bf16 v[208:211], v[224:227], v[8:11], v[208:211]
ds_read_b128 v[240:243], v248 offset:47104
v_mfma_f32_16x16x32_bf16 v[208:211], v[228:231], v[12:15], v[208:211]
v_exp_f32 v205, v205
v_mfma_f32_16x16x32_bf16 v[212:215], v[224:227], v[40:43], v[212:215]
v_exp_f32 v206, v206
v_mfma_f32_16x16x32_bf16 v[212:215], v[228:231], v[44:47], v[212:215]
v_exp_f32 v207, v207
v_mfma_f32_16x16x32_bf16 v[216:219], v[224:227], v[72:75], v[216:219]
ds_read_b128 v[244:247], v248 offset:47616
v_cvt_pk_bf16_f32 v172, v204, v205
v_mfma_f32_16x16x32_bf16 v[216:219], v[228:231], v[76:79], v[216:219]
v_cvt_pk_bf16_f32 v173, v206, v207
v_mfma_f32_16x16x32_bf16 v[220:223], v[224:227], v[104:107], v[220:223]
v_mfma_f32_16x16x32_bf16 v[220:223], v[228:231], v[108:111], v[220:223]
s_waitcnt lgkmcnt(2)
s_waitcnt vmcnt(0)
s_barrier
v_mfma_f32_16x16x32_bf16 v[208:211], v[232:235], v[16:19], v[208:211]
ds_read_b128 v[224:227], v248 offset:49152
v_mfma_f32_16x16x32_bf16 v[208:211], v[236:239], v[20:23], v[208:211]
v_mfma_f32_16x16x32_bf16 v[212:215], v[232:235], v[48:51], v[212:215]
v_mfma_f32_16x16x32_bf16 v[212:215], v[236:239], v[52:55], v[212:215]
v_mfma_f32_16x16x32_bf16 v[216:219], v[232:235], v[80:83], v[216:219]
ds_read_b128 v[228:231], v248 offset:49664
v_mfma_f32_16x16x32_bf16 v[216:219], v[236:239], v[84:87], v[216:219]
v_mfma_f32_16x16x32_bf16 v[220:223], v[232:235], v[112:115], v[220:223]
v_mfma_f32_16x16x32_bf16 v[220:223], v[236:239], v[116:119], v[220:223]
s_waitcnt lgkmcnt(2)
v_mfma_f32_16x16x32_bf16 v[208:211], v[240:243], v[24:27], v[208:211]
ds_read_b128 v[232:235], v248 offset:53248
v_mfma_f32_16x16x32_bf16 v[208:211], v[244:247], v[28:31], v[208:211]
v_mfma_f32_16x16x32_bf16 v[212:215], v[240:243], v[56:59], v[212:215]
v_mfma_f32_16x16x32_bf16 v[212:215], v[244:247], v[60:63], v[212:215]
v_mfma_f32_16x16x32_bf16 v[216:219], v[240:243], v[88:91], v[216:219]
ds_read_b128 v[236:239], v248 offset:53760
v_mfma_f32_16x16x32_bf16 v[216:219], v[244:247], v[92:95], v[216:219]
v_mfma_f32_16x16x32_bf16 v[220:223], v[240:243], v[120:123], v[220:223]
v_mfma_f32_16x16x32_bf16 v[220:223], v[244:247], v[124:127], v[220:223]
s_waitcnt lgkmcnt(2)
v_mfma_f32_16x16x32_bf16 v[192:195], v[224:227], v[0:3], 0
ds_read_b128 v[240:243], v248 offset:57344
v_mfma_f32_16x16x32_bf16 v[192:195], v[228:231], v[4:7], v[192:195]
v_exp_f32 v208, v208
v_mfma_f32_16x16x32_bf16 v[196:199], v[224:227], v[32:35], 0
v_exp_f32 v209, v209
v_mfma_f32_16x16x32_bf16 v[196:199], v[228:231], v[36:39], v[196:199]
v_exp_f32 v210, v210
v_mfma_f32_16x16x32_bf16 v[200:203], v[224:227], v[64:67], 0
ds_read_b128 v[244:247], v248 offset:57856
v_cvt_pk_bf16_f32 v162, v208, v209
v_mfma_f32_16x16x32_bf16 v[200:203], v[228:231], v[68:71], v[200:203]
v_exp_f32 v211, v211
v_mfma_f32_16x16x32_bf16 v[204:207], v[224:227], v[96:99], 0
v_exp_f32 v212, v212
v_mfma_f32_16x16x32_bf16 v[204:207], v[228:231], v[100:103], v[204:207]
s_waitcnt lgkmcnt(2)
v_cvt_pk_bf16_f32 v163, v210, v211
v_mfma_f32_16x16x32_bf16 v[192:195], v[232:235], v[8:11], v[192:195]
ds_read_b128 v[224:227], v248 offset:61440
v_mfma_f32_16x16x32_bf16 v[192:195], v[236:239], v[12:15], v[192:195]
v_exp_f32 v213, v213
v_mfma_f32_16x16x32_bf16 v[196:199], v[232:235], v[40:43], v[196:199]
v_exp_f32 v214, v214
v_mfma_f32_16x16x32_bf16 v[196:199], v[236:239], v[44:47], v[196:199]
v_exp_f32 v215, v215
v_mfma_f32_16x16x32_bf16 v[200:203], v[232:235], v[72:75], v[200:203]
ds_read_b128 v[228:231], v248 offset:61952
v_cvt_pk_bf16_f32 v166, v212, v213
v_mfma_f32_16x16x32_bf16 v[200:203], v[236:239], v[76:79], v[200:203]
v_cvt_pk_bf16_f32 v167, v214, v215
v_mfma_f32_16x16x32_bf16 v[204:207], v[232:235], v[104:107], v[204:207]
v_exp_f32 v216, v216
v_mfma_f32_16x16x32_bf16 v[204:207], v[236:239], v[108:111], v[204:207]
s_waitcnt lgkmcnt(2)
v_mfma_f32_16x16x32_bf16 v[192:195], v[240:243], v[16:19], v[192:195]
ds_read_b128 v[232:235], v248 offset:51200
v_mfma_f32_16x16x32_bf16 v[192:195], v[244:247], v[20:23], v[192:195]
v_exp_f32 v217, v217
v_mfma_f32_16x16x32_bf16 v[196:199], v[240:243], v[48:51], v[196:199]
v_exp_f32 v218, v218
v_mfma_f32_16x16x32_bf16 v[196:199], v[244:247], v[52:55], v[196:199]
v_exp_f32 v219, v219
v_mfma_f32_16x16x32_bf16 v[200:203], v[240:243], v[80:83], v[200:203]
ds_read_b128 v[236:239], v248 offset:51712
v_cvt_pk_bf16_f32 v170, v216, v217
v_mfma_f32_16x16x32_bf16 v[200:203], v[244:247], v[84:87], v[200:203]
v_cvt_pk_bf16_f32 v171, v218, v219
v_mfma_f32_16x16x32_bf16 v[204:207], v[240:243], v[112:115], v[204:207]
v_exp_f32 v220, v220
v_mfma_f32_16x16x32_bf16 v[204:207], v[244:247], v[116:119], v[204:207]
s_waitcnt lgkmcnt(2)
v_mfma_f32_16x16x32_bf16 v[192:195], v[224:227], v[24:27], v[192:195]
ds_read_b128 v[240:243], v248 offset:55296
v_mfma_f32_16x16x32_bf16 v[192:195], v[228:231], v[28:31], v[192:195]
v_exp_f32 v221, v221
v_mfma_f32_16x16x32_bf16 v[196:199], v[224:227], v[56:59], v[196:199]
v_exp_f32 v222, v222
v_mfma_f32_16x16x32_bf16 v[196:199], v[228:231], v[60:63], v[196:199]
v_exp_f32 v223, v223
v_mfma_f32_16x16x32_bf16 v[200:203], v[224:227], v[88:91], v[200:203]
ds_read_b128 v[244:247], v248 offset:55808
v_cvt_pk_bf16_f32 v174, v220, v221
v_mfma_f32_16x16x32_bf16 v[200:203], v[228:231], v[92:95], v[200:203]
v_cvt_pk_bf16_f32 v175, v222, v223
v_mfma_f32_16x16x32_bf16 v[204:207], v[224:227], v[120:123], v[204:207]
v_mfma_f32_16x16x32_bf16 v[204:207], v[228:231], v[124:127], v[204:207]
s_waitcnt lgkmcnt(2)
v_mfma_f32_16x16x32_bf16 v[208:211], v[232:235], v[0:3], 0
ds_read_b128 v[224:227], v248 offset:59392
v_mfma_f32_16x16x32_bf16 v[208:211], v[236:239], v[4:7], v[208:211]
v_exp_f32 v192, v192
v_mfma_f32_16x16x32_bf16 v[212:215], v[232:235], v[32:35], 0
v_exp_f32 v193, v193
v_mfma_f32_16x16x32_bf16 v[212:215], v[236:239], v[36:39], v[212:215]
v_exp_f32 v194, v194
v_mfma_f32_16x16x32_bf16 v[216:219], v[232:235], v[64:67], 0
ds_read_b128 v[228:231], v248 offset:59904
v_cvt_pk_bf16_f32 v176, v192, v193
v_mfma_f32_16x16x32_bf16 v[216:219], v[236:239], v[68:71], v[216:219]
v_exp_f32 v195, v195
v_mfma_f32_16x16x32_bf16 v[220:223], v[232:235], v[96:99], 0
v_exp_f32 v196, v196
v_mfma_f32_16x16x32_bf16 v[220:223], v[236:239], v[100:103], v[220:223]
s_waitcnt lgkmcnt(2)
v_cvt_pk_bf16_f32 v177, v194, v195
v_mfma_f32_16x16x32_bf16 v[208:211], v[240:243], v[8:11], v[208:211]
ds_read_b128 v[232:235], v248 offset:63488
v_mfma_f32_16x16x32_bf16 v[208:211], v[244:247], v[12:15], v[208:211]
v_exp_f32 v197, v197
v_mfma_f32_16x16x32_bf16 v[212:215], v[240:243], v[40:43], v[212:215]
v_exp_f32 v198, v198
v_mfma_f32_16x16x32_bf16 v[212:215], v[244:247], v[44:47], v[212:215]
v_exp_f32 v199, v199
v_mfma_f32_16x16x32_bf16 v[216:219], v[240:243], v[72:75], v[216:219]
ds_read_b128 v[236:239], v248 offset:64000
v_cvt_pk_bf16_f32 v180, v196, v197
v_mfma_f32_16x16x32_bf16 v[216:219], v[244:247], v[76:79], v[216:219]
v_cvt_pk_bf16_f32 v181, v198, v199
v_mfma_f32_16x16x32_bf16 v[220:223], v[240:243], v[104:107], v[220:223]
v_exp_f32 v200, v200
v_mfma_f32_16x16x32_bf16 v[220:223], v[244:247], v[108:111], v[220:223]
s_waitcnt lgkmcnt(2)
v_mfma_f32_16x16x32_bf16 v[208:211], v[224:227], v[16:19], v[208:211]
ds_read_b64_tr_b16 v[240:241], v249 offset:512
v_mfma_f32_16x16x32_bf16 v[208:211], v[228:231], v[20:23], v[208:211]
v_exp_f32 v201, v201
v_mfma_f32_16x16x32_bf16 v[212:215], v[224:227], v[48:51], v[212:215]
ds_read_b64_tr_b16 v[242:243], v249 offset:2560
v_cvt_pk_bf16_f32 v184, v200, v201
v_mfma_f32_16x16x32_bf16 v[212:215], v[228:231], v[52:55], v[212:215]
v_exp_f32 v202, v202
v_mfma_f32_16x16x32_bf16 v[216:219], v[224:227], v[80:83], v[216:219]
ds_read_b64_tr_b16 v[244:245], v249 offset:16896
v_mfma_f32_16x16x32_bf16 v[216:219], v[228:231], v[84:87], v[216:219]
v_exp_f32 v203, v203
v_mfma_f32_16x16x32_bf16 v[220:223], v[224:227], v[112:115], v[220:223]
ds_read_b64_tr_b16 v[246:247], v249 offset:18944
v_cvt_pk_bf16_f32 v185, v202, v203
v_mfma_f32_16x16x32_bf16 v[220:223], v[228:231], v[116:119], v[220:223]
s_waitcnt lgkmcnt(4)
v_mfma_f32_16x16x32_bf16 v[208:211], v[232:235], v[24:27], v[208:211]
ds_read_b64_tr_b16 v[224:225], v250 offset:512
v_mfma_f32_16x16x32_bf16 v[208:211], v[236:239], v[28:31], v[208:211]
v_exp_f32 v204, v204
v_mfma_f32_16x16x32_bf16 v[212:215], v[232:235], v[56:59], v[212:215]
ds_read_b64_tr_b16 v[226:227], v250 offset:2560
v_mfma_f32_16x16x32_bf16 v[212:215], v[236:239], v[60:63], v[212:215]
v_exp_f32 v205, v205
v_mfma_f32_16x16x32_bf16 v[216:219], v[232:235], v[88:91], v[216:219]
ds_read_b64_tr_b16 v[228:229], v250 offset:16896
v_cvt_pk_bf16_f32 v188, v204, v205
v_mfma_f32_16x16x32_bf16 v[216:219], v[236:239], v[92:95], v[216:219]
v_exp_f32 v206, v206
v_mfma_f32_16x16x32_bf16 v[220:223], v[232:235], v[120:123], v[220:223]
ds_read_b64_tr_b16 v[230:231], v250 offset:18944
v_mfma_f32_16x16x32_bf16 v[220:223], v[236:239], v[124:127], v[220:223]
s_waitcnt lgkmcnt(4)
v_mfma_f32_16x16x32_bf16 a[32:35], v[240:243], v[128:131], a[32:35]
ds_read_b64_tr_b16 v[232:233], v249 offset:4096
v_mfma_f32_16x16x32_bf16 a[32:35], v[244:247], v[144:147], a[32:35]
v_exp_f32 v207, v207
v_mfma_f32_16x16x32_bf16 a[36:39], v[240:243], v[132:135], a[36:39]
ds_read_b64_tr_b16 v[234:235], v249 offset:6144
v_cvt_pk_bf16_f32 v189, v206, v207
v_mfma_f32_16x16x32_bf16 a[36:39], v[244:247], v[148:151], a[36:39]
v_exp_f32 v208, v208
v_mfma_f32_16x16x32_bf16 a[40:43], v[240:243], v[136:139], a[40:43]
ds_read_b64_tr_b16 v[236:237], v249 offset:20480
v_mfma_f32_16x16x32_bf16 a[40:43], v[244:247], v[152:155], a[40:43]
v_exp_f32 v209, v209
v_mfma_f32_16x16x32_bf16 a[44:47], v[240:243], v[140:143], a[44:47]
ds_read_b64_tr_b16 v[238:239], v249 offset:22528
v_cvt_pk_bf16_f32 v178, v208, v209
v_mfma_f32_16x16x32_bf16 a[44:47], v[244:247], v[156:159], a[44:47]
s_waitcnt lgkmcnt(4)
v_mfma_f32_16x16x32_bf16 a[48:51], v[224:227], v[128:131], a[48:51]
ds_read_b64_tr_b16 v[240:241], v250 offset:4096
v_mfma_f32_16x16x32_bf16 a[48:51], v[228:231], v[144:147], a[48:51]
v_exp_f32 v210, v210
v_mfma_f32_16x16x32_bf16 a[52:55], v[224:227], v[132:135], a[52:55]
ds_read_b64_tr_b16 v[242:243], v250 offset:6144
v_mfma_f32_16x16x32_bf16 a[52:55], v[228:231], v[148:151], a[52:55]
v_exp_f32 v211, v211
v_mfma_f32_16x16x32_bf16 a[56:59], v[224:227], v[136:139], a[56:59]
ds_read_b64_tr_b16 v[244:245], v250 offset:20480
v_cvt_pk_bf16_f32 v179, v210, v211
v_mfma_f32_16x16x32_bf16 a[56:59], v[228:231], v[152:155], a[56:59]
v_exp_f32 v212, v212
v_mfma_f32_16x16x32_bf16 a[60:63], v[224:227], v[140:143], a[60:63]
ds_read_b64_tr_b16 v[246:247], v250 offset:22528
v_mfma_f32_16x16x32_bf16 a[60:63], v[228:231], v[156:159], a[60:63]
s_waitcnt lgkmcnt(4)
v_mfma_f32_16x16x32_bf16 a[64:67], v[232:235], v[128:131], a[64:67]
ds_read_b64_tr_b16 v[224:225], v249 offset:4608
v_mfma_f32_16x16x32_bf16 a[64:67], v[236:239], v[144:147], a[64:67]
v_exp_f32 v213, v213
v_mfma_f32_16x16x32_bf16 a[68:71], v[232:235], v[132:135], a[68:71]
ds_read_b64_tr_b16 v[226:227], v249 offset:6656
v_cvt_pk_bf16_f32 v182, v212, v213
v_mfma_f32_16x16x32_bf16 a[68:71], v[236:239], v[148:151], a[68:71]
v_exp_f32 v214, v214
v_mfma_f32_16x16x32_bf16 a[72:75], v[232:235], v[136:139], a[72:75]
ds_read_b64_tr_b16 v[228:229], v249 offset:20992
v_mfma_f32_16x16x32_bf16 a[72:75], v[236:239], v[152:155], a[72:75]
v_exp_f32 v215, v215
v_mfma_f32_16x16x32_bf16 a[76:79], v[232:235], v[140:143], a[76:79]
ds_read_b64_tr_b16 v[230:231], v249 offset:23040
v_cvt_pk_bf16_f32 v183, v214, v215
v_mfma_f32_16x16x32_bf16 a[76:79], v[236:239], v[156:159], a[76:79]
s_waitcnt lgkmcnt(4)
v_mfma_f32_16x16x32_bf16 a[80:83], v[240:243], v[128:131], a[80:83]
ds_read_b64_tr_b16 v[232:233], v250 offset:4608
v_mfma_f32_16x16x32_bf16 a[80:83], v[244:247], v[144:147], a[80:83]
v_exp_f32 v216, v216
v_mfma_f32_16x16x32_bf16 a[84:87], v[240:243], v[132:135], a[84:87]
ds_read_b64_tr_b16 v[234:235], v250 offset:6656
v_mfma_f32_16x16x32_bf16 a[84:87], v[244:247], v[148:151], a[84:87]
v_exp_f32 v217, v217
v_mfma_f32_16x16x32_bf16 a[88:91], v[240:243], v[136:139], a[88:91]
ds_read_b64_tr_b16 v[236:237], v250 offset:20992
v_cvt_pk_bf16_f32 v186, v216, v217
v_mfma_f32_16x16x32_bf16 a[88:91], v[244:247], v[152:155], a[88:91]
v_exp_f32 v218, v218
v_mfma_f32_16x16x32_bf16 a[92:95], v[240:243], v[140:143], a[92:95]
ds_read_b64_tr_b16 v[238:239], v250 offset:23040
v_mfma_f32_16x16x32_bf16 a[92:95], v[244:247], v[156:159], a[92:95]
s_waitcnt lgkmcnt(4)
v_mfma_f32_16x16x32_bf16 a[96:99], v[224:227], v[128:131], a[96:99]
ds_read_b64_tr_b16 v[240:241], v249 offset:8192
v_mfma_f32_16x16x32_bf16 a[96:99], v[228:231], v[144:147], a[96:99]
v_exp_f32 v219, v219
v_mfma_f32_16x16x32_bf16 a[100:103], v[224:227], v[132:135], a[100:103]
ds_read_b64_tr_b16 v[242:243], v249 offset:10240
v_cvt_pk_bf16_f32 v187, v218, v219
v_mfma_f32_16x16x32_bf16 a[100:103], v[228:231], v[148:151], a[100:103]
v_exp_f32 v220, v220
v_mfma_f32_16x16x32_bf16 a[104:107], v[224:227], v[136:139], a[104:107]
ds_read_b64_tr_b16 v[244:245], v249 offset:24576
v_mfma_f32_16x16x32_bf16 a[104:107], v[228:231], v[152:155], a[104:107]
v_exp_f32 v221, v221
v_mfma_f32_16x16x32_bf16 a[108:111], v[224:227], v[140:143], a[108:111]
ds_read_b64_tr_b16 v[246:247], v249 offset:26624
v_cvt_pk_bf16_f32 v190, v220, v221
v_mfma_f32_16x16x32_bf16 a[108:111], v[228:231], v[156:159], a[108:111]
s_waitcnt lgkmcnt(4)
v_mfma_f32_16x16x32_bf16 a[112:115], v[232:235], v[128:131], a[112:115]
ds_read_b64_tr_b16 v[224:225], v249 offset:32768
v_mfma_f32_16x16x32_bf16 a[112:115], v[236:239], v[144:147], a[112:115]
v_exp_f32 v222, v222
v_mfma_f32_16x16x32_bf16 a[116:119], v[232:235], v[132:135], a[116:119]
ds_read_b64_tr_b16 v[226:227], v249 offset:34816
v_mfma_f32_16x16x32_bf16 a[116:119], v[236:239], v[148:151], a[116:119]
v_exp_f32 v223, v223
v_mfma_f32_16x16x32_bf16 a[120:123], v[232:235], v[136:139], a[120:123]
ds_read_b64_tr_b16 v[228:229], v249 offset:49152
v_cvt_pk_bf16_f32 v191, v222, v223
v_mfma_f32_16x16x32_bf16 a[120:123], v[236:239], v[152:155], a[120:123]
v_mfma_f32_16x16x32_bf16 a[124:127], v[232:235], v[140:143], a[124:127]
ds_read_b64_tr_b16 v[230:231], v249 offset:51200
v_mfma_f32_16x16x32_bf16 a[124:127], v[236:239], v[156:159], a[124:127]
s_waitcnt lgkmcnt(4)
v_mfma_f32_16x16x32_bf16 a[128:131], v[240:243], v[128:131], a[128:131]
ds_read_b64_tr_b16 v[232:233], v250 offset:32768
v_mfma_f32_16x16x32_bf16 a[128:131], v[244:247], v[144:147], a[128:131]
v_mfma_f32_16x16x32_bf16 a[132:135], v[240:243], v[132:135], a[132:135]
ds_read_b64_tr_b16 v[234:235], v250 offset:34816
v_mfma_f32_16x16x32_bf16 a[132:135], v[244:247], v[148:151], a[132:135]
v_mfma_f32_16x16x32_bf16 a[136:139], v[240:243], v[136:139], a[136:139]
ds_read_b64_tr_b16 v[236:237], v250 offset:49152
v_mfma_f32_16x16x32_bf16 a[136:139], v[244:247], v[152:155], a[136:139]
v_mfma_f32_16x16x32_bf16 a[140:143], v[240:243], v[140:143], a[140:143]
ds_read_b64_tr_b16 v[238:239], v250 offset:51200
v_mfma_f32_16x16x32_bf16 a[140:143], v[244:247], v[156:159], a[140:143]
s_waitcnt lgkmcnt(4)
v_mfma_f32_16x16x32_bf16 a[0:3], v[224:227], v[160:163], a[0:3]
ds_read_b64_tr_b16 v[240:241], v249 offset:33280
v_mfma_f32_16x16x32_bf16 a[0:3], v[228:231], v[176:179], a[0:3]
v_mfma_f32_16x16x32_bf16 a[4:7], v[224:227], v[164:167], a[4:7]
ds_read_b64_tr_b16 v[242:243], v249 offset:35328
v_mfma_f32_16x16x32_bf16 a[4:7], v[228:231], v[180:183], a[4:7]
v_mfma_f32_16x16x32_bf16 a[8:11], v[224:227], v[168:171], a[8:11]
ds_read_b64_tr_b16 v[244:245], v249 offset:49664
v_mfma_f32_16x16x32_bf16 a[8:11], v[228:231], v[184:187], a[8:11]
v_mfma_f32_16x16x32_bf16 a[12:15], v[224:227], v[172:175], a[12:15]
ds_read_b64_tr_b16 v[246:247], v249 offset:51712
v_mfma_f32_16x16x32_bf16 a[12:15], v[228:231], v[188:191], a[12:15]
s_waitcnt lgkmcnt(4)
v_mfma_f32_16x16x32_bf16 a[16:19], v[232:235], v[160:163], a[16:19]
ds_read_b64_tr_b16 v[224:225], v250 offset:33280
v_mfma_f32_16x16x32_bf16 a[16:19], v[236:239], v[176:179], a[16:19]
v_mfma_f32_16x16x32_bf16 a[20:23], v[232:235], v[164:167], a[20:23]
ds_read_b64_tr_b16 v[226:227], v250 offset:35328
v_accvgpr_read_b32 v192, a0
v_accvgpr_read_b32 v193, a4
v_mfma_f32_16x16x32_bf16 a[20:23], v[236:239], v[180:183], a[20:23]
v_accvgpr_read_b32 v194, a8
v_accvgpr_read_b32 v195, a12
v_lshlrev_b32 v253, 2, v252
v_mfma_f32_16x16x32_bf16 a[24:27], v[232:235], v[168:171], a[24:27]
ds_read_b64_tr_b16 v[228:229], v250 offset:49664
v_max3_u32 v254, v192, v193, v194
v_min3_u32 v255, v192, v193, v194
v_mfma_f32_16x16x32_bf16 a[24:27], v[236:239], v[184:187], a[24:27]
v_max_u32 v254, v254, v195
v_min_u32 v255, v255, v195
v_mfma_f32_16x16x32_bf16 a[28:31], v[232:235], v[172:175], a[28:31]
ds_read_b64_tr_b16 v[230:231], v250 offset:51712
v_mfma_f32_16x16x32_bf16 a[28:31], v[236:239], v[188:191], a[28:31]
s_waitcnt lgkmcnt(4)
v_mfma_f32_16x16x32_bf16 a[32:35], v[240:243], v[160:163], a[32:35]
ds_read_b64_tr_b16 v[232:233], v249 offset:36864
v_mfma_f32_16x16x32_bf16 a[32:35], v[244:247], v[176:179], a[32:35]
s_mov_b64 exec, 0xffff
buffer_store_dword v192, v253, s[24:27], s48 offen offset:4 sc1
buffer_store_dword v193, v253, s[24:27], s48 offen offset:1028 sc1
buffer_store_dword v194, v253, s[24:27], s48 offen offset:2052 sc1
buffer_store_dword v195, v253, s[24:27], s48 offen offset:3076 sc1
v_cmp_lt_u32 s[50:51], s52, v254
v_cmp_gt_u32 vcc, s53, v255
s_mov_b64 exec, -1
v_mfma_f32_16x16x32_bf16 a[36:39], v[240:243], v[164:167], a[36:39]
ds_read_b64_tr_b16 v[234:235], v249 offset:38912
v_accvgpr_read_b32 v192, a0
v_accvgpr_read_b32 v193, a1
v_mfma_f32_16x16x32_bf16 a[36:39], v[244:247], v[180:183], a[36:39]
v_accvgpr_read_b32 v194, a2
v_accvgpr_read_b32 v195, a3
v_cvt_pk_bf16_f32 v16, v192, v193
v_mfma_f32_16x16x32_bf16 a[40:43], v[240:243], v[168:171], a[40:43]
ds_read_b64_tr_b16 v[236:237], v249 offset:53248
v_cvt_pk_bf16_f32 v17, v194, v195
v_accvgpr_read_b32 v200, a4
v_mfma_f32_16x16x32_bf16 a[40:43], v[244:247], v[184:187], a[40:43]
v_accvgpr_read_b32 v201, a5
v_accvgpr_read_b32 v202, a6
v_accvgpr_read_b32 v203, a7
v_mfma_f32_16x16x32_bf16 a[44:47], v[240:243], v[172:175], a[44:47]
ds_read_b64_tr_b16 v[238:239], v249 offset:55296
v_cvt_pk_bf16_f32 v48, v200, v201
v_cvt_pk_bf16_f32 v49, v202, v203
v_mfma_f32_16x16x32_bf16 a[44:47], v[244:247], v[188:191], a[44:47]
s_waitcnt lgkmcnt(4)
v_accvgpr_read_b32 v208, a8
v_accvgpr_read_b32 v209, a9
v_mfma_f32_16x16x32_bf16 a[48:51], v[224:227], v[160:163], a[48:51]
ds_read_b64_tr_b16 v[240:241], v250 offset:36864
v_accvgpr_read_b32 v210, a10
v_accvgpr_read_b32 v211, a11
v_mfma_f32_16x16x32_bf16 a[48:51], v[228:231], v[176:179], a[48:51]
v_cvt_pk_bf16_f32 v80, v208, v209
v_cvt_pk_bf16_f32 v81, v210, v211
v_accvgpr_read_b32 v216, a12
v_mfma_f32_16x16x32_bf16 a[52:55], v[224:227], v[164:167], a[52:55]
ds_read_b64_tr_b16 v[242:243], v250 offset:38912
v_accvgpr_read_b32 v217, a13
v_accvgpr_read_b32 v218, a14
v_mfma_f32_16x16x32_bf16 a[52:55], v[228:231], v[180:183], a[52:55]
v_accvgpr_read_b32 v219, a15
v_cvt_pk_bf16_f32 v112, v216, v217
v_cvt_pk_bf16_f32 v113, v218, v219
v_mfma_f32_16x16x32_bf16 a[56:59], v[224:227], v[168:171], a[56:59]
ds_read_b64_tr_b16 v[244:245], v250 offset:53248
v_accvgpr_read_b32 v196, a16
v_accvgpr_read_b32 v197, a17
v_mfma_f32_16x16x32_bf16 a[56:59], v[228:231], v[184:187], a[56:59]
v_accvgpr_read_b32 v198, a18
v_accvgpr_read_b32 v199, a19
v_cvt_pk_bf16_f32 v18, v196, v197
v_mfma_f32_16x16x32_bf16 a[60:63], v[224:227], v[172:175], a[60:63]
ds_read_b64_tr_b16 v[246:247], v250 offset:55296
v_cvt_pk_bf16_f32 v19, v198, v199
buffer_store_dwordx4 v[16:19], v252, s[20:23], s40 offen offset:0 sc1
v_mfma_f32_16x16x32_bf16 a[60:63], v[228:231], v[188:191], a[60:63]
s_waitcnt lgkmcnt(4)
v_accvgpr_read_b32 v204, a20
v_accvgpr_read_b32 v205, a21
v_mfma_f32_16x16x32_bf16 a[64:67], v[232:235], v[160:163], a[64:67]
ds_read_b64_tr_b16 v[224:225], v249 offset:37376
v_accvgpr_read_b32 v206, a22
v_accvgpr_read_b32 v207, a23
v_mfma_f32_16x16x32_bf16 a[64:67], v[236:239], v[176:179], a[64:67]
v_cvt_pk_bf16_f32 v50, v204, v205
v_cvt_pk_bf16_f32 v51, v206, v207
buffer_store_dwordx4 v[48:51], v252, s[20:23], s41 offen offset:0 sc1
v_mfma_f32_16x16x32_bf16 a[68:71], v[232:235], v[164:167], a[68:71]
ds_read_b64_tr_b16 v[226:227], v249 offset:39424
v_accvgpr_read_b32 v212, a24
v_accvgpr_read_b32 v213, a25
v_mfma_f32_16x16x32_bf16 a[68:71], v[236:239], v[180:183], a[68:71]
v_accvgpr_read_b32 v214, a26
v_accvgpr_read_b32 v215, a27
v_cvt_pk_bf16_f32 v82, v212, v213
v_mfma_f32_16x16x32_bf16 a[72:75], v[232:235], v[168:171], a[72:75]
ds_read_b64_tr_b16 v[228:229], v249 offset:53760
v_cvt_pk_bf16_f32 v83, v214, v215
buffer_store_dwordx4 v[80:83], v252, s[20:23], s42 offen offset:0 sc1
v_mfma_f32_16x16x32_bf16 a[72:75], v[236:239], v[184:187], a[72:75]
v_accvgpr_read_b32 v220, a28
v_accvgpr_read_b32 v221, a29
v_accvgpr_read_b32 v222, a30
v_mfma_f32_16x16x32_bf16 a[76:79], v[232:235], v[172:175], a[76:79]
ds_read_b64_tr_b16 v[230:231], v249 offset:55808
v_accvgpr_read_b32 v223, a31
v_cvt_pk_bf16_f32 v114, v220, v221
v_mfma_f32_16x16x32_bf16 a[76:79], v[236:239], v[188:191], a[76:79]
s_waitcnt lgkmcnt(4)
v_cvt_pk_bf16_f32 v115, v222, v223
buffer_store_dwordx4 v[112:115], v252, s[20:23], s43 offen offset:0 sc1
v_mfma_f32_16x16x32_bf16 a[80:83], v[240:243], v[160:163], a[80:83]
ds_read_b64_tr_b16 v[232:233], v250 offset:37376
v_accvgpr_read_b32 v192, a32
v_accvgpr_read_b32 v193, a33
v_mfma_f32_16x16x32_bf16 a[80:83], v[244:247], v[176:179], a[80:83]
v_accvgpr_read_b32 v194, a34
v_accvgpr_read_b32 v195, a35
v_cvt_pk_bf16_f32 v20, v192, v193
v_mfma_f32_16x16x32_bf16 a[84:87], v[240:243], v[164:167], a[84:87]
ds_read_b64_tr_b16 v[234:235], v250 offset:39424
v_cvt_pk_bf16_f32 v21, v194, v195
v_accvgpr_read_b32 v200, a36
v_mfma_f32_16x16x32_bf16 a[84:87], v[244:247], v[180:183], a[84:87]
v_accvgpr_read_b32 v201, a37
v_accvgpr_read_b32 v202, a38
v_accvgpr_read_b32 v203, a39
v_mfma_f32_16x16x32_bf16 a[88:91], v[240:243], v[168:171], a[88:91]
ds_read_b64_tr_b16 v[236:237], v250 offset:53760
v_cvt_pk_bf16_f32 v52, v200, v201
v_cvt_pk_bf16_f32 v53, v202, v203
v_mfma_f32_16x16x32_bf16 a[88:91], v[244:247], v[184:187], a[88:91]
v_accvgpr_read_b32 v208, a40
v_accvgpr_read_b32 v209, a41
v_accvgpr_read_b32 v210, a42
v_mfma_f32_16x16x32_bf16 a[92:95], v[240:243], v[172:175], a[92:95]
ds_read_b64_tr_b16 v[238:239], v250 offset:55808
v_accvgpr_read_b32 v211, a43
v_cvt_pk_bf16_f32 v84, v208, v209
v_mfma_f32_16x16x32_bf16 a[92:95], v[244:247], v[188:191], a[92:95]
s_waitcnt lgkmcnt(4)
v_cvt_pk_bf16_f32 v85, v210, v211
v_accvgpr_read_b32 v216, a44
v_mfma_f32_16x16x32_bf16 a[96:99], v[224:227], v[160:163], a[96:99]
ds_read_b64_tr_b16 v[240:241], v250 offset:8192
v_accvgpr_read_b32 v217, a45
v_accvgpr_read_b32 v218, a46
v_mfma_f32_16x16x32_bf16 a[96:99], v[228:231], v[176:179], a[96:99]
v_accvgpr_read_b32 v219, a47
v_cvt_pk_bf16_f32 v116, v216, v217
v_cvt_pk_bf16_f32 v117, v218, v219
v_mfma_f32_16x16x32_bf16 a[100:103], v[224:227], v[164:167], a[100:103]
ds_read_b64_tr_b16 v[242:243], v250 offset:10240
v_accvgpr_read_b32 v196, a48
v_accvgpr_read_b32 v197, a49
v_mfma_f32_16x16x32_bf16 a[100:103], v[228:231], v[180:183], a[100:103]
v_accvgpr_read_b32 v198, a50
v_accvgpr_read_b32 v199, a51
v_cvt_pk_bf16_f32 v22, v196, v197
v_mfma_f32_16x16x32_bf16 a[104:107], v[224:227], v[168:171], a[104:107]
ds_read_b64_tr_b16 v[244:245], v250 offset:24576
v_cvt_pk_bf16_f32 v23, v198, v199
buffer_store_dwordx4 v[20:23], v252, s[20:23], s40 offen offset:1024 sc1
v_mfma_f32_16x16x32_bf16 a[104:107], v[228:231], v[184:187], a[104:107]
v_accvgpr_read_b32 v204, a52
v_accvgpr_read_b32 v205, a53
v_accvgpr_read_b32 v206, a54
v_mfma_f32_16x16x32_bf16 a[108:111], v[224:227], v[172:175], a[108:111]
ds_read_b64_tr_b16 v[246:247], v250 offset:26624
v_accvgpr_read_b32 v207, a55
v_cvt_pk_bf16_f32 v54, v204, v205
v_mfma_f32_16x16x32_bf16 a[108:111], v[228:231], v[188:191], a[108:111]
s_waitcnt lgkmcnt(4)
v_cvt_pk_bf16_f32 v55, v206, v207
buffer_store_dwordx4 v[52:55], v252, s[20:23], s41 offen offset:1024 sc1
v_mfma_f32_16x16x32_bf16 a[112:115], v[232:235], v[160:163], a[112:115]
ds_read_b64_tr_b16 v[224:225], v249 offset:40960
v_accvgpr_read_b32 v212, a56
v_accvgpr_read_b32 v213, a57
v_mfma_f32_16x16x32_bf16 a[112:115], v[236:239], v[176:179], a[112:115]
v_accvgpr_read_b32 v214, a58
v_accvgpr_read_b32 v215, a59
v_cvt_pk_bf16_f32 v86, v212, v213
v_mfma_f32_16x16x32_bf16 a[116:119], v[232:235], v[164:167], a[116:119]
ds_read_b64_tr_b16 v[226:227], v249 offset:43008
v_cvt_pk_bf16_f32 v87, v214, v215
buffer_store_dwordx4 v[84:87], v252, s[20:23], s42 offen offset:1024 sc1
v_mfma_f32_16x16x32_bf16 a[116:119], v[236:239], v[180:183], a[116:119]
v_accvgpr_read_b32 v220, a60
v_accvgpr_read_b32 v221, a61
v_accvgpr_read_b32 v222, a62
v_mfma_f32_16x16x32_bf16 a[120:123], v[232:235], v[168:171], a[120:123]
ds_read_b64_tr_b16 v[228:229], v249 offset:57344
v_accvgpr_read_b32 v223, a63
v_cvt_pk_bf16_f32 v118, v220, v221
v_mfma_f32_16x16x32_bf16 a[120:123], v[236:239], v[184:187], a[120:123]
v_cvt_pk_bf16_f32 v119, v222, v223
buffer_store_dwordx4 v[116:119], v252, s[20:23], s43 offen offset:1024 sc1
v_accvgpr_read_b32 v192, a64
v_mfma_f32_16x16x32_bf16 a[124:127], v[232:235], v[172:175], a[124:127]
ds_read_b64_tr_b16 v[230:231], v249 offset:59392
v_accvgpr_read_b32 v193, a65
v_accvgpr_read_b32 v194, a66
v_mfma_f32_16x16x32_bf16 a[124:127], v[236:239], v[188:191], a[124:127]
s_waitcnt lgkmcnt(4)
v_accvgpr_read_b32 v195, a67
v_cvt_pk_bf16_f32 v24, v192, v193
v_mfma_f32_16x16x32_bf16 a[144:147], v[240:243], v[128:131], a[144:147]
ds_read_b64_tr_b16 v[232:233], v250 offset:40960
v_cvt_pk_bf16_f32 v25, v194, v195
v_accvgpr_read_b32 v200, a68
v_mfma_f32_16x16x32_bf16 a[144:147], v[244:247], v[144:147], a[144:147]
v_accvgpr_read_b32 v201, a69
v_accvgpr_read_b32 v202, a70
v_accvgpr_read_b32 v203, a71
v_mfma_f32_16x16x32_bf16 a[148:151], v[240:243], v[132:135], a[148:151]
ds_read_b64_tr_b16 v[234:235], v250 offset:43008
v_cvt_pk_bf16_f32 v56, v200, v201
v_cvt_pk_bf16_f32 v57, v202, v203
v_mfma_f32_16x16x32_bf16 a[148:151], v[244:247], v[148:151], a[148:151]
v_accvgpr_read_b32 v208, a72
v_accvgpr_read_b32 v209, a73
v_accvgpr_read_b32 v210, a74
v_mfma_f32_16x16x32_bf16 a[152:155], v[240:243], v[136:139], a[152:155]
ds_read_b64_tr_b16 v[236:237], v250 offset:57344
v_accvgpr_read_b32 v211, a75
v_cvt_pk_bf16_f32 v88, v208, v209
v_mfma_f32_16x16x32_bf16 a[152:155], v[244:247], v[152:155], a[152:155]
v_cvt_pk_bf16_f32 v89, v210, v211
v_accvgpr_read_b32 v216, a76
v_accvgpr_read_b32 v217, a77
v_mfma_f32_16x16x32_bf16 a[156:159], v[240:243], v[140:143], a[156:159]
ds_read_b64_tr_b16 v[238:239], v250 offset:59392
v_accvgpr_read_b32 v218, a78
v_accvgpr_read_b32 v219, a79
v_mfma_f32_16x16x32_bf16 a[156:159], v[244:247], v[156:159], a[156:159]
s_waitcnt lgkmcnt(4)
v_cvt_pk_bf16_f32 v120, v216, v217
v_cvt_pk_bf16_f32 v121, v218, v219
v_mfma_f32_16x16x32_bf16 a[128:131], v[224:227], v[160:163], a[128:131]
ds_read_b64_tr_b16 v[240:241], v249 offset:8704
v_accvgpr_read_b32 v196, a80
v_accvgpr_read_b32 v197, a81
v_mfma_f32_16x16x32_bf16 a[128:131], v[228:231], v[176:179], a[128:131]
v_accvgpr_read_b32 v198, a82
v_accvgpr_read_b32 v199, a83
v_cvt_pk_bf16_f32 v26, v196, v197
v_mfma_f32_16x16x32_bf16 a[132:135], v[224:227], v[164:167], a[132:135]
ds_read_b64_tr_b16 v[242:243], v249 offset:10752
v_cvt_pk_bf16_f32 v27, v198, v199
buffer_store_dwordx4 v[24:27], v252, s[20:23], s40 offen offset:2048 sc1
v_mfma_f32_16x16x32_bf16 a[132:135], v[228:231], v[180:183], a[132:135]
v_accvgpr_read_b32 v204, a84
v_accvgpr_read_b32 v205, a85
v_accvgpr_read_b32 v206, a86
v_mfma_f32_16x16x32_bf16 a[136:139], v[224:227], v[168:171], a[136:139]
ds_read_b64_tr_b16 v[244:245], v249 offset:25088
v_accvgpr_read_b32 v207, a87
v_cvt_pk_bf16_f32 v58, v204, v205
v_mfma_f32_16x16x32_bf16 a[136:139], v[228:231], v[184:187], a[136:139]
v_cvt_pk_bf16_f32 v59, v206, v207
buffer_store_dwordx4 v[56:59], v252, s[20:23], s41 offen offset:2048 sc1
v_accvgpr_read_b32 v212, a88
v_mfma_f32_16x16x32_bf16 a[140:143], v[224:227], v[172:175], a[140:143]
ds_read_b64_tr_b16 v[246:247], v249 offset:27136
v_accvgpr_read_b32 v213, a89
v_accvgpr_read_b32 v214, a90
v_mfma_f32_16x16x32_bf16 a[140:143], v[228:231], v[188:191], a[140:143]
s_waitcnt lgkmcnt(4)
v_accvgpr_read_b32 v215, a91
v_cvt_pk_bf16_f32 v90, v212, v213
v_mfma_f32_16x16x32_bf16 a[144:147], v[232:235], v[160:163], a[144:147]
ds_read_b64_tr_b16 v[224:225], v250 offset:8704
v_cvt_pk_bf16_f32 v91, v214, v215
buffer_store_dwordx4 v[88:91], v252, s[20:23], s42 offen offset:2048 sc1
v_mfma_f32_16x16x32_bf16 a[144:147], v[236:239], v[176:179], a[144:147]
v_accvgpr_read_b32 v220, a92
v_accvgpr_read_b32 v221, a93
v_accvgpr_read_b32 v222, a94
v_mfma_f32_16x16x32_bf16 a[148:151], v[232:235], v[164:167], a[148:151]
ds_read_b64_tr_b16 v[226:227], v250 offset:10752
v_accvgpr_read_b32 v223, a95
v_cvt_pk_bf16_f32 v122, v220, v221
v_mfma_f32_16x16x32_bf16 a[148:151], v[236:239], v[180:183], a[148:151]
v_cvt_pk_bf16_f32 v123, v222, v223
buffer_store_dwordx4 v[120:123], v252, s[20:23], s43 offen offset:2048 sc1
v_mfma_f32_16x16x32_bf16 a[152:155], v[232:235], v[168:171], a[152:155]
ds_read_b64_tr_b16 v[228:229], v250 offset:25088
v_accvgpr_read_b32 v192, a96
v_mfma_f32_16x16x32_bf16 a[152:155], v[236:239], v[184:187], a[152:155]
v_accvgpr_read_b32 v193, a97
v_accvgpr_read_b32 v194, a98
v_mfma_f32_16x16x32_bf16 a[156:159], v[232:235], v[172:175], a[156:159]
ds_read_b64_tr_b16 v[230:231], v250 offset:27136
v_accvgpr_read_b32 v195, a99
v_mfma_f32_16x16x32_bf16 a[156:159], v[236:239], v[188:191], a[156:159]
s_waitcnt lgkmcnt(4)
v_cvt_pk_bf16_f32 v28, v192, v193
v_mfma_f32_16x16x32_bf16 a[160:163], v[240:243], v[128:131], a[160:163]
ds_read_b64_tr_b16 v[232:233], v249 offset:41472
v_cvt_pk_bf16_f32 v29, v194, v195
v_mfma_f32_16x16x32_bf16 a[160:163], v[244:247], v[144:147], a[160:163]
v_accvgpr_read_b32 v200, a100
v_accvgpr_read_b32 v201, a101
v_mfma_f32_16x16x32_bf16 a[164:167], v[240:243], v[132:135], a[164:167]
ds_read_b64_tr_b16 v[234:235], v249 offset:43520
v_accvgpr_read_b32 v202, a102
v_mfma_f32_16x16x32_bf16 a[164:167], v[244:247], v[148:151], a[164:167]
v_accvgpr_read_b32 v203, a103
v_cvt_pk_bf16_f32 v60, v200, v201
v_mfma_f32_16x16x32_bf16 a[168:171], v[240:243], v[136:139], a[168:171]
ds_read_b64_tr_b16 v[236:237], v249 offset:57856
v_cvt_pk_bf16_f32 v61, v202, v203
v_mfma_f32_16x16x32_bf16 a[168:171], v[244:247], v[152:155], a[168:171]
v_accvgpr_read_b32 v208, a104
v_accvgpr_read_b32 v209, a105
v_mfma_f32_16x16x32_bf16 a[172:175], v[240:243], v[140:143], a[172:175]
ds_read_b64_tr_b16 v[238:239], v249 offset:59904
v_accvgpr_read_b32 v210, a106
v_mfma_f32_16x16x32_bf16 a[172:175], v[244:247], v[156:159], a[172:175]
s_waitcnt lgkmcnt(4)
v_accvgpr_read_b32 v211, a107
v_mfma_f32_16x16x32_bf16 a[176:179], v[224:227], v[128:131], a[176:179]
ds_read_b64_tr_b16 v[240:241], v250 offset:41472
v_cvt_pk_bf16_f32 v92, v208, v209
v_mfma_f32_16x16x32_bf16 a[176:179], v[228:231], v[144:147], a[176:179]
v_cvt_pk_bf16_f32 v93, v210, v211
v_accvgpr_read_b32 v216, a108
v_mfma_f32_16x16x32_bf16 a[180:183], v[224:227], v[132:135], a[180:183]
ds_read_b64_tr_b16 v[242:243], v250 offset:43520
v_accvgpr_read_b32 v217, a109
v_mfma_f32_16x16x32_bf16 a[180:183], v[228:231], v[148:151], a[180:183]
v_accvgpr_read_b32 v218, a110
v_accvgpr_read_b32 v219, a111
v_mfma_f32_16x16x32_bf16 a[184:187], v[224:227], v[136:139], a[184:187]
ds_read_b64_tr_b16 v[244:245], v250 offset:57856
v_cvt_pk_bf16_f32 v124, v216, v217
v_mfma_f32_16x16x32_bf16 a[184:187], v[228:231], v[152:155], a[184:187]
v_cvt_pk_bf16_f32 v125, v218, v219
v_accvgpr_read_b32 v196, a112
v_mfma_f32_16x16x32_bf16 a[188:191], v[224:227], v[140:143], a[188:191]
ds_read_b64_tr_b16 v[246:247], v250 offset:59904
v_accvgpr_read_b32 v197, a113
v_mfma_f32_16x16x32_bf16 a[188:191], v[228:231], v[156:159], a[188:191]
s_waitcnt lgkmcnt(4)
v_accvgpr_read_b32 v198, a114
v_mfma_f32_16x16x32_bf16 a[160:163], v[232:235], v[160:163], a[160:163]
ds_read_b64_tr_b16 v[224:225], v249 offset:12288
v_accvgpr_read_b32 v199, a115
v_mfma_f32_16x16x32_bf16 a[160:163], v[236:239], v[176:179], a[160:163]
v_cvt_pk_bf16_f32 v30, v196, v197
v_cvt_pk_bf16_f32 v31, v198, v199
v_mfma_f32_16x16x32_bf16 a[164:167], v[232:235], v[164:167], a[164:167]
ds_read_b64_tr_b16 v[226:227], v249 offset:14336
buffer_store_dwordx4 v[28:31], v252, s[20:23], s40 offen offset:3072 sc1
v_mfma_f32_16x16x32_bf16 a[164:167], v[236:239], v[180:183], a[164:167]
v_accvgpr_read_b32 v204, a116
v_accvgpr_read_b32 v205, a117
v_mfma_f32_16x16x32_bf16 a[168:171], v[232:235], v[168:171], a[168:171]
ds_read_b64_tr_b16 v[228:229], v249 offset:28672
v_accvgpr_read_b32 v206, a118
v_mfma_f32_16x16x32_bf16 a[168:171], v[236:239], v[184:187], a[168:171]
v_accvgpr_read_b32 v207, a119
v_cvt_pk_bf16_f32 v62, v204, v205
v_mfma_f32_16x16x32_bf16 a[172:175], v[232:235], v[172:175], a[172:175]
ds_read_b64_tr_b16 v[230:231], v249 offset:30720
v_cvt_pk_bf16_f32 v63, v206, v207
v_mfma_f32_16x16x32_bf16 a[172:175], v[236:239], v[188:191], a[172:175]
s_waitcnt lgkmcnt(4)
buffer_store_dwordx4 v[60:63], v252, s[20:23], s41 offen offset:3072 sc1
v_mfma_f32_16x16x32_bf16 a[176:179], v[240:243], v[160:163], a[176:179]
ds_read_b64_tr_b16 v[232:233], v250 offset:12288
v_accvgpr_read_b32 v212, a120
v_mfma_f32_16x16x32_bf16 a[176:179], v[244:247], v[176:179], a[176:179]
v_accvgpr_read_b32 v213, a121
v_accvgpr_read_b32 v214, a122
v_mfma_f32_16x16x32_bf16 a[180:183], v[240:243], v[164:167], a[180:183]
ds_read_b64_tr_b16 v[234:235], v250 offset:14336
v_accvgpr_read_b32 v215, a123
v_mfma_f32_16x16x32_bf16 a[180:183], v[244:247], v[180:183], a[180:183]
v_cvt_pk_bf16_f32 v94, v212, v213
v_cvt_pk_bf16_f32 v95, v214, v215
v_mfma_f32_16x16x32_bf16 a[184:187], v[240:243], v[168:171], a[184:187]
ds_read_b64_tr_b16 v[236:237], v250 offset:28672
buffer_store_dwordx4 v[92:95], v252, s[20:23], s42 offen offset:3072 sc1
v_mfma_f32_16x16x32_bf16 a[184:187], v[244:247], v[184:187], a[184:187]
v_accvgpr_read_b32 v220, a124
v_accvgpr_read_b32 v221, a125
v_mfma_f32_16x16x32_bf16 a[188:191], v[240:243], v[172:175], a[188:191]
ds_read_b64_tr_b16 v[238:239], v250 offset:30720
v_accvgpr_read_b32 v222, a126
v_mfma_f32_16x16x32_bf16 a[188:191], v[244:247], v[188:191], a[188:191]
s_waitcnt lgkmcnt(4)
v_accvgpr_read_b32 v223, a127
v_mfma_f32_16x16x32_bf16 a[192:195], v[224:227], v[128:131], a[192:195]
ds_read_b64_tr_b16 v[240:241], v249 offset:45056
v_cvt_pk_bf16_f32 v126, v220, v221
v_mfma_f32_16x16x32_bf16 a[192:195], v[228:231], v[144:147], a[192:195]
v_cvt_pk_bf16_f32 v127, v222, v223
buffer_store_dwordx4 v[124:127], v252, s[20:23], s43 offen offset:3072 sc1
v_mfma_f32_16x16x32_bf16 a[196:199], v[224:227], v[132:135], a[196:199]
ds_read_b64_tr_b16 v[242:243], v249 offset:47104
v_accvgpr_read_b32 v192, a128
v_mfma_f32_16x16x32_bf16 a[196:199], v[228:231], v[148:151], a[196:199]
v_accvgpr_read_b32 v193, a129
v_accvgpr_read_b32 v194, a130
v_mfma_f32_16x16x32_bf16 a[200:203], v[224:227], v[136:139], a[200:203]
ds_read_b64_tr_b16 v[244:245], v249 offset:61440
v_accvgpr_read_b32 v195, a131
v_mfma_f32_16x16x32_bf16 a[200:203], v[228:231], v[152:155], a[200:203]
v_cvt_pk_bf16_f32 v16, v192, v193
v_cvt_pk_bf16_f32 v17, v194, v195
v_mfma_f32_16x16x32_bf16 a[204:207], v[224:227], v[140:143], a[204:207]
ds_read_b64_tr_b16 v[246:247], v249 offset:63488
v_accvgpr_read_b32 v200, a132
v_mfma_f32_16x16x32_bf16 a[204:207], v[228:231], v[156:159], a[204:207]
s_waitcnt lgkmcnt(4)
v_accvgpr_read_b32 v201, a133
v_mfma_f32_16x16x32_bf16 a[208:211], v[232:235], v[128:131], a[208:211]
ds_read_b64_tr_b16 v[224:225], v250 offset:45056
v_accvgpr_read_b32 v202, a134
v_mfma_f32_16x16x32_bf16 a[208:211], v[236:239], v[144:147], a[208:211]
v_accvgpr_read_b32 v203, a135
v_cvt_pk_bf16_f32 v48, v200, v201
v_mfma_f32_16x16x32_bf16 a[212:215], v[232:235], v[132:135], a[212:215]
ds_read_b64_tr_b16 v[226:227], v250 offset:47104
v_cvt_pk_bf16_f32 v49, v202, v203
v_mfma_f32_16x16x32_bf16 a[212:215], v[236:239], v[148:151], a[212:215]
v_accvgpr_read_b32 v208, a136
v_accvgpr_read_b32 v209, a137
v_mfma_f32_16x16x32_bf16 a[216:219], v[232:235], v[136:139], a[216:219]
ds_read_b64_tr_b16 v[228:229], v250 offset:61440
v_accvgpr_read_b32 v210, a138
v_mfma_f32_16x16x32_bf16 a[216:219], v[236:239], v[152:155], a[216:219]
v_accvgpr_read_b32 v211, a139
v_cvt_pk_bf16_f32 v80, v208, v209
v_mfma_f32_16x16x32_bf16 a[220:223], v[232:235], v[140:143], a[220:223]
ds_read_b64_tr_b16 v[230:231], v250 offset:63488
v_cvt_pk_bf16_f32 v81, v210, v211
v_mfma_f32_16x16x32_bf16 a[220:223], v[236:239], v[156:159], a[220:223]
s_waitcnt lgkmcnt(4)
v_accvgpr_read_b32 v216, a140
v_mfma_f32_16x16x32_bf16 a[192:195], v[240:243], v[160:163], a[192:195]
ds_read_b64_tr_b16 v[232:233], v249 offset:12800
v_accvgpr_read_b32 v217, a141
v_mfma_f32_16x16x32_bf16 a[192:195], v[244:247], v[176:179], a[192:195]
v_accvgpr_read_b32 v218, a142
v_accvgpr_read_b32 v219, a143
v_mfma_f32_16x16x32_bf16 a[196:199], v[240:243], v[164:167], a[196:199]
ds_read_b64_tr_b16 v[234:235], v249 offset:14848
v_cvt_pk_bf16_f32 v112, v216, v217
v_mfma_f32_16x16x32_bf16 a[196:199], v[244:247], v[180:183], a[196:199]
v_cvt_pk_bf16_f32 v113, v218, v219
v_accvgpr_read_b32 v196, a144
v_mfma_f32_16x16x32_bf16 a[200:203], v[240:243], v[168:171], a[200:203]
ds_read_b64_tr_b16 v[236:237], v249 offset:29184
v_accvgpr_read_b32 v197, a145
v_mfma_f32_16x16x32_bf16 a[200:203], v[244:247], v[184:187], a[200:203]
v_accvgpr_read_b32 v198, a146
v_accvgpr_read_b32 v199, a147
v_mfma_f32_16x16x32_bf16 a[204:207], v[240:243], v[172:175], a[204:207]
ds_read_b64_tr_b16 v[238:239], v249 offset:31232
v_cvt_pk_bf16_f32 v18, v196, v197
v_mfma_f32_16x16x32_bf16 a[204:207], v[244:247], v[188:191], a[204:207]
s_waitcnt lgkmcnt(4)
v_cvt_pk_bf16_f32 v19, v198, v199
v_mfma_f32_16x16x32_bf16 a[208:211], v[224:227], v[160:163], a[208:211]
ds_read_b64_tr_b16 v[240:241], v250 offset:12800
buffer_store_dwordx4 v[16:19], v252, s[20:23], s44 offen offset:0 sc1
v_mfma_f32_16x16x32_bf16 a[208:211], v[228:231], v[176:179], a[208:211]
v_accvgpr_read_b32 v204, a148
v_accvgpr_read_b32 v205, a149
v_mfma_f32_16x16x32_bf16 a[212:215], v[224:227], v[164:167], a[212:215]
ds_read_b64_tr_b16 v[242:243], v250 offset:14848
v_accvgpr_read_b32 v206, a150
v_mfma_f32_16x16x32_bf16 a[212:215], v[228:231], v[180:183], a[212:215]
v_accvgpr_read_b32 v207, a151
v_cvt_pk_bf16_f32 v50, v204, v205
v_mfma_f32_16x16x32_bf16 a[216:219], v[224:227], v[168:171], a[216:219]
ds_read_b64_tr_b16 v[244:245], v250 offset:29184
v_cvt_pk_bf16_f32 v51, v206, v207
v_mfma_f32_16x16x32_bf16 a[216:219], v[228:231], v[184:187], a[216:219]
buffer_store_dwordx4 v[48:51], v252, s[20:23], s45 offen offset:0 sc1
v_accvgpr_read_b32 v212, a152
v_mfma_f32_16x16x32_bf16 a[220:223], v[224:227], v[172:175], a[220:223]
ds_read_b64_tr_b16 v[246:247], v250 offset:31232
v_accvgpr_read_b32 v213, a153
v_mfma_f32_16x16x32_bf16 a[220:223], v[228:231], v[188:191], a[220:223]
s_waitcnt lgkmcnt(4)
v_accvgpr_read_b32 v214, a154
v_mfma_f32_16x16x32_bf16 a[224:227], v[232:235], v[128:131], a[224:227]
ds_read_b64_tr_b16 v[224:225], v249 offset:45568
v_accvgpr_read_b32 v215, a155
v_mfma_f32_16x16x32_bf16 a[224:227], v[236:239], v[144:147], a[224:227]
v_cvt_pk_bf16_f32 v82, v212, v213
v_cvt_pk_bf16_f32 v83, v214, v215
v_mfma_f32_16x16x32_bf16 a[228:231], v[232:235], v[132:135], a[228:231]
ds_read_b64_tr_b16 v[226:227], v249 offset:47616
buffer_store_dwordx4 v[80:83], v252, s[20:23], s46 offen offset:0 sc1
v_mfma_f32_16x16x32_bf16 a[228:231], v[236:239], v[148:151], a[228:231]
v_accvgpr_read_b32 v220, a156
v_accvgpr_read_b32 v221, a157
v_mfma_f32_16x16x32_bf16 a[232:235], v[232:235], v[136:139], a[232:235]
ds_read_b64_tr_b16 v[228:229], v249 offset:61952
v_accvgpr_read_b32 v222, a158
v_mfma_f32_16x16x32_bf16 a[232:235], v[236:239], v[152:155], a[232:235]
v_accvgpr_read_b32 v223, a159
v_cvt_pk_bf16_f32 v114, v220, v221
v_mfma_f32_16x16x32_bf16 a[236:239], v[232:235], v[140:143], a[236:239]
ds_read_b64_tr_b16 v[230:231], v249 offset:64000
v_cvt_pk_bf16_f32 v115, v222, v223
v_mfma_f32_16x16x32_bf16 a[236:239], v[236:239], v[156:159], a[236:239]
s_waitcnt lgkmcnt(4)
buffer_store_dwordx4 v[112:115], v252, s[20:23], s47 offen offset:0 sc1
v_mfma_f32_16x16x32_bf16 a[240:243], v[240:243], v[128:131], a[240:243]
ds_read_b64_tr_b16 v[232:233], v250 offset:45568
v_accvgpr_read_b32 v192, a160
v_mfma_f32_16x16x32_bf16 a[240:243], v[244:247], v[144:147], a[240:243]
v_accvgpr_read_b32 v193, a161
v_accvgpr_read_b32 v194, a162
v_mfma_f32_16x16x32_bf16 a[244:247], v[240:243], v[132:135], a[244:247]
ds_read_b64_tr_b16 v[234:235], v250 offset:47616
v_accvgpr_read_b32 v195, a163
v_mfma_f32_16x16x32_bf16 a[244:247], v[244:247], v[148:151], a[244:247]
v_cvt_pk_bf16_f32 v20, v192, v193
v_cvt_pk_bf16_f32 v21, v194, v195
v_mfma_f32_16x16x32_bf16 a[248:251], v[240:243], v[136:139], a[248:251]
ds_read_b64_tr_b16 v[236:237], v250 offset:61952
v_accvgpr_read_b32 v200, a164
v_mfma_f32_16x16x32_bf16 a[248:251], v[244:247], v[152:155], a[248:251]
v_accvgpr_read_b32 v201, a165
v_accvgpr_read_b32 v202, a166
v_mfma_f32_16x16x32_bf16 a[252:255], v[240:243], v[140:143], a[252:255]
ds_read_b64_tr_b16 v[238:239], v250 offset:64000
v_accvgpr_read_b32 v203, a167
v_mfma_f32_16x16x32_bf16 a[252:255], v[244:247], v[156:159], a[252:255]
s_waitcnt lgkmcnt(4)
v_cvt_pk_bf16_f32 v52, v200, v201
v_mfma_f32_16x16x32_bf16 a[224:227], v[224:227], v[160:163], a[224:227]
v_cvt_pk_bf16_f32 v53, v202, v203
v_accvgpr_read_b32 v208, a168
v_mfma_f32_16x16x32_bf16 a[224:227], v[228:231], v[176:179], a[224:227]
v_accvgpr_read_b32 v209, a169
v_accvgpr_read_b32 v210, a170
v_mfma_f32_16x16x32_bf16 a[228:231], v[224:227], v[164:167], a[228:231]
v_accvgpr_read_b32 v211, a171
v_cvt_pk_bf16_f32 v84, v208, v209
v_mfma_f32_16x16x32_bf16 a[228:231], v[228:231], v[180:183], a[228:231]
v_cvt_pk_bf16_f32 v85, v210, v211
v_accvgpr_read_b32 v216, a172
v_mfma_f32_16x16x32_bf16 a[232:235], v[224:227], v[168:171], a[232:235]
v_accvgpr_read_b32 v217, a173
v_accvgpr_read_b32 v218, a174
v_mfma_f32_16x16x32_bf16 a[232:235], v[228:231], v[184:187], a[232:235]
v_accvgpr_read_b32 v219, a175
v_cvt_pk_bf16_f32 v116, v216, v217
v_mfma_f32_16x16x32_bf16 a[236:239], v[224:227], v[172:175], a[236:239]
v_cvt_pk_bf16_f32 v117, v218, v219
v_accvgpr_read_b32 v196, a176
v_mfma_f32_16x16x32_bf16 a[236:239], v[228:231], v[188:191], a[236:239]
s_waitcnt lgkmcnt(0)
v_accvgpr_read_b32 v197, a177
v_mfma_f32_16x16x32_bf16 a[240:243], v[232:235], v[160:163], a[240:243]
v_accvgpr_read_b32 v198, a178
v_accvgpr_read_b32 v199, a179
v_mfma_f32_16x16x32_bf16 a[240:243], v[236:239], v[176:179], a[240:243]
v_cvt_pk_bf16_f32 v22, v196, v197
v_cvt_pk_bf16_f32 v23, v198, v199
v_mfma_f32_16x16x32_bf16 a[244:247], v[232:235], v[164:167], a[244:247]
buffer_store_dwordx4 v[20:23], v252, s[20:23], s44 offen offset:1024 sc1
v_accvgpr_read_b32 v204, a180
v_mfma_f32_16x16x32_bf16 a[244:247], v[236:239], v[180:183], a[244:247]
v_accvgpr_read_b32 v205, a181
v_accvgpr_read_b32 v206, a182
v_mfma_f32_16x16x32_bf16 a[248:251], v[232:235], v[168:171], a[248:251]
v_accvgpr_read_b32 v207, a183
v_cvt_pk_bf16_f32 v54, v204, v205
v_mfma_f32_16x16x32_bf16 a[248:251], v[236:239], v[184:187], a[248:251]
v_cvt_pk_bf16_f32 v55, v206, v207
buffer_store_dwordx4 v[52:55], v252, s[20:23], s45 offen offset:1024 sc1
v_mfma_f32_16x16x32_bf16 a[252:255], v[232:235], v[172:175], a[252:255]
v_accvgpr_read_b32 v212, a184
v_accvgpr_read_b32 v213, a185
v_mfma_f32_16x16x32_bf16 a[252:255], v[236:239], v[188:191], a[252:255]
v_accvgpr_read_b32 v214, a186
v_accvgpr_read_b32 v215, a187
v_cvt_pk_bf16_f32 v86, v212, v213
v_cvt_pk_bf16_f32 v87, v214, v215
buffer_store_dwordx4 v[84:87], v252, s[20:23], s46 offen offset:1024 sc1
v_accvgpr_read_b32 v220, a188
v_accvgpr_read_b32 v221, a189
v_accvgpr_read_b32 v222, a190
v_accvgpr_read_b32 v223, a191
v_cvt_pk_bf16_f32 v118, v220, v221
v_cvt_pk_bf16_f32 v119, v222, v223
buffer_store_dwordx4 v[116:119], v252, s[20:23], s47 offen offset:1024 sc1
v_accvgpr_read_b32 v192, a192
v_accvgpr_read_b32 v193, a193
v_accvgpr_read_b32 v194, a194
v_accvgpr_read_b32 v195, a195
v_cvt_pk_bf16_f32 v24, v192, v193
v_cvt_pk_bf16_f32 v25, v194, v195
v_accvgpr_read_b32 v200, a196
v_accvgpr_read_b32 v201, a197
v_accvgpr_read_b32 v202, a198
v_accvgpr_read_b32 v203, a199
v_cvt_pk_bf16_f32 v56, v200, v201
v_cvt_pk_bf16_f32 v57, v202, v203
v_accvgpr_read_b32 v208, a200
v_accvgpr_read_b32 v209, a201
v_accvgpr_read_b32 v210, a202
v_accvgpr_read_b32 v211, a203
v_cvt_pk_bf16_f32 v88, v208, v209
v_cvt_pk_bf16_f32 v89, v210, v211
v_accvgpr_read_b32 v216, a204
v_accvgpr_read_b32 v217, a205
v_accvgpr_read_b32 v218, a206
v_accvgpr_read_b32 v219, a207
v_cvt_pk_bf16_f32 v120, v216, v217
v_cvt_pk_bf16_f32 v121, v218, v219
v_accvgpr_read_b32 v196, a208
v_accvgpr_read_b32 v197, a209
v_accvgpr_read_b32 v198, a210
v_accvgpr_read_b32 v199, a211
v_cvt_pk_bf16_f32 v26, v196, v197
v_cvt_pk_bf16_f32 v27, v198, v199
buffer_store_dwordx4 v[24:27], v252, s[20:23], s44 offen offset:2048 sc1
v_accvgpr_read_b32 v204, a212
v_accvgpr_read_b32 v205, a213
v_accvgpr_read_b32 v206, a214
v_accvgpr_read_b32 v207, a215
v_cvt_pk_bf16_f32 v58, v204, v205
v_cvt_pk_bf16_f32 v59, v206, v207
buffer_store_dwordx4 v[56:59], v252, s[20:23], s45 offen offset:2048 sc1
v_accvgpr_read_b32 v212, a216
v_accvgpr_read_b32 v213, a217
v_accvgpr_read_b32 v214, a218
v_accvgpr_read_b32 v215, a219
v_cvt_pk_bf16_f32 v90, v212, v213
v_cvt_pk_bf16_f32 v91, v214, v215
buffer_store_dwordx4 v[88:91], v252, s[20:23], s46 offen offset:2048 sc1
v_accvgpr_read_b32 v220, a220
v_accvgpr_read_b32 v221, a221
v_accvgpr_read_b32 v222, a222
v_accvgpr_read_b32 v223, a223
v_cvt_pk_bf16_f32 v122, v220, v221
v_cvt_pk_bf16_f32 v123, v222, v223
buffer_store_dwordx4 v[120:123], v252, s[20:23], s47 offen offset:2048 sc1
v_accvgpr_read_b32 v192, a224
v_accvgpr_read_b32 v193, a225
v_accvgpr_read_b32 v194, a226
v_accvgpr_read_b32 v195, a227
v_cvt_pk_bf16_f32 v28, v192, v193
v_cvt_pk_bf16_f32 v29, v194, v195
v_accvgpr_read_b32 v200, a228
v_accvgpr_read_b32 v201, a229
v_accvgpr_read_b32 v202, a230
v_accvgpr_read_b32 v203, a231
v_cvt_pk_bf16_f32 v60, v200, v201
v_cvt_pk_bf16_f32 v61, v202, v203
v_accvgpr_read_b32 v208, a232
v_accvgpr_read_b32 v209, a233
v_accvgpr_read_b32 v210, a234
v_accvgpr_read_b32 v211, a235
v_cvt_pk_bf16_f32 v92, v208, v209
v_cvt_pk_bf16_f32 v93, v210, v211
v_accvgpr_read_b32 v216, a236
v_accvgpr_read_b32 v217, a237
v_accvgpr_read_b32 v218, a238
v_accvgpr_read_b32 v219, a239
v_cvt_pk_bf16_f32 v124, v216, v217
v_cvt_pk_bf16_f32 v125, v218, v219
s_nop 7
v_accvgpr_read_b32 v196, a240
v_accvgpr_read_b32 v197, a241
v_accvgpr_read_b32 v198, a242
v_accvgpr_read_b32 v199, a243
v_cvt_pk_bf16_f32 v30, v196, v197
v_cvt_pk_bf16_f32 v31, v198, v199
buffer_store_dwordx4 v[28:31], v252, s[20:23], s44 offen offset:3072 sc1
v_accvgpr_read_b32 v204, a244
v_accvgpr_read_b32 v205, a245
v_accvgpr_read_b32 v206, a246
v_accvgpr_read_b32 v207, a247
v_cvt_pk_bf16_f32 v62, v204, v205
v_cvt_pk_bf16_f32 v63, v206, v207
buffer_store_dwordx4 v[60:63], v252, s[20:23], s45 offen offset:3072 sc1
v_accvgpr_read_b32 v212, a248
v_accvgpr_read_b32 v213, a249
v_accvgpr_read_b32 v214, a250
v_accvgpr_read_b32 v215, a251
v_cvt_pk_bf16_f32 v94, v212, v213
v_cvt_pk_bf16_f32 v95, v214, v215
buffer_store_dwordx4 v[92:95], v252, s[20:23], s46 offen offset:3072 sc1
v_accvgpr_read_b32 v220, a252
v_accvgpr_read_b32 v221, a253
v_accvgpr_read_b32 v222, a254
v_accvgpr_read_b32 v223, a255
v_cvt_pk_bf16_f32 v126, v220, v221
v_cvt_pk_bf16_f32 v127, v222, v223
buffer_store_dwordx4 v[124:127], v252, s[20:23], s47 offen offset:3072 sc1
s_branch L2_chk
L2_tail_0_5:
s_waitcnt lgkmcnt(4)
v_mfma_f32_16x16x32_bf16 a[0:3], v[224:227], v[128:131], a[0:3]
ds_read_b128 v[240:243], v248 offset:34816
v_mfma_f32_16x16x32_bf16 a[0:3], v[228:231], v[144:147], a[0:3]
v_mfma_f32_16x16x32_bf16 a[4:7], v[224:227], v[132:135], a[4:7]
v_mfma_f32_16x16x32_bf16 a[4:7], v[228:231], v[148:151], a[4:7]
v_exp_f32 v192, v192
v_mfma_f32_16x16x32_bf16 a[8:11], v[224:227], v[136:139], a[8:11]
ds_read_b128 v[244:247], v248 offset:35328
v_mfma_f32_16x16x32_bf16 a[8:11], v[228:231], v[152:155], a[8:11]
v_exp_f32 v193, v193
v_mfma_f32_16x16x32_bf16 a[12:15], v[224:227], v[140:143], a[12:15]
v_exp_f32 v194, v194
v_mfma_f32_16x16x32_bf16 a[12:15], v[228:231], v[156:159], a[12:15]
s_waitcnt lgkmcnt(2)
v_cvt_pk_bf16_f32 v160, v192, v193
v_mfma_f32_16x16x32_bf16 a[16:19], v[232:235], v[128:131], a[16:19]
ds_read_b128 v[224:227], v248 offset:38912
v_mfma_f32_16x16x32_bf16 a[16:19], v[236:239], v[144:147], a[16:19]
v_exp_f32 v195, v195
v_mfma_f32_16x16x32_bf16 a[20:23], v[232:235], v[132:135], a[20:23]
v_exp_f32 v196, v196
v_mfma_f32_16x16x32_bf16 a[20:23], v[236:239], v[148:151], a[20:23]
v_exp_f32 v197, v197
v_mfma_f32_16x16x32_bf16 a[24:27], v[232:235], v[136:139], a[24:27]
ds_read_b128 v[228:231], v248 offset:39424
v_cvt_pk_bf16_f32 v161, v194, v195
v_mfma_f32_16x16x32_bf16 a[24:27], v[236:239], v[152:155], a[24:27]
v_exp_f32 v198, v198
v_mfma_f32_16x16x32_bf16 a[28:31], v[232:235], v[140:143], a[28:31]
v_exp_f32 v199, v199
v_mfma_f32_16x16x32_bf16 a[28:31], v[236:239], v[156:159], a[28:31]
s_waitcnt lgkmcnt(2)
v_cvt_pk_bf16_f32 v164, v196, v197
v_mfma_f32_16x16x32_bf16 v[208:211], v[240:243], v[0:3], 0
ds_read_b128 v[232:235], v248 offset:43008
v_cvt_pk_bf16_f32 v165, v198, v199
v_mfma_f32_16x16x32_bf16 v[208:211], v[244:247], v[4:7], v[208:211]
v_exp_f32 v200, v200
v_mfma_f32_16x16x32_bf16 v[212:215], v[240:243], v[32:35], 0
v_exp_f32 v201, v201
v_mfma_f32_16x16x32_bf16 v[212:215], v[244:247], v[36:39], v[212:215]
v_exp_f32 v202, v202
v_mfma_f32_16x16x32_bf16 v[216:219], v[240:243], v[64:67], 0
ds_read_b128 v[236:239], v248 offset:43520
v_cvt_pk_bf16_f32 v168, v200, v201
v_mfma_f32_16x16x32_bf16 v[216:219], v[244:247], v[68:71], v[216:219]
v_exp_f32 v203, v203
v_mfma_f32_16x16x32_bf16 v[220:223], v[240:243], v[96:99], 0
v_exp_f32 v204, v204
v_mfma_f32_16x16x32_bf16 v[220:223], v[244:247], v[100:103], v[220:223]
s_waitcnt lgkmcnt(2)
v_cvt_pk_bf16_f32 v169, v202, v203
v_mfma_f32_16x16x32_bf16 v[208:211], v[224:227], v[8:11], v[208:211]
ds_read_b128 v[240:243], v248 offset:47104
v_mfma_f32_16x16x32_bf16 v[208:211], v[228:231], v[12:15], v[208:211]
v_exp_f32 v205, v205
v_mfma_f32_16x16x32_bf16 v[212:215], v[224:227], v[40:43], v[212:215]
v_exp_f32 v206, v206
v_mfma_f32_16x16x32_bf16 v[212:215], v[228:231], v[44:47], v[212:215]
v_exp_f32 v207, v207
v_mfma_f32_16x16x32_bf16 v[216:219], v[224:227], v[72:75], v[216:219]
ds_read_b128 v[244:247], v248 offset:47616
v_cvt_pk_bf16_f32 v172, v204, v205
v_mfma_f32_16x16x32_bf16 v[216:219], v[228:231], v[76:79], v[216:219]
v_cvt_pk_bf16_f32 v173, v206, v207
v_mfma_f32_16x16x32_bf16 v[220:223], v[224:227], v[104:107], v[220:223]
v_mfma_f32_16x16x32_bf16 v[220:223], v[228:231], v[108:111], v[220:223]
s_waitcnt lgkmcnt(2)
s_waitcnt vmcnt(0)
s_barrier
v_mfma_f32_16x16x32_bf16 v[208:211], v[232:235], v[16:19], v[208:211]
ds_read_b128 v[224:227], v248 offset:49152
v_mfma_f32_16x16x32_bf16 v[208:211], v[236:239], v[20:23], v[208:211]
v_mfma_f32_16x16x32_bf16 v[212:215], v[232:235], v[48:51], v[212:215]
v_mfma_f32_16x16x32_bf16 v[212:215], v[236:239], v[52:55], v[212:215]
v_mfma_f32_16x16x32_bf16 v[216:219], v[232:235], v[80:83], v[216:219]
ds_read_b128 v[228:231], v248 offset:49664
v_mfma_f32_16x16x32_bf16 v[216:219], v[236:239], v[84:87], v[216:219]
v_mfma_f32_16x16x32_bf16 v[220:223], v[232:235], v[112:115], v[220:223]
v_mfma_f32_16x16x32_bf16 v[220:223], v[236:239], v[116:119], v[220:223]
s_waitcnt lgkmcnt(2)
v_mfma_f32_16x16x32_bf16 v[208:211], v[240:243], v[24:27], v[208:211]
ds_read_b128 v[232:235], v248 offset:53248
v_mfma_f32_16x16x32_bf16 v[208:211], v[244:247], v[28:31], v[208:211]
v_mfma_f32_16x16x32_bf16 v[212:215], v[240:243], v[56:59], v[212:215]
v_mfma_f32_16x16x32_bf16 v[212:215], v[244:247], v[60:63], v[212:215]
v_mfma_f32_16x16x32_bf16 v[216:219], v[240:243], v[88:91], v[216:219]
ds_read_b128 v[236:239], v248 offset:53760
v_mfma_f32_16x16x32_bf16 v[216:219], v[244:247], v[92:95], v[216:219]
v_mfma_f32_16x16x32_bf16 v[220:223], v[240:243], v[120:123], v[220:223]
v_mfma_f32_16x16x32_bf16 v[220:223], v[244:247], v[124:127], v[220:223]
s_waitcnt lgkmcnt(2)
v_mfma_f32_16x16x32_bf16 v[192:195], v[224:227], v[0:3], 0
ds_read_b128 v[240:243], v248 offset:57344
v_mfma_f32_16x16x32_bf16 v[192:195], v[228:231], v[4:7], v[192:195]
v_exp_f32 v208, v208
v_mfma_f32_16x16x32_bf16 v[196:199], v[224:227], v[32:35], 0
v_exp_f32 v209, v209
v_mfma_f32_16x16x32_bf16 v[196:199], v[228:231], v[36:39], v[196:199]
v_exp_f32 v210, v210
v_mfma_f32_16x16x32_bf16 v[200:203], v[224:227], v[64:67], 0
ds_read_b128 v[244:247], v248 offset:57856
v_cvt_pk_bf16_f32 v162, v208, v209
v_mfma_f32_16x16x32_bf16 v[200:203], v[228:231], v[68:71], v[200:203]
v_exp_f32 v211, v211
v_mfma_f32_16x16x32_bf16 v[204:207], v[224:227], v[96:99], 0
v_exp_f32 v212, v212
v_mfma_f32_16x16x32_bf16 v[204:207], v[228:231], v[100:103], v[204:207]
s_waitcnt lgkmcnt(2)
v_cvt_pk_bf16_f32 v163, v210, v211
v_mfma_f32_16x16x32_bf16 v[192:195], v[232:235], v[8:11], v[192:195]
ds_read_b128 v[224:227], v248 offset:61440
v_mfma_f32_16x16x32_bf16 v[192:195], v[236:239], v[12:15], v[192:195]
v_exp_f32 v213, v213
v_mfma_f32_16x16x32_bf16 v[196:199], v[232:235], v[40:43], v[196:199]
v_exp_f32 v214, v214
v_mfma_f32_16x16x32_bf16 v[196:199], v[236:239], v[44:47], v[196:199]
v_exp_f32 v215, v215
v_mfma_f32_16x16x32_bf16 v[200:203], v[232:235], v[72:75], v[200:203]
ds_read_b128 v[228:231], v248 offset:61952
v_cvt_pk_bf16_f32 v166, v212, v213
v_mfma_f32_16x16x32_bf16 v[200:203], v[236:239], v[76:79], v[200:203]
v_cvt_pk_bf16_f32 v167, v214, v215
v_mfma_f32_16x16x32_bf16 v[204:207], v[232:235], v[104:107], v[204:207]
v_exp_f32 v216, v216
v_mfma_f32_16x16x32_bf16 v[204:207], v[236:239], v[108:111], v[204:207]
s_waitcnt lgkmcnt(2)
v_mfma_f32_16x16x32_bf16 v[192:195], v[240:243], v[16:19], v[192:195]
ds_read_b128 v[232:235], v248 offset:51200
v_mfma_f32_16x16x32_bf16 v[192:195], v[244:247], v[20:23], v[192:195]
v_exp_f32 v217, v217
v_mfma_f32_16x16x32_bf16 v[196:199], v[240:243], v[48:51], v[196:199]
v_exp_f32 v218, v218
v_mfma_f32_16x16x32_bf16 v[196:199], v[244:247], v[52:55], v[196:199]
v_exp_f32 v219, v219
v_mfma_f32_16x16x32_bf16 v[200:203], v[240:243], v[80:83], v[200:203]
ds_read_b128 v[236:239], v248 offset:51712
v_cvt_pk_bf16_f32 v170, v216, v217
v_mfma_f32_16x16x32_bf16 v[200:203], v[244:247], v[84:87], v[200:203]
v_cvt_pk_bf16_f32 v171, v218, v219
v_mfma_f32_16x16x32_bf16 v[204:207], v[240:243], v[112:115], v[204:207]
v_exp_f32 v220, v220
v_mfma_f32_16x16x32_bf16 v[204:207], v[244:247], v[116:119], v[204:207]
s_waitcnt lgkmcnt(2)
v_mfma_f32_16x16x32_bf16 v[192:195], v[224:227], v[24:27], v[192:195]
ds_read_b128 v[240:243], v248 offset:55296
v_mfma_f32_16x16x32_bf16 v[192:195], v[228:231], v[28:31], v[192:195]
v_exp_f32 v221, v221
v_mfma_f32_16x16x32_bf16 v[196:199], v[224:227], v[56:59], v[196:199]
v_exp_f32 v222, v222
v_mfma_f32_16x16x32_bf16 v[196:199], v[228:231], v[60:63], v[196:199]
v_exp_f32 v223, v223
v_mfma_f32_16x16x32_bf16 v[200:203], v[224:227], v[88:91], v[200:203]
ds_read_b128 v[244:247], v248 offset:55808
v_cvt_pk_bf16_f32 v174, v220, v221
v_mfma_f32_16x16x32_bf16 v[200:203], v[228:231], v[92:95], v[200:203]
v_cvt_pk_bf16_f32 v175, v222, v223
v_mfma_f32_16x16x32_bf16 v[204:207], v[224:227], v[120:123], v[204:207]
v_mfma_f32_16x16x32_bf16 v[204:207], v[228:231], v[124:127], v[204:207]
s_waitcnt lgkmcnt(2)
v_mfma_f32_16x16x32_bf16 v[208:211], v[232:235], v[0:3], 0
ds_read_b128 v[224:227], v248 offset:59392
v_mfma_f32_16x16x32_bf16 v[208:211], v[236:239], v[4:7], v[208:211]
v_exp_f32 v192, v192
v_mfma_f32_16x16x32_bf16 v[212:215], v[232:235], v[32:35], 0
v_exp_f32 v193, v193
v_mfma_f32_16x16x32_bf16 v[212:215], v[236:239], v[36:39], v[212:215]
v_exp_f32 v194, v194
v_mfma_f32_16x16x32_bf16 v[216:219], v[232:235], v[64:67], 0
ds_read_b128 v[228:231], v248 offset:59904
v_cvt_pk_bf16_f32 v176, v192, v193
v_mfma_f32_16x16x32_bf16 v[216:219], v[236:239], v[68:71], v[216:219]
v_exp_f32 v195, v195
v_mfma_f32_16x16x32_bf16 v[220:223], v[232:235], v[96:99], 0
v_exp_f32 v196, v196
v_mfma_f32_16x16x32_bf16 v[220:223], v[236:239], v[100:103], v[220:223]
s_waitcnt lgkmcnt(2)
v_cvt_pk_bf16_f32 v177, v194, v195
v_mfma_f32_16x16x32_bf16 v[208:211], v[240:243], v[8:11], v[208:211]
ds_read_b128 v[232:235], v248 offset:63488
v_mfma_f32_16x16x32_bf16 v[208:211], v[244:247], v[12:15], v[208:211]
v_exp_f32 v197, v197
v_mfma_f32_16x16x32_bf16 v[212:215], v[240:243], v[40:43], v[212:215]
v_exp_f32 v198, v198
v_mfma_f32_16x16x32_bf16 v[212:215], v[244:247], v[44:47], v[212:215]
v_exp_f32 v199, v199
v_mfma_f32_16x16x32_bf16 v[216:219], v[240:243], v[72:75], v[216:219]
ds_read_b128 v[236:239], v248 offset:64000
v_cvt_pk_bf16_f32 v180, v196, v197
v_mfma_f32_16x16x32_bf16 v[216:219], v[244:247], v[76:79], v[216:219]
v_cvt_pk_bf16_f32 v181, v198, v199
v_mfma_f32_16x16x32_bf16 v[220:223], v[240:243], v[104:107], v[220:223]
v_exp_f32 v200, v200
v_mfma_f32_16x16x32_bf16 v[220:223], v[244:247], v[108:111], v[220:223]
s_waitcnt lgkmcnt(2)
v_xor_b32 v248, 0x10000, v248
v_mfma_f32_16x16x32_bf16 v[208:211], v[224:227], v[16:19], v[208:211]
ds_read_b128 v[240:243], v248 offset:0
v_mfma_f32_16x16x32_bf16 v[208:211], v[228:231], v[20:23], v[208:211]
v_exp_f32 v201, v201
v_mfma_f32_16x16x32_bf16 v[212:215], v[224:227], v[48:51], v[212:215]
v_exp_f32 v202, v202
v_mfma_f32_16x16x32_bf16 v[212:215], v[228:231], v[52:55], v[212:215]
v_exp_f32 v203, v203
v_mfma_f32_16x16x32_bf16 v[216:219], v[224:227], v[80:83], v[216:219]
ds_read_b128 v[244:247], v248 offset:512
v_cvt_pk_bf16_f32 v184, v200, v201
v_mfma_f32_16x16x32_bf16 v[216:219], v[228:231], v[84:87], v[216:219]
v_cvt_pk_bf16_f32 v185, v202, v203
v_mfma_f32_16x16x32_bf16 v[220:223], v[224:227], v[112:115], v[220:223]
v_exp_f32 v204, v204
v_mfma_f32_16x16x32_bf16 v[220:223], v[228:231], v[116:119], v[220:223]
s_waitcnt lgkmcnt(2)
v_mfma_f32_16x16x32_bf16 v[208:211], v[232:235], v[24:27], v[208:211]
ds_read_b128 v[224:227], v248 offset:4096
v_mfma_f32_16x16x32_bf16 v[208:211], v[236:239], v[28:31], v[208:211]
v_exp_f32 v205, v205
v_mfma_f32_16x16x32_bf16 v[212:215], v[232:235], v[56:59], v[212:215]
v_exp_f32 v206, v206
v_mfma_f32_16x16x32_bf16 v[212:215], v[236:239], v[60:63], v[212:215]
v_exp_f32 v207, v207
v_mfma_f32_16x16x32_bf16 v[216:219], v[232:235], v[88:91], v[216:219]
ds_read_b128 v[228:231], v248 offset:4608
v_cvt_pk_bf16_f32 v188, v204, v205
v_mfma_f32_16x16x32_bf16 v[216:219], v[236:239], v[92:95], v[216:219]
v_cvt_pk_bf16_f32 v189, v206, v207
v_mfma_f32_16x16x32_bf16 v[220:223], v[232:235], v[120:123], v[220:223]
v_mfma_f32_16x16x32_bf16 v[220:223], v[236:239], v[124:127], v[220:223]
s_waitcnt lgkmcnt(2)
v_mfma_f32_16x16x32_bf16 v[192:195], v[240:243], v[0:3], 0
ds_read_b128 v[232:235], v248 offset:8192
v_mfma_f32_16x16x32_bf16 v[192:195], v[244:247], v[4:7], v[192:195]
v_exp_f32 v208, v208
v_mfma_f32_16x16x32_bf16 v[196:199], v[240:243], v[32:35], 0
v_exp_f32 v209, v209
v_mfma_f32_16x16x32_bf16 v[196:199], v[244:247], v[36:39], v[196:199]
v_exp_f32 v210, v210
v_mfma_f32_16x16x32_bf16 v[200:203], v[240:243], v[64:67], 0
ds_read_b128 v[236:239], v248 offset:8704
v_cvt_pk_bf16_f32 v178, v208, v209
v_mfma_f32_16x16x32_bf16 v[200:203], v[244:247], v[68:71], v[200:203]
v_exp_f32 v211, v211
v_mfma_f32_16x16x32_bf16 v[204:207], v[240:243], v[96:99], 0
v_exp_f32 v212, v212
v_mfma_f32_16x16x32_bf16 v[204:207], v[244:247], v[100:103], v[204:207]
s_waitcnt lgkmcnt(2)
v_cvt_pk_bf16_f32 v179, v210, v211
v_mfma_f32_16x16x32_bf16 v[192:195], v[224:227], v[8:11], v[192:195]
ds_read_b128 v[240:243], v248 offset:12288
v_mfma_f32_16x16x32_bf16 v[192:195], v[228:231], v[12:15], v[192:195]
v_exp_f32 v213, v213
v_mfma_f32_16x16x32_bf16 v[196:199], v[224:227], v[40:43], v[196:199]
v_exp_f32 v214, v214
v_mfma_f32_16x16x32_bf16 v[196:199], v[228:231], v[44:47], v[196:199]
v_exp_f32 v215, v215
v_mfma_f32_16x16x32_bf16 v[200:203], v[224:227], v[72:75], v[200:203]
ds_read_b128 v[244:247], v248 offset:12800
v_cvt_pk_bf16_f32 v182, v212, v213
v_mfma_f32_16x16x32_bf16 v[200:203], v[228:231], v[76:79], v[200:203]
v_cvt_pk_bf16_f32 v183, v214, v215
v_mfma_f32_16x16x32_bf16 v[204:207], v[224:227], v[104:107], v[204:207]
v_exp_f32 v216, v216
v_mfma_f32_16x16x32_bf16 v[204:207], v[228:231], v[108:111], v[204:207]
s_waitcnt lgkmcnt(2)
v_mfma_f32_16x16x32_bf16 v[192:195], v[232:235], v[16:19], v[192:195]
ds_read_b128 v[224:227], v248 offset:2048
v_mfma_f32_16x16x32_bf16 v[192:195], v[236:239], v[20:23], v[192:195]
v_exp_f32 v217, v217
v_mfma_f32_16x16x32_bf16 v[196:199], v[232:235], v[48:51], v[196:199]
v_exp_f32 v218, v218
v_mfma_f32_16x16x32_bf16 v[196:199], v[236:239], v[52:55], v[196:199]
v_exp_f32 v219, v219
v_mfma_f32_16x16x32_bf16 v[200:203], v[232:235], v[80:83], v[200:203]
ds_read_b128 v[228:231], v248 offset:2560
v_cvt_pk_bf16_f32 v186, v216, v217
v_mfma_f32_16x16x32_bf16 v[200:203], v[236:239], v[84:87], v[200:203]
v_cvt_pk_bf16_f32 v187, v218, v219
v_mfma_f32_16x16x32_bf16 v[204:207], v[232:235], v[112:115], v[204:207]
v_exp_f32 v220, v220
v_mfma_f32_16x16x32_bf16 v[204:207], v[236:239], v[116:119], v[204:207]
s_waitcnt lgkmcnt(2)
v_mfma_f32_16x16x32_bf16 v[192:195], v[240:243], v[24:27], v[192:195]
ds_read_b128 v[232:235], v248 offset:6144
v_mfma_f32_16x16x32_bf16 v[192:195], v[244:247], v[28:31], v[192:195]
v_exp_f32 v221, v221
v_mfma_f32_16x16x32_bf16 v[196:199], v[240:243], v[56:59], v[196:199]
v_exp_f32 v222, v222
v_mfma_f32_16x16x32_bf16 v[196:199], v[244:247], v[60:63], v[196:199]
v_exp_f32 v223, v223
v_mfma_f32_16x16x32_bf16 v[200:203], v[240:243], v[88:91], v[200:203]
ds_read_b128 v[236:239], v248 offset:6656
v_cvt_pk_bf16_f32 v190, v220, v221
v_mfma_f32_16x16x32_bf16 v[200:203], v[244:247], v[92:95], v[200:203]
v_cvt_pk_bf16_f32 v191, v222, v223
v_mfma_f32_16x16x32_bf16 v[204:207], v[240:243], v[120:123], v[204:207]
v_mfma_f32_16x16x32_bf16 v[204:207], v[244:247], v[124:127], v[204:207]
s_waitcnt lgkmcnt(2)
v_mfma_f32_16x16x32_bf16 v[208:211], v[224:227], v[0:3], 0
ds_read_b128 v[240:243], v248 offset:10240
v_mfma_f32_16x16x32_bf16 v[208:211], v[228:231], v[4:7], v[208:211]
v_exp_f32 v192, v192
v_mfma_f32_16x16x32_bf16 v[212:215], v[224:227], v[32:35], 0
v_exp_f32 v193, v193
v_mfma_f32_16x16x32_bf16 v[212:215], v[228:231], v[36:39], v[212:215]
v_exp_f32 v194, v194
v_mfma_f32_16x16x32_bf16 v[216:219], v[224:227], v[64:67], 0
ds_read_b128 v[244:247], v248 offset:10752
v_cvt_pk_bf16_f32 v0, v192, v193
v_mfma_f32_16x16x32_bf16 v[216:219], v[228:231], v[68:71], v[216:219]
v_exp_f32 v195, v195
v_mfma_f32_16x16x32_bf16 v[220:223], v[224:227], v[96:99], 0
v_exp_f32 v196, v196
v_mfma_f32_16x16x32_bf16 v[220:223], v[228:231], v[100:103], v[220:223]
s_waitcnt lgkmcnt(2)
v_cvt_pk_bf16_f32 v1, v194, v195
v_mfma_f32_16x16x32_bf16 v[208:211], v[232:235], v[8:11], v[208:211]
ds_read_b128 v[224:227], v248 offset:14336
v_mfma_f32_16x16x32_bf16 v[208:211], v[236:239], v[12:15], v[208:211]
v_exp_f32 v197, v197
v_mfma_f32_16x16x32_bf16 v[212:215], v[232:235], v[40:43], v[212:215]
v_exp_f32 v198, v198
v_mfma_f32_16x16x32_bf16 v[212:215], v[236:239], v[44:47], v[212:215]
v_exp_f32 v199, v199
v_mfma_f32_16x16x32_bf16 v[216:219], v[232:235], v[72:75], v[216:219]
ds_read_b128 v[228:231], v248 offset:14848
v_xor_b32 v12, 0x10000, v249
v_mfma_f32_16x16x32_bf16 v[216:219], v[236:239], v[76:79], v[216:219]
v_xor_b32 v13, 0x10000, v250
v_cvt_pk_bf16_f32 v32, v196, v197
v_mfma_f32_16x16x32_bf16 v[220:223], v[232:235], v[104:107], v[220:223]
v_cvt_pk_bf16_f32 v33, v198, v199
v_mfma_f32_16x16x32_bf16 v[220:223], v[236:239], v[108:111], v[220:223]
s_waitcnt lgkmcnt(2)
v_mfma_f32_16x16x32_bf16 v[208:211], v[240:243], v[16:19], v[208:211]
ds_read_b64_tr_b16 v[232:233], v249 offset:32768
v_mfma_f32_16x16x32_bf16 v[208:211], v[244:247], v[20:23], v[208:211]
v_exp_f32 v200, v200
v_mfma_f32_16x16x32_bf16 v[212:215], v[240:243], v[48:51], v[212:215]
ds_read_b64_tr_b16 v[234:235], v249 offset:34816
v_mfma_f32_16x16x32_bf16 v[212:215], v[244:247], v[52:55], v[212:215]
v_exp_f32 v201, v201
v_mfma_f32_16x16x32_bf16 v[216:219], v[240:243], v[80:83], v[216:219]
ds_read_b64_tr_b16 v[236:237], v249 offset:49152
v_cvt_pk_bf16_f32 v64, v200, v201
v_mfma_f32_16x16x32_bf16 v[216:219], v[244:247], v[84:87], v[216:219]
v_exp_f32 v202, v202
v_mfma_f32_16x16x32_bf16 v[220:223], v[240:243], v[112:115], v[220:223]
ds_read_b64_tr_b16 v[238:239], v249 offset:51200
v_mfma_f32_16x16x32_bf16 v[220:223], v[244:247], v[116:119], v[220:223]
s_waitcnt lgkmcnt(4)
v_mfma_f32_16x16x32_bf16 v[208:211], v[224:227], v[24:27], v[208:211]
ds_read_b64_tr_b16 v[240:241], v250 offset:32768
v_mfma_f32_16x16x32_bf16 v[208:211], v[228:231], v[28:31], v[208:211]
v_exp_f32 v203, v203
v_mfma_f32_16x16x32_bf16 v[212:215], v[224:227], v[56:59], v[212:215]
ds_read_b64_tr_b16 v[242:243], v250 offset:34816
v_cvt_pk_bf16_f32 v65, v202, v203
v_mfma_f32_16x16x32_bf16 v[212:215], v[228:231], v[60:63], v[212:215]
v_exp_f32 v204, v204
v_mfma_f32_16x16x32_bf16 v[216:219], v[224:227], v[88:91], v[216:219]
ds_read_b64_tr_b16 v[244:245], v250 offset:49152
v_mfma_f32_16x16x32_bf16 v[216:219], v[228:231], v[92:95], v[216:219]
v_exp_f32 v205, v205
v_mfma_f32_16x16x32_bf16 v[220:223], v[224:227], v[120:123], v[220:223]
ds_read_b64_tr_b16 v[246:247], v250 offset:51200
v_cvt_pk_bf16_f32 v96, v204, v205
v_mfma_f32_16x16x32_bf16 v[220:223], v[228:231], v[124:127], v[220:223]
s_waitcnt lgkmcnt(4)
v_mfma_f32_16x16x32_bf16 a[0:3], v[232:235], v[160:163], a[0:3]
ds_read_b64_tr_b16 v[224:225], v249 offset:512
v_mfma_f32_16x16x32_bf16 a[0:3], v[236:239], v[176:179], a[0:3]
v_exp_f32 v206, v206
v_mfma_f32_16x16x32_bf16 a[4:7], v[232:235], v[164:167], a[4:7]
ds_read_b64_tr_b16 v[226:227], v249 offset:2560
v_mfma_f32_16x16x32_bf16 a[4:7], v[236:239], v[180:183], a[4:7]
v_exp_f32 v207, v207
v_mfma_f32_16x16x32_bf16 a[8:11], v[232:235], v[168:171], a[8:11]
ds_read_b64_tr_b16 v[228:229], v249 offset:16896
v_cvt_pk_bf16_f32 v97, v206, v207
v_mfma_f32_16x16x32_bf16 a[8:11], v[236:239], v[184:187], a[8:11]
v_exp_f32 v208, v208
v_mfma_f32_16x16x32_bf16 a[12:15], v[232:235], v[172:175], a[12:15]
ds_read_b64_tr_b16 v[230:231], v249 offset:18944
v_mfma_f32_16x16x32_bf16 a[12:15], v[236:239], v[188:191], a[12:15]
s_waitcnt lgkmcnt(4)
v_mfma_f32_16x16x32_bf16 a[16:19], v[240:243], v[160:163], a[16:19]
ds_read_b64_tr_b16 v[232:233], v249 offset:33280
v_mfma_f32_16x16x32_bf16 a[16:19], v[244:247], v[176:179], a[16:19]
v_exp_f32 v209, v209
v_mfma_f32_16x16x32_bf16 a[20:23], v[240:243], v[164:167], a[20:23]
ds_read_b64_tr_b16 v[234:235], v249 offset:35328
v_cvt_pk_bf16_f32 v2, v208, v209
v_mfma_f32_16x16x32_bf16 a[20:23], v[244:247], v[180:183], a[20:23]
v_exp_f32 v210, v210
v_mfma_f32_16x16x32_bf16 a[24:27], v[240:243], v[168:171], a[24:27]
ds_read_b64_tr_b16 v[236:237], v249 offset:49664
v_mfma_f32_16x16x32_bf16 a[24:27], v[244:247], v[184:187], a[24:27]
v_exp_f32 v211, v211
v_mfma_f32_16x16x32_bf16 a[28:31], v[240:243], v[172:175], a[28:31]
ds_read_b64_tr_b16 v[238:239], v249 offset:51712
v_cvt_pk_bf16_f32 v3, v210, v211
v_mfma_f32_16x16x32_bf16 a[28:31], v[244:247], v[188:191], a[28:31]
s_waitcnt lgkmcnt(4)
v_mfma_f32_16x16x32_bf16 a[32:35], v[224:227], v[128:131], a[32:35]
ds_read_b64_tr_b16 v[240:241], v250 offset:512
v_mfma_f32_16x16x32_bf16 a[32:35], v[228:231], v[144:147], a[32:35]
v_exp_f32 v212, v212
v_mfma_f32_16x16x32_bf16 a[36:39], v[224:227], v[132:135], a[36:39]
ds_read_b64_tr_b16 v[242:243], v250 offset:2560
v_mfma_f32_16x16x32_bf16 a[36:39], v[228:231], v[148:151], a[36:39]
v_exp_f32 v213, v213
v_mfma_f32_16x16x32_bf16 a[40:43], v[224:227], v[136:139], a[40:43]
ds_read_b64_tr_b16 v[244:245], v250 offset:16896
v_cvt_pk_bf16_f32 v34, v212, v213
v_mfma_f32_16x16x32_bf16 a[40:43], v[228:231], v[152:155], a[40:43]
v_exp_f32 v214, v214
v_mfma_f32_16x16x32_bf16 a[44:47], v[224:227], v[140:143], a[44:47]
ds_read_b64_tr_b16 v[246:247], v250 offset:18944
v_mfma_f32_16x16x32_bf16 a[44:47], v[228:231], v[156:159], a[44:47]
s_waitcnt lgkmcnt(4)
v_mfma_f32_16x16x32_bf16 a[32:35], v[232:235], v[160:163], a[32:35]
ds_read_b64_tr_b16 v[224:225], v250 offset:33280
v_mfma_f32_16x16x32_bf16 a[32:35], v[236:239], v[176:179], a[32:35]
v_exp_f32 v215, v215
v_mfma_f32_16x16x32_bf16 a[36:39], v[232:235], v[164:167], a[36:39]
ds_read_b64_tr_b16 v[226:227], v250 offset:35328
v_cvt_pk_bf16_f32 v35, v214, v215
v_mfma_f32_16x16x32_bf16 a[36:39], v[236:239], v[180:183], a[36:39]
v_exp_f32 v216, v216
v_mfma_f32_16x16x32_bf16 a[40:43], v[232:235], v[168:171], a[40:43]
ds_read_b64_tr_b16 v[228:229], v250 offset:49664
v_mfma_f32_16x16x32_bf16 a[40:43], v[236:239], v[184:187], a[40:43]
v_exp_f32 v217, v217
v_mfma_f32_16x16x32_bf16 a[44:47], v[232:235], v[172:175], a[44:47]
ds_read_b64_tr_b16 v[230:231], v250 offset:51712
v_cvt_pk_bf16_f32 v66, v216, v217
v_mfma_f32_16x16x32_bf16 a[44:47], v[236:239], v[188:191], a[44:47]
s_waitcnt lgkmcnt(4)
v_mfma_f32_16x16x32_bf16 a[48:51], v[240:243], v[128:131], a[48:51]
ds_read_b64_tr_b16 v[232:233], v249 offset:4096
v_mfma_f32_16x16x32_bf16 a[48:51], v[244:247], v[144:147], a[48:51]
v_exp_f32 v218, v218
v_mfma_f32_16x16x32_bf16 a[52:55], v[240:243], v[132:135], a[52:55]
ds_read_b64_tr_b16 v[234:235], v249 offset:6144
v_mfma_f32_16x16x32_bf16 a[52:55], v[244:247], v[148:151], a[52:55]
v_exp_f32 v219, v219
v_mfma_f32_16x16x32_bf16 a[56:59], v[240:243], v[136:139], a[56:59]
ds_read_b64_tr_b16 v[236:237], v249 offset:20480
v_cvt_pk_bf16_f32 v67, v218, v219
v_mfma_f32_16x16x32_bf16 a[56:59], v[244:247], v[152:155], a[56:59]
v_exp_f32 v220, v220
v_mfma_f32_16x16x32_bf16 a[60:63], v[240:243], v[140:143], a[60:63]
ds_read_b64_tr_b16 v[238:239], v249 offset:22528
v_mfma_f32_16x16x32_bf16 a[60:63], v[244:247], v[156:159], a[60:63]
s_waitcnt lgkmcnt(4)
v_mfma_f32_16x16x32_bf16 a[48:51], v[224:227], v[160:163], a[48:51]
ds_read_b64_tr_b16 v[240:241], v12 offset:0
v_mfma_f32_16x16x32_bf16 a[48:51], v[228:231], v[176:179], a[48:51]
v_exp_f32 v221, v221
v_mfma_f32_16x16x32_bf16 a[52:55], v[224:227], v[164:167], a[52:55]
ds_read_b64_tr_b16 v[242:243], v12 offset:2048
v_cvt_pk_bf16_f32 v98, v220, v221
v_mfma_f32_16x16x32_bf16 a[52:55], v[228:231], v[180:183], a[52:55]
v_exp_f32 v222, v222
v_mfma_f32_16x16x32_bf16 a[56:59], v[224:227], v[168:171], a[56:59]
ds_read_b64_tr_b16 v[244:245], v13 offset:0
v_mfma_f32_16x16x32_bf16 a[56:59], v[228:231], v[184:187], a[56:59]
v_exp_f32 v223, v223
v_mfma_f32_16x16x32_bf16 a[60:63], v[224:227], v[172:175], a[60:63]
ds_read_b64_tr_b16 v[246:247], v13 offset:2048
v_cvt_pk_bf16_f32 v99, v222, v223
v_mfma_f32_16x16x32_bf16 a[60:63], v[228:231], v[188:191], a[60:63]
s_waitcnt lgkmcnt(4)
v_mfma_f32_16x16x32_bf16 a[64:67], v[232:235], v[128:131], a[64:67]
ds_read_b64_tr_b16 v[224:225], v12 offset:512
v_mfma_f32_16x16x32_bf16 a[64:67], v[236:239], v[144:147], a[64:67]
v_mfma_f32_16x16x32_bf16 a[68:71], v[232:235], v[132:135], a[68:71]
ds_read_b64_tr_b16 v[226:227], v12 offset:2560
v_mfma_f32_16x16x32_bf16 a[68:71], v[236:239], v[148:151], a[68:71]
v_mfma_f32_16x16x32_bf16 a[72:75], v[232:235], v[136:139], a[72:75]
ds_read_b64_tr_b16 v[228:229], v13 offset:512
v_mfma_f32_16x16x32_bf16 a[72:75], v[236:239], v[152:155], a[72:75]
v_mfma_f32_16x16x32_bf16 a[76:79], v[232:235], v[140:143], a[76:79]
ds_read_b64_tr_b16 v[230:231], v13 offset:2560
v_mfma_f32_16x16x32_bf16 a[76:79], v[236:239], v[156:159], a[76:79]
s_waitcnt lgkmcnt(4)
v_mfma_f32_16x16x32_bf16 a[0:3], v[240:243], v[0:3], a[0:3]
ds_read_b64_tr_b16 v[232:233], v249 offset:36864
v_mfma_f32_16x16x32_bf16 a[4:7], v[240:243], v[32:35], a[4:7]
v_mfma_f32_16x16x32_bf16 a[8:11], v[240:243], v[64:67], a[8:11]
ds_read_b64_tr_b16 v[234:235], v249 offset:38912
v_mfma_f32_16x16x32_bf16 a[12:15], v[240:243], v[96:99], a[12:15]
v_mfma_f32_16x16x32_bf16 a[16:19], v[244:247], v[0:3], a[16:19]
ds_read_b64_tr_b16 v[236:237], v249 offset:53248
v_mfma_f32_16x16x32_bf16 a[20:23], v[244:247], v[32:35], a[20:23]
v_mfma_f32_16x16x32_bf16 a[24:27], v[244:247], v[64:67], a[24:27]
ds_read_b64_tr_b16 v[238:239], v249 offset:55296
v_mfma_f32_16x16x32_bf16 a[28:31], v[244:247], v[96:99], a[28:31]
s_waitcnt lgkmcnt(4)
v_mfma_f32_16x16x32_bf16 a[32:35], v[224:227], v[0:3], a[32:35]
ds_read_b64_tr_b16 v[240:241], v250 offset:4096
v_mfma_f32_16x16x32_bf16 a[36:39], v[224:227], v[32:35], a[36:39]
v_mfma_f32_16x16x32_bf16 a[40:43], v[224:227], v[64:67], a[40:43]
ds_read_b64_tr_b16 v[242:243], v250 offset:6144
v_accvgpr_read_b32 v192, a0
v_accvgpr_read_b32 v193, a4
v_mfma_f32_16x16x32_bf16 a[44:47], v[224:227], v[96:99], a[44:47]
v_accvgpr_read_b32 v194, a8
v_accvgpr_read_b32 v195, a12
v_lshlrev_b32 v253, 2, v252
v_mfma_f32_16x16x32_bf16 a[48:51], v[228:231], v[0:3], a[48:51]
ds_read_b64_tr_b16 v[244:245], v250 offset:20480
v_max3_u32 v254, v192, v193, v194
v_min3_u32 v255, v192, v193, v194
v_mfma_f32_16x16x32_bf16 a[52:55], v[228:231], v[32:35], a[52:55]
v_max_u32 v254, v254, v195
v_min_u32 v255, v255, v195
v_mfma_f32_16x16x32_bf16 a[56:59], v[228:231], v[64:67], a[56:59]
ds_read_b64_tr_b16 v[246:247], v250 offset:22528
v_mfma_f32_16x16x32_bf16 a[60:63], v[228:231], v[96:99], a[60:63]
s_waitcnt lgkmcnt(4)
v_mfma_f32_16x16x32_bf16 a[64:67], v[232:235], v[160:163], a[64:67]
ds_read_b64_tr_b16 v[224:225], v250 offset:36864
v_mfma_f32_16x16x32_bf16 a[64:67], v[236:239], v[176:179], a[64:67]
s_mov_b64 exec, 0xffff
buffer_store_dword v192, v253, s[24:27], s48 offen offset:4 sc1
buffer_store_dword v193, v253, s[24:27], s48 offen offset:1028 sc1
buffer_store_dword v194, v253, s[24:27], s48 offen offset:2052 sc1
buffer_store_dword v195, v253, s[24:27], s48 offen offset:3076 sc1
v_cmp_lt_u32 s[50:51], s52, v254
v_cmp_gt_u32 vcc, s53, v255
s_mov_b64 exec, -1
v_mfma_f32_16x16x32_bf16 a[68:71], v[232:235], v[164:167], a[68:71]
ds_read_b64_tr_b16 v[226:227], v250 offset:38912
v_accvgpr_read_b32 v192, a0
v_accvgpr_read_b32 v193, a1
v_mfma_f32_16x16x32_bf16 a[68:71], v[236:239], v[180:183], a[68:71]
v_accvgpr_read_b32 v194, a2
v_accvgpr_read_b32 v195, a3
v_cvt_pk_bf16_f32 v16, v192, v193
v_mfma_f32_16x16x32_bf16 a[72:75], v[232:235], v[168:171], a[72:75]
ds_read_b64_tr_b16 v[228:229], v250 offset:53248
v_cvt_pk_bf16_f32 v17, v194, v195
v_accvgpr_read_b32 v200, a4
v_mfma_f32_16x16x32_bf16 a[72:75], v[236:239], v[184:187], a[72:75]
v_accvgpr_read_b32 v201, a5
v_accvgpr_read_b32 v202, a6
v_accvgpr_read_b32 v203, a7
v_mfma_f32_16x16x32_bf16 a[76:79], v[232:235], v[172:175], a[76:79]
ds_read_b64_tr_b16 v[230:231], v250 offset:55296
v_cvt_pk_bf16_f32 v48, v200, v201
v_cvt_pk_bf16_f32 v49, v202, v203
v_mfma_f32_16x16x32_bf16 a[76:79], v[236:239], v[188:191], a[76:79]
s_waitcnt lgkmcnt(4)
v_accvgpr_read_b32 v208, a8
v_accvgpr_read_b32 v209, a9
v_mfma_f32_16x16x32_bf16 a[80:83], v[240:243], v[128:131], a[80:83]
ds_read_b64_tr_b16 v[232:233], v12 offset:4096
v_accvgpr_read_b32 v210, a10
v_accvgpr_read_b32 v211, a11
v_mfma_f32_16x16x32_bf16 a[80:83], v[244:247], v[144:147], a[80:83]
v_cvt_pk_bf16_f32 v80, v208, v209
v_cvt_pk_bf16_f32 v81, v210, v211
v_accvgpr_read_b32 v216, a12
v_mfma_f32_16x16x32_bf16 a[84:87], v[240:243], v[132:135], a[84:87]
ds_read_b64_tr_b16 v[234:235], v12 offset:6144
v_accvgpr_read_b32 v217, a13
v_accvgpr_read_b32 v218, a14
v_mfma_f32_16x16x32_bf16 a[84:87], v[244:247], v[148:151], a[84:87]
v_accvgpr_read_b32 v219, a15
v_cvt_pk_bf16_f32 v112, v216, v217
v_cvt_pk_bf16_f32 v113, v218, v219
v_mfma_f32_16x16x32_bf16 a[88:91], v[240:243], v[136:139], a[88:91]
ds_read_b64_tr_b16 v[236:237], v13 offset:4096
v_accvgpr_read_b32 v196, a16
v_accvgpr_read_b32 v197, a17
v_mfma_f32_16x16x32_bf16 a[88:91], v[244:247], v[152:155], a[88:91]
v_accvgpr_read_b32 v198, a18
v_accvgpr_read_b32 v199, a19
v_cvt_pk_bf16_f32 v18, v196, v197
v_mfma_f32_16x16x32_bf16 a[92:95], v[240:243], v[140:143], a[92:95]
ds_read_b64_tr_b16 v[238:239], v13 offset:6144
v_cvt_pk_bf16_f32 v19, v198, v199
buffer_store_dwordx4 v[16:19], v252, s[20:23], s40 offen offset:0 sc1
v_mfma_f32_16x16x32_bf16 a[92:95], v[244:247], v[156:159], a[92:95]
s_waitcnt lgkmcnt(4)
v_accvgpr_read_b32 v204, a20
v_accvgpr_read_b32 v205, a21
v_mfma_f32_16x16x32_bf16 a[80:83], v[224:227], v[160:163], a[80:83]
ds_read_b64_tr_b16 v[240:241], v249 offset:4608
v_accvgpr_read_b32 v206, a22
v_accvgpr_read_b32 v207, a23
v_mfma_f32_16x16x32_bf16 a[80:83], v[228:231], v[176:179], a[80:83]
v_cvt_pk_bf16_f32 v50, v204, v205
v_cvt_pk_bf16_f32 v51, v206, v207
buffer_store_dwordx4 v[48:51], v252, s[20:23], s41 offen offset:0 sc1
v_mfma_f32_16x16x32_bf16 a[84:87], v[224:227], v[164:167], a[84:87]
ds_read_b64_tr_b16 v[242:243], v249 offset:6656
v_accvgpr_read_b32 v212, a24
v_accvgpr_read_b32 v213, a25
v_mfma_f32_16x16x32_bf16 a[84:87], v[228:231], v[180:183], a[84:87]
v_accvgpr_read_b32 v214, a26
v_accvgpr_read_b32 v215, a27
v_cvt_pk_bf16_f32 v82, v212, v213
v_mfma_f32_16x16x32_bf16 a[88:91], v[224:227], v[168:171], a[88:91]
ds_read_b64_tr_b16 v[244:245], v249 offset:20992
v_cvt_pk_bf16_f32 v83, v214, v215
buffer_store_dwordx4 v[80:83], v252, s[20:23], s42 offen offset:0 sc1
v_mfma_f32_16x16x32_bf16 a[88:91], v[228:231], v[184:187], a[88:91]
v_accvgpr_read_b32 v220, a28
v_accvgpr_read_b32 v221, a29
v_accvgpr_read_b32 v222, a30
v_mfma_f32_16x16x32_bf16 a[92:95], v[224:227], v[172:175], a[92:95]
ds_read_b64_tr_b16 v[246:247], v249 offset:23040
v_accvgpr_read_b32 v223, a31
v_cvt_pk_bf16_f32 v114, v220, v221
v_mfma_f32_16x16x32_bf16 a[92:95], v[228:231], v[188:191], a[92:95]
s_waitcnt lgkmcnt(4)
v_cvt_pk_bf16_f32 v115, v222, v223
buffer_store_dwordx4 v[112:115], v252, s[20:23], s43 offen offset:0 sc1
v_mfma_f32_16x16x32_bf16 a[64:67], v[232:235], v[0:3], a[64:67]
ds_read_b64_tr_b16 v[224:225], v249 offset:37376
v_accvgpr_read_b32 v192, a32
v_accvgpr_read_b32 v193, a33
v_mfma_f32_16x16x32_bf16 a[68:71], v[232:235], v[32:35], a[68:71]
v_accvgpr_read_b32 v194, a34
v_accvgpr_read_b32 v195, a35
v_cvt_pk_bf16_f32 v20, v192, v193
v_mfma_f32_16x16x32_bf16 a[72:75], v[232:235], v[64:67], a[72:75]
ds_read_b64_tr_b16 v[226:227], v249 offset:39424
v_cvt_pk_bf16_f32 v21, v194, v195
v_accvgpr_read_b32 v200, a36
v_mfma_f32_16x16x32_bf16 a[76:79], v[232:235], v[96:99], a[76:79]
v_accvgpr_read_b32 v201, a37
v_accvgpr_read_b32 v202, a38
v_accvgpr_read_b32 v203, a39
v_mfma_f32_16x16x32_bf16 a[80:83], v[236:239], v[0:3], a[80:83]
ds_read_b64_tr_b16 v[228:229], v249 offset:53760
v_cvt_pk_bf16_f32 v52, v200, v201
v_cvt_pk_bf16_f32 v53, v202, v203
v_mfma_f32_16x16x32_bf16 a[84:87], v[236:239], v[32:35], a[84:87]
v_accvgpr_read_b32 v208, a40
v_accvgpr_read_b32 v209, a41
v_accvgpr_read_b32 v210, a42
v_mfma_f32_16x16x32_bf16 a[88:91], v[236:239], v[64:67], a[88:91]
ds_read_b64_tr_b16 v[230:231], v249 offset:55808
v_accvgpr_read_b32 v211, a43
v_cvt_pk_bf16_f32 v84, v208, v209
v_mfma_f32_16x16x32_bf16 a[92:95], v[236:239], v[96:99], a[92:95]
s_waitcnt lgkmcnt(4)
v_cvt_pk_bf16_f32 v85, v210, v211
v_accvgpr_read_b32 v216, a44
v_mfma_f32_16x16x32_bf16 a[96:99], v[240:243], v[128:131], a[96:99]
ds_read_b64_tr_b16 v[232:233], v250 offset:4608
v_accvgpr_read_b32 v217, a45
v_accvgpr_read_b32 v218, a46
v_mfma_f32_16x16x32_bf16 a[96:99], v[244:247], v[144:147], a[96:99]
v_accvgpr_read_b32 v219, a47
v_cvt_pk_bf16_f32 v116, v216, v217
v_cvt_pk_bf16_f32 v117, v218, v219
v_mfma_f32_16x16x32_bf16 a[100:103], v[240:243], v[132:135], a[100:103]
ds_read_b64_tr_b16 v[234:235], v250 offset:6656
v_accvgpr_read_b32 v196, a48
v_accvgpr_read_b32 v197, a49
v_mfma_f32_16x16x32_bf16 a[100:103], v[244:247], v[148:151], a[100:103]
v_accvgpr_read_b32 v198, a50
v_accvgpr_read_b32 v199, a51
v_cvt_pk_bf16_f32 v22, v196, v197
v_mfma_f32_16x16x32_bf16 a[104:107], v[240:243], v[136:139], a[104:107]
ds_read_b64_tr_b16 v[236:237], v250 offset:20992
v_cvt_pk_bf16_f32 v23, v198, v199
buffer_store_dwordx4 v[20:23], v252, s[20:23], s40 offen offset:1024 sc1
v_mfma_f32_16x16x32_bf16 a[104:107], v[244:247], v[152:155], a[104:107]
v_accvgpr_read_b32 v204, a52
v_accvgpr_read_b32 v205, a53
v_accvgpr_read_b32 v206, a54
v_mfma_f32_16x16x32_bf16 a[108:111], v[240:243], v[140:143], a[108:111]
ds_read_b64_tr_b16 v[238:239], v250 offset:23040
v_accvgpr_read_b32 v207, a55
v_cvt_pk_bf16_f32 v54, v204, v205
v_mfma_f32_16x16x32_bf16 a[108:111], v[244:247], v[156:159], a[108:111]
s_waitcnt lgkmcnt(4)
v_cvt_pk_bf16_f32 v55, v206, v207
buffer_store_dwordx4 v[52:55], v252, s[20:23], s41 offen offset:1024 sc1
v_mfma_f32_16x16x32_bf16 a[96:99], v[224:227], v[160:163], a[96:99]
ds_read_b64_tr_b16 v[240:241], v250 offset:37376
v_accvgpr_read_b32 v212, a56
v_accvgpr_read_b32 v213, a57
v_mfma_f32_16x16x32_bf16 a[96:99], v[228:231], v[176:179], a[96:99]
v_accvgpr_read_b32 v214, a58
v_accvgpr_read_b32 v215, a59
v_cvt_pk_bf16_f32 v86, v212, v213
v_mfma_f32_16x16x32_bf16 a[100:103], v[224:227], v[164:167], a[100:103]
ds_read_b64_tr_b16 v[242:243], v250 offset:39424
v_cvt_pk_bf16_f32 v87, v214, v215
buffer_store_dwordx4 v[84:87], v252, s[20:23], s42 offen offset:1024 sc1
v_mfma_f32_16x16x32_bf16 a[100:103], v[228:231], v[180:183], a[100:103]
v_accvgpr_read_b32 v220, a60
v_accvgpr_read_b32 v221, a61
v_accvgpr_read_b32 v222, a62
v_mfma_f32_16x16x32_bf16 a[104:107], v[224:227], v[168:171], a[104:107]
ds_read_b64_tr_b16 v[244:245], v250 offset:53760
v_accvgpr_read_b32 v223, a63
v_cvt_pk_bf16_f32 v118, v220, v221
v_mfma_f32_16x16x32_bf16 a[104:107], v[228:231], v[184:187], a[104:107]
v_cvt_pk_bf16_f32 v119, v222, v223
buffer_store_dwordx4 v[116:119], v252, s[20:23], s43 offen offset:1024 sc1
v_accvgpr_read_b32 v192, a64
v_mfma_f32_16x16x32_bf16 a[108:111], v[224:227], v[172:175], a[108:111]
ds_read_b64_tr_b16 v[246:247], v250 offset:55808
v_accvgpr_read_b32 v193, a65
v_accvgpr_read_b32 v194, a66
v_mfma_f32_16x16x32_bf16 a[108:111], v[228:231], v[188:191], a[108:111]
s_waitcnt lgkmcnt(4)
v_accvgpr_read_b32 v195, a67
v_cvt_pk_bf16_f32 v24, v192, v193
v_mfma_f32_16x16x32_bf16 a[112:115], v[232:235], v[128:131], a[112:115]
ds_read_b64_tr_b16 v[224:225], v12 offset:4608
v_cvt_pk_bf16_f32 v25, v194, v195
v_accvgpr_read_b32 v200, a68
v_mfma_f32_16x16x32_bf16 a[112:115], v[236:239], v[144:147], a[112:115]
v_accvgpr_read_b32 v201, a69
v_accvgpr_read_b32 v202, a70
v_accvgpr_read_b32 v203, a71
v_mfma_f32_16x16x32_bf16 a[116:119], v[232:235], v[132:135], a[116:119]
ds_read_b64_tr_b16 v[226:227], v12 offset:6656
v_cvt_pk_bf16_f32 v56, v200, v201
v_cvt_pk_bf16_f32 v57, v202, v203
v_mfma_f32_16x16x32_bf16 a[116:119], v[236:239], v[148:151], a[116:119]
v_accvgpr_read_b32 v208, a72
v_accvgpr_read_b32 v209, a73
v_accvgpr_read_b32 v210, a74
v_mfma_f32_16x16x32_bf16 a[120:123], v[232:235], v[136:139], a[120:123]
ds_read_b64_tr_b16 v[228:229], v13 offset:4608
v_accvgpr_read_b32 v211, a75
v_cvt_pk_bf16_f32 v88, v208, v209
v_mfma_f32_16x16x32_bf16 a[120:123], v[236:239], v[152:155], a[120:123]
v_cvt_pk_bf16_f32 v89, v210, v211
v_accvgpr_read_b32 v216, a76
v_accvgpr_read_b32 v217, a77
v_mfma_f32_16x16x32_bf16 a[124:127], v[232:235], v[140:143], a[124:127]
ds_read_b64_tr_b16 v[230:231], v13 offset:6656
v_accvgpr_read_b32 v218, a78
v_accvgpr_read_b32 v219, a79
v_mfma_f32_16x16x32_bf16 a[124:127], v[236:239], v[156:159], a[124:127]
s_waitcnt lgkmcnt(4)
v_cvt_pk_bf16_f32 v120, v216, v217
v_cvt_pk_bf16_f32 v121, v218, v219
v_mfma_f32_16x16x32_bf16 a[112:115], v[240:243], v[160:163], a[112:115]
ds_read_b64_tr_b16 v[232:233], v249 offset:8192
v_accvgpr_read_b32 v196, a80
v_accvgpr_read_b32 v197, a81
v_mfma_f32_16x16x32_bf16 a[112:115], v[244:247], v[176:179], a[112:115]
v_accvgpr_read_b32 v198, a82
v_accvgpr_read_b32 v199, a83
v_cvt_pk_bf16_f32 v26, v196, v197
v_mfma_f32_16x16x32_bf16 a[116:119], v[240:243], v[164:167], a[116:119]
ds_read_b64_tr_b16 v[234:235], v249 offset:10240
v_cvt_pk_bf16_f32 v27, v198, v199
buffer_store_dwordx4 v[24:27], v252, s[20:23], s40 offen offset:2048 sc1
v_mfma_f32_16x16x32_bf16 a[116:119], v[244:247], v[180:183], a[116:119]
v_accvgpr_read_b32 v204, a84
v_accvgpr_read_b32 v205, a85
v_accvgpr_read_b32 v206, a86
v_mfma_f32_16x16x32_bf16 a[120:123], v[240:243], v[168:171], a[120:123]
ds_read_b64_tr_b16 v[236:237], v249 offset:24576
v_accvgpr_read_b32 v207, a87
v_cvt_pk_bf16_f32 v58, v204, v205
v_mfma_f32_16x16x32_bf16 a[120:123], v[244:247], v[184:187], a[120:123]
v_cvt_pk_bf16_f32 v59, v206, v207
buffer_store_dwordx4 v[56:59], v252, s[20:23], s41 offen offset:2048 sc1
v_accvgpr_read_b32 v212, a88
v_mfma_f32_16x16x32_bf16 a[124:127], v[240:243], v[172:175], a[124:127]
ds_read_b64_tr_b16 v[238:239], v249 offset:26624
v_accvgpr_read_b32 v213, a89
v_accvgpr_read_b32 v214, a90
v_mfma_f32_16x16x32_bf16 a[124:127], v[244:247], v[188:191], a[124:127]
s_waitcnt lgkmcnt(4)
v_accvgpr_read_b32 v215, a91
v_cvt_pk_bf16_f32 v90, v212, v213
v_mfma_f32_16x16x32_bf16 a[96:99], v[224:227], v[0:3], a[96:99]
ds_read_b64_tr_b16 v[240:241], v249 offset:40960
v_cvt_pk_bf16_f32 v91, v214, v215
buffer_store_dwordx4 v[88:91], v252, s[20:23], s42 offen offset:2048 sc1
v_mfma_f32_16x16x32_bf16 a[100:103], v[224:227], v[32:35], a[100:103]
v_accvgpr_read_b32 v220, a92
v_accvgpr_read_b32 v221, a93
v_accvgpr_read_b32 v222, a94
v_mfma_f32_16x16x32_bf16 a[104:107], v[224:227], v[64:67], a[104:107]
ds_read_b64_tr_b16 v[242:243], v249 offset:43008
v_accvgpr_read_b32 v223, a95
v_cvt_pk_bf16_f32 v122, v220, v221
v_mfma_f32_16x16x32_bf16 a[108:111], v[224:227], v[96:99], a[108:111]
v_cvt_pk_bf16_f32 v123, v222, v223
buffer_store_dwordx4 v[120:123], v252, s[20:23], s43 offen offset:2048 sc1
v_mfma_f32_16x16x32_bf16 a[112:115], v[228:231], v[0:3], a[112:115]
ds_read_b64_tr_b16 v[244:245], v249 offset:57344
v_mfma_f32_16x16x32_bf16 a[116:119], v[228:231], v[32:35], a[116:119]
v_mfma_f32_16x16x32_bf16 a[120:123], v[228:231], v[64:67], a[120:123]
ds_read_b64_tr_b16 v[246:247], v249 offset:59392
v_mfma_f32_16x16x32_bf16 a[124:127], v[228:231], v[96:99], a[124:127]
s_waitcnt lgkmcnt(4)
v_mfma_f32_16x16x32_bf16 a[128:131], v[232:235], v[128:131], a[128:131]
ds_read_b64_tr_b16 v[224:225], v250 offset:8192
v_mfma_f32_16x16x32_bf16 a[128:131], v[236:239], v[144:147], a[128:131]
v_mfma_f32_16x16x32_bf16 a[132:135], v[232:235], v[132:135], a[132:135]
ds_read_b64_tr_b16 v[226:227], v250 offset:10240
v_mfma_f32_16x16x32_bf16 a[132:135], v[236:239], v[148:151], a[132:135]
v_mfma_f32_16x16x32_bf16 a[136:139], v[232:235], v[136:139], a[136:139]
ds_read_b64_tr_b16 v[228:229], v250 offset:24576
v_accvgpr_read_b32 v192, a96
v_mfma_f32_16x16x32_bf16 a[136:139], v[236:239], v[152:155], a[136:139]
v_accvgpr_read_b32 v193, a97
v_accvgpr_read_b32 v194, a98
v_mfma_f32_16x16x32_bf16 a[140:143], v[232:235], v[140:143], a[140:143]
ds_read_b64_tr_b16 v[230:231], v250 offset:26624
v_accvgpr_read_b32 v195, a99
v_mfma_f32_16x16x32_bf16 a[140:143], v[236:239], v[156:159], a[140:143]
s_waitcnt lgkmcnt(4)
v_cvt_pk_bf16_f32 v28, v192, v193
v_mfma_f32_16x16x32_bf16 a[128:131], v[240:243], v[160:163], a[128:131]
ds_read_b64_tr_b16 v[232:233], v250 offset:40960
v_cvt_pk_bf16_f32 v29, v194, v195
v_mfma_f32_16x16x32_bf16 a[128:131], v[244:247], v[176:179], a[128:131]
v_accvgpr_read_b32 v200, a100
v_accvgpr_read_b32 v201, a101
v_mfma_f32_16x16x32_bf16 a[132:135], v[240:243], v[164:167], a[132:135]
ds_read_b64_tr_b16 v[234:235], v250 offset:43008
v_accvgpr_read_b32 v202, a102
v_mfma_f32_16x16x32_bf16 a[132:135], v[244:247], v[180:183], a[132:135]
v_accvgpr_read_b32 v203, a103
v_cvt_pk_bf16_f32 v60, v200, v201
v_mfma_f32_16x16x32_bf16 a[136:139], v[240:243], v[168:171], a[136:139]
ds_read_b64_tr_b16 v[236:237], v250 offset:57344
v_cvt_pk_bf16_f32 v61, v202, v203
v_mfma_f32_16x16x32_bf16 a[136:139], v[244:247], v[184:187], a[136:139]
v_accvgpr_read_b32 v208, a104
v_accvgpr_read_b32 v209, a105
v_mfma_f32_16x16x32_bf16 a[140:143], v[240:243], v[172:175], a[140:143]
ds_read_b64_tr_b16 v[238:239], v250 offset:59392
v_accvgpr_read_b32 v210, a106
v_mfma_f32_16x16x32_bf16 a[140:143], v[244:247], v[188:191], a[140:143]
s_waitcnt lgkmcnt(4)
v_accvgpr_read_b32 v211, a107
v_mfma_f32_16x16x32_bf16 a[144:147], v[224:227], v[128:131], a[144:147]
ds_read_b64_tr_b16 v[240:241], v12 offset:8192
v_cvt_pk_bf16_f32 v92, v208, v209
v_mfma_f32_16x16x32_bf16 a[144:147], v[228:231], v[144:147], a[144:147]
v_cvt_pk_bf16_f32 v93, v210, v211
v_accvgpr_read_b32 v216, a108
v_mfma_f32_16x16x32_bf16 a[148:151], v[224:227], v[132:135], a[148:151]
ds_read_b64_tr_b16 v[242:243], v12 offset:10240
v_accvgpr_read_b32 v217, a109
v_mfma_f32_16x16x32_bf16 a[148:151], v[228:231], v[148:151], a[148:151]
v_accvgpr_read_b32 v218, a110
v_accvgpr_read_b32 v219, a111
v_mfma_f32_16x16x32_bf16 a[152:155], v[224:227], v[136:139], a[152:155]
ds_read_b64_tr_b16 v[244:245], v13 offset:8192
v_cvt_pk_bf16_f32 v124, v216, v217
v_mfma_f32_16x16x32_bf16 a[152:155], v[228:231], v[152:155], a[152:155]
v_cvt_pk_bf16_f32 v125, v218, v219
v_accvgpr_read_b32 v196, a112
v_mfma_f32_16x16x32_bf16 a[156:159], v[224:227], v[140:143], a[156:159]
ds_read_b64_tr_b16 v[246:247], v13 offset:10240
v_accvgpr_read_b32 v197, a113
v_mfma_f32_16x16x32_bf16 a[156:159], v[228:231], v[156:159], a[156:159]
s_waitcnt lgkmcnt(4)
v_accvgpr_read_b32 v198, a114
v_mfma_f32_16x16x32_bf16 a[144:147], v[232:235], v[160:163], a[144:147]
ds_read_b64_tr_b16 v[224:225], v249 offset:8704
v_accvgpr_read_b32 v199, a115
v_mfma_f32_16x16x32_bf16 a[144:147], v[236:239], v[176:179], a[144:147]
v_cvt_pk_bf16_f32 v30, v196, v197
v_cvt_pk_bf16_f32 v31, v198, v199
v_mfma_f32_16x16x32_bf16 a[148:151], v[232:235], v[164:167], a[148:151]
ds_read_b64_tr_b16 v[226:227], v249 offset:10752
buffer_store_dwordx4 v[28:31], v252, s[20:23], s40 offen offset:3072 sc1
v_mfma_f32_16x16x32_bf16 a[148:151], v[236:239], v[180:183], a[148:151]
v_accvgpr_read_b32 v204, a116
v_accvgpr_read_b32 v205, a117
v_mfma_f32_16x16x32_bf16 a[152:155], v[232:235], v[168:171], a[152:155]
ds_read_b64_tr_b16 v[228:229], v249 offset:25088
v_accvgpr_read_b32 v206, a118
v_mfma_f32_16x16x32_bf16 a[152:155], v[236:239], v[184:187], a[152:155]
v_accvgpr_read_b32 v207, a119
v_cvt_pk_bf16_f32 v62, v204, v205
v_mfma_f32_16x16x32_bf16 a[156:159], v[232:235], v[172:175], a[156:159]
ds_read_b64_tr_b16 v[230:231], v249 offset:27136
v_cvt_pk_bf16_f32 v63, v206, v207
v_mfma_f32_16x16x32_bf16 a[156:159], v[236:239], v[188:191], a[156:159]
s_waitcnt lgkmcnt(4)
buffer_store_dwordx4 v[60:63], v252, s[20:23], s41 offen offset:3072 sc1
v_mfma_f32_16x16x32_bf16 a[128:131], v[240:243], v[0:3], a[128:131]
ds_read_b64_tr_b16 v[232:233], v249 offset:41472
v_accvgpr_read_b32 v212, a120
v_mfma_f32_16x16x32_bf16 a[132:135], v[240:243], v[32:35], a[132:135]
v_accvgpr_read_b32 v213, a121
v_accvgpr_read_b32 v214, a122
v_mfma_f32_16x16x32_bf16 a[136:139], v[240:243], v[64:67], a[136:139]
ds_read_b64_tr_b16 v[234:235], v249 offset:43520
v_accvgpr_read_b32 v215, a123
v_mfma_f32_16x16x32_bf16 a[140:143], v[240:243], v[96:99], a[140:143]
v_cvt_pk_bf16_f32 v94, v212, v213
v_cvt_pk_bf16_f32 v95, v214, v215
v_mfma_f32_16x16x32_bf16 a[144:147], v[244:247], v[0:3], a[144:147]
ds_read_b64_tr_b16 v[236:237], v249 offset:57856
buffer_store_dwordx4 v[92:95], v252, s[20:23], s42 offen offset:3072 sc1
v_mfma_f32_16x16x32_bf16 a[148:151], v[244:247], v[32:35], a[148:151]
v_accvgpr_read_b32 v220, a124
v_accvgpr_read_b32 v221, a125
v_mfma_f32_16x16x32_bf16 a[152:155], v[244:247], v[64:67], a[152:155]
ds_read_b64_tr_b16 v[238:239], v249 offset:59904
v_accvgpr_read_b32 v222, a126
v_mfma_f32_16x16x32_bf16 a[156:159], v[244:247], v[96:99], a[156:159]
s_waitcnt lgkmcnt(4)
v_accvgpr_read_b32 v223, a127
v_mfma_f32_16x16x32_bf16 a[160:163], v[224:227], v[128:131], a[160:163]
ds_read_b64_tr_b16 v[240:241], v250 offset:8704
v_cvt_pk_bf16_f32 v126, v220, v221
v_mfma_f32_16x16x32_bf16 a[160:163], v[228:231], v[144:147], a[160:163]
v_cvt_pk_bf16_f32 v127, v222, v223
buffer_store_dwordx4 v[124:127], v252, s[20:23], s43 offen offset:3072 sc1
v_mfma_f32_16x16x32_bf16 a[164:167], v[224:227], v[132:135], a[164:167]
ds_read_b64_tr_b16 v[242:243], v250 offset:10752
v_mfma_f32_16x16x32_bf16 a[164:167], v[228:231], v[148:151], a[164:167]
v_mfma_f32_16x16x32_bf16 a[168:171], v[224:227], v[136:139], a[168:171]
ds_read_b64_tr_b16 v[244:245], v250 offset:25088
v_accvgpr_read_b32 v192, a128
v_mfma_f32_16x16x32_bf16 a[168:171], v[228:231], v[152:155], a[168:171]
v_accvgpr_read_b32 v193, a129
v_accvgpr_read_b32 v194, a130
v_mfma_f32_16x16x32_bf16 a[172:175], v[224:227], v[140:143], a[172:175]
ds_read_b64_tr_b16 v[246:247], v250 offset:27136
v_accvgpr_read_b32 v195, a131
v_mfma_f32_16x16x32_bf16 a[172:175], v[228:231], v[156:159], a[172:175]
s_waitcnt lgkmcnt(4)
v_cvt_pk_bf16_f32 v16, v192, v193
v_mfma_f32_16x16x32_bf16 a[160:163], v[232:235], v[160:163], a[160:163]
ds_read_b64_tr_b16 v[224:225], v250 offset:41472
v_cvt_pk_bf16_f32 v17, v194, v195
v_mfma_f32_16x16x32_bf16 a[160:163], v[236:239], v[176:179], a[160:163]
v_accvgpr_read_b32 v200, a132
v_accvgpr_read_b32 v201, a133
v_mfma_f32_16x16x32_bf16 a[164:167], v[232:235], v[164:167], a[164:167]
ds_read_b64_tr_b16 v[226:227], v250 offset:43520
v_accvgpr_read_b32 v202, a134
v_mfma_f32_16x16x32_bf16 a[164:167], v[236:239], v[180:183], a[164:167]
v_accvgpr_read_b32 v203, a135
v_cvt_pk_bf16_f32 v48, v200, v201
v_mfma_f32_16x16x32_bf16 a[168:171], v[232:235], v[168:171], a[168:171]
ds_read_b64_tr_b16 v[228:229], v250 offset:57856
v_cvt_pk_bf16_f32 v49, v202, v203
v_mfma_f32_16x16x32_bf16 a[168:171], v[236:239], v[184:187], a[168:171]
v_accvgpr_read_b32 v208, a136
v_accvgpr_read_b32 v209, a137
v_mfma_f32_16x16x32_bf16 a[172:175], v[232:235], v[172:175], a[172:175]
ds_read_b64_tr_b16 v[230:231], v250 offset:59904
v_accvgpr_read_b32 v210, a138
v_mfma_f32_16x16x32_bf16 a[172:175], v[236:239], v[188:191], a[172:175]
s_waitcnt lgkmcnt(4)
v_accvgpr_read_b32 v211, a139
v_mfma_f32_16x16x32_bf16 a[176:179], v[240:243], v[128:131], a[176:179]
ds_read_b64_tr_b16 v[232:233], v12 offset:8704
v_cvt_pk_bf16_f32 v80, v208, v209
v_mfma_f32_16x16x32_bf16 a[176:179], v[244:247], v[144:147], a[176:179]
v_cvt_pk_bf16_f32 v81, v210, v211
v_accvgpr_read_b32 v216, a140
v_mfma_f32_16x16x32_bf16 a[180:183], v[240:243], v[132:135], a[180:183]
ds_read_b64_tr_b16 v[234:235], v12 offset:10752
v_accvgpr_read_b32 v217, a141
v_mfma_f32_16x16x32_bf16 a[180:183], v[244:247], v[148:151], a[180:183]
v_accvgpr_read_b32 v218, a142
v_accvgpr_read_b32 v219, a143
v_mfma_f32_16x16x32_bf16 a[184:187], v[240:243], v[136:139], a[184:187]
ds_read_b64_tr_b16 v[236:237], v13 offset:8704
v_cvt_pk_bf16_f32 v112, v216, v217
v_mfma_f32_16x16x32_bf16 a[184:187], v[244:247], v[152:155], a[184:187]
v_cvt_pk_bf16_f32 v113, v218, v219
v_accvgpr_read_b32 v196, a144
v_mfma_f32_16x16x32_bf16 a[188:191], v[240:243], v[140:143], a[188:191]
ds_read_b64_tr_b16 v[238:239], v13 offset:10752
v_accvgpr_read_b32 v197, a145
v_mfma_f32_16x16x32_bf16 a[188:191], v[244:247], v[156:159], a[188:191]
s_waitcnt lgkmcnt(4)
v_accvgpr_read_b32 v198, a146
v_mfma_f32_16x16x32_bf16 a[176:179], v[224:227], v[160:163], a[176:179]
ds_read_b64_tr_b16 v[240:241], v249 offset:12288
v_accvgpr_read_b32 v199, a147
v_mfma_f32_16x16x32_bf16 a[176:179], v[228:231], v[176:179], a[176:179]
v_cvt_pk_bf16_f32 v18, v196, v197
v_cvt_pk_bf16_f32 v19, v198, v199
v_mfma_f32_16x16x32_bf16 a[180:183], v[224:227], v[164:167], a[180:183]
ds_read_b64_tr_b16 v[242:243], v249 offset:14336
buffer_store_dwordx4 v[16:19], v252, s[20:23], s44 offen offset:0 sc1
v_mfma_f32_16x16x32_bf16 a[180:183], v[228:231], v[180:183], a[180:183]
v_accvgpr_read_b32 v204, a148
v_accvgpr_read_b32 v205, a149
v_mfma_f32_16x16x32_bf16 a[184:187], v[224:227], v[168:171], a[184:187]
ds_read_b64_tr_b16 v[244:245], v249 offset:28672
v_accvgpr_read_b32 v206, a150
v_mfma_f32_16x16x32_bf16 a[184:187], v[228:231], v[184:187], a[184:187]
v_accvgpr_read_b32 v207, a151
v_cvt_pk_bf16_f32 v50, v204, v205
v_mfma_f32_16x16x32_bf16 a[188:191], v[224:227], v[172:175], a[188:191]
ds_read_b64_tr_b16 v[246:247], v249 offset:30720
v_cvt_pk_bf16_f32 v51, v206, v207
v_mfma_f32_16x16x32_bf16 a[188:191], v[228:231], v[188:191], a[188:191]
s_waitcnt lgkmcnt(4)
buffer_store_dwordx4 v[48:51], v252, s[20:23], s45 offen offset:0 sc1
v_mfma_f32_16x16x32_bf16 a[160:163], v[232:235], v[0:3], a[160:163]
ds_read_b64_tr_b16 v[224:225], v249 offset:45056
v_accvgpr_read_b32 v212, a152
v_mfma_f32_16x16x32_bf16 a[164:167], v[232:235], v[32:35], a[164:167]
v_accvgpr_read_b32 v213, a153
v_accvgpr_read_b32 v214, a154
v_mfma_f32_16x16x32_bf16 a[168:171], v[232:235], v[64:67], a[168:171]
ds_read_b64_tr_b16 v[226:227], v249 offset:47104
v_accvgpr_read_b32 v215, a155
v_mfma_f32_16x16x32_bf16 a[172:175], v[232:235], v[96:99], a[172:175]
v_cvt_pk_bf16_f32 v82, v212, v213
v_cvt_pk_bf16_f32 v83, v214, v215
v_mfma_f32_16x16x32_bf16 a[176:179], v[236:239], v[0:3], a[176:179]
ds_read_b64_tr_b16 v[228:229], v249 offset:61440
buffer_store_dwordx4 v[80:83], v252, s[20:23], s46 offen offset:0 sc1
v_mfma_f32_16x16x32_bf16 a[180:183], v[236:239], v[32:35], a[180:183]
v_accvgpr_read_b32 v220, a156
v_accvgpr_read_b32 v221, a157
v_mfma_f32_16x16x32_bf16 a[184:187], v[236:239], v[64:67], a[184:187]
ds_read_b64_tr_b16 v[230:231], v249 offset:63488
v_accvgpr_read_b32 v222, a158
v_mfma_f32_16x16x32_bf16 a[188:191], v[236:239], v[96:99], a[188:191]
s_waitcnt lgkmcnt(4)
v_accvgpr_read_b32 v223, a159
v_mfma_f32_16x16x32_bf16 a[192:195], v[240:243], v[128:131], a[192:195]
ds_read_b64_tr_b16 v[232:233], v250 offset:12288
v_cvt_pk_bf16_f32 v114, v220, v221
v_mfma_f32_16x16x32_bf16 a[192:195], v[244:247], v[144:147], a[192:195]
v_cvt_pk_bf16_f32 v115, v222, v223
buffer_store_dwordx4 v[112:115], v252, s[20:23], s47 offen offset:0 sc1
v_mfma_f32_16x16x32_bf16 a[196:199], v[240:243], v[132:135], a[196:199]
ds_read_b64_tr_b16 v[234:235], v250 offset:14336
v_mfma_f32_16x16x32_bf16 a[196:199], v[244:247], v[148:151], a[196:199]
v_mfma_f32_16x16x32_bf16 a[200:203], v[240:243], v[136:139], a[200:203]
ds_read_b64_tr_b16 v[236:237], v250 offset:28672
v_accvgpr_read_b32 v192, a160
v_mfma_f32_16x16x32_bf16 a[200:203], v[244:247], v[152:155], a[200:203]
v_accvgpr_read_b32 v193, a161
v_accvgpr_read_b32 v194, a162
v_mfma_f32_16x16x32_bf16 a[204:207], v[240:243], v[140:143], a[204:207]
ds_read_b64_tr_b16 v[238:239], v250 offset:30720
v_accvgpr_read_b32 v195, a163
v_mfma_f32_16x16x32_bf16 a[204:207], v[244:247], v[156:159], a[204:207]
s_waitcnt lgkmcnt(4)
v_cvt_pk_bf16_f32 v20, v192, v193
v_mfma_f32_16x16x32_bf16 a[192:195], v[224:227], v[160:163], a[192:195]
ds_read_b64_tr_b16 v[240:241], v250 offset:45056
v_cvt_pk_bf16_f32 v21, v194, v195
v_mfma_f32_16x16x32_bf16 a[192:195], v[228:231], v[176:179], a[192:195]
v_accvgpr_read_b32 v200, a164
v_accvgpr_read_b32 v201, a165
v_mfma_f32_16x16x32_bf16 a[196:199], v[224:227], v[164:167], a[196:199]
ds_read_b64_tr_b16 v[242:243], v250 offset:47104
v_accvgpr_read_b32 v202, a166
v_mfma_f32_16x16x32_bf16 a[196:199], v[228:231], v[180:183], a[196:199]
v_accvgpr_read_b32 v203, a167
v_cvt_pk_bf16_f32 v52, v200, v201
v_mfma_f32_16x16x32_bf16 a[200:203], v[224:227], v[168:171], a[200:203]
ds_read_b64_tr_b16 v[244:245], v250 offset:61440
v_cvt_pk_bf16_f32 v53, v202, v203
v_mfma_f32_16x16x32_bf16 a[200:203], v[228:231], v[184:187], a[200:203]
v_accvgpr_read_b32 v208, a168
v_accvgpr_read_b32 v209, a169
v_mfma_f32_16x16x32_bf16 a[204:207], v[224:227], v[172:175], a[204:207]
ds_read_b64_tr_b16 v[246:247], v250 offset:63488
v_accvgpr_read_b32 v210, a170
v_mfma_f32_16x16x32_bf16 a[204:207], v[228:231], v[188:191], a[204:207]
s_waitcnt lgkmcnt(4)
v_accvgpr_read_b32 v211, a171
v_mfma_f32_16x16x32_bf16 a[208:211], v[232:235], v[128:131], a[208:211]
ds_read_b64_tr_b16 v[224:225], v12 offset:12288
v_cvt_pk_bf16_f32 v84, v208, v209
v_mfma_f32_16x16x32_bf16 a[208:211], v[236:239], v[144:147], a[208:211]
v_cvt_pk_bf16_f32 v85, v210, v211
v_accvgpr_read_b32 v216, a172
v_mfma_f32_16x16x32_bf16 a[212:215], v[232:235], v[132:135], a[212:215]
ds_read_b64_tr_b16 v[226:227], v12 offset:14336
v_accvgpr_read_b32 v217, a173
v_mfma_f32_16x16x32_bf16 a[212:215], v[236:239], v[148:151], a[212:215]
v_accvgpr_read_b32 v218, a174
v_accvgpr_read_b32 v219, a175
v_mfma_f32_16x16x32_bf16 a[216:219], v[232:235], v[136:139], a[216:219]
ds_read_b64_tr_b16 v[228:229], v13 offset:12288
v_cvt_pk_bf16_f32 v116, v216, v217
v_mfma_f32_16x16x32_bf16 a[216:219], v[236:239], v[152:155], a[216:219]
v_cvt_pk_bf16_f32 v117, v218, v219
v_accvgpr_read_b32 v196, a176
v_mfma_f32_16x16x32_bf16 a[220:223], v[232:235], v[140:143], a[220:223]
ds_read_b64_tr_b16 v[230:231], v13 offset:14336
v_accvgpr_read_b32 v197, a177
v_mfma_f32_16x16x32_bf16 a[220:223], v[236:239], v[156:159], a[220:223]
s_waitcnt lgkmcnt(4)
v_accvgpr_read_b32 v198, a178
v_mfma_f32_16x16x32_bf16 a[208:211], v[240:243], v[160:163], a[208:211]
ds_read_b64_tr_b16 v[232:233], v249 offset:12800
v_accvgpr_read_b32 v199, a179
v_mfma_f32_16x16x32_bf16 a[208:211], v[244:247], v[176:179], a[208:211]
v_cvt_pk_bf16_f32 v22, v196, v197
v_cvt_pk_bf16_f32 v23, v198, v199
v_mfma_f32_16x16x32_bf16 a[212:215], v[240:243], v[164:167], a[212:215]
ds_read_b64_tr_b16 v[234:235], v249 offset:14848
buffer_store_dwordx4 v[20:23], v252, s[20:23], s44 offen offset:1024 sc1
v_mfma_f32_16x16x32_bf16 a[212:215], v[244:247], v[180:183], a[212:215]
v_accvgpr_read_b32 v204, a180
v_accvgpr_read_b32 v205, a181
v_mfma_f32_16x16x32_bf16 a[216:219], v[240:243], v[168:171], a[216:219]
ds_read_b64_tr_b16 v[236:237], v249 offset:29184
v_accvgpr_read_b32 v206, a182
v_mfma_f32_16x16x32_bf16 a[216:219], v[244:247], v[184:187], a[216:219]
v_accvgpr_read_b32 v207, a183
v_cvt_pk_bf16_f32 v54, v204, v205
v_mfma_f32_16x16x32_bf16 a[220:223], v[240:243], v[172:175], a[220:223]
ds_read_b64_tr_b16 v[238:239], v249 offset:31232
v_cvt_pk_bf16_f32 v55, v206, v207
v_mfma_f32_16x16x32_bf16 a[220:223], v[244:247], v[188:191], a[220:223]
s_waitcnt lgkmcnt(4)
buffer_store_dwordx4 v[52:55], v252, s[20:23], s45 offen offset:1024 sc1
v_mfma_f32_16x16x32_bf16 a[192:195], v[224:227], v[0:3], a[192:195]
ds_read_b64_tr_b16 v[240:241], v249 offset:45568
v_accvgpr_read_b32 v212, a184
v_mfma_f32_16x16x32_bf16 a[196:199], v[224:227], v[32:35], a[196:199]
v_accvgpr_read_b32 v213, a185
v_accvgpr_read_b32 v214, a186
v_mfma_f32_16x16x32_bf16 a[200:203], v[224:227], v[64:67], a[200:203]
ds_read_b64_tr_b16 v[242:243], v249 offset:47616
v_accvgpr_read_b32 v215, a187
v_mfma_f32_16x16x32_bf16 a[204:207], v[224:227], v[96:99], a[204:207]
v_cvt_pk_bf16_f32 v86, v212, v213
v_cvt_pk_bf16_f32 v87, v214, v215
v_mfma_f32_16x16x32_bf16 a[208:211], v[228:231], v[0:3], a[208:211]
ds_read_b64_tr_b16 v[244:245], v249 offset:61952
buffer_store_dwordx4 v[84:87], v252, s[20:23], s46 offen offset:1024 sc1
v_mfma_f32_16x16x32_bf16 a[212:215], v[228:231], v[32:35], a[212:215]
v_accvgpr_read_b32 v220, a188
v_accvgpr_read_b32 v221, a189
v_mfma_f32_16x16x32_bf16 a[216:219], v[228:231], v[64:67], a[216:219]
ds_read_b64_tr_b16 v[246:247], v249 offset:64000
v_accvgpr_read_b32 v222, a190
v_mfma_f32_16x16x32_bf16 a[220:223], v[228:231], v[96:99], a[220:223]
s_waitcnt lgkmcnt(4)
v_accvgpr_read_b32 v223, a191
v_mfma_f32_16x16x32_bf16 a[224:227], v[232:235], v[128:131], a[224:227]
ds_read_b64_tr_b16 v[224:225], v250 offset:12800
v_cvt_pk_bf16_f32 v118, v220, v221
v_mfma_f32_16x16x32_bf16 a[224:227], v[236:239], v[144:147], a[224:227]
v_cvt_pk_bf16_f32 v119, v222, v223
buffer_store_dwordx4 v[116:119], v252, s[20:23], s47 offen offset:1024 sc1
v_mfma_f32_16x16x32_bf16 a[228:231], v[232:235], v[132:135], a[228:231]
ds_read_b64_tr_b16 v[226:227], v250 offset:14848
v_mfma_f32_16x16x32_bf16 a[228:231], v[236:239], v[148:151], a[228:231]
v_mfma_f32_16x16x32_bf16 a[232:235], v[232:235], v[136:139], a[232:235]
ds_read_b64_tr_b16 v[228:229], v250 offset:29184
v_accvgpr_read_b32 v192, a192
v_mfma_f32_16x16x32_bf16 a[232:235], v[236:239], v[152:155], a[232:235]
v_accvgpr_read_b32 v193, a193
v_accvgpr_read_b32 v194, a194
v_mfma_f32_16x16x32_bf16 a[236:239], v[232:235], v[140:143], a[236:239]
ds_read_b64_tr_b16 v[230:231], v250 offset:31232
v_accvgpr_read_b32 v195, a195
v_mfma_f32_16x16x32_bf16 a[236:239], v[236:239], v[156:159], a[236:239]
s_waitcnt lgkmcnt(4)
v_cvt_pk_bf16_f32 v24, v192, v193
v_mfma_f32_16x16x32_bf16 a[224:227], v[240:243], v[160:163], a[224:227]
ds_read_b64_tr_b16 v[232:233], v250 offset:45568
v_cvt_pk_bf16_f32 v25, v194, v195
v_mfma_f32_16x16x32_bf16 a[224:227], v[244:247], v[176:179], a[224:227]
v_accvgpr_read_b32 v200, a196
v_accvgpr_read_b32 v201, a197
v_mfma_f32_16x16x32_bf16 a[228:231], v[240:243], v[164:167], a[228:231]
ds_read_b64_tr_b16 v[234:235], v250 offset:47616
v_accvgpr_read_b32 v202, a198
v_mfma_f32_16x16x32_bf16 a[228:231], v[244:247], v[180:183], a[228:231]
v_accvgpr_read_b32 v203, a199
v_cvt_pk_bf16_f32 v56, v200, v201
v_mfma_f32_16x16x32_bf16 a[232:235], v[240:243], v[168:171], a[232:235]
ds_read_b64_tr_b16 v[236:237], v250 offset:61952
v_cvt_pk_bf16_f32 v57, v202, v203
v_mfma_f32_16x16x32_bf16 a[232:235], v[244:247], v[184:187], a[232:235]
v_accvgpr_read_b32 v208, a200
v_accvgpr_read_b32 v209, a201
v_mfma_f32_16x16x32_bf16 a[236:239], v[240:243], v[172:175], a[236:239]
ds_read_b64_tr_b16 v[238:239], v250 offset:64000
v_accvgpr_read_b32 v210, a202
v_mfma_f32_16x16x32_bf16 a[236:239], v[244:247], v[188:191], a[236:239]
s_waitcnt lgkmcnt(4)
v_accvgpr_read_b32 v211, a203
v_mfma_f32_16x16x32_bf16 a[240:243], v[224:227], v[128:131], a[240:243]
ds_read_b64_tr_b16 v[240:241], v12 offset:12800
v_cvt_pk_bf16_f32 v88, v208, v209
v_mfma_f32_16x16x32_bf16 a[240:243], v[228:231], v[144:147], a[240:243]
v_cvt_pk_bf16_f32 v89, v210, v211
v_accvgpr_read_b32 v216, a204
v_mfma_f32_16x16x32_bf16 a[244:247], v[224:227], v[132:135], a[244:247]
ds_read_b64_tr_b16 v[242:243], v12 offset:14848
v_accvgpr_read_b32 v217, a205
v_mfma_f32_16x16x32_bf16 a[244:247], v[228:231], v[148:151], a[244:247]
v_accvgpr_read_b32 v218, a206
v_accvgpr_read_b32 v219, a207
v_mfma_f32_16x16x32_bf16 a[248:251], v[224:227], v[136:139], a[248:251]
ds_read_b64_tr_b16 v[244:245], v13 offset:12800
v_cvt_pk_bf16_f32 v120, v216, v217
v_mfma_f32_16x16x32_bf16 a[248:251], v[228:231], v[152:155], a[248:251]
v_cvt_pk_bf16_f32 v121, v218, v219
v_accvgpr_read_b32 v196, a208
v_mfma_f32_16x16x32_bf16 a[252:255], v[224:227], v[140:143], a[252:255]
ds_read_b64_tr_b16 v[246:247], v13 offset:14848
v_accvgpr_read_b32 v197, a209
v_mfma_f32_16x16x32_bf16 a[252:255], v[228:231], v[156:159], a[252:255]
s_waitcnt lgkmcnt(4)
v_accvgpr_read_b32 v198, a210
v_mfma_f32_16x16x32_bf16 a[240:243], v[232:235], v[160:163], a[240:243]
v_accvgpr_read_b32 v199, a211
v_cvt_pk_bf16_f32 v26, v196, v197
v_mfma_f32_16x16x32_bf16 a[240:243], v[236:239], v[176:179], a[240:243]
v_cvt_pk_bf16_f32 v27, v198, v199
buffer_store_dwordx4 v[24:27], v252, s[20:23], s44 offen offset:2048 sc1
v_mfma_f32_16x16x32_bf16 a[244:247], v[232:235], v[164:167], a[244:247]
v_accvgpr_read_b32 v204, a212
v_accvgpr_read_b32 v205, a213
v_mfma_f32_16x16x32_bf16 a[244:247], v[236:239], v[180:183], a[244:247]
v_accvgpr_read_b32 v206, a214
v_accvgpr_read_b32 v207, a215
v_mfma_f32_16x16x32_bf16 a[248:251], v[232:235], v[168:171], a[248:251]
v_cvt_pk_bf16_f32 v58, v204, v205
v_cvt_pk_bf16_f32 v59, v206, v207
v_mfma_f32_16x16x32_bf16 a[248:251], v[236:239], v[184:187], a[248:251]
buffer_store_dwordx4 v[56:59], v252, s[20:23], s45 offen offset:2048 sc1
v_accvgpr_read_b32 v212, a216
v_mfma_f32_16x16x32_bf16 a[252:255], v[232:235], v[172:175], a[252:255]
v_accvgpr_read_b32 v213, a217
v_accvgpr_read_b32 v214, a218
v_mfma_f32_16x16x32_bf16 a[252:255], v[236:239], v[188:191], a[252:255]
s_waitcnt lgkmcnt(0)
v_accvgpr_read_b32 v215, a219
v_mfma_f32_16x16x32_bf16 a[224:227], v[240:243], v[0:3], a[224:227]
v_cvt_pk_bf16_f32 v90, v212, v213
v_cvt_pk_bf16_f32 v91, v214, v215
v_mfma_f32_16x16x32_bf16 a[228:231], v[240:243], v[32:35], a[228:231]
buffer_store_dwordx4 v[88:91], v252, s[20:23], s46 offen offset:2048 sc1
v_accvgpr_read_b32 v220, a220
v_mfma_f32_16x16x32_bf16 a[232:235], v[240:243], v[64:67], a[232:235]
v_accvgpr_read_b32 v221, a221
v_accvgpr_read_b32 v222, a222
v_mfma_f32_16x16x32_bf16 a[236:239], v[240:243], v[96:99], a[236:239]
v_accvgpr_read_b32 v223, a223
v_cvt_pk_bf16_f32 v122, v220, v221
v_mfma_f32_16x16x32_bf16 a[240:243], v[244:247], v[0:3], a[240:243]
v_cvt_pk_bf16_f32 v123, v222, v223
buffer_store_dwordx4 v[120:123], v252, s[20:23], s47 offen offset:2048 sc1
v_mfma_f32_16x16x32_bf16 a[244:247], v[244:247], v[32:35], a[244:247]
v_mfma_f32_16x16x32_bf16 a[248:251], v[244:247], v[64:67], a[248:251]
v_mfma_f32_16x16x32_bf16 a[252:255], v[244:247], v[96:99], a[252:255]
v_accvgpr_read_b32 v192, a224
v_accvgpr_read_b32 v193, a225
v_accvgpr_read_b32 v194, a226
v_accvgpr_read_b32 v195, a227
v_cvt_pk_bf16_f32 v28, v192, v193
v_cvt_pk_bf16_f32 v29, v194, v195
v_accvgpr_read_b32 v200, a228
v_accvgpr_read_b32 v201, a229
v_accvgpr_read_b32 v202, a230
v_accvgpr_read_b32 v203, a231
v_cvt_pk_bf16_f32 v60, v200, v201
v_cvt_pk_bf16_f32 v61, v202, v203
v_accvgpr_read_b32 v208, a232
v_accvgpr_read_b32 v209, a233
v_accvgpr_read_b32 v210, a234
v_accvgpr_read_b32 v211, a235
v_cvt_pk_bf16_f32 v92, v208, v209
v_cvt_pk_bf16_f32 v93, v210, v211
v_accvgpr_read_b32 v216, a236
v_accvgpr_read_b32 v217, a237
v_accvgpr_read_b32 v218, a238
v_accvgpr_read_b32 v219, a239
v_cvt_pk_bf16_f32 v124, v216, v217
v_cvt_pk_bf16_f32 v125, v218, v219
s_nop 7
v_accvgpr_read_b32 v196, a240
v_accvgpr_read_b32 v197, a241
v_accvgpr_read_b32 v198, a242
v_accvgpr_read_b32 v199, a243
v_cvt_pk_bf16_f32 v30, v196, v197
v_cvt_pk_bf16_f32 v31, v198, v199
buffer_store_dwordx4 v[28:31], v252, s[20:23], s44 offen offset:3072 sc1
v_accvgpr_read_b32 v204, a244
v_accvgpr_read_b32 v205, a245
v_accvgpr_read_b32 v206, a246
v_accvgpr_read_b32 v207, a247
v_cvt_pk_bf16_f32 v62, v204, v205
v_cvt_pk_bf16_f32 v63, v206, v207
buffer_store_dwordx4 v[60:63], v252, s[20:23], s45 offen offset:3072 sc1
v_accvgpr_read_b32 v212, a248
v_accvgpr_read_b32 v213, a249
v_accvgpr_read_b32 v214, a250
v_accvgpr_read_b32 v215, a251
v_cvt_pk_bf16_f32 v94, v212, v213
v_cvt_pk_bf16_f32 v95, v214, v215
buffer_store_dwordx4 v[92:95], v252, s[20:23], s46 offen offset:3072 sc1
v_accvgpr_read_b32 v220, a252
v_accvgpr_read_b32 v221, a253
v_accvgpr_read_b32 v222, a254
v_accvgpr_read_b32 v223, a255
v_cvt_pk_bf16_f32 v126, v220, v221
v_cvt_pk_bf16_f32 v127, v222, v223
buffer_store_dwordx4 v[124:127], v252, s[20:23], s47 offen offset:3072 sc1
s_branch L2_chk
L2_chk:
s_or_b64 vcc, vcc, s[50:51]
s_barrier
s_cbranch_vccz L2_fin
s_waitcnt vmcnt(0)
v_bfe_u32 v248, v252, 4, 3
v_lshlrev_b32 v248, 6, v248
v_bfe_u32 v253, v252, 7, 1
v_lshl_or_b32 v248, v253, 10, v248
v_bfe_u32 v253, v252, 8, 2
v_lshl_or_b32 v248, v253, 4, v248
v_bfe_u32 v253, v252, 6, 1
v_lshlrev_b32 v253, 5, v253
v_xor_b32 v248, v248, v253
v_and_b32 v249, 0x1c0, v252
v_bfe_u32 v253, v252, 9, 1
v_lshl_or_b32 v249, v253, 10, v249
v_bfe_u32 v253, v252, 8, 1
v_lshl_or_b32 v249, v253, 5, v249
v_bfe_u32 v253, v252, 4, 2
v_lshl_or_b32 v249, v253, 3, v249
v_xor_b32 v250, 32, v249
v_and_b32 v251, 0xfffffe7f, v251
s_mul_i32 s36, s34, 0xa000
s_mov_b32 s56, s36
s_add_u32 s57, s56, 32768
s_mov_b32 s55, 4
v_bfe_i32 v188, v252, 8, 1
LS_q:
s_add_u32 s44, s40, 4096
buffer_load_dwordx4 v[0:3], v252, s[8:11], s40 offen offset:0
buffer_load_dwordx4 v[4:7], v252, s[8:11], s40 offen offset:1024
buffer_load_dwordx4 v[8:11], v252, s[8:11], s40 offen offset:2048
buffer_load_dwordx4 v[12:15], v252, s[8:11], s40 offen offset:3072
buffer_load_dwordx4 v[16:19], v252, s[8:11], s44 offen offset:0
buffer_load_dwordx4 v[20:23], v252, s[8:11], s44 offen offset:1024
buffer_load_dwordx4 v[24:27], v252, s[8:11], s44 offen offset:2048
buffer_load_dwordx4 v[28:31], v252, s[8:11], s44 offen offset:3072
s_mov_b32 s53, s56
s_mov_b32 s58, s39
s_add_u32 m0, s53, 0
s_add_u32 s54, s58, 0
buffer_load_dwordx4 v251, s[12:15], s54 offen offset:0 lds
buffer_load_dwordx4 v251, s[12:15], s54 offen offset:1024 lds
buffer_load_dwordx4 v251, s[12:15], s54 offen offset:2048 lds
buffer_load_dwordx4 v251, s[12:15], s54 offen offset:3072 lds
s_add_u32 m0, s53, 4096
s_add_u32 s54, s58, 128
buffer_load_dwordx4 v251, s[12:15], s54 offen offset:0 lds
buffer_load_dwordx4 v251, s[12:15], s54 offen offset:1024 lds
buffer_load_dwordx4 v251, s[12:15], s54 offen offset:2048 lds
buffer_load_dwordx4 v251, s[12:15], s54 offen offset:3072 lds
s_add_u32 m0, s53, 8192
s_add_u32 s54, s58, 256
buffer_load_dwordx4 v251, s[12:15], s54 offen offset:0 lds
buffer_load_dwordx4 v251, s[12:15], s54 offen offset:1024 lds
buffer_load_dwordx4 v251, s[12:15], s54 offen offset:2048 lds
buffer_load_dwordx4 v251, s[12:15], s54 offen offset:3072 lds
s_add_u32 m0, s53, 12288
s_add_u32 s54, s58, 384
buffer_load_dwordx4 v251, s[12:15], s54 offen offset:0 lds
buffer_load_dwordx4 v251, s[12:15], s54 offen offset:1024 lds
buffer_load_dwordx4 v251, s[12:15], s54 offen offset:2048 lds
buffer_load_dwordx4 v251, s[12:15], s54 offen offset:3072 lds
s_add_u32 s53, s53, 0x4000
s_cmp_eq_u32 s53, s57
s_cselect_b32 s53, s56, s53
s_add_u32 s58, s58, 0x4000
s_mov_b32 s51, s29
s_mov_b32 s52, s56
v_mov_b32 v172, 0xff800000
v_accvgpr_write_b32 a0, 0
v_accvgpr_write_b32 a1, 0
v_accvgpr_write_b32 a2, 0
v_accvgpr_write_b32 a3, 0
v_accvgpr_write_b32 a4, 0
v_accvgpr_write_b32 a5, 0
v_accvgpr_write_b32 a6, 0
v_accvgpr_write_b32 a7, 0
v_accvgpr_write_b32 a8, 0
v_accvgpr_write_b32 a9, 0
v_accvgpr_write_b32 a10, 0
v_accvgpr_write_b32 a11, 0
v_accvgpr_write_b32 a12, 0
v_accvgpr_write_b32 a13, 0
v_accvgpr_write_b32 a14, 0
v_accvgpr_write_b32 a15, 0
v_accvgpr_write_b32 a16, 0
v_accvgpr_write_b32 a17, 0
v_accvgpr_write_b32 a18, 0
v_accvgpr_write_b32 a19, 0
v_accvgpr_write_b32 a20, 0
v_accvgpr_write_b32 a21, 0
v_accvgpr_write_b32 a22, 0
v_accvgpr_write_b32 a23, 0
v_accvgpr_write_b32 a24, 0
v_accvgpr_write_b32 a25, 0
v_accvgpr_write_b32 a26, 0
v_accvgpr_write_b32 a27, 0
v_accvgpr_write_b32 a28, 0
v_accvgpr_write_b32 a29, 0
v_accvgpr_write_b32 a30, 0
v_accvgpr_write_b32 a31, 0
v_accvgpr_write_b32 a32, 0
v_accvgpr_write_b32 a33, 0
v_accvgpr_write_b32 a34, 0
v_accvgpr_write_b32 a35, 0
v_accvgpr_write_b32 a36, 0
v_accvgpr_write_b32 a37, 0
v_accvgpr_write_b32 a38, 0
v_accvgpr_write_b32 a39, 0
v_accvgpr_write_b32 a40, 0
v_accvgpr_write_b32 a41, 0
v_accvgpr_write_b32 a42, 0
v_accvgpr_write_b32 a43, 0
v_accvgpr_write_b32 a44, 0
v_accvgpr_write_b32 a45, 0
v_accvgpr_write_b32 a46, 0
v_accvgpr_write_b32 a47, 0
v_accvgpr_write_b32 a48, 0
v_accvgpr_write_b32 a49, 0
v_accvgpr_write_b32 a50, 0
v_accvgpr_write_b32 a51, 0
v_accvgpr_write_b32 a52, 0
v_accvgpr_write_b32 a53, 0
v_accvgpr_write_b32 a54, 0
v_accvgpr_write_b32 a55, 0
v_accvgpr_write_b32 a56, 0
v_accvgpr_write_b32 a57, 0
v_accvgpr_write_b32 a58, 0
v_accvgpr_write_b32 a59, 0
v_accvgpr_write_b32 a60, 0
v_accvgpr_write_b32 a61, 0
v_accvgpr_write_b32 a62, 0
v_accvgpr_write_b32 a63, 0
LS_loop:
s_add_u32 m0, s53, 0
s_add_u32 s54, s58, 0
buffer_load_dwordx4 v251, s[12:15], s54 offen offset:0 lds
buffer_load_dwordx4 v251, s[12:15], s54 offen offset:1024 lds
buffer_load_dwordx4 v251, s[12:15], s54 offen offset:2048 lds
buffer_load_dwordx4 v251, s[12:15], s54 offen offset:3072 lds
s_add_u32 m0, s53, 4096
s_add_u32 s54, s58, 128
buffer_load_dwordx4 v251, s[12:15], s54 offen offset:0 lds
buffer_load_dwordx4 v251, s[12:15], s54 offen offset:1024 lds
buffer_load_dwordx4 v251, s[12:15], s54 offen offset:2048 lds
buffer_load_dwordx4 v251, s[12:15], s54 offen offset:3072 lds
s_add_u32 m0, s53, 8192
s_add_u32 s54, s58, 256
buffer_load_dwordx4 v251, s[12:15], s54 offen offset:0 lds
buffer_load_dwordx4 v251, s[12:15], s54 offen offset:1024 lds
buffer_load_dwordx4 v251, s[12:15], s54 offen offset:2048 lds
buffer_load_dwordx4 v251, s[12:15], s54 offen offset:3072 lds
s_add_u32 m0, s53, 12288
s_add_u32 s54, s58, 384
buffer_load_dwordx4 v251, s[12:15], s54 offen offset:0 lds
buffer_load_dwordx4 v251, s[12:15], s54 offen offset:1024 lds
buffer_load_dwordx4 v251, s[12:15], s54 offen offset:2048 lds
buffer_load_dwordx4 v251, s[12:15], s54 offen offset:3072 lds
s_add_u32 s53, s53, 0x4000
s_cmp_eq_u32 s53, s57
s_cselect_b32 s53, s56, s53
s_add_u32 s58, s58, 0x4000
v_add_u32 v177, s52, v248
v_add_u32 v178, s52, v249
v_add_u32 v179, s52, v250
s_add_u32 s52, s52, 0x4000
s_cmp_eq_u32 s52, s57
s_cselect_b32 s52, s56, s52
s_cmp_eq_u32 s51, 1
s_cselect_b32 s54, s33, 0
v_and_b32 v192, s54, v188
v_and_b32 v193, s54, v188
v_and_b32 v194, s54, v188
v_and_b32 v195, s54, v188
s_waitcnt vmcnt(16)
ds_read_b128 v[32:35], v177 offset:0
ds_read_b128 v[64:67], v177 offset:2048
ds_read_b128 v[36:39], v177 offset:512
ds_read_b128 v[68:71], v177 offset:2560
ds_read_b128 v[40:43], v177 offset:4096
ds_read_b128 v[72:75], v177 offset:6144
ds_read_b128 v[44:47], v177 offset:4608
ds_read_b128 v[76:79], v177 offset:6656
ds_read_b128 v[48:51], v177 offset:8192
ds_read_b128 v[80:83], v177 offset:10240
ds_read_b128 v[52:55], v177 offset:8704
ds_read_b128 v[84:87], v177 offset:10752
ds_read_b128 v[56:59], v177 offset:12288
ds_read_b128 v[88:91], v177 offset:14336
ds_read_b128 v[60:63], v177 offset:12800
ds_read_b128 v[92:95], v177 offset:14848
s_waitcnt lgkmcnt(14)
v_mfma_f32_16x16x32_bf16 v[160:163], v[32:35], v[0:3], v[192:195]
v_mfma_f32_16x16x32_bf16 v[164:167], v[64:67], v[0:3], v[192:195]
s_waitcnt lgkmcnt(12)
v_mfma_f32_16x16x32_bf16 v[160:163], v[36:39], v[4:7], v[160:163]
v_mfma_f32_16x16x32_bf16 v[164:167], v[68:71], v[4:7], v[164:167]
s_waitcnt lgkmcnt(10)
v_mfma_f32_16x16x32_bf16 v[160:163], v[40:43], v[8:11], v[160:163]
v_mfma_f32_16x16x32_bf16 v[164:167], v[72:75], v[8:11], v[164:167]
s_waitcnt lgkmcnt(8)
v_mfma_f32_16x16x32_bf16 v[160:163], v[44:47], v[12:15], v[160:163]
v_mfma_f32_16x16x32_bf16 v[164:167], v[76:79], v[12:15], v[164:167]
s_waitcnt lgkmcnt(6)
v_mfma_f32_16x16x32_bf16 v[160:163], v[48:51], v[16:19], v[160:163]
v_mfma_f32_16x16x32_bf16 v[164:167], v[80:83], v[16:19], v[164:167]
s_waitcnt lgkmcnt(4)
v_mfma_f32_16x16x32_bf16 v[160:163], v[52:55], v[20:23], v[160:163]
v_mfma_f32_16x16x32_bf16 v[164:167], v[84:87], v[20:23], v[164:167]
s_waitcnt lgkmcnt(2)
v_mfma_f32_16x16x32_bf16 v[160:163], v[56:59], v[24:27], v[160:163]
v_mfma_f32_16x16x32_bf16 v[164:167], v[88:91], v[24:27], v[164:167]
s_waitcnt lgkmcnt(0)
v_mfma_f32_16x16x32_bf16 v[160:163], v[60:63], v[28:31], v[160:163]
v_mfma_f32_16x16x32_bf16 v[164:167], v[92:95], v[28:31], v[164:167]
ds_read_b64_tr_b16 v[96:97], v178 offset:0
ds_read_b64_tr_b16 v[98:99], v178 offset:2048
ds_read_b64_tr_b16 v[100:101], v179 offset:0
ds_read_b64_tr_b16 v[102:103], v179 offset:2048
ds_read_b64_tr_b16 v[104:105], v178 offset:512
ds_read_b64_tr_b16 v[106:107], v178 offset:2560
ds_read_b64_tr_b16 v[108:109], v179 offset:512
ds_read_b64_tr_b16 v[110:111], v179 offset:2560
ds_read_b64_tr_b16 v[112:113], v178 offset:4096
ds_read_b64_tr_b16 v[114:115], v178 offset:6144
ds_read_b64_tr_b16 v[116:117], v179 offset:4096
ds_read_b64_tr_b16 v[118:119], v179 offset:6144
ds_read_b64_tr_b16 v[120:121], v178 offset:4608
ds_read_b64_tr_b16 v[122:123], v178 offset:6656
ds_read_b64_tr_b16 v[124:125], v179 offset:4608
ds_read_b64_tr_b16 v[126:127], v179 offset:6656
ds_read_b64_tr_b16 v[128:129], v178 offset:8192
ds_read_b64_tr_b16 v[130:131], v178 offset:10240
ds_read_b64_tr_b16 v[132:133], v179 offset:8192
ds_read_b64_tr_b16 v[134:135], v179 offset:10240
ds_read_b64_tr_b16 v[136:137], v178 offset:8704
ds_read_b64_tr_b16 v[138:139], v178 offset:10752
ds_read_b64_tr_b16 v[140:141], v179 offset:8704
ds_read_b64_tr_b16 v[142:143], v179 offset:10752
ds_read_b64_tr_b16 v[144:145], v178 offset:12288
ds_read_b64_tr_b16 v[146:147], v178 offset:14336
ds_read_b64_tr_b16 v[148:149], v179 offset:12288
ds_read_b64_tr_b16 v[150:151], v179 offset:14336
ds_read_b64_tr_b16 v[152:153], v178 offset:12800
ds_read_b64_tr_b16 v[154:155], v178 offset:14848
ds_read_b64_tr_b16 v[156:157], v179 offset:12800
ds_read_b64_tr_b16 v[158:159], v179 offset:14848
s_nop 7
v_max3_f32 v175, v160, v161, v162
v_max3_f32 v175, v175, v163, v164
v_max3_f32 v175, v175, v165, v166
v_max3_f32 v175, v175, v167, v172
v_mov_b32 v176, v175
s_nop 1
v_permlane32_swap_b32 v175, v176
s_nop 1
v_max_f32 v175, v175, v176
v_mov_b32 v176, v175
s_nop 1
v_permlane16_swap_b32 v175, v176
s_nop 1
v_max_f32 v175, v175, v176
v_sub_f32 v174, v172, v175
v_exp_f32 v174, v174
v_mov_b32 v172, v175
v_sub_f32 v160, v160, v172
v_sub_f32 v161, v161, v172
v_sub_f32 v162, v162, v172
v_sub_f32 v163, v163, v172
v_sub_f32 v164, v164, v172
v_sub_f32 v165, v165, v172
v_sub_f32 v166, v166, v172
v_sub_f32 v167, v167, v172
v_exp_f32 v160, v160
v_exp_f32 v161, v161
v_exp_f32 v162, v162
v_exp_f32 v163, v163
v_exp_f32 v164, v164
v_exp_f32 v165, v165
v_exp_f32 v166, v166
v_exp_f32 v167, v167
v_cmp_neq_f32 vcc, 1.0, v174
v_cvt_pk_bf16_f32 v168, v160, v161
v_cvt_pk_bf16_f32 v169, v162, v163
v_cvt_pk_bf16_f32 v170, v164, v165
v_cvt_pk_bf16_f32 v171, v166, v167
s_cbranch_vccz LS_nors
v_accvgpr_read_b32 v180, a0
v_accvgpr_read_b32 v181, a1
v_accvgpr_read_b32 v182, a2
v_accvgpr_read_b32 v183, a3
v_accvgpr_read_b32 v184, a4
v_accvgpr_read_b32 v185, a5
v_accvgpr_read_b32 v186, a6
v_accvgpr_read_b32 v187, a7
v_mul_f32 v180, v180, v174
v_mul_f32 v181, v181, v174
v_mul_f32 v182, v182, v174
v_mul_f32 v183, v183, v174
v_mul_f32 v184, v184, v174
v_mul_f32 v185, v185, v174
v_mul_f32 v186, v186, v174
v_mul_f32 v187, v187, v174
v_accvgpr_write_b32 a0, v180
v_accvgpr_write_b32 a1, v181
v_accvgpr_write_b32 a2, v182
v_accvgpr_write_b32 a3, v183
v_accvgpr_write_b32 a4, v184
v_accvgpr_write_b32 a5, v185
v_accvgpr_write_b32 a6, v186
v_accvgpr_write_b32 a7, v187
v_accvgpr_read_b32 v180, a8
v_accvgpr_read_b32 v181, a9
v_accvgpr_read_b32 v182, a10
v_accvgpr_read_b32 v183, a11
v_accvgpr_read_b32 v184, a12
v_accvgpr_read_b32 v185, a13
v_accvgpr_read_b32 v186, a14
v_accvgpr_read_b32 v187, a15
v_mul_f32 v180, v180, v174
v_mul_f32 v181, v181, v174
v_mul_f32 v182, v182, v174
v_mul_f32 v183, v183, v174
v_mul_f32 v184, v184, v174
v_mul_f32 v185, v185, v174
v_mul_f32 v186, v186, v174
v_mul_f32 v187, v187, v174
v_accvgpr_write_b32 a8, v180
v_accvgpr_write_b32 a9, v181
v_accvgpr_write_b32 a10, v182
v_accvgpr_write_b32 a11, v183
v_accvgpr_write_b32 a12, v184
v_accvgpr_write_b32 a13, v185
v_accvgpr_write_b32 a14, v186
v_accvgpr_write_b32 a15, v187
v_accvgpr_read_b32 v180, a16
v_accvgpr_read_b32 v181, a17
v_accvgpr_read_b32 v182, a18
v_accvgpr_read_b32 v183, a19
v_accvgpr_read_b32 v184, a20
v_accvgpr_read_b32 v185, a21
v_accvgpr_read_b32 v186, a22
v_accvgpr_read_b32 v187, a23
v_mul_f32 v180, v180, v174
v_mul_f32 v181, v181, v174
v_mul_f32 v182, v182, v174
v_mul_f32 v183, v183, v174
v_mul_f32 v184, v184, v174
v_mul_f32 v185, v185, v174
v_mul_f32 v186, v186, v174
v_mul_f32 v187, v187, v174
v_accvgpr_write_b32 a16, v180
v_accvgpr_write_b32 a17, v181
v_accvgpr_write_b32 a18, v182
v_accvgpr_write_b32 a19, v183
v_accvgpr_write_b32 a20, v184
v_accvgpr_write_b32 a21, v185
v_accvgpr_write_b32 a22, v186
v_accvgpr_write_b32 a23, v187
v_accvgpr_read_b32 v180, a24
v_accvgpr_read_b32 v181, a25
v_accvgpr_read_b32 v182, a26
v_accvgpr_read_b32 v183, a27
v_accvgpr_read_b32 v184, a28
v_accvgpr_read_b32 v185, a29
v_accvgpr_read_b32 v186, a30
v_accvgpr_read_b32 v187, a31
v_mul_f32 v180, v180, v174
v_mul_f32 v181, v181, v174
v_mul_f32 v182, v182, v174
v_mul_f32 v183, v183, v174
v_mul_f32 v184, v184, v174
v_mul_f32 v185, v185, v174
v_mul_f32 v186, v186, v174
v_mul_f32 v187, v187, v174
v_accvgpr_write_b32 a24, v180
v_accvgpr_write_b32 a25, v181
v_accvgpr_write_b32 a26, v182
v_accvgpr_write_b32 a27, v183
v_accvgpr_write_b32 a28, v184
v_accvgpr_write_b32 a29, v185
v_accvgpr_write_b32 a30, v186
v_accvgpr_write_b32 a31, v187
v_accvgpr_read_b32 v180, a32
v_accvgpr_read_b32 v181, a33
v_accvgpr_read_b32 v182, a34
v_accvgpr_read_b32 v183, a35
v_accvgpr_read_b32 v184, a36
v_accvgpr_read_b32 v185, a37
v_accvgpr_read_b32 v186, a38
v_accvgpr_read_b32 v187, a39
v_mul_f32 v180, v180, v174
v_mul_f32 v181, v181, v174
v_mul_f32 v182, v182, v174
v_mul_f32 v183, v183, v174
v_mul_f32 v184, v184, v174
v_mul_f32 v185, v185, v174
v_mul_f32 v186, v186, v174
v_mul_f32 v187, v187, v174
v_accvgpr_write_b32 a32, v180
v_accvgpr_write_b32 a33, v181
v_accvgpr_write_b32 a34, v182
v_accvgpr_write_b32 a35, v183
v_accvgpr_write_b32 a36, v184
v_accvgpr_write_b32 a37, v185
v_accvgpr_write_b32 a38, v186
v_accvgpr_write_b32 a39, v187
v_accvgpr_read_b32 v180, a40
v_accvgpr_read_b32 v181, a41
v_accvgpr_read_b32 v182, a42
v_accvgpr_read_b32 v183, a43
v_accvgpr_read_b32 v184, a44
v_accvgpr_read_b32 v185, a45
v_accvgpr_read_b32 v186, a46
v_accvgpr_read_b32 v187, a47
v_mul_f32 v180, v180, v174
v_mul_f32 v181, v181, v174
v_mul_f32 v182, v182, v174
v_mul_f32 v183, v183, v174
v_mul_f32 v184, v184, v174
v_mul_f32 v185, v185, v174
v_mul_f32 v186, v186, v174
v_mul_f32 v187, v187, v174
v_accvgpr_write_b32 a40, v180
v_accvgpr_write_b32 a41, v181
v_accvgpr_write_b32 a42, v182
v_accvgpr_write_b32 a43, v183
v_accvgpr_write_b32 a44, v184
v_accvgpr_write_b32 a45, v185
v_accvgpr_write_b32 a46, v186
v_accvgpr_write_b32 a47, v187
v_accvgpr_read_b32 v180, a48
v_accvgpr_read_b32 v181, a49
v_accvgpr_read_b32 v182, a50
v_accvgpr_read_b32 v183, a51
v_accvgpr_read_b32 v184, a52
v_accvgpr_read_b32 v185, a53
v_accvgpr_read_b32 v186, a54
v_accvgpr_read_b32 v187, a55
v_mul_f32 v180, v180, v174
v_mul_f32 v181, v181, v174
v_mul_f32 v182, v182, v174
v_mul_f32 v183, v183, v174
v_mul_f32 v184, v184, v174
v_mul_f32 v185, v185, v174
v_mul_f32 v186, v186, v174
v_mul_f32 v187, v187, v174
v_accvgpr_write_b32 a48, v180
v_accvgpr_write_b32 a49, v181
v_accvgpr_write_b32 a50, v182
v_accvgpr_write_b32 a51, v183
v_accvgpr_write_b32 a52, v184
v_accvgpr_write_b32 a53, v185
v_accvgpr_write_b32 a54, v186
v_accvgpr_write_b32 a55, v187
v_accvgpr_read_b32 v180, a56
v_accvgpr_read_b32 v181, a57
v_accvgpr_read_b32 v182, a58
v_accvgpr_read_b32 v183, a59
v_accvgpr_read_b32 v184, a60
v_accvgpr_read_b32 v185, a61
v_accvgpr_read_b32 v186, a62
v_accvgpr_read_b32 v187, a63
v_mul_f32 v180, v180, v174
v_mul_f32 v181, v181, v174
v_mul_f32 v182, v182, v174
v_mul_f32 v183, v183, v174
v_mul_f32 v184, v184, v174
v_mul_f32 v185, v185, v174
v_mul_f32 v186, v186, v174
v_mul_f32 v187, v187, v174
v_accvgpr_write_b32 a56, v180
v_accvgpr_write_b32 a57, v181
v_accvgpr_write_b32 a58, v182
v_accvgpr_write_b32 a59, v183
v_accvgpr_write_b32 a60, v184
v_accvgpr_write_b32 a61, v185
v_accvgpr_write_b32 a62, v186
v_accvgpr_write_b32 a63, v187
LS_nors:
s_waitcnt lgkmcnt(0)
s_nop 1
v_mfma_f32_16x16x32_bf16 a[0:3], v[96:99], v[168:171], a[0:3]
v_mfma_f32_16x16x32_bf16 a[4:7], v[100:103], v[168:171], a[4:7]
v_mfma_f32_16x16x32_bf16 a[8:11], v[104:107], v[168:171], a[8:11]
v_mfma_f32_16x16x32_bf16 a[12:15], v[108:111], v[168:171], a[12:15]
v_mfma_f32_16x16x32_bf16 a[16:19], v[112:115], v[168:171], a[16:19]
v_mfma_f32_16x16x32_bf16 a[20:23], v[116:119], v[168:171], a[20:23]
v_mfma_f32_16x16x32_bf16 a[24:27], v[120:123], v[168:171], a[24:27]
v_mfma_f32_16x16x32_bf16 a[28:31], v[124:127], v[168:171], a[28:31]
v_mfma_f32_16x16x32_bf16 a[32:35], v[128:131], v[168:171], a[32:35]
v_mfma_f32_16x16x32_bf16 a[36:39], v[132:135], v[168:171], a[36:39]
v_mfma_f32_16x16x32_bf16 a[40:43], v[136:139], v[168:171], a[40:43]
v_mfma_f32_16x16x32_bf16 a[44:47], v[140:143], v[168:171], a[44:47]
v_mfma_f32_16x16x32_bf16 a[48:51], v[144:147], v[168:171], a[48:51]
v_mfma_f32_16x16x32_bf16 a[52:55], v[148:151], v[168:171], a[52:55]
v_mfma_f32_16x16x32_bf16 a[56:59], v[152:155], v[168:171], a[56:59]
v_mfma_f32_16x16x32_bf16 a[60:63], v[156:159], v[168:171], a[60:63]
s_sub_u32 s51, s51, 1
s_cmp_lg_u32 s51, 0
s_cbranch_scc1 LS_loop
s_nop 15
v_accvgpr_read_b32 v173, a0
v_accvgpr_read_b32 v180, a0
v_accvgpr_read_b32 v181, a1
v_accvgpr_read_b32 v182, a2
v_accvgpr_read_b32 v183, a3
v_accvgpr_read_b32 v184, a4
v_accvgpr_read_b32 v185, a5
v_accvgpr_read_b32 v186, a6
v_accvgpr_read_b32 v187, a7
v_cvt_pk_bf16_f32 v32, v180, v181
v_cvt_pk_bf16_f32 v33, v182, v183
v_cvt_pk_bf16_f32 v34, v184, v185
v_cvt_pk_bf16_f32 v35, v186, v187
buffer_store_dwordx4 v[32:35], v252, s[20:23], s40 offen offset:0 sc1
v_accvgpr_read_b32 v180, a8
v_accvgpr_read_b32 v181, a9
v_accvgpr_read_b32 v182, a10
v_accvgpr_read_b32 v183, a11
v_accvgpr_read_b32 v184, a12
v_accvgpr_read_b32 v185, a13
v_accvgpr_read_b32 v186, a14
v_accvgpr_read_b32 v187, a15
v_cvt_pk_bf16_f32 v36, v180, v181
v_cvt_pk_bf16_f32 v37, v182, v183
v_cvt_pk_bf16_f32 v38, v184, v185
v_cvt_pk_bf16_f32 v39, v186, v187
buffer_store_dwordx4 v[36:39], v252, s[20:23], s40 offen offset:1024 sc1
v_accvgpr_read_b32 v180, a16
v_accvgpr_read_b32 v181, a17
v_accvgpr_read_b32 v182, a18
v_accvgpr_read_b32 v183, a19
v_accvgpr_read_b32 v184, a20
v_accvgpr_read_b32 v185, a21
v_accvgpr_read_b32 v186, a22
v_accvgpr_read_b32 v187, a23
v_cvt_pk_bf16_f32 v40, v180, v181
v_cvt_pk_bf16_f32 v41, v182, v183
v_cvt_pk_bf16_f32 v42, v184, v185
v_cvt_pk_bf16_f32 v43, v186, v187
buffer_store_dwordx4 v[40:43], v252, s[20:23], s40 offen offset:2048 sc1
v_accvgpr_read_b32 v180, a24
v_accvgpr_read_b32 v181, a25
v_accvgpr_read_b32 v182, a26
v_accvgpr_read_b32 v183, a27
v_accvgpr_read_b32 v184, a28
v_accvgpr_read_b32 v185, a29
v_accvgpr_read_b32 v186, a30
v_accvgpr_read_b32 v187, a31
v_cvt_pk_bf16_f32 v44, v180, v181
v_cvt_pk_bf16_f32 v45, v182, v183
v_cvt_pk_bf16_f32 v46, v184, v185
v_cvt_pk_bf16_f32 v47, v186, v187
buffer_store_dwordx4 v[44:47], v252, s[20:23], s40 offen offset:3072 sc1
v_accvgpr_read_b32 v180, a32
v_accvgpr_read_b32 v181, a33
v_accvgpr_read_b32 v182, a34
v_accvgpr_read_b32 v183, a35
v_accvgpr_read_b32 v184, a36
v_accvgpr_read_b32 v185, a37
v_accvgpr_read_b32 v186, a38
v_accvgpr_read_b32 v187, a39
v_cvt_pk_bf16_f32 v48, v180, v181
v_cvt_pk_bf16_f32 v49, v182, v183
v_cvt_pk_bf16_f32 v50, v184, v185
v_cvt_pk_bf16_f32 v51, v186, v187
buffer_store_dwordx4 v[48:51], v252, s[20:23], s44 offen offset:0 sc1
v_accvgpr_read_b32 v180, a40
v_accvgpr_read_b32 v181, a41
v_accvgpr_read_b32 v182, a42
v_accvgpr_read_b32 v183, a43
v_accvgpr_read_b32 v184, a44
v_accvgpr_read_b32 v185, a45
v_accvgpr_read_b32 v186, a46
v_accvgpr_read_b32 v187, a47
v_cvt_pk_bf16_f32 v52, v180, v181
v_cvt_pk_bf16_f32 v53, v182, v183
v_cvt_pk_bf16_f32 v54, v184, v185
v_cvt_pk_bf16_f32 v55, v186, v187
buffer_store_dwordx4 v[52:55], v252, s[20:23], s44 offen offset:1024 sc1
v_accvgpr_read_b32 v180, a48
v_accvgpr_read_b32 v181, a49
v_accvgpr_read_b32 v182, a50
v_accvgpr_read_b32 v183, a51
v_accvgpr_read_b32 v184, a52
v_accvgpr_read_b32 v185, a53
v_accvgpr_read_b32 v186, a54
v_accvgpr_read_b32 v187, a55
v_cvt_pk_bf16_f32 v56, v180, v181
v_cvt_pk_bf16_f32 v57, v182, v183
v_cvt_pk_bf16_f32 v58, v184, v185
v_cvt_pk_bf16_f32 v59, v186, v187
buffer_store_dwordx4 v[56:59], v252, s[20:23], s44 offen offset:2048 sc1
v_accvgpr_read_b32 v180, a56
v_accvgpr_read_b32 v181, a57
v_accvgpr_read_b32 v182, a58
v_accvgpr_read_b32 v183, a59
v_accvgpr_read_b32 v184, a60
v_accvgpr_read_b32 v185, a61
v_accvgpr_read_b32 v186, a62
v_accvgpr_read_b32 v187, a63
v_cvt_pk_bf16_f32 v60, v180, v181
v_cvt_pk_bf16_f32 v61, v182, v183
v_cvt_pk_bf16_f32 v62, v184, v185
v_cvt_pk_bf16_f32 v63, v186, v187
buffer_store_dwordx4 v[60:63], v252, s[20:23], s44 offen offset:3072 sc1
v_lshlrev_b32 v175, 2, v252
s_mov_b64 exec, 0xffff
buffer_store_dwordx2 v[172:173], v175, s[24:27], s48 offen sc1
s_mov_b64 exec, -1
s_waitcnt vmcnt(0)
s_add_u32 s40, s40, 8192
s_add_u32 s48, s48, 1024
s_sub_u32 s55, s55, 1
s_cmp_lg_u32 s55, 0
s_cbranch_scc1 LS_q
s_branch L2_fin
LT_disp:
s_cmp_eq_u32 s34, 0
s_cbranch_scc1 LT_start
s_mov_b32 s41, s34
s_mul_i32 s40, s34, 6
s_add_u32 s40, s40, s37
s_add_u32 s40, s40, 42
s_cmp_lt_u32 s40, 64
s_cbranch_scc1 LE_common
s_branch L2_end
LT_start:
s_waitcnt lgkmcnt(0)
s_add_u32 s12, s4, 0x6800000
s_addc_u32 s13, s5, 0
s_mov_b32 s14, s49
s_mov_b32 s15, 0x00020000
s_add_u32 s8, s4, 0x0
s_addc_u32 s9, s5, 0
s_mov_b32 s10, 0x4e4000
s_mov_b32 s11, 0x00020000
s_mul_i32 s35, s37, 0x600000
s_add_u32 s20, s4, 0x2000000
s_addc_u32 s21, s5, 0
s_add_u32 s20, s20, s35
s_addc_u32 s21, s21, 0
s_mov_b32 s22, 0x4e4000
s_mov_b32 s23, 0x00020000
s_add_u32 s24, s4, 0x6000000
s_addc_u32 s25, s5, 0
s_mov_b32 s26, 0x9c800
s_mov_b32 s27, 0x00020000
s_lshl_b32 s35, s38, 4
s_lshl_b32 s41, s34, 2
s_add_u32 s35, s35, s41
s_lshl_b32 s40, s35, 13
s_lshl_b32 s48, s35, 10
s_lshl_b32 s35, s37, 3
s_add_u32 s48, s48, s35
v_bfe_u32 v248, v252, 4, 3
v_lshlrev_b32 v248, 6, v248
v_bfe_u32 v253, v252, 7, 1
v_lshl_or_b32 v248, v253, 10, v248
v_bfe_u32 v253, v252, 8, 2
v_lshl_or_b32 v248, v253, 4, v248
v_bfe_u32 v253, v252, 6, 1
v_lshlrev_b32 v253, 5, v253
v_xor_b32 v248, v248, v253
v_and_b32 v249, 0x1c0, v252
v_bfe_u32 v253, v252, 9, 1
v_lshl_or_b32 v249, v253, 10, v249
v_bfe_u32 v253, v252, 8, 1
v_lshl_or_b32 v249, v253, 5, v249
v_bfe_u32 v253, v252, 4, 2
v_lshl_or_b32 v249, v253, 3, v249
v_xor_b32 v250, 32, v249
s_mov_b32 s56, 90112
s_add_u32 s57, s56, 65536
s_mov_b32 s55, 1
v_bfe_i32 v188, v252, 8, 1
LT_q:
s_add_u32 s44, s40, 4096
buffer_load_dwordx4 v[0:3], v252, s[8:11], s40 offen offset:0
buffer_load_dwordx4 v[4:7], v252, s[8:11], s40 offen offset:1024
buffer_load_dwordx4 v[8:11], v252, s[8:11], s40 offen offset:2048
buffer_load_dwordx4 v[12:15], v252, s[8:11], s40 offen offset:3072
buffer_load_dwordx4 v[16:19], v252, s[8:11], s44 offen offset:0
buffer_load_dwordx4 v[20:23], v252, s[8:11], s44 offen offset:1024
buffer_load_dwordx4 v[24:27], v252, s[8:11], s44 offen offset:2048
buffer_load_dwordx4 v[28:31], v252, s[8:11], s44 offen offset:3072
s_mov_b32 s53, s56
s_mov_b32 s58, s39
s_add_u32 m0, s53, 0
s_add_u32 s54, s58, 0
buffer_load_dwordx4 v251, s[12:15], s54 offen offset:0 lds
buffer_load_dwordx4 v251, s[12:15], s54 offen offset:1024 lds
buffer_load_dwordx4 v251, s[12:15], s54 offen offset:2048 lds
buffer_load_dwordx4 v251, s[12:15], s54 offen offset:3072 lds
s_add_u32 m0, s53, 4096
s_add_u32 s54, s58, 128
buffer_load_dwordx4 v251, s[12:15], s54 offen offset:0 lds
buffer_load_dwordx4 v251, s[12:15], s54 offen offset:1024 lds
buffer_load_dwordx4 v251, s[12:15], s54 offen offset:2048 lds
buffer_load_dwordx4 v251, s[12:15], s54 offen offset:3072 lds
s_add_u32 m0, s53, 8192
s_add_u32 s54, s58, 256
buffer_load_dwordx4 v251, s[12:15], s54 offen offset:0 lds
buffer_load_dwordx4 v251, s[12:15], s54 offen offset:1024 lds
buffer_load_dwordx4 v251, s[12:15], s54 offen offset:2048 lds
buffer_load_dwordx4 v251, s[12:15], s54 offen offset:3072 lds
s_add_u32 m0, s53, 12288
s_add_u32 s54, s58, 384
buffer_load_dwordx4 v251, s[12:15], s54 offen offset:0 lds
buffer_load_dwordx4 v251, s[12:15], s54 offen offset:1024 lds
buffer_load_dwordx4 v251, s[12:15], s54 offen offset:2048 lds
buffer_load_dwordx4 v251, s[12:15], s54 offen offset:3072 lds
s_add_u32 s53, s53, 0x4000
s_cmp_eq_u32 s53, s57
s_cselect_b32 s53, s56, s53
s_add_u32 s58, s58, 0x4000
s_add_u32 m0, s53, 0
s_add_u32 s54, s58, 0
buffer_load_dwordx4 v251, s[12:15], s54 offen offset:0 lds
buffer_load_dwordx4 v251, s[12:15], s54 offen offset:1024 lds
buffer_load_dwordx4 v251, s[12:15], s54 offen offset:2048 lds
buffer_load_dwordx4 v251, s[12:15], s54 offen offset:3072 lds
s_add_u32 m0, s53, 4096
s_add_u32 s54, s58, 128
buffer_load_dwordx4 v251, s[12:15], s54 offen offset:0 lds
buffer_load_dwordx4 v251, s[12:15], s54 offen offset:1024 lds
buffer_load_dwordx4 v251, s[12:15], s54 offen offset:2048 lds
buffer_load_dwordx4 v251, s[12:15], s54 offen offset:3072 lds
s_add_u32 m0, s53, 8192
s_add_u32 s54, s58, 256
buffer_load_dwordx4 v251, s[12:15], s54 offen offset:0 lds
buffer_load_dwordx4 v251, s[12:15], s54 offen offset:1024 lds
buffer_load_dwordx4 v251, s[12:15], s54 offen offset:2048 lds
buffer_load_dwordx4 v251, s[12:15], s54 offen offset:3072 lds
s_add_u32 m0, s53, 12288
s_add_u32 s54, s58, 384
buffer_load_dwordx4 v251, s[12:15], s54 offen offset:0 lds
buffer_load_dwordx4 v251, s[12:15], s54 offen offset:1024 lds
buffer_load_dwordx4 v251, s[12:15], s54 offen offset:2048 lds
buffer_load_dwordx4 v251, s[12:15], s54 offen offset:3072 lds
s_add_u32 s53, s53, 0x4000
s_cmp_eq_u32 s53, s57
s_cselect_b32 s53, s56, s53
s_add_u32 s58, s58, 0x4000
s_add_u32 m0, s53, 0
s_add_u32 s54, s58, 0
buffer_load_dwordx4 v251, s[12:15], s54 offen offset:0 lds
buffer_load_dwordx4 v251, s[12:15], s54 offen offset:1024 lds
buffer_load_dwordx4 v251, s[12:15], s54 offen offset:2048 lds
buffer_load_dwordx4 v251, s[12:15], s54 offen offset:3072 lds
s_add_u32 m0, s53, 4096
s_add_u32 s54, s58, 128
buffer_load_dwordx4 v251, s[12:15], s54 offen offset:0 lds
buffer_load_dwordx4 v251, s[12:15], s54 offen offset:1024 lds
buffer_load_dwordx4 v251, s[12:15], s54 offen offset:2048 lds
buffer_load_dwordx4 v251, s[12:15], s54 offen offset:3072 lds
s_add_u32 m0, s53, 8192
s_add_u32 s54, s58, 256
buffer_load_dwordx4 v251, s[12:15], s54 offen offset:0 lds
buffer_load_dwordx4 v251, s[12:15], s54 offen offset:1024 lds
buffer_load_dwordx4 v251, s[12:15], s54 offen offset:2048 lds
buffer_load_dwordx4 v251, s[12:15], s54 offen offset:3072 lds
s_add_u32 m0, s53, 12288
s_add_u32 s54, s58, 384
buffer_load_dwordx4 v251, s[12:15], s54 offen offset:0 lds
buffer_load_dwordx4 v251, s[12:15], s54 offen offset:1024 lds
buffer_load_dwordx4 v251, s[12:15], s54 offen offset:2048 lds
buffer_load_dwordx4 v251, s[12:15], s54 offen offset:3072 lds
s_add_u32 s53, s53, 0x4000
s_cmp_eq_u32 s53, s57
s_cselect_b32 s53, s56, s53
s_add_u32 s58, s58, 0x4000
s_mov_b32 s51, s29
s_mov_b32 s52, s56
v_mov_b32 v172, 0xff800000
v_accvgpr_write_b32 a0, 0
v_accvgpr_write_b32 a1, 0
v_accvgpr_write_b32 a2, 0
v_accvgpr_write_b32 a3, 0
v_accvgpr_write_b32 a4, 0
v_accvgpr_write_b32 a5, 0
v_accvgpr_write_b32 a6, 0
v_accvgpr_write_b32 a7, 0
v_accvgpr_write_b32 a8, 0
v_accvgpr_write_b32 a9, 0
v_accvgpr_write_b32 a10, 0
v_accvgpr_write_b32 a11, 0
v_accvgpr_write_b32 a12, 0
v_accvgpr_write_b32 a13, 0
v_accvgpr_write_b32 a14, 0
v_accvgpr_write_b32 a15, 0
v_accvgpr_write_b32 a16, 0
v_accvgpr_write_b32 a17, 0
v_accvgpr_write_b32 a18, 0
v_accvgpr_write_b32 a19, 0
v_accvgpr_write_b32 a20, 0
v_accvgpr_write_b32 a21, 0
v_accvgpr_write_b32 a22, 0
v_accvgpr_write_b32 a23, 0
v_accvgpr_write_b32 a24, 0
v_accvgpr_write_b32 a25, 0
v_accvgpr_write_b32 a26, 0
v_accvgpr_write_b32 a27, 0
v_accvgpr_write_b32 a28, 0
v_accvgpr_write_b32 a29, 0
v_accvgpr_write_b32 a30, 0
v_accvgpr_write_b32 a31, 0
v_accvgpr_write_b32 a32, 0
v_accvgpr_write_b32 a33, 0
v_accvgpr_write_b32 a34, 0
v_accvgpr_write_b32 a35, 0
v_accvgpr_write_b32 a36, 0
v_accvgpr_write_b32 a37, 0
v_accvgpr_write_b32 a38, 0
v_accvgpr_write_b32 a39, 0
v_accvgpr_write_b32 a40, 0
v_accvgpr_write_b32 a41, 0
v_accvgpr_write_b32 a42, 0
v_accvgpr_write_b32 a43, 0
v_accvgpr_write_b32 a44, 0
v_accvgpr_write_b32 a45, 0
v_accvgpr_write_b32 a46, 0
v_accvgpr_write_b32 a47, 0
v_accvgpr_write_b32 a48, 0
v_accvgpr_write_b32 a49, 0
v_accvgpr_write_b32 a50, 0
v_accvgpr_write_b32 a51, 0
v_accvgpr_write_b32 a52, 0
v_accvgpr_write_b32 a53, 0
v_accvgpr_write_b32 a54, 0
v_accvgpr_write_b32 a55, 0
v_accvgpr_write_b32 a56, 0
v_accvgpr_write_b32 a57, 0
v_accvgpr_write_b32 a58, 0
v_accvgpr_write_b32 a59, 0
v_accvgpr_write_b32 a60, 0
v_accvgpr_write_b32 a61, 0
v_accvgpr_write_b32 a62, 0
v_accvgpr_write_b32 a63, 0
LT_loop:
s_add_u32 m0, s53, 0
s_add_u32 s54, s58, 0
buffer_load_dwordx4 v251, s[12:15], s54 offen offset:0 lds
buffer_load_dwordx4 v251, s[12:15], s54 offen offset:1024 lds
buffer_load_dwordx4 v251, s[12:15], s54 offen offset:2048 lds
buffer_load_dwordx4 v251, s[12:15], s54 offen offset:3072 lds
s_add_u32 m0, s53, 4096
s_add_u32 s54, s58, 128
buffer_load_dwordx4 v251, s[12:15], s54 offen offset:0 lds
buffer_load_dwordx4 v251, s[12:15], s54 offen offset:1024 lds
buffer_load_dwordx4 v251, s[12:15], s54 offen offset:2048 lds
buffer_load_dwordx4 v251, s[12:15], s54 offen offset:3072 lds
s_add_u32 m0, s53, 8192
s_add_u32 s54, s58, 256
buffer_load_dwordx4 v251, s[12:15], s54 offen offset:0 lds
buffer_load_dwordx4 v251, s[12:15], s54 offen offset:1024 lds
buffer_load_dwordx4 v251, s[12:15], s54 offen offset:2048 lds
buffer_load_dwordx4 v251, s[12:15], s54 offen offset:3072 lds
s_add_u32 m0, s53, 12288
s_add_u32 s54, s58, 384
buffer_load_dwordx4 v251, s[12:15], s54 offen offset:0 lds
buffer_load_dwordx4 v251, s[12:15], s54 offen offset:1024 lds
buffer_load_dwordx4 v251, s[12:15], s54 offen offset:2048 lds
buffer_load_dwordx4 v251, s[12:15], s54 offen offset:3072 lds
s_add_u32 s53, s53, 0x4000
s_cmp_eq_u32 s53, s57
s_cselect_b32 s53, s56, s53
s_add_u32 s58, s58, 0x4000
v_add_u32 v177, s52, v248
v_add_u32 v178, s52, v249
v_add_u32 v179, s52, v250
s_add_u32 s52, s52, 0x4000
s_cmp_eq_u32 s52, s57
s_cselect_b32 s52, s56, s52
s_cmp_eq_u32 s51, 1
s_cselect_b32 s54, s33, 0
v_and_b32 v192, s54, v188
v_and_b32 v193, s54, v188
v_and_b32 v194, s54, v188
v_and_b32 v195, s54, v188
s_waitcnt vmcnt(48)
ds_read_b128 v[32:35], v177 offset:0
ds_read_b128 v[64:67], v177 offset:2048
ds_read_b128 v[36:39], v177 offset:512
ds_read_b128 v[68:71], v177 offset:2560
ds_read_b128 v[40:43], v177 offset:4096
ds_read_b128 v[72:75], v177 offset:6144
ds_read_b128 v[44:47], v177 offset:4608
ds_read_b128 v[76:79], v177 offset:6656
ds_read_b128 v[48:51], v177 offset:8192
ds_read_b128 v[80:83], v177 offset:10240
ds_read_b128 v[52:55], v177 offset:8704
ds_read_b128 v[84:87], v177 offset:10752
ds_read_b128 v[56:59], v177 offset:12288
ds_read_b128 v[88:91], v177 offset:14336
ds_read_b128 v[60:63], v177 offset:12800
ds_read_b128 v[92:95], v177 offset:14848
s_waitcnt lgkmcnt(14)
v_mfma_f32_16x16x32_bf16 v[160:163], v[32:35], v[0:3], v[192:195]
v_mfma_f32_16x16x32_bf16 v[164:167], v[64:67], v[0:3], v[192:195]
s_waitcnt lgkmcnt(12)
v_mfma_f32_16x16x32_bf16 v[160:163], v[36:39], v[4:7], v[160:163]
v_mfma_f32_16x16x32_bf16 v[164:167], v[68:71], v[4:7], v[164:167]
s_waitcnt lgkmcnt(10)
v_mfma_f32_16x16x32_bf16 v[160:163], v[40:43], v[8:11], v[160:163]
v_mfma_f32_16x16x32_bf16 v[164:167], v[72:75], v[8:11], v[164:167]
s_waitcnt lgkmcnt(8)
v_mfma_f32_16x16x32_bf16 v[160:163], v[44:47], v[12:15], v[160:163]
v_mfma_f32_16x16x32_bf16 v[164:167], v[76:79], v[12:15], v[164:167]
s_waitcnt lgkmcnt(6)
v_mfma_f32_16x16x32_bf16 v[160:163], v[48:51], v[16:19], v[160:163]
v_mfma_f32_16x16x32_bf16 v[164:167], v[80:83], v[16:19], v[164:167]
s_waitcnt lgkmcnt(4)
v_mfma_f32_16x16x32_bf16 v[160:163], v[52:55], v[20:23], v[160:163]
v_mfma_f32_16x16x32_bf16 v[164:167], v[84:87], v[20:23], v[164:167]
s_waitcnt lgkmcnt(2)
v_mfma_f32_16x16x32_bf16 v[160:163], v[56:59], v[24:27], v[160:163]
v_mfma_f32_16x16x32_bf16 v[164:167], v[88:91], v[24:27], v[164:167]
s_waitcnt lgkmcnt(0)
v_mfma_f32_16x16x32_bf16 v[160:163], v[60:63], v[28:31], v[160:163]
v_mfma_f32_16x16x32_bf16 v[164:167], v[92:95], v[28:31], v[164:167]
ds_read_b64_tr_b16 v[96:97], v178 offset:0
ds_read_b64_tr_b16 v[98:99], v178 offset:2048
ds_read_b64_tr_b16 v[100:101], v179 offset:0
ds_read_b64_tr_b16 v[102:103], v179 offset:2048
ds_read_b64_tr_b16 v[104:105], v178 offset:512
ds_read_b64_tr_b16 v[106:107], v178 offset:2560
ds_read_b64_tr_b16 v[108:109], v179 offset:512
ds_read_b64_tr_b16 v[110:111], v179 offset:2560
ds_read_b64_tr_b16 v[112:113], v178 offset:4096
ds_read_b64_tr_b16 v[114:115], v178 offset:6144
ds_read_b64_tr_b16 v[116:117], v179 offset:4096
ds_read_b64_tr_b16 v[118:119], v179 offset:6144
ds_read_b64_tr_b16 v[120:121], v178 offset:4608
ds_read_b64_tr_b16 v[122:123], v178 offset:6656
ds_read_b64_tr_b16 v[124:125], v179 offset:4608
ds_read_b64_tr_b16 v[126:127], v179 offset:6656
ds_read_b64_tr_b16 v[128:129], v178 offset:8192
ds_read_b64_tr_b16 v[130:131], v178 offset:10240
ds_read_b64_tr_b16 v[132:133], v179 offset:8192
ds_read_b64_tr_b16 v[134:135], v179 offset:10240
ds_read_b64_tr_b16 v[136:137], v178 offset:8704
ds_read_b64_tr_b16 v[138:139], v178 offset:10752
ds_read_b64_tr_b16 v[140:141], v179 offset:8704
ds_read_b64_tr_b16 v[142:143], v179 offset:10752
ds_read_b64_tr_b16 v[144:145], v178 offset:12288
ds_read_b64_tr_b16 v[146:147], v178 offset:14336
ds_read_b64_tr_b16 v[148:149], v179 offset:12288
ds_read_b64_tr_b16 v[150:151], v179 offset:14336
ds_read_b64_tr_b16 v[152:153], v178 offset:12800
ds_read_b64_tr_b16 v[154:155], v178 offset:14848
ds_read_b64_tr_b16 v[156:157], v179 offset:12800
ds_read_b64_tr_b16 v[158:159], v179 offset:14848
s_nop 7
v_max3_f32 v175, v160, v161, v162
v_max3_f32 v175, v175, v163, v164
v_max3_f32 v175, v175, v165, v166
v_max3_f32 v175, v175, v167, v172
v_mov_b32 v176, v175
s_nop 1
v_permlane32_swap_b32 v175, v176
s_nop 1
v_max_f32 v175, v175, v176
v_mov_b32 v176, v175
s_nop 1
v_permlane16_swap_b32 v175, v176
s_nop 1
v_max_f32 v175, v175, v176
v_sub_f32 v174, v172, v175
v_exp_f32 v174, v174
v_mov_b32 v172, v175
v_sub_f32 v160, v160, v172
v_sub_f32 v161, v161, v172
v_sub_f32 v162, v162, v172
v_sub_f32 v163, v163, v172
v_sub_f32 v164, v164, v172
v_sub_f32 v165, v165, v172
v_sub_f32 v166, v166, v172
v_sub_f32 v167, v167, v172
v_exp_f32 v160, v160
v_exp_f32 v161, v161
v_exp_f32 v162, v162
v_exp_f32 v163, v163
v_exp_f32 v164, v164
v_exp_f32 v165, v165
v_exp_f32 v166, v166
v_exp_f32 v167, v167
v_cmp_neq_f32 vcc, 1.0, v174
v_cvt_pk_bf16_f32 v168, v160, v161
v_cvt_pk_bf16_f32 v169, v162, v163
v_cvt_pk_bf16_f32 v170, v164, v165
v_cvt_pk_bf16_f32 v171, v166, v167
s_cbranch_vccz LT_nors
v_accvgpr_read_b32 v180, a0
v_accvgpr_read_b32 v181, a1
v_accvgpr_read_b32 v182, a2
v_accvgpr_read_b32 v183, a3
v_accvgpr_read_b32 v184, a4
v_accvgpr_read_b32 v185, a5
v_accvgpr_read_b32 v186, a6
v_accvgpr_read_b32 v187, a7
v_mul_f32 v180, v180, v174
v_mul_f32 v181, v181, v174
v_mul_f32 v182, v182, v174
v_mul_f32 v183, v183, v174
v_mul_f32 v184, v184, v174
v_mul_f32 v185, v185, v174
v_mul_f32 v186, v186, v174
v_mul_f32 v187, v187, v174
v_accvgpr_write_b32 a0, v180
v_accvgpr_write_b32 a1, v181
v_accvgpr_write_b32 a2, v182
v_accvgpr_write_b32 a3, v183
v_accvgpr_write_b32 a4, v184
v_accvgpr_write_b32 a5, v185
v_accvgpr_write_b32 a6, v186
v_accvgpr_write_b32 a7, v187
v_accvgpr_read_b32 v180, a8
v_accvgpr_read_b32 v181, a9
v_accvgpr_read_b32 v182, a10
v_accvgpr_read_b32 v183, a11
v_accvgpr_read_b32 v184, a12
v_accvgpr_read_b32 v185, a13
v_accvgpr_read_b32 v186, a14
v_accvgpr_read_b32 v187, a15
v_mul_f32 v180, v180, v174
v_mul_f32 v181, v181, v174
v_mul_f32 v182, v182, v174
v_mul_f32 v183, v183, v174
v_mul_f32 v184, v184, v174
v_mul_f32 v185, v185, v174
v_mul_f32 v186, v186, v174
v_mul_f32 v187, v187, v174
v_accvgpr_write_b32 a8, v180
v_accvgpr_write_b32 a9, v181
v_accvgpr_write_b32 a10, v182
v_accvgpr_write_b32 a11, v183
v_accvgpr_write_b32 a12, v184
v_accvgpr_write_b32 a13, v185
v_accvgpr_write_b32 a14, v186
v_accvgpr_write_b32 a15, v187
v_accvgpr_read_b32 v180, a16
v_accvgpr_read_b32 v181, a17
v_accvgpr_read_b32 v182, a18
v_accvgpr_read_b32 v183, a19
v_accvgpr_read_b32 v184, a20
v_accvgpr_read_b32 v185, a21
v_accvgpr_read_b32 v186, a22
v_accvgpr_read_b32 v187, a23
v_mul_f32 v180, v180, v174
v_mul_f32 v181, v181, v174
v_mul_f32 v182, v182, v174
v_mul_f32 v183, v183, v174
v_mul_f32 v184, v184, v174
v_mul_f32 v185, v185, v174
v_mul_f32 v186, v186, v174
v_mul_f32 v187, v187, v174
v_accvgpr_write_b32 a16, v180
v_accvgpr_write_b32 a17, v181
v_accvgpr_write_b32 a18, v182
v_accvgpr_write_b32 a19, v183
v_accvgpr_write_b32 a20, v184
v_accvgpr_write_b32 a21, v185
v_accvgpr_write_b32 a22, v186
v_accvgpr_write_b32 a23, v187
v_accvgpr_read_b32 v180, a24
v_accvgpr_read_b32 v181, a25
v_accvgpr_read_b32 v182, a26
v_accvgpr_read_b32 v183, a27
v_accvgpr_read_b32 v184, a28
v_accvgpr_read_b32 v185, a29
v_accvgpr_read_b32 v186, a30
v_accvgpr_read_b32 v187, a31
v_mul_f32 v180, v180, v174
v_mul_f32 v181, v181, v174
v_mul_f32 v182, v182, v174
v_mul_f32 v183, v183, v174
v_mul_f32 v184, v184, v174
v_mul_f32 v185, v185, v174
v_mul_f32 v186, v186, v174
v_mul_f32 v187, v187, v174
v_accvgpr_write_b32 a24, v180
v_accvgpr_write_b32 a25, v181
v_accvgpr_write_b32 a26, v182
v_accvgpr_write_b32 a27, v183
v_accvgpr_write_b32 a28, v184
v_accvgpr_write_b32 a29, v185
v_accvgpr_write_b32 a30, v186
v_accvgpr_write_b32 a31, v187
v_accvgpr_read_b32 v180, a32
v_accvgpr_read_b32 v181, a33
v_accvgpr_read_b32 v182, a34
v_accvgpr_read_b32 v183, a35
v_accvgpr_read_b32 v184, a36
v_accvgpr_read_b32 v185, a37
v_accvgpr_read_b32 v186, a38
v_accvgpr_read_b32 v187, a39
v_mul_f32 v180, v180, v174
v_mul_f32 v181, v181, v174
v_mul_f32 v182, v182, v174
v_mul_f32 v183, v183, v174
v_mul_f32 v184, v184, v174
v_mul_f32 v185, v185, v174
v_mul_f32 v186, v186, v174
v_mul_f32 v187, v187, v174
v_accvgpr_write_b32 a32, v180
v_accvgpr_write_b32 a33, v181
v_accvgpr_write_b32 a34, v182
v_accvgpr_write_b32 a35, v183
v_accvgpr_write_b32 a36, v184
v_accvgpr_write_b32 a37, v185
v_accvgpr_write_b32 a38, v186
v_accvgpr_write_b32 a39, v187
v_accvgpr_read_b32 v180, a40
v_accvgpr_read_b32 v181, a41
v_accvgpr_read_b32 v182, a42
v_accvgpr_read_b32 v183, a43
v_accvgpr_read_b32 v184, a44
v_accvgpr_read_b32 v185, a45
v_accvgpr_read_b32 v186, a46
v_accvgpr_read_b32 v187, a47
v_mul_f32 v180, v180, v174
v_mul_f32 v181, v181, v174
v_mul_f32 v182, v182, v174
v_mul_f32 v183, v183, v174
v_mul_f32 v184, v184, v174
v_mul_f32 v185, v185, v174
v_mul_f32 v186, v186, v174
v_mul_f32 v187, v187, v174
v_accvgpr_write_b32 a40, v180
v_accvgpr_write_b32 a41, v181
v_accvgpr_write_b32 a42, v182
v_accvgpr_write_b32 a43, v183
v_accvgpr_write_b32 a44, v184
v_accvgpr_write_b32 a45, v185
v_accvgpr_write_b32 a46, v186
v_accvgpr_write_b32 a47, v187
v_accvgpr_read_b32 v180, a48
v_accvgpr_read_b32 v181, a49
v_accvgpr_read_b32 v182, a50
v_accvgpr_read_b32 v183, a51
v_accvgpr_read_b32 v184, a52
v_accvgpr_read_b32 v185, a53
v_accvgpr_read_b32 v186, a54
v_accvgpr_read_b32 v187, a55
v_mul_f32 v180, v180, v174
v_mul_f32 v181, v181, v174
v_mul_f32 v182, v182, v174
v_mul_f32 v183, v183, v174
v_mul_f32 v184, v184, v174
v_mul_f32 v185, v185, v174
v_mul_f32 v186, v186, v174
v_mul_f32 v187, v187, v174
v_accvgpr_write_b32 a48, v180
v_accvgpr_write_b32 a49, v181
v_accvgpr_write_b32 a50, v182
v_accvgpr_write_b32 a51, v183
v_accvgpr_write_b32 a52, v184
v_accvgpr_write_b32 a53, v185
v_accvgpr_write_b32 a54, v186
v_accvgpr_write_b32 a55, v187
v_accvgpr_read_b32 v180, a56
v_accvgpr_read_b32 v181, a57
v_accvgpr_read_b32 v182, a58
v_accvgpr_read_b32 v183, a59
v_accvgpr_read_b32 v184, a60
v_accvgpr_read_b32 v185, a61
v_accvgpr_read_b32 v186, a62
v_accvgpr_read_b32 v187, a63
v_mul_f32 v180, v180, v174
v_mul_f32 v181, v181, v174
v_mul_f32 v182, v182, v174
v_mul_f32 v183, v183, v174
v_mul_f32 v184, v184, v174
v_mul_f32 v185, v185, v174
v_mul_f32 v186, v186, v174
v_mul_f32 v187, v187, v174
v_accvgpr_write_b32 a56, v180
v_accvgpr_write_b32 a57, v181
v_accvgpr_write_b32 a58, v182
v_accvgpr_write_b32 a59, v183
v_accvgpr_write_b32 a60, v184
v_accvgpr_write_b32 a61, v185
v_accvgpr_write_b32 a62, v186
v_accvgpr_write_b32 a63, v187
LT_nors:
s_waitcnt lgkmcnt(0)
s_nop 1
v_mfma_f32_16x16x32_bf16 a[0:3], v[96:99], v[168:171], a[0:3]
v_mfma_f32_16x16x32_bf16 a[4:7], v[100:103], v[168:171], a[4:7]
v_mfma_f32_16x16x32_bf16 a[8:11], v[104:107], v[168:171], a[8:11]
v_mfma_f32_16x16x32_bf16 a[12:15], v[108:111], v[168:171], a[12:15]
v_mfma_f32_16x16x32_bf16 a[16:19], v[112:115], v[168:171], a[16:19]
v_mfma_f32_16x16x32_bf16 a[20:23], v[116:119], v[168:171], a[20:23]
v_mfma_f32_16x16x32_bf16 a[24:27], v[120:123], v[168:171], a[24:27]
v_mfma_f32_16x16x32_bf16 a[28:31], v[124:127], v[168:171], a[28:31]
v_mfma_f32_16x16x32_bf16 a[32:35], v[128:131], v[168:171], a[32:35]
v_mfma_f32_16x16x32_bf16 a[36:39], v[132:135], v[168:171], a[36:39]
v_mfma_f32_16x16x32_bf16 a[40:43], v[136:139], v[168:171], a[40:43]
v_mfma_f32_16x16x32_bf16 a[44:47], v[140:143], v[168:171], a[44:47]
v_mfma_f32_16x16x32_bf16 a[48:51], v[144:147], v[168:171], a[48:51]
v_mfma_f32_16x16x32_bf16 a[52:55], v[148:151], v[168:171], a[52:55]
v_mfma_f32_16x16x32_bf16 a[56:59], v[152:155], v[168:171], a[56:59]
v_mfma_f32_16x16x32_bf16 a[60:63], v[156:159], v[168:171], a[60:63]
s_sub_u32 s51, s51, 1
s_cmp_lg_u32 s51, 0
s_cbranch_scc1 LT_loop
s_nop 15
v_accvgpr_read_b32 v173, a0
v_accvgpr_read_b32 v180, a0
v_accvgpr_read_b32 v181, a1
v_accvgpr_read_b32 v182, a2
v_accvgpr_read_b32 v183, a3
v_accvgpr_read_b32 v184, a4
v_accvgpr_read_b32 v185, a5
v_accvgpr_read_b32 v186, a6
v_accvgpr_read_b32 v187, a7
v_cvt_pk_bf16_f32 v32, v180, v181
v_cvt_pk_bf16_f32 v33, v182, v183
v_cvt_pk_bf16_f32 v34, v184, v185
v_cvt_pk_bf16_f32 v35, v186, v187
buffer_store_dwordx4 v[32:35], v252, s[20:23], s40 offen offset:0 sc1
v_accvgpr_read_b32 v180, a8
v_accvgpr_read_b32 v181, a9
v_accvgpr_read_b32 v182, a10
v_accvgpr_read_b32 v183, a11
v_accvgpr_read_b32 v184, a12
v_accvgpr_read_b32 v185, a13
v_accvgpr_read_b32 v186, a14
v_accvgpr_read_b32 v187, a15
v_cvt_pk_bf16_f32 v36, v180, v181
v_cvt_pk_bf16_f32 v37, v182, v183
v_cvt_pk_bf16_f32 v38, v184, v185
v_cvt_pk_bf16_f32 v39, v186, v187
buffer_store_dwordx4 v[36:39], v252, s[20:23], s40 offen offset:1024 sc1
v_accvgpr_read_b32 v180, a16
v_accvgpr_read_b32 v181, a17
v_accvgpr_read_b32 v182, a18
v_accvgpr_read_b32 v183, a19
v_accvgpr_read_b32 v184, a20
v_accvgpr_read_b32 v185, a21
v_accvgpr_read_b32 v186, a22
v_accvgpr_read_b32 v187, a23
v_cvt_pk_bf16_f32 v40, v180, v181
v_cvt_pk_bf16_f32 v41, v182, v183
v_cvt_pk_bf16_f32 v42, v184, v185
v_cvt_pk_bf16_f32 v43, v186, v187
buffer_store_dwordx4 v[40:43], v252, s[20:23], s40 offen offset:2048 sc1
v_accvgpr_read_b32 v180, a24
v_accvgpr_read_b32 v181, a25
v_accvgpr_read_b32 v182, a26
v_accvgpr_read_b32 v183, a27
v_accvgpr_read_b32 v184, a28
v_accvgpr_read_b32 v185, a29
v_accvgpr_read_b32 v186, a30
v_accvgpr_read_b32 v187, a31
v_cvt_pk_bf16_f32 v44, v180, v181
v_cvt_pk_bf16_f32 v45, v182, v183
v_cvt_pk_bf16_f32 v46, v184, v185
v_cvt_pk_bf16_f32 v47, v186, v187
buffer_store_dwordx4 v[44:47], v252, s[20:23], s40 offen offset:3072 sc1
v_accvgpr_read_b32 v180, a32
v_accvgpr_read_b32 v181, a33
v_accvgpr_read_b32 v182, a34
v_accvgpr_read_b32 v183, a35
v_accvgpr_read_b32 v184, a36
v_accvgpr_read_b32 v185, a37
v_accvgpr_read_b32 v186, a38
v_accvgpr_read_b32 v187, a39
v_cvt_pk_bf16_f32 v48, v180, v181
v_cvt_pk_bf16_f32 v49, v182, v183
v_cvt_pk_bf16_f32 v50, v184, v185
v_cvt_pk_bf16_f32 v51, v186, v187
buffer_store_dwordx4 v[48:51], v252, s[20:23], s44 offen offset:0 sc1
v_accvgpr_read_b32 v180, a40
v_accvgpr_read_b32 v181, a41
v_accvgpr_read_b32 v182, a42
v_accvgpr_read_b32 v183, a43
v_accvgpr_read_b32 v184, a44
v_accvgpr_read_b32 v185, a45
v_accvgpr_read_b32 v186, a46
v_accvgpr_read_b32 v187, a47
v_cvt_pk_bf16_f32 v52, v180, v181
v_cvt_pk_bf16_f32 v53, v182, v183
v_cvt_pk_bf16_f32 v54, v184, v185
v_cvt_pk_bf16_f32 v55, v186, v187
buffer_store_dwordx4 v[52:55], v252, s[20:23], s44 offen offset:1024 sc1
v_accvgpr_read_b32 v180, a48
v_accvgpr_read_b32 v181, a49
v_accvgpr_read_b32 v182, a50
v_accvgpr_read_b32 v183, a51
v_accvgpr_read_b32 v184, a52
v_accvgpr_read_b32 v185, a53
v_accvgpr_read_b32 v186, a54
v_accvgpr_read_b32 v187, a55
v_cvt_pk_bf16_f32 v56, v180, v181
v_cvt_pk_bf16_f32 v57, v182, v183
v_cvt_pk_bf16_f32 v58, v184, v185
v_cvt_pk_bf16_f32 v59, v186, v187
buffer_store_dwordx4 v[56:59], v252, s[20:23], s44 offen offset:2048 sc1
v_accvgpr_read_b32 v180, a56
v_accvgpr_read_b32 v181, a57
v_accvgpr_read_b32 v182, a58
v_accvgpr_read_b32 v183, a59
v_accvgpr_read_b32 v184, a60
v_accvgpr_read_b32 v185, a61
v_accvgpr_read_b32 v186, a62
v_accvgpr_read_b32 v187, a63
v_cvt_pk_bf16_f32 v60, v180, v181
v_cvt_pk_bf16_f32 v61, v182, v183
v_cvt_pk_bf16_f32 v62, v184, v185
v_cvt_pk_bf16_f32 v63, v186, v187
buffer_store_dwordx4 v[60:63], v252, s[20:23], s44 offen offset:3072 sc1
v_lshlrev_b32 v175, 2, v252
s_mov_b64 exec, 0xffff
buffer_store_dwordx2 v[172:173], v175, s[24:27], s48 offen sc1
s_mov_b64 exec, -1
s_waitcnt vmcnt(0)
s_add_u32 s40, s40, 8192
s_add_u32 s48, s48, 1024
s_sub_u32 s55, s55, 1
s_cmp_lg_u32 s55, 0
s_cbranch_scc1 LT_q
s_branch L2_fin
LE_start:
s_cmp_ge_u32 s37, 32
s_cbranch_scc1 L2_end
v_lshrrev_b32 v1, 6, v0
s_sub_u32 s37, s37, 30
s_lshl_b32 s35, s35, 1
v_readfirstlane_b32 s41, v1
s_add_u32 s35, s35, s37
s_mul_i32 s35, s35, 3
s_add_u32 s40, s35, s41
s_cmp_ge_u32 s41, 3
s_cbranch_scc1 L2_end
LE_common:
v_and_b32 v1, 63, v0
s_mov_b32 s42, 0
s_mov_b32 s49, 512
v_lshrrev_b32 v33, 1, v1
v_and_b32 v34, 1, v1
v_mul_u32_u24 v6, 0x5000, v33
v_lshl_add_u32 v6, v34, 4, v6
v_lshlrev_b32 v33, 2, v33
s_mul_i32 s50, s40, 655360
s_mul_i32 s48, s40, 128
s_waitcnt lgkmcnt(0)
s_add_u32 s8, s4, 0x7800000
s_addc_u32 s9, s5, 0
s_mov_b32 s10, 0x2000
s_mov_b32 s11, 0x00020000
s_add_u32 s12, s4, 0x8000000
s_addc_u32 s13, s5, 0
s_mov_b32 s14, 0x2800000
s_mov_b32 s15, 0x00020000
buffer_load_dword v4, v33, s[8:11], s48 offen
buffer_load_dwordx4 v[192:195], v6, s[12:15], s50 offen offset:0
buffer_load_dwordx4 v[196:199], v6, s[12:15], s50 offen offset:32
buffer_load_dwordx4 v[200:203], v6, s[12:15], s50 offen offset:64
buffer_load_dwordx4 v[204:207], v6, s[12:15], s50 offen offset:96
buffer_load_dwordx4 v[208:211], v6, s[12:15], s50 offen offset:128
buffer_load_dwordx4 v[212:215], v6, s[12:15], s50 offen offset:160
buffer_load_dwordx4 v[216:219], v6, s[12:15], s50 offen offset:192
buffer_load_dwordx4 v[220:223], v6, s[12:15], s50 offen offset:224
buffer_load_dwordx4 v[224:227], v6, s[12:15], s50 offen offset:256
buffer_load_dwordx4 v[228:231], v6, s[12:15], s50 offen offset:288
buffer_load_dwordx4 v[232:235], v6, s[12:15], s50 offen offset:320
buffer_load_dwordx4 v[236:239], v6, s[12:15], s50 offen offset:352
buffer_load_dwordx4 v[240:243], v6, s[12:15], s50 offen offset:384
buffer_load_dwordx4 v[244:247], v6, s[12:15], s50 offen offset:416
buffer_load_dwordx4 v[248:251], v6, s[12:15], s50 offen offset:448
buffer_load_dwordx4 v[252:255], v6, s[12:15], s50 offen offset:480
s_add_u32 s16, s4, 0x6800000
s_addc_u32 s17, s5, 0
s_mov_b32 s18, 0x4e2000
s_mov_b32 s19, 0x00020000
s_add_u32 s20, s4, 0x7000000
s_addc_u32 s21, s5, 0
s_mov_b32 s22, 0x4e2000
s_mov_b32 s23, 0x00020000
v_lshlrev_b32 v5, 2, v34
v_and_b32 v2, 15, v1
v_lshrrev_b32 v3, 4, v1
v_mov_b32 v16, 1
v_mov_b32 v17, 4
v_and_b32 v33, 1, v2
v_lshlrev_b32 v33, 4, v33
v_lshlrev_b32 v33, v33, v16
v_mul_u32_u24 v33, 0x3f80, v33
v_lshrrev_b32 v34, 1, v2
v_cmp_eq_u32 vcc, 0, v34
s_nop 1
v_cndmask_b32 v40, 0, v33, vcc
v_cmp_eq_u32 vcc, 1, v34
s_nop 1
v_cndmask_b32 v41, 0, v33, vcc
v_cmp_eq_u32 vcc, 2, v34
s_nop 1
v_cndmask_b32 v42, 0, v33, vcc
v_cmp_eq_u32 vcc, 3, v34
s_nop 1
v_cndmask_b32 v43, 0, v33, vcc
v_cmp_eq_u32 vcc, 4, v34
s_nop 1
v_cndmask_b32 v44, 0, v33, vcc
v_cmp_eq_u32 vcc, 5, v34
s_nop 1
v_cndmask_b32 v45, 0, v33, vcc
v_cmp_eq_u32 vcc, 6, v34
s_nop 1
v_cndmask_b32 v46, 0, v33, vcc
v_cmp_eq_u32 vcc, 7, v34
s_nop 1
v_cndmask_b32 v47, 0, v33, vcc
v_lshlrev_b32 v39, 5, v2
v_lshl_add_u32 v39, v3, 3, v39
v_lshlrev_b32 v2, 4, v2
s_mul_i32 s48, s41, 21504
s_add_u32 s48, s48, 4096
v_mov_b32 v36, s48
v_lshl_add_u32 v38, v3, 2, v36
s_lshl_b32 s36, s41, 10
v_mov_b32 v7, s36
v_lshlrev_b32 v35, 4, v1
v_add_u32 v68, s48, v35
v_add_u32 v35, s36, v35
v_lshlrev_b32 v33, 2, v1
v_mov_b32 v72, 0xffff
v_mov_b32 v73, 0xffff
v_mov_b32 v74, 0xffff
v_mov_b32 v75, 0xffff
v_cmp_gt_u32 vcc, 157, v33
v_mov_b32 v48, 0
s_nop 0
v_cndmask_b32 v18, 0, v16, vcc
v_cmp_gt_u32 vcc, 156, v33
v_mov_b32 v49, 0
s_nop 0
v_cndmask_b32 v19, 0, v16, vcc
v_cmp_gt_u32 vcc, 155, v33
v_mov_b32 v50, 0
s_nop 0
v_cndmask_b32 v20, 0, v16, vcc
v_cmp_gt_u32 vcc, 154, v33
v_mov_b32 v51, 0
s_nop 0
v_cndmask_b32 v21, 0, v16, vcc
LE_pass:
ds_write_b128 v35, v[48:51]
ds_write_b128 v68, v[72:75] offset:0
ds_write_b128 v68, v[72:75] offset:1024
ds_write_b128 v68, v[72:75] offset:2048
ds_write_b128 v68, v[72:75] offset:3072
ds_write_b128 v68, v[72:75] offset:4096
ds_write_b128 v68, v[72:75] offset:5120
ds_write_b128 v68, v[72:75] offset:6144
ds_write_b128 v68, v[72:75] offset:7168
ds_write_b128 v68, v[72:75] offset:8192
ds_write_b128 v68, v[72:75] offset:9216
ds_write_b128 v68, v[72:75] offset:10240
ds_write_b128 v68, v[72:75] offset:11264
ds_write_b128 v68, v[72:75] offset:12288
ds_write_b128 v68, v[72:75] offset:13312
ds_write_b128 v68, v[72:75] offset:14336
ds_write_b128 v68, v[72:75] offset:15360
ds_write_b128 v68, v[72:75] offset:16384
ds_write_b128 v68, v[72:75] offset:17408
ds_write_b128 v68, v[72:75] offset:18432
ds_write_b128 v68, v[72:75] offset:19456
v_lshl_add_u32 v32, v1, 2, v36
ds_write_b32 v32, v48 offset:20480
s_waitcnt vmcnt(16)
v_sub_u32 v32, v4, v5
s_waitcnt vmcnt(15)
v_cmpx_lt_i32 vcc, 0, v32
s_cbranch_execz LE_c
v_mad_u32_u16 v128, v192, 1, v7 op_sel:[1,0,0,0]
ds_add_u32 v128, v16
v_cmpx_lt_i32 vcc, 1, v32
v_mad_u32_u16 v129, v193, 1, v7 op_sel:[1,0,0,0]
ds_add_u32 v129, v16
v_cmpx_lt_i32 vcc, 2, v32
v_mad_u32_u16 v130, v194, 1, v7 op_sel:[1,0,0,0]
ds_add_u32 v130, v16
v_cmpx_lt_i32 vcc, 3, v32
v_mad_u32_u16 v131, v195, 1, v7 op_sel:[1,0,0,0]
ds_add_u32 v131, v16
s_waitcnt vmcnt(14)
v_cmpx_lt_i32 vcc, 8, v32
s_cbranch_execz LE_c
v_mad_u32_u16 v132, v196, 1, v7 op_sel:[1,0,0,0]
ds_add_u32 v132, v16
v_cmpx_lt_i32 vcc, 9, v32
v_mad_u32_u16 v133, v197, 1, v7 op_sel:[1,0,0,0]
ds_add_u32 v133, v16
v_cmpx_lt_i32 vcc, 10, v32
v_mad_u32_u16 v134, v198, 1, v7 op_sel:[1,0,0,0]
ds_add_u32 v134, v16
v_cmpx_lt_i32 vcc, 11, v32
v_mad_u32_u16 v135, v199, 1, v7 op_sel:[1,0,0,0]
ds_add_u32 v135, v16
s_waitcnt vmcnt(13)
v_cmpx_lt_i32 vcc, 16, v32
s_cbranch_execz LE_c
v_mad_u32_u16 v136, v200, 1, v7 op_sel:[1,0,0,0]
ds_add_u32 v136, v16
v_cmpx_lt_i32 vcc, 17, v32
v_mad_u32_u16 v137, v201, 1, v7 op_sel:[1,0,0,0]
ds_add_u32 v137, v16
v_cmpx_lt_i32 vcc, 18, v32
v_mad_u32_u16 v138, v202, 1, v7 op_sel:[1,0,0,0]
ds_add_u32 v138, v16
v_cmpx_lt_i32 vcc, 19, v32
v_mad_u32_u16 v139, v203, 1, v7 op_sel:[1,0,0,0]
ds_add_u32 v139, v16
s_waitcnt vmcnt(12)
v_cmpx_lt_i32 vcc, 24, v32
s_cbranch_execz LE_c
v_mad_u32_u16 v140, v204, 1, v7 op_sel:[1,0,0,0]
ds_add_u32 v140, v16
v_cmpx_lt_i32 vcc, 25, v32
v_mad_u32_u16 v141, v205, 1, v7 op_sel:[1,0,0,0]
ds_add_u32 v141, v16
v_cmpx_lt_i32 vcc, 26, v32
v_mad_u32_u16 v142, v206, 1, v7 op_sel:[1,0,0,0]
ds_add_u32 v142, v16
v_cmpx_lt_i32 vcc, 27, v32
v_mad_u32_u16 v143, v207, 1, v7 op_sel:[1,0,0,0]
ds_add_u32 v143, v16
s_waitcnt vmcnt(11)
v_cmpx_lt_i32 vcc, 32, v32
s_cbranch_execz LE_c
v_mad_u32_u16 v144, v208, 1, v7 op_sel:[1,0,0,0]
ds_add_u32 v144, v16
v_cmpx_lt_i32 vcc, 33, v32
v_mad_u32_u16 v145, v209, 1, v7 op_sel:[1,0,0,0]
ds_add_u32 v145, v16
v_cmpx_lt_i32 vcc, 34, v32
v_mad_u32_u16 v146, v210, 1, v7 op_sel:[1,0,0,0]
ds_add_u32 v146, v16
v_cmpx_lt_i32 vcc, 35, v32
v_mad_u32_u16 v147, v211, 1, v7 op_sel:[1,0,0,0]
ds_add_u32 v147, v16
s_waitcnt vmcnt(10)
v_cmpx_lt_i32 vcc, 40, v32
s_cbranch_execz LE_c
v_mad_u32_u16 v148, v212, 1, v7 op_sel:[1,0,0,0]
ds_add_u32 v148, v16
v_cmpx_lt_i32 vcc, 41, v32
v_mad_u32_u16 v149, v213, 1, v7 op_sel:[1,0,0,0]
ds_add_u32 v149, v16
v_cmpx_lt_i32 vcc, 42, v32
v_mad_u32_u16 v150, v214, 1, v7 op_sel:[1,0,0,0]
ds_add_u32 v150, v16
v_cmpx_lt_i32 vcc, 43, v32
v_mad_u32_u16 v151, v215, 1, v7 op_sel:[1,0,0,0]
ds_add_u32 v151, v16
s_waitcnt vmcnt(9)
v_cmpx_lt_i32 vcc, 48, v32
s_cbranch_execz LE_c
v_mad_u32_u16 v152, v216, 1, v7 op_sel:[1,0,0,0]
ds_add_u32 v152, v16
v_cmpx_lt_i32 vcc, 49, v32
v_mad_u32_u16 v153, v217, 1, v7 op_sel:[1,0,0,0]
ds_add_u32 v153, v16
v_cmpx_lt_i32 vcc, 50, v32
v_mad_u32_u16 v154, v218, 1, v7 op_sel:[1,0,0,0]
ds_add_u32 v154, v16
v_cmpx_lt_i32 vcc, 51, v32
v_mad_u32_u16 v155, v219, 1, v7 op_sel:[1,0,0,0]
ds_add_u32 v155, v16
s_waitcnt vmcnt(8)
v_cmpx_lt_i32 vcc, 56, v32
s_cbranch_execz LE_c
v_mad_u32_u16 v156, v220, 1, v7 op_sel:[1,0,0,0]
ds_add_u32 v156, v16
v_cmpx_lt_i32 vcc, 57, v32
v_mad_u32_u16 v157, v221, 1, v7 op_sel:[1,0,0,0]
ds_add_u32 v157, v16
v_cmpx_lt_i32 vcc, 58, v32
v_mad_u32_u16 v158, v222, 1, v7 op_sel:[1,0,0,0]
ds_add_u32 v158, v16
v_cmpx_lt_i32 vcc, 59, v32
v_mad_u32_u16 v159, v223, 1, v7 op_sel:[1,0,0,0]
ds_add_u32 v159, v16
s_waitcnt vmcnt(7)
v_cmpx_lt_i32 vcc, 64, v32
s_cbranch_execz LE_c
v_mad_u32_u16 v160, v224, 1, v7 op_sel:[1,0,0,0]
ds_add_u32 v160, v16
v_cmpx_lt_i32 vcc, 65, v32
v_mad_u32_u16 v161, v225, 1, v7 op_sel:[1,0,0,0]
ds_add_u32 v161, v16
v_cmpx_lt_i32 vcc, 66, v32
v_mad_u32_u16 v162, v226, 1, v7 op_sel:[1,0,0,0]
ds_add_u32 v162, v16
v_cmpx_lt_i32 vcc, 67, v32
v_mad_u32_u16 v163, v227, 1, v7 op_sel:[1,0,0,0]
ds_add_u32 v163, v16
s_waitcnt vmcnt(6)
v_cmpx_lt_i32 vcc, 72, v32
s_cbranch_execz LE_c
v_mad_u32_u16 v164, v228, 1, v7 op_sel:[1,0,0,0]
ds_add_u32 v164, v16
v_cmpx_lt_i32 vcc, 73, v32
v_mad_u32_u16 v165, v229, 1, v7 op_sel:[1,0,0,0]
ds_add_u32 v165, v16
v_cmpx_lt_i32 vcc, 74, v32
v_mad_u32_u16 v166, v230, 1, v7 op_sel:[1,0,0,0]
ds_add_u32 v166, v16
v_cmpx_lt_i32 vcc, 75, v32
v_mad_u32_u16 v167, v231, 1, v7 op_sel:[1,0,0,0]
ds_add_u32 v167, v16
s_waitcnt vmcnt(5)
v_cmpx_lt_i32 vcc, 80, v32
s_cbranch_execz LE_c
v_mad_u32_u16 v168, v232, 1, v7 op_sel:[1,0,0,0]
ds_add_u32 v168, v16
v_cmpx_lt_i32 vcc, 81, v32
v_mad_u32_u16 v169, v233, 1, v7 op_sel:[1,0,0,0]
ds_add_u32 v169, v16
v_cmpx_lt_i32 vcc, 82, v32
v_mad_u32_u16 v170, v234, 1, v7 op_sel:[1,0,0,0]
ds_add_u32 v170, v16
v_cmpx_lt_i32 vcc, 83, v32
v_mad_u32_u16 v171, v235, 1, v7 op_sel:[1,0,0,0]
ds_add_u32 v171, v16
s_waitcnt vmcnt(4)
v_cmpx_lt_i32 vcc, 88, v32
s_cbranch_execz LE_c
v_mad_u32_u16 v172, v236, 1, v7 op_sel:[1,0,0,0]
ds_add_u32 v172, v16
v_cmpx_lt_i32 vcc, 89, v32
v_mad_u32_u16 v173, v237, 1, v7 op_sel:[1,0,0,0]
ds_add_u32 v173, v16
v_cmpx_lt_i32 vcc, 90, v32
v_mad_u32_u16 v174, v238, 1, v7 op_sel:[1,0,0,0]
ds_add_u32 v174, v16
v_cmpx_lt_i32 vcc, 91, v32
v_mad_u32_u16 v175, v239, 1, v7 op_sel:[1,0,0,0]
ds_add_u32 v175, v16
s_waitcnt vmcnt(3)
v_cmpx_lt_i32 vcc, 96, v32
s_cbranch_execz LE_c
v_mad_u32_u16 v176, v240, 1, v7 op_sel:[1,0,0,0]
ds_add_u32 v176, v16
v_cmpx_lt_i32 vcc, 97, v32
v_mad_u32_u16 v177, v241, 1, v7 op_sel:[1,0,0,0]
ds_add_u32 v177, v16
v_cmpx_lt_i32 vcc, 98, v32
v_mad_u32_u16 v178, v242, 1, v7 op_sel:[1,0,0,0]
ds_add_u32 v178, v16
v_cmpx_lt_i32 vcc, 99, v32
v_mad_u32_u16 v179, v243, 1, v7 op_sel:[1,0,0,0]
ds_add_u32 v179, v16
s_waitcnt vmcnt(2)
v_cmpx_lt_i32 vcc, 104, v32
s_cbranch_execz LE_c
v_mad_u32_u16 v180, v244, 1, v7 op_sel:[1,0,0,0]
ds_add_u32 v180, v16
v_cmpx_lt_i32 vcc, 105, v32
v_mad_u32_u16 v181, v245, 1, v7 op_sel:[1,0,0,0]
ds_add_u32 v181, v16
v_cmpx_lt_i32 vcc, 106, v32
v_mad_u32_u16 v182, v246, 1, v7 op_sel:[1,0,0,0]
ds_add_u32 v182, v16
v_cmpx_lt_i32 vcc, 107, v32
v_mad_u32_u16 v183, v247, 1, v7 op_sel:[1,0,0,0]
ds_add_u32 v183, v16
s_waitcnt vmcnt(1)
v_cmpx_lt_i32 vcc, 112, v32
s_cbranch_execz LE_c
v_mad_u32_u16 v184, v248, 1, v7 op_sel:[1,0,0,0]
ds_add_u32 v184, v16
v_cmpx_lt_i32 vcc, 113, v32
v_mad_u32_u16 v185, v249, 1, v7 op_sel:[1,0,0,0]
ds_add_u32 v185, v16
v_cmpx_lt_i32 vcc, 114, v32
v_mad_u32_u16 v186, v250, 1, v7 op_sel:[1,0,0,0]
ds_add_u32 v186, v16
v_cmpx_lt_i32 vcc, 115, v32
v_mad_u32_u16 v187, v251, 1, v7 op_sel:[1,0,0,0]
ds_add_u32 v187, v16
s_waitcnt vmcnt(0)
v_cmpx_lt_i32 vcc, 120, v32
s_cbranch_execz LE_c
v_mad_u32_u16 v188, v252, 1, v7 op_sel:[1,0,0,0]
ds_add_u32 v188, v16
v_cmpx_lt_i32 vcc, 121, v32
v_mad_u32_u16 v189, v253, 1, v7 op_sel:[1,0,0,0]
ds_add_u32 v189, v16
v_cmpx_lt_i32 vcc, 122, v32
v_mad_u32_u16 v190, v254, 1, v7 op_sel:[1,0,0,0]
ds_add_u32 v190, v16
v_cmpx_lt_i32 vcc, 123, v32
v_mad_u32_u16 v191, v255, 1, v7 op_sel:[1,0,0,0]
ds_add_u32 v191, v16
LE_c:
s_mov_b64 exec, -1
ds_read_b128 v[24:27], v35
s_waitcnt lgkmcnt(0)
v_add_u32 v24, 3, v24
v_lshrrev_b32 v24, 2, v24
v_max_u32 v24, v24, v18
v_add_u32 v25, 3, v25
v_lshrrev_b32 v25, 2, v25
v_max_u32 v25, v25, v19
v_add_u32 v26, 3, v26
v_lshrrev_b32 v26, 2, v26
v_max_u32 v26, v26, v20
v_add_u32 v27, 3, v27
v_lshrrev_b32 v27, 2, v27
v_max_u32 v27, v27, v21
v_add_u32 v33, v24, v25
v_add3_u32 v33, v33, v26, v27
v_mov_b32 v64, v33
s_nop 1
v_add_u32_dpp v64, v64, v64 row_shr:1 row_mask:0xf bank_mask:0xf
s_nop 1
v_add_u32_dpp v64, v64, v64 row_shr:2 row_mask:0xf bank_mask:0xf
s_nop 1
v_add_u32_dpp v64, v64, v64 row_shr:4 row_mask:0xf bank_mask:0xf
s_nop 1
v_add_u32_dpp v64, v64, v64 row_shr:8 row_mask:0xf bank_mask:0xf
s_nop 1
v_add_u32_dpp v64, v64, v64 row_bcast:15 row_mask:0xa bank_mask:0xf
s_nop 1
v_add_u32_dpp v64, v64, v64 row_bcast:31 row_mask:0xc bank_mask:0xf
s_nop 1
v_readlane_b32 s44, v64, 63
v_sub_u32 v28, v64, v33
v_add_u32 v29, v28, v24
v_add_u32 v30, v29, v25
v_add_u32 v31, v30, v26
v_add3_u32 v33, v28, v24, -1
v_lshlrev_b32 v34, v33, v18
v_lshrrev_b32 v33, 5, v33
v_lshl_add_u32 v33, v33, 2, v36
ds_or_b32 v33, v34 offset:20480
v_lshl_add_u32 v28, v28, 4, v36
v_add3_u32 v33, v29, v25, -1
v_lshlrev_b32 v34, v33, v19
v_lshrrev_b32 v33, 5, v33
v_lshl_add_u32 v33, v33, 2, v36
ds_or_b32 v33, v34 offset:20480
v_lshl_add_u32 v29, v29, 4, v36
v_add3_u32 v33, v30, v26, -1
v_lshlrev_b32 v34, v33, v20
v_lshrrev_b32 v33, 5, v33
v_lshl_add_u32 v33, v33, 2, v36
ds_or_b32 v33, v34 offset:20480
v_lshl_add_u32 v30, v30, 4, v36
v_add3_u32 v33, v31, v27, -1
v_lshlrev_b32 v34, v33, v21
v_lshrrev_b32 v33, 5, v33
v_lshl_add_u32 v33, v33, 2, v36
ds_or_b32 v33, v34 offset:20480
v_lshl_add_u32 v31, v31, 4, v36
ds_write_b128 v35, v[28:31]
s_add_u32 s44, s44, 31
s_lshr_b32 s44, s44, 5
v_cmpx_lt_i32 vcc, 0, v32
s_cbranch_execz LE_p
ds_add_rtn_u32 v128, v128, v17
v_cmpx_lt_i32 vcc, 1, v32
ds_add_rtn_u32 v129, v129, v17
v_cmpx_lt_i32 vcc, 2, v32
ds_add_rtn_u32 v130, v130, v17
v_cmpx_lt_i32 vcc, 3, v32
ds_add_rtn_u32 v131, v131, v17
v_cmpx_lt_i32 vcc, 8, v32
s_cbranch_execz LE_p
ds_add_rtn_u32 v132, v132, v17
v_cmpx_lt_i32 vcc, 9, v32
ds_add_rtn_u32 v133, v133, v17
v_cmpx_lt_i32 vcc, 10, v32
ds_add_rtn_u32 v134, v134, v17
v_cmpx_lt_i32 vcc, 11, v32
ds_add_rtn_u32 v135, v135, v17
v_cmpx_lt_i32 vcc, 16, v32
s_cbranch_execz LE_p
ds_add_rtn_u32 v136, v136, v17
v_cmpx_lt_i32 vcc, 17, v32
ds_add_rtn_u32 v137, v137, v17
v_cmpx_lt_i32 vcc, 18, v32
ds_add_rtn_u32 v138, v138, v17
v_cmpx_lt_i32 vcc, 19, v32
ds_add_rtn_u32 v139, v139, v17
v_cmpx_lt_i32 vcc, 24, v32
s_cbranch_execz LE_p
ds_add_rtn_u32 v140, v140, v17
v_cmpx_lt_i32 vcc, 25, v32
ds_add_rtn_u32 v141, v141, v17
v_cmpx_lt_i32 vcc, 26, v32
ds_add_rtn_u32 v142, v142, v17
v_cmpx_lt_i32 vcc, 27, v32
ds_add_rtn_u32 v143, v143, v17
v_cmpx_lt_i32 vcc, 32, v32
s_cbranch_execz LE_p
ds_add_rtn_u32 v144, v144, v17
v_cmpx_lt_i32 vcc, 33, v32
ds_add_rtn_u32 v145, v145, v17
v_cmpx_lt_i32 vcc, 34, v32
ds_add_rtn_u32 v146, v146, v17
v_cmpx_lt_i32 vcc, 35, v32
ds_add_rtn_u32 v147, v147, v17
v_cmpx_lt_i32 vcc, 40, v32
s_cbranch_execz LE_p
ds_add_rtn_u32 v148, v148, v17
v_cmpx_lt_i32 vcc, 41, v32
ds_add_rtn_u32 v149, v149, v17
v_cmpx_lt_i32 vcc, 42, v32
ds_add_rtn_u32 v150, v150, v17
v_cmpx_lt_i32 vcc, 43, v32
ds_add_rtn_u32 v151, v151, v17
v_cmpx_lt_i32 vcc, 48, v32
s_cbranch_execz LE_p
ds_add_rtn_u32 v152, v152, v17
v_cmpx_lt_i32 vcc, 49, v32
ds_add_rtn_u32 v153, v153, v17
v_cmpx_lt_i32 vcc, 50, v32
ds_add_rtn_u32 v154, v154, v17
v_cmpx_lt_i32 vcc, 51, v32
ds_add_rtn_u32 v155, v155, v17
v_cmpx_lt_i32 vcc, 56, v32
s_cbranch_execz LE_p
ds_add_rtn_u32 v156, v156, v17
v_cmpx_lt_i32 vcc, 57, v32
ds_add_rtn_u32 v157, v157, v17
v_cmpx_lt_i32 vcc, 58, v32
ds_add_rtn_u32 v158, v158, v17
v_cmpx_lt_i32 vcc, 59, v32
ds_add_rtn_u32 v159, v159, v17
v_cmpx_lt_i32 vcc, 64, v32
s_cbranch_execz LE_p
ds_add_rtn_u32 v160, v160, v17
v_cmpx_lt_i32 vcc, 65, v32
ds_add_rtn_u32 v161, v161, v17
v_cmpx_lt_i32 vcc, 66, v32
ds_add_rtn_u32 v162, v162, v17
v_cmpx_lt_i32 vcc, 67, v32
ds_add_rtn_u32 v163, v163, v17
v_cmpx_lt_i32 vcc, 72, v32
s_cbranch_execz LE_p
ds_add_rtn_u32 v164, v164, v17
v_cmpx_lt_i32 vcc, 73, v32
ds_add_rtn_u32 v165, v165, v17
v_cmpx_lt_i32 vcc, 74, v32
ds_add_rtn_u32 v166, v166, v17
v_cmpx_lt_i32 vcc, 75, v32
ds_add_rtn_u32 v167, v167, v17
v_cmpx_lt_i32 vcc, 80, v32
s_cbranch_execz LE_p
ds_add_rtn_u32 v168, v168, v17
v_cmpx_lt_i32 vcc, 81, v32
ds_add_rtn_u32 v169, v169, v17
v_cmpx_lt_i32 vcc, 82, v32
ds_add_rtn_u32 v170, v170, v17
v_cmpx_lt_i32 vcc, 83, v32
ds_add_rtn_u32 v171, v171, v17
v_cmpx_lt_i32 vcc, 88, v32
s_cbranch_execz LE_p
ds_add_rtn_u32 v172, v172, v17
v_cmpx_lt_i32 vcc, 89, v32
ds_add_rtn_u32 v173, v173, v17
v_cmpx_lt_i32 vcc, 90, v32
ds_add_rtn_u32 v174, v174, v17
v_cmpx_lt_i32 vcc, 91, v32
ds_add_rtn_u32 v175, v175, v17
v_cmpx_lt_i32 vcc, 96, v32
s_cbranch_execz LE_p
ds_add_rtn_u32 v176, v176, v17
v_cmpx_lt_i32 vcc, 97, v32
ds_add_rtn_u32 v177, v177, v17
v_cmpx_lt_i32 vcc, 98, v32
ds_add_rtn_u32 v178, v178, v17
v_cmpx_lt_i32 vcc, 99, v32
ds_add_rtn_u32 v179, v179, v17
v_cmpx_lt_i32 vcc, 104, v32
s_cbranch_execz LE_p
ds_add_rtn_u32 v180, v180, v17
v_cmpx_lt_i32 vcc, 105, v32
ds_add_rtn_u32 v181, v181, v17
v_cmpx_lt_i32 vcc, 106, v32
ds_add_rtn_u32 v182, v182, v17
v_cmpx_lt_i32 vcc, 107, v32
ds_add_rtn_u32 v183, v183, v17
v_cmpx_lt_i32 vcc, 112, v32
s_cbranch_execz LE_p
ds_add_rtn_u32 v184, v184, v17
v_cmpx_lt_i32 vcc, 113, v32
ds_add_rtn_u32 v185, v185, v17
v_cmpx_lt_i32 vcc, 114, v32
ds_add_rtn_u32 v186, v186, v17
v_cmpx_lt_i32 vcc, 115, v32
ds_add_rtn_u32 v187, v187, v17
v_cmpx_lt_i32 vcc, 120, v32
s_cbranch_execz LE_p
ds_add_rtn_u32 v188, v188, v17
v_cmpx_lt_i32 vcc, 121, v32
ds_add_rtn_u32 v189, v189, v17
v_cmpx_lt_i32 vcc, 122, v32
ds_add_rtn_u32 v190, v190, v17
v_cmpx_lt_i32 vcc, 123, v32
ds_add_rtn_u32 v191, v191, v17
LE_p:
s_mov_b64 exec, -1
v_lshl_add_u32 v33, v1, 2, v36
ds_read_b32 v37, v33 offset:20480
s_waitcnt lgkmcnt(0)
v_cmpx_lt_i32 vcc, 0, v32
s_cbranch_execz LE_w
ds_write_b32 v128, v192
v_cmpx_lt_i32 vcc, 1, v32
ds_write_b32 v129, v193
v_cmpx_lt_i32 vcc, 2, v32
ds_write_b32 v130, v194
v_cmpx_lt_i32 vcc, 3, v32
ds_write_b32 v131, v195
v_cmpx_lt_i32 vcc, 8, v32
s_cbranch_execz LE_w
ds_write_b32 v132, v196
v_cmpx_lt_i32 vcc, 9, v32
ds_write_b32 v133, v197
v_cmpx_lt_i32 vcc, 10, v32
ds_write_b32 v134, v198
v_cmpx_lt_i32 vcc, 11, v32
ds_write_b32 v135, v199
v_cmpx_lt_i32 vcc, 16, v32
s_cbranch_execz LE_w
ds_write_b32 v136, v200
v_cmpx_lt_i32 vcc, 17, v32
ds_write_b32 v137, v201
v_cmpx_lt_i32 vcc, 18, v32
ds_write_b32 v138, v202
v_cmpx_lt_i32 vcc, 19, v32
ds_write_b32 v139, v203
v_cmpx_lt_i32 vcc, 24, v32
s_cbranch_execz LE_w
ds_write_b32 v140, v204
v_cmpx_lt_i32 vcc, 25, v32
ds_write_b32 v141, v205
v_cmpx_lt_i32 vcc, 26, v32
ds_write_b32 v142, v206
v_cmpx_lt_i32 vcc, 27, v32
ds_write_b32 v143, v207
v_cmpx_lt_i32 vcc, 32, v32
s_cbranch_execz LE_w
ds_write_b32 v144, v208
v_cmpx_lt_i32 vcc, 33, v32
ds_write_b32 v145, v209
v_cmpx_lt_i32 vcc, 34, v32
ds_write_b32 v146, v210
v_cmpx_lt_i32 vcc, 35, v32
ds_write_b32 v147, v211
v_cmpx_lt_i32 vcc, 40, v32
s_cbranch_execz LE_w
ds_write_b32 v148, v212
v_cmpx_lt_i32 vcc, 41, v32
ds_write_b32 v149, v213
v_cmpx_lt_i32 vcc, 42, v32
ds_write_b32 v150, v214
v_cmpx_lt_i32 vcc, 43, v32
ds_write_b32 v151, v215
v_cmpx_lt_i32 vcc, 48, v32
s_cbranch_execz LE_w
ds_write_b32 v152, v216
v_cmpx_lt_i32 vcc, 49, v32
ds_write_b32 v153, v217
v_cmpx_lt_i32 vcc, 50, v32
ds_write_b32 v154, v218
v_cmpx_lt_i32 vcc, 51, v32
ds_write_b32 v155, v219
v_cmpx_lt_i32 vcc, 56, v32
s_cbranch_execz LE_w
ds_write_b32 v156, v220
v_cmpx_lt_i32 vcc, 57, v32
ds_write_b32 v157, v221
v_cmpx_lt_i32 vcc, 58, v32
ds_write_b32 v158, v222
v_cmpx_lt_i32 vcc, 59, v32
ds_write_b32 v159, v223
v_cmpx_lt_i32 vcc, 64, v32
s_cbranch_execz LE_w
ds_write_b32 v160, v224
v_cmpx_lt_i32 vcc, 65, v32
ds_write_b32 v161, v225
v_cmpx_lt_i32 vcc, 66, v32
ds_write_b32 v162, v226
v_cmpx_lt_i32 vcc, 67, v32
ds_write_b32 v163, v227
v_cmpx_lt_i32 vcc, 72, v32
s_cbranch_execz LE_w
ds_write_b32 v164, v228
v_cmpx_lt_i32 vcc, 73, v32
ds_write_b32 v165, v229
v_cmpx_lt_i32 vcc, 74, v32
ds_write_b32 v166, v230
v_cmpx_lt_i32 vcc, 75, v32
ds_write_b32 v167, v231
v_cmpx_lt_i32 vcc, 80, v32
s_cbranch_execz LE_w
ds_write_b32 v168, v232
v_cmpx_lt_i32 vcc, 81, v32
ds_write_b32 v169, v233
v_cmpx_lt_i32 vcc, 82, v32
ds_write_b32 v170, v234
v_cmpx_lt_i32 vcc, 83, v32
ds_write_b32 v171, v235
v_cmpx_lt_i32 vcc, 88, v32
s_cbranch_execz LE_w
ds_write_b32 v172, v236
v_cmpx_lt_i32 vcc, 89, v32
ds_write_b32 v173, v237
v_cmpx_lt_i32 vcc, 90, v32
ds_write_b32 v174, v238
v_cmpx_lt_i32 vcc, 91, v32
ds_write_b32 v175, v239
v_cmpx_lt_i32 vcc, 96, v32
s_cbranch_execz LE_w
ds_write_b32 v176, v240
v_cmpx_lt_i32 vcc, 97, v32
ds_write_b32 v177, v241
v_cmpx_lt_i32 vcc, 98, v32
ds_write_b32 v178, v242
v_cmpx_lt_i32 vcc, 99, v32
ds_write_b32 v179, v243
v_cmpx_lt_i32 vcc, 104, v32
s_cbranch_execz LE_w
ds_write_b32 v180, v244
v_cmpx_lt_i32 vcc, 105, v32
ds_write_b32 v181, v245
v_cmpx_lt_i32 vcc, 106, v32
ds_write_b32 v182, v246
v_cmpx_lt_i32 vcc, 107, v32
ds_write_b32 v183, v247
v_cmpx_lt_i32 vcc, 112, v32
s_cbranch_execz LE_w
ds_write_b32 v184, v248
v_cmpx_lt_i32 vcc, 113, v32
ds_write_b32 v185, v249
v_cmpx_lt_i32 vcc, 114, v32
ds_write_b32 v186, v250
v_cmpx_lt_i32 vcc, 115, v32
ds_write_b32 v187, v251
v_cmpx_lt_i32 vcc, 120, v32
s_cbranch_execz LE_w
ds_write_b32 v188, v252
v_cmpx_lt_i32 vcc, 121, v32
ds_write_b32 v189, v253
v_cmpx_lt_i32 vcc, 122, v32
ds_write_b32 v190, v254
v_cmpx_lt_i32 vcc, 123, v32
ds_write_b32 v191, v255
LE_w:
s_mov_b64 exec, -1
v_mov_b32 v34, v38
ds_read2_b32 v[52:53], v34 offset0:0 offset1:4
ds_read2_b32 v[54:55], v34 offset0:8 offset1:12
s_waitcnt lgkmcnt(0)
ds_read2_b32 v[56:57], v34 offset0:16 offset1:20
ds_read2_b32 v[58:59], v34 offset0:24 offset1:28
v_mad_u32_u16 v60, v52, s49, v2
v_mad_u32_u16 v61, v53, s49, v2
v_mad_u32_u16 v62, v54, s49, v2
v_mad_u32_u16 v63, v55, s49, v2
buffer_load_dwordx4 a[0:3], v60, s[16:19], 0 offen
buffer_load_dwordx4 a[4:7], v60, s[16:19], 0 offen offset:256
buffer_load_dwordx4 a[8:11], v61, s[16:19], 0 offen
buffer_load_dwordx4 a[12:15], v61, s[16:19], 0 offen offset:256
buffer_load_dwordx4 a[16:19], v62, s[16:19], 0 offen
buffer_load_dwordx4 a[20:23], v62, s[16:19], 0 offen offset:256
buffer_load_dwordx4 a[24:27], v63, s[16:19], 0 offen
buffer_load_dwordx4 a[28:31], v63, s[16:19], 0 offen offset:256
s_waitcnt lgkmcnt(0)
ds_read2_b32 v[52:53], v34 offset0:32 offset1:36
ds_read2_b32 v[54:55], v34 offset0:40 offset1:44
v_mad_u32_u16 v60, v56, s49, v2
v_mad_u32_u16 v61, v57, s49, v2
v_mad_u32_u16 v62, v58, s49, v2
v_mad_u32_u16 v63, v59, s49, v2
buffer_load_dwordx4 a[32:35], v60, s[16:19], 0 offen
buffer_load_dwordx4 a[36:39], v60, s[16:19], 0 offen offset:256
buffer_load_dwordx4 a[40:43], v61, s[16:19], 0 offen
buffer_load_dwordx4 a[44:47], v61, s[16:19], 0 offen offset:256
buffer_load_dwordx4 a[48:51], v62, s[16:19], 0 offen
buffer_load_dwordx4 a[52:55], v62, s[16:19], 0 offen offset:256
buffer_load_dwordx4 a[56:59], v63, s[16:19], 0 offen
buffer_load_dwordx4 a[60:63], v63, s[16:19], 0 offen offset:256
s_waitcnt lgkmcnt(0)
ds_read2_b32 v[56:57], v34 offset0:48 offset1:52
ds_read2_b32 v[58:59], v34 offset0:56 offset1:60
v_mad_u32_u16 v60, v52, s49, v2
v_mad_u32_u16 v61, v53, s49, v2
v_mad_u32_u16 v62, v54, s49, v2
v_mad_u32_u16 v63, v55, s49, v2
buffer_load_dwordx4 a[64:67], v60, s[16:19], 0 offen
buffer_load_dwordx4 a[68:71], v60, s[16:19], 0 offen offset:256
buffer_load_dwordx4 a[72:75], v61, s[16:19], 0 offen
buffer_load_dwordx4 a[76:79], v61, s[16:19], 0 offen offset:256
buffer_load_dwordx4 a[80:83], v62, s[16:19], 0 offen
buffer_load_dwordx4 a[84:87], v62, s[16:19], 0 offen offset:256
buffer_load_dwordx4 a[88:91], v63, s[16:19], 0 offen
buffer_load_dwordx4 a[92:95], v63, s[16:19], 0 offen offset:256
s_waitcnt lgkmcnt(0)
ds_read2_b32 v[52:53], v34 offset0:64 offset1:68
ds_read2_b32 v[54:55], v34 offset0:72 offset1:76
v_mad_u32_u16 v60, v56, s49, v2
v_mad_u32_u16 v61, v57, s49, v2
v_mad_u32_u16 v62, v58, s49, v2
v_mad_u32_u16 v63, v59, s49, v2
buffer_load_dwordx4 a[96:99], v60, s[16:19], 0 offen
buffer_load_dwordx4 a[100:103], v60, s[16:19], 0 offen offset:256
buffer_load_dwordx4 a[104:107], v61, s[16:19], 0 offen
buffer_load_dwordx4 a[108:111], v61, s[16:19], 0 offen offset:256
buffer_load_dwordx4 a[112:115], v62, s[16:19], 0 offen
buffer_load_dwordx4 a[116:119], v62, s[16:19], 0 offen offset:256
buffer_load_dwordx4 a[120:123], v63, s[16:19], 0 offen
buffer_load_dwordx4 a[124:127], v63, s[16:19], 0 offen offset:256
s_waitcnt lgkmcnt(0)
ds_read2_b32 v[56:57], v34 offset0:80 offset1:84
ds_read2_b32 v[58:59], v34 offset0:88 offset1:92
v_mad_u32_u16 v60, v52, s49, v2
v_mad_u32_u16 v61, v53, s49, v2
v_mad_u32_u16 v62, v54, s49, v2
v_mad_u32_u16 v63, v55, s49, v2
buffer_load_dwordx4 a[128:131], v60, s[16:19], 0 offen
buffer_load_dwordx4 a[132:135], v60, s[16:19], 0 offen offset:256
buffer_load_dwordx4 a[136:139], v61, s[16:19], 0 offen
buffer_load_dwordx4 a[140:143], v61, s[16:19], 0 offen offset:256
buffer_load_dwordx4 a[144:147], v62, s[16:19], 0 offen
buffer_load_dwordx4 a[148:151], v62, s[16:19], 0 offen offset:256
buffer_load_dwordx4 a[152:155], v63, s[16:19], 0 offen
buffer_load_dwordx4 a[156:159], v63, s[16:19], 0 offen offset:256
s_waitcnt lgkmcnt(0)
ds_read2_b32 v[52:53], v34 offset0:96 offset1:100
ds_read2_b32 v[54:55], v34 offset0:104 offset1:108
v_mad_u32_u16 v60, v56, s49, v2
v_mad_u32_u16 v61, v57, s49, v2
v_mad_u32_u16 v62, v58, s49, v2
v_mad_u32_u16 v63, v59, s49, v2
buffer_load_dwordx4 a[160:163], v60, s[16:19], 0 offen
buffer_load_dwordx4 a[164:167], v60, s[16:19], 0 offen offset:256
buffer_load_dwordx4 a[168:171], v61, s[16:19], 0 offen
buffer_load_dwordx4 a[172:175], v61, s[16:19], 0 offen offset:256
buffer_load_dwordx4 a[176:179], v62, s[16:19], 0 offen
buffer_load_dwordx4 a[180:183], v62, s[16:19], 0 offen offset:256
buffer_load_dwordx4 a[184:187], v63, s[16:19], 0 offen
buffer_load_dwordx4 a[188:191], v63, s[16:19], 0 offen offset:256
s_waitcnt lgkmcnt(0)
ds_read2_b32 v[56:57], v34 offset0:112 offset1:116
ds_read2_b32 v[58:59], v34 offset0:120 offset1:124
v_mad_u32_u16 v60, v52, s49, v2
v_mad_u32_u16 v61, v53, s49, v2
v_mad_u32_u16 v62, v54, s49, v2
v_mad_u32_u16 v63, v55, s49, v2
buffer_load_dwordx4 a[192:195], v60, s[16:19], 0 offen
buffer_load_dwordx4 a[196:199], v60, s[16:19], 0 offen offset:256
buffer_load_dwordx4 a[200:203], v61, s[16:19], 0 offen
buffer_load_dwordx4 a[204:207], v61, s[16:19], 0 offen offset:256
buffer_load_dwordx4 a[208:211], v62, s[16:19], 0 offen
buffer_load_dwordx4 a[212:215], v62, s[16:19], 0 offen offset:256
buffer_load_dwordx4 a[216:219], v63, s[16:19], 0 offen
buffer_load_dwordx4 a[220:223], v63, s[16:19], 0 offen offset:256
s_waitcnt lgkmcnt(0)
ds_read2_b32 v[52:53], v34 offset0:128 offset1:132
ds_read2_b32 v[54:55], v34 offset0:136 offset1:140
v_mad_u32_u16 v60, v56, s49, v2
v_mad_u32_u16 v61, v57, s49, v2
v_mad_u32_u16 v62, v58, s49, v2
v_mad_u32_u16 v63, v59, s49, v2
buffer_load_dwordx4 a[224:227], v60, s[16:19], 0 offen
buffer_load_dwordx4 a[228:231], v60, s[16:19], 0 offen offset:256
buffer_load_dwordx4 a[232:235], v61, s[16:19], 0 offen
buffer_load_dwordx4 a[236:239], v61, s[16:19], 0 offen offset:256
buffer_load_dwordx4 a[240:243], v62, s[16:19], 0 offen
buffer_load_dwordx4 a[244:247], v62, s[16:19], 0 offen offset:256
buffer_load_dwordx4 a[248:251], v63, s[16:19], 0 offen
buffer_load_dwordx4 a[252:255], v63, s[16:19], 0 offen offset:256
v_add_u32 v34, 512, v34
s_mov_b32 s45, 0
s_mul_i32 s47, s40, 80384
LE_loop:
v_readlane_b32 s46, v37, s45
s_add_u32 s45, s45, 1
s_waitcnt vmcnt(56)
v_mfma_f32_16x16x32_bf16 v[48:51], a[0:3], v[40:43], v[48:51]
v_mfma_f32_16x16x32_bf16 v[48:51], a[4:7], v[44:47], v[48:51]
s_bitcmp1_b32 s46, 0
s_cbranch_scc0 LE_nf0
s_cmp_eq_u32 s42, 0
s_cbranch_scc1 LE_fl0
buffer_load_dwordx2 v[66:67], v39, s[20:23], s47 offen sc1
s_waitcnt vmcnt(0)
v_lshlrev_b32 v64, 16, v66
v_and_b32 v65, 0xffff0000, v66
v_add_f32 v48, v48, v64
v_add_f32 v49, v49, v65
v_lshlrev_b32 v64, 16, v67
v_and_b32 v65, 0xffff0000, v67
v_add_f32 v50, v50, v64
v_add_f32 v51, v51, v65
LE_fl0:
s_nop 3
v_cvt_pk_bf16_f32 v64, v48, v49
v_cvt_pk_bf16_f32 v65, v50, v51
v_mov_b32 v48, 0
v_mov_b32 v49, 0
v_mov_b32 v50, 0
v_mov_b32 v51, 0
buffer_store_dwordx2 v[64:65], v39, s[20:23], s47 offen
s_add_u32 s47, s47, 512
LE_nf0:
v_mfma_f32_16x16x32_bf16 v[48:51], a[8:11], v[40:43], v[48:51]
v_mfma_f32_16x16x32_bf16 v[48:51], a[12:15], v[44:47], v[48:51]
s_bitcmp1_b32 s46, 1
s_cbranch_scc0 LE_nf1
s_cmp_eq_u32 s42, 0
s_cbranch_scc1 LE_fl1
buffer_load_dwordx2 v[66:67], v39, s[20:23], s47 offen sc1
s_waitcnt vmcnt(0)
v_lshlrev_b32 v64, 16, v66
v_and_b32 v65, 0xffff0000, v66
v_add_f32 v48, v48, v64
v_add_f32 v49, v49, v65
v_lshlrev_b32 v64, 16, v67
v_and_b32 v65, 0xffff0000, v67
v_add_f32 v50, v50, v64
v_add_f32 v51, v51, v65
LE_fl1:
s_nop 3
v_cvt_pk_bf16_f32 v64, v48, v49
v_cvt_pk_bf16_f32 v65, v50, v51
v_mov_b32 v48, 0
v_mov_b32 v49, 0
v_mov_b32 v50, 0
v_mov_b32 v51, 0
buffer_store_dwordx2 v[64:65], v39, s[20:23], s47 offen
s_add_u32 s47, s47, 512
LE_nf1:
v_mfma_f32_16x16x32_bf16 v[48:51], a[16:19], v[40:43], v[48:51]
v_mfma_f32_16x16x32_bf16 v[48:51], a[20:23], v[44:47], v[48:51]
s_bitcmp1_b32 s46, 2
s_cbranch_scc0 LE_nf2
s_cmp_eq_u32 s42, 0
s_cbranch_scc1 LE_fl2
buffer_load_dwordx2 v[66:67], v39, s[20:23], s47 offen sc1
s_waitcnt vmcnt(0)
v_lshlrev_b32 v64, 16, v66
v_and_b32 v65, 0xffff0000, v66
v_add_f32 v48, v48, v64
v_add_f32 v49, v49, v65
v_lshlrev_b32 v64, 16, v67
v_and_b32 v65, 0xffff0000, v67
v_add_f32 v50, v50, v64
v_add_f32 v51, v51, v65
LE_fl2:
s_nop 3
v_cvt_pk_bf16_f32 v64, v48, v49
v_cvt_pk_bf16_f32 v65, v50, v51
v_mov_b32 v48, 0
v_mov_b32 v49, 0
v_mov_b32 v50, 0
v_mov_b32 v51, 0
buffer_store_dwordx2 v[64:65], v39, s[20:23], s47 offen
s_add_u32 s47, s47, 512
LE_nf2:
v_mfma_f32_16x16x32_bf16 v[48:51], a[24:27], v[40:43], v[48:51]
v_mfma_f32_16x16x32_bf16 v[48:51], a[28:31], v[44:47], v[48:51]
s_bitcmp1_b32 s46, 3
s_cbranch_scc0 LE_nf3
s_cmp_eq_u32 s42, 0
s_cbranch_scc1 LE_fl3
buffer_load_dwordx2 v[66:67], v39, s[20:23], s47 offen sc1
s_waitcnt vmcnt(0)
v_lshlrev_b32 v64, 16, v66
v_and_b32 v65, 0xffff0000, v66
v_add_f32 v48, v48, v64
v_add_f32 v49, v49, v65
v_lshlrev_b32 v64, 16, v67
v_and_b32 v65, 0xffff0000, v67
v_add_f32 v50, v50, v64
v_add_f32 v51, v51, v65
LE_fl3:
s_nop 3
v_cvt_pk_bf16_f32 v64, v48, v49
v_cvt_pk_bf16_f32 v65, v50, v51
v_mov_b32 v48, 0
v_mov_b32 v49, 0
v_mov_b32 v50, 0
v_mov_b32 v51, 0
buffer_store_dwordx2 v[64:65], v39, s[20:23], s47 offen
s_add_u32 s47, s47, 512
LE_nf3:
s_waitcnt lgkmcnt(0)
ds_read2_b32 v[56:57], v34 offset0:16 offset1:20
ds_read2_b32 v[58:59], v34 offset0:24 offset1:28
v_mad_u32_u16 v60, v52, s49, v2
v_mad_u32_u16 v61, v53, s49, v2
v_mad_u32_u16 v62, v54, s49, v2
v_mad_u32_u16 v63, v55, s49, v2
buffer_load_dwordx4 a[0:3], v60, s[16:19], 0 offen
buffer_load_dwordx4 a[4:7], v60, s[16:19], 0 offen offset:256
buffer_load_dwordx4 a[8:11], v61, s[16:19], 0 offen
buffer_load_dwordx4 a[12:15], v61, s[16:19], 0 offen offset:256
buffer_load_dwordx4 a[16:19], v62, s[16:19], 0 offen
buffer_load_dwordx4 a[20:23], v62, s[16:19], 0 offen offset:256
buffer_load_dwordx4 a[24:27], v63, s[16:19], 0 offen
buffer_load_dwordx4 a[28:31], v63, s[16:19], 0 offen offset:256
s_waitcnt vmcnt(56)
v_mfma_f32_16x16x32_bf16 v[48:51], a[32:35], v[40:43], v[48:51]
v_mfma_f32_16x16x32_bf16 v[48:51], a[36:39], v[44:47], v[48:51]
s_bitcmp1_b32 s46, 4
s_cbranch_scc0 LE_nf4
s_cmp_eq_u32 s42, 0
s_cbranch_scc1 LE_fl4
buffer_load_dwordx2 v[66:67], v39, s[20:23], s47 offen sc1
s_waitcnt vmcnt(0)
v_lshlrev_b32 v64, 16, v66
v_and_b32 v65, 0xffff0000, v66
v_add_f32 v48, v48, v64
v_add_f32 v49, v49, v65
v_lshlrev_b32 v64, 16, v67
v_and_b32 v65, 0xffff0000, v67
v_add_f32 v50, v50, v64
v_add_f32 v51, v51, v65
LE_fl4:
s_nop 3
v_cvt_pk_bf16_f32 v64, v48, v49
v_cvt_pk_bf16_f32 v65, v50, v51
v_mov_b32 v48, 0
v_mov_b32 v49, 0
v_mov_b32 v50, 0
v_mov_b32 v51, 0
buffer_store_dwordx2 v[64:65], v39, s[20:23], s47 offen
s_add_u32 s47, s47, 512
LE_nf4:
v_mfma_f32_16x16x32_bf16 v[48:51], a[40:43], v[40:43], v[48:51]
v_mfma_f32_16x16x32_bf16 v[48:51], a[44:47], v[44:47], v[48:51]
s_bitcmp1_b32 s46, 5
s_cbranch_scc0 LE_nf5
s_cmp_eq_u32 s42, 0
s_cbranch_scc1 LE_fl5
buffer_load_dwordx2 v[66:67], v39, s[20:23], s47 offen sc1
s_waitcnt vmcnt(0)
v_lshlrev_b32 v64, 16, v66
v_and_b32 v65, 0xffff0000, v66
v_add_f32 v48, v48, v64
v_add_f32 v49, v49, v65
v_lshlrev_b32 v64, 16, v67
v_and_b32 v65, 0xffff0000, v67
v_add_f32 v50, v50, v64
v_add_f32 v51, v51, v65
LE_fl5:
s_nop 3
v_cvt_pk_bf16_f32 v64, v48, v49
v_cvt_pk_bf16_f32 v65, v50, v51
v_mov_b32 v48, 0
v_mov_b32 v49, 0
v_mov_b32 v50, 0
v_mov_b32 v51, 0
buffer_store_dwordx2 v[64:65], v39, s[20:23], s47 offen
s_add_u32 s47, s47, 512
LE_nf5:
v_mfma_f32_16x16x32_bf16 v[48:51], a[48:51], v[40:43], v[48:51]
v_mfma_f32_16x16x32_bf16 v[48:51], a[52:55], v[44:47], v[48:51]
s_bitcmp1_b32 s46, 6
s_cbranch_scc0 LE_nf6
s_cmp_eq_u32 s42, 0
s_cbranch_scc1 LE_fl6
buffer_load_dwordx2 v[66:67], v39, s[20:23], s47 offen sc1
s_waitcnt vmcnt(0)
v_lshlrev_b32 v64, 16, v66
v_and_b32 v65, 0xffff0000, v66
v_add_f32 v48, v48, v64
v_add_f32 v49, v49, v65
v_lshlrev_b32 v64, 16, v67
v_and_b32 v65, 0xffff0000, v67
v_add_f32 v50, v50, v64
v_add_f32 v51, v51, v65
LE_fl6:
s_nop 3
v_cvt_pk_bf16_f32 v64, v48, v49
v_cvt_pk_bf16_f32 v65, v50, v51
v_mov_b32 v48, 0
v_mov_b32 v49, 0
v_mov_b32 v50, 0
v_mov_b32 v51, 0
buffer_store_dwordx2 v[64:65], v39, s[20:23], s47 offen
s_add_u32 s47, s47, 512
LE_nf6:
v_mfma_f32_16x16x32_bf16 v[48:51], a[56:59], v[40:43], v[48:51]
v_mfma_f32_16x16x32_bf16 v[48:51], a[60:63], v[44:47], v[48:51]
s_bitcmp1_b32 s46, 7
s_cbranch_scc0 LE_nf7
s_cmp_eq_u32 s42, 0
s_cbranch_scc1 LE_fl7
buffer_load_dwordx2 v[66:67], v39, s[20:23], s47 offen sc1
s_waitcnt vmcnt(0)
v_lshlrev_b32 v64, 16, v66
v_and_b32 v65, 0xffff0000, v66
v_add_f32 v48, v48, v64
v_add_f32 v49, v49, v65
v_lshlrev_b32 v64, 16, v67
v_and_b32 v65, 0xffff0000, v67
v_add_f32 v50, v50, v64
v_add_f32 v51, v51, v65
LE_fl7:
s_nop 3
v_cvt_pk_bf16_f32 v64, v48, v49
v_cvt_pk_bf16_f32 v65, v50, v51
v_mov_b32 v48, 0
v_mov_b32 v49, 0
v_mov_b32 v50, 0
v_mov_b32 v51, 0
buffer_store_dwordx2 v[64:65], v39, s[20:23], s47 offen
s_add_u32 s47, s47, 512
LE_nf7:
s_waitcnt lgkmcnt(0)
ds_read2_b32 v[52:53], v34 offset0:32 offset1:36
ds_read2_b32 v[54:55], v34 offset0:40 offset1:44
v_mad_u32_u16 v60, v56, s49, v2
v_mad_u32_u16 v61, v57, s49, v2
v_mad_u32_u16 v62, v58, s49, v2
v_mad_u32_u16 v63, v59, s49, v2
buffer_load_dwordx4 a[32:35], v60, s[16:19], 0 offen
buffer_load_dwordx4 a[36:39], v60, s[16:19], 0 offen offset:256
buffer_load_dwordx4 a[40:43], v61, s[16:19], 0 offen
buffer_load_dwordx4 a[44:47], v61, s[16:19], 0 offen offset:256
buffer_load_dwordx4 a[48:51], v62, s[16:19], 0 offen
buffer_load_dwordx4 a[52:55], v62, s[16:19], 0 offen offset:256
buffer_load_dwordx4 a[56:59], v63, s[16:19], 0 offen
buffer_load_dwordx4 a[60:63], v63, s[16:19], 0 offen offset:256
s_waitcnt vmcnt(56)
v_mfma_f32_16x16x32_bf16 v[48:51], a[64:67], v[40:43], v[48:51]
v_mfma_f32_16x16x32_bf16 v[48:51], a[68:71], v[44:47], v[48:51]
s_bitcmp1_b32 s46, 8
s_cbranch_scc0 LE_nf8
s_cmp_eq_u32 s42, 0
s_cbranch_scc1 LE_fl8
buffer_load_dwordx2 v[66:67], v39, s[20:23], s47 offen sc1
s_waitcnt vmcnt(0)
v_lshlrev_b32 v64, 16, v66
v_and_b32 v65, 0xffff0000, v66
v_add_f32 v48, v48, v64
v_add_f32 v49, v49, v65
v_lshlrev_b32 v64, 16, v67
v_and_b32 v65, 0xffff0000, v67
v_add_f32 v50, v50, v64
v_add_f32 v51, v51, v65
LE_fl8:
s_nop 3
v_cvt_pk_bf16_f32 v64, v48, v49
v_cvt_pk_bf16_f32 v65, v50, v51
v_mov_b32 v48, 0
v_mov_b32 v49, 0
v_mov_b32 v50, 0
v_mov_b32 v51, 0
buffer_store_dwordx2 v[64:65], v39, s[20:23], s47 offen
s_add_u32 s47, s47, 512
LE_nf8:
v_mfma_f32_16x16x32_bf16 v[48:51], a[72:75], v[40:43], v[48:51]
v_mfma_f32_16x16x32_bf16 v[48:51], a[76:79], v[44:47], v[48:51]
s_bitcmp1_b32 s46, 9
s_cbranch_scc0 LE_nf9
s_cmp_eq_u32 s42, 0
s_cbranch_scc1 LE_fl9
buffer_load_dwordx2 v[66:67], v39, s[20:23], s47 offen sc1
s_waitcnt vmcnt(0)
v_lshlrev_b32 v64, 16, v66
v_and_b32 v65, 0xffff0000, v66
v_add_f32 v48, v48, v64
v_add_f32 v49, v49, v65
v_lshlrev_b32 v64, 16, v67
v_and_b32 v65, 0xffff0000, v67
v_add_f32 v50, v50, v64
v_add_f32 v51, v51, v65
LE_fl9:
s_nop 3
v_cvt_pk_bf16_f32 v64, v48, v49
v_cvt_pk_bf16_f32 v65, v50, v51
v_mov_b32 v48, 0
v_mov_b32 v49, 0
v_mov_b32 v50, 0
v_mov_b32 v51, 0
buffer_store_dwordx2 v[64:65], v39, s[20:23], s47 offen
s_add_u32 s47, s47, 512
LE_nf9:
v_mfma_f32_16x16x32_bf16 v[48:51], a[80:83], v[40:43], v[48:51]
v_mfma_f32_16x16x32_bf16 v[48:51], a[84:87], v[44:47], v[48:51]
s_bitcmp1_b32 s46, 10
s_cbranch_scc0 LE_nf10
s_cmp_eq_u32 s42, 0
s_cbranch_scc1 LE_fl10
buffer_load_dwordx2 v[66:67], v39, s[20:23], s47 offen sc1
s_waitcnt vmcnt(0)
v_lshlrev_b32 v64, 16, v66
v_and_b32 v65, 0xffff0000, v66
v_add_f32 v48, v48, v64
v_add_f32 v49, v49, v65
v_lshlrev_b32 v64, 16, v67
v_and_b32 v65, 0xffff0000, v67
v_add_f32 v50, v50, v64
v_add_f32 v51, v51, v65
LE_fl10:
s_nop 3
v_cvt_pk_bf16_f32 v64, v48, v49
v_cvt_pk_bf16_f32 v65, v50, v51
v_mov_b32 v48, 0
v_mov_b32 v49, 0
v_mov_b32 v50, 0
v_mov_b32 v51, 0
buffer_store_dwordx2 v[64:65], v39, s[20:23], s47 offen
s_add_u32 s47, s47, 512
LE_nf10:
v_mfma_f32_16x16x32_bf16 v[48:51], a[88:91], v[40:43], v[48:51]
v_mfma_f32_16x16x32_bf16 v[48:51], a[92:95], v[44:47], v[48:51]
s_bitcmp1_b32 s46, 11
s_cbranch_scc0 LE_nf11
s_cmp_eq_u32 s42, 0
s_cbranch_scc1 LE_fl11
buffer_load_dwordx2 v[66:67], v39, s[20:23], s47 offen sc1
s_waitcnt vmcnt(0)
v_lshlrev_b32 v64, 16, v66
v_and_b32 v65, 0xffff0000, v66
v_add_f32 v48, v48, v64
v_add_f32 v49, v49, v65
v_lshlrev_b32 v64, 16, v67
v_and_b32 v65, 0xffff0000, v67
v_add_f32 v50, v50, v64
v_add_f32 v51, v51, v65
LE_fl11:
s_nop 3
v_cvt_pk_bf16_f32 v64, v48, v49
v_cvt_pk_bf16_f32 v65, v50, v51
v_mov_b32 v48, 0
v_mov_b32 v49, 0
v_mov_b32 v50, 0
v_mov_b32 v51, 0
buffer_store_dwordx2 v[64:65], v39, s[20:23], s47 offen
s_add_u32 s47, s47, 512
LE_nf11:
s_waitcnt lgkmcnt(0)
ds_read2_b32 v[56:57], v34 offset0:48 offset1:52
ds_read2_b32 v[58:59], v34 offset0:56 offset1:60
v_mad_u32_u16 v60, v52, s49, v2
v_mad_u32_u16 v61, v53, s49, v2
v_mad_u32_u16 v62, v54, s49, v2
v_mad_u32_u16 v63, v55, s49, v2
buffer_load_dwordx4 a[64:67], v60, s[16:19], 0 offen
buffer_load_dwordx4 a[68:71], v60, s[16:19], 0 offen offset:256
buffer_load_dwordx4 a[72:75], v61, s[16:19], 0 offen
buffer_load_dwordx4 a[76:79], v61, s[16:19], 0 offen offset:256
buffer_load_dwordx4 a[80:83], v62, s[16:19], 0 offen
buffer_load_dwordx4 a[84:87], v62, s[16:19], 0 offen offset:256
buffer_load_dwordx4 a[88:91], v63, s[16:19], 0 offen
buffer_load_dwordx4 a[92:95], v63, s[16:19], 0 offen offset:256
s_waitcnt vmcnt(56)
v_mfma_f32_16x16x32_bf16 v[48:51], a[96:99], v[40:43], v[48:51]
v_mfma_f32_16x16x32_bf16 v[48:51], a[100:103], v[44:47], v[48:51]
s_bitcmp1_b32 s46, 12
s_cbranch_scc0 LE_nf12
s_cmp_eq_u32 s42, 0
s_cbranch_scc1 LE_fl12
buffer_load_dwordx2 v[66:67], v39, s[20:23], s47 offen sc1
s_waitcnt vmcnt(0)
v_lshlrev_b32 v64, 16, v66
v_and_b32 v65, 0xffff0000, v66
v_add_f32 v48, v48, v64
v_add_f32 v49, v49, v65
v_lshlrev_b32 v64, 16, v67
v_and_b32 v65, 0xffff0000, v67
v_add_f32 v50, v50, v64
v_add_f32 v51, v51, v65
LE_fl12:
s_nop 3
v_cvt_pk_bf16_f32 v64, v48, v49
v_cvt_pk_bf16_f32 v65, v50, v51
v_mov_b32 v48, 0
v_mov_b32 v49, 0
v_mov_b32 v50, 0
v_mov_b32 v51, 0
buffer_store_dwordx2 v[64:65], v39, s[20:23], s47 offen
s_add_u32 s47, s47, 512
LE_nf12:
v_mfma_f32_16x16x32_bf16 v[48:51], a[104:107], v[40:43], v[48:51]
v_mfma_f32_16x16x32_bf16 v[48:51], a[108:111], v[44:47], v[48:51]
s_bitcmp1_b32 s46, 13
s_cbranch_scc0 LE_nf13
s_cmp_eq_u32 s42, 0
s_cbranch_scc1 LE_fl13
buffer_load_dwordx2 v[66:67], v39, s[20:23], s47 offen sc1
s_waitcnt vmcnt(0)
v_lshlrev_b32 v64, 16, v66
v_and_b32 v65, 0xffff0000, v66
v_add_f32 v48, v48, v64
v_add_f32 v49, v49, v65
v_lshlrev_b32 v64, 16, v67
v_and_b32 v65, 0xffff0000, v67
v_add_f32 v50, v50, v64
v_add_f32 v51, v51, v65
LE_fl13:
s_nop 3
v_cvt_pk_bf16_f32 v64, v48, v49
v_cvt_pk_bf16_f32 v65, v50, v51
v_mov_b32 v48, 0
v_mov_b32 v49, 0
v_mov_b32 v50, 0
v_mov_b32 v51, 0
buffer_store_dwordx2 v[64:65], v39, s[20:23], s47 offen
s_add_u32 s47, s47, 512
LE_nf13:
v_mfma_f32_16x16x32_bf16 v[48:51], a[112:115], v[40:43], v[48:51]
v_mfma_f32_16x16x32_bf16 v[48:51], a[116:119], v[44:47], v[48:51]
s_bitcmp1_b32 s46, 14
s_cbranch_scc0 LE_nf14
s_cmp_eq_u32 s42, 0
s_cbranch_scc1 LE_fl14
buffer_load_dwordx2 v[66:67], v39, s[20:23], s47 offen sc1
s_waitcnt vmcnt(0)
v_lshlrev_b32 v64, 16, v66
v_and_b32 v65, 0xffff0000, v66
v_add_f32 v48, v48, v64
v_add_f32 v49, v49, v65
v_lshlrev_b32 v64, 16, v67
v_and_b32 v65, 0xffff0000, v67
v_add_f32 v50, v50, v64
v_add_f32 v51, v51, v65
LE_fl14:
s_nop 3
v_cvt_pk_bf16_f32 v64, v48, v49
v_cvt_pk_bf16_f32 v65, v50, v51
v_mov_b32 v48, 0
v_mov_b32 v49, 0
v_mov_b32 v50, 0
v_mov_b32 v51, 0
buffer_store_dwordx2 v[64:65], v39, s[20:23], s47 offen
s_add_u32 s47, s47, 512
LE_nf14:
v_mfma_f32_16x16x32_bf16 v[48:51], a[120:123], v[40:43], v[48:51]
v_mfma_f32_16x16x32_bf16 v[48:51], a[124:127], v[44:47], v[48:51]
s_bitcmp1_b32 s46, 15
s_cbranch_scc0 LE_nf15
s_cmp_eq_u32 s42, 0
s_cbranch_scc1 LE_fl15
buffer_load_dwordx2 v[66:67], v39, s[20:23], s47 offen sc1
s_waitcnt vmcnt(0)
v_lshlrev_b32 v64, 16, v66
v_and_b32 v65, 0xffff0000, v66
v_add_f32 v48, v48, v64
v_add_f32 v49, v49, v65
v_lshlrev_b32 v64, 16, v67
v_and_b32 v65, 0xffff0000, v67
v_add_f32 v50, v50, v64
v_add_f32 v51, v51, v65
LE_fl15:
s_nop 3
v_cvt_pk_bf16_f32 v64, v48, v49
v_cvt_pk_bf16_f32 v65, v50, v51
v_mov_b32 v48, 0
v_mov_b32 v49, 0
v_mov_b32 v50, 0
v_mov_b32 v51, 0
buffer_store_dwordx2 v[64:65], v39, s[20:23], s47 offen
s_add_u32 s47, s47, 512
LE_nf15:
s_waitcnt lgkmcnt(0)
ds_read2_b32 v[52:53], v34 offset0:64 offset1:68
ds_read2_b32 v[54:55], v34 offset0:72 offset1:76
v_mad_u32_u16 v60, v56, s49, v2
v_mad_u32_u16 v61, v57, s49, v2
v_mad_u32_u16 v62, v58, s49, v2
v_mad_u32_u16 v63, v59, s49, v2
buffer_load_dwordx4 a[96:99], v60, s[16:19], 0 offen
buffer_load_dwordx4 a[100:103], v60, s[16:19], 0 offen offset:256
buffer_load_dwordx4 a[104:107], v61, s[16:19], 0 offen
buffer_load_dwordx4 a[108:111], v61, s[16:19], 0 offen offset:256
buffer_load_dwordx4 a[112:115], v62, s[16:19], 0 offen
buffer_load_dwordx4 a[116:119], v62, s[16:19], 0 offen offset:256
buffer_load_dwordx4 a[120:123], v63, s[16:19], 0 offen
buffer_load_dwordx4 a[124:127], v63, s[16:19], 0 offen offset:256
s_waitcnt vmcnt(56)
v_mfma_f32_16x16x32_bf16 v[48:51], a[128:131], v[40:43], v[48:51]
v_mfma_f32_16x16x32_bf16 v[48:51], a[132:135], v[44:47], v[48:51]
s_bitcmp1_b32 s46, 16
s_cbranch_scc0 LE_nf16
s_cmp_eq_u32 s42, 0
s_cbranch_scc1 LE_fl16
buffer_load_dwordx2 v[66:67], v39, s[20:23], s47 offen sc1
s_waitcnt vmcnt(0)
v_lshlrev_b32 v64, 16, v66
v_and_b32 v65, 0xffff0000, v66
v_add_f32 v48, v48, v64
v_add_f32 v49, v49, v65
v_lshlrev_b32 v64, 16, v67
v_and_b32 v65, 0xffff0000, v67
v_add_f32 v50, v50, v64
v_add_f32 v51, v51, v65
LE_fl16:
s_nop 3
v_cvt_pk_bf16_f32 v64, v48, v49
v_cvt_pk_bf16_f32 v65, v50, v51
v_mov_b32 v48, 0
v_mov_b32 v49, 0
v_mov_b32 v50, 0
v_mov_b32 v51, 0
buffer_store_dwordx2 v[64:65], v39, s[20:23], s47 offen
s_add_u32 s47, s47, 512
LE_nf16:
v_mfma_f32_16x16x32_bf16 v[48:51], a[136:139], v[40:43], v[48:51]
v_mfma_f32_16x16x32_bf16 v[48:51], a[140:143], v[44:47], v[48:51]
s_bitcmp1_b32 s46, 17
s_cbranch_scc0 LE_nf17
s_cmp_eq_u32 s42, 0
s_cbranch_scc1 LE_fl17
buffer_load_dwordx2 v[66:67], v39, s[20:23], s47 offen sc1
s_waitcnt vmcnt(0)
v_lshlrev_b32 v64, 16, v66
v_and_b32 v65, 0xffff0000, v66
v_add_f32 v48, v48, v64
v_add_f32 v49, v49, v65
v_lshlrev_b32 v64, 16, v67
v_and_b32 v65, 0xffff0000, v67
v_add_f32 v50, v50, v64
v_add_f32 v51, v51, v65
LE_fl17:
s_nop 3
v_cvt_pk_bf16_f32 v64, v48, v49
v_cvt_pk_bf16_f32 v65, v50, v51
v_mov_b32 v48, 0
v_mov_b32 v49, 0
v_mov_b32 v50, 0
v_mov_b32 v51, 0
buffer_store_dwordx2 v[64:65], v39, s[20:23], s47 offen
s_add_u32 s47, s47, 512
LE_nf17:
v_mfma_f32_16x16x32_bf16 v[48:51], a[144:147], v[40:43], v[48:51]
v_mfma_f32_16x16x32_bf16 v[48:51], a[148:151], v[44:47], v[48:51]
s_bitcmp1_b32 s46, 18
s_cbranch_scc0 LE_nf18
s_cmp_eq_u32 s42, 0
s_cbranch_scc1 LE_fl18
buffer_load_dwordx2 v[66:67], v39, s[20:23], s47 offen sc1
s_waitcnt vmcnt(0)
v_lshlrev_b32 v64, 16, v66
v_and_b32 v65, 0xffff0000, v66
v_add_f32 v48, v48, v64
v_add_f32 v49, v49, v65
v_lshlrev_b32 v64, 16, v67
v_and_b32 v65, 0xffff0000, v67
v_add_f32 v50, v50, v64
v_add_f32 v51, v51, v65
LE_fl18:
s_nop 3
v_cvt_pk_bf16_f32 v64, v48, v49
v_cvt_pk_bf16_f32 v65, v50, v51
v_mov_b32 v48, 0
v_mov_b32 v49, 0
v_mov_b32 v50, 0
v_mov_b32 v51, 0
buffer_store_dwordx2 v[64:65], v39, s[20:23], s47 offen
s_add_u32 s47, s47, 512
LE_nf18:
v_mfma_f32_16x16x32_bf16 v[48:51], a[152:155], v[40:43], v[48:51]
v_mfma_f32_16x16x32_bf16 v[48:51], a[156:159], v[44:47], v[48:51]
s_bitcmp1_b32 s46, 19
s_cbranch_scc0 LE_nf19
s_cmp_eq_u32 s42, 0
s_cbranch_scc1 LE_fl19
buffer_load_dwordx2 v[66:67], v39, s[20:23], s47 offen sc1
s_waitcnt vmcnt(0)
v_lshlrev_b32 v64, 16, v66
v_and_b32 v65, 0xffff0000, v66
v_add_f32 v48, v48, v64
v_add_f32 v49, v49, v65
v_lshlrev_b32 v64, 16, v67
v_and_b32 v65, 0xffff0000, v67
v_add_f32 v50, v50, v64
v_add_f32 v51, v51, v65
LE_fl19:
s_nop 3
v_cvt_pk_bf16_f32 v64, v48, v49
v_cvt_pk_bf16_f32 v65, v50, v51
v_mov_b32 v48, 0
v_mov_b32 v49, 0
v_mov_b32 v50, 0
v_mov_b32 v51, 0
buffer_store_dwordx2 v[64:65], v39, s[20:23], s47 offen
s_add_u32 s47, s47, 512
LE_nf19:
s_waitcnt lgkmcnt(0)
ds_read2_b32 v[56:57], v34 offset0:80 offset1:84
ds_read2_b32 v[58:59], v34 offset0:88 offset1:92
v_mad_u32_u16 v60, v52, s49, v2
v_mad_u32_u16 v61, v53, s49, v2
v_mad_u32_u16 v62, v54, s49, v2
v_mad_u32_u16 v63, v55, s49, v2
buffer_load_dwordx4 a[128:131], v60, s[16:19], 0 offen
buffer_load_dwordx4 a[132:135], v60, s[16:19], 0 offen offset:256
buffer_load_dwordx4 a[136:139], v61, s[16:19], 0 offen
buffer_load_dwordx4 a[140:143], v61, s[16:19], 0 offen offset:256
buffer_load_dwordx4 a[144:147], v62, s[16:19], 0 offen
buffer_load_dwordx4 a[148:151], v62, s[16:19], 0 offen offset:256
buffer_load_dwordx4 a[152:155], v63, s[16:19], 0 offen
buffer_load_dwordx4 a[156:159], v63, s[16:19], 0 offen offset:256
s_waitcnt vmcnt(56)
v_mfma_f32_16x16x32_bf16 v[48:51], a[160:163], v[40:43], v[48:51]
v_mfma_f32_16x16x32_bf16 v[48:51], a[164:167], v[44:47], v[48:51]
s_bitcmp1_b32 s46, 20
s_cbranch_scc0 LE_nf20
s_cmp_eq_u32 s42, 0
s_cbranch_scc1 LE_fl20
buffer_load_dwordx2 v[66:67], v39, s[20:23], s47 offen sc1
s_waitcnt vmcnt(0)
v_lshlrev_b32 v64, 16, v66
v_and_b32 v65, 0xffff0000, v66
v_add_f32 v48, v48, v64
v_add_f32 v49, v49, v65
v_lshlrev_b32 v64, 16, v67
v_and_b32 v65, 0xffff0000, v67
v_add_f32 v50, v50, v64
v_add_f32 v51, v51, v65
LE_fl20:
s_nop 3
v_cvt_pk_bf16_f32 v64, v48, v49
v_cvt_pk_bf16_f32 v65, v50, v51
v_mov_b32 v48, 0
v_mov_b32 v49, 0
v_mov_b32 v50, 0
v_mov_b32 v51, 0
buffer_store_dwordx2 v[64:65], v39, s[20:23], s47 offen
s_add_u32 s47, s47, 512
LE_nf20:
v_mfma_f32_16x16x32_bf16 v[48:51], a[168:171], v[40:43], v[48:51]
v_mfma_f32_16x16x32_bf16 v[48:51], a[172:175], v[44:47], v[48:51]
s_bitcmp1_b32 s46, 21
s_cbranch_scc0 LE_nf21
s_cmp_eq_u32 s42, 0
s_cbranch_scc1 LE_fl21
buffer_load_dwordx2 v[66:67], v39, s[20:23], s47 offen sc1
s_waitcnt vmcnt(0)
v_lshlrev_b32 v64, 16, v66
v_and_b32 v65, 0xffff0000, v66
v_add_f32 v48, v48, v64
v_add_f32 v49, v49, v65
v_lshlrev_b32 v64, 16, v67
v_and_b32 v65, 0xffff0000, v67
v_add_f32 v50, v50, v64
v_add_f32 v51, v51, v65
LE_fl21:
s_nop 3
v_cvt_pk_bf16_f32 v64, v48, v49
v_cvt_pk_bf16_f32 v65, v50, v51
v_mov_b32 v48, 0
v_mov_b32 v49, 0
v_mov_b32 v50, 0
v_mov_b32 v51, 0
buffer_store_dwordx2 v[64:65], v39, s[20:23], s47 offen
s_add_u32 s47, s47, 512
LE_nf21:
v_mfma_f32_16x16x32_bf16 v[48:51], a[176:179], v[40:43], v[48:51]
v_mfma_f32_16x16x32_bf16 v[48:51], a[180:183], v[44:47], v[48:51]
s_bitcmp1_b32 s46, 22
s_cbranch_scc0 LE_nf22
s_cmp_eq_u32 s42, 0
s_cbranch_scc1 LE_fl22
buffer_load_dwordx2 v[66:67], v39, s[20:23], s47 offen sc1
s_waitcnt vmcnt(0)
v_lshlrev_b32 v64, 16, v66
v_and_b32 v65, 0xffff0000, v66
v_add_f32 v48, v48, v64
v_add_f32 v49, v49, v65
v_lshlrev_b32 v64, 16, v67
v_and_b32 v65, 0xffff0000, v67
v_add_f32 v50, v50, v64
v_add_f32 v51, v51, v65
LE_fl22:
s_nop 3
v_cvt_pk_bf16_f32 v64, v48, v49
v_cvt_pk_bf16_f32 v65, v50, v51
v_mov_b32 v48, 0
v_mov_b32 v49, 0
v_mov_b32 v50, 0
v_mov_b32 v51, 0
buffer_store_dwordx2 v[64:65], v39, s[20:23], s47 offen
s_add_u32 s47, s47, 512
LE_nf22:
v_mfma_f32_16x16x32_bf16 v[48:51], a[184:187], v[40:43], v[48:51]
v_mfma_f32_16x16x32_bf16 v[48:51], a[188:191], v[44:47], v[48:51]
s_bitcmp1_b32 s46, 23
s_cbranch_scc0 LE_nf23
s_cmp_eq_u32 s42, 0
s_cbranch_scc1 LE_fl23
buffer_load_dwordx2 v[66:67], v39, s[20:23], s47 offen sc1
s_waitcnt vmcnt(0)
v_lshlrev_b32 v64, 16, v66
v_and_b32 v65, 0xffff0000, v66
v_add_f32 v48, v48, v64
v_add_f32 v49, v49, v65
v_lshlrev_b32 v64, 16, v67
v_and_b32 v65, 0xffff0000, v67
v_add_f32 v50, v50, v64
v_add_f32 v51, v51, v65
LE_fl23:
s_nop 3
v_cvt_pk_bf16_f32 v64, v48, v49
v_cvt_pk_bf16_f32 v65, v50, v51
v_mov_b32 v48, 0
v_mov_b32 v49, 0
v_mov_b32 v50, 0
v_mov_b32 v51, 0
buffer_store_dwordx2 v[64:65], v39, s[20:23], s47 offen
s_add_u32 s47, s47, 512
LE_nf23:
s_waitcnt lgkmcnt(0)
ds_read2_b32 v[52:53], v34 offset0:96 offset1:100
ds_read2_b32 v[54:55], v34 offset0:104 offset1:108
v_mad_u32_u16 v60, v56, s49, v2
v_mad_u32_u16 v61, v57, s49, v2
v_mad_u32_u16 v62, v58, s49, v2
v_mad_u32_u16 v63, v59, s49, v2
buffer_load_dwordx4 a[160:163], v60, s[16:19], 0 offen
buffer_load_dwordx4 a[164:167], v60, s[16:19], 0 offen offset:256
buffer_load_dwordx4 a[168:171], v61, s[16:19], 0 offen
buffer_load_dwordx4 a[172:175], v61, s[16:19], 0 offen offset:256
buffer_load_dwordx4 a[176:179], v62, s[16:19], 0 offen
buffer_load_dwordx4 a[180:183], v62, s[16:19], 0 offen offset:256
buffer_load_dwordx4 a[184:187], v63, s[16:19], 0 offen
buffer_load_dwordx4 a[188:191], v63, s[16:19], 0 offen offset:256
s_waitcnt vmcnt(56)
v_mfma_f32_16x16x32_bf16 v[48:51], a[192:195], v[40:43], v[48:51]
v_mfma_f32_16x16x32_bf16 v[48:51], a[196:199], v[44:47], v[48:51]
s_bitcmp1_b32 s46, 24
s_cbranch_scc0 LE_nf24
s_cmp_eq_u32 s42, 0
s_cbranch_scc1 LE_fl24
buffer_load_dwordx2 v[66:67], v39, s[20:23], s47 offen sc1
s_waitcnt vmcnt(0)
v_lshlrev_b32 v64, 16, v66
v_and_b32 v65, 0xffff0000, v66
v_add_f32 v48, v48, v64
v_add_f32 v49, v49, v65
v_lshlrev_b32 v64, 16, v67
v_and_b32 v65, 0xffff0000, v67
v_add_f32 v50, v50, v64
v_add_f32 v51, v51, v65
LE_fl24:
s_nop 3
v_cvt_pk_bf16_f32 v64, v48, v49
v_cvt_pk_bf16_f32 v65, v50, v51
v_mov_b32 v48, 0
v_mov_b32 v49, 0
v_mov_b32 v50, 0
v_mov_b32 v51, 0
buffer_store_dwordx2 v[64:65], v39, s[20:23], s47 offen
s_add_u32 s47, s47, 512
LE_nf24:
v_mfma_f32_16x16x32_bf16 v[48:51], a[200:203], v[40:43], v[48:51]
v_mfma_f32_16x16x32_bf16 v[48:51], a[204:207], v[44:47], v[48:51]
s_bitcmp1_b32 s46, 25
s_cbranch_scc0 LE_nf25
s_cmp_eq_u32 s42, 0
s_cbranch_scc1 LE_fl25
buffer_load_dwordx2 v[66:67], v39, s[20:23], s47 offen sc1
s_waitcnt vmcnt(0)
v_lshlrev_b32 v64, 16, v66
v_and_b32 v65, 0xffff0000, v66
v_add_f32 v48, v48, v64
v_add_f32 v49, v49, v65
v_lshlrev_b32 v64, 16, v67
v_and_b32 v65, 0xffff0000, v67
v_add_f32 v50, v50, v64
v_add_f32 v51, v51, v65
LE_fl25:
s_nop 3
v_cvt_pk_bf16_f32 v64, v48, v49
v_cvt_pk_bf16_f32 v65, v50, v51
v_mov_b32 v48, 0
v_mov_b32 v49, 0
v_mov_b32 v50, 0
v_mov_b32 v51, 0
buffer_store_dwordx2 v[64:65], v39, s[20:23], s47 offen
s_add_u32 s47, s47, 512
LE_nf25:
v_mfma_f32_16x16x32_bf16 v[48:51], a[208:211], v[40:43], v[48:51]
v_mfma_f32_16x16x32_bf16 v[48:51], a[212:215], v[44:47], v[48:51]
s_bitcmp1_b32 s46, 26
s_cbranch_scc0 LE_nf26
s_cmp_eq_u32 s42, 0
s_cbranch_scc1 LE_fl26
buffer_load_dwordx2 v[66:67], v39, s[20:23], s47 offen sc1
s_waitcnt vmcnt(0)
v_lshlrev_b32 v64, 16, v66
v_and_b32 v65, 0xffff0000, v66
v_add_f32 v48, v48, v64
v_add_f32 v49, v49, v65
v_lshlrev_b32 v64, 16, v67
v_and_b32 v65, 0xffff0000, v67
v_add_f32 v50, v50, v64
v_add_f32 v51, v51, v65
LE_fl26:
s_nop 3
v_cvt_pk_bf16_f32 v64, v48, v49
v_cvt_pk_bf16_f32 v65, v50, v51
v_mov_b32 v48, 0
v_mov_b32 v49, 0
v_mov_b32 v50, 0
v_mov_b32 v51, 0
buffer_store_dwordx2 v[64:65], v39, s[20:23], s47 offen
s_add_u32 s47, s47, 512
LE_nf26:
v_mfma_f32_16x16x32_bf16 v[48:51], a[216:219], v[40:43], v[48:51]
v_mfma_f32_16x16x32_bf16 v[48:51], a[220:223], v[44:47], v[48:51]
s_bitcmp1_b32 s46, 27
s_cbranch_scc0 LE_nf27
s_cmp_eq_u32 s42, 0
s_cbranch_scc1 LE_fl27
buffer_load_dwordx2 v[66:67], v39, s[20:23], s47 offen sc1
s_waitcnt vmcnt(0)
v_lshlrev_b32 v64, 16, v66
v_and_b32 v65, 0xffff0000, v66
v_add_f32 v48, v48, v64
v_add_f32 v49, v49, v65
v_lshlrev_b32 v64, 16, v67
v_and_b32 v65, 0xffff0000, v67
v_add_f32 v50, v50, v64
v_add_f32 v51, v51, v65
LE_fl27:
s_nop 3
v_cvt_pk_bf16_f32 v64, v48, v49
v_cvt_pk_bf16_f32 v65, v50, v51
v_mov_b32 v48, 0
v_mov_b32 v49, 0
v_mov_b32 v50, 0
v_mov_b32 v51, 0
buffer_store_dwordx2 v[64:65], v39, s[20:23], s47 offen
s_add_u32 s47, s47, 512
LE_nf27:
s_waitcnt lgkmcnt(0)
ds_read2_b32 v[56:57], v34 offset0:112 offset1:116
ds_read2_b32 v[58:59], v34 offset0:120 offset1:124
v_mad_u32_u16 v60, v52, s49, v2
v_mad_u32_u16 v61, v53, s49, v2
v_mad_u32_u16 v62, v54, s49, v2
v_mad_u32_u16 v63, v55, s49, v2
buffer_load_dwordx4 a[192:195], v60, s[16:19], 0 offen
buffer_load_dwordx4 a[196:199], v60, s[16:19], 0 offen offset:256
buffer_load_dwordx4 a[200:203], v61, s[16:19], 0 offen
buffer_load_dwordx4 a[204:207], v61, s[16:19], 0 offen offset:256
buffer_load_dwordx4 a[208:211], v62, s[16:19], 0 offen
buffer_load_dwordx4 a[212:215], v62, s[16:19], 0 offen offset:256
buffer_load_dwordx4 a[216:219], v63, s[16:19], 0 offen
buffer_load_dwordx4 a[220:223], v63, s[16:19], 0 offen offset:256
s_waitcnt vmcnt(56)
v_mfma_f32_16x16x32_bf16 v[48:51], a[224:227], v[40:43], v[48:51]
v_mfma_f32_16x16x32_bf16 v[48:51], a[228:231], v[44:47], v[48:51]
s_bitcmp1_b32 s46, 28
s_cbranch_scc0 LE_nf28
s_cmp_eq_u32 s42, 0
s_cbranch_scc1 LE_fl28
buffer_load_dwordx2 v[66:67], v39, s[20:23], s47 offen sc1
s_waitcnt vmcnt(0)
v_lshlrev_b32 v64, 16, v66
v_and_b32 v65, 0xffff0000, v66
v_add_f32 v48, v48, v64
v_add_f32 v49, v49, v65
v_lshlrev_b32 v64, 16, v67
v_and_b32 v65, 0xffff0000, v67
v_add_f32 v50, v50, v64
v_add_f32 v51, v51, v65
LE_fl28:
s_nop 3
v_cvt_pk_bf16_f32 v64, v48, v49
v_cvt_pk_bf16_f32 v65, v50, v51
v_mov_b32 v48, 0
v_mov_b32 v49, 0
v_mov_b32 v50, 0
v_mov_b32 v51, 0
buffer_store_dwordx2 v[64:65], v39, s[20:23], s47 offen
s_add_u32 s47, s47, 512
LE_nf28:
v_mfma_f32_16x16x32_bf16 v[48:51], a[232:235], v[40:43], v[48:51]
v_mfma_f32_16x16x32_bf16 v[48:51], a[236:239], v[44:47], v[48:51]
s_bitcmp1_b32 s46, 29
s_cbranch_scc0 LE_nf29
s_cmp_eq_u32 s42, 0
s_cbranch_scc1 LE_fl29
buffer_load_dwordx2 v[66:67], v39, s[20:23], s47 offen sc1
s_waitcnt vmcnt(0)
v_lshlrev_b32 v64, 16, v66
v_and_b32 v65, 0xffff0000, v66
v_add_f32 v48, v48, v64
v_add_f32 v49, v49, v65
v_lshlrev_b32 v64, 16, v67
v_and_b32 v65, 0xffff0000, v67
v_add_f32 v50, v50, v64
v_add_f32 v51, v51, v65
LE_fl29:
s_nop 3
v_cvt_pk_bf16_f32 v64, v48, v49
v_cvt_pk_bf16_f32 v65, v50, v51
v_mov_b32 v48, 0
v_mov_b32 v49, 0
v_mov_b32 v50, 0
v_mov_b32 v51, 0
buffer_store_dwordx2 v[64:65], v39, s[20:23], s47 offen
s_add_u32 s47, s47, 512
LE_nf29:
v_mfma_f32_16x16x32_bf16 v[48:51], a[240:243], v[40:43], v[48:51]
v_mfma_f32_16x16x32_bf16 v[48:51], a[244:247], v[44:47], v[48:51]
s_bitcmp1_b32 s46, 30
s_cbranch_scc0 LE_nf30
s_cmp_eq_u32 s42, 0
s_cbranch_scc1 LE_fl30
buffer_load_dwordx2 v[66:67], v39, s[20:23], s47 offen sc1
s_waitcnt vmcnt(0)
v_lshlrev_b32 v64, 16, v66
v_and_b32 v65, 0xffff0000, v66
v_add_f32 v48, v48, v64
v_add_f32 v49, v49, v65
v_lshlrev_b32 v64, 16, v67
v_and_b32 v65, 0xffff0000, v67
v_add_f32 v50, v50, v64
v_add_f32 v51, v51, v65
LE_fl30:
s_nop 3
v_cvt_pk_bf16_f32 v64, v48, v49
v_cvt_pk_bf16_f32 v65, v50, v51
v_mov_b32 v48, 0
v_mov_b32 v49, 0
v_mov_b32 v50, 0
v_mov_b32 v51, 0
buffer_store_dwordx2 v[64:65], v39, s[20:23], s47 offen
s_add_u32 s47, s47, 512
LE_nf30:
v_mfma_f32_16x16x32_bf16 v[48:51], a[248:251], v[40:43], v[48:51]
v_mfma_f32_16x16x32_bf16 v[48:51], a[252:255], v[44:47], v[48:51]
s_bitcmp1_b32 s46, 31
s_cbranch_scc0 LE_nf31
s_cmp_eq_u32 s42, 0
s_cbranch_scc1 LE_fl31
buffer_load_dwordx2 v[66:67], v39, s[20:23], s47 offen sc1
s_waitcnt vmcnt(0)
v_lshlrev_b32 v64, 16, v66
v_and_b32 v65, 0xffff0000, v66
v_add_f32 v48, v48, v64
v_add_f32 v49, v49, v65
v_lshlrev_b32 v64, 16, v67
v_and_b32 v65, 0xffff0000, v67
v_add_f32 v50, v50, v64
v_add_f32 v51, v51, v65
LE_fl31:
s_nop 3
v_cvt_pk_bf16_f32 v64, v48, v49
v_cvt_pk_bf16_f32 v65, v50, v51
v_mov_b32 v48, 0
v_mov_b32 v49, 0
v_mov_b32 v50, 0
v_mov_b32 v51, 0
buffer_store_dwordx2 v[64:65], v39, s[20:23], s47 offen
s_add_u32 s47, s47, 512
LE_nf31:
s_waitcnt lgkmcnt(0)
ds_read2_b32 v[52:53], v34 offset0:128 offset1:132
ds_read2_b32 v[54:55], v34 offset0:136 offset1:140
v_mad_u32_u16 v60, v56, s49, v2
v_mad_u32_u16 v61, v57, s49, v2
v_mad_u32_u16 v62, v58, s49, v2
v_mad_u32_u16 v63, v59, s49, v2
buffer_load_dwordx4 a[224:227], v60, s[16:19], 0 offen
buffer_load_dwordx4 a[228:231], v60, s[16:19], 0 offen offset:256
buffer_load_dwordx4 a[232:235], v61, s[16:19], 0 offen
buffer_load_dwordx4 a[236:239], v61, s[16:19], 0 offen offset:256
buffer_load_dwordx4 a[240:243], v62, s[16:19], 0 offen
buffer_load_dwordx4 a[244:247], v62, s[16:19], 0 offen offset:256
buffer_load_dwordx4 a[248:251], v63, s[16:19], 0 offen
buffer_load_dwordx4 a[252:255], v63, s[16:19], 0 offen offset:256
v_add_u32 v34, 512, v34
s_cmp_lt_u32 s45, s44
s_cbranch_scc1 LE_loop
s_add_u32 s42, s42, 1
s_mul_i32 s43, s42, 128
v_cmp_lt_u32 vcc, s43, v4
s_cbranch_vccz LE_done
s_cmp_ge_u32 s42, 40
s_cbranch_scc1 LE_done
s_waitcnt vmcnt(0) lgkmcnt(0)
s_add_u32 s50, s50, 512
v_add_u32 v5, 0x80, v5
buffer_load_dwordx4 v[192:195], v6, s[12:15], s50 offen offset:0
buffer_load_dwordx4 v[196:199], v6, s[12:15], s50 offen offset:32
buffer_load_dwordx4 v[200:203], v6, s[12:15], s50 offen offset:64
buffer_load_dwordx4 v[204:207], v6, s[12:15], s50 offen offset:96
buffer_load_dwordx4 v[208:211], v6, s[12:15], s50 offen offset:128
buffer_load_dwordx4 v[212:215], v6, s[12:15], s50 offen offset:160
buffer_load_dwordx4 v[216:219], v6, s[12:15], s50 offen offset:192
buffer_load_dwordx4 v[220:223], v6, s[12:15], s50 offen offset:224
buffer_load_dwordx4 v[224:227], v6, s[12:15], s50 offen offset:256
buffer_load_dwordx4 v[228:231], v6, s[12:15], s50 offen offset:288
buffer_load_dwordx4 v[232:235], v6, s[12:15], s50 offen offset:320
buffer_load_dwordx4 v[236:239], v6, s[12:15], s50 offen offset:352
buffer_load_dwordx4 v[240:243], v6, s[12:15], s50 offen offset:384
buffer_load_dwordx4 v[244:247], v6, s[12:15], s50 offen offset:416
buffer_load_dwordx4 v[248:251], v6, s[12:15], s50 offen offset:448
buffer_load_dwordx4 v[252:255], v6, s[12:15], s50 offen offset:480
s_branch LE_pass
LE_done:
s_branch L2_end
L2_fin:
L2_end:
s_endpgm
.globl k3_kernel
.p2align 8
.type k3_kernel,@function
k3_kernel:
s_load_dwordx2 s[4:5], s[0:1], 0
s_load_dwordx2 s[6:7], s[0:1], 24
s_load_dwordx2 s[8:9], s[0:1], 72
s_load_dwordx2 s[10:11], s[0:1], 88
s_cmp_ge_u32 s2, 256
s_cbranch_scc1 L3_end
v_lshrrev_b32 v1, 6, v0
v_and_b32 v0, 63, v0
s_and_b32 s3, s2, 7
v_readfirstlane_b32 s44, v1
s_lshr_b32 s12, s2, 3
s_mul_i32 s3, s3, 1280
s_mul_i32 s13, s12, 40
s_add_u32 s45, s3, s13
v_and_b32 v2, 15, v0
v_lshrrev_b32 v3, 4, v0
v_lshlrev_b32 v4, 4, v0
v_lshlrev_b32 v68, 7, v0
s_lshl_b32 s81, s12, 13
s_cmp_eq_u32 s44, 7
s_cselect_b32 s81, s81, 0x7fff0000
s_lshr_b32 s14, s44, 2
s_lshl_b32 s15, s14, 2
v_add_u32 v1, s15, v3
v_and_b32 v5, 7, v0
v_xor_b32 v1, v1, v5
v_lshrrev_b32 v5, 3, v0
v_lshlrev_b32 v5, 9, v5
v_lshl_add_u32 v5, v1, 4, v5
s_lshl_b32 s46, s45, 9
s_add_u32 s47, s46, 8192
s_add_u32 s48, s46, 16384
s_lshl_b32 s15, s14, 12
s_and_b32 s3, s44, 3
s_lshl_b32 s3, s3, 7
s_add_u32 s15, s15, s3
s_add_u32 s50, s46, s15
s_add_u32 s51, s47, s15
s_add_u32 s52, s48, s15
s_cmp_eq_u32 s14, 0
s_cselect_b32 s52, s52, 0x7fff0000
s_lshl_b32 s53, s44, 10
v_lshlrev_b32 v6, 6, v0
v_lshlrev_b32 v7, 1, v0
s_lshl_b32 s14, s45, 6
s_lshl_b32 s15, s45, 1
s_lshl_b32 s3, s44, 6
v_lshrrev_b32 v1, 2, v0
v_xor_b32 v8, v0, v3
v_and_b32 v8, 3, v8
v_lshl_add_u32 v1, v1, 9, s3
v_lshl_add_u32 v8, v8, 4, v1
s_and_b32 s3, s45, 8
v_add_u32 v1, s3, v2
v_lshrrev_b32 v9, 4, v1
v_and_b32 v1, 15, v1
v_lshlrev_b32 v9, 13, v9
v_lshl_add_u32 v9, v1, 4, v9
v_lshl_add_u32 v9, v3, 8, v9
v_add_u32 v9, s53, v9
s_lshr_b32 s3, s45, 4
s_lshl_b32 s3, s3, 13
s_waitcnt lgkmcnt(0)
s_add_u32 s40, s10, 0x1000000
s_addc_u32 s41, s11, 0
s_mov_b32 s42, 0x40000
s_mov_b32 s43, 0x00020000
buffer_load_dword v68, v68, s[40:43], s81 offen
s_cmp_ge_u32 s45, 10000
s_cbranch_scc1 L3_end
s_add_u32 s36, s10, 0x7000000
s_addc_u32 s37, s11, 0
s_mov_b32 s38, 0x4e2000
s_mov_b32 s39, 0x00020000
s_add_u32 s32, s10, 0x6000000
s_addc_u32 s33, s11, 0
s_mov_b32 s34, 0x9c800
s_mov_b32 s35, 0x00020000
s_add_u32 s20, s6, 0x0
s_addc_u32 s21, s7, 0
s_mov_b32 s22, 0x4e20
s_mov_b32 s23, 0x00020000
s_add_u32 s28, s10, 0x2000000
s_addc_u32 s29, s11, 0
s_mov_b32 s30, 0x22e4000
s_mov_b32 s31, 0x00020000
s_add_u32 s16, s4, 0x0
s_addc_u32 s17, s5, 0
s_mov_b32 s18, 0x4e2000
s_mov_b32 s19, 0x00020000
s_mul_i32 s81, s44, 3072
s_add_u32 s81, s81, 65536
s_lshl_b32 s72, s44, 14
s_add_u32 s73, s72, 0x1000
s_add_u32 s74, s72, 0x2000
s_add_u32 s75, s72, 0x3000
s_add_u32 s76, s72, 0x20000
s_add_u32 s77, s72, 0x21000
s_add_u32 s78, s72, 0x22000
s_add_u32 s79, s72, 0x23000
s_mov_b32 exec_hi, 0xff
buffer_load_dwordx4 v[100:103], v6, s[32:35], s14 offen offset:0
s_mov_b32 exec_hi, -1
s_mov_b32 exec_hi, 0xff
buffer_load_dwordx4 v[104:107], v6, s[32:35], s14 offen offset:16
s_mov_b32 exec_hi, -1
s_mov_b32 exec_hi, 0xff
buffer_load_dwordx4 v[108:111], v6, s[32:35], s14 offen offset:32
s_mov_b32 exec_hi, -1
s_mov_b32 exec_hi, 0xff
buffer_load_ushort v112, v7, s[20:23], s15 offen
s_mov_b32 exec_hi, -1
s_add_u32 m0, s53, 0
s_nop 0
buffer_load_dwordx4 v5, s[36:39], s50 offen lds
s_add_u32 m0, s53, 8192
s_nop 0
buffer_load_dwordx4 v5, s[36:39], s51 offen lds
s_and_b32 s12, s45, 8
v_and_b32 v1, 7, v2
v_add_u32 v1, s12, v1
v_lshl_add_u32 v17, v3, 8, s53
v_lshl_add_u32 v17, v1, 4, v17
v_lshrrev_b32 v1, 3, v2
s_mov_b32 s12, 0x1200000
v_mul_lo_u32 v1, v1, s12
v_add_u32 v17, v1, v17
v_lshrrev_b32 v1, 1, v2
v_xor_b32 v1, v1, v3
v_lshrrev_b32 v10, 3, v2
v_lshlrev_b32 v10, 12, v10
v_lshl_add_u32 v10, v1, 4, v10
v_and_b32 v1, 7, v2
v_lshl_add_u32 v10, v1, 7, v10
v_xor_b32 v11, 64, v10
s_lshl_b32 s12, s44, 11
s_add_u32 s12, s12, 49152
v_lshl_add_u32 v12, v0, 5, s12
v_lshl_add_u32 v13, v2, 5, s12
v_lshl_add_u32 v18, v1, 5, s12
v_lshrrev_b32 v1, 3, v2
v_lshl_add_u32 v18, v1, 4, v18
v_lshrrev_b32 v1, 2, v2
v_xor_b32 v1, v1, v3
v_lshl_add_u32 v14, v2, 6, s81
v_lshl_add_u32 v14, v1, 4, v14
v_add_u32 v15, s81, v4
s_add_u32 s12, s53, 24576
v_add_u32 v16, s12, v4
s_mov_b32 s80, 0xffff0000
s_add_u32 s24, s8, 0x0
s_addc_u32 s25, s9, 0
s_mov_b32 s26, 0x4e2000
s_mov_b32 s27, 0x00020000
s_waitcnt vmcnt(5)
s_add_u32 m0, s53, 16384
s_nop 0
buffer_load_dwordx4 v5, s[36:39], s52 offen lds
s_waitcnt vmcnt(5)
s_add_u32 s54, s3, 0x0
buffer_load_dwordx4 v[116:119], v9, s[28:31], s54 offen
s_waitcnt vmcnt(5)
s_add_u32 s55, s3, 0x600000
buffer_load_dwordx4 v[120:123], v9, s[28:31], s55 offen
s_waitcnt vmcnt(5)
s_add_u32 s56, s3, 0xc00000
buffer_load_dwordx4 v[124:127], v9, s[28:31], s56 offen
v_max3_f32 v1, v100, v102, v104
v_max3_f32 v69, v106, v108, v110
v_max_f32 v1, v1, v69
v_sub_f32 v100, v100, v1
v_sub_f32 v102, v102, v1
v_sub_f32 v104, v104, v1
v_sub_f32 v106, v106, v1
v_sub_f32 v108, v108, v1
v_sub_f32 v110, v110, v1
v_exp_f32 v100, v100
v_exp_f32 v102, v102
v_exp_f32 v104, v104
v_exp_f32 v106, v106
v_exp_f32 v108, v108
v_exp_f32 v110, v110
v_lshlrev_b32 v63, 16, v112
v_mul_f32 v1, v100, v101
v_fmac_f32 v1, v102, v103
v_fmac_f32 v1, v104, v105
v_fmac_f32 v1, v106, v107
v_fmac_f32 v1, v108, v109
v_fmac_f32 v1, v110, v111
v_rcp_f32 v1, v1
v_mov_b32 v67, v63
v_mul_f32 v60, v100, v1
v_mul_f32 v61, v102, v1
v_mul_f32 v62, v104, v1
v_mul_f32 v64, v106, v1
v_mul_f32 v65, v108, v1
v_mul_f32 v66, v110, v1
ds_write_b128 v12, v[60:63]
ds_write_b128 v12, v[64:67] offset:16
ds_read_b32 v19, v13 offset:12
ds_read_b32 v20, v13 offset:524
ds_read_b32 v21, v13 offset:1036
ds_read_b128 v[52:55], v13 offset:0
ds_read_b128 v[56:59], v13 offset:16
s_waitcnt vmcnt(5)
buffer_load_dwordx4 v[128:131], v4, s[40:43], s72 offen offset:0
s_waitcnt vmcnt(5)
buffer_load_dwordx4 v[132:135], v4, s[40:43], s72 offen offset:1024
s_waitcnt vmcnt(5)
buffer_load_dwordx4 v[136:139], v4, s[40:43], s72 offen offset:2048
s_waitcnt vmcnt(5)
s_add_u32 s57, s3, 0x1200000
buffer_load_dwordx4 v[140:143], v9, s[28:31], s57 offen
s_waitcnt lgkmcnt(0)
v_lshlrev_b32 v70, 16, v116
v_and_b32 v71, s80, v116
v_mul_f32 v60, v70, v52
v_mul_f32 v61, v71, v52
v_lshlrev_b32 v72, 16, v117
v_and_b32 v73, s80, v117
v_mul_f32 v62, v72, v52
v_mul_f32 v63, v73, v52
v_lshlrev_b32 v74, 16, v118
v_and_b32 v75, s80, v118
v_mul_f32 v64, v74, v52
v_mul_f32 v65, v75, v52
v_lshlrev_b32 v68, 16, v119
v_and_b32 v69, s80, v119
v_mul_f32 v66, v68, v52
v_mul_f32 v67, v69, v52
s_barrier
ds_read_b128 v[76:79], v10 offset:0
ds_read_b128 v[80:83], v10 offset:8192
ds_read_b128 v[84:87], v10 offset:16384
ds_read_b128 v[88:91], v11 offset:0
ds_read_b128 v[92:95], v11 offset:8192
s_waitcnt vmcnt(5)
buffer_load_dwordx4 v[144:147], v4, s[40:43], s72 offen offset:3072
v_lshlrev_b32 v70, 16, v120
v_and_b32 v71, s80, v120
v_fmac_f32 v60, v70, v53
v_fmac_f32 v61, v71, v53
v_lshlrev_b32 v72, 16, v121
v_and_b32 v73, s80, v121
v_fmac_f32 v62, v72, v53
v_fmac_f32 v63, v73, v53
v_lshlrev_b32 v74, 16, v122
v_and_b32 v75, s80, v122
v_fmac_f32 v64, v74, v53
v_fmac_f32 v65, v75, v53
v_lshlrev_b32 v68, 16, v123
v_and_b32 v69, s80, v123
v_fmac_f32 v66, v68, v53
v_fmac_f32 v67, v69, v53
s_waitcnt vmcnt(5)
buffer_load_dwordx4 v[148:151], v4, s[40:43], s73 offen offset:0
v_lshlrev_b32 v70, 16, v124
v_and_b32 v71, s80, v124
v_fmac_f32 v60, v70, v54
v_fmac_f32 v61, v71, v54
v_lshlrev_b32 v72, 16, v125
v_and_b32 v73, s80, v125
v_fmac_f32 v62, v72, v54
v_fmac_f32 v63, v73, v54
v_lshlrev_b32 v74, 16, v126
v_and_b32 v75, s80, v126
v_fmac_f32 v64, v74, v54
v_fmac_f32 v65, v75, v54
v_lshlrev_b32 v68, 16, v127
v_and_b32 v69, s80, v127
v_fmac_f32 v66, v68, v54
v_fmac_f32 v67, v69, v54
s_waitcnt vmcnt(5)
buffer_load_dwordx4 v[152:155], v4, s[40:43], s73 offen offset:1024
s_waitcnt vmcnt(5)
s_add_u32 s54, s3, 0x1800000
buffer_load_dwordx4 v[156:159], v9, s[28:31], s54 offen
s_waitcnt lgkmcnt(4)
v_mfma_f32_16x16x32_bf16 v[24:27], v[128:131], v[76:79], 0
ds_read_b128 v[96:99], v11 offset:16384
v_mfma_f32_16x16x32_bf16 v[28:31], v[132:135], v[76:79], 0
s_waitcnt lgkmcnt(4)
v_mfma_f32_16x16x32_bf16 v[32:35], v[128:131], v[80:83], 0
ds_read_b128 v[76:79], v10 offset:1024
v_mfma_f32_16x16x32_bf16 v[36:39], v[132:135], v[80:83], 0
s_waitcnt lgkmcnt(4)
v_mfma_f32_16x16x32_bf16 v[40:43], v[128:131], v[84:87], 0
ds_read_b128 v[80:83], v10 offset:9216
v_mfma_f32_16x16x32_bf16 v[44:47], v[132:135], v[84:87], 0
s_waitcnt vmcnt(5)
buffer_load_dwordx4 v[160:163], v4, s[40:43], s73 offen offset:2048
s_waitcnt vmcnt(5)
buffer_load_dwordx4 v[164:167], v4, s[40:43], s73 offen offset:3072
v_lshlrev_b32 v70, 16, v140
v_and_b32 v71, s80, v140
v_fmac_f32 v60, v70, v56
v_fmac_f32 v61, v71, v56
v_lshlrev_b32 v72, 16, v141
v_and_b32 v73, s80, v141
v_fmac_f32 v62, v72, v56
v_fmac_f32 v63, v73, v56
v_lshlrev_b32 v74, 16, v142
v_and_b32 v75, s80, v142
v_fmac_f32 v64, v74, v56
v_fmac_f32 v65, v75, v56
v_lshlrev_b32 v68, 16, v143
v_and_b32 v69, s80, v143
v_fmac_f32 v66, v68, v56
v_fmac_f32 v67, v69, v56
s_waitcnt vmcnt(5)
buffer_load_dwordx4 v[168:171], v4, s[40:43], s74 offen offset:0
s_waitcnt lgkmcnt(4)
v_mfma_f32_16x16x32_bf16 v[24:27], v[136:139], v[88:91], v[24:27]
ds_read_b128 v[84:87], v10 offset:17408
v_mfma_f32_16x16x32_bf16 v[28:31], v[144:147], v[88:91], v[28:31]
s_waitcnt lgkmcnt(4)
v_mfma_f32_16x16x32_bf16 v[32:35], v[136:139], v[92:95], v[32:35]
ds_read_b128 v[88:91], v11 offset:1024
v_mfma_f32_16x16x32_bf16 v[36:39], v[144:147], v[92:95], v[36:39]
s_waitcnt lgkmcnt(4)
v_mfma_f32_16x16x32_bf16 v[40:43], v[136:139], v[96:99], v[40:43]
ds_read_b128 v[92:95], v11 offset:9216
v_mfma_f32_16x16x32_bf16 v[44:47], v[144:147], v[96:99], v[44:47]
s_waitcnt vmcnt(5)
s_add_u32 s55, s3, 0x1e00000
buffer_load_dwordx4 v[172:175], v9, s[28:31], s55 offen
s_waitcnt vmcnt(5)
buffer_load_dwordx4 v[176:179], v4, s[40:43], s74 offen offset:1024
s_waitcnt lgkmcnt(4)
v_mfma_f32_16x16x32_bf16 v[24:27], v[148:151], v[76:79], v[24:27]
ds_read_b128 v[96:99], v11 offset:17408
v_mfma_f32_16x16x32_bf16 v[28:31], v[152:155], v[76:79], v[28:31]
s_waitcnt lgkmcnt(4)
v_mfma_f32_16x16x32_bf16 v[32:35], v[148:151], v[80:83], v[32:35]
ds_read_b128 v[76:79], v10 offset:2048
v_mfma_f32_16x16x32_bf16 v[36:39], v[152:155], v[80:83], v[36:39]
s_waitcnt lgkmcnt(4)
v_mfma_f32_16x16x32_bf16 v[40:43], v[148:151], v[84:87], v[40:43]
ds_read_b128 v[80:83], v10 offset:10240
v_mfma_f32_16x16x32_bf16 v[44:47], v[152:155], v[84:87], v[44:47]
s_waitcnt vmcnt(5)
buffer_load_dwordx4 v[180:183], v4, s[40:43], s74 offen offset:2048
v_lshlrev_b32 v70, 16, v156
v_and_b32 v71, s80, v156
v_fmac_f32 v60, v70, v57
v_fmac_f32 v61, v71, v57
v_lshlrev_b32 v72, 16, v157
v_and_b32 v73, s80, v157
v_fmac_f32 v62, v72, v57
v_fmac_f32 v63, v73, v57
v_lshlrev_b32 v74, 16, v158
v_and_b32 v75, s80, v158
v_fmac_f32 v64, v74, v57
v_fmac_f32 v65, v75, v57
v_lshlrev_b32 v68, 16, v159
v_and_b32 v69, s80, v159
v_fmac_f32 v66, v68, v57
v_fmac_f32 v67, v69, v57
s_waitcnt vmcnt(5)
buffer_load_dwordx4 v[184:187], v4, s[40:43], s74 offen offset:3072
s_waitcnt vmcnt(5)
s_add_u32 m0, s81, 0
s_nop 0
buffer_load_dwordx4 v8, s[16:19], s46 offen lds
s_waitcnt lgkmcnt(4)
v_mfma_f32_16x16x32_bf16 v[24:27], v[160:163], v[88:91], v[24:27]
ds_read_b128 v[84:87], v10 offset:18432
v_mfma_f32_16x16x32_bf16 v[28:31], v[164:167], v[88:91], v[28:31]
s_waitcnt lgkmcnt(4)
v_mfma_f32_16x16x32_bf16 v[32:35], v[160:163], v[92:95], v[32:35]
ds_read_b128 v[88:91], v11 offset:2048
v_mfma_f32_16x16x32_bf16 v[36:39], v[164:167], v[92:95], v[36:39]
s_waitcnt lgkmcnt(4)
v_mfma_f32_16x16x32_bf16 v[40:43], v[160:163], v[96:99], v[40:43]
ds_read_b128 v[92:95], v11 offset:10240
v_mfma_f32_16x16x32_bf16 v[44:47], v[164:167], v[96:99], v[44:47]
s_waitcnt vmcnt(5)
buffer_load_dwordx4 v[188:191], v4, s[40:43], s75 offen offset:0
s_waitcnt vmcnt(5)
s_add_u32 m0, s81, 1024
s_nop 0
buffer_load_dwordx4 v8, s[16:19], s47 offen lds
v_lshlrev_b32 v70, 16, v172
v_and_b32 v71, s80, v172
v_fmac_f32 v60, v70, v58
v_fmac_f32 v61, v71, v58
v_lshlrev_b32 v72, 16, v173
v_and_b32 v73, s80, v173
v_fmac_f32 v62, v72, v58
v_fmac_f32 v63, v73, v58
v_lshlrev_b32 v74, 16, v174
v_and_b32 v75, s80, v174
v_fmac_f32 v64, v74, v58
v_fmac_f32 v65, v75, v58
v_lshlrev_b32 v68, 16, v175
v_and_b32 v69, s80, v175
v_fmac_f32 v66, v68, v58
v_fmac_f32 v67, v69, v58
ds_read_b128 v[52:55], v18 offset:1024
v_cvt_pk_bf16_f32 v68, v60, v61
v_cvt_pk_bf16_f32 v69, v62, v63
v_cvt_pk_bf16_f32 v70, v64, v65
v_cvt_pk_bf16_f32 v71, v66, v67
ds_write_b128 v16, v[68:71] offset:0
s_waitcnt vmcnt(5)
buffer_load_dwordx4 v[192:195], v4, s[40:43], s75 offen offset:1024
s_waitcnt lgkmcnt(6)
v_mfma_f32_16x16x32_bf16 v[24:27], v[168:171], v[76:79], v[24:27]
ds_read_b128 v[96:99], v11 offset:18432
v_mfma_f32_16x16x32_bf16 v[28:31], v[176:179], v[76:79], v[28:31]
s_waitcnt lgkmcnt(6)
v_mfma_f32_16x16x32_bf16 v[32:35], v[168:171], v[80:83], v[32:35]
ds_read_b128 v[76:79], v10 offset:3072
v_mfma_f32_16x16x32_bf16 v[36:39], v[176:179], v[80:83], v[36:39]
s_waitcnt lgkmcnt(6)
v_mfma_f32_16x16x32_bf16 v[40:43], v[168:171], v[84:87], v[40:43]
ds_read_b128 v[80:83], v10 offset:11264
v_mfma_f32_16x16x32_bf16 v[44:47], v[176:179], v[84:87], v[44:47]
s_waitcnt vmcnt(5)
s_add_u32 m0, s81, 2048
s_mov_b32 exec_hi, 0
buffer_load_dwordx4 v8, s[16:19], s48 offen lds
s_mov_b32 exec_hi, -1
s_waitcnt vmcnt(5)
buffer_load_dwordx4 v[196:199], v4, s[40:43], s75 offen offset:2048
s_waitcnt lgkmcnt(6)
v_mfma_f32_16x16x32_bf16 v[24:27], v[180:183], v[88:91], v[24:27]
ds_read_b128 v[84:87], v10 offset:19456
v_mfma_f32_16x16x32_bf16 v[28:31], v[184:187], v[88:91], v[28:31]
s_waitcnt lgkmcnt(6)
v_mfma_f32_16x16x32_bf16 v[32:35], v[180:183], v[92:95], v[32:35]
ds_read_b128 v[88:91], v11 offset:3072
v_mfma_f32_16x16x32_bf16 v[36:39], v[184:187], v[92:95], v[36:39]
s_waitcnt lgkmcnt(4)
v_mfma_f32_16x16x32_bf16 v[40:43], v[180:183], v[96:99], v[40:43]
ds_read_b128 v[92:95], v11 offset:11264
v_mfma_f32_16x16x32_bf16 v[44:47], v[184:187], v[96:99], v[44:47]
s_waitcnt vmcnt(5)
buffer_load_dwordx4 v[200:203], v4, s[40:43], s75 offen offset:3072
s_waitcnt vmcnt(5)
s_add_u32 s54, s3, 0x4000
buffer_load_dwordx4 v[204:207], v17, s[28:31], s54 offen
s_waitcnt vmcnt(5)
buffer_load_dwordx4 v[208:211], v4, s[40:43], s76 offen offset:0
s_waitcnt vmcnt(5)
buffer_load_dwordx4 v[212:215], v4, s[40:43], s76 offen offset:1024
s_waitcnt lgkmcnt(4)
v_mfma_f32_16x16x32_bf16 v[24:27], v[188:191], v[76:79], v[24:27]
ds_read_b128 v[96:99], v11 offset:19456
v_mfma_f32_16x16x32_bf16 v[28:31], v[192:195], v[76:79], v[28:31]
s_waitcnt lgkmcnt(4)
v_mfma_f32_16x16x32_bf16 v[32:35], v[188:191], v[80:83], v[32:35]
v_mfma_f32_16x16x32_bf16 v[36:39], v[192:195], v[80:83], v[36:39]
s_waitcnt lgkmcnt(3)
v_mfma_f32_16x16x32_bf16 v[40:43], v[188:191], v[84:87], v[40:43]
v_mfma_f32_16x16x32_bf16 v[44:47], v[192:195], v[84:87], v[44:47]
s_waitcnt vmcnt(5)
buffer_load_dwordx4 v[216:219], v4, s[40:43], s76 offen offset:2048
s_waitcnt vmcnt(5)
s_add_u32 s55, s3, 0x604000
buffer_load_dwordx4 v[220:223], v17, s[28:31], s55 offen
s_waitcnt vmcnt(5)
buffer_load_dwordx4 v[224:227], v4, s[40:43], s76 offen offset:3072
s_waitcnt lgkmcnt(2)
v_mfma_f32_16x16x32_bf16 v[24:27], v[196:199], v[88:91], v[24:27]
v_mfma_f32_16x16x32_bf16 v[28:31], v[200:203], v[88:91], v[28:31]
s_waitcnt lgkmcnt(1)
v_mfma_f32_16x16x32_bf16 v[32:35], v[196:199], v[92:95], v[32:35]
v_mfma_f32_16x16x32_bf16 v[36:39], v[200:203], v[92:95], v[36:39]
ds_read_b128 v[48:51], v14 offset:0
s_waitcnt lgkmcnt(0)
v_lshlrev_b32 v70, 16, v48
v_and_b32 v71, s80, v48
v_fma_f32 v24, v24, v19, v70
v_fma_f32 v25, v25, v19, v71
v_lshlrev_b32 v72, 16, v49
v_and_b32 v73, s80, v49
v_fma_f32 v26, v26, v19, v72
v_fma_f32 v27, v27, v19, v73
v_lshlrev_b32 v74, 16, v50
v_and_b32 v75, s80, v50
v_fma_f32 v28, v28, v19, v74
v_fma_f32 v29, v29, v19, v75
v_lshlrev_b32 v68, 16, v51
v_and_b32 v69, s80, v51
v_fma_f32 v30, v30, v19, v68
v_fma_f32 v31, v31, v19, v69
v_mfma_f32_16x16x32_bf16 v[40:43], v[196:199], v[96:99], v[40:43]
v_mfma_f32_16x16x32_bf16 v[44:47], v[200:203], v[96:99], v[44:47]
ds_read_b128 v[48:51], v14 offset:1024
s_waitcnt lgkmcnt(0)
v_lshlrev_b32 v70, 16, v48
v_and_b32 v71, s80, v48
v_fma_f32 v32, v32, v20, v70
v_fma_f32 v33, v33, v20, v71
v_lshlrev_b32 v72, 16, v49
v_and_b32 v73, s80, v49
v_fma_f32 v34, v34, v20, v72
v_fma_f32 v35, v35, v20, v73
v_lshlrev_b32 v74, 16, v50
v_and_b32 v75, s80, v50
v_fma_f32 v36, v36, v20, v74
v_fma_f32 v37, v37, v20, v75
v_lshlrev_b32 v68, 16, v51
v_and_b32 v69, s80, v51
v_fma_f32 v38, v38, v20, v68
v_fma_f32 v39, v39, v20, v69
s_waitcnt vmcnt(5)
buffer_load_dwordx4 v[228:231], v4, s[40:43], s77 offen offset:0
ds_read_b128 v[48:51], v14 offset:2048
s_waitcnt lgkmcnt(0)
v_lshlrev_b32 v70, 16, v48
v_and_b32 v71, s80, v48
v_fma_f32 v40, v40, v21, v70
v_fma_f32 v41, v41, v21, v71
v_lshlrev_b32 v72, 16, v49
v_and_b32 v73, s80, v49
v_fma_f32 v42, v42, v21, v72
v_fma_f32 v43, v43, v21, v73
v_lshlrev_b32 v74, 16, v50
v_and_b32 v75, s80, v50
v_fma_f32 v44, v44, v21, v74
v_fma_f32 v45, v45, v21, v75
v_lshlrev_b32 v68, 16, v51
v_and_b32 v69, s80, v51
v_fma_f32 v46, v46, v21, v68
v_fma_f32 v47, v47, v21, v69
v_lshlrev_b32 v70, 16, v204
v_and_b32 v71, s80, v204
v_mul_f32 v60, v70, v52
v_mul_f32 v61, v71, v52
v_lshlrev_b32 v72, 16, v205
v_and_b32 v73, s80, v205
v_mul_f32 v62, v72, v52
v_mul_f32 v63, v73, v52
v_lshlrev_b32 v74, 16, v206
v_and_b32 v75, s80, v206
v_mul_f32 v64, v74, v52
v_mul_f32 v65, v75, v52
v_lshlrev_b32 v68, 16, v207
v_and_b32 v69, s80, v207
v_mul_f32 v66, v68, v52
v_mul_f32 v67, v69, v52
s_waitcnt vmcnt(5)
buffer_load_dwordx4 v[232:235], v4, s[40:43], s77 offen offset:1024
s_waitcnt vmcnt(5)
s_add_u32 s56, s3, 0xc04000
buffer_load_dwordx4 v[236:239], v17, s[28:31], s56 offen
s_waitcnt vmcnt(5)
buffer_load_dwordx4 v[240:243], v4, s[40:43], s77 offen offset:2048
s_waitcnt vmcnt(5)
buffer_load_dwordx4 v[244:247], v4, s[40:43], s77 offen offset:3072
v_lshlrev_b32 v70, 16, v220
v_and_b32 v71, s80, v220
v_fmac_f32 v60, v70, v53
v_fmac_f32 v61, v71, v53
v_lshlrev_b32 v72, 16, v221
v_and_b32 v73, s80, v221
v_fmac_f32 v62, v72, v53
v_fmac_f32 v63, v73, v53
v_lshlrev_b32 v74, 16, v222
v_and_b32 v75, s80, v222
v_fmac_f32 v64, v74, v53
v_fmac_f32 v65, v75, v53
v_lshlrev_b32 v68, 16, v223
v_and_b32 v69, s80, v223
v_fmac_f32 v66, v68, v53
v_fmac_f32 v67, v69, v53
s_waitcnt vmcnt(5)
buffer_load_dwordx4 v[248:251], v4, s[40:43], s78 offen offset:0
s_waitcnt vmcnt(5)
s_add_u32 s56, s3, 0x2000
buffer_load_dwordx4 v[252:255], v9, s[28:31], s56 offen
s_waitcnt vmcnt(5)
buffer_load_dwordx4 v[100:103], v4, s[40:43], s78 offen offset:1024
s_waitcnt vmcnt(5)
buffer_load_dwordx4 v[104:107], v4, s[40:43], s78 offen offset:2048
v_lshlrev_b32 v70, 16, v236
v_and_b32 v71, s80, v236
v_fmac_f32 v60, v70, v54
v_fmac_f32 v61, v71, v54
v_lshlrev_b32 v72, 16, v237
v_and_b32 v73, s80, v237
v_fmac_f32 v62, v72, v54
v_fmac_f32 v63, v73, v54
v_lshlrev_b32 v74, 16, v238
v_and_b32 v75, s80, v238
v_fmac_f32 v64, v74, v54
v_fmac_f32 v65, v75, v54
v_lshlrev_b32 v68, 16, v239
v_and_b32 v69, s80, v239
v_fmac_f32 v66, v68, v54
v_fmac_f32 v67, v69, v54
ds_read_b128 v[52:55], v13 offset:512
ds_read_b128 v[56:59], v13 offset:528
v_add_f32_dpp v60, v60, v60 row_ror:8 row_mask:0xf bank_mask:0xf
v_add_f32_dpp v61, v61, v61 row_ror:8 row_mask:0xf bank_mask:0xf
v_add_f32_dpp v62, v62, v62 row_ror:8 row_mask:0xf bank_mask:0xf
v_add_f32_dpp v63, v63, v63 row_ror:8 row_mask:0xf bank_mask:0xf
v_add_f32_dpp v64, v64, v64 row_ror:8 row_mask:0xf bank_mask:0xf
v_add_f32_dpp v65, v65, v65 row_ror:8 row_mask:0xf bank_mask:0xf
v_add_f32_dpp v66, v66, v66 row_ror:8 row_mask:0xf bank_mask:0xf
v_add_f32_dpp v67, v67, v67 row_ror:8 row_mask:0xf bank_mask:0xf
v_cvt_pk_bf16_f32 v68, v60, v61
v_cvt_pk_bf16_f32 v69, v62, v63
v_cvt_pk_bf16_f32 v70, v64, v65
v_cvt_pk_bf16_f32 v71, v66, v67
ds_write_b128 v16, v[68:71] offset:16384
s_waitcnt lgkmcnt(0)
s_barrier
ds_read_b128 v[76:79], v4 offset:24576
ds_read_b128 v[80:83], v4 offset:40960
ds_read_b128 v[84:87], v4 offset:25600
ds_read_b128 v[88:91], v4 offset:41984
ds_read_b128 v[92:95], v4 offset:26624
s_waitcnt lgkmcnt(4)
v_mfma_f32_16x16x32_bf16 v[24:27], v[208:211], v[76:79], v[24:27]
ds_read_b128 v[96:99], v4 offset:43008
v_mfma_f32_16x16x32_bf16 v[28:31], v[212:215], v[76:79], v[28:31]
s_waitcnt lgkmcnt(4)
v_mfma_f32_16x16x32_bf16 v[40:43], v[208:211], v[80:83], v[40:43]
ds_read_b128 v[76:79], v4 offset:27648
v_mfma_f32_16x16x32_bf16 v[44:47], v[212:215], v[80:83], v[44:47]
s_waitcnt lgkmcnt(4)
v_mfma_f32_16x16x32_bf16 v[24:27], v[216:219], v[84:87], v[24:27]
ds_read_b128 v[80:83], v4 offset:44032
v_mfma_f32_16x16x32_bf16 v[28:31], v[224:227], v[84:87], v[28:31]
s_waitcnt lgkmcnt(4)
v_mfma_f32_16x16x32_bf16 v[40:43], v[216:219], v[88:91], v[40:43]
ds_read_b128 v[84:87], v4 offset:28672
v_mfma_f32_16x16x32_bf16 v[44:47], v[224:227], v[88:91], v[44:47]
s_waitcnt vmcnt(5)
s_add_u32 s57, s3, 0x602000
buffer_load_dwordx4 v[108:111], v9, s[28:31], s57 offen
s_waitcnt lgkmcnt(4)
v_mfma_f32_16x16x32_bf16 v[24:27], v[228:231], v[92:95], v[24:27]
ds_read_b128 v[88:91], v4 offset:45056
v_mfma_f32_16x16x32_bf16 v[28:31], v[232:235], v[92:95], v[28:31]
s_waitcnt lgkmcnt(4)
v_mfma_f32_16x16x32_bf16 v[40:43], v[228:231], v[96:99], v[40:43]
ds_read_b128 v[92:95], v4 offset:29696
v_mfma_f32_16x16x32_bf16 v[44:47], v[232:235], v[96:99], v[44:47]
s_waitcnt vmcnt(5)
buffer_load_dwordx4 v[112:115], v4, s[40:43], s78 offen offset:3072
s_waitcnt lgkmcnt(4)
v_mfma_f32_16x16x32_bf16 v[24:27], v[240:243], v[76:79], v[24:27]
ds_read_b128 v[96:99], v4 offset:46080
v_mfma_f32_16x16x32_bf16 v[28:31], v[244:247], v[76:79], v[28:31]
s_waitcnt lgkmcnt(4)
v_mfma_f32_16x16x32_bf16 v[40:43], v[240:243], v[80:83], v[40:43]
ds_read_b128 v[76:79], v4 offset:30720
v_mfma_f32_16x16x32_bf16 v[44:47], v[244:247], v[80:83], v[44:47]
s_waitcnt vmcnt(5)
buffer_load_dwordx4 v[116:119], v4, s[40:43], s79 offen offset:0
s_waitcnt vmcnt(5)
s_add_u32 s54, s3, 0xc02000
buffer_load_dwordx4 v[120:123], v9, s[28:31], s54 offen
v_lshlrev_b32 v70, 16, v252
v_and_b32 v71, s80, v252
v_mul_f32 v60, v70, v52
v_mul_f32 v61, v71, v52
v_lshlrev_b32 v72, 16, v253
v_and_b32 v73, s80, v253
v_mul_f32 v62, v72, v52
v_mul_f32 v63, v73, v52
v_lshlrev_b32 v74, 16, v254
v_and_b32 v75, s80, v254
v_mul_f32 v64, v74, v52
v_mul_f32 v65, v75, v52
v_lshlrev_b32 v68, 16, v255
v_and_b32 v69, s80, v255
v_mul_f32 v66, v68, v52
v_mul_f32 v67, v69, v52
s_waitcnt vmcnt(5)
buffer_load_dwordx4 v[124:127], v4, s[40:43], s79 offen offset:1024
s_waitcnt lgkmcnt(4)
v_mfma_f32_16x16x32_bf16 v[24:27], v[248:251], v[84:87], v[24:27]
ds_read_b128 v[80:83], v4 offset:47104
v_mfma_f32_16x16x32_bf16 v[28:31], v[100:103], v[84:87], v[28:31]
s_waitcnt lgkmcnt(4)
v_mfma_f32_16x16x32_bf16 v[40:43], v[248:251], v[88:91], v[40:43]
ds_read_b128 v[84:87], v4 offset:31744
v_mfma_f32_16x16x32_bf16 v[44:47], v[100:103], v[88:91], v[44:47]
s_waitcnt vmcnt(5)
s_add_u32 s55, s3, 0x1202000
buffer_load_dwordx4 v[128:131], v9, s[28:31], s55 offen
s_waitcnt vmcnt(5)
buffer_load_dwordx4 v[132:135], v4, s[40:43], s79 offen offset:2048
v_lshlrev_b32 v70, 16, v108
v_and_b32 v71, s80, v108
v_fmac_f32 v60, v70, v53
v_fmac_f32 v61, v71, v53
v_lshlrev_b32 v72, 16, v109
v_and_b32 v73, s80, v109
v_fmac_f32 v62, v72, v53
v_fmac_f32 v63, v73, v53
v_lshlrev_b32 v74, 16, v110
v_and_b32 v75, s80, v110
v_fmac_f32 v64, v74, v53
v_fmac_f32 v65, v75, v53
v_lshlrev_b32 v68, 16, v111
v_and_b32 v69, s80, v111
v_fmac_f32 v66, v68, v53
v_fmac_f32 v67, v69, v53
s_waitcnt vmcnt(5)
s_add_u32 s56, s3, 0x1802000
buffer_load_dwordx4 v[140:143], v9, s[28:31], s56 offen
s_waitcnt lgkmcnt(4)
v_mfma_f32_16x16x32_bf16 v[24:27], v[104:107], v[92:95], v[24:27]
ds_read_b128 v[88:91], v4 offset:48128
v_mfma_f32_16x16x32_bf16 v[28:31], v[112:115], v[92:95], v[28:31]
s_waitcnt lgkmcnt(4)
v_mfma_f32_16x16x32_bf16 v[40:43], v[104:107], v[96:99], v[40:43]
v_mfma_f32_16x16x32_bf16 v[44:47], v[112:115], v[96:99], v[44:47]
s_waitcnt vmcnt(5)
buffer_load_dwordx4 v[136:139], v4, s[40:43], s79 offen offset:3072
s_waitcnt vmcnt(5)
s_add_u32 s57, s3, 0x1e02000
buffer_load_dwordx4 v[144:147], v9, s[28:31], s57 offen
v_lshlrev_b32 v70, 16, v120
v_and_b32 v71, s80, v120
v_fmac_f32 v60, v70, v54
v_fmac_f32 v61, v71, v54
v_lshlrev_b32 v72, 16, v121
v_and_b32 v73, s80, v121
v_fmac_f32 v62, v72, v54
v_fmac_f32 v63, v73, v54
v_lshlrev_b32 v74, 16, v122
v_and_b32 v75, s80, v122
v_fmac_f32 v64, v74, v54
v_fmac_f32 v65, v75, v54
v_lshlrev_b32 v68, 16, v123
v_and_b32 v69, s80, v123
v_fmac_f32 v66, v68, v54
v_fmac_f32 v67, v69, v54
s_waitcnt vmcnt(5)
s_waitcnt lgkmcnt(3)
v_mfma_f32_16x16x32_bf16 v[24:27], v[116:119], v[76:79], v[24:27]
v_mfma_f32_16x16x32_bf16 v[28:31], v[124:127], v[76:79], v[28:31]
s_waitcnt lgkmcnt(2)
v_mfma_f32_16x16x32_bf16 v[40:43], v[116:119], v[80:83], v[40:43]
v_mfma_f32_16x16x32_bf16 v[44:47], v[124:127], v[80:83], v[44:47]
s_waitcnt vmcnt(4)
v_lshlrev_b32 v70, 16, v128
v_and_b32 v71, s80, v128
v_fmac_f32 v60, v70, v56
v_fmac_f32 v61, v71, v56
v_lshlrev_b32 v72, 16, v129
v_and_b32 v73, s80, v129
v_fmac_f32 v62, v72, v56
v_fmac_f32 v63, v73, v56
v_lshlrev_b32 v74, 16, v130
v_and_b32 v75, s80, v130
v_fmac_f32 v64, v74, v56
v_fmac_f32 v65, v75, v56
v_lshlrev_b32 v68, 16, v131
v_and_b32 v69, s80, v131
v_fmac_f32 v66, v68, v56
v_fmac_f32 v67, v69, v56
s_waitcnt vmcnt(3)
s_waitcnt vmcnt(2)
v_lshlrev_b32 v70, 16, v140
v_and_b32 v71, s80, v140
v_fmac_f32 v60, v70, v57
v_fmac_f32 v61, v71, v57
v_lshlrev_b32 v72, 16, v141
v_and_b32 v73, s80, v141
v_fmac_f32 v62, v72, v57
v_fmac_f32 v63, v73, v57
v_lshlrev_b32 v74, 16, v142
v_and_b32 v75, s80, v142
v_fmac_f32 v64, v74, v57
v_fmac_f32 v65, v75, v57
v_lshlrev_b32 v68, 16, v143
v_and_b32 v69, s80, v143
v_fmac_f32 v66, v68, v57
v_fmac_f32 v67, v69, v57
s_waitcnt vmcnt(1)
s_waitcnt lgkmcnt(1)
v_mfma_f32_16x16x32_bf16 v[24:27], v[132:135], v[84:87], v[24:27]
v_mfma_f32_16x16x32_bf16 v[28:31], v[136:139], v[84:87], v[28:31]
s_waitcnt lgkmcnt(0)
v_mfma_f32_16x16x32_bf16 v[40:43], v[132:135], v[88:91], v[40:43]
v_mfma_f32_16x16x32_bf16 v[44:47], v[136:139], v[88:91], v[44:47]
s_nop 3
v_cvt_pk_bf16_f32 v24, v24, v25
v_cvt_pk_bf16_f32 v25, v26, v27
v_cvt_pk_bf16_f32 v26, v28, v29
v_cvt_pk_bf16_f32 v27, v30, v31
ds_write_b128 v14, v[24:27] offset:0
ds_read_b128 v[28:31], v15 offset:0
s_waitcnt vmcnt(0)
s_waitcnt lgkmcnt(0)
buffer_store_dwordx4 v[28:31], v8, s[24:27], s46 offen
v_cvt_pk_bf16_f32 v40, v40, v41
v_cvt_pk_bf16_f32 v41, v42, v43
v_cvt_pk_bf16_f32 v42, v44, v45
v_cvt_pk_bf16_f32 v43, v46, v47
ds_write_b128 v14, v[40:43] offset:2048
ds_read_b128 v[44:47], v15 offset:2048
v_lshlrev_b32 v70, 16, v144
v_and_b32 v71, s80, v144
v_fmac_f32 v60, v70, v58
v_fmac_f32 v61, v71, v58
v_lshlrev_b32 v72, 16, v145
v_and_b32 v73, s80, v145
v_fmac_f32 v62, v72, v58
v_fmac_f32 v63, v73, v58
v_lshlrev_b32 v74, 16, v146
v_and_b32 v75, s80, v146
v_fmac_f32 v64, v74, v58
v_fmac_f32 v65, v75, v58
v_lshlrev_b32 v68, 16, v147
v_and_b32 v69, s80, v147
v_fmac_f32 v66, v68, v58
v_fmac_f32 v67, v69, v58
v_cvt_pk_bf16_f32 v68, v60, v61
v_cvt_pk_bf16_f32 v69, v62, v63
v_cvt_pk_bf16_f32 v70, v64, v65
v_cvt_pk_bf16_f32 v71, v66, v67
ds_write_b128 v16, v[68:71] offset:8192
s_waitcnt lgkmcnt(0)
s_barrier
ds_read_b128 v[92:95], v4 offset:32768
ds_read_b128 v[96:99], v4 offset:33792
ds_read_b128 v[76:79], v4 offset:34816
ds_read_b128 v[80:83], v4 offset:35840
ds_read_b128 v[84:87], v4 offset:36864
s_waitcnt lgkmcnt(4)
v_mfma_f32_16x16x32_bf16 v[32:35], v[208:211], v[92:95], v[32:35]
ds_read_b128 v[88:91], v4 offset:37888
v_mfma_f32_16x16x32_bf16 v[36:39], v[212:215], v[92:95], v[36:39]
s_waitcnt lgkmcnt(4)
v_mfma_f32_16x16x32_bf16 v[32:35], v[216:219], v[96:99], v[32:35]
ds_read_b128 v[92:95], v4 offset:38912
v_mfma_f32_16x16x32_bf16 v[36:39], v[224:227], v[96:99], v[36:39]
s_waitcnt lgkmcnt(4)
v_mfma_f32_16x16x32_bf16 v[32:35], v[228:231], v[76:79], v[32:35]
ds_read_b128 v[96:99], v4 offset:39936
v_mfma_f32_16x16x32_bf16 v[36:39], v[232:235], v[76:79], v[36:39]
s_waitcnt lgkmcnt(4)
v_mfma_f32_16x16x32_bf16 v[32:35], v[240:243], v[80:83], v[32:35]
v_mfma_f32_16x16x32_bf16 v[36:39], v[244:247], v[80:83], v[36:39]
s_waitcnt lgkmcnt(3)
v_mfma_f32_16x16x32_bf16 v[32:35], v[248:251], v[84:87], v[32:35]
v_mfma_f32_16x16x32_bf16 v[36:39], v[100:103], v[84:87], v[36:39]
s_waitcnt lgkmcnt(2)
v_mfma_f32_16x16x32_bf16 v[32:35], v[104:107], v[88:91], v[32:35]
v_mfma_f32_16x16x32_bf16 v[36:39], v[112:115], v[88:91], v[36:39]
s_waitcnt lgkmcnt(1)
v_mfma_f32_16x16x32_bf16 v[32:35], v[116:119], v[92:95], v[32:35]
v_mfma_f32_16x16x32_bf16 v[36:39], v[124:127], v[92:95], v[36:39]
s_waitcnt lgkmcnt(0)
v_mfma_f32_16x16x32_bf16 v[32:35], v[132:135], v[96:99], v[32:35]
v_mfma_f32_16x16x32_bf16 v[36:39], v[136:139], v[96:99], v[36:39]
s_nop 6
v_cvt_pk_bf16_f32 v32, v32, v33
v_cvt_pk_bf16_f32 v33, v34, v35
v_cvt_pk_bf16_f32 v34, v36, v37
v_cvt_pk_bf16_f32 v35, v38, v39
ds_write_b128 v14, v[32:35] offset:1024
ds_read_b128 v[36:39], v15 offset:1024
s_mov_b32 exec_hi, 0
buffer_store_dwordx4 v[44:47], v8, s[24:27], s48 offen
s_mov_b32 exec_hi, -1
s_waitcnt lgkmcnt(0)
buffer_store_dwordx4 v[36:39], v8, s[24:27], s47 offen
L3_end:
s_endpgm
.section .rodata,"a"
.p2align 6
.amdhsa_kernel k1_kernel
  .amdhsa_next_free_vgpr 256
  .amdhsa_next_free_sgpr 102
  .amdhsa_accum_offset 256
  .amdhsa_group_segment_fixed_size 0
  .amdhsa_kernarg_size 96
  .amdhsa_user_sgpr_count 2
  .amdhsa_user_sgpr_kernarg_segment_ptr 1
  .amdhsa_system_sgpr_workgroup_id_x 1
.end_amdhsa_kernel
.p2align 6
.amdhsa_kernel k2_kernel
  .amdhsa_next_free_vgpr 512
  .amdhsa_next_free_sgpr 102
  .amdhsa_accum_offset 256
  .amdhsa_group_segment_fixed_size 0
  .amdhsa_kernarg_size 96
  .amdhsa_user_sgpr_count 2
  .amdhsa_user_sgpr_kernarg_segment_ptr 1
  .amdhsa_system_sgpr_workgroup_id_x 1
.end_amdhsa_kernel
.p2align 6
.amdhsa_kernel k3_kernel
  .amdhsa_next_free_vgpr 256
  .amdhsa_next_free_sgpr 102
  .amdhsa_accum_offset 256
  .amdhsa_group_segment_fixed_size 0
  .amdhsa_kernarg_size 96
  .amdhsa_user_sgpr_count 2
  .amdhsa_user_sgpr_kernarg_segment_ptr 1
  .amdhsa_system_sgpr_workgroup_id_x 1
.end_amdhsa_kernel
```

```asm
; @launch kernel=k1_kernel grid=(249,1,1) block=(512,1,1) lds=163840
; @launch kernel=k2_kernel grid=(256,1,1) block=(256,1,1) lds=163840
; @launch kernel=k3_kernel grid=(256,1,1) block=(512,1,1) lds=90112
.amdgcn_target "amdgcn-amd-amdhsa--gfx950"
.text
.globl k1_kernel
.p2align 8
.type k1_kernel,@function
k1_kernel:
s_getpc_b64 s[56:57]
s_load_dwordx16 s[16:31], s[0:1], 0
s_load_dwordx8 s[32:39], s[0:1], 64
s_cmp_ge_u32 s2, 249
s_cbranch_scc1 L1_end
v_lshrrev_b32 v1, 6, v0
v_and_b32 v2, 63, v0
s_lshr_b32 s3, s2, 3
v_readfirstlane_b32 s60, v1
s_mul_i32 s5, s3, 8
s_add_u32 s5, s5, s60
s_and_b32 s56, s56, 0xffffff00
s_mov_b32 s58, L3_end-k1_kernel
s_mov_b32 s59, 0x00020000
s_and_b32 s6, s5, 15
s_lshl_b32 s6, s6, 13
v_lshlrev_b32 v10, 7, v2
buffer_load_dword v255, v10, s[56:59], s6 offen
v_and_b32 v3, 15, v2
v_lshrrev_b32 v4, 4, v2
s_and_b32 s62, s3, 7
s_sub_u32 s4, s2, 40
s_cmp_lt_u32 s2, 40
s_cbranch_scc1 L1_notq
s_mov_b32 s61, 0
v_lshlrev_b32 v16, 4, v2
s_mul_i32 s63, s60, 6144
s_mul_i32 s6, s4, 24576
s_mul_i32 s7, s60, 3072
s_add_u32 s64, s6, s7
s_add_u32 s65, s64, 4096
s_lshl_b32 s7, s60, 6
v_lshrrev_b32 v5, 2, v2
v_and_b32 v6, 3, v2
v_lshrrev_b32 v7, 5, v2
v_lshlrev_b32 v7, 1, v7
v_xor_b32 v6, v6, v7
v_lshl_add_u32 v5, v5, 9, s7
v_lshl_add_u32 v17, v6, 4, v5
v_add_u32 v18, 0x1c00, v17
s_xor_b32 s6, s62, 0
s_lshl_b32 s66, s6, 14
s_xor_b32 s6, s62, 1
s_lshl_b32 s67, s6, 14
s_xor_b32 s6, s62, 2
s_lshl_b32 s68, s6, 14
s_xor_b32 s6, s62, 3
s_lshl_b32 s69, s6, 14
s_xor_b32 s6, s62, 4
s_lshl_b32 s70, s6, 14
s_xor_b32 s6, s62, 5
s_lshl_b32 s71, s6, 14
s_xor_b32 s6, s62, 6
s_lshl_b32 s72, s6, 14
s_xor_b32 s6, s62, 7
s_lshl_b32 s73, s6, 14
s_waitcnt lgkmcnt(0)
s_add_u32 s40, s16, 0x0
s_addc_u32 s41, s17, 0
s_mov_b32 s42, 0x4e2000
s_mov_b32 s43, 0x00020000
s_add_u32 s44, s26, 0x0
s_addc_u32 s45, s27, 0
s_mov_b32 s46, 0x20000
s_mov_b32 s47, 0x00020000
buffer_load_dwordx4 v[40:43], v16, s[40:43], s64 offen offset:0
buffer_load_dwordx4 v[44:47], v16, s[40:43], s64 offen offset:1024
buffer_load_dwordx4 v[48:51], v16, s[40:43], s64 offen offset:2048
s_add_u32 m0, s63, 0x0
s_nop 0
buffer_load_dwordx4 v17, s[44:47], s66 offen offset:0 lds
buffer_load_dwordx4 v18, s[44:47], s66 offen offset:1024 lds
s_add_u32 m0, s63, 0x800
s_nop 0
buffer_load_dwordx4 v17, s[44:47], s67 offen offset:0 lds
buffer_load_dwordx4 v18, s[44:47], s67 offen offset:1024 lds
v_bfe_u32 v5, v2, 2, 3
v_xor_b32 v5, s62, v5
v_and_b32 v6, 3, v2
v_lshlrev_b32 v7, 10, v5
v_lshl_add_u32 v7, v6, 8, v7
v_add_u32 v7, 0xc000, v7
v_and_b32 v5, 1, v5
v_lshl_or_b32 v6, v5, 2, v6
v_lshrrev_b32 v5, 5, v2
s_mul_i32 s6, s60, 6
v_add3_u32 v8, v5, s6, 0
v_lshrrev_b32 v9, 4, v8
v_lshl_add_u32 v9, v9, 13, v7
v_and_b32 v8, 15, v8
v_xor_b32 v8, v8, v6
v_lshl_add_u32 v36, v8, 4, v9
v_add3_u32 v8, v5, s6, 2
v_lshrrev_b32 v9, 4, v8
v_lshl_add_u32 v9, v9, 13, v7
v_and_b32 v8, 15, v8
v_xor_b32 v8, v8, v6
v_lshl_add_u32 v37, v8, 4, v9
v_add3_u32 v8, v5, s6, 4
v_lshrrev_b32 v9, 4, v8
v_lshl_add_u32 v9, v9, 13, v7
v_and_b32 v8, 15, v8
v_xor_b32 v8, v8, v6
v_lshl_add_u32 v38, v8, 4, v9
v_xor_b32 v5, v3, v4
v_lshlrev_b32 v5, 4, v5
v_lshl_add_u32 v5, v4, 8, v5
v_add_u32 v31, 0xc000, v5
v_xor_b32 v32, 64, v31
v_lshrrev_b32 v5, 2, v3
v_and_b32 v6, 3, v3
v_and_b32 v7, 1, v4
v_lshlrev_b32 v7, 1, v7
v_lshl_add_u32 v8, v4, 3, v5
v_lshlrev_b32 v8, 6, v8
v_add_u32 v8, s63, v8
v_and_b32 v9, 1, v6
v_lshl_add_u32 v8, v9, 3, v8
v_lshrrev_b32 v6, 1, v6
v_xor_b32 v6, v6, v7
v_xor_b32 v9, 0, v6
v_lshl_add_u32 v25, v9, 4, v8
v_xor_b32 v9, 2, v6
v_lshl_add_u32 v26, v9, 4, v8
v_lshrrev_b32 v5, 3, v2
v_and_b32 v6, 7, v2
v_lshrrev_b32 v7, 1, v5
v_xor_b32 v6, v6, v7
v_and_b32 v7, 4, v5
v_add_u32 v5, v5, v7
s_mul_i32 s6, s60, 16384
v_lshl_add_u32 v5, v5, 9, s6
v_lshl_add_u32 v21, v6, 4, v5
v_xor_b32 v6, 4, v6
v_lshl_add_u32 v22, v6, 4, v5
v_add_u32 v22, 0x1c00, v22
s_lshr_b32 s7, s62, 1
s_xor_b32 s6, s7, 0
s_lshl_b32 s74, s6, 7
s_add_u32 s75, s74, 2048
s_xor_b32 s6, s7, 1
s_lshl_b32 s76, s6, 7
s_add_u32 s77, s76, 2048
s_xor_b32 s6, s7, 2
s_lshl_b32 s78, s6, 7
s_add_u32 s79, s78, 2048
s_xor_b32 s6, s7, 3
s_lshl_b32 s80, s6, 7
s_add_u32 s81, s80, 2048
s_and_b32 s6, s62, 1
s_lshl_b32 s6, s6, 2
v_lshrrev_b32 v5, 1, v3
v_xor_b32 v5, v5, v4
v_xor_b32 v5, s6, v5
v_lshl_add_u32 v6, v3, 7, s63
v_lshl_add_u32 v29, v5, 4, v6
v_xor_b32 v30, 64, v29
s_mul_i32 s6, s60, 1
s_xor_b32 s6, s6, s62
s_lshl_b32 s6, s6, 10
s_add_u32 s6, s6, 0x12000
v_lshrrev_b32 v5, 1, v4
v_and_b32 v6, 1, v4
v_lshl_add_u32 v5, v5, 8, s6
v_lshl_add_u32 v5, v6, 3, v5
v_lshl_add_u32 v33, v3, 4, v5
v_xor_b32 v34, 0x400, v33
v_add_u32 v35, 0x12000, v16
s_mul_i32 s6, s4, 24576
s_mul_i32 s7, s60, 1024
s_add_u32 s82, s6, s7
s_add_u32 s83, s82, 8192
s_add_u32 s84, s82, 16384
s_mov_b32 s86, 0x3db8aa3b
s_mov_b32 s87, 0x3db8aa3b
s_mov_b32 s88, 0x3727c5ac
s_mov_b32 s89, 0x3b800000
s_mov_b32 s90, 0xffff0000
s_add_u32 s48, s28, 0x0
s_addc_u32 s49, s29, 0
s_mov_b32 s50, 0x20000
s_mov_b32 s51, 0x00020000
s_add_u32 s52, s38, 0x0
s_addc_u32 s53, s39, 0
s_mov_b32 s54, 0x4e4000
s_mov_b32 s55, 0x00020000
s_add_u32 s56, s38, 0x6800000
s_addc_u32 s57, s39, 0
s_mov_b32 s58, 0x4e4000
s_mov_b32 s59, 0x00020000
v_lshlrev_b32 v5, 4, v4
s_lshr_b32 s6, s66, 8
buffer_load_dwordx4 v[172:175], v5, s[48:51], s6 offen
s_lshr_b32 s6, s67, 8
buffer_load_dwordx4 v[176:179], v5, s[48:51], s6 offen
s_lshr_b32 s6, s68, 8
buffer_load_dwordx4 v[180:183], v5, s[48:51], s6 offen
s_lshr_b32 s6, s69, 8
buffer_load_dwordx4 v[184:187], v5, s[48:51], s6 offen
s_lshr_b32 s6, s70, 8
buffer_load_dwordx4 v[188:191], v5, s[48:51], s6 offen
s_lshr_b32 s6, s71, 8
buffer_load_dwordx4 v[192:195], v5, s[48:51], s6 offen
s_lshr_b32 s6, s72, 8
buffer_load_dwordx4 v[196:199], v5, s[48:51], s6 offen
s_lshr_b32 s6, s73, 8
buffer_load_dwordx4 v[200:203], v5, s[48:51], s6 offen
s_waitcnt vmcnt(14)
v_lshlrev_b32 v76, 16, v40
v_and_b32 v77, s90, v40
v_lshlrev_b32 v78, 16, v41
v_and_b32 v79, s90, v41
v_lshlrev_b32 v80, 16, v42
v_and_b32 v81, s90, v42
v_lshlrev_b32 v82, 16, v43
v_and_b32 v83, s90, v43
v_pk_add_f32 v[100:101], v[76:77], v[78:79]
v_pk_mul_f32 v[102:103], v[76:77], v[76:77]
v_pk_add_f32 v[40:41], v[80:81], v[82:83]
v_pk_fma_f32 v[102:103], v[78:79], v[78:79], v[102:103]
v_pk_add_f32 v[100:101], v[100:101], v[40:41]
v_pk_fma_f32 v[102:103], v[80:81], v[80:81], v[102:103]
v_add_f32 v100, v100, v101
v_pk_fma_f32 v[102:103], v[82:83], v[82:83], v[102:103]
v_add_f32 v102, v102, v103
s_waitcnt vmcnt(13)
v_lshlrev_b32 v84, 16, v44
v_and_b32 v85, s90, v44
v_lshlrev_b32 v86, 16, v45
v_and_b32 v87, s90, v45
v_lshlrev_b32 v88, 16, v46
v_and_b32 v89, s90, v46
v_lshlrev_b32 v90, 16, v47
v_and_b32 v91, s90, v47
v_pk_add_f32 v[104:105], v[84:85], v[86:87]
v_pk_mul_f32 v[106:107], v[84:85], v[84:85]
v_pk_add_f32 v[44:45], v[88:89], v[90:91]
v_pk_fma_f32 v[106:107], v[86:87], v[86:87], v[106:107]
v_pk_add_f32 v[104:105], v[104:105], v[44:45]
v_pk_fma_f32 v[106:107], v[88:89], v[88:89], v[106:107]
v_add_f32 v104, v104, v105
v_pk_fma_f32 v[106:107], v[90:91], v[90:91], v[106:107]
v_add_f32 v106, v106, v107
s_waitcnt vmcnt(12)
v_lshlrev_b32 v92, 16, v48
v_and_b32 v93, s90, v48
v_lshlrev_b32 v94, 16, v49
v_and_b32 v95, s90, v49
v_lshlrev_b32 v96, 16, v50
v_and_b32 v97, s90, v50
v_lshlrev_b32 v98, 16, v51
v_and_b32 v99, s90, v51
v_pk_add_f32 v[108:109], v[92:93], v[94:95]
v_pk_mul_f32 v[110:111], v[92:93], v[92:93]
v_pk_add_f32 v[48:49], v[96:97], v[98:99]
v_pk_fma_f32 v[110:111], v[94:95], v[94:95], v[110:111]
v_pk_add_f32 v[108:109], v[108:109], v[48:49]
v_pk_fma_f32 v[110:111], v[96:97], v[96:97], v[110:111]
v_add_f32 v108, v108, v109
v_pk_fma_f32 v[110:111], v[98:99], v[98:99], v[110:111]
v_add_f32 v110, v110, v111
v_permlane16_swap_b32 v100, v102
v_permlane16_swap_b32 v104, v106
v_permlane16_swap_b32 v108, v110
v_add_f32 v100, v100, v102
v_add_f32 v104, v104, v106
v_add_f32 v108, v108, v110
v_add_f32_dpp v101, v100, v100 row_ror:8 row_mask:0xf bank_mask:0x3
v_add_f32_dpp v101, v104, v104 row_ror:8 row_mask:0xf bank_mask:0xc
v_add_f32_dpp v109, v108, v108 row_ror:8 row_mask:0xf bank_mask:0xf
s_nop 0
v_add_f32_dpp v102, v101, v101 row_half_mirror row_mask:0xf bank_mask:0x5
v_add_f32_dpp v102, v109, v109 row_half_mirror row_mask:0xf bank_mask:0xa
s_nop 1
v_add_f32_dpp v102, v102, v102 quad_perm:[1,0,3,2] row_mask:0xf bank_mask:0xf
s_nop 1
v_add_f32_dpp v102, v102, v102 quad_perm:[2,3,0,1] row_mask:0xf bank_mask:0xf
v_mov_b32 v103, v102
s_nop 1
v_permlane16_swap_b32 v103, v102
v_mul_f32 v103, s89, v103
v_mul_f32 v102, s89, v102
v_fma_f32 v102, -v103, v103, v102
v_max_f32 v102, 0, v102
v_cvt_pk_bf16_f32 v102, v102, v102
v_and_b32 v102, s90, v102
v_add_f32 v102, s88, v102
v_cvt_pk_bf16_f32 v102, v102, v102
v_and_b32 v102, s90, v102
v_sqrt_f32 v102, v102
s_nop 0
v_cvt_pk_bf16_f32 v102, v102, v102
v_and_b32 v102, s90, v102
v_rcp_f32 v102, v102
s_nop 0
v_mul_f32 v103, -v103, v102
s_nop 1
v_mov_b64_dpp v[100:101], v[102:103] row_newbcast:0 row_mask:0xf bank_mask:0xf
v_mov_b64_dpp v[104:105], v[102:103] row_newbcast:8 row_mask:0xf bank_mask:0xf
v_mov_b64_dpp v[108:109], v[102:103] row_newbcast:4 row_mask:0xf bank_mask:0xf
v_fma_f32 v76, v76, v100, v101
v_fma_f32 v77, v77, v100, v101
v_fma_f32 v78, v78, v100, v101
v_fma_f32 v79, v79, v100, v101
v_fma_f32 v80, v80, v100, v101
v_fma_f32 v81, v81, v100, v101
v_fma_f32 v82, v82, v100, v101
v_fma_f32 v83, v83, v100, v101
v_cvt_pk_bf16_f32 v40, v76, v77
v_cvt_pk_bf16_f32 v41, v78, v79
v_cvt_pk_bf16_f32 v42, v80, v81
v_cvt_pk_bf16_f32 v43, v82, v83
ds_write_b128 v36, v[40:43]
v_fma_f32 v84, v84, v104, v105
v_fma_f32 v85, v85, v104, v105
v_fma_f32 v86, v86, v104, v105
v_fma_f32 v87, v87, v104, v105
v_fma_f32 v88, v88, v104, v105
v_fma_f32 v89, v89, v104, v105
v_fma_f32 v90, v90, v104, v105
v_fma_f32 v91, v91, v104, v105
v_cvt_pk_bf16_f32 v44, v84, v85
v_cvt_pk_bf16_f32 v45, v86, v87
v_cvt_pk_bf16_f32 v46, v88, v89
v_cvt_pk_bf16_f32 v47, v90, v91
ds_write_b128 v37, v[44:47]
v_fma_f32 v92, v92, v108, v109
v_fma_f32 v93, v93, v108, v109
v_fma_f32 v94, v94, v108, v109
v_fma_f32 v95, v95, v108, v109
v_fma_f32 v96, v96, v108, v109
v_fma_f32 v97, v97, v108, v109
v_fma_f32 v98, v98, v108, v109
v_fma_f32 v99, v99, v108, v109
v_cvt_pk_bf16_f32 v48, v92, v93
v_cvt_pk_bf16_f32 v49, v94, v95
v_cvt_pk_bf16_f32 v50, v96, v97
v_cvt_pk_bf16_f32 v51, v98, v99
ds_write_b128 v38, v[48:51]
s_add_u32 m0, s63, 0x1000
s_nop 0
buffer_load_dwordx4 v17, s[44:47], s68 offen offset:0 lds
buffer_load_dwordx4 v18, s[44:47], s68 offen offset:1024 lds
s_waitcnt vmcnt(12)
ds_read_b64_tr_b16 v[100:101], v25 offset:0
ds_read_b64_tr_b16 v[102:103], v25 offset:256
ds_read_b64_tr_b16 v[104:105], v26 offset:0
ds_read_b64_tr_b16 v[106:107], v26 offset:256
s_waitcnt lgkmcnt(4)
s_barrier
ds_read_b128 v[124:127], v31 offset:0
ds_read_b128 v[128:131], v31 offset:8192
ds_read_b128 v[132:135], v31 offset:16384
ds_read_b128 v[136:139], v32 offset:1024
s_waitcnt vmcnt(10)
ds_read_b64_tr_b16 v[108:109], v25 offset:2048
ds_read_b64_tr_b16 v[110:111], v25 offset:2304
s_waitcnt lgkmcnt(5)
v_mfma_f32_16x16x32_bf16 v[52:55], v[100:103], v[124:127], 0
ds_read_b128 v[140:143], v32 offset:9216
s_waitcnt lgkmcnt(5)
v_mfma_f32_16x16x32_bf16 v[56:59], v[100:103], v[128:131], 0
ds_read_b128 v[144:147], v32 offset:17408
s_waitcnt lgkmcnt(5)
v_mfma_f32_16x16x32_bf16 v[60:63], v[100:103], v[132:135], 0
ds_read_b64_tr_b16 v[112:113], v26 offset:2048
ds_read_b64_tr_b16 v[114:115], v26 offset:2304
v_mfma_f32_16x16x32_bf16 v[64:67], v[104:107], v[124:127], 0
s_add_u32 m0, s63, 0x0
s_nop 0
buffer_load_dwordx4 v17, s[44:47], s69 offen offset:0 lds
buffer_load_dwordx4 v18, s[44:47], s69 offen offset:1024 lds
v_mfma_f32_16x16x32_bf16 v[68:71], v[104:107], v[128:131], 0
v_and_b32 v5, 31, v2
v_lshrrev_b32 v6, 5, v2
v_mfma_f32_16x16x32_bf16 v[72:75], v[104:107], v[132:135], 0
ds_read_b128 v[148:151], v31 offset:2048
s_waitcnt vmcnt(2)
ds_read_b64_tr_b16 v[116:117], v25 offset:4096
ds_read_b64_tr_b16 v[118:119], v25 offset:4352
s_waitcnt lgkmcnt(7)
v_mfma_f32_16x16x32_bf16 v[52:55], v[108:111], v[136:139], v[52:55]
ds_read_b128 v[152:155], v31 offset:10240
s_lshr_b32 s6, s64, 9
s_waitcnt lgkmcnt(7)
v_mfma_f32_16x16x32_bf16 v[56:59], v[108:111], v[140:143], v[56:59]
ds_read_b128 v[156:159], v31 offset:18432
v_cmp_eq_u32 vcc, 0, v5
s_waitcnt lgkmcnt(7)
v_mfma_f32_16x16x32_bf16 v[60:63], v[108:111], v[144:147], v[60:63]
ds_read_b64_tr_b16 v[120:121], v26 offset:4096
ds_read_b64_tr_b16 v[122:123], v26 offset:4352
s_waitcnt lgkmcnt(7)
v_mfma_f32_16x16x32_bf16 v[64:67], v[112:115], v[136:139], v[64:67]
s_add_u32 m0, s63, 0x800
s_nop 0
buffer_load_dwordx4 v17, s[44:47], s70 offen offset:0 lds
buffer_load_dwordx4 v18, s[44:47], s70 offen offset:1024 lds
v_mfma_f32_16x16x32_bf16 v[68:71], v[112:115], v[140:143], v[68:71]
s_sub_u32 s6, 10000, s6
v_mov_b32 v7, 0x7fffffff
v_mfma_f32_16x16x32_bf16 v[72:75], v[112:115], v[144:147], v[72:75]
ds_read_b128 v[160:163], v32 offset:3072
s_waitcnt vmcnt(2)
ds_read_b64_tr_b16 v[100:101], v25 offset:0
ds_read_b64_tr_b16 v[102:103], v25 offset:256
s_waitcnt lgkmcnt(7)
v_mfma_f32_16x16x32_bf16 v[52:55], v[116:119], v[148:151], v[52:55]
ds_read_b128 v[164:167], v32 offset:11264
v_cndmask_b32 v6, v7, v6, vcc
s_waitcnt lgkmcnt(7)
v_mfma_f32_16x16x32_bf16 v[56:59], v[116:119], v[152:155], v[56:59]
ds_read_b128 v[168:171], v32 offset:19456
v_cmp_gt_i32 vcc, s6, v6
s_waitcnt lgkmcnt(7)
v_mfma_f32_16x16x32_bf16 v[60:63], v[116:119], v[156:159], v[60:63]
ds_read_b64_tr_b16 v[104:105], v26 offset:0
ds_read_b64_tr_b16 v[106:107], v26 offset:256
s_waitcnt lgkmcnt(7)
v_mfma_f32_16x16x32_bf16 v[64:67], v[120:123], v[148:151], v[64:67]
s_add_u32 m0, s63, 0x1000
s_nop 0
buffer_load_dwordx4 v17, s[44:47], s71 offen offset:0 lds
buffer_load_dwordx4 v18, s[44:47], s71 offen offset:1024 lds
v_mfma_f32_16x16x32_bf16 v[68:71], v[120:123], v[152:155], v[68:71]
v_and_b32 v5, s90, v40
v_or_b32 v5, 0x3f80, v5
v_mfma_f32_16x16x32_bf16 v[72:75], v[120:123], v[156:159], v[72:75]
ds_read_b128 v[124:127], v31 offset:4096
s_waitcnt vmcnt(2)
ds_read_b64_tr_b16 v[108:109], v25 offset:2048
ds_read_b64_tr_b16 v[110:111], v25 offset:2304
s_waitcnt lgkmcnt(7)
v_mfma_f32_16x16x32_bf16 v[52:55], v[100:103], v[160:163], v[52:55]
ds_read_b128 v[128:131], v31 offset:12288
s_sub_u32 s6, s6, 2
s_waitcnt lgkmcnt(7)
v_mfma_f32_16x16x32_bf16 v[56:59], v[100:103], v[164:167], v[56:59]
ds_read_b128 v[132:135], v31 offset:20480
v_cndmask_b32 v40, v40, v5, vcc
s_waitcnt lgkmcnt(7)
v_mfma_f32_16x16x32_bf16 v[60:63], v[100:103], v[168:171], v[60:63]
ds_read_b64_tr_b16 v[112:113], v26 offset:2048
ds_read_b64_tr_b16 v[114:115], v26 offset:2304
s_waitcnt lgkmcnt(7)
v_mfma_f32_16x16x32_bf16 v[64:67], v[104:107], v[160:163], v[64:67]
s_add_u32 m0, s63, 0x0
s_nop 0
buffer_load_dwordx4 v17, s[44:47], s72 offen offset:0 lds
buffer_load_dwordx4 v18, s[44:47], s72 offen offset:1024 lds
v_mfma_f32_16x16x32_bf16 v[68:71], v[104:107], v[164:167], v[68:71]
v_cmp_gt_i32 vcc, s6, v6
v_and_b32 v5, s90, v44
v_mfma_f32_16x16x32_bf16 v[72:75], v[104:107], v[168:171], v[72:75]
ds_read_b128 v[136:139], v32 offset:5120
s_waitcnt vmcnt(2)
ds_read_b64_tr_b16 v[116:117], v25 offset:4096
ds_read_b64_tr_b16 v[118:119], v25 offset:4352
s_waitcnt lgkmcnt(7)
v_mfma_f32_16x16x32_bf16 v[52:55], v[108:111], v[124:127], v[52:55]
ds_read_b128 v[140:143], v32 offset:13312
v_or_b32 v5, 0x3f80, v5
s_waitcnt lgkmcnt(7)
v_mfma_f32_16x16x32_bf16 v[56:59], v[108:111], v[128:131], v[56:59]
ds_read_b128 v[144:147], v32 offset:21504
s_sub_u32 s6, s6, 2
s_waitcnt lgkmcnt(7)
v_mfma_f32_16x16x32_bf16 v[60:63], v[108:111], v[132:135], v[60:63]
ds_read_b64_tr_b16 v[120:121], v26 offset:4096
ds_read_b64_tr_b16 v[122:123], v26 offset:4352
s_waitcnt lgkmcnt(7)
v_mfma_f32_16x16x32_bf16 v[64:67], v[112:115], v[124:127], v[64:67]
s_add_u32 m0, s63, 0x800
s_nop 0
buffer_load_dwordx4 v17, s[44:47], s73 offen offset:0 lds
buffer_load_dwordx4 v18, s[44:47], s73 offen offset:1024 lds
v_mfma_f32_16x16x32_bf16 v[68:71], v[112:115], v[128:131], v[68:71]
v_cndmask_b32 v44, v44, v5, vcc
v_cmp_gt_i32 vcc, s6, v6
v_mfma_f32_16x16x32_bf16 v[72:75], v[112:115], v[132:135], v[72:75]
ds_read_b128 v[148:151], v31 offset:6144
s_waitcnt vmcnt(2)
ds_read_b64_tr_b16 v[100:101], v25 offset:0
ds_read_b64_tr_b16 v[102:103], v25 offset:256
s_waitcnt lgkmcnt(7)
v_mfma_f32_16x16x32_bf16 v[52:55], v[116:119], v[136:139], v[52:55]
ds_read_b128 v[152:155], v31 offset:14336
v_and_b32 v5, s90, v48
s_waitcnt lgkmcnt(7)
v_mfma_f32_16x16x32_bf16 v[56:59], v[116:119], v[140:143], v[56:59]
ds_read_b128 v[156:159], v31 offset:22528
v_or_b32 v5, 0x3f80, v5
s_waitcnt lgkmcnt(7)
v_mfma_f32_16x16x32_bf16 v[60:63], v[116:119], v[144:147], v[60:63]
ds_read_b64_tr_b16 v[104:105], v26 offset:0
ds_read_b64_tr_b16 v[106:107], v26 offset:256
s_waitcnt lgkmcnt(7)
v_mfma_f32_16x16x32_bf16 v[64:67], v[120:123], v[136:139], v[64:67]
s_add_u32 m0, s63, 0x1000
s_nop 0
buffer_load_dwordx4 v21, s[48:51], s74 offen offset:0 lds
buffer_load_dwordx4 v22, s[48:51], s74 offen offset:1024 lds
v_mfma_f32_16x16x32_bf16 v[68:71], v[120:123], v[140:143], v[68:71]
s_sub_u32 s6, s6, 2
v_cndmask_b32 v48, v48, v5, vcc
v_mfma_f32_16x16x32_bf16 v[72:75], v[120:123], v[144:147], v[72:75]
ds_read_b128 v[160:163], v32 offset:7168
s_waitcnt vmcnt(2)
ds_read_b64_tr_b16 v[108:109], v25 offset:2048
ds_read_b64_tr_b16 v[110:111], v25 offset:2304
s_waitcnt lgkmcnt(7)
v_mfma_f32_16x16x32_bf16 v[52:55], v[100:103], v[148:151], v[52:55]
ds_read_b128 v[164:167], v32 offset:15360
s_waitcnt lgkmcnt(7)
v_mfma_f32_16x16x32_bf16 v[56:59], v[100:103], v[152:155], v[56:59]
ds_read_b128 v[168:171], v32 offset:23552
s_waitcnt lgkmcnt(7)
v_mfma_f32_16x16x32_bf16 v[60:63], v[100:103], v[156:159], v[60:63]
ds_read_b64_tr_b16 v[112:113], v26 offset:2048
ds_read_b64_tr_b16 v[114:115], v26 offset:2304
s_waitcnt lgkmcnt(7)
v_mfma_f32_16x16x32_bf16 v[64:67], v[104:107], v[148:151], v[64:67]
s_add_u32 m0, s63, 0x0
s_nop 0
buffer_load_dwordx4 v21, s[48:51], s75 offen offset:0 lds
buffer_load_dwordx4 v22, s[48:51], s75 offen offset:1024 lds
v_mfma_f32_16x16x32_bf16 v[68:71], v[104:107], v[152:155], v[68:71]
v_mfma_f32_16x16x32_bf16 v[72:75], v[104:107], v[156:159], v[72:75]
s_waitcnt lgkmcnt(4)
v_mfma_f32_16x16x32_bf16 v[52:55], v[108:111], v[160:163], v[52:55]
s_waitcnt lgkmcnt(3)
v_mfma_f32_16x16x32_bf16 v[56:59], v[108:111], v[164:167], v[56:59]
s_waitcnt lgkmcnt(2)
v_mfma_f32_16x16x32_bf16 v[60:63], v[108:111], v[168:171], v[60:63]
s_waitcnt lgkmcnt(0)
v_mfma_f32_16x16x32_bf16 v[64:67], v[112:115], v[160:163], v[64:67]
s_nop 1
v_cvt_pk_bf16_f32 v52, v52, v53
v_cvt_pk_bf16_f32 v53, v54, v55
ds_write_b64 v33, v[52:53] offset:0
s_add_u32 m0, s63, 0x800
s_nop 0
buffer_load_dwordx4 v21, s[48:51], s76 offen offset:0 lds
buffer_load_dwordx4 v22, s[48:51], s76 offen offset:1024 lds
v_mfma_f32_16x16x32_bf16 v[68:71], v[112:115], v[164:167], v[68:71]
v_cvt_pk_bf16_f32 v56, v56, v57
v_cvt_pk_bf16_f32 v57, v58, v59
ds_write_b64 v33, v[56:57] offset:8192
v_mfma_f32_16x16x32_bf16 v[72:75], v[112:115], v[168:171], v[72:75]
v_cvt_pk_bf16_f32 v60, v60, v61
v_cvt_pk_bf16_f32 v61, v62, v63
ds_write_b64 v33, v[60:61] offset:16384
v_cvt_pk_bf16_f32 v64, v64, v65
v_cvt_pk_bf16_f32 v65, v66, v67
ds_write_b64 v33, v[64:65] offset:512
v_cvt_pk_bf16_f32 v68, v68, v69
v_cvt_pk_bf16_f32 v69, v70, v71
ds_write_b64 v33, v[68:69] offset:8704
v_cvt_pk_bf16_f32 v72, v72, v73
v_cvt_pk_bf16_f32 v73, v74, v75
ds_write_b64 v33, v[72:73] offset:16896
s_waitcnt vmcnt(4)
ds_read_b128 v[116:119], v29 offset:4096
ds_read_b128 v[120:123], v30 offset:4096
s_waitcnt lgkmcnt(2)
s_barrier
ds_read_b128 v[124:127], v35 offset:0
ds_read_b128 v[128:131], v35 offset:8192
ds_read_b128 v[132:135], v35 offset:16384
ds_read_b128 v[136:139], v35 offset:1024
s_waitcnt lgkmcnt(3)
v_mfma_f32_16x16x32_bf16 v[76:79], v[116:119], v[124:127], 0
ds_read_b128 v[140:143], v35 offset:9216
s_waitcnt lgkmcnt(3)
v_mfma_f32_16x16x32_bf16 v[84:87], v[116:119], v[128:131], 0
ds_read_b128 v[144:147], v35 offset:17408
s_waitcnt lgkmcnt(3)
v_mfma_f32_16x16x32_bf16 v[92:95], v[116:119], v[132:135], 0
v_mfma_f32_16x16x32_bf16 v[204:207], v[172:175], v[124:127], 0
v_mfma_f32_16x16x32_bf16 v[208:211], v[172:175], v[128:131], 0
v_mfma_f32_16x16x32_bf16 v[212:215], v[172:175], v[132:135], 0
s_waitcnt vmcnt(2)
ds_read_b128 v[100:103], v29 offset:0
s_waitcnt lgkmcnt(3)
v_mfma_f32_16x16x32_bf16 v[76:79], v[120:123], v[136:139], v[76:79]
s_add_u32 m0, s63, 0x1000
s_nop 0
buffer_load_dwordx4 v21, s[48:51], s77 offen offset:0 lds
buffer_load_dwordx4 v22, s[48:51], s77 offen offset:1024 lds
s_waitcnt lgkmcnt(2)
v_mfma_f32_16x16x32_bf16 v[84:87], v[120:123], v[140:143], v[84:87]
s_waitcnt lgkmcnt(1)
v_mfma_f32_16x16x32_bf16 v[92:95], v[120:123], v[144:147], v[92:95]
ds_read_b128 v[104:107], v30 offset:0
v_mfma_f32_16x16x32_bf16 v[204:207], v[176:179], v[136:139], v[204:207]
v_mfma_f32_16x16x32_bf16 v[208:211], v[176:179], v[140:143], v[208:211]
v_mfma_f32_16x16x32_bf16 v[212:215], v[176:179], v[144:147], v[212:215]
ds_read_b128 v[148:151], v35 offset:2048
s_waitcnt vmcnt(2)
ds_read_b128 v[108:111], v29 offset:2048
s_waitcnt lgkmcnt(3)
v_mfma_f32_16x16x32_bf16 v[80:83], v[100:103], v[124:127], 0
ds_read_b128 v[152:155], v35 offset:10240
v_mfma_f32_16x16x32_bf16 v[88:91], v[100:103], v[128:131], 0
ds_read_b128 v[156:159], v35 offset:18432
v_mfma_f32_16x16x32_bf16 v[96:99], v[100:103], v[132:135], 0
s_waitcnt lgkmcnt(4)
v_mfma_f32_16x16x32_bf16 v[80:83], v[104:107], v[136:139], v[80:83]
s_add_u32 m0, s63, 0x0
s_nop 0
buffer_load_dwordx4 v21, s[48:51], s78 offen offset:0 lds
buffer_load_dwordx4 v22, s[48:51], s78 offen offset:1024 lds
v_mfma_f32_16x16x32_bf16 v[88:91], v[104:107], v[140:143], v[88:91]
v_mfma_f32_16x16x32_bf16 v[96:99], v[104:107], v[144:147], v[96:99]
ds_read_b128 v[160:163], v35 offset:3072
ds_read_b128 v[112:115], v30 offset:2048
s_waitcnt lgkmcnt(4)
v_mfma_f32_16x16x32_bf16 v[76:79], v[108:111], v[148:151], v[76:79]
ds_read_b128 v[164:167], v35 offset:11264
s_waitcnt lgkmcnt(4)
v_mfma_f32_16x16x32_bf16 v[84:87], v[108:111], v[152:155], v[84:87]
ds_read_b128 v[168:171], v35 offset:19456
s_waitcnt lgkmcnt(4)
v_mfma_f32_16x16x32_bf16 v[92:95], v[108:111], v[156:159], v[92:95]
v_mfma_f32_16x16x32_bf16 v[204:207], v[180:183], v[148:151], v[204:207]
v_mfma_f32_16x16x32_bf16 v[208:211], v[180:183], v[152:155], v[208:211]
v_mfma_f32_16x16x32_bf16 v[212:215], v[180:183], v[156:159], v[212:215]
s_waitcnt vmcnt(2)
ds_read_b128 v[116:119], v29 offset:4096
s_waitcnt lgkmcnt(3)
v_mfma_f32_16x16x32_bf16 v[76:79], v[112:115], v[160:163], v[76:79]
s_add_u32 m0, s63, 0x800
s_nop 0
buffer_load_dwordx4 v21, s[48:51], s79 offen offset:0 lds
buffer_load_dwordx4 v22, s[48:51], s79 offen offset:1024 lds
s_waitcnt lgkmcnt(2)
v_mfma_f32_16x16x32_bf16 v[84:87], v[112:115], v[164:167], v[84:87]
s_waitcnt lgkmcnt(1)
v_mfma_f32_16x16x32_bf16 v[92:95], v[112:115], v[168:171], v[92:95]
ds_read_b128 v[120:123], v30 offset:4096
v_mfma_f32_16x16x32_bf16 v[204:207], v[184:187], v[160:163], v[204:207]
v_mfma_f32_16x16x32_bf16 v[208:211], v[184:187], v[164:167], v[208:211]
v_mfma_f32_16x16x32_bf16 v[212:215], v[184:187], v[168:171], v[212:215]
ds_read_b128 v[124:127], v35 offset:4096
s_waitcnt vmcnt(2)
ds_read_b128 v[100:103], v29 offset:0
s_waitcnt lgkmcnt(3)
v_mfma_f32_16x16x32_bf16 v[80:83], v[116:119], v[148:151], v[80:83]
ds_read_b128 v[128:131], v35 offset:12288
v_mfma_f32_16x16x32_bf16 v[88:91], v[116:119], v[152:155], v[88:91]
ds_read_b128 v[132:135], v35 offset:20480
v_mfma_f32_16x16x32_bf16 v[96:99], v[116:119], v[156:159], v[96:99]
s_waitcnt lgkmcnt(4)
v_mfma_f32_16x16x32_bf16 v[80:83], v[120:123], v[160:163], v[80:83]
s_add_u32 m0, s63, 0x1000
s_nop 0
buffer_load_dwordx4 v21, s[48:51], s80 offen offset:0 lds
buffer_load_dwordx4 v22, s[48:51], s80 offen offset:1024 lds
v_mfma_f32_16x16x32_bf16 v[88:91], v[120:123], v[164:167], v[88:91]
v_mfma_f32_16x16x32_bf16 v[96:99], v[120:123], v[168:171], v[96:99]
ds_read_b128 v[136:139], v35 offset:5120
ds_read_b128 v[104:107], v30 offset:0
s_waitcnt lgkmcnt(4)
v_mfma_f32_16x16x32_bf16 v[76:79], v[100:103], v[124:127], v[76:79]
ds_read_b128 v[140:143], v35 offset:13312
s_waitcnt lgkmcnt(4)
v_mfma_f32_16x16x32_bf16 v[84:87], v[100:103], v[128:131], v[84:87]
ds_read_b128 v[144:147], v35 offset:21504
s_waitcnt lgkmcnt(4)
v_mfma_f32_16x16x32_bf16 v[92:95], v[100:103], v[132:135], v[92:95]
v_mfma_f32_16x16x32_bf16 v[204:207], v[188:191], v[124:127], v[204:207]
v_mfma_f32_16x16x32_bf16 v[208:211], v[188:191], v[128:131], v[208:211]
v_mfma_f32_16x16x32_bf16 v[212:215], v[188:191], v[132:135], v[212:215]
s_waitcnt vmcnt(2)
ds_read_b128 v[108:111], v29 offset:2048
s_waitcnt lgkmcnt(3)
v_mfma_f32_16x16x32_bf16 v[76:79], v[104:107], v[136:139], v[76:79]
s_add_u32 m0, s63, 0x0
s_nop 0
buffer_load_dwordx4 v21, s[48:51], s81 offen offset:0 lds
buffer_load_dwordx4 v22, s[48:51], s81 offen offset:1024 lds
s_waitcnt lgkmcnt(2)
v_mfma_f32_16x16x32_bf16 v[84:87], v[104:107], v[140:143], v[84:87]
buffer_store_dwordx4 v[40:43], v16, s[56:59], s64 offen offset:0 sc1
buffer_store_dwordx4 v[44:47], v16, s[56:59], s64 offen offset:1024 sc1
s_waitcnt lgkmcnt(1)
v_mfma_f32_16x16x32_bf16 v[92:95], v[104:107], v[144:147], v[92:95]
ds_read_b128 v[112:115], v30 offset:2048
buffer_store_dwordx4 v[48:51], v16, s[56:59], s64 offen offset:2048 sc1
v_mfma_f32_16x16x32_bf16 v[204:207], v[192:195], v[136:139], v[204:207]
v_mfma_f32_16x16x32_bf16 v[208:211], v[192:195], v[140:143], v[208:211]
v_mfma_f32_16x16x32_bf16 v[212:215], v[192:195], v[144:147], v[212:215]
ds_read_b128 v[148:151], v35 offset:6144
s_waitcnt vmcnt(5)
ds_read_b128 v[116:119], v29 offset:4096
s_waitcnt lgkmcnt(3)
v_mfma_f32_16x16x32_bf16 v[80:83], v[108:111], v[124:127], v[80:83]
ds_read_b128 v[152:155], v35 offset:14336
v_mfma_f32_16x16x32_bf16 v[88:91], v[108:111], v[128:131], v[88:91]
ds_read_b128 v[156:159], v35 offset:22528
v_mfma_f32_16x16x32_bf16 v[96:99], v[108:111], v[132:135], v[96:99]
s_waitcnt lgkmcnt(4)
v_mfma_f32_16x16x32_bf16 v[80:83], v[112:115], v[136:139], v[80:83]
v_mfma_f32_16x16x32_bf16 v[88:91], v[112:115], v[140:143], v[88:91]
v_mfma_f32_16x16x32_bf16 v[96:99], v[112:115], v[144:147], v[96:99]
ds_read_b128 v[160:163], v35 offset:7168
ds_read_b128 v[120:123], v30 offset:4096
s_waitcnt lgkmcnt(4)
v_mfma_f32_16x16x32_bf16 v[76:79], v[116:119], v[148:151], v[76:79]
ds_read_b128 v[164:167], v35 offset:15360
s_waitcnt lgkmcnt(4)
v_mfma_f32_16x16x32_bf16 v[84:87], v[116:119], v[152:155], v[84:87]
ds_read_b128 v[168:171], v35 offset:23552
s_waitcnt lgkmcnt(4)
v_mfma_f32_16x16x32_bf16 v[92:95], v[116:119], v[156:159], v[92:95]
v_mfma_f32_16x16x32_bf16 v[204:207], v[196:199], v[148:151], v[204:207]
v_mfma_f32_16x16x32_bf16 v[208:211], v[196:199], v[152:155], v[208:211]
v_mfma_f32_16x16x32_bf16 v[212:215], v[196:199], v[156:159], v[212:215]
s_waitcnt vmcnt(3)
ds_read_b128 v[100:103], v29 offset:0
s_waitcnt lgkmcnt(3)
v_mfma_f32_16x16x32_bf16 v[76:79], v[120:123], v[160:163], v[76:79]
s_waitcnt lgkmcnt(2)
v_mfma_f32_16x16x32_bf16 v[84:87], v[120:123], v[164:167], v[84:87]
s_waitcnt lgkmcnt(1)
v_mfma_f32_16x16x32_bf16 v[92:95], v[120:123], v[168:171], v[92:95]
ds_read_b128 v[104:107], v30 offset:0
v_mfma_f32_16x16x32_bf16 v[204:207], v[200:203], v[160:163], v[204:207]
v_mfma_f32_16x16x32_bf16 v[208:211], v[200:203], v[164:167], v[208:211]
v_mfma_f32_16x16x32_bf16 v[212:215], v[200:203], v[168:171], v[212:215]
s_waitcnt lgkmcnt(1)
v_mfma_f32_16x16x32_bf16 v[80:83], v[100:103], v[148:151], v[80:83]
s_nop 3
v_mul_f32 v204, -v204, s86
v_mfma_f32_16x16x32_bf16 v[88:91], v[100:103], v[152:155], v[88:91]
v_mul_f32 v208, -v208, s86
v_mfma_f32_16x16x32_bf16 v[96:99], v[100:103], v[156:159], v[96:99]
v_mul_f32 v212, -v212, s86
s_waitcnt lgkmcnt(0)
v_mfma_f32_16x16x32_bf16 v[80:83], v[104:107], v[160:163], v[80:83]
v_mfma_f32_16x16x32_bf16 v[88:91], v[104:107], v[164:167], v[88:91]
v_mfma_f32_16x16x32_bf16 v[96:99], v[104:107], v[168:171], v[96:99]
v_fma_f32 v76, v76, s86, v204
v_fma_f32 v77, v77, s86, v204
v_fma_f32 v78, v78, s86, v204
v_fma_f32 v79, v79, s86, v204
s_nop 1
v_fma_f32 v80, v80, s86, v204
v_fma_f32 v81, v81, s86, v204
v_fma_f32 v82, v82, s86, v204
v_fma_f32 v83, v83, s86, v204
v_cvt_pk_bf16_f32 v76, v76, v77
v_cvt_pk_bf16_f32 v77, v78, v79
v_cvt_pk_bf16_f32 v78, v80, v81
v_cvt_pk_bf16_f32 v79, v82, v83
buffer_store_dwordx4 v[76:79], v16, s[52:55], s82 offen offset:0 sc1
v_fma_f32 v84, v84, s86, v208
v_fma_f32 v85, v85, s86, v208
v_fma_f32 v86, v86, s86, v208
v_fma_f32 v87, v87, s86, v208
v_fma_f32 v88, v88, s86, v208
v_fma_f32 v89, v89, s86, v208
v_fma_f32 v90, v90, s86, v208
v_fma_f32 v91, v91, s86, v208
v_cvt_pk_bf16_f32 v84, v84, v85
v_cvt_pk_bf16_f32 v85, v86, v87
v_cvt_pk_bf16_f32 v86, v88, v89
v_cvt_pk_bf16_f32 v87, v90, v91
buffer_store_dwordx4 v[84:87], v16, s[52:55], s83 offen offset:0 sc1
v_fma_f32 v92, v92, s86, v212
v_fma_f32 v93, v93, s86, v212
v_fma_f32 v94, v94, s86, v212
v_fma_f32 v95, v95, s86, v212
v_fma_f32 v96, v96, s86, v212
v_fma_f32 v97, v97, s86, v212
v_fma_f32 v98, v98, s86, v212
v_fma_f32 v99, v99, s86, v212
v_cvt_pk_bf16_f32 v92, v92, v93
v_cvt_pk_bf16_f32 v93, v94, v95
v_cvt_pk_bf16_f32 v94, v96, v97
v_cvt_pk_bf16_f32 v95, v98, v99
buffer_store_dwordx4 v[92:95], v16, s[52:55], s84 offen offset:0 sc1
s_branch L1_fin
L1_notq:
s_sub_u32 s4, s2, 32
s_cmp_lt_u32 s2, 32
s_cbranch_scc1 L1_edge
s_mov_b32 s61, 1
v_lshlrev_b32 v16, 4, v2
s_mul_i32 s63, s60, 6144
s_and_b32 s6, s4, 3
s_lshl_b32 s6, s6, 6
s_mul_i32 s7, s60, 8
s_add_u32 s6, s6, s7
v_lshrrev_b32 v5, 5, v2
v_and_b32 v6, 31, v2
v_lshlrev_b32 v6, 4, v6
v_mov_b32 v176, v6
s_cmp_ge_u32 s4, 4
s_cselect_b64 vcc, -1, 0
v_add3_u32 v7, v5, s6, 0
v_and_b32 v8, 0x80, v7
v_bfe_u32 v9, v7, 2, 1
v_lshl_or_b32 v8, v9, 6, v8
v_bfe_u32 v9, v7, 4, 1
v_lshl_or_b32 v8, v9, 5, v8
v_and_b32 v9, 3, v7
v_lshl_or_b32 v8, v9, 3, v8
v_bfe_u32 v9, v7, 5, 2
v_lshl_or_b32 v8, v9, 1, v8
v_bfe_u32 v9, v7, 3, 1
v_or_b32 v8, v9, v8
v_cndmask_b32 v8, v8, v7, vcc
v_lshl_add_u32 v40, v8, 9, v6
v_add3_u32 v7, v5, s6, 2
v_and_b32 v8, 0x80, v7
v_bfe_u32 v9, v7, 2, 1
v_lshl_or_b32 v8, v9, 6, v8
v_bfe_u32 v9, v7, 4, 1
v_lshl_or_b32 v8, v9, 5, v8
v_and_b32 v9, 3, v7
v_lshl_or_b32 v8, v9, 3, v8
v_bfe_u32 v9, v7, 5, 2
v_lshl_or_b32 v8, v9, 1, v8
v_bfe_u32 v9, v7, 3, 1
v_or_b32 v8, v9, v8
v_cndmask_b32 v8, v8, v7, vcc
v_lshl_add_u32 v44, v8, 9, v6
v_add3_u32 v7, v5, s6, 4
v_and_b32 v8, 0x80, v7
v_bfe_u32 v9, v7, 2, 1
v_lshl_or_b32 v8, v9, 6, v8
v_bfe_u32 v9, v7, 4, 1
v_lshl_or_b32 v8, v9, 5, v8
v_and_b32 v9, 3, v7
v_lshl_or_b32 v8, v9, 3, v8
v_bfe_u32 v9, v7, 5, 2
v_lshl_or_b32 v8, v9, 1, v8
v_bfe_u32 v9, v7, 3, 1
v_or_b32 v8, v9, v8
v_cndmask_b32 v8, v8, v7, vcc
v_lshl_add_u32 v48, v8, 9, v6
v_add3_u32 v7, v5, s6, 6
v_and_b32 v8, 0x80, v7
v_bfe_u32 v9, v7, 2, 1
v_lshl_or_b32 v8, v9, 6, v8
v_bfe_u32 v9, v7, 4, 1
v_lshl_or_b32 v8, v9, 5, v8
v_and_b32 v9, 3, v7
v_lshl_or_b32 v8, v9, 3, v8
v_bfe_u32 v9, v7, 5, 2
v_lshl_or_b32 v8, v9, 1, v8
v_bfe_u32 v9, v7, 3, 1
v_or_b32 v8, v9, v8
v_cndmask_b32 v8, v8, v7, vcc
v_lshl_add_u32 v52, v8, 9, v6
s_lshl_b32 s7, s60, 6
v_lshrrev_b32 v5, 2, v2
v_and_b32 v6, 3, v2
v_lshrrev_b32 v7, 5, v2
v_lshlrev_b32 v7, 1, v7
v_xor_b32 v6, v6, v7
v_lshl_add_u32 v5, v5, 9, s7
v_lshl_add_u32 v17, v6, 4, v5
v_add_u32 v18, 0x1c00, v17
s_xor_b32 s6, s62, 0
s_lshl_b32 s66, s6, 14
s_xor_b32 s6, s62, 1
s_lshl_b32 s67, s6, 14
s_xor_b32 s6, s62, 2
s_lshl_b32 s68, s6, 14
s_xor_b32 s6, s62, 3
s_lshl_b32 s69, s6, 14
s_xor_b32 s6, s62, 4
s_lshl_b32 s70, s6, 14
s_xor_b32 s6, s62, 5
s_lshl_b32 s71, s6, 14
s_xor_b32 s6, s62, 6
s_lshl_b32 s72, s6, 14
s_xor_b32 s6, s62, 7
s_lshl_b32 s73, s6, 14
s_waitcnt lgkmcnt(0)
s_cmp_ge_u32 s4, 4
s_cselect_b32 s6, s30, s24
s_cselect_b32 s7, s31, s25
s_add_u32 s40, s6, 0x0
s_addc_u32 s41, s7, 0
s_mov_b32 s42, 0x20000
s_mov_b32 s43, 0x00020000
s_add_u32 s44, s32, 0x0
s_addc_u32 s45, s33, 0
s_mov_b32 s46, 0x20000
s_mov_b32 s47, 0x00020000
buffer_load_dwordx4 v[40:43], v40, s[40:43], 0 offen
buffer_load_dwordx4 v[44:47], v44, s[40:43], 0 offen
buffer_load_dwordx4 v[48:51], v48, s[40:43], 0 offen
buffer_load_dwordx4 v[52:55], v52, s[40:43], 0 offen
buffer_load_dwordx4 v[176:179], v176, s[40:43], 0 offen
s_add_u32 m0, s63, 0x0
s_nop 0
buffer_load_dwordx4 v17, s[44:47], s66 offen offset:0 lds
buffer_load_dwordx4 v18, s[44:47], s66 offen offset:1024 lds
s_add_u32 m0, s63, 0x800
s_nop 0
buffer_load_dwordx4 v17, s[44:47], s67 offen offset:0 lds
buffer_load_dwordx4 v18, s[44:47], s67 offen offset:1024 lds
v_bfe_u32 v5, v2, 2, 3
v_xor_b32 v5, s62, v5
v_and_b32 v6, 3, v2
v_lshlrev_b32 v7, 10, v5
v_lshl_add_u32 v7, v6, 8, v7
v_add_u32 v7, 0xc000, v7
v_and_b32 v5, 1, v5
v_lshl_or_b32 v6, v5, 2, v6
v_lshrrev_b32 v5, 5, v2
s_mul_i32 s6, s60, 8
v_add3_u32 v8, v5, s6, 0
v_lshrrev_b32 v9, 4, v8
v_lshl_add_u32 v9, v9, 13, v7
v_and_b32 v8, 15, v8
v_xor_b32 v8, v8, v6
v_lshl_add_u32 v36, v8, 4, v9
v_add3_u32 v8, v5, s6, 2
v_lshrrev_b32 v9, 4, v8
v_lshl_add_u32 v9, v9, 13, v7
v_and_b32 v8, 15, v8
v_xor_b32 v8, v8, v6
v_lshl_add_u32 v37, v8, 4, v9
v_add3_u32 v8, v5, s6, 4
v_lshrrev_b32 v9, 4, v8
v_lshl_add_u32 v9, v9, 13, v7
v_and_b32 v8, 15, v8
v_xor_b32 v8, v8, v6
v_lshl_add_u32 v38, v8, 4, v9
v_add3_u32 v8, v5, s6, 6
v_lshrrev_b32 v9, 4, v8
v_lshl_add_u32 v9, v9, 13, v7
v_and_b32 v8, 15, v8
v_xor_b32 v8, v8, v6
v_lshl_add_u32 v39, v8, 4, v9
v_xor_b32 v5, v3, v4
v_lshlrev_b32 v5, 4, v5
v_lshl_add_u32 v5, v4, 8, v5
v_add_u32 v31, 0xc000, v5
v_xor_b32 v32, 64, v31
v_lshrrev_b32 v5, 2, v3
v_and_b32 v6, 3, v3
v_and_b32 v7, 1, v4
v_lshlrev_b32 v7, 1, v7
v_lshl_add_u32 v8, v4, 3, v5
v_lshlrev_b32 v8, 6, v8
v_add_u32 v8, s63, v8
v_xor_b32 v6, v6, v7
v_xor_b32 v9, 0, v6
v_lshl_add_u32 v25, v9, 4, v8
v_add_u32 v26, 8, v25
s_lshr_b32 s6, s4, 2
s_lshl_b32 s6, s6, 17
s_and_b32 s7, s4, 3
s_lshl_b32 s7, s7, 12
s_add_u32 s6, s6, s7
s_mul_i32 s7, s60, 16384
s_add_u32 s82, s6, s7
s_add_u32 s83, s82, 16384
s_add_u32 s52, s38, 0x1000000
s_addc_u32 s53, s39, 0
s_mov_b32 s54, 0x40000
s_mov_b32 s55, 0x00020000
s_mov_b32 s90, 0xffff0000
s_waitcnt vmcnt(4)
v_lshlrev_b32 v180, 16, v176
v_and_b32 v181, s90, v176
v_lshlrev_b32 v182, 16, v177
v_and_b32 v183, s90, v177
v_lshlrev_b32 v184, 16, v178
v_and_b32 v185, s90, v178
v_lshlrev_b32 v186, 16, v179
v_and_b32 v187, s90, v179
v_lshlrev_b32 v176, 16, v40
v_and_b32 v177, s90, v40
v_sub_f32 v176, v176, v180
v_sub_f32 v177, v177, v181
v_cvt_pk_bf16_f32 v40, v176, v177
v_lshlrev_b32 v176, 16, v41
v_and_b32 v177, s90, v41
v_sub_f32 v176, v176, v182
v_sub_f32 v177, v177, v183
v_cvt_pk_bf16_f32 v41, v176, v177
v_lshlrev_b32 v176, 16, v42
v_and_b32 v177, s90, v42
v_sub_f32 v176, v176, v184
v_sub_f32 v177, v177, v185
v_cvt_pk_bf16_f32 v42, v176, v177
v_lshlrev_b32 v176, 16, v43
v_and_b32 v177, s90, v43
v_sub_f32 v176, v176, v186
v_sub_f32 v177, v177, v187
v_cvt_pk_bf16_f32 v43, v176, v177
v_lshlrev_b32 v176, 16, v44
v_and_b32 v177, s90, v44
v_sub_f32 v176, v176, v180
v_sub_f32 v177, v177, v181
v_cvt_pk_bf16_f32 v44, v176, v177
v_lshlrev_b32 v176, 16, v45
v_and_b32 v177, s90, v45
v_sub_f32 v176, v176, v182
v_sub_f32 v177, v177, v183
v_cvt_pk_bf16_f32 v45, v176, v177
v_lshlrev_b32 v176, 16, v46
v_and_b32 v177, s90, v46
v_sub_f32 v176, v176, v184
v_sub_f32 v177, v177, v185
v_cvt_pk_bf16_f32 v46, v176, v177
v_lshlrev_b32 v176, 16, v47
v_and_b32 v177, s90, v47
v_sub_f32 v176, v176, v186
v_sub_f32 v177, v177, v187
v_cvt_pk_bf16_f32 v47, v176, v177
v_lshlrev_b32 v176, 16, v48
v_and_b32 v177, s90, v48
v_sub_f32 v176, v176, v180
v_sub_f32 v177, v177, v181
v_cvt_pk_bf16_f32 v48, v176, v177
v_lshlrev_b32 v176, 16, v49
v_and_b32 v177, s90, v49
v_sub_f32 v176, v176, v182
v_sub_f32 v177, v177, v183
v_cvt_pk_bf16_f32 v49, v176, v177
v_lshlrev_b32 v176, 16, v50
v_and_b32 v177, s90, v50
v_sub_f32 v176, v176, v184
v_sub_f32 v177, v177, v185
v_cvt_pk_bf16_f32 v50, v176, v177
v_lshlrev_b32 v176, 16, v51
v_and_b32 v177, s90, v51
v_sub_f32 v176, v176, v186
v_sub_f32 v177, v177, v187
v_cvt_pk_bf16_f32 v51, v176, v177
v_lshlrev_b32 v176, 16, v52
v_and_b32 v177, s90, v52
v_sub_f32 v176, v176, v180
v_sub_f32 v177, v177, v181
v_cvt_pk_bf16_f32 v52, v176, v177
v_lshlrev_b32 v176, 16, v53
v_and_b32 v177, s90, v53
v_sub_f32 v176, v176, v182
v_sub_f32 v177, v177, v183
v_cvt_pk_bf16_f32 v53, v176, v177
v_lshlrev_b32 v176, 16, v54
v_and_b32 v177, s90, v54
v_sub_f32 v176, v176, v184
v_sub_f32 v177, v177, v185
v_cvt_pk_bf16_f32 v54, v176, v177
v_lshlrev_b32 v176, 16, v55
v_and_b32 v177, s90, v55
v_sub_f32 v176, v176, v186
v_sub_f32 v177, v177, v187
v_cvt_pk_bf16_f32 v55, v176, v177
ds_write_b128 v36, v[40:43]
ds_write_b128 v37, v[44:47]
ds_write_b128 v38, v[48:51]
ds_write_b128 v39, v[52:55]
s_add_u32 m0, s63, 0x1000
s_nop 0
buffer_load_dwordx4 v17, s[44:47], s68 offen offset:0 lds
buffer_load_dwordx4 v18, s[44:47], s68 offen offset:1024 lds
s_waitcnt vmcnt(4)
ds_read_b64_tr_b16 v[88:89], v25 offset:0
ds_read_b64_tr_b16 v[90:91], v25 offset:256
ds_read_b64_tr_b16 v[92:93], v26 offset:0
ds_read_b64_tr_b16 v[94:95], v26 offset:256
s_waitcnt lgkmcnt(4)
s_barrier
ds_read_b128 v[112:115], v31 offset:0
ds_read_b128 v[116:119], v31 offset:8192
ds_read_b128 v[120:123], v31 offset:16384
ds_read_b128 v[124:127], v31 offset:24576
ds_read_b128 v[128:131], v32 offset:1024
s_waitcnt vmcnt(2)
ds_read_b64_tr_b16 v[96:97], v25 offset:2048
ds_read_b64_tr_b16 v[98:99], v25 offset:2304
s_waitcnt lgkmcnt(6)
v_mfma_f32_16x16x32_bf16 v[56:59], v[112:115], v[88:91], 0
ds_read_b128 v[132:135], v32 offset:9216
s_waitcnt lgkmcnt(6)
v_mfma_f32_16x16x32_bf16 v[60:63], v[116:119], v[88:91], 0
ds_read_b128 v[136:139], v32 offset:17408
s_waitcnt lgkmcnt(6)
v_mfma_f32_16x16x32_bf16 v[64:67], v[120:123], v[88:91], 0
ds_read_b128 v[140:143], v32 offset:25600
s_waitcnt lgkmcnt(6)
v_mfma_f32_16x16x32_bf16 v[68:71], v[124:127], v[88:91], 0
ds_read_b64_tr_b16 v[100:101], v26 offset:2048
ds_read_b64_tr_b16 v[102:103], v26 offset:2304
v_mfma_f32_16x16x32_bf16 v[72:75], v[112:115], v[92:95], 0
s_add_u32 m0, s63, 0x0
s_nop 0
buffer_load_dwordx4 v17, s[44:47], s69 offen offset:0 lds
buffer_load_dwordx4 v18, s[44:47], s69 offen offset:1024 lds
v_mfma_f32_16x16x32_bf16 v[76:79], v[116:119], v[92:95], 0
v_mfma_f32_16x16x32_bf16 v[80:83], v[120:123], v[92:95], 0
v_mfma_f32_16x16x32_bf16 v[84:87], v[124:127], v[92:95], 0
ds_read_b128 v[144:147], v31 offset:2048
s_waitcnt vmcnt(2)
ds_read_b64_tr_b16 v[104:105], v25 offset:4096
ds_read_b64_tr_b16 v[106:107], v25 offset:4352
s_waitcnt lgkmcnt(8)
v_mfma_f32_16x16x32_bf16 v[56:59], v[128:131], v[96:99], v[56:59]
ds_read_b128 v[148:151], v31 offset:10240
s_waitcnt lgkmcnt(8)
v_mfma_f32_16x16x32_bf16 v[60:63], v[132:135], v[96:99], v[60:63]
ds_read_b128 v[152:155], v31 offset:18432
s_waitcnt lgkmcnt(8)
v_mfma_f32_16x16x32_bf16 v[64:67], v[136:139], v[96:99], v[64:67]
ds_read_b128 v[156:159], v31 offset:26624
s_waitcnt lgkmcnt(8)
v_mfma_f32_16x16x32_bf16 v[68:71], v[140:143], v[96:99], v[68:71]
ds_read_b64_tr_b16 v[108:109], v26 offset:4096
ds_read_b64_tr_b16 v[110:111], v26 offset:4352
s_waitcnt lgkmcnt(8)
v_mfma_f32_16x16x32_bf16 v[72:75], v[128:131], v[100:103], v[72:75]
s_add_u32 m0, s63, 0x800
s_nop 0
buffer_load_dwordx4 v17, s[44:47], s70 offen offset:0 lds
buffer_load_dwordx4 v18, s[44:47], s70 offen offset:1024 lds
v_mfma_f32_16x16x32_bf16 v[76:79], v[132:135], v[100:103], v[76:79]
v_mfma_f32_16x16x32_bf16 v[80:83], v[136:139], v[100:103], v[80:83]
v_mfma_f32_16x16x32_bf16 v[84:87], v[140:143], v[100:103], v[84:87]
ds_read_b128 v[160:163], v32 offset:3072
s_waitcnt vmcnt(2)
ds_read_b64_tr_b16 v[88:89], v25 offset:0
ds_read_b64_tr_b16 v[90:91], v25 offset:256
s_waitcnt lgkmcnt(8)
v_mfma_f32_16x16x32_bf16 v[56:59], v[144:147], v[104:107], v[56:59]
ds_read_b128 v[164:167], v32 offset:11264
s_waitcnt lgkmcnt(8)
v_mfma_f32_16x16x32_bf16 v[60:63], v[148:151], v[104:107], v[60:63]
ds_read_b128 v[168:171], v32 offset:19456
s_waitcnt lgkmcnt(8)
v_mfma_f32_16x16x32_bf16 v[64:67], v[152:155], v[104:107], v[64:67]
ds_read_b128 v[172:175], v32 offset:27648
s_waitcnt lgkmcnt(8)
v_mfma_f32_16x16x32_bf16 v[68:71], v[156:159], v[104:107], v[68:71]
ds_read_b64_tr_b16 v[92:93], v26 offset:0
ds_read_b64_tr_b16 v[94:95], v26 offset:256
s_waitcnt lgkmcnt(8)
v_mfma_f32_16x16x32_bf16 v[72:75], v[144:147], v[108:111], v[72:75]
s_add_u32 m0, s63, 0x1000
s_nop 0
buffer_load_dwordx4 v17, s[44:47], s71 offen offset:0 lds
buffer_load_dwordx4 v18, s[44:47], s71 offen offset:1024 lds
v_mfma_f32_16x16x32_bf16 v[76:79], v[148:151], v[108:111], v[76:79]
v_mfma_f32_16x16x32_bf16 v[80:83], v[152:155], v[108:111], v[80:83]
v_mfma_f32_16x16x32_bf16 v[84:87], v[156:159], v[108:111], v[84:87]
ds_read_b128 v[112:115], v31 offset:4096
s_waitcnt vmcnt(2)
ds_read_b64_tr_b16 v[96:97], v25 offset:2048
ds_read_b64_tr_b16 v[98:99], v25 offset:2304
s_waitcnt lgkmcnt(8)
v_mfma_f32_16x16x32_bf16 v[56:59], v[160:163], v[88:91], v[56:59]
ds_read_b128 v[116:119], v31 offset:12288
s_waitcnt lgkmcnt(8)
v_mfma_f32_16x16x32_bf16 v[60:63], v[164:167], v[88:91], v[60:63]
ds_read_b128 v[120:123], v31 offset:20480
s_waitcnt lgkmcnt(8)
v_mfma_f32_16x16x32_bf16 v[64:67], v[168:171], v[88:91], v[64:67]
ds_read_b128 v[124:127], v31 offset:28672
s_waitcnt lgkmcnt(8)
v_mfma_f32_16x16x32_bf16 v[68:71], v[172:175], v[88:91], v[68:71]
ds_read_b64_tr_b16 v[100:101], v26 offset:2048
ds_read_b64_tr_b16 v[102:103], v26 offset:2304
s_waitcnt lgkmcnt(8)
v_mfma_f32_16x16x32_bf16 v[72:75], v[160:163], v[92:95], v[72:75]
s_add_u32 m0, s63, 0x0
s_nop 0
buffer_load_dwordx4 v17, s[44:47], s72 offen offset:0 lds
buffer_load_dwordx4 v18, s[44:47], s72 offen offset:1024 lds
v_mfma_f32_16x16x32_bf16 v[76:79], v[164:167], v[92:95], v[76:79]
v_mfma_f32_16x16x32_bf16 v[80:83], v[168:171], v[92:95], v[80:83]
v_mfma_f32_16x16x32_bf16 v[84:87], v[172:175], v[92:95], v[84:87]
ds_read_b128 v[128:131], v32 offset:5120
s_waitcnt vmcnt(2)
ds_read_b64_tr_b16 v[104:105], v25 offset:4096
ds_read_b64_tr_b16 v[106:107], v25 offset:4352
s_waitcnt lgkmcnt(8)
v_mfma_f32_16x16x32_bf16 v[56:59], v[112:115], v[96:99], v[56:59]
ds_read_b128 v[132:135], v32 offset:13312
s_waitcnt lgkmcnt(8)
v_mfma_f32_16x16x32_bf16 v[60:63], v[116:119], v[96:99], v[60:63]
ds_read_b128 v[136:139], v32 offset:21504
s_waitcnt lgkmcnt(8)
v_mfma_f32_16x16x32_bf16 v[64:67], v[120:123], v[96:99], v[64:67]
ds_read_b128 v[140:143], v32 offset:29696
s_waitcnt lgkmcnt(8)
v_mfma_f32_16x16x32_bf16 v[68:71], v[124:127], v[96:99], v[68:71]
ds_read_b64_tr_b16 v[108:109], v26 offset:4096
ds_read_b64_tr_b16 v[110:111], v26 offset:4352
s_waitcnt lgkmcnt(8)
v_mfma_f32_16x16x32_bf16 v[72:75], v[112:115], v[100:103], v[72:75]
s_add_u32 m0, s63, 0x800
s_nop 0
buffer_load_dwordx4 v17, s[44:47], s73 offen offset:0 lds
buffer_load_dwordx4 v18, s[44:47], s73 offen offset:1024 lds
v_mfma_f32_16x16x32_bf16 v[76:79], v[116:119], v[100:103], v[76:79]
v_mfma_f32_16x16x32_bf16 v[80:83], v[120:123], v[100:103], v[80:83]
v_mfma_f32_16x16x32_bf16 v[84:87], v[124:127], v[100:103], v[84:87]
ds_read_b128 v[144:147], v31 offset:6144
s_waitcnt vmcnt(2)
ds_read_b64_tr_b16 v[88:89], v25 offset:0
ds_read_b64_tr_b16 v[90:91], v25 offset:256
s_waitcnt lgkmcnt(8)
v_mfma_f32_16x16x32_bf16 v[56:59], v[128:131], v[104:107], v[56:59]
ds_read_b128 v[148:151], v31 offset:14336
s_waitcnt lgkmcnt(8)
v_mfma_f32_16x16x32_bf16 v[60:63], v[132:135], v[104:107], v[60:63]
ds_read_b128 v[152:155], v31 offset:22528
s_waitcnt lgkmcnt(8)
v_mfma_f32_16x16x32_bf16 v[64:67], v[136:139], v[104:107], v[64:67]
ds_read_b128 v[156:159], v31 offset:30720
s_waitcnt lgkmcnt(8)
v_mfma_f32_16x16x32_bf16 v[68:71], v[140:143], v[104:107], v[68:71]
ds_read_b64_tr_b16 v[92:93], v26 offset:0
ds_read_b64_tr_b16 v[94:95], v26 offset:256
s_waitcnt lgkmcnt(8)
v_mfma_f32_16x16x32_bf16 v[72:75], v[128:131], v[108:111], v[72:75]
v_mfma_f32_16x16x32_bf16 v[76:79], v[132:135], v[108:111], v[76:79]
v_mfma_f32_16x16x32_bf16 v[80:83], v[136:139], v[108:111], v[80:83]
v_mfma_f32_16x16x32_bf16 v[84:87], v[140:143], v[108:111], v[84:87]
ds_read_b128 v[160:163], v32 offset:7168
s_waitcnt vmcnt(0)
ds_read_b64_tr_b16 v[96:97], v25 offset:2048
ds_read_b64_tr_b16 v[98:99], v25 offset:2304
s_waitcnt lgkmcnt(8)
v_mfma_f32_16x16x32_bf16 v[56:59], v[144:147], v[88:91], v[56:59]
ds_read_b128 v[164:167], v32 offset:15360
s_waitcnt lgkmcnt(8)
v_mfma_f32_16x16x32_bf16 v[60:63], v[148:151], v[88:91], v[60:63]
ds_read_b128 v[168:171], v32 offset:23552
s_waitcnt lgkmcnt(8)
v_mfma_f32_16x16x32_bf16 v[64:67], v[152:155], v[88:91], v[64:67]
ds_read_b128 v[172:175], v32 offset:31744
s_waitcnt lgkmcnt(8)
v_mfma_f32_16x16x32_bf16 v[68:71], v[156:159], v[88:91], v[68:71]
ds_read_b64_tr_b16 v[100:101], v26 offset:2048
ds_read_b64_tr_b16 v[102:103], v26 offset:2304
s_waitcnt lgkmcnt(8)
v_mfma_f32_16x16x32_bf16 v[72:75], v[144:147], v[92:95], v[72:75]
v_mfma_f32_16x16x32_bf16 v[76:79], v[148:151], v[92:95], v[76:79]
v_mfma_f32_16x16x32_bf16 v[80:83], v[152:155], v[92:95], v[80:83]
v_mfma_f32_16x16x32_bf16 v[84:87], v[156:159], v[92:95], v[84:87]
s_waitcnt lgkmcnt(5)
v_mfma_f32_16x16x32_bf16 v[56:59], v[160:163], v[96:99], v[56:59]
s_waitcnt lgkmcnt(4)
v_mfma_f32_16x16x32_bf16 v[60:63], v[164:167], v[96:99], v[60:63]
s_waitcnt lgkmcnt(3)
v_mfma_f32_16x16x32_bf16 v[64:67], v[168:171], v[96:99], v[64:67]
s_waitcnt lgkmcnt(2)
v_mfma_f32_16x16x32_bf16 v[68:71], v[172:175], v[96:99], v[68:71]
s_waitcnt lgkmcnt(0)
v_mfma_f32_16x16x32_bf16 v[72:75], v[160:163], v[100:103], v[72:75]
v_cvt_pk_bf16_f32 v56, v56, v57
v_cvt_pk_bf16_f32 v57, v58, v59
v_cvt_pk_bf16_f32 v58, v60, v61
v_cvt_pk_bf16_f32 v59, v62, v63
buffer_store_dwordx4 v[56:59], v16, s[52:55], s82 offen offset:0 sc1
v_mfma_f32_16x16x32_bf16 v[76:79], v[164:167], v[100:103], v[76:79]
v_mfma_f32_16x16x32_bf16 v[80:83], v[168:171], v[100:103], v[80:83]
v_cvt_pk_bf16_f32 v64, v64, v65
v_cvt_pk_bf16_f32 v65, v66, v67
v_cvt_pk_bf16_f32 v66, v68, v69
v_cvt_pk_bf16_f32 v67, v70, v71
buffer_store_dwordx4 v[64:67], v16, s[52:55], s82 offen offset:2048 sc1
v_mfma_f32_16x16x32_bf16 v[84:87], v[172:175], v[100:103], v[84:87]
v_cvt_pk_bf16_f32 v72, v72, v73
v_cvt_pk_bf16_f32 v73, v74, v75
v_cvt_pk_bf16_f32 v74, v76, v77
v_cvt_pk_bf16_f32 v75, v78, v79
buffer_store_dwordx4 v[72:75], v16, s[52:55], s82 offen offset:1024 sc1
v_cvt_pk_bf16_f32 v80, v80, v81
v_cvt_pk_bf16_f32 v81, v82, v83
s_nop 0
v_cvt_pk_bf16_f32 v82, v84, v85
v_cvt_pk_bf16_f32 v83, v86, v87
buffer_store_dwordx4 v[80:83], v16, s[52:55], s82 offen offset:3072 sc1
s_branch L1_fin
L1_edge:
s_mov_b32 s61, 4
s_mov_b32 s4, s2
s_mul_i32 s6, s4, 20000
v_lshlrev_b32 v5, 4, v0
v_lshlrev_b32 v6, 2, v2
v_add_u32 v6, 0x10000, v6
v_mov_b32 v7, 0
ds_write_b32 v6, v7
s_mov_b32 s66, 0
s_mov_b32 s67, 8192
s_mov_b32 s68, 16384
s_waitcnt lgkmcnt(0)
s_add_u32 s40, s20, 0x0
s_addc_u32 s41, s21, 0
s_add_u32 s40, s40, s6
s_addc_u32 s41, s41, 0
s_mov_b32 s42, 0x4e20
s_mov_b32 s43, 0x00020000
s_add_u32 s44, s18, 0x0
s_addc_u32 s45, s19, 0
s_add_u32 s44, s44, s6
s_addc_u32 s45, s45, 0
s_mov_b32 s46, 0x4e20
s_mov_b32 s47, 0x00020000
buffer_load_dwordx4 v[16:19], v5, s[40:43], s66 offen
buffer_load_dwordx4 v[20:23], v5, s[40:43], s67 offen
buffer_load_dwordx4 v[24:27], v5, s[40:43], s68 offen
buffer_load_dwordx4 v[28:31], v5, s[44:47], s66 offen
buffer_load_dwordx4 v[32:35], v5, s[44:47], s67 offen
buffer_load_dwordx4 v[36:39], v5, s[44:47], s68 offen
s_add_u32 s48, s38, 0x8000000
s_addc_u32 s49, s39, 0
s_mov_b32 s50, 0x2800000
s_mov_b32 s51, 0x00020000
s_add_u32 s52, s38, 0x7800000
s_addc_u32 s53, s39, 0
s_mov_b32 s54, 0x2000
s_mov_b32 s55, 0x00020000
s_mov_b32 s9, 6279
s_mov_b32 s10, 4294967129
s_mov_b32 s11, 0x10000
v_mov_b32 v7, 1
v_cmp_gt_u32 vcc, 0xe2, v0
s_mov_b64 s[12:13], vcc
s_barrier
s_waitcnt vmcnt(5)
v_mul_u32_u24 v40, s9, v16
v_lshrrev_b32 v40, 20, v40
v_lshl_add_u32 v52, v40, 2, s11
ds_add_rtn_u32 v52, v52, v7
v_mad_i32_i24 v16, v40, s10, v16
v_mul_u32_u24 v41, s9, v17
v_lshrrev_b32 v41, 20, v41
v_lshl_add_u32 v53, v41, 2, s11
ds_add_rtn_u32 v53, v53, v7
v_mad_i32_i24 v17, v41, s10, v17
v_mul_u32_u24 v42, s9, v18
v_lshrrev_b32 v42, 20, v42
v_lshl_add_u32 v54, v42, 2, s11
ds_add_rtn_u32 v54, v54, v7
v_mad_i32_i24 v18, v42, s10, v18
v_mul_u32_u24 v43, s9, v19
v_lshrrev_b32 v43, 20, v43
v_lshl_add_u32 v55, v43, 2, s11
ds_add_rtn_u32 v55, v55, v7
v_mad_i32_i24 v19, v43, s10, v19
s_waitcnt vmcnt(4)
v_mul_u32_u24 v44, s9, v20
v_lshrrev_b32 v44, 20, v44
v_lshl_add_u32 v56, v44, 2, s11
ds_add_rtn_u32 v56, v56, v7
v_mad_i32_i24 v20, v44, s10, v20
v_mul_u32_u24 v45, s9, v21
v_lshrrev_b32 v45, 20, v45
v_lshl_add_u32 v57, v45, 2, s11
ds_add_rtn_u32 v57, v57, v7
v_mad_i32_i24 v21, v45, s10, v21
v_mul_u32_u24 v46, s9, v22
v_lshrrev_b32 v46, 20, v46
v_lshl_add_u32 v58, v46, 2, s11
ds_add_rtn_u32 v58, v58, v7
v_mad_i32_i24 v22, v46, s10, v22
v_mul_u32_u24 v47, s9, v23
v_lshrrev_b32 v47, 20, v47
v_lshl_add_u32 v59, v47, 2, s11
ds_add_rtn_u32 v59, v59, v7
v_mad_i32_i24 v23, v47, s10, v23
s_waitcnt vmcnt(3)
s_mov_b64 exec, s[12:13]
v_mul_u32_u24 v48, s9, v24
v_lshrrev_b32 v48, 20, v48
v_lshl_add_u32 v60, v48, 2, s11
ds_add_rtn_u32 v60, v60, v7
v_mad_i32_i24 v24, v48, s10, v24
v_mul_u32_u24 v49, s9, v25
v_lshrrev_b32 v49, 20, v49
v_lshl_add_u32 v61, v49, 2, s11
ds_add_rtn_u32 v61, v61, v7
v_mad_i32_i24 v25, v49, s10, v25
v_mul_u32_u24 v50, s9, v26
v_lshrrev_b32 v50, 20, v50
v_lshl_add_u32 v62, v50, 2, s11
ds_add_rtn_u32 v62, v62, v7
v_mad_i32_i24 v26, v50, s10, v26
v_mul_u32_u24 v51, s9, v27
v_lshrrev_b32 v51, 20, v51
v_lshl_add_u32 v63, v51, 2, s11
ds_add_rtn_u32 v63, v63, v7
v_mad_i32_i24 v27, v51, s10, v27
s_mov_b64 exec, -1
s_waitcnt vmcnt(2) lgkmcnt(4)
v_and_b32 v8, 0x7f, v52
v_lshl_or_b32 v28, v16, 18, v28
v_lshlrev_b32 v8, 2, v8
v_lshl_add_u32 v8, v40, 9, v8
ds_write_b32 v8, v28
v_and_b32 v8, 0x7f, v53
v_lshl_or_b32 v29, v17, 18, v29
v_lshlrev_b32 v8, 2, v8
v_lshl_add_u32 v8, v41, 9, v8
ds_write_b32 v8, v29
v_and_b32 v8, 0x7f, v54
v_lshl_or_b32 v30, v18, 18, v30
v_lshlrev_b32 v8, 2, v8
v_lshl_add_u32 v8, v42, 9, v8
ds_write_b32 v8, v30
v_and_b32 v8, 0x7f, v55
v_lshl_or_b32 v31, v19, 18, v31
v_lshlrev_b32 v8, 2, v8
v_lshl_add_u32 v8, v43, 9, v8
ds_write_b32 v8, v31
s_waitcnt vmcnt(1) lgkmcnt(4)
v_and_b32 v8, 0x7f, v56
v_lshl_or_b32 v32, v20, 18, v32
v_lshlrev_b32 v8, 2, v8
v_lshl_add_u32 v8, v44, 9, v8
ds_write_b32 v8, v32
v_and_b32 v8, 0x7f, v57
v_lshl_or_b32 v33, v21, 18, v33
v_lshlrev_b32 v8, 2, v8
v_lshl_add_u32 v8, v45, 9, v8
ds_write_b32 v8, v33
v_and_b32 v8, 0x7f, v58
v_lshl_or_b32 v34, v22, 18, v34
v_lshlrev_b32 v8, 2, v8
v_lshl_add_u32 v8, v46, 9, v8
ds_write_b32 v8, v34
v_and_b32 v8, 0x7f, v59
v_lshl_or_b32 v35, v23, 18, v35
v_lshlrev_b32 v8, 2, v8
v_lshl_add_u32 v8, v47, 9, v8
ds_write_b32 v8, v35
s_waitcnt vmcnt(0) lgkmcnt(8)
s_mov_b64 exec, s[12:13]
v_and_b32 v8, 0x7f, v60
v_lshl_or_b32 v36, v24, 18, v36
v_lshlrev_b32 v8, 2, v8
v_lshl_add_u32 v8, v48, 9, v8
ds_write_b32 v8, v36
v_and_b32 v8, 0x7f, v61
v_lshl_or_b32 v37, v25, 18, v37
v_lshlrev_b32 v8, 2, v8
v_lshl_add_u32 v8, v49, 9, v8
ds_write_b32 v8, v37
v_and_b32 v8, 0x7f, v62
v_lshl_or_b32 v38, v26, 18, v38
v_lshlrev_b32 v8, 2, v8
v_lshl_add_u32 v8, v50, 9, v8
ds_write_b32 v8, v38
v_and_b32 v8, 0x7f, v63
v_lshl_or_b32 v39, v27, 18, v39
v_lshlrev_b32 v8, 2, v8
v_lshl_add_u32 v8, v51, 9, v8
ds_write_b32 v8, v39
s_mov_b64 exec, -1
s_waitcnt lgkmcnt(0)
s_barrier
ds_read_b32 v8, v6
s_mul_i32 s6, s60, 4096
v_lshlrev_b32 v10, 4, v2
v_add_u32 v9, s6, v10
ds_read_b128 v[64:67], v9 offset:0
ds_read_b128 v[68:71], v9 offset:1024
ds_read_b128 v[72:75], v9 offset:2048
ds_read_b128 v[76:79], v9 offset:3072
v_lshrrev_b32 v11, 5, v2
v_mul_u32_u24 v11, 0x9fe00, v11
v_add_u32 v10, v10, v11
s_mul_i32 s6, s60, 5242880
s_mul_i32 s7, s4, 20480
s_add_u32 s6, s6, s7
v_lshlrev_b32 v9, 7, v2
s_lshl_b32 s8, s4, 2
s_cmp_eq_u32 s60, 0
s_cselect_b32 s8, s8, 0x7fff0000
s_waitcnt lgkmcnt(4)
buffer_store_dword v8, v9, s[52:55], s8 offen
v_cmp_lt_u32 vcc, 0x80, v8
s_cbranch_vccnz L1_eslow
s_waitcnt lgkmcnt(3)
buffer_store_dwordx4 v[64:67], v10, s[48:51], s6 offen
s_add_u32 s6, s6, 1310720
s_waitcnt lgkmcnt(2)
buffer_store_dwordx4 v[68:71], v10, s[48:51], s6 offen
s_add_u32 s6, s6, 1310720
s_waitcnt lgkmcnt(1)
buffer_store_dwordx4 v[72:75], v10, s[48:51], s6 offen
s_add_u32 s6, s6, 1310720
s_waitcnt lgkmcnt(0)
buffer_store_dwordx4 v[76:79], v10, s[48:51], s6 offen
s_add_u32 s6, s6, 1310720
s_branch L1_fin
L1_eslow:
s_mov_b32 s9, 655360
v_mul_u32_u24 v40, s9, v40
v_lshl_add_u32 v40, v52, 2, v40
v_mul_u32_u24 v41, s9, v41
v_lshl_add_u32 v41, v53, 2, v41
v_mul_u32_u24 v42, s9, v42
v_lshl_add_u32 v42, v54, 2, v42
v_mul_u32_u24 v43, s9, v43
v_lshl_add_u32 v43, v55, 2, v43
v_mul_u32_u24 v44, s9, v44
v_lshl_add_u32 v44, v56, 2, v44
v_mul_u32_u24 v45, s9, v45
v_lshl_add_u32 v45, v57, 2, v45
v_mul_u32_u24 v46, s9, v46
v_lshl_add_u32 v46, v58, 2, v46
v_mul_u32_u24 v47, s9, v47
v_lshl_add_u32 v47, v59, 2, v47
v_mul_u32_u24 v48, s9, v48
v_lshl_add_u32 v48, v60, 2, v48
v_mul_u32_u24 v49, s9, v49
v_lshl_add_u32 v49, v61, 2, v49
v_mul_u32_u24 v50, s9, v50
v_lshl_add_u32 v50, v62, 2, v50
v_mul_u32_u24 v51, s9, v51
v_lshl_add_u32 v51, v63, 2, v51
buffer_store_dword v28, v40, s[48:51], s7 offen
buffer_store_dword v29, v41, s[48:51], s7 offen
buffer_store_dword v30, v42, s[48:51], s7 offen
buffer_store_dword v31, v43, s[48:51], s7 offen
buffer_store_dword v32, v44, s[48:51], s7 offen
buffer_store_dword v33, v45, s[48:51], s7 offen
buffer_store_dword v34, v46, s[48:51], s7 offen
buffer_store_dword v35, v47, s[48:51], s7 offen
s_mov_b64 exec, s[12:13]
buffer_store_dword v36, v48, s[48:51], s7 offen
buffer_store_dword v37, v49, s[48:51], s7 offen
buffer_store_dword v38, v50, s[48:51], s7 offen
buffer_store_dword v39, v51, s[48:51], s7 offen
s_mov_b64 exec, -1
L1_fin:
L1_end:
s_endpgm
.globl k2_kernel
.p2align 8
.type k2_kernel,@function
k2_kernel:
s_load_dwordx2 s[4:5], s[0:1], 88
s_and_b32 s35, s2, 7
s_lshr_b32 s37, s2, 3
s_cmp_ge_u32 s37, 30
s_cbranch_scc1 LE_start
s_mul_i32 s38, s37, 52
s_lshr_b32 s38, s38, 8
s_mul_i32 s39, s38, 5
s_sub_u32 s39, s37, s39
s_mov_b32 s37, s38
s_mul_i32 s38, s35, 5
s_add_u32 s38, s38, s39
v_lshrrev_b32 v1, 6, v0
v_and_b32 v252, 63, v0
v_lshlrev_b32 v252, 4, v252
v_readfirstlane_b32 s34, v1
s_mov_b32 s50, 0xd1986600
s_mov_b32 s51, 0x4e608cf4
s_mul_i32 s39, s37, 9
s_lshr_b64 s[50:51], s[50:51], s39
s_and_b32 s39, s50, 0x1ff
s_bfe_u32 s49, s50, 0x90009
s_sub_u32 s29, s49, s39
s_lshl_b32 s50, s37, 2
s_lshr_b32 s59, 0x777655, s50
s_and_b32 s59, s59, 15
s_sub_u32 s31, s29, s59
s_lshr_b32 s31, s31, 1
s_sub_u32 s31, s31, 1
s_lshl_b32 s39, s39, 14
s_lshl_b32 s49, s49, 14
s_add_u32 s28, s39, 0x4000
s_cmp_eq_u32 s37, 5
s_cselect_b32 s33, 0xff800000, 0
s_mov_b32 s32, 0xffff
v_and_b32 v2, 63, v0
v_bfe_u32 v3, v2, 3, 2
v_bfe_u32 v4, v2, 2, 1
v_lshlrev_b32 v251, 12, v3
v_lshl_or_b32 v251, v4, 9, v251
v_lshl_or_b32 v251, v1, 7, v251
v_lshrrev_b32 v4, 5, v2
v_lshl_or_b32 v251, v4, 6, v251
v_and_b32 v3, 2, v3
v_and_b32 v4, 3, v2
v_xor_b32 v3, v3, v4
v_lshl_or_b32 v251, v3, 4, v251
s_cmp_eq_u32 s38, 39
s_cbranch_scc1 LT_disp
s_lshl_b32 s30, s34, 12
s_mov_b32 m0, s30
s_waitcnt lgkmcnt(0)
s_add_u32 s12, s4, 0x6800000
s_addc_u32 s13, s5, 0
s_mov_b32 s14, s49
s_mov_b32 s15, 0x00020000
buffer_load_dwordx4 v251, s[12:15], s39 offen offset:0 lds
buffer_load_dwordx4 v251, s[12:15], s39 offen offset:1024 lds
buffer_load_dwordx4 v251, s[12:15], s39 offen offset:2048 lds
buffer_load_dwordx4 v251, s[12:15], s39 offen offset:3072 lds
s_add_u32 m0, s30, 0x4000
s_nop 0
buffer_load_dwordx4 v251, s[12:15], s28 offen offset:0 lds
buffer_load_dwordx4 v251, s[12:15], s28 offen offset:1024 lds
s_add_u32 s8, s4, 0x0
s_addc_u32 s9, s5, 0
s_mov_b32 s10, 0x4e4000
s_mov_b32 s11, 0x00020000
s_mul_i32 s35, s37, 0x600000
s_add_u32 s20, s4, 0x2000000
s_addc_u32 s21, s5, 0
s_add_u32 s20, s20, s35
s_addc_u32 s21, s21, 0
s_mov_b32 s22, 0x4e4000
s_mov_b32 s23, 0x00020000
s_add_u32 s24, s4, 0x6000000
s_addc_u32 s25, s5, 0
s_mov_b32 s26, 0x9c800
s_mov_b32 s27, 0x00020000
s_lshl_b32 s35, s38, 4
s_lshl_b32 s41, s34, 2
s_add_u32 s35, s35, s41
s_lshl_b32 s40, s35, 13
s_lshl_b32 s48, s35, 10
s_lshl_b32 s35, s37, 3
s_add_u32 s48, s48, s35
s_add_u32 s41, s40, 8192
s_add_u32 s42, s40, 16384
s_add_u32 s43, s40, 24576
s_add_u32 s44, s40, 4096
s_add_u32 s45, s41, 4096
s_add_u32 s46, s42, 4096
s_add_u32 s47, s43, 4096
s_mov_b32 s52, 0x71800000
s_mov_b32 s53, 0x0d800000
v_mov_b32 v208, 0
v_mov_b32 v209, 0
v_mov_b32 v210, 0
v_mov_b32 v211, 0
buffer_load_dwordx4 v[0:3], v252, s[8:11], s40 offen offset:0
buffer_load_dwordx4 v[32:35], v252, s[8:11], s41 offen offset:0
v_mfma_f32_32x32x16_bf16 a[0:15], v[208:211], v[208:211], 0
buffer_load_dwordx4 v[64:67], v252, s[8:11], s42 offen offset:0
buffer_load_dwordx4 v[96:99], v252, s[8:11], s43 offen offset:0
v_mfma_f32_32x32x16_bf16 a[16:31], v[208:211], v[208:211], 0
buffer_load_dwordx4 v[4:7], v252, s[8:11], s40 offen offset:1024
buffer_load_dwordx4 v[36:39], v252, s[8:11], s41 offen offset:1024
v_mfma_f32_32x32x16_bf16 a[32:47], v[208:211], v[208:211], 0
buffer_load_dwordx4 v[68:71], v252, s[8:11], s42 offen offset:1024
buffer_load_dwordx4 v[100:103], v252, s[8:11], s43 offen offset:1024
v_mfma_f32_32x32x16_bf16 a[48:63], v[208:211], v[208:211], 0
buffer_load_dwordx4 v[8:11], v252, s[8:11], s40 offen offset:2048
buffer_load_dwordx4 v[40:43], v252, s[8:11], s41 offen offset:2048
v_mfma_f32_32x32x16_bf16 a[64:79], v[208:211], v[208:211], 0
buffer_load_dwordx4 v[72:75], v252, s[8:11], s42 offen offset:2048
buffer_load_dwordx4 v[104:107], v252, s[8:11], s43 offen offset:2048
v_mfma_f32_32x32x16_bf16 a[80:95], v[208:211], v[208:211], 0
buffer_load_dwordx4 v[12:15], v252, s[8:11], s40 offen offset:3072
buffer_load_dwordx4 v[44:47], v252, s[8:11], s41 offen offset:3072
v_mfma_f32_32x32x16_bf16 a[96:111], v[208:211], v[208:211], 0
buffer_load_dwordx4 v[76:79], v252, s[8:11], s42 offen offset:3072
buffer_load_dwordx4 v[108:111], v252, s[8:11], s43 offen offset:3072
v_mfma_f32_32x32x16_bf16 a[112:127], v[208:211], v[208:211], 0
buffer_load_dwordx4 v[16:19], v252, s[8:11], s44 offen offset:0
buffer_load_dwordx4 v[48:51], v252, s[8:11], s45 offen offset:0
v_mfma_f32_32x32x16_bf16 a[128:143], v[208:211], v[208:211], 0
buffer_load_dwordx4 v[80:83], v252, s[8:11], s46 offen offset:0
buffer_load_dwordx4 v[112:115], v252, s[8:11], s47 offen offset:0
v_mfma_f32_32x32x16_bf16 a[144:159], v[208:211], v[208:211], 0
buffer_load_dwordx4 v[20:23], v252, s[8:11], s44 offen offset:1024
buffer_load_dwordx4 v[52:55], v252, s[8:11], s45 offen offset:1024
v_mfma_f32_32x32x16_bf16 a[160:175], v[208:211], v[208:211], 0
buffer_load_dwordx4 v[84:87], v252, s[8:11], s46 offen offset:1024
buffer_load_dwordx4 v[116:119], v252, s[8:11], s47 offen offset:1024
v_mfma_f32_32x32x16_bf16 a[176:191], v[208:211], v[208:211], 0
buffer_load_dwordx4 v[24:27], v252, s[8:11], s44 offen offset:2048
buffer_load_dwordx4 v[56:59], v252, s[8:11], s45 offen offset:2048
v_mfma_f32_32x32x16_bf16 a[192:207], v[208:211], v[208:211], 0
buffer_load_dwordx4 v[88:91], v252, s[8:11], s46 offen offset:2048
buffer_load_dwordx4 v[120:123], v252, s[8:11], s47 offen offset:2048
v_mfma_f32_32x32x16_bf16 a[208:223], v[208:211], v[208:211], 0
buffer_load_dwordx4 v[28:31], v252, s[8:11], s44 offen offset:3072
buffer_load_dwordx4 v[60:63], v252, s[8:11], s45 offen offset:3072
v_mfma_f32_32x32x16_bf16 a[224:239], v[208:211], v[208:211], 0
buffer_load_dwordx4 v[92:95], v252, s[8:11], s46 offen offset:3072
buffer_load_dwordx4 v[124:127], v252, s[8:11], s47 offen offset:3072
v_mfma_f32_32x32x16_bf16 a[240:255], v[208:211], v[208:211], 0
v_bfe_u32 v248, v252, 4, 3
v_lshlrev_b32 v248, 6, v248
v_bfe_u32 v253, v252, 7, 1
v_lshl_or_b32 v248, v253, 10, v248
v_bfe_u32 v253, v252, 8, 2
v_lshl_or_b32 v248, v253, 4, v248
v_bfe_u32 v253, v252, 6, 1
v_lshlrev_b32 v253, 5, v253
v_xor_b32 v248, v248, v253
v_and_b32 v249, 0x1c0, v252
v_bfe_u32 v253, v252, 9, 1
v_lshl_or_b32 v249, v253, 10, v249
v_bfe_u32 v253, v252, 8, 1
v_lshl_or_b32 v249, v253, 5, v249
v_bfe_u32 v253, v252, 4, 2
v_lshl_or_b32 v249, v253, 3, v249
v_xor_b32 v250, 32, v249
s_waitcnt vmcnt(32)
s_barrier
ds_read_b128 v[224:227], v248 offset:0
ds_read_b128 v[228:231], v248 offset:512
ds_read_b128 v[232:235], v248 offset:2048
ds_read_b128 v[236:239], v248 offset:2560
s_waitcnt lgkmcnt(2)
s_waitcnt vmcnt(24)
v_mfma_f32_16x16x32_bf16 v[160:163], v[224:227], v[0:3], 0
ds_read_b128 v[240:243], v248 offset:16384
v_mfma_f32_16x16x32_bf16 v[160:163], v[228:231], v[4:7], v[160:163]
buffer_load_dwordx4 v251, s[12:15], s28 offen offset:2048 lds
v_mfma_f32_16x16x32_bf16 v[164:167], v[224:227], v[32:35], 0
v_mfma_f32_16x16x32_bf16 v[164:167], v[228:231], v[36:39], v[164:167]
buffer_load_dwordx4 v251, s[12:15], s28 offen offset:3072 lds
v_mfma_f32_16x16x32_bf16 v[168:171], v[224:227], v[64:67], 0
ds_read_b128 v[244:247], v248 offset:16896
v_mfma_f32_16x16x32_bf16 v[168:171], v[228:231], v[68:71], v[168:171]
s_add_u32 s28, s28, 0x4000
s_add_u32 m0, s30, 0x8000
s_nop 0
v_mfma_f32_16x16x32_bf16 v[172:175], v[224:227], v[96:99], 0
v_mfma_f32_16x16x32_bf16 v[172:175], v[228:231], v[100:103], v[172:175]
s_waitcnt lgkmcnt(2)
buffer_load_dwordx4 v251, s[12:15], s28 offen offset:0 lds
v_mfma_f32_16x16x32_bf16 v[176:179], v[232:235], v[0:3], 0
ds_read_b128 v[224:227], v248 offset:4096
v_mfma_f32_16x16x32_bf16 v[176:179], v[236:239], v[4:7], v[176:179]
buffer_load_dwordx4 v251, s[12:15], s28 offen offset:1024 lds
v_mfma_f32_16x16x32_bf16 v[180:183], v[232:235], v[32:35], 0
v_mfma_f32_16x16x32_bf16 v[180:183], v[236:239], v[36:39], v[180:183]
v_mfma_f32_16x16x32_bf16 v[184:187], v[232:235], v[64:67], 0
ds_read_b128 v[228:231], v248 offset:4608
v_mfma_f32_16x16x32_bf16 v[184:187], v[236:239], v[68:71], v[184:187]
v_mfma_f32_16x16x32_bf16 v[188:191], v[232:235], v[96:99], 0
v_mfma_f32_16x16x32_bf16 v[188:191], v[236:239], v[100:103], v[188:191]
s_waitcnt lgkmcnt(2)
v_mfma_f32_16x16x32_bf16 v[192:195], v[240:243], v[0:3], 0
ds_read_b128 v[232:235], v248 offset:6144
v_mfma_f32_16x16x32_bf16 v[192:195], v[244:247], v[4:7], v[192:195]
v_mfma_f32_16x16x32_bf16 v[196:199], v[240:243], v[32:35], 0
v_mfma_f32_16x16x32_bf16 v[196:199], v[244:247], v[36:39], v[196:199]
v_mfma_f32_16x16x32_bf16 v[200:203], v[240:243], v[64:67], 0
ds_read_b128 v[236:239], v248 offset:6656
v_mfma_f32_16x16x32_bf16 v[200:203], v[244:247], v[68:71], v[200:203]
v_mfma_f32_16x16x32_bf16 v[204:207], v[240:243], v[96:99], 0
v_mfma_f32_16x16x32_bf16 v[204:207], v[244:247], v[100:103], v[204:207]
s_waitcnt lgkmcnt(2)
s_waitcnt vmcnt(20)
v_mfma_f32_16x16x32_bf16 v[160:163], v[224:227], v[8:11], v[160:163]
ds_read_b128 v[240:243], v248 offset:20480
v_mfma_f32_16x16x32_bf16 v[160:163], v[228:231], v[12:15], v[160:163]
buffer_load_dwordx4 v251, s[12:15], s28 offen offset:2048 lds
v_mfma_f32_16x16x32_bf16 v[164:167], v[224:227], v[40:43], v[164:167]
v_mfma_f32_16x16x32_bf16 v[164:167], v[228:231], v[44:47], v[164:167]
buffer_load_dwordx4 v251, s[12:15], s28 offen offset:3072 lds
v_mfma_f32_16x16x32_bf16 v[168:171], v[224:227], v[72:75], v[168:171]
ds_read_b128 v[244:247], v248 offset:20992
v_mfma_f32_16x16x32_bf16 v[168:171], v[228:231], v[76:79], v[168:171]
s_add_u32 s28, s28, 0x4000
s_add_u32 m0, s30, 0xc000
s_nop 0
v_mfma_f32_16x16x32_bf16 v[172:175], v[224:227], v[104:107], v[172:175]
v_mfma_f32_16x16x32_bf16 v[172:175], v[228:231], v[108:111], v[172:175]
s_waitcnt lgkmcnt(2)
buffer_load_dwordx4 v251, s[12:15], s28 offen offset:0 lds
v_mfma_f32_16x16x32_bf16 v[176:179], v[232:235], v[8:11], v[176:179]
ds_read_b128 v[224:227], v248 offset:8192
v_mfma_f32_16x16x32_bf16 v[176:179], v[236:239], v[12:15], v[176:179]
buffer_load_dwordx4 v251, s[12:15], s28 offen offset:1024 lds
v_mfma_f32_16x16x32_bf16 v[180:183], v[232:235], v[40:43], v[180:183]
v_mfma_f32_16x16x32_bf16 v[180:183], v[236:239], v[44:47], v[180:183]
v_mfma_f32_16x16x32_bf16 v[184:187], v[232:235], v[72:75], v[184:187]
ds_read_b128 v[228:231], v248 offset:8704
v_mfma_f32_16x16x32_bf16 v[184:187], v[236:239], v[76:79], v[184:187]
v_mfma_f32_16x16x32_bf16 v[188:191], v[232:235], v[104:107], v[188:191]
v_mfma_f32_16x16x32_bf16 v[188:191], v[236:239], v[108:111], v[188:191]
s_waitcnt lgkmcnt(2)
v_mfma_f32_16x16x32_bf16 v[192:195], v[240:243], v[8:11], v[192:195]
ds_read_b128 v[232:235], v248 offset:10240
v_mfma_f32_16x16x32_bf16 v[192:195], v[244:247], v[12:15], v[192:195]
v_mfma_f32_16x16x32_bf16 v[196:199], v[240:243], v[40:43], v[196:199]
v_mfma_f32_16x16x32_bf16 v[196:199], v[244:247], v[44:47], v[196:199]
v_mfma_f32_16x16x32_bf16 v[200:203], v[240:243], v[72:75], v[200:203]
ds_read_b128 v[236:239], v248 offset:10752
v_mfma_f32_16x16x32_bf16 v[200:203], v[244:247], v[76:79], v[200:203]
v_mfma_f32_16x16x32_bf16 v[204:207], v[240:243], v[104:107], v[204:207]
v_mfma_f32_16x16x32_bf16 v[204:207], v[244:247], v[108:111], v[204:207]
s_waitcnt lgkmcnt(2)
s_waitcnt vmcnt(16)
v_mfma_f32_16x16x32_bf16 v[160:163], v[224:227], v[16:19], v[160:163]
ds_read_b128 v[240:243], v248 offset:24576
v_mfma_f32_16x16x32_bf16 v[160:163], v[228:231], v[20:23], v[160:163]
buffer_load_dwordx4 v251, s[12:15], s28 offen offset:2048 lds
v_mfma_f32_16x16x32_bf16 v[164:167], v[224:227], v[48:51], v[164:167]
v_mfma_f32_16x16x32_bf16 v[164:167], v[228:231], v[52:55], v[164:167]
buffer_load_dwordx4 v251, s[12:15], s28 offen offset:3072 lds
v_mfma_f32_16x16x32_bf16 v[168:171], v[224:227], v[80:83], v[168:171]
ds_read_b128 v[244:247], v248 offset:25088
v_mfma_f32_16x16x32_bf16 v[168:171], v[228:231], v[84:87], v[168:171]
s_add_u32 s28, s28, 0x4000
s_add_u32 m0, s30, 0x10000
s_nop 0
v_mfma_f32_16x16x32_bf16 v[172:175], v[224:227], v[112:115], v[172:175]
v_mfma_f32_16x16x32_bf16 v[172:175], v[228:231], v[116:119], v[172:175]
s_waitcnt lgkmcnt(2)
buffer_load_dwordx4 v251, s[12:15], s28 offen offset:0 lds
v_mfma_f32_16x16x32_bf16 v[176:179], v[232:235], v[16:19], v[176:179]
ds_read_b128 v[224:227], v248 offset:12288
v_mfma_f32_16x16x32_bf16 v[176:179], v[236:239], v[20:23], v[176:179]
buffer_load_dwordx4 v251, s[12:15], s28 offen offset:1024 lds
v_mfma_f32_16x16x32_bf16 v[180:183], v[232:235], v[48:51], v[180:183]
v_mfma_f32_16x16x32_bf16 v[180:183], v[236:239], v[52:55], v[180:183]
v_mfma_f32_16x16x32_bf16 v[184:187], v[232:235], v[80:83], v[184:187]
ds_read_b128 v[228:231], v248 offset:12800
v_mfma_f32_16x16x32_bf16 v[184:187], v[236:239], v[84:87], v[184:187]
v_mfma_f32_16x16x32_bf16 v[188:191], v[232:235], v[112:115], v[188:191]
v_mfma_f32_16x16x32_bf16 v[188:191], v[236:239], v[116:119], v[188:191]
s_waitcnt lgkmcnt(2)
v_mfma_f32_16x16x32_bf16 v[192:195], v[240:243], v[16:19], v[192:195]
ds_read_b128 v[232:235], v248 offset:14336
v_mfma_f32_16x16x32_bf16 v[192:195], v[244:247], v[20:23], v[192:195]
v_mfma_f32_16x16x32_bf16 v[196:199], v[240:243], v[48:51], v[196:199]
v_mfma_f32_16x16x32_bf16 v[196:199], v[244:247], v[52:55], v[196:199]
v_mfma_f32_16x16x32_bf16 v[200:203], v[240:243], v[80:83], v[200:203]
ds_read_b128 v[236:239], v248 offset:14848
v_mfma_f32_16x16x32_bf16 v[200:203], v[244:247], v[84:87], v[200:203]
v_mfma_f32_16x16x32_bf16 v[204:207], v[240:243], v[112:115], v[204:207]
v_mfma_f32_16x16x32_bf16 v[204:207], v[244:247], v[116:119], v[204:207]
s_waitcnt lgkmcnt(2)
s_waitcnt vmcnt(12)
v_mfma_f32_16x16x32_bf16 v[160:163], v[224:227], v[24:27], v[160:163]
ds_read_b128 v[240:243], v248 offset:28672
v_mfma_f32_16x16x32_bf16 v[160:163], v[228:231], v[28:31], v[160:163]
buffer_load_dwordx4 v251, s[12:15], s28 offen offset:2048 lds
v_mfma_f32_16x16x32_bf16 v[164:167], v[224:227], v[56:59], v[164:167]
v_mfma_f32_16x16x32_bf16 v[164:167], v[228:231], v[60:63], v[164:167]
buffer_load_dwordx4 v251, s[12:15], s28 offen offset:3072 lds
v_mfma_f32_16x16x32_bf16 v[168:171], v[224:227], v[88:91], v[168:171]
ds_read_b128 v[244:247], v248 offset:29184
v_mfma_f32_16x16x32_bf16 v[168:171], v[228:231], v[92:95], v[168:171]
s_add_u32 s28, s28, 0x4000
s_xor_b32 s30, s30, 0x10000
v_mfma_f32_16x16x32_bf16 v[172:175], v[224:227], v[120:123], v[172:175]
v_mfma_f32_16x16x32_bf16 v[172:175], v[228:231], v[124:127], v[172:175]
s_waitcnt lgkmcnt(2)
v_mfma_f32_16x16x32_bf16 v[176:179], v[232:235], v[24:27], v[176:179]
v_mfma_f32_16x16x32_bf16 v[176:179], v[236:239], v[28:31], v[176:179]
v_mfma_f32_16x16x32_bf16 v[180:183], v[232:235], v[56:59], v[180:183]
v_mfma_f32_16x16x32_bf16 v[180:183], v[236:239], v[60:63], v[180:183]
v_mfma_f32_16x16x32_bf16 v[184:187], v[232:235], v[88:91], v[184:187]
v_mfma_f32_16x16x32_bf16 v[184:187], v[236:239], v[92:95], v[184:187]
v_mfma_f32_16x16x32_bf16 v[188:191], v[232:235], v[120:123], v[188:191]
v_mfma_f32_16x16x32_bf16 v[188:191], v[236:239], v[124:127], v[188:191]
s_waitcnt lgkmcnt(0)
v_mfma_f32_16x16x32_bf16 v[192:195], v[240:243], v[24:27], v[192:195]
v_mfma_f32_16x16x32_bf16 v[192:195], v[244:247], v[28:31], v[192:195]
v_mfma_f32_16x16x32_bf16 v[196:199], v[240:243], v[56:59], v[196:199]
v_mfma_f32_16x16x32_bf16 v[196:199], v[244:247], v[60:63], v[196:199]
v_mfma_f32_16x16x32_bf16 v[200:203], v[240:243], v[88:91], v[200:203]
v_mfma_f32_16x16x32_bf16 v[200:203], v[244:247], v[92:95], v[200:203]
v_mfma_f32_16x16x32_bf16 v[204:207], v[240:243], v[120:123], v[204:207]
v_mfma_f32_16x16x32_bf16 v[204:207], v[244:247], v[124:127], v[204:207]
s_nop 3
v_max3_f32 v224, v160, v161, v162
v_max3_f32 v225, v164, v165, v166
v_max3_f32 v226, v168, v169, v170
v_max3_f32 v227, v172, v173, v174
v_max3_f32 v224, v224, v163, v176
v_max3_f32 v225, v225, v167, v180
v_max3_f32 v226, v226, v171, v184
v_max3_f32 v227, v227, v175, v188
v_max3_f32 v224, v224, v177, v178
v_max3_f32 v225, v225, v181, v182
v_max3_f32 v226, v226, v185, v186
v_max3_f32 v227, v227, v189, v190
v_max_f32 v224, v224, v179
v_max_f32 v225, v225, v183
v_max_f32 v226, v226, v187
v_max_f32 v227, v227, v191
v_mov_b32 v228, v224
v_mov_b32 v229, v225
v_mov_b32 v230, v226
v_mov_b32 v231, v227
v_permlane32_swap_b32 v224, v228
v_permlane32_swap_b32 v225, v229
v_permlane32_swap_b32 v226, v230
v_permlane32_swap_b32 v227, v231
v_max_f32 v224, v224, v228
v_max_f32 v225, v225, v229
v_max_f32 v226, v226, v230
v_max_f32 v227, v227, v231
v_mov_b32 v228, v224
v_mov_b32 v229, v225
v_mov_b32 v230, v226
v_mov_b32 v231, v227
v_permlane16_swap_b32 v224, v228
v_permlane16_swap_b32 v225, v229
v_permlane16_swap_b32 v226, v230
v_permlane16_swap_b32 v227, v231
v_max_f32 v224, v224, v228
v_max_f32 v225, v225, v229
v_max_f32 v226, v226, v230
v_max_f32 v227, v227, v231
s_waitcnt vmcnt(8)
s_barrier
ds_read_b128 v[232:235], v248 offset:18432
ds_read_b128 v[236:239], v248 offset:18944
ds_read_b128 v[240:243], v248 offset:22528
ds_read_b128 v[244:247], v248 offset:23040
v_cvt_pk_bf16_f32 v228, -v224, -v224
v_cvt_pk_bf16_f32 v229, -v225, -v225
v_cvt_pk_bf16_f32 v230, -v226, -v226
v_cvt_pk_bf16_f32 v231, -v227, -v227
v_lshlrev_b32 v253, 2, v252
v_lshlrev_b32 v147, 16, v228
v_lshlrev_b32 v151, 16, v229
v_lshlrev_b32 v155, 16, v230
v_lshlrev_b32 v159, 16, v231
s_mov_b64 exec, 0xffff
v_bfi_b32 v0, s32, v228, v0
v_bfi_b32 v32, s32, v229, v32
v_bfi_b32 v64, s32, v230, v64
v_bfi_b32 v96, s32, v231, v96
v_xor_b32 v224, 0x80000000, v147
v_xor_b32 v225, 0x80000000, v151
v_xor_b32 v226, 0x80000000, v155
v_xor_b32 v227, 0x80000000, v159
buffer_store_dword v224, v253, s[24:27], s48 offen offset:0 sc1
buffer_store_dword v225, v253, s[24:27], s48 offen offset:1024 sc1
buffer_store_dword v226, v253, s[24:27], s48 offen offset:2048 sc1
buffer_store_dword v227, v253, s[24:27], s48 offen offset:3072 sc1
s_mov_b64 exec, -1
s_waitcnt lgkmcnt(2)
v_mfma_f32_16x16x32_bf16 v[208:211], v[232:235], v[0:3], 0
ds_read_b128 v[224:227], v248 offset:26624
v_add_f32 v192, v192, v147
v_add_f32 v193, v193, v147
v_add_f32 v194, v194, v147
v_mfma_f32_16x16x32_bf16 v[208:211], v[236:239], v[4:7], v[208:211]
v_add_f32 v195, v195, v147
v_exp_f32 v192, v192
v_mfma_f32_16x16x32_bf16 v[212:215], v[232:235], v[32:35], 0
v_exp_f32 v193, v193
v_exp_f32 v194, v194
v_mfma_f32_16x16x32_bf16 v[212:215], v[236:239], v[36:39], v[212:215]
v_exp_f32 v195, v195
v_add_f32 v196, v196, v151
v_add_f32 v197, v197, v151
v_mfma_f32_16x16x32_bf16 v[216:219], v[232:235], v[64:67], 0
ds_read_b128 v[228:231], v248 offset:27136
v_cvt_pk_bf16_f32 v144, v192, v193
v_cvt_pk_bf16_f32 v145, v194, v195
v_add_f32 v198, v198, v151
v_mfma_f32_16x16x32_bf16 v[216:219], v[236:239], v[68:71], v[216:219]
v_add_f32 v199, v199, v151
v_exp_f32 v196, v196
v_mfma_f32_16x16x32_bf16 v[220:223], v[232:235], v[96:99], 0
v_exp_f32 v197, v197
v_exp_f32 v198, v198
v_mfma_f32_16x16x32_bf16 v[220:223], v[236:239], v[100:103], v[220:223]
s_waitcnt lgkmcnt(2)
v_exp_f32 v199, v199
v_cvt_pk_bf16_f32 v148, v196, v197
v_mfma_f32_16x16x32_bf16 v[208:211], v[240:243], v[8:11], v[208:211]
ds_read_b128 v[232:235], v248 offset:30720
v_cvt_pk_bf16_f32 v149, v198, v199
v_add_f32 v200, v200, v155
v_add_f32 v201, v201, v155
v_mfma_f32_16x16x32_bf16 v[208:211], v[244:247], v[12:15], v[208:211]
v_add_f32 v202, v202, v155
v_add_f32 v203, v203, v155
v_exp_f32 v200, v200
v_mfma_f32_16x16x32_bf16 v[212:215], v[240:243], v[40:43], v[212:215]
v_exp_f32 v201, v201
v_exp_f32 v202, v202
v_mfma_f32_16x16x32_bf16 v[212:215], v[244:247], v[44:47], v[212:215]
v_exp_f32 v203, v203
v_add_f32 v204, v204, v159
v_add_f32 v205, v205, v159
v_mfma_f32_16x16x32_bf16 v[216:219], v[240:243], v[72:75], v[216:219]
ds_read_b128 v[236:239], v248 offset:31232
v_cvt_pk_bf16_f32 v152, v200, v201
v_cvt_pk_bf16_f32 v153, v202, v203
v_add_f32 v206, v206, v159
v_mfma_f32_16x16x32_bf16 v[216:219], v[244:247], v[76:79], v[216:219]
v_add_f32 v207, v207, v159
v_exp_f32 v204, v204
v_mfma_f32_16x16x32_bf16 v[220:223], v[240:243], v[104:107], v[220:223]
v_exp_f32 v205, v205
v_exp_f32 v206, v206
v_mfma_f32_16x16x32_bf16 v[220:223], v[244:247], v[108:111], v[220:223]
s_waitcnt lgkmcnt(2)
v_exp_f32 v207, v207
v_cvt_pk_bf16_f32 v156, v204, v205
v_mfma_f32_16x16x32_bf16 v[208:211], v[224:227], v[16:19], v[208:211]
ds_read_b128 v[240:243], v248 offset:32768
v_cvt_pk_bf16_f32 v157, v206, v207
v_add_f32 v160, v160, v147
v_add_f32 v161, v161, v147
v_mfma_f32_16x16x32_bf16 v[208:211], v[228:231], v[20:23], v[208:211]
v_add_f32 v162, v162, v147
v_add_f32 v163, v163, v147
v_exp_f32 v160, v160
v_mfma_f32_16x16x32_bf16 v[212:215], v[224:227], v[48:51], v[212:215]
v_exp_f32 v161, v161
v_exp_f32 v162, v162
v_mfma_f32_16x16x32_bf16 v[212:215], v[228:231], v[52:55], v[212:215]
v_exp_f32 v163, v163
v_add_f32 v164, v164, v151
v_add_f32 v165, v165, v151
v_mfma_f32_16x16x32_bf16 v[216:219], v[224:227], v[80:83], v[216:219]
ds_read_b128 v[244:247], v248 offset:33280
v_cvt_pk_bf16_f32 v128, v160, v161
v_cvt_pk_bf16_f32 v129, v162, v163
v_add_f32 v166, v166, v151
v_mfma_f32_16x16x32_bf16 v[216:219], v[228:231], v[84:87], v[216:219]
v_add_f32 v167, v167, v151
v_exp_f32 v164, v164
v_mfma_f32_16x16x32_bf16 v[220:223], v[224:227], v[112:115], v[220:223]
v_exp_f32 v165, v165
v_exp_f32 v166, v166
v_mfma_f32_16x16x32_bf16 v[220:223], v[228:231], v[116:119], v[220:223]
s_waitcnt lgkmcnt(2)
v_exp_f32 v167, v167
v_cvt_pk_bf16_f32 v132, v164, v165
v_mfma_f32_16x16x32_bf16 v[208:211], v[232:235], v[24:27], v[208:211]
ds_read_b128 v[224:227], v248 offset:36864
v_cvt_pk_bf16_f32 v133, v166, v167
v_add_f32 v168, v168, v155
v_add_f32 v169, v169, v155
v_mfma_f32_16x16x32_bf16 v[208:211], v[236:239], v[28:31], v[208:211]
v_add_f32 v170, v170, v155
v_add_f32 v171, v171, v155
v_exp_f32 v168, v168
v_mfma_f32_16x16x32_bf16 v[212:215], v[232:235], v[56:59], v[212:215]
v_exp_f32 v169, v169
v_exp_f32 v170, v170
v_mfma_f32_16x16x32_bf16 v[212:215], v[236:239], v[60:63], v[212:215]
v_exp_f32 v171, v171
v_add_f32 v172, v172, v159
v_add_f32 v173, v173, v159
v_mfma_f32_16x16x32_bf16 v[216:219], v[232:235], v[88:91], v[216:219]
ds_read_b128 v[228:231], v248 offset:37376
v_cvt_pk_bf16_f32 v136, v168, v169
v_cvt_pk_bf16_f32 v137, v170, v171
v_add_f32 v174, v174, v159
v_mfma_f32_16x16x32_bf16 v[216:219], v[236:239], v[92:95], v[216:219]
v_add_f32 v175, v175, v159
v_exp_f32 v172, v172
v_mfma_f32_16x16x32_bf16 v[220:223], v[232:235], v[120:123], v[220:223]
v_exp_f32 v173, v173
v_exp_f32 v174, v174
v_mfma_f32_16x16x32_bf16 v[220:223], v[236:239], v[124:127], v[220:223]
s_waitcnt lgkmcnt(2)
v_exp_f32 v175, v175
v_cvt_pk_bf16_f32 v140, v172, v173
v_mfma_f32_16x16x32_bf16 v[192:195], v[240:243], v[0:3], 0
ds_read_b128 v[232:235], v248 offset:40960
v_cvt_pk_bf16_f32 v141, v174, v175
v_add_f32 v176, v176, v147
v_add_f32 v177, v177, v147
v_mfma_f32_16x16x32_bf16 v[192:195], v[244:247], v[4:7], v[192:195]
v_add_f32 v178, v178, v147
v_add_f32 v179, v179, v147
v_exp_f32 v176, v176
v_mfma_f32_16x16x32_bf16 v[196:199], v[240:243], v[32:35], 0
v_exp_f32 v177, v177
v_exp_f32 v178, v178
v_mfma_f32_16x16x32_bf16 v[196:199], v[244:247], v[36:39], v[196:199]
v_exp_f32 v179, v179
v_add_f32 v180, v180, v151
v_add_f32 v181, v181, v151
v_mfma_f32_16x16x32_bf16 v[200:203], v[240:243], v[64:67], 0
ds_read_b128 v[236:239], v248 offset:41472
v_cvt_pk_bf16_f32 v130, v176, v177
v_cvt_pk_bf16_f32 v131, v178, v179
v_add_f32 v182, v182, v151
v_mfma_f32_16x16x32_bf16 v[200:203], v[244:247], v[68:71], v[200:203]
v_add_f32 v183, v183, v151
v_exp_f32 v180, v180
v_mfma_f32_16x16x32_bf16 v[204:207], v[240:243], v[96:99], 0
v_exp_f32 v181, v181
v_exp_f32 v182, v182
v_mfma_f32_16x16x32_bf16 v[204:207], v[244:247], v[100:103], v[204:207]
s_waitcnt lgkmcnt(2)
v_exp_f32 v183, v183
v_cvt_pk_bf16_f32 v134, v180, v181
v_mfma_f32_16x16x32_bf16 v[192:195], v[224:227], v[8:11], v[192:195]
ds_read_b128 v[240:243], v248 offset:45056
v_cvt_pk_bf16_f32 v135, v182, v183
v_add_f32 v184, v184, v155
v_add_f32 v185, v185, v155
v_mfma_f32_16x16x32_bf16 v[192:195], v[228:231], v[12:15], v[192:195]
v_add_f32 v186, v186, v155
v_add_f32 v187, v187, v155
v_exp_f32 v184, v184
v_mfma_f32_16x16x32_bf16 v[196:199], v[224:227], v[40:43], v[196:199]
v_exp_f32 v185, v185
v_exp_f32 v186, v186
v_mfma_f32_16x16x32_bf16 v[196:199], v[228:231], v[44:47], v[196:199]
v_exp_f32 v187, v187
v_add_f32 v188, v188, v159
v_add_f32 v189, v189, v159
v_mfma_f32_16x16x32_bf16 v[200:203], v[224:227], v[72:75], v[200:203]
ds_read_b128 v[244:247], v248 offset:45568
v_cvt_pk_bf16_f32 v138, v184, v185
v_cvt_pk_bf16_f32 v139, v186, v187
v_add_f32 v190, v190, v159
v_mfma_f32_16x16x32_bf16 v[200:203], v[228:231], v[76:79], v[200:203]
v_add_f32 v191, v191, v159
v_exp_f32 v188, v188
v_mfma_f32_16x16x32_bf16 v[204:207], v[224:227], v[104:107], v[204:207]
v_exp_f32 v189, v189
v_exp_f32 v190, v190
v_mfma_f32_16x16x32_bf16 v[204:207], v[228:231], v[108:111], v[204:207]
s_waitcnt lgkmcnt(2)
v_exp_f32 v191, v191
v_cvt_pk_bf16_f32 v142, v188, v189
v_mfma_f32_16x16x32_bf16 v[192:195], v[232:235], v[16:19], v[192:195]
ds_read_b64_tr_b16 v[224:225], v249 offset:0
v_cvt_pk_bf16_f32 v143, v190, v191
v_exp_f32 v208, v208
v_mfma_f32_16x16x32_bf16 v[192:195], v[236:239], v[20:23], v[192:195]
v_exp_f32 v209, v209
v_exp_f32 v210, v210
v_mfma_f32_16x16x32_bf16 v[196:199], v[232:235], v[48:51], v[196:199]
ds_read_b64_tr_b16 v[226:227], v249 offset:2048
v_exp_f32 v211, v211
v_cvt_pk_bf16_f32 v146, v208, v209
v_mfma_f32_16x16x32_bf16 v[196:199], v[236:239], v[52:55], v[196:199]
v_cvt_pk_bf16_f32 v147, v210, v211
v_exp_f32 v212, v212
v_mfma_f32_16x16x32_bf16 v[200:203], v[232:235], v[80:83], v[200:203]
ds_read_b64_tr_b16 v[228:229], v249 offset:16384
v_exp_f32 v213, v213
v_mfma_f32_16x16x32_bf16 v[200:203], v[236:239], v[84:87], v[200:203]
v_exp_f32 v214, v214
v_exp_f32 v215, v215
v_mfma_f32_16x16x32_bf16 v[204:207], v[232:235], v[112:115], v[204:207]
ds_read_b64_tr_b16 v[230:231], v249 offset:18432
v_cvt_pk_bf16_f32 v150, v212, v213
v_cvt_pk_bf16_f32 v151, v214, v215
v_mfma_f32_16x16x32_bf16 v[204:207], v[236:239], v[116:119], v[204:207]
s_waitcnt lgkmcnt(4)
v_exp_f32 v216, v216
v_mfma_f32_16x16x32_bf16 v[192:195], v[240:243], v[24:27], v[192:195]
ds_read_b64_tr_b16 v[232:233], v250 offset:0
v_exp_f32 v217, v217
v_mfma_f32_16x16x32_bf16 v[192:195], v[244:247], v[28:31], v[192:195]
v_exp_f32 v218, v218
v_exp_f32 v219, v219
v_mfma_f32_16x16x32_bf16 v[196:199], v[240:243], v[56:59], v[196:199]
ds_read_b64_tr_b16 v[234:235], v250 offset:2048
v_cvt_pk_bf16_f32 v154, v216, v217
v_cvt_pk_bf16_f32 v155, v218, v219
v_mfma_f32_16x16x32_bf16 v[196:199], v[244:247], v[60:63], v[196:199]
v_exp_f32 v220, v220
v_exp_f32 v221, v221
v_mfma_f32_16x16x32_bf16 v[200:203], v[240:243], v[88:91], v[200:203]
ds_read_b64_tr_b16 v[236:237], v250 offset:16384
v_exp_f32 v222, v222
v_cvt_pk_bf16_f32 v158, v220, v221
v_mfma_f32_16x16x32_bf16 v[200:203], v[244:247], v[92:95], v[200:203]
v_exp_f32 v223, v223
v_mfma_f32_16x16x32_bf16 v[204:207], v[240:243], v[120:123], v[204:207]
ds_read_b64_tr_b16 v[238:239], v250 offset:18432
v_cvt_pk_bf16_f32 v159, v222, v223
v_mfma_f32_16x16x32_bf16 v[204:207], v[244:247], v[124:127], v[204:207]
.p2align 6
L2_loop:
s_waitcnt lgkmcnt(4)
v_mfma_f32_16x16x32_bf16 a[0:3], v[224:227], v[128:131], a[0:3]
ds_read_b64_tr_b16 v[240:241], v249 offset:512
v_mfma_f32_16x16x32_bf16 a[0:3], v[228:231], v[144:147], a[0:3]
v_mfma_f32_16x16x32_bf16 a[4:7], v[224:227], v[132:135], a[4:7]
ds_read_b64_tr_b16 v[242:243], v249 offset:2560
v_mfma_f32_16x16x32_bf16 a[4:7], v[228:231], v[148:151], a[4:7]
v_exp_f32 v192, v192
v_mfma_f32_16x16x32_bf16 a[8:11], v[224:227], v[136:139], a[8:11]
ds_read_b64_tr_b16 v[244:245], v249 offset:16896
v_mfma_f32_16x16x32_bf16 a[8:11], v[228:231], v[152:155], a[8:11]
v_exp_f32 v193, v193
v_mfma_f32_16x16x32_bf16 a[12:15], v[224:227], v[140:143], a[12:15]
ds_read_b64_tr_b16 v[246:247], v249 offset:18944
v_cvt_pk_bf16_f32 v160, v192, v193
v_mfma_f32_16x16x32_bf16 a[12:15], v[228:231], v[156:159], a[12:15]
s_waitcnt lgkmcnt(4)
v_mfma_f32_16x16x32_bf16 a[16:19], v[232:235], v[128:131], a[16:19]
ds_read_b64_tr_b16 v[176:177], v250 offset:512
v_mfma_f32_16x16x32_bf16 a[16:19], v[236:239], v[144:147], a[16:19]
v_exp_f32 v194, v194
v_mfma_f32_16x16x32_bf16 a[20:23], v[232:235], v[132:135], a[20:23]
ds_read_b64_tr_b16 v[178:179], v250 offset:2560
v_mfma_f32_16x16x32_bf16 a[20:23], v[236:239], v[148:151], a[20:23]
v_exp_f32 v195, v195
v_mfma_f32_16x16x32_bf16 a[24:27], v[232:235], v[136:139], a[24:27]
ds_read_b64_tr_b16 v[180:181], v250 offset:16896
v_cvt_pk_bf16_f32 v161, v194, v195
v_mfma_f32_16x16x32_bf16 a[24:27], v[236:239], v[152:155], a[24:27]
v_exp_f32 v196, v196
v_mfma_f32_16x16x32_bf16 a[28:31], v[232:235], v[140:143], a[28:31]
ds_read_b64_tr_b16 v[182:183], v250 offset:18944
v_mfma_f32_16x16x32_bf16 a[28:31], v[236:239], v[156:159], a[28:31]
s_waitcnt lgkmcnt(4)
v_mfma_f32_16x16x32_bf16 a[32:35], v[240:243], v[128:131], a[32:35]
ds_read_b128 v[224:227], v248 offset:34816
v_mfma_f32_16x16x32_bf16 a[32:35], v[244:247], v[144:147], a[32:35]
v_exp_f32 v197, v197
v_mfma_f32_16x16x32_bf16 a[36:39], v[240:243], v[132:135], a[36:39]
v_exp_f32 v198, v198
v_mfma_f32_16x16x32_bf16 a[36:39], v[244:247], v[148:151], a[36:39]
v_exp_f32 v199, v199
v_mfma_f32_16x16x32_bf16 a[40:43], v[240:243], v[136:139], a[40:43]
ds_read_b128 v[228:231], v248 offset:35328
v_cvt_pk_bf16_f32 v164, v196, v197
v_mfma_f32_16x16x32_bf16 a[40:43], v[244:247], v[152:155], a[40:43]
v_cvt_pk_bf16_f32 v165, v198, v199
v_mfma_f32_16x16x32_bf16 a[44:47], v[240:243], v[140:143], a[44:47]
v_exp_f32 v200, v200
v_mfma_f32_16x16x32_bf16 a[44:47], v[244:247], v[156:159], a[44:47]
s_waitcnt lgkmcnt(2)
v_mfma_f32_16x16x32_bf16 a[48:51], v[176:179], v[128:131], a[48:51]
ds_read_b128 v[232:235], v248 offset:38912
v_mfma_f32_16x16x32_bf16 a[48:51], v[180:183], v[144:147], a[48:51]
v_exp_f32 v201, v201
v_mfma_f32_16x16x32_bf16 a[52:55], v[176:179], v[132:135], a[52:55]
v_exp_f32 v202, v202
v_mfma_f32_16x16x32_bf16 a[52:55], v[180:183], v[148:151], a[52:55]
v_exp_f32 v203, v203
v_mfma_f32_16x16x32_bf16 a[56:59], v[176:179], v[136:139], a[56:59]
ds_read_b128 v[236:239], v248 offset:39424
v_cvt_pk_bf16_f32 v168, v200, v201
v_mfma_f32_16x16x32_bf16 a[56:59], v[180:183], v[152:155], a[56:59]
v_cvt_pk_bf16_f32 v169, v202, v203
v_mfma_f32_16x16x32_bf16 a[60:63], v[176:179], v[140:143], a[60:63]
v_exp_f32 v204, v204
v_mfma_f32_16x16x32_bf16 a[60:63], v[180:183], v[156:159], a[60:63]
s_waitcnt lgkmcnt(2)
v_mfma_f32_16x16x32_bf16 v[208:211], v[224:227], v[0:3], 0
ds_read_b128 v[240:243], v248 offset:43008
v_mfma_f32_16x16x32_bf16 v[208:211], v[228:231], v[4:7], v[208:211]
v_exp_f32 v205, v205
v_mfma_f32_16x16x32_bf16 v[212:215], v[224:227], v[32:35], 0
v_exp_f32 v206, v206
v_mfma_f32_16x16x32_bf16 v[212:215], v[228:231], v[36:39], v[212:215]
v_exp_f32 v207, v207
v_mfma_f32_16x16x32_bf16 v[216:219], v[224:227], v[64:67], 0
ds_read_b128 v[244:247], v248 offset:43520
v_cvt_pk_bf16_f32 v172, v204, v205
v_mfma_f32_16x16x32_bf16 v[216:219], v[228:231], v[68:71], v[216:219]
v_cvt_pk_bf16_f32 v173, v206, v207
v_mfma_f32_16x16x32_bf16 v[220:223], v[224:227], v[96:99], 0
v_mfma_f32_16x16x32_bf16 v[220:223], v[228:231], v[100:103], v[220:223]
s_waitcnt lgkmcnt(2)
v_mfma_f32_16x16x32_bf16 v[208:211], v[232:235], v[8:11], v[208:211]
ds_read_b128 v[176:179], v248 offset:47104
v_mfma_f32_16x16x32_bf16 v[208:211], v[236:239], v[12:15], v[208:211]
v_mfma_f32_16x16x32_bf16 v[212:215], v[232:235], v[40:43], v[212:215]
v_mfma_f32_16x16x32_bf16 v[212:215], v[236:239], v[44:47], v[212:215]
v_mfma_f32_16x16x32_bf16 v[216:219], v[232:235], v[72:75], v[216:219]
ds_read_b128 v[180:183], v248 offset:47616
v_mfma_f32_16x16x32_bf16 v[216:219], v[236:239], v[76:79], v[216:219]
v_mfma_f32_16x16x32_bf16 v[220:223], v[232:235], v[104:107], v[220:223]
v_mfma_f32_16x16x32_bf16 v[220:223], v[236:239], v[108:111], v[220:223]
s_waitcnt lgkmcnt(2)
v_mfma_f32_16x16x32_bf16 v[208:211], v[240:243], v[16:19], v[208:211]
ds_read_b64_tr_b16 v[224:225], v249 offset:4096
v_mfma_f32_16x16x32_bf16 v[208:211], v[244:247], v[20:23], v[208:211]
v_mfma_f32_16x16x32_bf16 v[212:215], v[240:243], v[48:51], v[212:215]
ds_read_b64_tr_b16 v[226:227], v249 offset:6144
v_mfma_f32_16x16x32_bf16 v[212:215], v[244:247], v[52:55], v[212:215]
v_mfma_f32_16x16x32_bf16 v[216:219], v[240:243], v[80:83], v[216:219]
ds_read_b64_tr_b16 v[228:229], v249 offset:20480
v_mfma_f32_16x16x32_bf16 v[216:219], v[244:247], v[84:87], v[216:219]
v_mfma_f32_16x16x32_bf16 v[220:223], v[240:243], v[112:115], v[220:223]
ds_read_b64_tr_b16 v[230:231], v249 offset:22528
v_mfma_f32_16x16x32_bf16 v[220:223], v[244:247], v[116:119], v[220:223]
s_waitcnt lgkmcnt(4)
v_mfma_f32_16x16x32_bf16 v[208:211], v[176:179], v[24:27], v[208:211]
ds_read_b64_tr_b16 v[232:233], v250 offset:4096
v_mfma_f32_16x16x32_bf16 v[208:211], v[180:183], v[28:31], v[208:211]
v_mfma_f32_16x16x32_bf16 v[212:215], v[176:179], v[56:59], v[212:215]
ds_read_b64_tr_b16 v[234:235], v250 offset:6144
v_mfma_f32_16x16x32_bf16 v[212:215], v[180:183], v[60:63], v[212:215]
v_mfma_f32_16x16x32_bf16 v[216:219], v[176:179], v[88:91], v[216:219]
ds_read_b64_tr_b16 v[236:237], v250 offset:20480
v_mfma_f32_16x16x32_bf16 v[216:219], v[180:183], v[92:95], v[216:219]
v_mfma_f32_16x16x32_bf16 v[220:223], v[176:179], v[120:123], v[220:223]
ds_read_b64_tr_b16 v[238:239], v250 offset:22528
v_mfma_f32_16x16x32_bf16 v[220:223], v[180:183], v[124:127], v[220:223]
s_waitcnt lgkmcnt(4)
v_mfma_f32_16x16x32_bf16 a[64:67], v[224:227], v[128:131], a[64:67]
ds_read_b64_tr_b16 v[240:241], v249 offset:4608
v_mfma_f32_16x16x32_bf16 a[64:67], v[228:231], v[144:147], a[64:67]
v_mfma_f32_16x16x32_bf16 a[68:71], v[224:227], v[132:135], a[68:71]
ds_read_b64_tr_b16 v[242:243], v249 offset:6656
v_mfma_f32_16x16x32_bf16 a[68:71], v[228:231], v[148:151], a[68:71]
v_exp_f32 v208, v208
v_mfma_f32_16x16x32_bf16 a[72:75], v[224:227], v[136:139], a[72:75]
ds_read_b64_tr_b16 v[244:245], v249 offset:20992
v_mfma_f32_16x16x32_bf16 a[72:75], v[228:231], v[152:155], a[72:75]
v_exp_f32 v209, v209
v_mfma_f32_16x16x32_bf16 a[76:79], v[224:227], v[140:143], a[76:79]
ds_read_b64_tr_b16 v[246:247], v249 offset:23040
v_cvt_pk_bf16_f32 v162, v208, v209
v_mfma_f32_16x16x32_bf16 a[76:79], v[228:231], v[156:159], a[76:79]
s_waitcnt lgkmcnt(4)
s_waitcnt vmcnt(0)
s_barrier
s_add_u32 m0, s30, 0x4000
v_mfma_f32_16x16x32_bf16 a[80:83], v[232:235], v[128:131], a[80:83]
ds_read_b64_tr_b16 v[224:225], v250 offset:4608
v_mfma_f32_16x16x32_bf16 a[80:83], v[236:239], v[144:147], a[80:83]
buffer_load_dwordx4 v251, s[12:15], s28 offen offset:0 lds
v_mfma_f32_16x16x32_bf16 a[84:87], v[232:235], v[132:135], a[84:87]
ds_read_b64_tr_b16 v[226:227], v250 offset:6656
v_mfma_f32_16x16x32_bf16 a[84:87], v[236:239], v[148:151], a[84:87]
v_exp_f32 v210, v210
v_mfma_f32_16x16x32_bf16 a[88:91], v[232:235], v[136:139], a[88:91]
ds_read_b64_tr_b16 v[228:229], v250 offset:20992
v_mfma_f32_16x16x32_bf16 a[88:91], v[236:239], v[152:155], a[88:91]
v_exp_f32 v211, v211
v_mfma_f32_16x16x32_bf16 a[92:95], v[232:235], v[140:143], a[92:95]
ds_read_b64_tr_b16 v[230:231], v250 offset:23040
v_cvt_pk_bf16_f32 v163, v210, v211
v_mfma_f32_16x16x32_bf16 a[92:95], v[236:239], v[156:159], a[92:95]
s_waitcnt lgkmcnt(4)
v_mfma_f32_16x16x32_bf16 a[96:99], v[240:243], v[128:131], a[96:99]
ds_read_b128 v[232:235], v248 offset:49152
v_mfma_f32_16x16x32_bf16 a[96:99], v[244:247], v[144:147], a[96:99]
buffer_load_dwordx4 v251, s[12:15], s28 offen offset:1024 lds
v_mfma_f32_16x16x32_bf16 a[100:103], v[240:243], v[132:135], a[100:103]
v_exp_f32 v212, v212
v_mfma_f32_16x16x32_bf16 a[100:103], v[244:247], v[148:151], a[100:103]
v_exp_f32 v213, v213
v_mfma_f32_16x16x32_bf16 a[104:107], v[240:243], v[136:139], a[104:107]
ds_read_b128 v[236:239], v248 offset:49664
v_cvt_pk_bf16_f32 v166, v212, v213
v_mfma_f32_16x16x32_bf16 a[104:107], v[244:247], v[152:155], a[104:107]
v_exp_f32 v214, v214
v_mfma_f32_16x16x32_bf16 a[108:111], v[240:243], v[140:143], a[108:111]
v_exp_f32 v215, v215
v_mfma_f32_16x16x32_bf16 a[108:111], v[244:247], v[156:159], a[108:111]
s_waitcnt lgkmcnt(2)
v_cvt_pk_bf16_f32 v167, v214, v215
v_mfma_f32_16x16x32_bf16 a[112:115], v[224:227], v[128:131], a[112:115]
ds_read_b128 v[240:243], v248 offset:53248
v_mfma_f32_16x16x32_bf16 a[112:115], v[228:231], v[144:147], a[112:115]
buffer_load_dwordx4 v251, s[12:15], s28 offen offset:2048 lds
v_mfma_f32_16x16x32_bf16 a[116:119], v[224:227], v[132:135], a[116:119]
v_exp_f32 v216, v216
v_mfma_f32_16x16x32_bf16 a[116:119], v[228:231], v[148:151], a[116:119]
v_exp_f32 v217, v217
v_mfma_f32_16x16x32_bf16 a[120:123], v[224:227], v[136:139], a[120:123]
ds_read_b128 v[244:247], v248 offset:53760
v_cvt_pk_bf16_f32 v170, v216, v217
v_mfma_f32_16x16x32_bf16 a[120:123], v[228:231], v[152:155], a[120:123]
v_exp_f32 v218, v218
v_mfma_f32_16x16x32_bf16 a[124:127], v[224:227], v[140:143], a[124:127]
v_exp_f32 v219, v219
v_mfma_f32_16x16x32_bf16 a[124:127], v[228:231], v[156:159], a[124:127]
s_waitcnt lgkmcnt(2)
v_cvt_pk_bf16_f32 v171, v218, v219
v_mfma_f32_16x16x32_bf16 v[192:195], v[232:235], v[0:3], 0
ds_read_b128 v[224:227], v248 offset:57344
v_mfma_f32_16x16x32_bf16 v[192:195], v[236:239], v[4:7], v[192:195]
buffer_load_dwordx4 v251, s[12:15], s28 offen offset:3072 lds
v_mfma_f32_16x16x32_bf16 v[196:199], v[232:235], v[32:35], 0
v_exp_f32 v220, v220
v_mfma_f32_16x16x32_bf16 v[196:199], v[236:239], v[36:39], v[196:199]
s_add_u32 s28, s28, 0x4000
v_mfma_f32_16x16x32_bf16 v[200:203], v[232:235], v[64:67], 0
ds_read_b128 v[228:231], v248 offset:57856
v_mfma_f32_16x16x32_bf16 v[200:203], v[236:239], v[68:71], v[200:203]
v_exp_f32 v221, v221
v_mfma_f32_16x16x32_bf16 v[204:207], v[232:235], v[96:99], 0
v_exp_f32 v222, v222
v_mfma_f32_16x16x32_bf16 v[204:207], v[236:239], v[100:103], v[204:207]
s_waitcnt lgkmcnt(2)
s_add_u32 m0, s30, 0x8000
v_mfma_f32_16x16x32_bf16 v[192:195], v[240:243], v[8:11], v[192:195]
ds_read_b128 v[232:235], v248 offset:61440
v_cvt_pk_bf16_f32 v174, v220, v221
v_mfma_f32_16x16x32_bf16 v[192:195], v[244:247], v[12:15], v[192:195]
buffer_load_dwordx4 v251, s[12:15], s28 offen offset:0 lds
v_mfma_f32_16x16x32_bf16 v[196:199], v[240:243], v[40:43], v[196:199]
v_exp_f32 v223, v223
v_mfma_f32_16x16x32_bf16 v[196:199], v[244:247], v[44:47], v[196:199]
v_mfma_f32_16x16x32_bf16 v[200:203], v[240:243], v[72:75], v[200:203]
ds_read_b128 v[236:239], v248 offset:61952
v_cvt_pk_bf16_f32 v175, v222, v223
v_mfma_f32_16x16x32_bf16 v[200:203], v[244:247], v[76:79], v[200:203]
v_mfma_f32_16x16x32_bf16 v[204:207], v[240:243], v[104:107], v[204:207]
v_mfma_f32_16x16x32_bf16 v[204:207], v[244:247], v[108:111], v[204:207]
s_waitcnt lgkmcnt(2)
v_mfma_f32_16x16x32_bf16 v[192:195], v[224:227], v[16:19], v[192:195]
ds_read_b64_tr_b16 v[240:241], v249 offset:8192
v_mfma_f32_16x16x32_bf16 v[192:195], v[228:231], v[20:23], v[192:195]
buffer_load_dwordx4 v251, s[12:15], s28 offen offset:1024 lds
v_mfma_f32_16x16x32_bf16 v[196:199], v[224:227], v[48:51], v[196:199]
ds_read_b64_tr_b16 v[242:243], v249 offset:10240
v_mfma_f32_16x16x32_bf16 v[196:199], v[228:231], v[52:55], v[196:199]
v_mfma_f32_16x16x32_bf16 v[200:203], v[224:227], v[80:83], v[200:203]
ds_read_b64_tr_b16 v[244:245], v249 offset:24576
v_mfma_f32_16x16x32_bf16 v[200:203], v[228:231], v[84:87], v[200:203]
v_mfma_f32_16x16x32_bf16 v[204:207], v[224:227], v[112:115], v[204:207]
ds_read_b64_tr_b16 v[246:247], v249 offset:26624
v_mfma_f32_16x16x32_bf16 v[204:207], v[228:231], v[116:119], v[204:207]
s_waitcnt lgkmcnt(4)
v_mfma_f32_16x16x32_bf16 v[192:195], v[232:235], v[24:27], v[192:195]
ds_read_b64_tr_b16 v[224:225], v250 offset:8192
v_mfma_f32_16x16x32_bf16 v[192:195], v[236:239], v[28:31], v[192:195]
buffer_load_dwordx4 v251, s[12:15], s28 offen offset:2048 lds
v_mfma_f32_16x16x32_bf16 v[196:199], v[232:235], v[56:59], v[196:199]
ds_read_b64_tr_b16 v[226:227], v250 offset:10240
v_mfma_f32_16x16x32_bf16 v[196:199], v[236:239], v[60:63], v[196:199]
v_mfma_f32_16x16x32_bf16 v[200:203], v[232:235], v[88:91], v[200:203]
ds_read_b64_tr_b16 v[228:229], v250 offset:24576
v_mfma_f32_16x16x32_bf16 v[200:203], v[236:239], v[92:95], v[200:203]
v_mfma_f32_16x16x32_bf16 v[204:207], v[232:235], v[120:123], v[204:207]
ds_read_b64_tr_b16 v[230:231], v250 offset:26624
v_mfma_f32_16x16x32_bf16 v[204:207], v[236:239], v[124:127], v[204:207]
s_waitcnt lgkmcnt(4)
v_mfma_f32_16x16x32_bf16 a[128:131], v[240:243], v[128:131], a[128:131]
ds_read_b64_tr_b16 v[232:233], v249 offset:8704
v_mfma_f32_16x16x32_bf16 a[128:131], v[244:247], v[144:147], a[128:131]
buffer_load_dwordx4 v251, s[12:15], s28 offen offset:3072 lds
v_mfma_f32_16x16x32_bf16 a[132:135], v[240:243], v[132:135], a[132:135]
ds_read_b64_tr_b16 v[234:235], v249 offset:10752
v_mfma_f32_16x16x32_bf16 a[132:135], v[244:247], v[148:151], a[132:135]
s_add_u32 s28, s28, 0x4000
v_mfma_f32_16x16x32_bf16 a[136:139], v[240:243], v[136:139], a[136:139]
ds_read_b64_tr_b16 v[236:237], v249 offset:25088
v_mfma_f32_16x16x32_bf16 a[136:139], v[244:247], v[152:155], a[136:139]
v_exp_f32 v192, v192
v_mfma_f32_16x16x32_bf16 a[140:143], v[240:243], v[140:143], a[140:143]
ds_read_b64_tr_b16 v[238:239], v249 offset:27136
v_mfma_f32_16x16x32_bf16 a[140:143], v[244:247], v[156:159], a[140:143]
s_waitcnt lgkmcnt(4)
v_mfma_f32_16x16x32_bf16 a[144:147], v[224:227], v[128:131], a[144:147]
ds_read_b64_tr_b16 v[240:241], v250 offset:8704
v_mfma_f32_16x16x32_bf16 a[144:147], v[228:231], v[144:147], a[144:147]
v_exp_f32 v193, v193
v_mfma_f32_16x16x32_bf16 a[148:151], v[224:227], v[132:135], a[148:151]
ds_read_b64_tr_b16 v[242:243], v250 offset:10752
v_cvt_pk_bf16_f32 v176, v192, v193
v_mfma_f32_16x16x32_bf16 a[148:151], v[228:231], v[148:151], a[148:151]
v_exp_f32 v194, v194
v_mfma_f32_16x16x32_bf16 a[152:155], v[224:227], v[136:139], a[152:155]
ds_read_b64_tr_b16 v[244:245], v250 offset:25088
v_mfma_f32_16x16x32_bf16 a[152:155], v[228:231], v[152:155], a[152:155]
v_exp_f32 v195, v195
v_mfma_f32_16x16x32_bf16 a[156:159], v[224:227], v[140:143], a[156:159]
ds_read_b64_tr_b16 v[246:247], v250 offset:27136
v_cvt_pk_bf16_f32 v177, v194, v195
v_mfma_f32_16x16x32_bf16 a[156:159], v[228:231], v[156:159], a[156:159]
s_waitcnt lgkmcnt(4)
v_mfma_f32_16x16x32_bf16 a[160:163], v[232:235], v[128:131], a[160:163]
ds_read_b128 v[224:227], v248 offset:51200
v_mfma_f32_16x16x32_bf16 a[160:163], v[236:239], v[144:147], a[160:163]
v_exp_f32 v196, v196
v_mfma_f32_16x16x32_bf16 a[164:167], v[232:235], v[132:135], a[164:167]
v_exp_f32 v197, v197
v_mfma_f32_16x16x32_bf16 a[164:167], v[236:239], v[148:151], a[164:167]
v_exp_f32 v198, v198
v_mfma_f32_16x16x32_bf16 a[168:171], v[232:235], v[136:139], a[168:171]
ds_read_b128 v[228:231], v248 offset:51712
v_cvt_pk_bf16_f32 v180, v196, v197
v_mfma_f32_16x16x32_bf16 a[168:171], v[236:239], v[152:155], a[168:171]
v_exp_f32 v199, v199
v_mfma_f32_16x16x32_bf16 a[172:175], v[232:235], v[140:143], a[172:175]
v_exp_f32 v200, v200
v_mfma_f32_16x16x32_bf16 a[172:175], v[236:239], v[156:159], a[172:175]
s_waitcnt lgkmcnt(2)
v_cvt_pk_bf16_f32 v181, v198, v199
v_mfma_f32_16x16x32_bf16 a[176:179], v[240:243], v[128:131], a[176:179]
ds_read_b128 v[232:235], v248 offset:55296
v_mfma_f32_16x16x32_bf16 a[176:179], v[244:247], v[144:147], a[176:179]
v_exp_f32 v201, v201
v_mfma_f32_16x16x32_bf16 a[180:183], v[240:243], v[132:135], a[180:183]
v_exp_f32 v202, v202
v_mfma_f32_16x16x32_bf16 a[180:183], v[244:247], v[148:151], a[180:183]
v_exp_f32 v203, v203
v_mfma_f32_16x16x32_bf16 a[184:187], v[240:243], v[136:139], a[184:187]
ds_read_b128 v[236:239], v248 offset:55808
v_cvt_pk_bf16_f32 v184, v200, v201
v_mfma_f32_16x16x32_bf16 a[184:187], v[244:247], v[152:155], a[184:187]
v_cvt_pk_bf16_f32 v185, v202, v203
v_mfma_f32_16x16x32_bf16 a[188:191], v[240:243], v[140:143], a[188:191]
v_exp_f32 v204, v204
v_mfma_f32_16x16x32_bf16 a[188:191], v[244:247], v[156:159], a[188:191]
s_waitcnt lgkmcnt(2)
v_mfma_f32_16x16x32_bf16 v[208:211], v[224:227], v[0:3], 0
ds_read_b128 v[240:243], v248 offset:59392
v_mfma_f32_16x16x32_bf16 v[208:211], v[228:231], v[4:7], v[208:211]
v_exp_f32 v205, v205
v_mfma_f32_16x16x32_bf16 v[212:215], v[224:227], v[32:35], 0
v_exp_f32 v206, v206
v_mfma_f32_16x16x32_bf16 v[212:215], v[228:231], v[36:39], v[212:215]
v_exp_f32 v207, v207
v_mfma_f32_16x16x32_bf16 v[216:219], v[224:227], v[64:67], 0
ds_read_b128 v[244:247], v248 offset:59904
v_cvt_pk_bf16_f32 v188, v204, v205
v_mfma_f32_16x16x32_bf16 v[216:219], v[228:231], v[68:71], v[216:219]
v_cvt_pk_bf16_f32 v189, v206, v207
v_mfma_f32_16x16x32_bf16 v[220:223], v[224:227], v[96:99], 0
v_mfma_f32_16x16x32_bf16 v[220:223], v[228:231], v[100:103], v[220:223]
s_waitcnt lgkmcnt(2)
v_mfma_f32_16x16x32_bf16 v[208:211], v[232:235], v[8:11], v[208:211]
ds_read_b128 v[224:227], v248 offset:63488
v_mfma_f32_16x16x32_bf16 v[208:211], v[236:239], v[12:15], v[208:211]
v_mfma_f32_16x16x32_bf16 v[212:215], v[232:235], v[40:43], v[212:215]
v_mfma_f32_16x16x32_bf16 v[212:215], v[236:239], v[44:47], v[212:215]
v_mfma_f32_16x16x32_bf16 v[216:219], v[232:235], v[72:75], v[216:219]
ds_read_b128 v[228:231], v248 offset:64000
v_mfma_f32_16x16x32_bf16 v[216:219], v[236:239], v[76:79], v[216:219]
v_mfma_f32_16x16x32_bf16 v[220:223], v[232:235], v[104:107], v[220:223]
v_mfma_f32_16x16x32_bf16 v[220:223], v[236:239], v[108:111], v[220:223]
s_waitcnt lgkmcnt(2)
v_mfma_f32_16x16x32_bf16 v[208:211], v[240:243], v[16:19], v[208:211]
ds_read_b64_tr_b16 v[232:233], v249 offset:12288
v_mfma_f32_16x16x32_bf16 v[208:211], v[244:247], v[20:23], v[208:211]
v_mfma_f32_16x16x32_bf16 v[212:215], v[240:243], v[48:51], v[212:215]
ds_read_b64_tr_b16 v[234:235], v249 offset:14336
v_mfma_f32_16x16x32_bf16 v[212:215], v[244:247], v[52:55], v[212:215]
v_mfma_f32_16x16x32_bf16 v[216:219], v[240:243], v[80:83], v[216:219]
ds_read_b64_tr_b16 v[236:237], v249 offset:28672
v_mfma_f32_16x16x32_bf16 v[216:219], v[244:247], v[84:87], v[216:219]
v_mfma_f32_16x16x32_bf16 v[220:223], v[240:243], v[112:115], v[220:223]
ds_read_b64_tr_b16 v[238:239], v249 offset:30720
v_mfma_f32_16x16x32_bf16 v[220:223], v[244:247], v[116:119], v[220:223]
s_waitcnt lgkmcnt(4)
v_mfma_f32_16x16x32_bf16 v[208:211], v[224:227], v[24:27], v[208:211]
ds_read_b64_tr_b16 v[240:241], v250 offset:12288
v_mfma_f32_16x16x32_bf16 v[208:211], v[228:231], v[28:31], v[208:211]
v_mfma_f32_16x16x32_bf16 v[212:215], v[224:227], v[56:59], v[212:215]
ds_read_b64_tr_b16 v[242:243], v250 offset:14336
v_mfma_f32_16x16x32_bf16 v[212:215], v[228:231], v[60:63], v[212:215]
v_mfma_f32_16x16x32_bf16 v[216:219], v[224:227], v[88:91], v[216:219]
ds_read_b64_tr_b16 v[244:245], v250 offset:28672
v_mfma_f32_16x16x32_bf16 v[216:219], v[228:231], v[92:95], v[216:219]
v_mfma_f32_16x16x32_bf16 v[220:223], v[224:227], v[120:123], v[220:223]
ds_read_b64_tr_b16 v[246:247], v250 offset:30720
v_xor_b32 v248, 0x10000, v248
v_mfma_f32_16x16x32_bf16 v[220:223], v[228:231], v[124:127], v[220:223]
s_waitcnt lgkmcnt(4)
v_mfma_f32_16x16x32_bf16 a[192:195], v[232:235], v[128:131], a[192:195]
ds_read_b64_tr_b16 v[224:225], v249 offset:12800
v_mfma_f32_16x16x32_bf16 a[192:195], v[236:239], v[144:147], a[192:195]
v_mfma_f32_16x16x32_bf16 a[196:199], v[232:235], v[132:135], a[196:199]
ds_read_b64_tr_b16 v[226:227], v249 offset:14848
v_mfma_f32_16x16x32_bf16 a[196:199], v[236:239], v[148:151], a[196:199]
v_exp_f32 v208, v208
v_mfma_f32_16x16x32_bf16 a[200:203], v[232:235], v[136:139], a[200:203]
ds_read_b64_tr_b16 v[228:229], v249 offset:29184
v_mfma_f32_16x16x32_bf16 a[200:203], v[236:239], v[152:155], a[200:203]
v_exp_f32 v209, v209
v_mfma_f32_16x16x32_bf16 a[204:207], v[232:235], v[140:143], a[204:207]
ds_read_b64_tr_b16 v[230:231], v249 offset:31232
v_cvt_pk_bf16_f32 v178, v208, v209
v_mfma_f32_16x16x32_bf16 a[204:207], v[236:239], v[156:159], a[204:207]
s_waitcnt lgkmcnt(4)
v_mfma_f32_16x16x32_bf16 a[208:211], v[240:243], v[128:131], a[208:211]
ds_read_b64_tr_b16 v[232:233], v250 offset:12800
v_mfma_f32_16x16x32_bf16 a[208:211], v[244:247], v[144:147], a[208:211]
v_exp_f32 v210, v210
v_mfma_f32_16x16x32_bf16 a[212:215], v[240:243], v[132:135], a[212:215]
ds_read_b64_tr_b16 v[234:235], v250 offset:14848
v_mfma_f32_16x16x32_bf16 a[212:215], v[244:247], v[148:151], a[212:215]
v_exp_f32 v211, v211
v_mfma_f32_16x16x32_bf16 a[216:219], v[240:243], v[136:139], a[216:219]
ds_read_b64_tr_b16 v[236:237], v250 offset:29184
v_cvt_pk_bf16_f32 v179, v210, v211
v_mfma_f32_16x16x32_bf16 a[216:219], v[244:247], v[152:155], a[216:219]
v_exp_f32 v212, v212
v_mfma_f32_16x16x32_bf16 a[220:223], v[240:243], v[140:143], a[220:223]
ds_read_b64_tr_b16 v[238:239], v250 offset:31232
v_mfma_f32_16x16x32_bf16 a[220:223], v[244:247], v[156:159], a[220:223]
s_waitcnt lgkmcnt(4)
v_mfma_f32_16x16x32_bf16 a[224:227], v[224:227], v[128:131], a[224:227]
ds_read_b128 v[240:243], v248 offset:0
v_mfma_f32_16x16x32_bf16 a[224:227], v[228:231], v[144:147], a[224:227]
v_exp_f32 v213, v213
v_mfma_f32_16x16x32_bf16 a[228:231], v[224:227], v[132:135], a[228:231]
v_exp_f32 v214, v214
v_mfma_f32_16x16x32_bf16 a[228:231], v[228:231], v[148:151], a[228:231]
v_exp_f32 v215, v215
v_mfma_f32_16x16x32_bf16 a[232:235], v[224:227], v[136:139], a[232:235]
ds_read_b128 v[244:247], v248 offset:512
v_cvt_pk_bf16_f32 v182, v212, v213
v_mfma_f32_16x16x32_bf16 a[232:235], v[228:231], v[152:155], a[232:235]
v_cvt_pk_bf16_f32 v183, v214, v215
v_mfma_f32_16x16x32_bf16 a[236:239], v[224:227], v[140:143], a[236:239]
v_exp_f32 v216, v216
v_mfma_f32_16x16x32_bf16 a[236:239], v[228:231], v[156:159], a[236:239]
s_waitcnt lgkmcnt(2)
v_mfma_f32_16x16x32_bf16 a[240:243], v[232:235], v[128:131], a[240:243]
ds_read_b128 v[224:227], v248 offset:4096
v_mfma_f32_16x16x32_bf16 a[240:243], v[236:239], v[144:147], a[240:243]
v_exp_f32 v217, v217
v_mfma_f32_16x16x32_bf16 a[244:247], v[232:235], v[132:135], a[244:247]
v_exp_f32 v218, v218
v_mfma_f32_16x16x32_bf16 a[244:247], v[236:239], v[148:151], a[244:247]
v_exp_f32 v219, v219
v_mfma_f32_16x16x32_bf16 a[248:251], v[232:235], v[136:139], a[248:251]
ds_read_b128 v[228:231], v248 offset:4608
v_cvt_pk_bf16_f32 v186, v216, v217
v_mfma_f32_16x16x32_bf16 a[248:251], v[236:239], v[152:155], a[248:251]
v_cvt_pk_bf16_f32 v187, v218, v219
v_mfma_f32_16x16x32_bf16 a[252:255], v[232:235], v[140:143], a[252:255]
v_exp_f32 v220, v220
v_mfma_f32_16x16x32_bf16 a[252:255], v[236:239], v[156:159], a[252:255]
s_waitcnt lgkmcnt(2)
v_mfma_f32_16x16x32_bf16 v[192:195], v[240:243], v[0:3], 0
ds_read_b128 v[232:235], v248 offset:8192
v_mfma_f32_16x16x32_bf16 v[192:195], v[244:247], v[4:7], v[192:195]
v_exp_f32 v221, v221
v_mfma_f32_16x16x32_bf16 v[196:199], v[240:243], v[32:35], 0
v_exp_f32 v222, v222
v_mfma_f32_16x16x32_bf16 v[196:199], v[244:247], v[36:39], v[196:199]
v_exp_f32 v223, v223
v_mfma_f32_16x16x32_bf16 v[200:203], v[240:243], v[64:67], 0
ds_read_b128 v[236:239], v248 offset:8704
v_cvt_pk_bf16_f32 v190, v220, v221
v_mfma_f32_16x16x32_bf16 v[200:203], v[244:247], v[68:71], v[200:203]
v_cvt_pk_bf16_f32 v191, v222, v223
v_mfma_f32_16x16x32_bf16 v[204:207], v[240:243], v[96:99], 0
v_mfma_f32_16x16x32_bf16 v[204:207], v[244:247], v[100:103], v[204:207]
s_waitcnt lgkmcnt(2)
v_mfma_f32_16x16x32_bf16 v[192:195], v[224:227], v[8:11], v[192:195]
ds_read_b128 v[240:243], v248 offset:12288
v_mfma_f32_16x16x32_bf16 v[192:195], v[228:231], v[12:15], v[192:195]
v_mfma_f32_16x16x32_bf16 v[196:199], v[224:227], v[40:43], v[196:199]
v_mfma_f32_16x16x32_bf16 v[196:199], v[228:231], v[44:47], v[196:199]
v_mfma_f32_16x16x32_bf16 v[200:203], v[224:227], v[72:75], v[200:203]
ds_read_b128 v[244:247], v248 offset:12800
v_mfma_f32_16x16x32_bf16 v[200:203], v[228:231], v[76:79], v[200:203]
v_mfma_f32_16x16x32_bf16 v[204:207], v[224:227], v[104:107], v[204:207]
v_mfma_f32_16x16x32_bf16 v[204:207], v[228:231], v[108:111], v[204:207]
s_waitcnt lgkmcnt(2)
v_mfma_f32_16x16x32_bf16 v[192:195], v[232:235], v[16:19], v[192:195]
ds_read_b64_tr_b16 v[224:225], v249 offset:32768
v_mfma_f32_16x16x32_bf16 v[192:195], v[236:239], v[20:23], v[192:195]
v_mfma_f32_16x16x32_bf16 v[196:199], v[232:235], v[48:51], v[196:199]
ds_read_b64_tr_b16 v[226:227], v249 offset:34816
v_mfma_f32_16x16x32_bf16 v[196:199], v[236:239], v[52:55], v[196:199]
v_mfma_f32_16x16x32_bf16 v[200:203], v[232:235], v[80:83], v[200:203]
ds_read_b64_tr_b16 v[228:229], v249 offset:49152
v_mfma_f32_16x16x32_bf16 v[200:203], v[236:239], v[84:87], v[200:203]
v_mfma_f32_16x16x32_bf16 v[204:207], v[232:235], v[112:115], v[204:207]
ds_read_b64_tr_b16 v[230:231], v249 offset:51200
v_mfma_f32_16x16x32_bf16 v[204:207], v[236:239], v[116:119], v[204:207]
s_waitcnt lgkmcnt(4)
v_mfma_f32_16x16x32_bf16 v[192:195], v[240:243], v[24:27], v[192:195]
ds_read_b64_tr_b16 v[232:233], v250 offset:32768
v_mfma_f32_16x16x32_bf16 v[192:195], v[244:247], v[28:31], v[192:195]
v_mfma_f32_16x16x32_bf16 v[196:199], v[240:243], v[56:59], v[196:199]
ds_read_b64_tr_b16 v[234:235], v250 offset:34816
v_mfma_f32_16x16x32_bf16 v[196:199], v[244:247], v[60:63], v[196:199]
v_mfma_f32_16x16x32_bf16 v[200:203], v[240:243], v[88:91], v[200:203]
ds_read_b64_tr_b16 v[236:237], v250 offset:49152
v_mfma_f32_16x16x32_bf16 v[200:203], v[244:247], v[92:95], v[200:203]
s_sub_u32 s31, s31, 1
v_mfma_f32_16x16x32_bf16 v[204:207], v[240:243], v[120:123], v[204:207]
ds_read_b64_tr_b16 v[238:239], v250 offset:51200
v_mfma_f32_16x16x32_bf16 v[204:207], v[244:247], v[124:127], v[204:207]
s_cbranch_scc1 L2_tail_1
s_waitcnt lgkmcnt(4)
v_mfma_f32_16x16x32_bf16 a[0:3], v[224:227], v[160:163], a[0:3]
ds_read_b64_tr_b16 v[240:241], v249 offset:33280
v_mfma_f32_16x16x32_bf16 a[0:3], v[228:231], v[176:179], a[0:3]
v_mfma_f32_16x16x32_bf16 a[4:7], v[224:227], v[164:167], a[4:7]
ds_read_b64_tr_b16 v[242:243], v249 offset:35328
v_mfma_f32_16x16x32_bf16 a[4:7], v[228:231], v[180:183], a[4:7]
v_exp_f32 v192, v192
v_mfma_f32_16x16x32_bf16 a[8:11], v[224:227], v[168:171], a[8:11]
ds_read_b64_tr_b16 v[244:245], v249 offset:49664
v_mfma_f32_16x16x32_bf16 a[8:11], v[228:231], v[184:187], a[8:11]
v_exp_f32 v193, v193
v_mfma_f32_16x16x32_bf16 a[12:15], v[224:227], v[172:175], a[12:15]
ds_read_b64_tr_b16 v[246:247], v249 offset:51712
v_cvt_pk_bf16_f32 v128, v192, v193
v_mfma_f32_16x16x32_bf16 a[12:15], v[228:231], v[188:191], a[12:15]
s_waitcnt lgkmcnt(4)
v_mfma_f32_16x16x32_bf16 a[16:19], v[232:235], v[160:163], a[16:19]
ds_read_b64_tr_b16 v[144:145], v250 offset:33280
v_mfma_f32_16x16x32_bf16 a[16:19], v[236:239], v[176:179], a[16:19]
v_exp_f32 v194, v194
v_mfma_f32_16x16x32_bf16 a[20:23], v[232:235], v[164:167], a[20:23]
ds_read_b64_tr_b16 v[146:147], v250 offset:35328
v_mfma_f32_16x16x32_bf16 a[20:23], v[236:239], v[180:183], a[20:23]
v_exp_f32 v195, v195
v_mfma_f32_16x16x32_bf16 a[24:27], v[232:235], v[168:171], a[24:27]
ds_read_b64_tr_b16 v[148:149], v250 offset:49664
v_cvt_pk_bf16_f32 v129, v194, v195
v_mfma_f32_16x16x32_bf16 a[24:27], v[236:239], v[184:187], a[24:27]
v_exp_f32 v196, v196
v_mfma_f32_16x16x32_bf16 a[28:31], v[232:235], v[172:175], a[28:31]
ds_read_b64_tr_b16 v[150:151], v250 offset:51712
v_mfma_f32_16x16x32_bf16 a[28:31], v[236:239], v[188:191], a[28:31]
s_waitcnt lgkmcnt(4)
v_mfma_f32_16x16x32_bf16 a[32:35], v[240:243], v[160:163], a[32:35]
ds_read_b128 v[224:227], v248 offset:2048
v_mfma_f32_16x16x32_bf16 a[32:35], v[244:247], v[176:179], a[32:35]
v_exp_f32 v197, v197
v_mfma_f32_16x16x32_bf16 a[36:39], v[240:243], v[164:167], a[36:39]
v_exp_f32 v198, v198
v_mfma_f32_16x16x32_bf16 a[36:39], v[244:247], v[180:183], a[36:39]
v_exp_f32 v199, v199
v_mfma_f32_16x16x32_bf16 a[40:43], v[240:243], v[168:171], a[40:43]
ds_read_b128 v[228:231], v248 offset:2560
v_cvt_pk_bf16_f32 v132, v196, v197
v_mfma_f32_16x16x32_bf16 a[40:43], v[244:247], v[184:187], a[40:43]
v_cvt_pk_bf16_f32 v133, v198, v199
v_mfma_f32_16x16x32_bf16 a[44:47], v[240:243], v[172:175], a[44:47]
v_exp_f32 v200, v200
v_mfma_f32_16x16x32_bf16 a[44:47], v[244:247], v[188:191], a[44:47]
s_waitcnt lgkmcnt(2)
v_mfma_f32_16x16x32_bf16 a[48:51], v[144:147], v[160:163], a[48:51]
ds_read_b128 v[232:235], v248 offset:6144
v_mfma_f32_16x16x32_bf16 a[48:51], v[148:151], v[176:179], a[48:51]
v_exp_f32 v201, v201
v_mfma_f32_16x16x32_bf16 a[52:55], v[144:147], v[164:167], a[52:55]
v_exp_f32 v202, v202
v_mfma_f32_16x16x32_bf16 a[52:55], v[148:151], v[180:183], a[52:55]
v_exp_f32 v203, v203
v_mfma_f32_16x16x32_bf16 a[56:59], v[144:147], v[168:171], a[56:59]
ds_read_b128 v[236:239], v248 offset:6656
v_cvt_pk_bf16_f32 v136, v200, v201
v_mfma_f32_16x16x32_bf16 a[56:59], v[148:151], v[184:187], a[56:59]
v_cvt_pk_bf16_f32 v137, v202, v203
v_mfma_f32_16x16x32_bf16 a[60:63], v[144:147], v[172:175], a[60:63]
v_exp_f32 v204, v204
v_mfma_f32_16x16x32_bf16 a[60:63], v[148:151], v[188:191], a[60:63]
s_waitcnt lgkmcnt(2)
v_mfma_f32_16x16x32_bf16 v[208:211], v[224:227], v[0:3], 0
ds_read_b128 v[240:243], v248 offset:10240
v_mfma_f32_16x16x32_bf16 v[208:211], v[228:231], v[4:7], v[208:211]
v_exp_f32 v205, v205
v_mfma_f32_16x16x32_bf16 v[212:215], v[224:227], v[32:35], 0
v_exp_f32 v206, v206
v_mfma_f32_16x16x32_bf16 v[212:215], v[228:231], v[36:39], v[212:215]
v_exp_f32 v207, v207
v_mfma_f32_16x16x32_bf16 v[216:219], v[224:227], v[64:67], 0
ds_read_b128 v[244:247], v248 offset:10752
v_cvt_pk_bf16_f32 v140, v204, v205
v_mfma_f32_16x16x32_bf16 v[216:219], v[228:231], v[68:71], v[216:219]
v_cvt_pk_bf16_f32 v141, v206, v207
v_mfma_f32_16x16x32_bf16 v[220:223], v[224:227], v[96:99], 0
v_mfma_f32_16x16x32_bf16 v[220:223], v[228:231], v[100:103], v[220:223]
s_waitcnt lgkmcnt(2)
v_mfma_f32_16x16x32_bf16 v[208:211], v[232:235], v[8:11], v[208:211]
ds_read_b128 v[144:147], v248 offset:14336
v_mfma_f32_16x16x32_bf16 v[208:211], v[236:239], v[12:15], v[208:211]
v_mfma_f32_16x16x32_bf16 v[212:215], v[232:235], v[40:43], v[212:215]
v_mfma_f32_16x16x32_bf16 v[212:215], v[236:239], v[44:47], v[212:215]
v_mfma_f32_16x16x32_bf16 v[216:219], v[232:235], v[72:75], v[216:219]
ds_read_b128 v[148:151], v248 offset:14848
v_mfma_f32_16x16x32_bf16 v[216:219], v[236:239], v[76:79], v[216:219]
v_mfma_f32_16x16x32_bf16 v[220:223], v[232:235], v[104:107], v[220:223]
v_mfma_f32_16x16x32_bf16 v[220:223], v[236:239], v[108:111], v[220:223]
s_waitcnt lgkmcnt(2)
v_mfma_f32_16x16x32_bf16 v[208:211], v[240:243], v[16:19], v[208:211]
ds_read_b64_tr_b16 v[224:225], v249 offset:36864
v_mfma_f32_16x16x32_bf16 v[208:211], v[244:247], v[20:23], v[208:211]
v_mfma_f32_16x16x32_bf16 v[212:215], v[240:243], v[48:51], v[212:215]
ds_read_b64_tr_b16 v[226:227], v249 offset:38912
v_mfma_f32_16x16x32_bf16 v[212:215], v[244:247], v[52:55], v[212:215]
v_mfma_f32_16x16x32_bf16 v[216:219], v[240:243], v[80:83], v[216:219]
ds_read_b64_tr_b16 v[228:229], v249 offset:53248
v_mfma_f32_16x16x32_bf16 v[216:219], v[244:247], v[84:87], v[216:219]
v_mfma_f32_16x16x32_bf16 v[220:223], v[240:243], v[112:115], v[220:223]
ds_read_b64_tr_b16 v[230:231], v249 offset:55296
v_mfma_f32_16x16x32_bf16 v[220:223], v[244:247], v[116:119], v[220:223]
s_waitcnt lgkmcnt(4)
v_mfma_f32_16x16x32_bf16 v[208:211], v[144:147], v[24:27], v[208:211]
ds_read_b64_tr_b16 v[232:233], v250 offset:36864
v_mfma_f32_16x16x32_bf16 v[208:211], v[148:151], v[28:31], v[208:211]
v_mfma_f32_16x16x32_bf16 v[212:215], v[144:147], v[56:59], v[212:215]
ds_read_b64_tr_b16 v[234:235], v250 offset:38912
v_mfma_f32_16x16x32_bf16 v[212:215], v[148:151], v[60:63], v[212:215]
v_mfma_f32_16x16x32_bf16 v[216:219], v[144:147], v[88:91], v[216:219]
ds_read_b64_tr_b16 v[236:237], v250 offset:53248
v_mfma_f32_16x16x32_bf16 v[216:219], v[148:151], v[92:95], v[216:219]
v_mfma_f32_16x16x32_bf16 v[220:223], v[144:147], v[120:123], v[220:223]
ds_read_b64_tr_b16 v[238:239], v250 offset:55296
v_mfma_f32_16x16x32_bf16 v[220:223], v[148:151], v[124:127], v[220:223]
s_waitcnt lgkmcnt(4)
v_mfma_f32_16x16x32_bf16 a[64:67], v[224:227], v[160:163], a[64:67]
ds_read_b64_tr_b16 v[240:241], v249 offset:37376
v_mfma_f32_16x16x32_bf16 a[64:67], v[228:231], v[176:179], a[64:67]
v_mfma_f32_16x16x32_bf16 a[68:71], v[224:227], v[164:167], a[68:71]
ds_read_b64_tr_b16 v[242:243], v249 offset:39424
v_mfma_f32_16x16x32_bf16 a[68:71], v[228:231], v[180:183], a[68:71]
v_exp_f32 v208, v208
v_mfma_f32_16x16x32_bf16 a[72:75], v[224:227], v[168:171], a[72:75]
ds_read_b64_tr_b16 v[244:245], v249 offset:53760
v_mfma_f32_16x16x32_bf16 a[72:75], v[228:231], v[184:187], a[72:75]
v_exp_f32 v209, v209
v_mfma_f32_16x16x32_bf16 a[76:79], v[224:227], v[172:175], a[76:79]
ds_read_b64_tr_b16 v[246:247], v249 offset:55808
v_cvt_pk_bf16_f32 v130, v208, v209
v_mfma_f32_16x16x32_bf16 a[76:79], v[228:231], v[188:191], a[76:79]
s_waitcnt lgkmcnt(4)
s_waitcnt vmcnt(0)
s_barrier
s_add_u32 m0, s30, 0xc000
v_mfma_f32_16x16x32_bf16 a[80:83], v[232:235], v[160:163], a[80:83]
ds_read_b64_tr_b16 v[224:225], v250 offset:37376
v_mfma_f32_16x16x32_bf16 a[80:83], v[236:239], v[176:179], a[80:83]
buffer_load_dwordx4 v251, s[12:15], s28 offen offset:0 lds
v_mfma_f32_16x16x32_bf16 a[84:87], v[232:235], v[164:167], a[84:87]
ds_read_b64_tr_b16 v[226:227], v250 offset:39424
v_mfma_f32_16x16x32_bf16 a[84:87], v[236:239], v[180:183], a[84:87]
v_exp_f32 v210, v210
v_mfma_f32_16x16x32_bf16 a[88:91], v[232:235], v[168:171], a[88:91]
ds_read_b64_tr_b16 v[228:229], v250 offset:53760
v_mfma_f32_16x16x32_bf16 a[88:91], v[236:239], v[184:187], a[88:91]
v_exp_f32 v211, v211
v_mfma_f32_16x16x32_bf16 a[92:95], v[232:235], v[172:175], a[92:95]
ds_read_b64_tr_b16 v[230:231], v250 offset:55808
v_cvt_pk_bf16_f32 v131, v210, v211
v_mfma_f32_16x16x32_bf16 a[92:95], v[236:239], v[188:191], a[92:95]
s_waitcnt lgkmcnt(4)
v_mfma_f32_16x16x32_bf16 a[96:99], v[240:243], v[160:163], a[96:99]
ds_read_b128 v[232:235], v248 offset:16384
v_mfma_f32_16x16x32_bf16 a[96:99], v[244:247], v[176:179], a[96:99]
buffer_load_dwordx4 v251, s[12:15], s28 offen offset:1024 lds
v_mfma_f32_16x16x32_bf16 a[100:103], v[240:243], v[164:167], a[100:103]
v_exp_f32 v212, v212
v_mfma_f32_16x16x32_bf16 a[100:103], v[244:247], v[180:183], a[100:103]
v_exp_f32 v213, v213
v_mfma_f32_16x16x32_bf16 a[104:107], v[240:243], v[168:171], a[104:107]
ds_read_b128 v[236:239], v248 offset:16896
v_cvt_pk_bf16_f32 v134, v212, v213
v_mfma_f32_16x16x32_bf16 a[104:107], v[244:247], v[184:187], a[104:107]
v_exp_f32 v214, v214
v_mfma_f32_16x16x32_bf16 a[108:111], v[240:243], v[172:175], a[108:111]
v_exp_f32 v215, v215
v_mfma_f32_16x16x32_bf16 a[108:111], v[244:247], v[188:191], a[108:111]
s_waitcnt lgkmcnt(2)
v_cvt_pk_bf16_f32 v135, v214, v215
v_mfma_f32_16x16x32_bf16 a[112:115], v[224:227], v[160:163], a[112:115]
ds_read_b128 v[240:243], v248 offset:20480
v_mfma_f32_16x16x32_bf16 a[112:115], v[228:231], v[176:179], a[112:115]
buffer_load_dwordx4 v251, s[12:15], s28 offen offset:2048 lds
v_mfma_f32_16x16x32_bf16 a[116:119], v[224:227], v[164:167], a[116:119]
v_exp_f32 v216, v216
v_mfma_f32_16x16x32_bf16 a[116:119], v[228:231], v[180:183], a[116:119]
v_exp_f32 v217, v217
v_mfma_f32_16x16x32_bf16 a[120:123], v[224:227], v[168:171], a[120:123]
ds_read_b128 v[244:247], v248 offset:20992
v_cvt_pk_bf16_f32 v138, v216, v217
v_mfma_f32_16x16x32_bf16 a[120:123], v[228:231], v[184:187], a[120:123]
v_exp_f32 v218, v218
v_mfma_f32_16x16x32_bf16 a[124:127], v[224:227], v[172:175], a[124:127]
v_exp_f32 v219, v219
v_mfma_f32_16x16x32_bf16 a[124:127], v[228:231], v[188:191], a[124:127]
s_waitcnt lgkmcnt(2)
v_cvt_pk_bf16_f32 v139, v218, v219
v_mfma_f32_16x16x32_bf16 v[192:195], v[232:235], v[0:3], 0
ds_read_b128 v[224:227], v248 offset:24576
v_mfma_f32_16x16x32_bf16 v[192:195], v[236:239], v[4:7], v[192:195]
buffer_load_dwordx4 v251, s[12:15], s28 offen offset:3072 lds
v_mfma_f32_16x16x32_bf16 v[196:199], v[232:235], v[32:35], 0
s_xor_b32 s30, s30, 0x10000
v_mfma_f32_16x16x32_bf16 v[196:199], v[236:239], v[36:39], v[196:199]
s_add_u32 s28, s28, 0x4000
v_mfma_f32_16x16x32_bf16 v[200:203], v[232:235], v[64:67], 0
ds_read_b128 v[228:231], v248 offset:25088
v_mfma_f32_16x16x32_bf16 v[200:203], v[236:239], v[68:71], v[200:203]
v_exp_f32 v220, v220
v_mfma_f32_16x16x32_bf16 v[204:207], v[232:235], v[96:99], 0
v_exp_f32 v221, v221
v_mfma_f32_16x16x32_bf16 v[204:207], v[236:239], v[100:103], v[204:207]
s_waitcnt lgkmcnt(2)
s_add_u32 m0, s30, 0x0
v_mfma_f32_16x16x32_bf16 v[192:195], v[240:243], v[8:11], v[192:195]
ds_read_b128 v[232:235], v248 offset:28672
v_cvt_pk_bf16_f32 v142, v220, v221
v_mfma_f32_16x16x32_bf16 v[192:195], v[244:247], v[12:15], v[192:195]
buffer_load_dwordx4 v251, s[12:15], s28 offen offset:0 lds
v_mfma_f32_16x16x32_bf16 v[196:199], v[240:243], v[40:43], v[196:199]
v_exp_f32 v222, v222
v_mfma_f32_16x16x32_bf16 v[196:199], v[244:247], v[44:47], v[196:199]
v_exp_f32 v223, v223
v_mfma_f32_16x16x32_bf16 v[200:203], v[240:243], v[72:75], v[200:203]
ds_read_b128 v[236:239], v248 offset:29184
v_cvt_pk_bf16_f32 v143, v222, v223
v_mfma_f32_16x16x32_bf16 v[200:203], v[244:247], v[76:79], v[200:203]
v_mfma_f32_16x16x32_bf16 v[204:207], v[240:243], v[104:107], v[204:207]
v_mfma_f32_16x16x32_bf16 v[204:207], v[244:247], v[108:111], v[204:207]
s_waitcnt lgkmcnt(2)
v_mfma_f32_16x16x32_bf16 v[192:195], v[224:227], v[16:19], v[192:195]
ds_read_b64_tr_b16 v[240:241], v249 offset:40960
v_mfma_f32_16x16x32_bf16 v[192:195], v[228:231], v[20:23], v[192:195]
buffer_load_dwordx4 v251, s[12:15], s28 offen offset:1024 lds
v_mfma_f32_16x16x32_bf16 v[196:199], v[224:227], v[48:51], v[196:199]
ds_read_b64_tr_b16 v[242:243], v249 offset:43008
v_mfma_f32_16x16x32_bf16 v[196:199], v[228:231], v[52:55], v[196:199]
v_mfma_f32_16x16x32_bf16 v[200:203], v[224:227], v[80:83], v[200:203]
ds_read_b64_tr_b16 v[244:245], v249 offset:57344
v_mfma_f32_16x16x32_bf16 v[200:203], v[228:231], v[84:87], v[200:203]
v_mfma_f32_16x16x32_bf16 v[204:207], v[224:227], v[112:115], v[204:207]
ds_read_b64_tr_b16 v[246:247], v249 offset:59392
v_mfma_f32_16x16x32_bf16 v[204:207], v[228:231], v[116:119], v[204:207]
s_waitcnt lgkmcnt(4)
v_mfma_f32_16x16x32_bf16 v[192:195], v[232:235], v[24:27], v[192:195]
ds_read_b64_tr_b16 v[224:225], v250 offset:40960
v_mfma_f32_16x16x32_bf16 v[192:195], v[236:239], v[28:31], v[192:195]
buffer_load_dwordx4 v251, s[12:15], s28 offen offset:2048 lds
v_mfma_f32_16x16x32_bf16 v[196:199], v[232:235], v[56:59], v[196:199]
ds_read_b64_tr_b16 v[226:227], v250 offset:43008
v_mfma_f32_16x16x32_bf16 v[196:199], v[236:239], v[60:63], v[196:199]
v_mfma_f32_16x16x32_bf16 v[200:203], v[232:235], v[88:91], v[200:203]
ds_read_b64_tr_b16 v[228:229], v250 offset:57344
v_mfma_f32_16x16x32_bf16 v[200:203], v[236:239], v[92:95], v[200:203]
v_mfma_f32_16x16x32_bf16 v[204:207], v[232:235], v[120:123], v[204:207]
ds_read_b64_tr_b16 v[230:231], v250 offset:59392
v_mfma_f32_16x16x32_bf16 v[204:207], v[236:239], v[124:127], v[204:207]
s_waitcnt lgkmcnt(4)
v_mfma_f32_16x16x32_bf16 a[128:131], v[240:243], v[160:163], a[128:131]
ds_read_b64_tr_b16 v[232:233], v249 offset:41472
v_mfma_f32_16x16x32_bf16 a[128:131], v[244:247], v[176:179], a[128:131]
buffer_load_dwordx4 v251, s[12:15], s28 offen offset:3072 lds
v_mfma_f32_16x16x32_bf16 a[132:135], v[240:243], v[164:167], a[132:135]
ds_read_b64_tr_b16 v[234:235], v249 offset:43520
v_mfma_f32_16x16x32_bf16 a[132:135], v[244:247], v[180:183], a[132:135]
s_add_u32 s28, s28, 0x4000
v_mfma_f32_16x16x32_bf16 a[136:139], v[240:243], v[168:171], a[136:139]
ds_read_b64_tr_b16 v[236:237], v249 offset:57856
v_mfma_f32_16x16x32_bf16 a[136:139], v[244:247], v[184:187], a[136:139]
v_exp_f32 v192, v192
v_mfma_f32_16x16x32_bf16 a[140:143], v[240:243], v[172:175], a[140:143]
ds_read_b64_tr_b16 v[238:239], v249 offset:59904
v_mfma_f32_16x16x32_bf16 a[140:143], v[244:247], v[188:191], a[140:143]
s_waitcnt lgkmcnt(4)
v_mfma_f32_16x16x32_bf16 a[144:147], v[224:227], v[160:163], a[144:147]
ds_read_b64_tr_b16 v[240:241], v250 offset:41472
v_mfma_f32_16x16x32_bf16 a[144:147], v[228:231], v[176:179], a[144:147]
v_exp_f32 v193, v193
v_mfma_f32_16x16x32_bf16 a[148:151], v[224:227], v[164:167], a[148:151]
ds_read_b64_tr_b16 v[242:243], v250 offset:43520
v_cvt_pk_bf16_f32 v144, v192, v193
v_mfma_f32_16x16x32_bf16 a[148:151], v[228:231], v[180:183], a[148:151]
v_exp_f32 v194, v194
v_mfma_f32_16x16x32_bf16 a[152:155], v[224:227], v[168:171], a[152:155]
ds_read_b64_tr_b16 v[244:245], v250 offset:57856
v_mfma_f32_16x16x32_bf16 a[152:155], v[228:231], v[184:187], a[152:155]
v_exp_f32 v195, v195
v_mfma_f32_16x16x32_bf16 a[156:159], v[224:227], v[172:175], a[156:159]
ds_read_b64_tr_b16 v[246:247], v250 offset:59904
v_cvt_pk_bf16_f32 v145, v194, v195
v_mfma_f32_16x16x32_bf16 a[156:159], v[228:231], v[188:191], a[156:159]
s_waitcnt lgkmcnt(4)
v_mfma_f32_16x16x32_bf16 a[160:163], v[232:235], v[160:163], a[160:163]
ds_read_b128 v[224:227], v248 offset:18432
v_mfma_f32_16x16x32_bf16 a[160:163], v[236:239], v[176:179], a[160:163]
v_exp_f32 v196, v196
v_mfma_f32_16x16x32_bf16 a[164:167], v[232:235], v[164:167], a[164:167]
v_exp_f32 v197, v197
v_mfma_f32_16x16x32_bf16 a[164:167], v[236:239], v[180:183], a[164:167]
v_exp_f32 v198, v198
v_mfma_f32_16x16x32_bf16 a[168:171], v[232:235], v[168:171], a[168:171]
ds_read_b128 v[228:231], v248 offset:18944
v_cvt_pk_bf16_f32 v148, v196, v197
v_mfma_f32_16x16x32_bf16 a[168:171], v[236:239], v[184:187], a[168:171]
v_exp_f32 v199, v199
v_mfma_f32_16x16x32_bf16 a[172:175], v[232:235], v[172:175], a[172:175]
v_exp_f32 v200, v200
v_mfma_f32_16x16x32_bf16 a[172:175], v[236:239], v[188:191], a[172:175]
s_waitcnt lgkmcnt(2)
v_cvt_pk_bf16_f32 v149, v198, v199
v_mfma_f32_16x16x32_bf16 a[176:179], v[240:243], v[160:163], a[176:179]
ds_read_b128 v[232:235], v248 offset:22528
v_mfma_f32_16x16x32_bf16 a[176:179], v[244:247], v[176:179], a[176:179]
v_exp_f32 v201, v201
v_mfma_f32_16x16x32_bf16 a[180:183], v[240:243], v[164:167], a[180:183]
v_exp_f32 v202, v202
v_mfma_f32_16x16x32_bf16 a[180:183], v[244:247], v[180:183], a[180:183]
v_exp_f32 v203, v203
v_mfma_f32_16x16x32_bf16 a[184:187], v[240:243], v[168:171], a[184:187]
ds_read_b128 v[236:239], v248 offset:23040
v_cvt_pk_bf16_f32 v152, v200, v201
v_mfma_f32_16x16x32_bf16 a[184:187], v[244:247], v[184:187], a[184:187]
v_cvt_pk_bf16_f32 v153, v202, v203
v_mfma_f32_16x16x32_bf16 a[188:191], v[240:243], v[172:175], a[188:191]
v_exp_f32 v204, v204
v_mfma_f32_16x16x32_bf16 a[188:191], v[244:247], v[188:191], a[188:191]
s_waitcnt lgkmcnt(2)
v_mfma_f32_16x16x32_bf16 v[208:211], v[224:227], v[0:3], 0
ds_read_b128 v[240:243], v248 offset:26624
v_mfma_f32_16x16x32_bf16 v[208:211], v[228:231], v[4:7], v[208:211]
v_exp_f32 v205, v205
v_mfma_f32_16x16x32_bf16 v[212:215], v[224:227], v[32:35], 0
v_exp_f32 v206, v206
v_mfma_f32_16x16x32_bf16 v[212:215], v[228:231], v[36:39], v[212:215]
v_exp_f32 v207, v207
v_mfma_f32_16x16x32_bf16 v[216:219], v[224:227], v[64:67], 0
ds_read_b128 v[244:247], v248 offset:27136
v_cvt_pk_bf16_f32 v156, v204, v205
v_mfma_f32_16x16x32_bf16 v[216:219], v[228:231], v[68:71], v[216:219]
v_cvt_pk_bf16_f32 v157, v206, v207
v_mfma_f32_16x16x32_bf16 v[220:223], v[224:227], v[96:99], 0
v_mfma_f32_16x16x32_bf16 v[220:223], v[228:231], v[100:103], v[220:223]
s_waitcnt lgkmcnt(2)
v_mfma_f32_16x16x32_bf16 v[208:211], v[232:235], v[8:11], v[208:211]
ds_read_b128 v[224:227], v248 offset:30720
v_mfma_f32_16x16x32_bf16 v[208:211], v[236:239], v[12:15], v[208:211]
v_mfma_f32_16x16x32_bf16 v[212:215], v[232:235], v[40:43], v[212:215]
v_mfma_f32_16x16x32_bf16 v[212:215], v[236:239], v[44:47], v[212:215]
v_mfma_f32_16x16x32_bf16 v[216:219], v[232:235], v[72:75], v[216:219]
ds_read_b128 v[228:231], v248 offset:31232
v_mfma_f32_16x16x32_bf16 v[216:219], v[236:239], v[76:79], v[216:219]
v_mfma_f32_16x16x32_bf16 v[220:223], v[232:235], v[104:107], v[220:223]
v_mfma_f32_16x16x32_bf16 v[220:223], v[236:239], v[108:111], v[220:223]
s_waitcnt lgkmcnt(2)
v_mfma_f32_16x16x32_bf16 v[208:211], v[240:243], v[16:19], v[208:211]
ds_read_b64_tr_b16 v[232:233], v249 offset:45056
v_mfma_f32_16x16x32_bf16 v[208:211], v[244:247], v[20:23], v[208:211]
v_mfma_f32_16x16x32_bf16 v[212:215], v[240:243], v[48:51], v[212:215]
ds_read_b64_tr_b16 v[234:235], v249 offset:47104
v_mfma_f32_16x16x32_bf16 v[212:215], v[244:247], v[52:55], v[212:215]
v_mfma_f32_16x16x32_bf16 v[216:219], v[240:243], v[80:83], v[216:219]
ds_read_b64_tr_b16 v[236:237], v249 offset:61440
v_mfma_f32_16x16x32_bf16 v[216:219], v[244:247], v[84:87], v[216:219]
v_mfma_f32_16x16x32_bf16 v[220:223], v[240:243], v[112:115], v[220:223]
ds_read_b64_tr_b16 v[238:239], v249 offset:63488
v_mfma_f32_16x16x32_bf16 v[220:223], v[244:247], v[116:119], v[220:223]
s_waitcnt lgkmcnt(4)
v_mfma_f32_16x16x32_bf16 v[208:211], v[224:227], v[24:27], v[208:211]
ds_read_b64_tr_b16 v[240:241], v250 offset:45056
v_mfma_f32_16x16x32_bf16 v[208:211], v[228:231], v[28:31], v[208:211]
v_mfma_f32_16x16x32_bf16 v[212:215], v[224:227], v[56:59], v[212:215]
ds_read_b64_tr_b16 v[242:243], v250 offset:47104
v_mfma_f32_16x16x32_bf16 v[212:215], v[228:231], v[60:63], v[212:215]
v_mfma_f32_16x16x32_bf16 v[216:219], v[224:227], v[88:91], v[216:219]
ds_read_b64_tr_b16 v[244:245], v250 offset:61440
v_mfma_f32_16x16x32_bf16 v[216:219], v[228:231], v[92:95], v[216:219]
v_mfma_f32_16x16x32_bf16 v[220:223], v[224:227], v[120:123], v[220:223]
ds_read_b64_tr_b16 v[246:247], v250 offset:63488
v_mfma_f32_16x16x32_bf16 v[220:223], v[228:231], v[124:127], v[220:223]
s_waitcnt lgkmcnt(4)
v_mfma_f32_16x16x32_bf16 a[192:195], v[232:235], v[160:163], a[192:195]
ds_read_b64_tr_b16 v[224:225], v249 offset:45568
v_mfma_f32_16x16x32_bf16 a[192:195], v[236:239], v[176:179], a[192:195]
v_mfma_f32_16x16x32_bf16 a[196:199], v[232:235], v[164:167], a[196:199]
ds_read_b64_tr_b16 v[226:227], v249 offset:47616
v_mfma_f32_16x16x32_bf16 a[196:199], v[236:239], v[180:183], a[196:199]
v_exp_f32 v208, v208
v_mfma_f32_16x16x32_bf16 a[200:203], v[232:235], v[168:171], a[200:203]
ds_read_b64_tr_b16 v[228:229], v249 offset:61952
v_mfma_f32_16x16x32_bf16 a[200:203], v[236:239], v[184:187], a[200:203]
v_exp_f32 v209, v209
v_mfma_f32_16x16x32_bf16 a[204:207], v[232:235], v[172:175], a[204:207]
ds_read_b64_tr_b16 v[230:231], v249 offset:64000
v_cvt_pk_bf16_f32 v146, v208, v209
v_mfma_f32_16x16x32_bf16 a[204:207], v[236:239], v[188:191], a[204:207]
s_waitcnt lgkmcnt(4)
v_mfma_f32_16x16x32_bf16 a[208:211], v[240:243], v[160:163], a[208:211]
ds_read_b64_tr_b16 v[232:233], v250 offset:45568
v_mfma_f32_16x16x32_bf16 a[208:211], v[244:247], v[176:179], a[208:211]
v_exp_f32 v210, v210
v_mfma_f32_16x16x32_bf16 a[212:215], v[240:243], v[164:167], a[212:215]
ds_read_b64_tr_b16 v[234:235], v250 offset:47616
v_mfma_f32_16x16x32_bf16 a[212:215], v[244:247], v[180:183], a[212:215]
v_exp_f32 v211, v211
v_mfma_f32_16x16x32_bf16 a[216:219], v[240:243], v[168:171], a[216:219]
ds_read_b64_tr_b16 v[236:237], v250 offset:61952
v_cvt_pk_bf16_f32 v147, v210, v211
v_mfma_f32_16x16x32_bf16 a[216:219], v[244:247], v[184:187], a[216:219]
v_exp_f32 v212, v212
v_mfma_f32_16x16x32_bf16 a[220:223], v[240:243], v[172:175], a[220:223]
ds_read_b64_tr_b16 v[238:239], v250 offset:64000
v_mfma_f32_16x16x32_bf16 a[220:223], v[244:247], v[188:191], a[220:223]
s_waitcnt lgkmcnt(4)
v_mfma_f32_16x16x32_bf16 a[224:227], v[224:227], v[160:163], a[224:227]
ds_read_b128 v[240:243], v248 offset:32768
v_mfma_f32_16x16x32_bf16 a[224:227], v[228:231], v[176:179], a[224:227]
v_exp_f32 v213, v213
v_mfma_f32_16x16x32_bf16 a[228:231], v[224:227], v[164:167], a[228:231]
v_exp_f32 v214, v214
v_mfma_f32_16x16x32_bf16 a[228:231], v[228:231], v[180:183], a[228:231]
v_exp_f32 v215, v215
v_mfma_f32_16x16x32_bf16 a[232:235], v[224:227], v[168:171], a[232:235]
ds_read_b128 v[244:247], v248 offset:33280
v_cvt_pk_bf16_f32 v150, v212, v213
v_mfma_f32_16x16x32_bf16 a[232:235], v[228:231], v[184:187], a[232:235]
v_cvt_pk_bf16_f32 v151, v214, v215
v_mfma_f32_16x16x32_bf16 a[236:239], v[224:227], v[172:175], a[236:239]
v_exp_f32 v216, v216
v_mfma_f32_16x16x32_bf16 a[236:239], v[228:231], v[188:191], a[236:239]
s_waitcnt lgkmcnt(2)
v_mfma_f32_16x16x32_bf16 a[240:243], v[232:235], v[160:163], a[240:243]
ds_read_b128 v[224:227], v248 offset:36864
v_mfma_f32_16x16x32_bf16 a[240:243], v[236:239], v[176:179], a[240:243]
v_exp_f32 v217, v217
v_mfma_f32_16x16x32_bf16 a[244:247], v[232:235], v[164:167], a[244:247]
v_exp_f32 v218, v218
v_mfma_f32_16x16x32_bf16 a[244:247], v[236:239], v[180:183], a[244:247]
v_exp_f32 v219, v219
v_mfma_f32_16x16x32_bf16 a[248:251], v[232:235], v[168:171], a[248:251]
ds_read_b128 v[228:231], v248 offset:37376
v_cvt_pk_bf16_f32 v154, v216, v217
v_mfma_f32_16x16x32_bf16 a[248:251], v[236:239], v[184:187], a[248:251]
v_cvt_pk_bf16_f32 v155, v218, v219
v_mfma_f32_16x16x32_bf16 a[252:255], v[232:235], v[172:175], a[252:255]
v_exp_f32 v220, v220
v_mfma_f32_16x16x32_bf16 a[252:255], v[236:239], v[188:191], a[252:255]
s_waitcnt lgkmcnt(2)
v_mfma_f32_16x16x32_bf16 v[192:195], v[240:243], v[0:3], 0
ds_read_b128 v[232:235], v248 offset:40960
v_mfma_f32_16x16x32_bf16 v[192:195], v[244:247], v[4:7], v[192:195]
v_xor_b32 v249, 0x10000, v249
v_mfma_f32_16x16x32_bf16 v[196:199], v[240:243], v[32:35], 0
v_exp_f32 v221, v221
v_mfma_f32_16x16x32_bf16 v[196:199], v[244:247], v[36:39], v[196:199]
v_xor_b32 v250, 0x10000, v250
v_cvt_pk_bf16_f32 v158, v220, v221
v_mfma_f32_16x16x32_bf16 v[200:203], v[240:243], v[64:67], 0
ds_read_b128 v[236:239], v248 offset:41472
v_mfma_f32_16x16x32_bf16 v[200:203], v[244:247], v[68:71], v[200:203]
v_exp_f32 v222, v222
v_mfma_f32_16x16x32_bf16 v[204:207], v[240:243], v[96:99], 0
v_exp_f32 v223, v223
v_mfma_f32_16x16x32_bf16 v[204:207], v[244:247], v[100:103], v[204:207]
s_waitcnt lgkmcnt(2)
v_cvt_pk_bf16_f32 v159, v222, v223
v_mfma_f32_16x16x32_bf16 v[192:195], v[224:227], v[8:11], v[192:195]
ds_read_b128 v[240:243], v248 offset:45056
v_mfma_f32_16x16x32_bf16 v[192:195], v[228:231], v[12:15], v[192:195]
v_mfma_f32_16x16x32_bf16 v[196:199], v[224:227], v[40:43], v[196:199]
v_mfma_f32_16x16x32_bf16 v[196:199], v[228:231], v[44:47], v[196:199]
v_mfma_f32_16x16x32_bf16 v[200:203], v[224:227], v[72:75], v[200:203]
ds_read_b128 v[244:247], v248 offset:45568
v_mfma_f32_16x16x32_bf16 v[200:203], v[228:231], v[76:79], v[200:203]
v_mfma_f32_16x16x32_bf16 v[204:207], v[224:227], v[104:107], v[204:207]
v_mfma_f32_16x16x32_bf16 v[204:207], v[228:231], v[108:111], v[204:207]
s_waitcnt lgkmcnt(2)
v_mfma_f32_16x16x32_bf16 v[192:195], v[232:235], v[16:19], v[192:195]
ds_read_b64_tr_b16 v[224:225], v249 offset:0
v_mfma_f32_16x16x32_bf16 v[192:195], v[236:239], v[20:23], v[192:195]
v_mfma_f32_16x16x32_bf16 v[196:199], v[232:235], v[48:51], v[196:199]
ds_read_b64_tr_b16 v[226:227], v249 offset:2048
v_mfma_f32_16x16x32_bf16 v[196:199], v[236:239], v[52:55], v[196:199]
v_mfma_f32_16x16x32_bf16 v[200:203], v[232:235], v[80:83], v[200:203]
ds_read_b64_tr_b16 v[228:229], v249 offset:16384
v_mfma_f32_16x16x32_bf16 v[200:203], v[236:239], v[84:87], v[200:203]
v_mfma_f32_16x16x32_bf16 v[204:207], v[232:235], v[112:115], v[204:207]
ds_read_b64_tr_b16 v[230:231], v249 offset:18432
v_mfma_f32_16x16x32_bf16 v[204:207], v[236:239], v[116:119], v[204:207]
s_waitcnt lgkmcnt(4)
v_mfma_f32_16x16x32_bf16 v[192:195], v[240:243], v[24:27], v[192:195]
ds_read_b64_tr_b16 v[232:233], v250 offset:0
v_mfma_f32_16x16x32_bf16 v[192:195], v[244:247], v[28:31], v[192:195]
v_mfma_f32_16x16x32_bf16 v[196:199], v[240:243], v[56:59], v[196:199]
ds_read_b64_tr_b16 v[234:235], v250 offset:2048
v_mfma_f32_16x16x32_bf16 v[196:199], v[244:247], v[60:63], v[196:199]
v_mfma_f32_16x16x32_bf16 v[200:203], v[240:243], v[88:91], v[200:203]
ds_read_b64_tr_b16 v[236:237], v250 offset:16384
v_mfma_f32_16x16x32_bf16 v[200:203], v[244:247], v[92:95], v[200:203]
s_sub_u32 s31, s31, 1
v_mfma_f32_16x16x32_bf16 v[204:207], v[240:243], v[120:123], v[204:207]
ds_read_b64_tr_b16 v[238:239], v250 offset:18432
v_mfma_f32_16x16x32_bf16 v[204:207], v[244:247], v[124:127], v[204:207]
s_cbranch_scc0 L2_loop
L2_tail_1:
s_cmp_eq_u32 s59, 6
s_cbranch_scc1 L2_tail_1_6
s_cmp_eq_u32 s59, 7
s_cbranch_scc1 L2_tail_1_7
L2_tail_1_5:
s_waitcnt lgkmcnt(4)
v_mfma_f32_16x16x32_bf16 a[0:3], v[224:227], v[160:163], a[0:3]
ds_read_b128 v[240:243], v248 offset:2048
v_mfma_f32_16x16x32_bf16 a[0:3], v[228:231], v[176:179], a[0:3]
v_mfma_f32_16x16x32_bf16 a[4:7], v[224:227], v[164:167], a[4:7]
v_mfma_f32_16x16x32_bf16 a[4:7], v[228:231], v[180:183], a[4:7]
v_exp_f32 v192, v192
v_mfma_f32_16x16x32_bf16 a[8:11], v[224:227], v[168:171], a[8:11]
ds_read_b128 v[244:247], v248 offset:2560
v_mfma_f32_16x16x32_bf16 a[8:11], v[228:231], v[184:187], a[8:11]
v_exp_f32 v193, v193
v_mfma_f32_16x16x32_bf16 a[12:15], v[224:227], v[172:175], a[12:15]
v_exp_f32 v194, v194
v_mfma_f32_16x16x32_bf16 a[12:15], v[228:231], v[188:191], a[12:15]
s_waitcnt lgkmcnt(2)
v_cvt_pk_bf16_f32 v128, v192, v193
v_mfma_f32_16x16x32_bf16 a[16:19], v[232:235], v[160:163], a[16:19]
ds_read_b128 v[224:227], v248 offset:6144
v_mfma_f32_16x16x32_bf16 a[16:19], v[236:239], v[176:179], a[16:19]
v_exp_f32 v195, v195
v_mfma_f32_16x16x32_bf16 a[20:23], v[232:235], v[164:167], a[20:23]
v_exp_f32 v196, v196
v_mfma_f32_16x16x32_bf16 a[20:23], v[236:239], v[180:183], a[20:23]
v_exp_f32 v197, v197
v_mfma_f32_16x16x32_bf16 a[24:27], v[232:235], v[168:171], a[24:27]
ds_read_b128 v[228:231], v248 offset:6656
v_cvt_pk_bf16_f32 v129, v194, v195
v_mfma_f32_16x16x32_bf16 a[24:27], v[236:239], v[184:187], a[24:27]
v_exp_f32 v198, v198
v_mfma_f32_16x16x32_bf16 a[28:31], v[232:235], v[172:175], a[28:31]
v_exp_f32 v199, v199
v_mfma_f32_16x16x32_bf16 a[28:31], v[236:239], v[188:191], a[28:31]
s_waitcnt lgkmcnt(2)
v_cvt_pk_bf16_f32 v132, v196, v197
v_mfma_f32_16x16x32_bf16 v[208:211], v[240:243], v[0:3], 0
ds_read_b128 v[232:235], v248 offset:10240
v_cvt_pk_bf16_f32 v133, v198, v199
v_mfma_f32_16x16x32_bf16 v[208:211], v[244:247], v[4:7], v[208:211]
v_exp_f32 v200, v200
v_mfma_f32_16x16x32_bf16 v[212:215], v[240:243], v[32:35], 0
v_exp_f32 v201, v201
v_mfma_f32_16x16x32_bf16 v[212:215], v[244:247], v[36:39], v[212:215]
v_exp_f32 v202, v202
v_mfma_f32_16x16x32_bf16 v[216:219], v[240:243], v[64:67], 0
ds_read_b128 v[236:239], v248 offset:10752
v_cvt_pk_bf16_f32 v136, v200, v201
v_mfma_f32_16x16x32_bf16 v[216:219], v[244:247], v[68:71], v[216:219]
v_exp_f32 v203, v203
v_mfma_f32_16x16x32_bf16 v[220:223], v[240:243], v[96:99], 0
v_exp_f32 v204, v204
v_mfma_f32_16x16x32_bf16 v[220:223], v[244:247], v[100:103], v[220:223]
s_waitcnt lgkmcnt(2)
v_cvt_pk_bf16_f32 v137, v202, v203
v_mfma_f32_16x16x32_bf16 v[208:211], v[224:227], v[8:11], v[208:211]
ds_read_b128 v[240:243], v248 offset:14336
v_mfma_f32_16x16x32_bf16 v[208:211], v[228:231], v[12:15], v[208:211]
v_exp_f32 v205, v205
v_mfma_f32_16x16x32_bf16 v[212:215], v[224:227], v[40:43], v[212:215]
v_exp_f32 v206, v206
v_mfma_f32_16x16x32_bf16 v[212:215], v[228:231], v[44:47], v[212:215]
v_exp_f32 v207, v207
v_mfma_f32_16x16x32_bf16 v[216:219], v[224:227], v[72:75], v[216:219]
ds_read_b128 v[244:247], v248 offset:14848
v_cvt_pk_bf16_f32 v140, v204, v205
v_mfma_f32_16x16x32_bf16 v[216:219], v[228:231], v[76:79], v[216:219]
v_cvt_pk_bf16_f32 v141, v206, v207
v_mfma_f32_16x16x32_bf16 v[220:223], v[224:227], v[104:107], v[220:223]
v_mfma_f32_16x16x32_bf16 v[220:223], v[228:231], v[108:111], v[220:223]
s_waitcnt lgkmcnt(2)
s_waitcnt vmcnt(0)
s_barrier
v_mfma_f32_16x16x32_bf16 v[208:211], v[232:235], v[16:19], v[208:211]
ds_read_b128 v[224:227], v248 offset:16384
v_mfma_f32_16x16x32_bf16 v[208:211], v[236:239], v[20:23], v[208:211]
v_mfma_f32_16x16x32_bf16 v[212:215], v[232:235], v[48:51], v[212:215]
v_mfma_f32_16x16x32_bf16 v[212:215], v[236:239], v[52:55], v[212:215]
v_mfma_f32_16x16x32_bf16 v[216:219], v[232:235], v[80:83], v[216:219]
ds_read_b128 v[228:231], v248 offset:16896
v_mfma_f32_16x16x32_bf16 v[216:219], v[236:239], v[84:87], v[216:219]
v_mfma_f32_16x16x32_bf16 v[220:223], v[232:235], v[112:115], v[220:223]
v_mfma_f32_16x16x32_bf16 v[220:223], v[236:239], v[116:119], v[220:223]
s_waitcnt lgkmcnt(2)
v_mfma_f32_16x16x32_bf16 v[208:211], v[240:243], v[24:27], v[208:211]
ds_read_b128 v[232:235], v248 offset:20480
v_mfma_f32_16x16x32_bf16 v[208:211], v[244:247], v[28:31], v[208:211]
v_mfma_f32_16x16x32_bf16 v[212:215], v[240:243], v[56:59], v[212:215]
v_mfma_f32_16x16x32_bf16 v[212:215], v[244:247], v[60:63], v[212:215]
v_mfma_f32_16x16x32_bf16 v[216:219], v[240:243], v[88:91], v[216:219]
ds_read_b128 v[236:239], v248 offset:20992
v_mfma_f32_16x16x32_bf16 v[216:219], v[244:247], v[92:95], v[216:219]
v_mfma_f32_16x16x32_bf16 v[220:223], v[240:243], v[120:123], v[220:223]
v_mfma_f32_16x16x32_bf16 v[220:223], v[244:247], v[124:127], v[220:223]
s_waitcnt lgkmcnt(2)
v_mfma_f32_16x16x32_bf16 v[192:195], v[224:227], v[0:3], 0
ds_read_b128 v[240:243], v248 offset:24576
v_mfma_f32_16x16x32_bf16 v[192:195], v[228:231], v[4:7], v[192:195]
v_exp_f32 v208, v208
v_mfma_f32_16x16x32_bf16 v[196:199], v[224:227], v[32:35], 0
v_exp_f32 v209, v209
v_mfma_f32_16x16x32_bf16 v[196:199], v[228:231], v[36:39], v[196:199]
v_exp_f32 v210, v210
v_mfma_f32_16x16x32_bf16 v[200:203], v[224:227], v[64:67], 0
ds_read_b128 v[244:247], v248 offset:25088
v_cvt_pk_bf16_f32 v130, v208, v209
v_mfma_f32_16x16x32_bf16 v[200:203], v[228:231], v[68:71], v[200:203]
v_exp_f32 v211, v211
v_mfma_f32_16x16x32_bf16 v[204:207], v[224:227], v[96:99], 0
v_exp_f32 v212, v212
v_mfma_f32_16x16x32_bf16 v[204:207], v[228:231], v[100:103], v[204:207]
s_waitcnt lgkmcnt(2)
v_cvt_pk_bf16_f32 v131, v210, v211
v_mfma_f32_16x16x32_bf16 v[192:195], v[232:235], v[8:11], v[192:195]
ds_read_b128 v[224:227], v248 offset:28672
v_mfma_f32_16x16x32_bf16 v[192:195], v[236:239], v[12:15], v[192:195]
v_exp_f32 v213, v213
v_mfma_f32_16x16x32_bf16 v[196:199], v[232:235], v[40:43], v[196:199]
v_exp_f32 v214, v214
v_mfma_f32_16x16x32_bf16 v[196:199], v[236:239], v[44:47], v[196:199]
v_exp_f32 v215, v215
v_mfma_f32_16x16x32_bf16 v[200:203], v[232:235], v[72:75], v[200:203]
ds_read_b128 v[228:231], v248 offset:29184
v_cvt_pk_bf16_f32 v134, v212, v213
v_mfma_f32_16x16x32_bf16 v[200:203], v[236:239], v[76:79], v[200:203]
v_cvt_pk_bf16_f32 v135, v214, v215
v_mfma_f32_16x16x32_bf16 v[204:207], v[232:235], v[104:107], v[204:207]
v_exp_f32 v216, v216
v_mfma_f32_16x16x32_bf16 v[204:207], v[236:239], v[108:111], v[204:207]
s_waitcnt lgkmcnt(2)
v_mfma_f32_16x16x32_bf16 v[192:195], v[240:243], v[16:19], v[192:195]
ds_read_b128 v[232:235], v248 offset:18432
v_mfma_f32_16x16x32_bf16 v[192:195], v[244:247], v[20:23], v[192:195]
v_exp_f32 v217, v217
v_mfma_f32_16x16x32_bf16 v[196:199], v[240:243], v[48:51], v[196:199]
v_exp_f32 v218, v218
v_mfma_f32_16x16x32_bf16 v[196:199], v[244:247], v[52:55], v[196:199]
v_exp_f32 v219, v219
v_mfma_f32_16x16x32_bf16 v[200:203], v[240:243], v[80:83], v[200:203]
ds_read_b128 v[236:239], v248 offset:18944
v_cvt_pk_bf16_f32 v138, v216, v217
v_mfma_f32_16x16x32_bf16 v[200:203], v[244:247], v[84:87], v[200:203]
v_cvt_pk_bf16_f32 v139, v218, v219
v_mfma_f32_16x16x32_bf16 v[204:207], v[240:243], v[112:115], v[204:207]
v_exp_f32 v220, v220
v_mfma_f32_16x16x32_bf16 v[204:207], v[244:247], v[116:119], v[204:207]
s_waitcnt lgkmcnt(2)
v_mfma_f32_16x16x32_bf16 v[192:195], v[224:227], v[24:27], v[192:195]
ds_read_b128 v[240:243], v248 offset:22528
v_mfma_f32_16x16x32_bf16 v[192:195], v[228:231], v[28:31], v[192:195]
v_exp_f32 v221, v221
v_mfma_f32_16x16x32_bf16 v[196:199], v[224:227], v[56:59], v[196:199]
v_exp_f32 v222, v222
v_mfma_f32_16x16x32_bf16 v[196:199], v[228:231], v[60:63], v[196:199]
v_exp_f32 v223, v223
v_mfma_f32_16x16x32_bf16 v[200:203], v[224:227], v[88:91], v[200:203]
ds_read_b128 v[244:247], v248 offset:23040
v_cvt_pk_bf16_f32 v142, v220, v221
v_mfma_f32_16x16x32_bf16 v[200:203], v[228:231], v[92:95], v[200:203]
v_cvt_pk_bf16_f32 v143, v222, v223
v_mfma_f32_16x16x32_bf16 v[204:207], v[224:227], v[120:123], v[204:207]
v_mfma_f32_16x16x32_bf16 v[204:207], v[228:231], v[124:127], v[204:207]
s_waitcnt lgkmcnt(2)
v_mfma_f32_16x16x32_bf16 v[208:211], v[232:235], v[0:3], 0
ds_read_b128 v[224:227], v248 offset:26624
v_mfma_f32_16x16x32_bf16 v[208:211], v[236:239], v[4:7], v[208:211]
v_exp_f32 v192, v192
v_mfma_f32_16x16x32_bf16 v[212:215], v[232:235], v[32:35], 0
v_exp_f32 v193, v193
v_mfma_f32_16x16x32_bf16 v[212:215], v[236:239], v[36:39], v[212:215]
v_exp_f32 v194, v194
v_mfma_f32_16x16x32_bf16 v[216:219], v[232:235], v[64:67], 0
ds_read_b128 v[228:231], v248 offset:27136
v_cvt_pk_bf16_f32 v144, v192, v193
v_mfma_f32_16x16x32_bf16 v[216:219], v[236:239], v[68:71], v[216:219]
v_exp_f32 v195, v195
v_mfma_f32_16x16x32_bf16 v[220:223], v[232:235], v[96:99], 0
v_exp_f32 v196, v196
v_mfma_f32_16x16x32_bf16 v[220:223], v[236:239], v[100:103], v[220:223]
s_waitcnt lgkmcnt(2)
v_cvt_pk_bf16_f32 v145, v194, v195
v_mfma_f32_16x16x32_bf16 v[208:211], v[240:243], v[8:11], v[208:211]
ds_read_b128 v[232:235], v248 offset:30720
v_mfma_f32_16x16x32_bf16 v[208:211], v[244:247], v[12:15], v[208:211]
v_exp_f32 v197, v197
v_mfma_f32_16x16x32_bf16 v[212:215], v[240:243], v[40:43], v[212:215]
v_exp_f32 v198, v198
v_mfma_f32_16x16x32_bf16 v[212:215], v[244:247], v[44:47], v[212:215]
v_exp_f32 v199, v199
v_mfma_f32_16x16x32_bf16 v[216:219], v[240:243], v[72:75], v[216:219]
ds_read_b128 v[236:239], v248 offset:31232
v_cvt_pk_bf16_f32 v148, v196, v197
v_mfma_f32_16x16x32_bf16 v[216:219], v[244:247], v[76:79], v[216:219]
v_cvt_pk_bf16_f32 v149, v198, v199
v_mfma_f32_16x16x32_bf16 v[220:223], v[240:243], v[104:107], v[220:223]
v_exp_f32 v200, v200
v_mfma_f32_16x16x32_bf16 v[220:223], v[244:247], v[108:111], v[220:223]
s_waitcnt lgkmcnt(2)
v_mfma_f32_16x16x32_bf16 v[208:211], v[224:227], v[16:19], v[208:211]
ds_read_b128 v[240:243], v248 offset:32768
v_mfma_f32_16x16x32_bf16 v[208:211], v[228:231], v[20:23], v[208:211]
v_exp_f32 v201, v201
v_mfma_f32_16x16x32_bf16 v[212:215], v[224:227], v[48:51], v[212:215]
v_exp_f32 v202, v202
v_mfma_f32_16x16x32_bf16 v[212:215], v[228:231], v[52:55], v[212:215]
v_exp_f32 v203, v203
v_mfma_f32_16x16x32_bf16 v[216:219], v[224:227], v[80:83], v[216:219]
ds_read_b128 v[244:247], v248 offset:33280
v_cvt_pk_bf16_f32 v152, v200, v201
v_mfma_f32_16x16x32_bf16 v[216:219], v[228:231], v[84:87], v[216:219]
v_cvt_pk_bf16_f32 v153, v202, v203
v_mfma_f32_16x16x32_bf16 v[220:223], v[224:227], v[112:115], v[220:223]
v_exp_f32 v204, v204
v_mfma_f32_16x16x32_bf16 v[220:223], v[228:231], v[116:119], v[220:223]
s_waitcnt lgkmcnt(2)
v_mfma_f32_16x16x32_bf16 v[208:211], v[232:235], v[24:27], v[208:211]
ds_read_b128 v[224:227], v248 offset:36864
v_mfma_f32_16x16x32_bf16 v[208:211], v[236:239], v[28:31], v[208:211]
v_exp_f32 v205, v205
v_mfma_f32_16x16x32_bf16 v[212:215], v[232:235], v[56:59], v[212:215]
v_exp_f32 v206, v206
v_mfma_f32_16x16x32_bf16 v[212:215], v[236:239], v[60:63], v[212:215]
v_exp_f32 v207, v207
v_mfma_f32_16x16x32_bf16 v[216:219], v[232:235], v[88:91], v[216:219]
ds_read_b128 v[228:231], v248 offset:37376
v_cvt_pk_bf16_f32 v156, v204, v205
v_mfma_f32_16x16x32_bf16 v[216:219], v[236:239], v[92:95], v[216:219]
v_cvt_pk_bf16_f32 v157, v206, v207
v_mfma_f32_16x16x32_bf16 v[220:223], v[232:235], v[120:123], v[220:223]
v_mfma_f32_16x16x32_bf16 v[220:223], v[236:239], v[124:127], v[220:223]
s_waitcnt lgkmcnt(2)
v_mfma_f32_16x16x32_bf16 v[192:195], v[240:243], v[0:3], 0
ds_read_b128 v[232:235], v248 offset:40960
v_mfma_f32_16x16x32_bf16 v[192:195], v[244:247], v[4:7], v[192:195]
v_exp_f32 v208, v208
v_mfma_f32_16x16x32_bf16 v[196:199], v[240:243], v[32:35], 0
v_exp_f32 v209, v209
v_mfma_f32_16x16x32_bf16 v[196:199], v[244:247], v[36:39], v[196:199]
v_exp_f32 v210, v210
v_mfma_f32_16x16x32_bf16 v[200:203], v[240:243], v[64:67], 0
ds_read_b128 v[236:239], v248 offset:41472
v_cvt_pk_bf16_f32 v146, v208, v209
v_mfma_f32_16x16x32_bf16 v[200:203], v[244:247], v[68:71], v[200:203]
v_exp_f32 v211, v211
v_mfma_f32_16x16x32_bf16 v[204:207], v[240:243], v[96:99], 0
v_exp_f32 v212, v212
v_mfma_f32_16x16x32_bf16 v[204:207], v[244:247], v[100:103], v[204:207]
s_waitcnt lgkmcnt(2)
v_cvt_pk_bf16_f32 v147, v210, v211
v_mfma_f32_16x16x32_bf16 v[192:195], v[224:227], v[8:11], v[192:195]
ds_read_b128 v[240:243], v248 offset:45056
v_mfma_f32_16x16x32_bf16 v[192:195], v[228:231], v[12:15], v[192:195]
v_exp_f32 v213, v213
v_mfma_f32_16x16x32_bf16 v[196:199], v[224:227], v[40:43], v[196:199]
v_exp_f32 v214, v214
v_mfma_f32_16x16x32_bf16 v[196:199], v[228:231], v[44:47], v[196:199]
v_exp_f32 v215, v215
v_mfma_f32_16x16x32_bf16 v[200:203], v[224:227], v[72:75], v[200:203]
ds_read_b128 v[244:247], v248 offset:45568
v_cvt_pk_bf16_f32 v150, v212, v213
v_mfma_f32_16x16x32_bf16 v[200:203], v[228:231], v[76:79], v[200:203]
v_cvt_pk_bf16_f32 v151, v214, v215
v_mfma_f32_16x16x32_bf16 v[204:207], v[224:227], v[104:107], v[204:207]
v_exp_f32 v216, v216
v_mfma_f32_16x16x32_bf16 v[204:207], v[228:231], v[108:111], v[204:207]
s_waitcnt lgkmcnt(2)
v_mfma_f32_16x16x32_bf16 v[192:195], v[232:235], v[16:19], v[192:195]
ds_read_b128 v[224:227], v248 offset:34816
v_mfma_f32_16x16x32_bf16 v[192:195], v[236:239], v[20:23], v[192:195]
v_exp_f32 v217, v217
v_mfma_f32_16x16x32_bf16 v[196:199], v[232:235], v[48:51], v[196:199]
v_exp_f32 v218, v218
v_mfma_f32_16x16x32_bf16 v[196:199], v[236:239], v[52:55], v[196:199]
v_exp_f32 v219, v219
v_mfma_f32_16x16x32_bf16 v[200:203], v[232:235], v[80:83], v[200:203]
ds_read_b128 v[228:231], v248 offset:35328
v_cvt_pk_bf16_f32 v154, v216, v217
v_mfma_f32_16x16x32_bf16 v[200:203], v[236:239], v[84:87], v[200:203]
v_cvt_pk_bf16_f32 v155, v218, v219
v_mfma_f32_16x16x32_bf16 v[204:207], v[232:235], v[112:115], v[204:207]
v_exp_f32 v220, v220
v_mfma_f32_16x16x32_bf16 v[204:207], v[236:239], v[116:119], v[204:207]
s_waitcnt lgkmcnt(2)
v_mfma_f32_16x16x32_bf16 v[192:195], v[240:243], v[24:27], v[192:195]
ds_read_b128 v[232:235], v248 offset:38912
v_mfma_f32_16x16x32_bf16 v[192:195], v[244:247], v[28:31], v[192:195]
v_exp_f32 v221, v221
v_mfma_f32_16x16x32_bf16 v[196:199], v[240:243], v[56:59], v[196:199]
v_exp_f32 v222, v222
v_mfma_f32_16x16x32_bf16 v[196:199], v[244:247], v[60:63], v[196:199]
v_exp_f32 v223, v223
v_mfma_f32_16x16x32_bf16 v[200:203], v[240:243], v[88:91], v[200:203]
ds_read_b128 v[236:239], v248 offset:39424
v_cvt_pk_bf16_f32 v158, v220, v221
v_mfma_f32_16x16x32_bf16 v[200:203], v[244:247], v[92:95], v[200:203]
v_cvt_pk_bf16_f32 v159, v222, v223
v_mfma_f32_16x16x32_bf16 v[204:207], v[240:243], v[120:123], v[204:207]
v_mfma_f32_16x16x32_bf16 v[204:207], v[244:247], v[124:127], v[204:207]
s_waitcnt lgkmcnt(2)
v_mfma_f32_16x16x32_bf16 v[208:211], v[224:227], v[0:3], 0
ds_read_b128 v[240:243], v248 offset:43008
v_mfma_f32_16x16x32_bf16 v[208:211], v[228:231], v[4:7], v[208:211]
v_exp_f32 v192, v192
v_mfma_f32_16x16x32_bf16 v[212:215], v[224:227], v[32:35], 0
v_exp_f32 v193, v193
v_mfma_f32_16x16x32_bf16 v[212:215], v[228:231], v[36:39], v[212:215]
v_exp_f32 v194, v194
v_mfma_f32_16x16x32_bf16 v[216:219], v[224:227], v[64:67], 0
ds_read_b128 v[244:247], v248 offset:43520
v_cvt_pk_bf16_f32 v0, v192, v193
v_mfma_f32_16x16x32_bf16 v[216:219], v[228:231], v[68:71], v[216:219]
v_exp_f32 v195, v195
v_mfma_f32_16x16x32_bf16 v[220:223], v[224:227], v[96:99], 0
v_exp_f32 v196, v196
v_mfma_f32_16x16x32_bf16 v[220:223], v[228:231], v[100:103], v[220:223]
s_waitcnt lgkmcnt(2)
v_cvt_pk_bf16_f32 v1, v194, v195
v_mfma_f32_16x16x32_bf16 v[208:211], v[232:235], v[8:11], v[208:211]
ds_read_b128 v[224:227], v248 offset:47104
v_mfma_f32_16x16x32_bf16 v[208:211], v[236:239], v[12:15], v[208:211]
v_exp_f32 v197, v197
v_mfma_f32_16x16x32_bf16 v[212:215], v[232:235], v[40:43], v[212:215]
v_exp_f32 v198, v198
v_mfma_f32_16x16x32_bf16 v[212:215], v[236:239], v[44:47], v[212:215]
v_exp_f32 v199, v199
v_mfma_f32_16x16x32_bf16 v[216:219], v[232:235], v[72:75], v[216:219]
ds_read_b128 v[228:231], v248 offset:47616
v_xor_b32 v12, 0x10000, v249
v_mfma_f32_16x16x32_bf16 v[216:219], v[236:239], v[76:79], v[216:219]
v_xor_b32 v13, 0x10000, v250
v_cvt_pk_bf16_f32 v32, v196, v197
v_mfma_f32_16x16x32_bf16 v[220:223], v[232:235], v[104:107], v[220:223]
v_cvt_pk_bf16_f32 v33, v198, v199
v_mfma_f32_16x16x32_bf16 v[220:223], v[236:239], v[108:111], v[220:223]
s_waitcnt lgkmcnt(2)
v_mfma_f32_16x16x32_bf16 v[208:211], v[240:243], v[16:19], v[208:211]
ds_read_b64_tr_b16 v[232:233], v12 offset:0
ds_read_b64_tr_b16 v[234:235], v12 offset:2048
v_mfma_f32_16x16x32_bf16 v[208:211], v[244:247], v[20:23], v[208:211]
v_exp_f32 v200, v200
v_mfma_f32_16x16x32_bf16 v[212:215], v[240:243], v[48:51], v[212:215]
v_exp_f32 v201, v201
v_mfma_f32_16x16x32_bf16 v[212:215], v[244:247], v[52:55], v[212:215]
v_exp_f32 v202, v202
v_mfma_f32_16x16x32_bf16 v[216:219], v[240:243], v[80:83], v[216:219]
ds_read_b64_tr_b16 v[236:237], v12 offset:16384
ds_read_b64_tr_b16 v[238:239], v12 offset:18432
v_mfma_f32_16x16x32_bf16 v[216:219], v[244:247], v[84:87], v[216:219]
v_exp_f32 v203, v203
v_mfma_f32_16x16x32_bf16 v[220:223], v[240:243], v[112:115], v[220:223]
v_cvt_pk_bf16_f32 v65, v202, v203
v_mfma_f32_16x16x32_bf16 v[220:223], v[244:247], v[116:119], v[220:223]
s_waitcnt lgkmcnt(4)
v_cvt_pk_bf16_f32 v64, v200, v201
v_mfma_f32_16x16x32_bf16 v[208:211], v[224:227], v[24:27], v[208:211]
ds_read_b64_tr_b16 v[240:241], v13 offset:0
ds_read_b64_tr_b16 v[242:243], v13 offset:2048
v_mfma_f32_16x16x32_bf16 v[208:211], v[228:231], v[28:31], v[208:211]
v_exp_f32 v204, v204
v_mfma_f32_16x16x32_bf16 v[212:215], v[224:227], v[56:59], v[212:215]
v_exp_f32 v205, v205
v_mfma_f32_16x16x32_bf16 v[212:215], v[228:231], v[60:63], v[212:215]
v_exp_f32 v206, v206
v_mfma_f32_16x16x32_bf16 v[216:219], v[224:227], v[88:91], v[216:219]
ds_read_b64_tr_b16 v[244:245], v13 offset:16384
ds_read_b64_tr_b16 v[246:247], v13 offset:18432
v_mfma_f32_16x16x32_bf16 v[216:219], v[228:231], v[92:95], v[216:219]
v_exp_f32 v207, v207
v_mfma_f32_16x16x32_bf16 v[220:223], v[224:227], v[120:123], v[220:223]
v_cvt_pk_bf16_f32 v97, v206, v207
v_mfma_f32_16x16x32_bf16 v[220:223], v[228:231], v[124:127], v[220:223]
s_waitcnt lgkmcnt(4)
v_cvt_pk_bf16_f32 v96, v204, v205
v_mfma_f32_16x16x32_bf16 a[0:3], v[232:235], v[128:131], a[0:3]
ds_read_b64_tr_b16 v[224:225], v249 offset:33280
ds_read_b64_tr_b16 v[226:227], v249 offset:35328
v_mfma_f32_16x16x32_bf16 a[0:3], v[236:239], v[144:147], a[0:3]
v_exp_f32 v208, v208
v_mfma_f32_16x16x32_bf16 a[4:7], v[232:235], v[132:135], a[4:7]
v_exp_f32 v209, v209
v_mfma_f32_16x16x32_bf16 a[4:7], v[236:239], v[148:151], a[4:7]
v_exp_f32 v210, v210
v_mfma_f32_16x16x32_bf16 a[8:11], v[232:235], v[136:139], a[8:11]
ds_read_b64_tr_b16 v[228:229], v249 offset:49664
ds_read_b64_tr_b16 v[230:231], v249 offset:51712
v_mfma_f32_16x16x32_bf16 a[8:11], v[236:239], v[152:155], a[8:11]
v_exp_f32 v211, v211
v_mfma_f32_16x16x32_bf16 a[12:15], v[232:235], v[140:143], a[12:15]
v_cvt_pk_bf16_f32 v3, v210, v211
v_mfma_f32_16x16x32_bf16 a[12:15], v[236:239], v[156:159], a[12:15]
s_waitcnt lgkmcnt(4)
v_cvt_pk_bf16_f32 v2, v208, v209
v_mfma_f32_16x16x32_bf16 a[16:19], v[240:243], v[128:131], a[16:19]
ds_read_b64_tr_b16 v[232:233], v12 offset:512
ds_read_b64_tr_b16 v[234:235], v12 offset:2560
v_mfma_f32_16x16x32_bf16 a[16:19], v[244:247], v[144:147], a[16:19]
v_exp_f32 v212, v212
v_mfma_f32_16x16x32_bf16 a[20:23], v[240:243], v[132:135], a[20:23]
v_exp_f32 v213, v213
v_mfma_f32_16x16x32_bf16 a[20:23], v[244:247], v[148:151], a[20:23]
v_exp_f32 v214, v214
v_mfma_f32_16x16x32_bf16 a[24:27], v[240:243], v[136:139], a[24:27]
ds_read_b64_tr_b16 v[236:237], v12 offset:16896
ds_read_b64_tr_b16 v[238:239], v12 offset:18944
v_mfma_f32_16x16x32_bf16 a[24:27], v[244:247], v[152:155], a[24:27]
v_exp_f32 v215, v215
v_mfma_f32_16x16x32_bf16 a[28:31], v[240:243], v[140:143], a[28:31]
v_cvt_pk_bf16_f32 v35, v214, v215
v_mfma_f32_16x16x32_bf16 a[28:31], v[244:247], v[156:159], a[28:31]
s_waitcnt lgkmcnt(4)
v_cvt_pk_bf16_f32 v34, v212, v213
v_mfma_f32_16x16x32_bf16 a[32:35], v[224:227], v[160:163], a[32:35]
ds_read_b64_tr_b16 v[240:241], v250 offset:33280
ds_read_b64_tr_b16 v[242:243], v250 offset:35328
v_mfma_f32_16x16x32_bf16 a[32:35], v[228:231], v[176:179], a[32:35]
v_exp_f32 v216, v216
v_mfma_f32_16x16x32_bf16 a[36:39], v[224:227], v[164:167], a[36:39]
v_exp_f32 v217, v217
v_mfma_f32_16x16x32_bf16 a[36:39], v[228:231], v[180:183], a[36:39]
v_exp_f32 v218, v218
v_mfma_f32_16x16x32_bf16 a[40:43], v[224:227], v[168:171], a[40:43]
ds_read_b64_tr_b16 v[244:245], v250 offset:49664
ds_read_b64_tr_b16 v[246:247], v250 offset:51712
v_mfma_f32_16x16x32_bf16 a[40:43], v[228:231], v[184:187], a[40:43]
v_exp_f32 v219, v219
v_mfma_f32_16x16x32_bf16 a[44:47], v[224:227], v[172:175], a[44:47]
v_cvt_pk_bf16_f32 v67, v218, v219
v_mfma_f32_16x16x32_bf16 a[44:47], v[228:231], v[188:191], a[44:47]
s_waitcnt lgkmcnt(4)
v_cvt_pk_bf16_f32 v66, v216, v217
v_mfma_f32_16x16x32_bf16 a[32:35], v[232:235], v[128:131], a[32:35]
ds_read_b64_tr_b16 v[224:225], v12 offset:32768
ds_read_b64_tr_b16 v[226:227], v12 offset:34816
v_mfma_f32_16x16x32_bf16 a[32:35], v[236:239], v[144:147], a[32:35]
v_exp_f32 v220, v220
v_mfma_f32_16x16x32_bf16 a[36:39], v[232:235], v[132:135], a[36:39]
v_exp_f32 v221, v221
v_mfma_f32_16x16x32_bf16 a[36:39], v[236:239], v[148:151], a[36:39]
v_exp_f32 v222, v222
v_mfma_f32_16x16x32_bf16 a[40:43], v[232:235], v[136:139], a[40:43]
ds_read_b64_tr_b16 v[228:229], v13 offset:32768
ds_read_b64_tr_b16 v[230:231], v13 offset:34816
v_mfma_f32_16x16x32_bf16 a[40:43], v[236:239], v[152:155], a[40:43]
v_exp_f32 v223, v223
v_mfma_f32_16x16x32_bf16 a[44:47], v[232:235], v[140:143], a[44:47]
v_cvt_pk_bf16_f32 v99, v222, v223
v_mfma_f32_16x16x32_bf16 a[44:47], v[236:239], v[156:159], a[44:47]
s_waitcnt lgkmcnt(4)
v_cvt_pk_bf16_f32 v98, v220, v221
v_mfma_f32_16x16x32_bf16 a[48:51], v[240:243], v[160:163], a[48:51]
ds_read_b64_tr_b16 v[232:233], v12 offset:33280
ds_read_b64_tr_b16 v[234:235], v12 offset:35328
v_mfma_f32_16x16x32_bf16 a[48:51], v[244:247], v[176:179], a[48:51]
v_mfma_f32_16x16x32_bf16 a[52:55], v[240:243], v[164:167], a[52:55]
v_mfma_f32_16x16x32_bf16 a[52:55], v[244:247], v[180:183], a[52:55]
v_mfma_f32_16x16x32_bf16 a[56:59], v[240:243], v[168:171], a[56:59]
ds_read_b64_tr_b16 v[236:237], v13 offset:33280
ds_read_b64_tr_b16 v[238:239], v13 offset:35328
v_mfma_f32_16x16x32_bf16 a[56:59], v[244:247], v[184:187], a[56:59]
v_mfma_f32_16x16x32_bf16 a[60:63], v[240:243], v[172:175], a[60:63]
v_mfma_f32_16x16x32_bf16 a[60:63], v[244:247], v[188:191], a[60:63]
s_waitcnt lgkmcnt(4)
v_mfma_f32_16x16x32_bf16 a[0:3], v[224:227], v[0:3], a[0:3]
ds_read_b64_tr_b16 v[240:241], v13 offset:512
ds_read_b64_tr_b16 v[242:243], v13 offset:2560
v_mfma_f32_16x16x32_bf16 a[4:7], v[224:227], v[32:35], a[4:7]
v_mfma_f32_16x16x32_bf16 a[8:11], v[224:227], v[64:67], a[8:11]
v_mfma_f32_16x16x32_bf16 a[12:15], v[224:227], v[96:99], a[12:15]
v_mfma_f32_16x16x32_bf16 a[16:19], v[228:231], v[0:3], a[16:19]
ds_read_b64_tr_b16 v[244:245], v13 offset:16896
ds_read_b64_tr_b16 v[246:247], v13 offset:18944
v_mfma_f32_16x16x32_bf16 a[20:23], v[228:231], v[32:35], a[20:23]
v_mfma_f32_16x16x32_bf16 a[24:27], v[228:231], v[64:67], a[24:27]
v_mfma_f32_16x16x32_bf16 a[28:31], v[228:231], v[96:99], a[28:31]
s_waitcnt lgkmcnt(4)
v_mfma_f32_16x16x32_bf16 a[32:35], v[232:235], v[0:3], a[32:35]
ds_read_b64_tr_b16 v[224:225], v249 offset:36864
ds_read_b64_tr_b16 v[226:227], v249 offset:38912
v_mfma_f32_16x16x32_bf16 a[36:39], v[232:235], v[32:35], a[36:39]
v_mfma_f32_16x16x32_bf16 a[40:43], v[232:235], v[64:67], a[40:43]
v_mfma_f32_16x16x32_bf16 a[44:47], v[232:235], v[96:99], a[44:47]
v_mfma_f32_16x16x32_bf16 a[48:51], v[236:239], v[0:3], a[48:51]
ds_read_b64_tr_b16 v[228:229], v249 offset:53248
ds_read_b64_tr_b16 v[230:231], v249 offset:55296
v_accvgpr_read_b32 v192, a0
v_mfma_f32_16x16x32_bf16 a[52:55], v[236:239], v[32:35], a[52:55]
v_accvgpr_read_b32 v193, a4
v_accvgpr_read_b32 v194, a8
v_accvgpr_read_b32 v195, a12
v_mfma_f32_16x16x32_bf16 a[56:59], v[236:239], v[64:67], a[56:59]
v_lshlrev_b32 v253, 2, v252
v_max3_u32 v254, v192, v193, v194
v_min3_u32 v255, v192, v193, v194
v_mfma_f32_16x16x32_bf16 a[60:63], v[236:239], v[96:99], a[60:63]
s_waitcnt lgkmcnt(4)
v_max_u32 v254, v254, v195
v_min_u32 v255, v255, v195
v_mfma_f32_16x16x32_bf16 a[48:51], v[240:243], v[128:131], a[48:51]
ds_read_b64_tr_b16 v[232:233], v12 offset:4096
ds_read_b64_tr_b16 v[234:235], v12 offset:6144
v_mfma_f32_16x16x32_bf16 a[48:51], v[244:247], v[144:147], a[48:51]
s_mov_b64 exec, 0xffff
buffer_store_dword v192, v253, s[24:27], s48 offen offset:4 sc1
buffer_store_dword v193, v253, s[24:27], s48 offen offset:1028 sc1
buffer_store_dword v194, v253, s[24:27], s48 offen offset:2052 sc1
buffer_store_dword v195, v253, s[24:27], s48 offen offset:3076 sc1
v_cmp_lt_u32 s[50:51], s52, v254
v_cmp_gt_u32 vcc, s53, v255
s_mov_b64 exec, -1
v_mfma_f32_16x16x32_bf16 a[52:55], v[240:243], v[132:135], a[52:55]
v_accvgpr_read_b32 v192, a0
v_accvgpr_read_b32 v193, a1
v_mfma_f32_16x16x32_bf16 a[52:55], v[244:247], v[148:151], a[52:55]
v_accvgpr_read_b32 v194, a2
v_accvgpr_read_b32 v195, a3
v_mfma_f32_16x16x32_bf16 a[56:59], v[240:243], v[136:139], a[56:59]
ds_read_b64_tr_b16 v[236:237], v12 offset:20480
ds_read_b64_tr_b16 v[238:239], v12 offset:22528
v_mfma_f32_16x16x32_bf16 a[56:59], v[244:247], v[152:155], a[56:59]
v_cvt_pk_bf16_f32 v16, v192, v193
v_cvt_pk_bf16_f32 v17, v194, v195
v_mfma_f32_16x16x32_bf16 a[60:63], v[240:243], v[140:143], a[60:63]
v_accvgpr_read_b32 v200, a4
v_accvgpr_read_b32 v201, a5
v_mfma_f32_16x16x32_bf16 a[60:63], v[244:247], v[156:159], a[60:63]
s_waitcnt lgkmcnt(4)
v_accvgpr_read_b32 v202, a6
v_mfma_f32_16x16x32_bf16 a[64:67], v[224:227], v[160:163], a[64:67]
ds_read_b64_tr_b16 v[240:241], v12 offset:36864
ds_read_b64_tr_b16 v[242:243], v12 offset:38912
v_mfma_f32_16x16x32_bf16 a[64:67], v[228:231], v[176:179], a[64:67]
v_accvgpr_read_b32 v203, a7
v_cvt_pk_bf16_f32 v48, v200, v201
v_mfma_f32_16x16x32_bf16 a[68:71], v[224:227], v[164:167], a[68:71]
v_cvt_pk_bf16_f32 v49, v202, v203
v_accvgpr_read_b32 v208, a8
v_mfma_f32_16x16x32_bf16 a[68:71], v[228:231], v[180:183], a[68:71]
v_accvgpr_read_b32 v209, a9
v_accvgpr_read_b32 v210, a10
v_mfma_f32_16x16x32_bf16 a[72:75], v[224:227], v[168:171], a[72:75]
ds_read_b64_tr_b16 v[244:245], v13 offset:36864
ds_read_b64_tr_b16 v[246:247], v13 offset:38912
v_mfma_f32_16x16x32_bf16 a[72:75], v[228:231], v[184:187], a[72:75]
v_accvgpr_read_b32 v211, a11
v_cvt_pk_bf16_f32 v80, v208, v209
v_mfma_f32_16x16x32_bf16 a[76:79], v[224:227], v[172:175], a[76:79]
v_cvt_pk_bf16_f32 v81, v210, v211
v_accvgpr_read_b32 v216, a12
v_mfma_f32_16x16x32_bf16 a[76:79], v[228:231], v[188:191], a[76:79]
s_waitcnt lgkmcnt(4)
v_accvgpr_read_b32 v217, a13
v_mfma_f32_16x16x32_bf16 a[64:67], v[232:235], v[128:131], a[64:67]
ds_read_b64_tr_b16 v[224:225], v250 offset:36864
ds_read_b64_tr_b16 v[226:227], v250 offset:38912
v_mfma_f32_16x16x32_bf16 a[64:67], v[236:239], v[144:147], a[64:67]
v_accvgpr_read_b32 v218, a14
v_accvgpr_read_b32 v219, a15
v_mfma_f32_16x16x32_bf16 a[68:71], v[232:235], v[132:135], a[68:71]
v_cvt_pk_bf16_f32 v112, v216, v217
v_cvt_pk_bf16_f32 v113, v218, v219
v_mfma_f32_16x16x32_bf16 a[68:71], v[236:239], v[148:151], a[68:71]
v_accvgpr_read_b32 v196, a16
v_accvgpr_read_b32 v197, a17
v_mfma_f32_16x16x32_bf16 a[72:75], v[232:235], v[136:139], a[72:75]
ds_read_b64_tr_b16 v[228:229], v250 offset:53248
ds_read_b64_tr_b16 v[230:231], v250 offset:55296
v_mfma_f32_16x16x32_bf16 a[72:75], v[236:239], v[152:155], a[72:75]
v_accvgpr_read_b32 v198, a18
v_accvgpr_read_b32 v199, a19
v_mfma_f32_16x16x32_bf16 a[76:79], v[232:235], v[140:143], a[76:79]
v_cvt_pk_bf16_f32 v18, v196, v197
v_cvt_pk_bf16_f32 v19, v198, v199
v_mfma_f32_16x16x32_bf16 a[76:79], v[236:239], v[156:159], a[76:79]
s_waitcnt lgkmcnt(4)
buffer_store_dwordx4 v[16:19], v252, s[20:23], s40 offen offset:0 sc1
v_mfma_f32_16x16x32_bf16 a[64:67], v[240:243], v[0:3], a[64:67]
ds_read_b64_tr_b16 v[232:233], v13 offset:4096
ds_read_b64_tr_b16 v[234:235], v13 offset:6144
v_mfma_f32_16x16x32_bf16 a[68:71], v[240:243], v[32:35], a[68:71]
v_accvgpr_read_b32 v204, a20
v_accvgpr_read_b32 v205, a21
v_mfma_f32_16x16x32_bf16 a[72:75], v[240:243], v[64:67], a[72:75]
v_accvgpr_read_b32 v206, a22
v_accvgpr_read_b32 v207, a23
v_mfma_f32_16x16x32_bf16 a[76:79], v[240:243], v[96:99], a[76:79]
v_cvt_pk_bf16_f32 v50, v204, v205
v_cvt_pk_bf16_f32 v51, v206, v207
v_mfma_f32_16x16x32_bf16 a[80:83], v[244:247], v[0:3], a[80:83]
ds_read_b64_tr_b16 v[236:237], v13 offset:20480
ds_read_b64_tr_b16 v[238:239], v13 offset:22528
v_mfma_f32_16x16x32_bf16 a[84:87], v[244:247], v[32:35], a[84:87]
buffer_store_dwordx4 v[48:51], v252, s[20:23], s41 offen offset:0 sc1
v_accvgpr_read_b32 v212, a24
v_mfma_f32_16x16x32_bf16 a[88:91], v[244:247], v[64:67], a[88:91]
v_accvgpr_read_b32 v213, a25
v_accvgpr_read_b32 v214, a26
v_mfma_f32_16x16x32_bf16 a[92:95], v[244:247], v[96:99], a[92:95]
s_waitcnt lgkmcnt(4)
v_accvgpr_read_b32 v215, a27
v_mfma_f32_16x16x32_bf16 a[80:83], v[224:227], v[160:163], a[80:83]
ds_read_b64_tr_b16 v[240:241], v249 offset:37376
ds_read_b64_tr_b16 v[242:243], v249 offset:39424
v_mfma_f32_16x16x32_bf16 a[80:83], v[228:231], v[176:179], a[80:83]
v_cvt_pk_bf16_f32 v82, v212, v213
v_cvt_pk_bf16_f32 v83, v214, v215
v_mfma_f32_16x16x32_bf16 a[84:87], v[224:227], v[164:167], a[84:87]
buffer_store_dwordx4 v[80:83], v252, s[20:23], s42 offen offset:0 sc1
v_accvgpr_read_b32 v220, a28
v_mfma_f32_16x16x32_bf16 a[84:87], v[228:231], v[180:183], a[84:87]
v_accvgpr_read_b32 v221, a29
v_accvgpr_read_b32 v222, a30
v_mfma_f32_16x16x32_bf16 a[88:91], v[224:227], v[168:171], a[88:91]
ds_read_b64_tr_b16 v[244:245], v249 offset:53760
ds_read_b64_tr_b16 v[246:247], v249 offset:55808
v_mfma_f32_16x16x32_bf16 a[88:91], v[228:231], v[184:187], a[88:91]
v_accvgpr_read_b32 v223, a31
v_cvt_pk_bf16_f32 v114, v220, v221
v_mfma_f32_16x16x32_bf16 a[92:95], v[224:227], v[172:175], a[92:95]
v_cvt_pk_bf16_f32 v115, v222, v223
buffer_store_dwordx4 v[112:115], v252, s[20:23], s43 offen offset:0 sc1
v_mfma_f32_16x16x32_bf16 a[92:95], v[228:231], v[188:191], a[92:95]
s_waitcnt lgkmcnt(4)
v_accvgpr_read_b32 v192, a32
v_mfma_f32_16x16x32_bf16 a[80:83], v[232:235], v[128:131], a[80:83]
ds_read_b64_tr_b16 v[224:225], v12 offset:4608
ds_read_b64_tr_b16 v[226:227], v12 offset:6656
v_mfma_f32_16x16x32_bf16 a[80:83], v[236:239], v[144:147], a[80:83]
v_accvgpr_read_b32 v193, a33
v_accvgpr_read_b32 v194, a34
v_mfma_f32_16x16x32_bf16 a[84:87], v[232:235], v[132:135], a[84:87]
v_accvgpr_read_b32 v195, a35
v_cvt_pk_bf16_f32 v20, v192, v193
v_mfma_f32_16x16x32_bf16 a[84:87], v[236:239], v[148:151], a[84:87]
v_cvt_pk_bf16_f32 v21, v194, v195
v_accvgpr_read_b32 v200, a36
v_mfma_f32_16x16x32_bf16 a[88:91], v[232:235], v[136:139], a[88:91]
ds_read_b64_tr_b16 v[228:229], v12 offset:20992
ds_read_b64_tr_b16 v[230:231], v12 offset:23040
v_mfma_f32_16x16x32_bf16 a[88:91], v[236:239], v[152:155], a[88:91]
v_accvgpr_read_b32 v201, a37
v_accvgpr_read_b32 v202, a38
v_mfma_f32_16x16x32_bf16 a[92:95], v[232:235], v[140:143], a[92:95]
v_accvgpr_read_b32 v203, a39
v_cvt_pk_bf16_f32 v52, v200, v201
v_mfma_f32_16x16x32_bf16 a[92:95], v[236:239], v[156:159], a[92:95]
s_waitcnt lgkmcnt(4)
v_cvt_pk_bf16_f32 v53, v202, v203
v_mfma_f32_16x16x32_bf16 a[96:99], v[240:243], v[160:163], a[96:99]
ds_read_b64_tr_b16 v[232:233], v12 offset:37376
ds_read_b64_tr_b16 v[234:235], v12 offset:39424
v_mfma_f32_16x16x32_bf16 a[96:99], v[244:247], v[176:179], a[96:99]
v_accvgpr_read_b32 v208, a40
v_accvgpr_read_b32 v209, a41
v_mfma_f32_16x16x32_bf16 a[100:103], v[240:243], v[164:167], a[100:103]
v_accvgpr_read_b32 v210, a42
v_accvgpr_read_b32 v211, a43
v_mfma_f32_16x16x32_bf16 a[100:103], v[244:247], v[180:183], a[100:103]
v_cvt_pk_bf16_f32 v84, v208, v209
v_cvt_pk_bf16_f32 v85, v210, v211
v_mfma_f32_16x16x32_bf16 a[104:107], v[240:243], v[168:171], a[104:107]
ds_read_b64_tr_b16 v[236:237], v13 offset:37376
ds_read_b64_tr_b16 v[238:239], v13 offset:39424
v_mfma_f32_16x16x32_bf16 a[104:107], v[244:247], v[184:187], a[104:107]
v_accvgpr_read_b32 v216, a44
v_accvgpr_read_b32 v217, a45
v_mfma_f32_16x16x32_bf16 a[108:111], v[240:243], v[172:175], a[108:111]
v_accvgpr_read_b32 v218, a46
v_accvgpr_read_b32 v219, a47
v_mfma_f32_16x16x32_bf16 a[108:111], v[244:247], v[188:191], a[108:111]
s_waitcnt lgkmcnt(4)
v_cvt_pk_bf16_f32 v116, v216, v217
v_mfma_f32_16x16x32_bf16 a[96:99], v[224:227], v[128:131], a[96:99]
ds_read_b64_tr_b16 v[240:241], v250 offset:37376
ds_read_b64_tr_b16 v[242:243], v250 offset:39424
v_mfma_f32_16x16x32_bf16 a[96:99], v[228:231], v[144:147], a[96:99]
v_cvt_pk_bf16_f32 v117, v218, v219
v_accvgpr_read_b32 v196, a48
v_mfma_f32_16x16x32_bf16 a[100:103], v[224:227], v[132:135], a[100:103]
v_accvgpr_read_b32 v197, a49
v_accvgpr_read_b32 v198, a50
v_mfma_f32_16x16x32_bf16 a[100:103], v[228:231], v[148:151], a[100:103]
v_accvgpr_read_b32 v199, a51
v_cvt_pk_bf16_f32 v22, v196, v197
v_mfma_f32_16x16x32_bf16 a[104:107], v[224:227], v[136:139], a[104:107]
ds_read_b64_tr_b16 v[244:245], v250 offset:53760
ds_read_b64_tr_b16 v[246:247], v250 offset:55808
v_mfma_f32_16x16x32_bf16 a[104:107], v[228:231], v[152:155], a[104:107]
v_cvt_pk_bf16_f32 v23, v198, v199
buffer_store_dwordx4 v[20:23], v252, s[20:23], s40 offen offset:1024 sc1
v_mfma_f32_16x16x32_bf16 a[108:111], v[224:227], v[140:143], a[108:111]
v_accvgpr_read_b32 v204, a52
v_accvgpr_read_b32 v205, a53
v_mfma_f32_16x16x32_bf16 a[108:111], v[228:231], v[156:159], a[108:111]
s_waitcnt lgkmcnt(4)
v_accvgpr_read_b32 v206, a54
v_mfma_f32_16x16x32_bf16 a[96:99], v[232:235], v[0:3], a[96:99]
ds_read_b64_tr_b16 v[224:225], v13 offset:4608
ds_read_b64_tr_b16 v[226:227], v13 offset:6656
v_mfma_f32_16x16x32_bf16 a[100:103], v[232:235], v[32:35], a[100:103]
v_accvgpr_read_b32 v207, a55
v_cvt_pk_bf16_f32 v54, v204, v205
v_mfma_f32_16x16x32_bf16 a[104:107], v[232:235], v[64:67], a[104:107]
v_cvt_pk_bf16_f32 v55, v206, v207
buffer_store_dwordx4 v[52:55], v252, s[20:23], s41 offen offset:1024 sc1
v_mfma_f32_16x16x32_bf16 a[108:111], v[232:235], v[96:99], a[108:111]
v_accvgpr_read_b32 v212, a56
v_accvgpr_read_b32 v213, a57
v_mfma_f32_16x16x32_bf16 a[112:115], v[236:239], v[0:3], a[112:115]
ds_read_b64_tr_b16 v[228:229], v13 offset:20992
ds_read_b64_tr_b16 v[230:231], v13 offset:23040
v_mfma_f32_16x16x32_bf16 a[116:119], v[236:239], v[32:35], a[116:119]
v_accvgpr_read_b32 v214, a58
v_accvgpr_read_b32 v215, a59
v_mfma_f32_16x16x32_bf16 a[120:123], v[236:239], v[64:67], a[120:123]
v_cvt_pk_bf16_f32 v86, v212, v213
v_cvt_pk_bf16_f32 v87, v214, v215
v_mfma_f32_16x16x32_bf16 a[124:127], v[236:239], v[96:99], a[124:127]
s_waitcnt lgkmcnt(4)
buffer_store_dwordx4 v[84:87], v252, s[20:23], s42 offen offset:1024 sc1
v_mfma_f32_16x16x32_bf16 a[112:115], v[240:243], v[160:163], a[112:115]
ds_read_b64_tr_b16 v[232:233], v249 offset:40960
ds_read_b64_tr_b16 v[234:235], v249 offset:43008
v_mfma_f32_16x16x32_bf16 a[112:115], v[244:247], v[176:179], a[112:115]
v_accvgpr_read_b32 v220, a60
v_accvgpr_read_b32 v221, a61
v_mfma_f32_16x16x32_bf16 a[116:119], v[240:243], v[164:167], a[116:119]
v_accvgpr_read_b32 v222, a62
v_accvgpr_read_b32 v223, a63
v_mfma_f32_16x16x32_bf16 a[116:119], v[244:247], v[180:183], a[116:119]
v_cvt_pk_bf16_f32 v118, v220, v221
v_cvt_pk_bf16_f32 v119, v222, v223
v_mfma_f32_16x16x32_bf16 a[120:123], v[240:243], v[168:171], a[120:123]
ds_read_b64_tr_b16 v[236:237], v249 offset:57344
ds_read_b64_tr_b16 v[238:239], v249 offset:59392
v_mfma_f32_16x16x32_bf16 a[120:123], v[244:247], v[184:187], a[120:123]
buffer_store_dwordx4 v[116:119], v252, s[20:23], s43 offen offset:1024 sc1
v_accvgpr_read_b32 v192, a64
v_mfma_f32_16x16x32_bf16 a[124:127], v[240:243], v[172:175], a[124:127]
v_accvgpr_read_b32 v193, a65
v_accvgpr_read_b32 v194, a66
v_mfma_f32_16x16x32_bf16 a[124:127], v[244:247], v[188:191], a[124:127]
s_waitcnt lgkmcnt(4)
v_accvgpr_read_b32 v195, a67
v_mfma_f32_16x16x32_bf16 a[112:115], v[224:227], v[128:131], a[112:115]
ds_read_b64_tr_b16 v[240:241], v12 offset:8192
ds_read_b64_tr_b16 v[242:243], v12 offset:10240
v_mfma_f32_16x16x32_bf16 a[112:115], v[228:231], v[144:147], a[112:115]
v_cvt_pk_bf16_f32 v24, v192, v193
v_cvt_pk_bf16_f32 v25, v194, v195
v_mfma_f32_16x16x32_bf16 a[116:119], v[224:227], v[132:135], a[116:119]
v_accvgpr_read_b32 v200, a68
v_accvgpr_read_b32 v201, a69
v_mfma_f32_16x16x32_bf16 a[116:119], v[228:231], v[148:151], a[116:119]
v_accvgpr_read_b32 v202, a70
v_accvgpr_read_b32 v203, a71
v_mfma_f32_16x16x32_bf16 a[120:123], v[224:227], v[136:139], a[120:123]
ds_read_b64_tr_b16 v[244:245], v12 offset:24576
ds_read_b64_tr_b16 v[246:247], v12 offset:26624
v_mfma_f32_16x16x32_bf16 a[120:123], v[228:231], v[152:155], a[120:123]
v_cvt_pk_bf16_f32 v56, v200, v201
v_cvt_pk_bf16_f32 v57, v202, v203
v_mfma_f32_16x16x32_bf16 a[124:127], v[224:227], v[140:143], a[124:127]
v_accvgpr_read_b32 v208, a72
v_accvgpr_read_b32 v209, a73
v_mfma_f32_16x16x32_bf16 a[124:127], v[228:231], v[156:159], a[124:127]
s_waitcnt lgkmcnt(4)
v_accvgpr_read_b32 v210, a74
v_mfma_f32_16x16x32_bf16 a[128:131], v[232:235], v[160:163], a[128:131]
ds_read_b64_tr_b16 v[224:225], v12 offset:40960
ds_read_b64_tr_b16 v[226:227], v12 offset:43008
v_mfma_f32_16x16x32_bf16 a[128:131], v[236:239], v[176:179], a[128:131]
v_accvgpr_read_b32 v211, a75
v_cvt_pk_bf16_f32 v88, v208, v209
v_mfma_f32_16x16x32_bf16 a[132:135], v[232:235], v[164:167], a[132:135]
v_cvt_pk_bf16_f32 v89, v210, v211
v_accvgpr_read_b32 v216, a76
v_mfma_f32_16x16x32_bf16 a[132:135], v[236:239], v[180:183], a[132:135]
v_accvgpr_read_b32 v217, a77
v_accvgpr_read_b32 v218, a78
v_mfma_f32_16x16x32_bf16 a[136:139], v[232:235], v[168:171], a[136:139]
ds_read_b64_tr_b16 v[228:229], v13 offset:40960
ds_read_b64_tr_b16 v[230:231], v13 offset:43008
v_mfma_f32_16x16x32_bf16 a[136:139], v[236:239], v[184:187], a[136:139]
v_accvgpr_read_b32 v219, a79
v_cvt_pk_bf16_f32 v120, v216, v217
v_mfma_f32_16x16x32_bf16 a[140:143], v[232:235], v[172:175], a[140:143]
v_cvt_pk_bf16_f32 v121, v218, v219
v_accvgpr_read_b32 v196, a80
v_mfma_f32_16x16x32_bf16 a[140:143], v[236:239], v[188:191], a[140:143]
s_waitcnt lgkmcnt(4)
v_accvgpr_read_b32 v197, a81
v_mfma_f32_16x16x32_bf16 a[128:131], v[240:243], v[128:131], a[128:131]
ds_read_b64_tr_b16 v[232:233], v250 offset:40960
ds_read_b64_tr_b16 v[234:235], v250 offset:43008
v_mfma_f32_16x16x32_bf16 a[128:131], v[244:247], v[144:147], a[128:131]
v_accvgpr_read_b32 v198, a82
v_accvgpr_read_b32 v199, a83
v_mfma_f32_16x16x32_bf16 a[132:135], v[240:243], v[132:135], a[132:135]
v_cvt_pk_bf16_f32 v26, v196, v197
v_cvt_pk_bf16_f32 v27, v198, v199
v_mfma_f32_16x16x32_bf16 a[132:135], v[244:247], v[148:151], a[132:135]
buffer_store_dwordx4 v[24:27], v252, s[20:23], s40 offen offset:2048 sc1
v_accvgpr_read_b32 v204, a84
v_mfma_f32_16x16x32_bf16 a[136:139], v[240:243], v[136:139], a[136:139]
ds_read_b64_tr_b16 v[236:237], v250 offset:57344
ds_read_b64_tr_b16 v[238:239], v250 offset:59392
v_mfma_f32_16x16x32_bf16 a[136:139], v[244:247], v[152:155], a[136:139]
v_accvgpr_read_b32 v205, a85
v_accvgpr_read_b32 v206, a86
v_mfma_f32_16x16x32_bf16 a[140:143], v[240:243], v[140:143], a[140:143]
v_accvgpr_read_b32 v207, a87
v_cvt_pk_bf16_f32 v58, v204, v205
v_mfma_f32_16x16x32_bf16 a[140:143], v[244:247], v[156:159], a[140:143]
s_waitcnt lgkmcnt(4)
v_cvt_pk_bf16_f32 v59, v206, v207
v_mfma_f32_16x16x32_bf16 a[128:131], v[224:227], v[0:3], a[128:131]
ds_read_b64_tr_b16 v[240:241], v13 offset:8192
ds_read_b64_tr_b16 v[242:243], v13 offset:10240
v_mfma_f32_16x16x32_bf16 a[132:135], v[224:227], v[32:35], a[132:135]
buffer_store_dwordx4 v[56:59], v252, s[20:23], s41 offen offset:2048 sc1
v_accvgpr_read_b32 v212, a88
v_mfma_f32_16x16x32_bf16 a[136:139], v[224:227], v[64:67], a[136:139]
v_accvgpr_read_b32 v213, a89
v_accvgpr_read_b32 v214, a90
v_mfma_f32_16x16x32_bf16 a[140:143], v[224:227], v[96:99], a[140:143]
v_accvgpr_read_b32 v215, a91
v_cvt_pk_bf16_f32 v90, v212, v213
v_mfma_f32_16x16x32_bf16 a[144:147], v[228:231], v[0:3], a[144:147]
ds_read_b64_tr_b16 v[244:245], v13 offset:24576
ds_read_b64_tr_b16 v[246:247], v13 offset:26624
v_mfma_f32_16x16x32_bf16 a[148:151], v[228:231], v[32:35], a[148:151]
v_cvt_pk_bf16_f32 v91, v214, v215
buffer_store_dwordx4 v[88:91], v252, s[20:23], s42 offen offset:2048 sc1
v_mfma_f32_16x16x32_bf16 a[152:155], v[228:231], v[64:67], a[152:155]
v_accvgpr_read_b32 v220, a92
v_accvgpr_read_b32 v221, a93
v_mfma_f32_16x16x32_bf16 a[156:159], v[228:231], v[96:99], a[156:159]
s_waitcnt lgkmcnt(4)
v_accvgpr_read_b32 v222, a94
v_mfma_f32_16x16x32_bf16 a[144:147], v[232:235], v[160:163], a[144:147]
ds_read_b64_tr_b16 v[224:225], v249 offset:41472
ds_read_b64_tr_b16 v[226:227], v249 offset:43520
v_mfma_f32_16x16x32_bf16 a[144:147], v[236:239], v[176:179], a[144:147]
v_accvgpr_read_b32 v223, a95
v_cvt_pk_bf16_f32 v122, v220, v221
v_mfma_f32_16x16x32_bf16 a[148:151], v[232:235], v[164:167], a[148:151]
v_cvt_pk_bf16_f32 v123, v222, v223
buffer_store_dwordx4 v[120:123], v252, s[20:23], s43 offen offset:2048 sc1
v_mfma_f32_16x16x32_bf16 a[148:151], v[236:239], v[180:183], a[148:151]
v_accvgpr_read_b32 v192, a96
v_accvgpr_read_b32 v193, a97
v_mfma_f32_16x16x32_bf16 a[152:155], v[232:235], v[168:171], a[152:155]
ds_read_b64_tr_b16 v[228:229], v249 offset:57856
ds_read_b64_tr_b16 v[230:231], v249 offset:59904
v_mfma_f32_16x16x32_bf16 a[152:155], v[236:239], v[184:187], a[152:155]
v_accvgpr_read_b32 v194, a98
v_accvgpr_read_b32 v195, a99
v_mfma_f32_16x16x32_bf16 a[156:159], v[232:235], v[172:175], a[156:159]
v_cvt_pk_bf16_f32 v28, v192, v193
v_cvt_pk_bf16_f32 v29, v194, v195
v_mfma_f32_16x16x32_bf16 a[156:159], v[236:239], v[188:191], a[156:159]
s_waitcnt lgkmcnt(4)
v_accvgpr_read_b32 v200, a100
v_mfma_f32_16x16x32_bf16 a[144:147], v[240:243], v[128:131], a[144:147]
ds_read_b64_tr_b16 v[232:233], v12 offset:8704
ds_read_b64_tr_b16 v[234:235], v12 offset:10752
v_mfma_f32_16x16x32_bf16 a[144:147], v[244:247], v[144:147], a[144:147]
v_accvgpr_read_b32 v201, a101
v_accvgpr_read_b32 v202, a102
v_mfma_f32_16x16x32_bf16 a[148:151], v[240:243], v[132:135], a[148:151]
v_accvgpr_read_b32 v203, a103
v_cvt_pk_bf16_f32 v60, v200, v201
v_mfma_f32_16x16x32_bf16 a[148:151], v[244:247], v[148:151], a[148:151]
v_cvt_pk_bf16_f32 v61, v202, v203
v_accvgpr_read_b32 v208, a104
v_mfma_f32_16x16x32_bf16 a[152:155], v[240:243], v[136:139], a[152:155]
ds_read_b64_tr_b16 v[236:237], v12 offset:25088
ds_read_b64_tr_b16 v[238:239], v12 offset:27136
v_mfma_f32_16x16x32_bf16 a[152:155], v[244:247], v[152:155], a[152:155]
v_accvgpr_read_b32 v209, a105
v_accvgpr_read_b32 v210, a106
v_mfma_f32_16x16x32_bf16 a[156:159], v[240:243], v[140:143], a[156:159]
v_accvgpr_read_b32 v211, a107
v_cvt_pk_bf16_f32 v92, v208, v209
v_mfma_f32_16x16x32_bf16 a[156:159], v[244:247], v[156:159], a[156:159]
s_waitcnt lgkmcnt(4)
v_cvt_pk_bf16_f32 v93, v210, v211
v_mfma_f32_16x16x32_bf16 a[160:163], v[224:227], v[160:163], a[160:163]
ds_read_b64_tr_b16 v[240:241], v12 offset:41472
ds_read_b64_tr_b16 v[242:243], v12 offset:43520
v_mfma_f32_16x16x32_bf16 a[160:163], v[228:231], v[176:179], a[160:163]
v_accvgpr_read_b32 v216, a108
v_accvgpr_read_b32 v217, a109
v_mfma_f32_16x16x32_bf16 a[164:167], v[224:227], v[164:167], a[164:167]
v_accvgpr_read_b32 v218, a110
v_accvgpr_read_b32 v219, a111
v_mfma_f32_16x16x32_bf16 a[164:167], v[228:231], v[180:183], a[164:167]
v_cvt_pk_bf16_f32 v124, v216, v217
v_cvt_pk_bf16_f32 v125, v218, v219
v_mfma_f32_16x16x32_bf16 a[168:171], v[224:227], v[168:171], a[168:171]
ds_read_b64_tr_b16 v[244:245], v13 offset:41472
ds_read_b64_tr_b16 v[246:247], v13 offset:43520
v_mfma_f32_16x16x32_bf16 a[168:171], v[228:231], v[184:187], a[168:171]
v_accvgpr_read_b32 v196, a112
v_accvgpr_read_b32 v197, a113
v_mfma_f32_16x16x32_bf16 a[172:175], v[224:227], v[172:175], a[172:175]
v_accvgpr_read_b32 v198, a114
v_accvgpr_read_b32 v199, a115
v_mfma_f32_16x16x32_bf16 a[172:175], v[228:231], v[188:191], a[172:175]
s_waitcnt lgkmcnt(4)
v_cvt_pk_bf16_f32 v30, v196, v197
v_mfma_f32_16x16x32_bf16 a[160:163], v[232:235], v[128:131], a[160:163]
ds_read_b64_tr_b16 v[224:225], v250 offset:41472
ds_read_b64_tr_b16 v[226:227], v250 offset:43520
v_mfma_f32_16x16x32_bf16 a[160:163], v[236:239], v[144:147], a[160:163]
v_cvt_pk_bf16_f32 v31, v198, v199
buffer_store_dwordx4 v[28:31], v252, s[20:23], s40 offen offset:3072 sc1
v_mfma_f32_16x16x32_bf16 a[164:167], v[232:235], v[132:135], a[164:167]
v_accvgpr_read_b32 v204, a116
v_accvgpr_read_b32 v205, a117
v_mfma_f32_16x16x32_bf16 a[164:167], v[236:239], v[148:151], a[164:167]
v_accvgpr_read_b32 v206, a118
v_accvgpr_read_b32 v207, a119
v_mfma_f32_16x16x32_bf16 a[168:171], v[232:235], v[136:139], a[168:171]
ds_read_b64_tr_b16 v[228:229], v250 offset:57856
ds_read_b64_tr_b16 v[230:231], v250 offset:59904
v_mfma_f32_16x16x32_bf16 a[168:171], v[236:239], v[152:155], a[168:171]
v_cvt_pk_bf16_f32 v62, v204, v205
v_cvt_pk_bf16_f32 v63, v206, v207
v_mfma_f32_16x16x32_bf16 a[172:175], v[232:235], v[140:143], a[172:175]
buffer_store_dwordx4 v[60:63], v252, s[20:23], s41 offen offset:3072 sc1
v_accvgpr_read_b32 v212, a120
v_mfma_f32_16x16x32_bf16 a[172:175], v[236:239], v[156:159], a[172:175]
s_waitcnt lgkmcnt(4)
v_accvgpr_read_b32 v213, a121
v_mfma_f32_16x16x32_bf16 a[160:163], v[240:243], v[0:3], a[160:163]
ds_read_b64_tr_b16 v[232:233], v13 offset:8704
ds_read_b64_tr_b16 v[234:235], v13 offset:10752
v_mfma_f32_16x16x32_bf16 a[164:167], v[240:243], v[32:35], a[164:167]
v_accvgpr_read_b32 v214, a122
v_accvgpr_read_b32 v215, a123
v_mfma_f32_16x16x32_bf16 a[168:171], v[240:243], v[64:67], a[168:171]
v_cvt_pk_bf16_f32 v94, v212, v213
v_cvt_pk_bf16_f32 v95, v214, v215
v_mfma_f32_16x16x32_bf16 a[172:175], v[240:243], v[96:99], a[172:175]
buffer_store_dwordx4 v[92:95], v252, s[20:23], s42 offen offset:3072 sc1
v_accvgpr_read_b32 v220, a124
v_mfma_f32_16x16x32_bf16 a[176:179], v[244:247], v[0:3], a[176:179]
ds_read_b64_tr_b16 v[236:237], v13 offset:25088
ds_read_b64_tr_b16 v[238:239], v13 offset:27136
v_mfma_f32_16x16x32_bf16 a[180:183], v[244:247], v[32:35], a[180:183]
v_accvgpr_read_b32 v221, a125
v_accvgpr_read_b32 v222, a126
v_mfma_f32_16x16x32_bf16 a[184:187], v[244:247], v[64:67], a[184:187]
v_accvgpr_read_b32 v223, a127
v_cvt_pk_bf16_f32 v126, v220, v221
v_mfma_f32_16x16x32_bf16 a[188:191], v[244:247], v[96:99], a[188:191]
s_waitcnt lgkmcnt(4)
v_cvt_pk_bf16_f32 v127, v222, v223
v_mfma_f32_16x16x32_bf16 a[176:179], v[224:227], v[160:163], a[176:179]
ds_read_b64_tr_b16 v[240:241], v249 offset:45056
ds_read_b64_tr_b16 v[242:243], v249 offset:47104
v_mfma_f32_16x16x32_bf16 a[176:179], v[228:231], v[176:179], a[176:179]
buffer_store_dwordx4 v[124:127], v252, s[20:23], s43 offen offset:3072 sc1
v_accvgpr_read_b32 v192, a128
v_mfma_f32_16x16x32_bf16 a[180:183], v[224:227], v[164:167], a[180:183]
v_accvgpr_read_b32 v193, a129
v_accvgpr_read_b32 v194, a130
v_mfma_f32_16x16x32_bf16 a[180:183], v[228:231], v[180:183], a[180:183]
v_accvgpr_read_b32 v195, a131
v_cvt_pk_bf16_f32 v16, v192, v193
v_mfma_f32_16x16x32_bf16 a[184:187], v[224:227], v[168:171], a[184:187]
ds_read_b64_tr_b16 v[244:245], v249 offset:61440
ds_read_b64_tr_b16 v[246:247], v249 offset:63488
v_mfma_f32_16x16x32_bf16 a[184:187], v[228:231], v[184:187], a[184:187]
v_cvt_pk_bf16_f32 v17, v194, v195
v_accvgpr_read_b32 v200, a132
v_mfma_f32_16x16x32_bf16 a[188:191], v[224:227], v[172:175], a[188:191]
v_accvgpr_read_b32 v201, a133
v_accvgpr_read_b32 v202, a134
v_mfma_f32_16x16x32_bf16 a[188:191], v[228:231], v[188:191], a[188:191]
s_waitcnt lgkmcnt(4)
v_accvgpr_read_b32 v203, a135
v_mfma_f32_16x16x32_bf16 a[176:179], v[232:235], v[128:131], a[176:179]
ds_read_b64_tr_b16 v[224:225], v12 offset:12288
ds_read_b64_tr_b16 v[226:227], v12 offset:14336
v_mfma_f32_16x16x32_bf16 a[176:179], v[236:239], v[144:147], a[176:179]
v_cvt_pk_bf16_f32 v48, v200, v201
v_cvt_pk_bf16_f32 v49, v202, v203
v_mfma_f32_16x16x32_bf16 a[180:183], v[232:235], v[132:135], a[180:183]
v_accvgpr_read_b32 v208, a136
v_accvgpr_read_b32 v209, a137
v_mfma_f32_16x16x32_bf16 a[180:183], v[236:239], v[148:151], a[180:183]
v_accvgpr_read_b32 v210, a138
v_accvgpr_read_b32 v211, a139
v_mfma_f32_16x16x32_bf16 a[184:187], v[232:235], v[136:139], a[184:187]
ds_read_b64_tr_b16 v[228:229], v12 offset:28672
ds_read_b64_tr_b16 v[230:231], v12 offset:30720
v_mfma_f32_16x16x32_bf16 a[184:187], v[236:239], v[152:155], a[184:187]
v_cvt_pk_bf16_f32 v80, v208, v209
v_cvt_pk_bf16_f32 v81, v210, v211
v_mfma_f32_16x16x32_bf16 a[188:191], v[232:235], v[140:143], a[188:191]
v_accvgpr_read_b32 v216, a140
v_accvgpr_read_b32 v217, a141
v_mfma_f32_16x16x32_bf16 a[188:191], v[236:239], v[156:159], a[188:191]
s_waitcnt lgkmcnt(4)
v_accvgpr_read_b32 v218, a142
v_mfma_f32_16x16x32_bf16 a[192:195], v[240:243], v[160:163], a[192:195]
ds_read_b64_tr_b16 v[232:233], v12 offset:45056
ds_read_b64_tr_b16 v[234:235], v12 offset:47104
v_mfma_f32_16x16x32_bf16 a[192:195], v[244:247], v[176:179], a[192:195]
v_accvgpr_read_b32 v219, a143
v_cvt_pk_bf16_f32 v112, v216, v217
v_mfma_f32_16x16x32_bf16 a[196:199], v[240:243], v[164:167], a[196:199]
v_cvt_pk_bf16_f32 v113, v218, v219
v_accvgpr_read_b32 v196, a144
v_mfma_f32_16x16x32_bf16 a[196:199], v[244:247], v[180:183], a[196:199]
v_accvgpr_read_b32 v197, a145
v_accvgpr_read_b32 v198, a146
v_mfma_f32_16x16x32_bf16 a[200:203], v[240:243], v[168:171], a[200:203]
ds_read_b64_tr_b16 v[236:237], v13 offset:45056
ds_read_b64_tr_b16 v[238:239], v13 offset:47104
v_mfma_f32_16x16x32_bf16 a[200:203], v[244:247], v[184:187], a[200:203]
v_accvgpr_read_b32 v199, a147
v_cvt_pk_bf16_f32 v18, v196, v197
v_mfma_f32_16x16x32_bf16 a[204:207], v[240:243], v[172:175], a[204:207]
v_cvt_pk_bf16_f32 v19, v198, v199
buffer_store_dwordx4 v[16:19], v252, s[20:23], s44 offen offset:0 sc1
v_mfma_f32_16x16x32_bf16 a[204:207], v[244:247], v[188:191], a[204:207]
s_waitcnt lgkmcnt(4)
v_accvgpr_read_b32 v204, a148
v_mfma_f32_16x16x32_bf16 a[192:195], v[224:227], v[128:131], a[192:195]
ds_read_b64_tr_b16 v[240:241], v250 offset:45056
ds_read_b64_tr_b16 v[242:243], v250 offset:47104
v_mfma_f32_16x16x32_bf16 a[192:195], v[228:231], v[144:147], a[192:195]
v_accvgpr_read_b32 v205, a149
v_accvgpr_read_b32 v206, a150
v_mfma_f32_16x16x32_bf16 a[196:199], v[224:227], v[132:135], a[196:199]
v_accvgpr_read_b32 v207, a151
v_cvt_pk_bf16_f32 v50, v204, v205
v_mfma_f32_16x16x32_bf16 a[196:199], v[228:231], v[148:151], a[196:199]
v_cvt_pk_bf16_f32 v51, v206, v207
buffer_store_dwordx4 v[48:51], v252, s[20:23], s45 offen offset:0 sc1
v_mfma_f32_16x16x32_bf16 a[200:203], v[224:227], v[136:139], a[200:203]
ds_read_b64_tr_b16 v[244:245], v250 offset:61440
ds_read_b64_tr_b16 v[246:247], v250 offset:63488
v_mfma_f32_16x16x32_bf16 a[200:203], v[228:231], v[152:155], a[200:203]
v_accvgpr_read_b32 v212, a152
v_accvgpr_read_b32 v213, a153
v_mfma_f32_16x16x32_bf16 a[204:207], v[224:227], v[140:143], a[204:207]
v_accvgpr_read_b32 v214, a154
v_accvgpr_read_b32 v215, a155
v_mfma_f32_16x16x32_bf16 a[204:207], v[228:231], v[156:159], a[204:207]
s_waitcnt lgkmcnt(4)
v_cvt_pk_bf16_f32 v82, v212, v213
v_mfma_f32_16x16x32_bf16 a[192:195], v[232:235], v[0:3], a[192:195]
ds_read_b64_tr_b16 v[224:225], v13 offset:12288
ds_read_b64_tr_b16 v[226:227], v13 offset:14336
v_mfma_f32_16x16x32_bf16 a[196:199], v[232:235], v[32:35], a[196:199]
v_cvt_pk_bf16_f32 v83, v214, v215
buffer_store_dwordx4 v[80:83], v252, s[20:23], s46 offen offset:0 sc1
v_mfma_f32_16x16x32_bf16 a[200:203], v[232:235], v[64:67], a[200:203]
v_accvgpr_read_b32 v220, a156
v_accvgpr_read_b32 v221, a157
v_mfma_f32_16x16x32_bf16 a[204:207], v[232:235], v[96:99], a[204:207]
v_accvgpr_read_b32 v222, a158
v_accvgpr_read_b32 v223, a159
v_mfma_f32_16x16x32_bf16 a[208:211], v[236:239], v[0:3], a[208:211]
ds_read_b64_tr_b16 v[228:229], v13 offset:28672
ds_read_b64_tr_b16 v[230:231], v13 offset:30720
v_mfma_f32_16x16x32_bf16 a[212:215], v[236:239], v[32:35], a[212:215]
v_cvt_pk_bf16_f32 v114, v220, v221
v_cvt_pk_bf16_f32 v115, v222, v223
v_mfma_f32_16x16x32_bf16 a[216:219], v[236:239], v[64:67], a[216:219]
buffer_store_dwordx4 v[112:115], v252, s[20:23], s47 offen offset:0 sc1
v_accvgpr_read_b32 v192, a160
v_mfma_f32_16x16x32_bf16 a[220:223], v[236:239], v[96:99], a[220:223]
s_waitcnt lgkmcnt(4)
v_accvgpr_read_b32 v193, a161
v_mfma_f32_16x16x32_bf16 a[208:211], v[240:243], v[160:163], a[208:211]
ds_read_b64_tr_b16 v[232:233], v249 offset:45568
ds_read_b64_tr_b16 v[234:235], v249 offset:47616
v_mfma_f32_16x16x32_bf16 a[208:211], v[244:247], v[176:179], a[208:211]
v_accvgpr_read_b32 v194, a162
v_accvgpr_read_b32 v195, a163
v_mfma_f32_16x16x32_bf16 a[212:215], v[240:243], v[164:167], a[212:215]
v_cvt_pk_bf16_f32 v20, v192, v193
v_cvt_pk_bf16_f32 v21, v194, v195
v_mfma_f32_16x16x32_bf16 a[212:215], v[244:247], v[180:183], a[212:215]
v_accvgpr_read_b32 v200, a164
v_accvgpr_read_b32 v201, a165
v_mfma_f32_16x16x32_bf16 a[216:219], v[240:243], v[168:171], a[216:219]
ds_read_b64_tr_b16 v[236:237], v249 offset:61952
ds_read_b64_tr_b16 v[238:239], v249 offset:64000
v_mfma_f32_16x16x32_bf16 a[216:219], v[244:247], v[184:187], a[216:219]
v_accvgpr_read_b32 v202, a166
v_accvgpr_read_b32 v203, a167
v_mfma_f32_16x16x32_bf16 a[220:223], v[240:243], v[172:175], a[220:223]
v_cvt_pk_bf16_f32 v52, v200, v201
v_cvt_pk_bf16_f32 v53, v202, v203
v_mfma_f32_16x16x32_bf16 a[220:223], v[244:247], v[188:191], a[220:223]
s_waitcnt lgkmcnt(4)
v_accvgpr_read_b32 v208, a168
v_mfma_f32_16x16x32_bf16 a[208:211], v[224:227], v[128:131], a[208:211]
ds_read_b64_tr_b16 v[240:241], v12 offset:12800
ds_read_b64_tr_b16 v[242:243], v12 offset:14848
v_mfma_f32_16x16x32_bf16 a[208:211], v[228:231], v[144:147], a[208:211]
v_accvgpr_read_b32 v209, a169
v_accvgpr_read_b32 v210, a170
v_mfma_f32_16x16x32_bf16 a[212:215], v[224:227], v[132:135], a[212:215]
v_accvgpr_read_b32 v211, a171
v_cvt_pk_bf16_f32 v84, v208, v209
v_mfma_f32_16x16x32_bf16 a[212:215], v[228:231], v[148:151], a[212:215]
v_cvt_pk_bf16_f32 v85, v210, v211
v_accvgpr_read_b32 v216, a172
v_mfma_f32_16x16x32_bf16 a[216:219], v[224:227], v[136:139], a[216:219]
ds_read_b64_tr_b16 v[244:245], v12 offset:29184
ds_read_b64_tr_b16 v[246:247], v12 offset:31232
v_mfma_f32_16x16x32_bf16 a[216:219], v[228:231], v[152:155], a[216:219]
v_accvgpr_read_b32 v217, a173
v_accvgpr_read_b32 v218, a174
v_mfma_f32_16x16x32_bf16 a[220:223], v[224:227], v[140:143], a[220:223]
v_accvgpr_read_b32 v219, a175
v_cvt_pk_bf16_f32 v116, v216, v217
v_mfma_f32_16x16x32_bf16 a[220:223], v[228:231], v[156:159], a[220:223]
s_waitcnt lgkmcnt(4)
v_cvt_pk_bf16_f32 v117, v218, v219
v_mfma_f32_16x16x32_bf16 a[224:227], v[232:235], v[160:163], a[224:227]
ds_read_b64_tr_b16 v[224:225], v12 offset:45568
ds_read_b64_tr_b16 v[226:227], v12 offset:47616
v_mfma_f32_16x16x32_bf16 a[224:227], v[236:239], v[176:179], a[224:227]
v_accvgpr_read_b32 v196, a176
v_accvgpr_read_b32 v197, a177
v_mfma_f32_16x16x32_bf16 a[228:231], v[232:235], v[164:167], a[228:231]
v_accvgpr_read_b32 v198, a178
v_accvgpr_read_b32 v199, a179
v_mfma_f32_16x16x32_bf16 a[228:231], v[236:239], v[180:183], a[228:231]
v_cvt_pk_bf16_f32 v22, v196, v197
v_cvt_pk_bf16_f32 v23, v198, v199
v_mfma_f32_16x16x32_bf16 a[232:235], v[232:235], v[168:171], a[232:235]
ds_read_b64_tr_b16 v[228:229], v13 offset:45568
ds_read_b64_tr_b16 v[230:231], v13 offset:47616
v_mfma_f32_16x16x32_bf16 a[232:235], v[236:239], v[184:187], a[232:235]
buffer_store_dwordx4 v[20:23], v252, s[20:23], s44 offen offset:1024 sc1
v_accvgpr_read_b32 v204, a180
v_mfma_f32_16x16x32_bf16 a[236:239], v[232:235], v[172:175], a[236:239]
v_accvgpr_read_b32 v205, a181
v_accvgpr_read_b32 v206, a182
v_mfma_f32_16x16x32_bf16 a[236:239], v[236:239], v[188:191], a[236:239]
s_waitcnt lgkmcnt(4)
v_accvgpr_read_b32 v207, a183
v_mfma_f32_16x16x32_bf16 a[224:227], v[240:243], v[128:131], a[224:227]
ds_read_b64_tr_b16 v[232:233], v250 offset:45568
ds_read_b64_tr_b16 v[234:235], v250 offset:47616
v_mfma_f32_16x16x32_bf16 a[224:227], v[244:247], v[144:147], a[224:227]
v_cvt_pk_bf16_f32 v54, v204, v205
v_cvt_pk_bf16_f32 v55, v206, v207
v_mfma_f32_16x16x32_bf16 a[228:231], v[240:243], v[132:135], a[228:231]
buffer_store_dwordx4 v[52:55], v252, s[20:23], s45 offen offset:1024 sc1
v_accvgpr_read_b32 v212, a184
v_mfma_f32_16x16x32_bf16 a[228:231], v[244:247], v[148:151], a[228:231]
v_accvgpr_read_b32 v213, a185
v_accvgpr_read_b32 v214, a186
v_mfma_f32_16x16x32_bf16 a[232:235], v[240:243], v[136:139], a[232:235]
ds_read_b64_tr_b16 v[236:237], v250 offset:61952
ds_read_b64_tr_b16 v[238:239], v250 offset:64000
v_mfma_f32_16x16x32_bf16 a[232:235], v[244:247], v[152:155], a[232:235]
v_accvgpr_read_b32 v215, a187
v_cvt_pk_bf16_f32 v86, v212, v213
v_mfma_f32_16x16x32_bf16 a[236:239], v[240:243], v[140:143], a[236:239]
v_cvt_pk_bf16_f32 v87, v214, v215
buffer_store_dwordx4 v[84:87], v252, s[20:23], s46 offen offset:1024 sc1
v_mfma_f32_16x16x32_bf16 a[236:239], v[244:247], v[156:159], a[236:239]
s_waitcnt lgkmcnt(4)
v_accvgpr_read_b32 v220, a188
v_mfma_f32_16x16x32_bf16 a[224:227], v[224:227], v[0:3], a[224:227]
ds_read_b64_tr_b16 v[240:241], v13 offset:12800
ds_read_b64_tr_b16 v[242:243], v13 offset:14848
v_mfma_f32_16x16x32_bf16 a[228:231], v[224:227], v[32:35], a[228:231]
v_accvgpr_read_b32 v221, a189
v_accvgpr_read_b32 v222, a190
v_mfma_f32_16x16x32_bf16 a[232:235], v[224:227], v[64:67], a[232:235]
v_accvgpr_read_b32 v223, a191
v_cvt_pk_bf16_f32 v118, v220, v221
v_mfma_f32_16x16x32_bf16 a[236:239], v[224:227], v[96:99], a[236:239]
v_cvt_pk_bf16_f32 v119, v222, v223
buffer_store_dwordx4 v[116:119], v252, s[20:23], s47 offen offset:1024 sc1
v_mfma_f32_16x16x32_bf16 a[240:243], v[228:231], v[0:3], a[240:243]
ds_read_b64_tr_b16 v[244:245], v13 offset:29184
ds_read_b64_tr_b16 v[246:247], v13 offset:31232
v_mfma_f32_16x16x32_bf16 a[244:247], v[228:231], v[32:35], a[244:247]
v_accvgpr_read_b32 v192, a192
v_accvgpr_read_b32 v193, a193
v_mfma_f32_16x16x32_bf16 a[248:251], v[228:231], v[64:67], a[248:251]
v_accvgpr_read_b32 v194, a194
v_accvgpr_read_b32 v195, a195
v_mfma_f32_16x16x32_bf16 a[252:255], v[228:231], v[96:99], a[252:255]
s_waitcnt lgkmcnt(4)
v_cvt_pk_bf16_f32 v24, v192, v193
v_mfma_f32_16x16x32_bf16 a[240:243], v[232:235], v[160:163], a[240:243]
v_cvt_pk_bf16_f32 v25, v194, v195
v_accvgpr_read_b32 v200, a196
v_mfma_f32_16x16x32_bf16 a[240:243], v[236:239], v[176:179], a[240:243]
v_accvgpr_read_b32 v201, a197
v_accvgpr_read_b32 v202, a198
v_mfma_f32_16x16x32_bf16 a[244:247], v[232:235], v[164:167], a[244:247]
v_accvgpr_read_b32 v203, a199
v_cvt_pk_bf16_f32 v56, v200, v201
v_mfma_f32_16x16x32_bf16 a[244:247], v[236:239], v[180:183], a[244:247]
v_cvt_pk_bf16_f32 v57, v202, v203
v_accvgpr_read_b32 v208, a200
v_mfma_f32_16x16x32_bf16 a[248:251], v[232:235], v[168:171], a[248:251]
v_accvgpr_read_b32 v209, a201
v_accvgpr_read_b32 v210, a202
v_mfma_f32_16x16x32_bf16 a[248:251], v[236:239], v[184:187], a[248:251]
v_accvgpr_read_b32 v211, a203
v_cvt_pk_bf16_f32 v88, v208, v209
v_mfma_f32_16x16x32_bf16 a[252:255], v[232:235], v[172:175], a[252:255]
v_cvt_pk_bf16_f32 v89, v210, v211
v_accvgpr_read_b32 v216, a204
v_mfma_f32_16x16x32_bf16 a[252:255], v[236:239], v[188:191], a[252:255]
s_waitcnt lgkmcnt(0)
v_accvgpr_read_b32 v217, a205
v_mfma_f32_16x16x32_bf16 a[240:243], v[240:243], v[128:131], a[240:243]
v_accvgpr_read_b32 v218, a206
v_accvgpr_read_b32 v219, a207
v_mfma_f32_16x16x32_bf16 a[240:243], v[244:247], v[144:147], a[240:243]
v_cvt_pk_bf16_f32 v120, v216, v217
v_cvt_pk_bf16_f32 v121, v218, v219
v_mfma_f32_16x16x32_bf16 a[244:247], v[240:243], v[132:135], a[244:247]
v_accvgpr_read_b32 v196, a208
v_accvgpr_read_b32 v197, a209
v_mfma_f32_16x16x32_bf16 a[244:247], v[244:247], v[148:151], a[244:247]
v_accvgpr_read_b32 v198, a210
v_accvgpr_read_b32 v199, a211
v_mfma_f32_16x16x32_bf16 a[248:251], v[240:243], v[136:139], a[248:251]
v_cvt_pk_bf16_f32 v26, v196, v197
v_cvt_pk_bf16_f32 v27, v198, v199
v_mfma_f32_16x16x32_bf16 a[248:251], v[244:247], v[152:155], a[248:251]
buffer_store_dwordx4 v[24:27], v252, s[20:23], s44 offen offset:2048 sc1
v_accvgpr_read_b32 v204, a212
v_mfma_f32_16x16x32_bf16 a[252:255], v[240:243], v[140:143], a[252:255]
v_accvgpr_read_b32 v205, a213
v_accvgpr_read_b32 v206, a214
v_mfma_f32_16x16x32_bf16 a[252:255], v[244:247], v[156:159], a[252:255]
v_accvgpr_read_b32 v207, a215
v_cvt_pk_bf16_f32 v58, v204, v205
v_cvt_pk_bf16_f32 v59, v206, v207
buffer_store_dwordx4 v[56:59], v252, s[20:23], s45 offen offset:2048 sc1
v_accvgpr_read_b32 v212, a216
v_accvgpr_read_b32 v213, a217
v_accvgpr_read_b32 v214, a218
v_accvgpr_read_b32 v215, a219
v_cvt_pk_bf16_f32 v90, v212, v213
v_cvt_pk_bf16_f32 v91, v214, v215
buffer_store_dwordx4 v[88:91], v252, s[20:23], s46 offen offset:2048 sc1
v_accvgpr_read_b32 v220, a220
v_accvgpr_read_b32 v221, a221
v_accvgpr_read_b32 v222, a222
v_accvgpr_read_b32 v223, a223
v_cvt_pk_bf16_f32 v122, v220, v221
v_cvt_pk_bf16_f32 v123, v222, v223
buffer_store_dwordx4 v[120:123], v252, s[20:23], s47 offen offset:2048 sc1
v_accvgpr_read_b32 v192, a224
v_accvgpr_read_b32 v193, a225
v_accvgpr_read_b32 v194, a226
v_accvgpr_read_b32 v195, a227
v_cvt_pk_bf16_f32 v28, v192, v193
v_cvt_pk_bf16_f32 v29, v194, v195
v_accvgpr_read_b32 v200, a228
v_accvgpr_read_b32 v201, a229
v_accvgpr_read_b32 v202, a230
v_accvgpr_read_b32 v203, a231
v_cvt_pk_bf16_f32 v60, v200, v201
v_cvt_pk_bf16_f32 v61, v202, v203
v_accvgpr_read_b32 v208, a232
v_accvgpr_read_b32 v209, a233
v_accvgpr_read_b32 v210, a234
v_accvgpr_read_b32 v211, a235
v_cvt_pk_bf16_f32 v92, v208, v209
v_cvt_pk_bf16_f32 v93, v210, v211
v_accvgpr_read_b32 v216, a236
v_accvgpr_read_b32 v217, a237
v_accvgpr_read_b32 v218, a238
v_accvgpr_read_b32 v219, a239
v_cvt_pk_bf16_f32 v124, v216, v217
v_cvt_pk_bf16_f32 v125, v218, v219
v_accvgpr_read_b32 v196, a240
v_accvgpr_read_b32 v197, a241
v_accvgpr_read_b32 v198, a242
v_accvgpr_read_b32 v199, a243
v_cvt_pk_bf16_f32 v30, v196, v197
v_cvt_pk_bf16_f32 v31, v198, v199
buffer_store_dwordx4 v[28:31], v252, s[20:23], s44 offen offset:3072 sc1
v_accvgpr_read_b32 v204, a244
v_accvgpr_read_b32 v205, a245
v_accvgpr_read_b32 v206, a246
v_accvgpr_read_b32 v207, a247
v_cvt_pk_bf16_f32 v62, v204, v205
v_cvt_pk_bf16_f32 v63, v206, v207
buffer_store_dwordx4 v[60:63], v252, s[20:23], s45 offen offset:3072 sc1
v_accvgpr_read_b32 v212, a248
v_accvgpr_read_b32 v213, a249
v_accvgpr_read_b32 v214, a250
v_accvgpr_read_b32 v215, a251
v_cvt_pk_bf16_f32 v94, v212, v213
v_cvt_pk_bf16_f32 v95, v214, v215
buffer_store_dwordx4 v[92:95], v252, s[20:23], s46 offen offset:3072 sc1
v_accvgpr_read_b32 v220, a252
v_accvgpr_read_b32 v221, a253
v_accvgpr_read_b32 v222, a254
v_accvgpr_read_b32 v223, a255
v_cvt_pk_bf16_f32 v126, v220, v221
v_cvt_pk_bf16_f32 v127, v222, v223
buffer_store_dwordx4 v[124:127], v252, s[20:23], s47 offen offset:3072 sc1
s_branch L2_chk
L2_tail_1_6:
s_waitcnt lgkmcnt(4)
v_mfma_f32_16x16x32_bf16 a[0:3], v[224:227], v[160:163], a[0:3]
ds_read_b128 v[240:243], v248 offset:2048
v_mfma_f32_16x16x32_bf16 a[0:3], v[228:231], v[176:179], a[0:3]
s_lshl_b32 s36, s34, 13
v_mfma_f32_16x16x32_bf16 a[4:7], v[224:227], v[164:167], a[4:7]
v_mfma_f32_16x16x32_bf16 a[4:7], v[228:231], v[180:183], a[4:7]
s_add_u32 s36, s36, 0x20000
v_mfma_f32_16x16x32_bf16 a[8:11], v[224:227], v[168:171], a[8:11]
ds_read_b128 v[244:247], v248 offset:2560
v_mfma_f32_16x16x32_bf16 a[8:11], v[228:231], v[184:187], a[8:11]
v_add_u32 v255, s36, v252
v_mfma_f32_16x16x32_bf16 a[12:15], v[224:227], v[172:175], a[12:15]
v_exp_f32 v192, v192
v_mfma_f32_16x16x32_bf16 a[12:15], v[228:231], v[188:191], a[12:15]
s_waitcnt lgkmcnt(2)
v_mfma_f32_16x16x32_bf16 a[16:19], v[232:235], v[160:163], a[16:19]
ds_read_b128 v[224:227], v248 offset:6144
ds_write_b128 v255, v[160:163] offset:0
v_mfma_f32_16x16x32_bf16 a[16:19], v[236:239], v[176:179], a[16:19]
v_exp_f32 v193, v193
v_mfma_f32_16x16x32_bf16 a[20:23], v[232:235], v[164:167], a[20:23]
v_exp_f32 v194, v194
v_mfma_f32_16x16x32_bf16 a[20:23], v[236:239], v[180:183], a[20:23]
v_exp_f32 v195, v195
v_mfma_f32_16x16x32_bf16 a[24:27], v[232:235], v[168:171], a[24:27]
ds_read_b128 v[228:231], v248 offset:6656
v_cvt_pk_bf16_f32 v128, v192, v193
v_mfma_f32_16x16x32_bf16 a[24:27], v[236:239], v[184:187], a[24:27]
v_cvt_pk_bf16_f32 v129, v194, v195
ds_write_b128 v255, v[164:167] offset:1024
v_mfma_f32_16x16x32_bf16 a[28:31], v[232:235], v[172:175], a[28:31]
v_exp_f32 v196, v196
v_mfma_f32_16x16x32_bf16 a[28:31], v[236:239], v[188:191], a[28:31]
s_waitcnt lgkmcnt(4)
ds_write_b128 v255, v[168:171] offset:2048
v_mfma_f32_16x16x32_bf16 v[208:211], v[240:243], v[0:3], 0
ds_read_b128 v[232:235], v248 offset:10240
ds_write_b128 v255, v[172:175] offset:3072
v_mfma_f32_16x16x32_bf16 v[208:211], v[244:247], v[4:7], v[208:211]
v_exp_f32 v197, v197
v_mfma_f32_16x16x32_bf16 v[212:215], v[240:243], v[32:35], 0
v_exp_f32 v198, v198
v_mfma_f32_16x16x32_bf16 v[212:215], v[244:247], v[36:39], v[212:215]
v_exp_f32 v199, v199
v_mfma_f32_16x16x32_bf16 v[216:219], v[240:243], v[64:67], 0
ds_read_b128 v[236:239], v248 offset:10752
v_cvt_pk_bf16_f32 v132, v196, v197
v_mfma_f32_16x16x32_bf16 v[216:219], v[244:247], v[68:71], v[216:219]
v_cvt_pk_bf16_f32 v133, v198, v199
v_mfma_f32_16x16x32_bf16 v[220:223], v[240:243], v[96:99], 0
v_exp_f32 v200, v200
v_mfma_f32_16x16x32_bf16 v[220:223], v[244:247], v[100:103], v[220:223]
s_waitcnt lgkmcnt(5)
v_mfma_f32_16x16x32_bf16 v[208:211], v[224:227], v[8:11], v[208:211]
ds_read_b128 v[240:243], v248 offset:14336
v_mfma_f32_16x16x32_bf16 v[208:211], v[228:231], v[12:15], v[208:211]
v_exp_f32 v201, v201
v_mfma_f32_16x16x32_bf16 v[212:215], v[224:227], v[40:43], v[212:215]
v_exp_f32 v202, v202
v_mfma_f32_16x16x32_bf16 v[212:215], v[228:231], v[44:47], v[212:215]
v_exp_f32 v203, v203
v_mfma_f32_16x16x32_bf16 v[216:219], v[224:227], v[72:75], v[216:219]
ds_read_b128 v[244:247], v248 offset:14848
v_cvt_pk_bf16_f32 v136, v200, v201
v_mfma_f32_16x16x32_bf16 v[216:219], v[228:231], v[76:79], v[216:219]
v_cvt_pk_bf16_f32 v137, v202, v203
v_mfma_f32_16x16x32_bf16 v[220:223], v[224:227], v[104:107], v[220:223]
v_exp_f32 v204, v204
v_mfma_f32_16x16x32_bf16 v[220:223], v[228:231], v[108:111], v[220:223]
s_waitcnt lgkmcnt(2)
s_waitcnt vmcnt(0)
s_barrier
v_mfma_f32_16x16x32_bf16 v[208:211], v[232:235], v[16:19], v[208:211]
ds_read_b128 v[224:227], v248 offset:16384
s_add_u32 m0, s30, 0xc000
v_mfma_f32_16x16x32_bf16 v[208:211], v[236:239], v[20:23], v[208:211]
v_exp_f32 v205, v205
v_mfma_f32_16x16x32_bf16 v[212:215], v[232:235], v[48:51], v[212:215]
v_exp_f32 v206, v206
v_mfma_f32_16x16x32_bf16 v[212:215], v[236:239], v[52:55], v[212:215]
v_exp_f32 v207, v207
v_mfma_f32_16x16x32_bf16 v[216:219], v[232:235], v[80:83], v[216:219]
ds_read_b128 v[228:231], v248 offset:16896
v_cvt_pk_bf16_f32 v140, v204, v205
v_mfma_f32_16x16x32_bf16 v[216:219], v[236:239], v[84:87], v[216:219]
v_cvt_pk_bf16_f32 v141, v206, v207
buffer_load_dwordx4 v251, s[12:15], s28 offen offset:0 lds
v_mfma_f32_16x16x32_bf16 v[220:223], v[232:235], v[112:115], v[220:223]
v_mfma_f32_16x16x32_bf16 v[220:223], v[236:239], v[116:119], v[220:223]
s_waitcnt lgkmcnt(2)
buffer_load_dwordx4 v251, s[12:15], s28 offen offset:1024 lds
v_mfma_f32_16x16x32_bf16 v[208:211], v[240:243], v[24:27], v[208:211]
ds_read_b128 v[232:235], v248 offset:20480
v_mfma_f32_16x16x32_bf16 v[208:211], v[244:247], v[28:31], v[208:211]
buffer_load_dwordx4 v251, s[12:15], s28 offen offset:2048 lds
v_mfma_f32_16x16x32_bf16 v[212:215], v[240:243], v[56:59], v[212:215]
v_mfma_f32_16x16x32_bf16 v[212:215], v[244:247], v[60:63], v[212:215]
buffer_load_dwordx4 v251, s[12:15], s28 offen offset:3072 lds
v_mfma_f32_16x16x32_bf16 v[216:219], v[240:243], v[88:91], v[216:219]
ds_read_b128 v[236:239], v248 offset:20992
v_mfma_f32_16x16x32_bf16 v[216:219], v[244:247], v[92:95], v[216:219]
s_add_u32 s28, s28, 0x4000
v_mfma_f32_16x16x32_bf16 v[220:223], v[240:243], v[120:123], v[220:223]
v_mfma_f32_16x16x32_bf16 v[220:223], v[244:247], v[124:127], v[220:223]
s_waitcnt lgkmcnt(2)
v_mfma_f32_16x16x32_bf16 v[192:195], v[224:227], v[0:3], 0
ds_read_b128 v[240:243], v248 offset:24576
v_mfma_f32_16x16x32_bf16 v[192:195], v[228:231], v[4:7], v[192:195]
v_exp_f32 v208, v208
v_mfma_f32_16x16x32_bf16 v[196:199], v[224:227], v[32:35], 0
v_exp_f32 v209, v209
v_mfma_f32_16x16x32_bf16 v[196:199], v[228:231], v[36:39], v[196:199]
v_exp_f32 v210, v210
v_mfma_f32_16x16x32_bf16 v[200:203], v[224:227], v[64:67], 0
ds_read_b128 v[244:247], v248 offset:25088
v_cvt_pk_bf16_f32 v130, v208, v209
v_mfma_f32_16x16x32_bf16 v[200:203], v[228:231], v[68:71], v[200:203]
v_exp_f32 v211, v211
v_mfma_f32_16x16x32_bf16 v[204:207], v[224:227], v[96:99], 0
v_exp_f32 v212, v212
v_mfma_f32_16x16x32_bf16 v[204:207], v[228:231], v[100:103], v[204:207]
s_waitcnt lgkmcnt(2)
v_cvt_pk_bf16_f32 v131, v210, v211
v_mfma_f32_16x16x32_bf16 v[192:195], v[232:235], v[8:11], v[192:195]
ds_read_b128 v[224:227], v248 offset:28672
v_mfma_f32_16x16x32_bf16 v[192:195], v[236:239], v[12:15], v[192:195]
v_exp_f32 v213, v213
v_mfma_f32_16x16x32_bf16 v[196:199], v[232:235], v[40:43], v[196:199]
v_exp_f32 v214, v214
v_mfma_f32_16x16x32_bf16 v[196:199], v[236:239], v[44:47], v[196:199]
v_exp_f32 v215, v215
v_mfma_f32_16x16x32_bf16 v[200:203], v[232:235], v[72:75], v[200:203]
ds_read_b128 v[228:231], v248 offset:29184
v_cvt_pk_bf16_f32 v134, v212, v213
v_mfma_f32_16x16x32_bf16 v[200:203], v[236:239], v[76:79], v[200:203]
v_cvt_pk_bf16_f32 v135, v214, v215
v_mfma_f32_16x16x32_bf16 v[204:207], v[232:235], v[104:107], v[204:207]
v_exp_f32 v216, v216
v_mfma_f32_16x16x32_bf16 v[204:207], v[236:239], v[108:111], v[204:207]
s_waitcnt lgkmcnt(2)
v_mfma_f32_16x16x32_bf16 v[192:195], v[240:243], v[16:19], v[192:195]
ds_read_b128 v[232:235], v248 offset:18432
v_mfma_f32_16x16x32_bf16 v[192:195], v[244:247], v[20:23], v[192:195]
v_exp_f32 v217, v217
v_mfma_f32_16x16x32_bf16 v[196:199], v[240:243], v[48:51], v[196:199]
v_exp_f32 v218, v218
v_mfma_f32_16x16x32_bf16 v[196:199], v[244:247], v[52:55], v[196:199]
v_exp_f32 v219, v219
v_mfma_f32_16x16x32_bf16 v[200:203], v[240:243], v[80:83], v[200:203]
ds_read_b128 v[236:239], v248 offset:18944
v_cvt_pk_bf16_f32 v138, v216, v217
v_mfma_f32_16x16x32_bf16 v[200:203], v[244:247], v[84:87], v[200:203]
v_cvt_pk_bf16_f32 v139, v218, v219
v_mfma_f32_16x16x32_bf16 v[204:207], v[240:243], v[112:115], v[204:207]
v_exp_f32 v220, v220
v_mfma_f32_16x16x32_bf16 v[204:207], v[244:247], v[116:119], v[204:207]
s_waitcnt lgkmcnt(2)
v_mfma_f32_16x16x32_bf16 v[192:195], v[224:227], v[24:27], v[192:195]
ds_read_b128 v[240:243], v248 offset:22528
v_mfma_f32_16x16x32_bf16 v[192:195], v[228:231], v[28:31], v[192:195]
v_exp_f32 v221, v221
v_mfma_f32_16x16x32_bf16 v[196:199], v[224:227], v[56:59], v[196:199]
v_exp_f32 v222, v222
v_mfma_f32_16x16x32_bf16 v[196:199], v[228:231], v[60:63], v[196:199]
v_exp_f32 v223, v223
v_mfma_f32_16x16x32_bf16 v[200:203], v[224:227], v[88:91], v[200:203]
ds_read_b128 v[244:247], v248 offset:23040
v_cvt_pk_bf16_f32 v142, v220, v221
v_mfma_f32_16x16x32_bf16 v[200:203], v[228:231], v[92:95], v[200:203]
v_cvt_pk_bf16_f32 v143, v222, v223
v_mfma_f32_16x16x32_bf16 v[204:207], v[224:227], v[120:123], v[204:207]
v_mfma_f32_16x16x32_bf16 v[204:207], v[228:231], v[124:127], v[204:207]
s_waitcnt lgkmcnt(2)
v_mfma_f32_16x16x32_bf16 v[208:211], v[232:235], v[0:3], 0
ds_read_b128 v[224:227], v248 offset:26624
v_mfma_f32_16x16x32_bf16 v[208:211], v[236:239], v[4:7], v[208:211]
v_exp_f32 v192, v192
v_mfma_f32_16x16x32_bf16 v[212:215], v[232:235], v[32:35], 0
v_exp_f32 v193, v193
v_mfma_f32_16x16x32_bf16 v[212:215], v[236:239], v[36:39], v[212:215]
v_exp_f32 v194, v194
v_mfma_f32_16x16x32_bf16 v[216:219], v[232:235], v[64:67], 0
ds_read_b128 v[228:231], v248 offset:27136
v_cvt_pk_bf16_f32 v144, v192, v193
v_mfma_f32_16x16x32_bf16 v[216:219], v[236:239], v[68:71], v[216:219]
v_exp_f32 v195, v195
v_mfma_f32_16x16x32_bf16 v[220:223], v[232:235], v[96:99], 0
v_exp_f32 v196, v196
v_mfma_f32_16x16x32_bf16 v[220:223], v[236:239], v[100:103], v[220:223]
s_waitcnt lgkmcnt(2)
v_cvt_pk_bf16_f32 v145, v194, v195
v_mfma_f32_16x16x32_bf16 v[208:211], v[240:243], v[8:11], v[208:211]
ds_read_b128 v[232:235], v248 offset:30720
v_mfma_f32_16x16x32_bf16 v[208:211], v[244:247], v[12:15], v[208:211]
v_exp_f32 v197, v197
v_mfma_f32_16x16x32_bf16 v[212:215], v[240:243], v[40:43], v[212:215]
v_exp_f32 v198, v198
v_mfma_f32_16x16x32_bf16 v[212:215], v[244:247], v[44:47], v[212:215]
v_exp_f32 v199, v199
v_mfma_f32_16x16x32_bf16 v[216:219], v[240:243], v[72:75], v[216:219]
ds_read_b128 v[236:239], v248 offset:31232
v_cvt_pk_bf16_f32 v148, v196, v197
v_mfma_f32_16x16x32_bf16 v[216:219], v[244:247], v[76:79], v[216:219]
v_cvt_pk_bf16_f32 v149, v198, v199
v_mfma_f32_16x16x32_bf16 v[220:223], v[240:243], v[104:107], v[220:223]
v_exp_f32 v200, v200
v_mfma_f32_16x16x32_bf16 v[220:223], v[244:247], v[108:111], v[220:223]
s_waitcnt lgkmcnt(2)
v_mfma_f32_16x16x32_bf16 v[208:211], v[224:227], v[16:19], v[208:211]
ds_read_b128 v[240:243], v248 offset:32768
v_mfma_f32_16x16x32_bf16 v[208:211], v[228:231], v[20:23], v[208:211]
v_exp_f32 v201, v201
v_mfma_f32_16x16x32_bf16 v[212:215], v[224:227], v[48:51], v[212:215]
v_exp_f32 v202, v202
v_mfma_f32_16x16x32_bf16 v[212:215], v[228:231], v[52:55], v[212:215]
v_exp_f32 v203, v203
v_mfma_f32_16x16x32_bf16 v[216:219], v[224:227], v[80:83], v[216:219]
ds_read_b128 v[244:247], v248 offset:33280
v_cvt_pk_bf16_f32 v152, v200, v201
v_mfma_f32_16x16x32_bf16 v[216:219], v[228:231], v[84:87], v[216:219]
v_cvt_pk_bf16_f32 v153, v202, v203
v_mfma_f32_16x16x32_bf16 v[220:223], v[224:227], v[112:115], v[220:223]
v_exp_f32 v204, v204
v_mfma_f32_16x16x32_bf16 v[220:223], v[228:231], v[116:119], v[220:223]
s_waitcnt lgkmcnt(2)
v_mfma_f32_16x16x32_bf16 v[208:211], v[232:235], v[24:27], v[208:211]
ds_read_b128 v[224:227], v248 offset:36864
v_mfma_f32_16x16x32_bf16 v[208:211], v[236:239], v[28:31], v[208:211]
v_exp_f32 v205, v205
v_mfma_f32_16x16x32_bf16 v[212:215], v[232:235], v[56:59], v[212:215]
v_exp_f32 v206, v206
v_mfma_f32_16x16x32_bf16 v[212:215], v[236:239], v[60:63], v[212:215]
v_exp_f32 v207, v207
v_mfma_f32_16x16x32_bf16 v[216:219], v[232:235], v[88:91], v[216:219]
ds_read_b128 v[228:231], v248 offset:37376
v_cvt_pk_bf16_f32 v156, v204, v205
v_mfma_f32_16x16x32_bf16 v[216:219], v[236:239], v[92:95], v[216:219]
v_cvt_pk_bf16_f32 v157, v206, v207
v_mfma_f32_16x16x32_bf16 v[220:223], v[232:235], v[120:123], v[220:223]
v_mfma_f32_16x16x32_bf16 v[220:223], v[236:239], v[124:127], v[220:223]
s_waitcnt lgkmcnt(2)
v_mfma_f32_16x16x32_bf16 v[192:195], v[240:243], v[0:3], 0
ds_read_b128 v[232:235], v248 offset:40960
v_mfma_f32_16x16x32_bf16 v[192:195], v[244:247], v[4:7], v[192:195]
v_exp_f32 v208, v208
v_mfma_f32_16x16x32_bf16 v[196:199], v[240:243], v[32:35], 0
v_exp_f32 v209, v209
v_mfma_f32_16x16x32_bf16 v[196:199], v[244:247], v[36:39], v[196:199]
v_exp_f32 v210, v210
v_mfma_f32_16x16x32_bf16 v[200:203], v[240:243], v[64:67], 0
ds_read_b128 v[236:239], v248 offset:41472
v_cvt_pk_bf16_f32 v146, v208, v209
v_mfma_f32_16x16x32_bf16 v[200:203], v[244:247], v[68:71], v[200:203]
v_exp_f32 v211, v211
v_mfma_f32_16x16x32_bf16 v[204:207], v[240:243], v[96:99], 0
v_exp_f32 v212, v212
v_mfma_f32_16x16x32_bf16 v[204:207], v[244:247], v[100:103], v[204:207]
s_waitcnt lgkmcnt(2)
v_cvt_pk_bf16_f32 v147, v210, v211
v_mfma_f32_16x16x32_bf16 v[192:195], v[224:227], v[8:11], v[192:195]
ds_read_b128 v[240:243], v248 offset:45056
v_mfma_f32_16x16x32_bf16 v[192:195], v[228:231], v[12:15], v[192:195]
v_exp_f32 v213, v213
v_mfma_f32_16x16x32_bf16 v[196:199], v[224:227], v[40:43], v[196:199]
v_exp_f32 v214, v214
v_mfma_f32_16x16x32_bf16 v[196:199], v[228:231], v[44:47], v[196:199]
v_exp_f32 v215, v215
v_mfma_f32_16x16x32_bf16 v[200:203], v[224:227], v[72:75], v[200:203]
ds_read_b128 v[244:247], v248 offset:45568
v_cvt_pk_bf16_f32 v150, v212, v213
v_mfma_f32_16x16x32_bf16 v[200:203], v[228:231], v[76:79], v[200:203]
v_cvt_pk_bf16_f32 v151, v214, v215
v_mfma_f32_16x16x32_bf16 v[204:207], v[224:227], v[104:107], v[204:207]
v_exp_f32 v216, v216
v_mfma_f32_16x16x32_bf16 v[204:207], v[228:231], v[108:111], v[204:207]
s_waitcnt lgkmcnt(2)
v_mfma_f32_16x16x32_bf16 v[192:195], v[232:235], v[16:19], v[192:195]
ds_read_b128 v[224:227], v248 offset:34816
v_mfma_f32_16x16x32_bf16 v[192:195], v[236:239], v[20:23], v[192:195]
v_exp_f32 v217, v217
v_mfma_f32_16x16x32_bf16 v[196:199], v[232:235], v[48:51], v[196:199]
v_exp_f32 v218, v218
v_mfma_f32_16x16x32_bf16 v[196:199], v[236:239], v[52:55], v[196:199]
v_exp_f32 v219, v219
v_mfma_f32_16x16x32_bf16 v[200:203], v[232:235], v[80:83], v[200:203]
ds_read_b128 v[228:231], v248 offset:35328
v_cvt_pk_bf16_f32 v154, v216, v217
v_mfma_f32_16x16x32_bf16 v[200:203], v[236:239], v[84:87], v[200:203]
v_cvt_pk_bf16_f32 v155, v218, v219
v_mfma_f32_16x16x32_bf16 v[204:207], v[232:235], v[112:115], v[204:207]
v_exp_f32 v220, v220
v_mfma_f32_16x16x32_bf16 v[204:207], v[236:239], v[116:119], v[204:207]
s_waitcnt lgkmcnt(2)
v_mfma_f32_16x16x32_bf16 v[192:195], v[240:243], v[24:27], v[192:195]
ds_read_b128 v[232:235], v248 offset:38912
v_mfma_f32_16x16x32_bf16 v[192:195], v[244:247], v[28:31], v[192:195]
v_exp_f32 v221, v221
v_mfma_f32_16x16x32_bf16 v[196:199], v[240:243], v[56:59], v[196:199]
v_exp_f32 v222, v222
v_mfma_f32_16x16x32_bf16 v[196:199], v[244:247], v[60:63], v[196:199]
v_exp_f32 v223, v223
v_mfma_f32_16x16x32_bf16 v[200:203], v[240:243], v[88:91], v[200:203]
ds_read_b128 v[236:239], v248 offset:39424
v_cvt_pk_bf16_f32 v158, v220, v221
v_mfma_f32_16x16x32_bf16 v[200:203], v[244:247], v[92:95], v[200:203]
v_cvt_pk_bf16_f32 v159, v222, v223
v_mfma_f32_16x16x32_bf16 v[204:207], v[240:243], v[120:123], v[204:207]
v_mfma_f32_16x16x32_bf16 v[204:207], v[244:247], v[124:127], v[204:207]
s_waitcnt lgkmcnt(2)
v_mfma_f32_16x16x32_bf16 v[208:211], v[224:227], v[0:3], 0
ds_read_b128 v[240:243], v248 offset:43008
v_mfma_f32_16x16x32_bf16 v[208:211], v[228:231], v[4:7], v[208:211]
v_exp_f32 v192, v192
v_mfma_f32_16x16x32_bf16 v[212:215], v[224:227], v[32:35], 0
v_exp_f32 v193, v193
v_mfma_f32_16x16x32_bf16 v[212:215], v[228:231], v[36:39], v[212:215]
v_exp_f32 v194, v194
v_mfma_f32_16x16x32_bf16 v[216:219], v[224:227], v[64:67], 0
ds_read_b128 v[244:247], v248 offset:43520
v_cvt_pk_bf16_f32 v160, v192, v193
v_mfma_f32_16x16x32_bf16 v[216:219], v[228:231], v[68:71], v[216:219]
v_exp_f32 v195, v195
v_mfma_f32_16x16x32_bf16 v[220:223], v[224:227], v[96:99], 0
v_exp_f32 v196, v196
v_mfma_f32_16x16x32_bf16 v[220:223], v[228:231], v[100:103], v[220:223]
s_waitcnt lgkmcnt(2)
v_cvt_pk_bf16_f32 v161, v194, v195
v_mfma_f32_16x16x32_bf16 v[208:211], v[232:235], v[8:11], v[208:211]
ds_read_b128 v[224:227], v248 offset:47104
v_mfma_f32_16x16x32_bf16 v[208:211], v[236:239], v[12:15], v[208:211]
v_exp_f32 v197, v197
v_mfma_f32_16x16x32_bf16 v[212:215], v[232:235], v[40:43], v[212:215]
v_exp_f32 v198, v198
v_mfma_f32_16x16x32_bf16 v[212:215], v[236:239], v[44:47], v[212:215]
v_exp_f32 v199, v199
v_mfma_f32_16x16x32_bf16 v[216:219], v[232:235], v[72:75], v[216:219]
ds_read_b128 v[228:231], v248 offset:47616
v_cvt_pk_bf16_f32 v164, v196, v197
v_mfma_f32_16x16x32_bf16 v[216:219], v[236:239], v[76:79], v[216:219]
v_cvt_pk_bf16_f32 v165, v198, v199
v_mfma_f32_16x16x32_bf16 v[220:223], v[232:235], v[104:107], v[220:223]
v_exp_f32 v200, v200
v_mfma_f32_16x16x32_bf16 v[220:223], v[236:239], v[108:111], v[220:223]
s_waitcnt lgkmcnt(2)
s_waitcnt vmcnt(0)
s_barrier
v_mfma_f32_16x16x32_bf16 v[208:211], v[240:243], v[16:19], v[208:211]
ds_read_b128 v[232:235], v248 offset:49152
v_mfma_f32_16x16x32_bf16 v[208:211], v[244:247], v[20:23], v[208:211]
v_exp_f32 v201, v201
v_mfma_f32_16x16x32_bf16 v[212:215], v[240:243], v[48:51], v[212:215]
v_exp_f32 v202, v202
v_mfma_f32_16x16x32_bf16 v[212:215], v[244:247], v[52:55], v[212:215]
v_exp_f32 v203, v203
v_mfma_f32_16x16x32_bf16 v[216:219], v[240:243], v[80:83], v[216:219]
ds_read_b128 v[236:239], v248 offset:49664
v_cvt_pk_bf16_f32 v168, v200, v201
v_mfma_f32_16x16x32_bf16 v[216:219], v[244:247], v[84:87], v[216:219]
v_cvt_pk_bf16_f32 v169, v202, v203
v_mfma_f32_16x16x32_bf16 v[220:223], v[240:243], v[112:115], v[220:223]
v_exp_f32 v204, v204
v_mfma_f32_16x16x32_bf16 v[220:223], v[244:247], v[116:119], v[220:223]
s_waitcnt lgkmcnt(2)
v_mfma_f32_16x16x32_bf16 v[208:211], v[224:227], v[24:27], v[208:211]
ds_read_b128 v[240:243], v248 offset:53248
v_mfma_f32_16x16x32_bf16 v[208:211], v[228:231], v[28:31], v[208:211]
v_exp_f32 v205, v205
v_mfma_f32_16x16x32_bf16 v[212:215], v[224:227], v[56:59], v[212:215]
v_exp_f32 v206, v206
v_mfma_f32_16x16x32_bf16 v[212:215], v[228:231], v[60:63], v[212:215]
v_exp_f32 v207, v207
v_mfma_f32_16x16x32_bf16 v[216:219], v[224:227], v[88:91], v[216:219]
ds_read_b128 v[244:247], v248 offset:53760
v_cvt_pk_bf16_f32 v172, v204, v205
v_mfma_f32_16x16x32_bf16 v[216:219], v[228:231], v[92:95], v[216:219]
v_cvt_pk_bf16_f32 v173, v206, v207
v_mfma_f32_16x16x32_bf16 v[220:223], v[224:227], v[120:123], v[220:223]
v_mfma_f32_16x16x32_bf16 v[220:223], v[228:231], v[124:127], v[220:223]
s_waitcnt lgkmcnt(2)
v_mfma_f32_16x16x32_bf16 v[192:195], v[232:235], v[0:3], 0
ds_read_b128 v[224:227], v248 offset:57344
v_mfma_f32_16x16x32_bf16 v[192:195], v[236:239], v[4:7], v[192:195]
v_exp_f32 v208, v208
v_mfma_f32_16x16x32_bf16 v[196:199], v[232:235], v[32:35], 0
v_exp_f32 v209, v209
v_mfma_f32_16x16x32_bf16 v[196:199], v[236:239], v[36:39], v[196:199]
v_exp_f32 v210, v210
v_mfma_f32_16x16x32_bf16 v[200:203], v[232:235], v[64:67], 0
ds_read_b128 v[228:231], v248 offset:57856
v_cvt_pk_bf16_f32 v162, v208, v209
v_mfma_f32_16x16x32_bf16 v[200:203], v[236:239], v[68:71], v[200:203]
v_exp_f32 v211, v211
v_mfma_f32_16x16x32_bf16 v[204:207], v[232:235], v[96:99], 0
v_exp_f32 v212, v212
v_mfma_f32_16x16x32_bf16 v[204:207], v[236:239], v[100:103], v[204:207]
s_waitcnt lgkmcnt(2)
v_cvt_pk_bf16_f32 v163, v210, v211
v_mfma_f32_16x16x32_bf16 v[192:195], v[240:243], v[8:11], v[192:195]
ds_read_b128 v[232:235], v248 offset:61440
v_mfma_f32_16x16x32_bf16 v[192:195], v[244:247], v[12:15], v[192:195]
v_exp_f32 v213, v213
v_mfma_f32_16x16x32_bf16 v[196:199], v[240:243], v[40:43], v[196:199]
v_exp_f32 v214, v214
v_mfma_f32_16x16x32_bf16 v[196:199], v[244:247], v[44:47], v[196:199]
v_exp_f32 v215, v215
v_mfma_f32_16x16x32_bf16 v[200:203], v[240:243], v[72:75], v[200:203]
ds_read_b128 v[236:239], v248 offset:61952
v_cvt_pk_bf16_f32 v166, v212, v213
v_mfma_f32_16x16x32_bf16 v[200:203], v[244:247], v[76:79], v[200:203]
v_cvt_pk_bf16_f32 v167, v214, v215
v_mfma_f32_16x16x32_bf16 v[204:207], v[240:243], v[104:107], v[204:207]
v_exp_f32 v216, v216
v_mfma_f32_16x16x32_bf16 v[204:207], v[244:247], v[108:111], v[204:207]
s_waitcnt lgkmcnt(2)
v_mfma_f32_16x16x32_bf16 v[192:195], v[224:227], v[16:19], v[192:195]
ds_read_b128 v[240:243], v248 offset:51200
v_mfma_f32_16x16x32_bf16 v[192:195], v[228:231], v[20:23], v[192:195]
v_exp_f32 v217, v217
v_mfma_f32_16x16x32_bf16 v[196:199], v[224:227], v[48:51], v[196:199]
v_exp_f32 v218, v218
v_mfma_f32_16x16x32_bf16 v[196:199], v[228:231], v[52:55], v[196:199]
v_exp_f32 v219, v219
v_mfma_f32_16x16x32_bf16 v[200:203], v[224:227], v[80:83], v[200:203]
ds_read_b128 v[244:247], v248 offset:51712
v_cvt_pk_bf16_f32 v170, v216, v217
v_mfma_f32_16x16x32_bf16 v[200:203], v[228:231], v[84:87], v[200:203]
v_cvt_pk_bf16_f32 v171, v218, v219
v_mfma_f32_16x16x32_bf16 v[204:207], v[224:227], v[112:115], v[204:207]
v_exp_f32 v220, v220
v_mfma_f32_16x16x32_bf16 v[204:207], v[228:231], v[116:119], v[204:207]
s_waitcnt lgkmcnt(2)
v_mfma_f32_16x16x32_bf16 v[192:195], v[232:235], v[24:27], v[192:195]
ds_read_b128 v[224:227], v248 offset:55296
v_mfma_f32_16x16x32_bf16 v[192:195], v[236:239], v[28:31], v[192:195]
v_exp_f32 v221, v221
v_mfma_f32_16x16x32_bf16 v[196:199], v[232:235], v[56:59], v[196:199]
v_exp_f32 v222, v222
v_mfma_f32_16x16x32_bf16 v[196:199], v[236:239], v[60:63], v[196:199]
v_exp_f32 v223, v223
v_mfma_f32_16x16x32_bf16 v[200:203], v[232:235], v[88:91], v[200:203]
ds_read_b128 v[228:231], v248 offset:55808
v_cvt_pk_bf16_f32 v174, v220, v221
v_mfma_f32_16x16x32_bf16 v[200:203], v[236:239], v[92:95], v[200:203]
v_cvt_pk_bf16_f32 v175, v222, v223
v_mfma_f32_16x16x32_bf16 v[204:207], v[232:235], v[120:123], v[204:207]
v_mfma_f32_16x16x32_bf16 v[204:207], v[236:239], v[124:127], v[204:207]
s_waitcnt lgkmcnt(2)
v_mfma_f32_16x16x32_bf16 v[208:211], v[240:243], v[0:3], 0
ds_read_b128 v[232:235], v248 offset:59392
v_mfma_f32_16x16x32_bf16 v[208:211], v[244:247], v[4:7], v[208:211]
v_exp_f32 v192, v192
v_mfma_f32_16x16x32_bf16 v[212:215], v[240:243], v[32:35], 0
v_exp_f32 v193, v193
v_mfma_f32_16x16x32_bf16 v[212:215], v[244:247], v[36:39], v[212:215]
v_exp_f32 v194, v194
v_mfma_f32_16x16x32_bf16 v[216:219], v[240:243], v[64:67], 0
ds_read_b128 v[236:239], v248 offset:59904
v_cvt_pk_bf16_f32 v0, v192, v193
v_mfma_f32_16x16x32_bf16 v[216:219], v[244:247], v[68:71], v[216:219]
v_exp_f32 v195, v195
v_mfma_f32_16x16x32_bf16 v[220:223], v[240:243], v[96:99], 0
v_exp_f32 v196, v196
v_mfma_f32_16x16x32_bf16 v[220:223], v[244:247], v[100:103], v[220:223]
s_waitcnt lgkmcnt(2)
v_cvt_pk_bf16_f32 v1, v194, v195
v_mfma_f32_16x16x32_bf16 v[208:211], v[224:227], v[8:11], v[208:211]
ds_read_b128 v[240:243], v248 offset:63488
v_mfma_f32_16x16x32_bf16 v[208:211], v[228:231], v[12:15], v[208:211]
v_exp_f32 v197, v197
v_mfma_f32_16x16x32_bf16 v[212:215], v[224:227], v[40:43], v[212:215]
ds_read_b128 v[4:7], v255 offset:0
ds_read_b128 v[36:39], v255 offset:1024
v_mfma_f32_16x16x32_bf16 v[212:215], v[228:231], v[44:47], v[212:215]
v_exp_f32 v198, v198
v_mfma_f32_16x16x32_bf16 v[216:219], v[224:227], v[72:75], v[216:219]
ds_read_b128 v[244:247], v248 offset:64000
v_xor_b32 v12, 0x10000, v249
v_mfma_f32_16x16x32_bf16 v[216:219], v[228:231], v[76:79], v[216:219]
v_xor_b32 v13, 0x10000, v250
v_cvt_pk_bf16_f32 v32, v196, v197
v_mfma_f32_16x16x32_bf16 v[220:223], v[224:227], v[104:107], v[220:223]
ds_read_b128 v[68:71], v255 offset:2048
ds_read_b128 v[100:103], v255 offset:3072
v_mfma_f32_16x16x32_bf16 v[220:223], v[228:231], v[108:111], v[220:223]
s_waitcnt lgkmcnt(6)
v_mfma_f32_16x16x32_bf16 v[208:211], v[232:235], v[16:19], v[208:211]
ds_read_b64_tr_b16 v[224:225], v12 offset:0
ds_read_b64_tr_b16 v[226:227], v12 offset:2048
v_mfma_f32_16x16x32_bf16 v[208:211], v[236:239], v[20:23], v[208:211]
v_exp_f32 v199, v199
v_mfma_f32_16x16x32_bf16 v[212:215], v[232:235], v[48:51], v[212:215]
v_cvt_pk_bf16_f32 v33, v198, v199
v_mfma_f32_16x16x32_bf16 v[212:215], v[236:239], v[52:55], v[212:215]
v_exp_f32 v200, v200
v_mfma_f32_16x16x32_bf16 v[216:219], v[232:235], v[80:83], v[216:219]
ds_read_b64_tr_b16 v[228:229], v12 offset:16384
ds_read_b64_tr_b16 v[230:231], v12 offset:18432
v_mfma_f32_16x16x32_bf16 v[216:219], v[236:239], v[84:87], v[216:219]
v_exp_f32 v201, v201
v_mfma_f32_16x16x32_bf16 v[220:223], v[232:235], v[112:115], v[220:223]
v_exp_f32 v202, v202
v_mfma_f32_16x16x32_bf16 v[220:223], v[236:239], v[116:119], v[220:223]
s_waitcnt lgkmcnt(6)
v_cvt_pk_bf16_f32 v64, v200, v201
v_mfma_f32_16x16x32_bf16 v[208:211], v[240:243], v[24:27], v[208:211]
ds_read_b64_tr_b16 v[232:233], v13 offset:0
ds_read_b64_tr_b16 v[234:235], v13 offset:2048
v_mfma_f32_16x16x32_bf16 v[208:211], v[244:247], v[28:31], v[208:211]
v_exp_f32 v203, v203
v_mfma_f32_16x16x32_bf16 v[212:215], v[240:243], v[56:59], v[212:215]
v_cvt_pk_bf16_f32 v65, v202, v203
v_mfma_f32_16x16x32_bf16 v[212:215], v[244:247], v[60:63], v[212:215]
v_exp_f32 v204, v204
v_mfma_f32_16x16x32_bf16 v[216:219], v[240:243], v[88:91], v[216:219]
ds_read_b64_tr_b16 v[236:237], v13 offset:16384
ds_read_b64_tr_b16 v[238:239], v13 offset:18432
v_mfma_f32_16x16x32_bf16 v[216:219], v[244:247], v[92:95], v[216:219]
v_exp_f32 v205, v205
v_mfma_f32_16x16x32_bf16 v[220:223], v[240:243], v[120:123], v[220:223]
v_exp_f32 v206, v206
v_mfma_f32_16x16x32_bf16 v[220:223], v[244:247], v[124:127], v[220:223]
s_waitcnt lgkmcnt(4)
v_mfma_f32_16x16x32_bf16 a[0:3], v[224:227], v[128:131], a[0:3]
ds_read_b64_tr_b16 v[240:241], v249 offset:33280
ds_read_b64_tr_b16 v[242:243], v249 offset:35328
v_mfma_f32_16x16x32_bf16 a[0:3], v[228:231], v[144:147], a[0:3]
v_exp_f32 v207, v207
v_mfma_f32_16x16x32_bf16 a[4:7], v[224:227], v[132:135], a[4:7]
v_cvt_pk_bf16_f32 v96, v204, v205
v_cvt_pk_bf16_f32 v97, v206, v207
v_mfma_f32_16x16x32_bf16 a[4:7], v[228:231], v[148:151], a[4:7]
v_exp_f32 v208, v208
v_mfma_f32_16x16x32_bf16 a[8:11], v[224:227], v[136:139], a[8:11]
ds_read_b64_tr_b16 v[244:245], v249 offset:49664
ds_read_b64_tr_b16 v[246:247], v249 offset:51712
v_mfma_f32_16x16x32_bf16 a[8:11], v[228:231], v[152:155], a[8:11]
v_exp_f32 v209, v209
v_mfma_f32_16x16x32_bf16 a[12:15], v[224:227], v[140:143], a[12:15]
v_exp_f32 v210, v210
v_mfma_f32_16x16x32_bf16 a[12:15], v[228:231], v[156:159], a[12:15]
s_waitcnt lgkmcnt(4)
v_cvt_pk_bf16_f32 v2, v208, v209
v_mfma_f32_16x16x32_bf16 a[16:19], v[232:235], v[128:131], a[16:19]
ds_read_b64_tr_b16 v[224:225], v12 offset:512
ds_read_b64_tr_b16 v[226:227], v12 offset:2560
v_mfma_f32_16x16x32_bf16 a[16:19], v[236:239], v[144:147], a[16:19]
v_exp_f32 v211, v211
v_mfma_f32_16x16x32_bf16 a[20:23], v[232:235], v[132:135], a[20:23]
v_cvt_pk_bf16_f32 v3, v210, v211
v_mfma_f32_16x16x32_bf16 a[20:23], v[236:239], v[148:151], a[20:23]
v_exp_f32 v212, v212
v_mfma_f32_16x16x32_bf16 a[24:27], v[232:235], v[136:139], a[24:27]
ds_read_b64_tr_b16 v[228:229], v12 offset:16896
ds_read_b64_tr_b16 v[230:231], v12 offset:18944
v_mfma_f32_16x16x32_bf16 a[24:27], v[236:239], v[152:155], a[24:27]
v_exp_f32 v213, v213
v_mfma_f32_16x16x32_bf16 a[28:31], v[232:235], v[140:143], a[28:31]
v_exp_f32 v214, v214
v_mfma_f32_16x16x32_bf16 a[28:31], v[236:239], v[156:159], a[28:31]
s_waitcnt lgkmcnt(4)
v_cvt_pk_bf16_f32 v34, v212, v213
v_mfma_f32_16x16x32_bf16 a[32:35], v[240:243], v[4:7], a[32:35]
ds_read_b64_tr_b16 v[232:233], v250 offset:33280
ds_read_b64_tr_b16 v[234:235], v250 offset:35328
v_mfma_f32_16x16x32_bf16 a[32:35], v[244:247], v[176:179], a[32:35]
v_exp_f32 v215, v215
v_mfma_f32_16x16x32_bf16 a[36:39], v[240:243], v[36:39], a[36:39]
v_cvt_pk_bf16_f32 v35, v214, v215
v_mfma_f32_16x16x32_bf16 a[36:39], v[244:247], v[180:183], a[36:39]
v_exp_f32 v216, v216
v_mfma_f32_16x16x32_bf16 a[40:43], v[240:243], v[68:71], a[40:43]
ds_read_b64_tr_b16 v[236:237], v250 offset:49664
ds_read_b64_tr_b16 v[238:239], v250 offset:51712
v_mfma_f32_16x16x32_bf16 a[40:43], v[244:247], v[184:187], a[40:43]
v_exp_f32 v217, v217
v_mfma_f32_16x16x32_bf16 a[44:47], v[240:243], v[100:103], a[44:47]
v_exp_f32 v218, v218
v_mfma_f32_16x16x32_bf16 a[44:47], v[244:247], v[188:191], a[44:47]
s_waitcnt lgkmcnt(4)
v_cvt_pk_bf16_f32 v66, v216, v217
v_mfma_f32_16x16x32_bf16 a[32:35], v[224:227], v[128:131], a[32:35]
ds_read_b64_tr_b16 v[240:241], v12 offset:32768
ds_read_b64_tr_b16 v[242:243], v12 offset:34816
v_mfma_f32_16x16x32_bf16 a[32:35], v[228:231], v[144:147], a[32:35]
v_exp_f32 v219, v219
v_mfma_f32_16x16x32_bf16 a[36:39], v[224:227], v[132:135], a[36:39]
v_cvt_pk_bf16_f32 v67, v218, v219
v_mfma_f32_16x16x32_bf16 a[36:39], v[228:231], v[148:151], a[36:39]
v_exp_f32 v220, v220
v_mfma_f32_16x16x32_bf16 a[40:43], v[224:227], v[136:139], a[40:43]
ds_read_b64_tr_b16 v[244:245], v12 offset:49152
ds_read_b64_tr_b16 v[246:247], v12 offset:51200
v_mfma_f32_16x16x32_bf16 a[40:43], v[228:231], v[152:155], a[40:43]
v_exp_f32 v221, v221
v_mfma_f32_16x16x32_bf16 a[44:47], v[224:227], v[140:143], a[44:47]
v_exp_f32 v222, v222
v_mfma_f32_16x16x32_bf16 a[44:47], v[228:231], v[156:159], a[44:47]
s_waitcnt lgkmcnt(4)
v_cvt_pk_bf16_f32 v98, v220, v221
v_mfma_f32_16x16x32_bf16 a[48:51], v[232:235], v[4:7], a[48:51]
ds_read_b64_tr_b16 v[224:225], v13 offset:32768
ds_read_b64_tr_b16 v[226:227], v13 offset:34816
v_mfma_f32_16x16x32_bf16 a[48:51], v[236:239], v[176:179], a[48:51]
v_exp_f32 v223, v223
v_mfma_f32_16x16x32_bf16 a[52:55], v[232:235], v[36:39], a[52:55]
v_cvt_pk_bf16_f32 v99, v222, v223
v_mfma_f32_16x16x32_bf16 a[52:55], v[236:239], v[180:183], a[52:55]
v_mfma_f32_16x16x32_bf16 a[56:59], v[232:235], v[68:71], a[56:59]
ds_read_b64_tr_b16 v[228:229], v13 offset:49152
ds_read_b64_tr_b16 v[230:231], v13 offset:51200
v_mfma_f32_16x16x32_bf16 a[56:59], v[236:239], v[184:187], a[56:59]
v_mfma_f32_16x16x32_bf16 a[60:63], v[232:235], v[100:103], a[60:63]
v_mfma_f32_16x16x32_bf16 a[60:63], v[236:239], v[188:191], a[60:63]
s_waitcnt lgkmcnt(4)
v_mfma_f32_16x16x32_bf16 a[0:3], v[240:243], v[160:163], a[0:3]
ds_read_b64_tr_b16 v[232:233], v12 offset:33280
ds_read_b64_tr_b16 v[234:235], v12 offset:35328
v_mfma_f32_16x16x32_bf16 a[0:3], v[244:247], v[0:3], a[0:3]
v_mfma_f32_16x16x32_bf16 a[4:7], v[240:243], v[164:167], a[4:7]
v_mfma_f32_16x16x32_bf16 a[4:7], v[244:247], v[32:35], a[4:7]
v_mfma_f32_16x16x32_bf16 a[8:11], v[240:243], v[168:171], a[8:11]
ds_read_b64_tr_b16 v[236:237], v12 offset:49664
ds_read_b64_tr_b16 v[238:239], v12 offset:51712
v_mfma_f32_16x16x32_bf16 a[8:11], v[244:247], v[64:67], a[8:11]
v_mfma_f32_16x16x32_bf16 a[12:15], v[240:243], v[172:175], a[12:15]
v_mfma_f32_16x16x32_bf16 a[12:15], v[244:247], v[96:99], a[12:15]
s_waitcnt lgkmcnt(4)
v_mfma_f32_16x16x32_bf16 a[16:19], v[224:227], v[160:163], a[16:19]
ds_read_b64_tr_b16 v[240:241], v13 offset:512
ds_read_b64_tr_b16 v[242:243], v13 offset:2560
v_mfma_f32_16x16x32_bf16 a[16:19], v[228:231], v[0:3], a[16:19]
v_mfma_f32_16x16x32_bf16 a[20:23], v[224:227], v[164:167], a[20:23]
v_mfma_f32_16x16x32_bf16 a[20:23], v[228:231], v[32:35], a[20:23]
v_mfma_f32_16x16x32_bf16 a[24:27], v[224:227], v[168:171], a[24:27]
ds_read_b64_tr_b16 v[244:245], v13 offset:16896
ds_read_b64_tr_b16 v[246:247], v13 offset:18944
v_accvgpr_read_b32 v192, a0
v_mfma_f32_16x16x32_bf16 a[24:27], v[228:231], v[64:67], a[24:27]
v_accvgpr_read_b32 v193, a4
v_accvgpr_read_b32 v194, a8
v_accvgpr_read_b32 v195, a12
v_mfma_f32_16x16x32_bf16 a[28:31], v[224:227], v[172:175], a[28:31]
v_lshlrev_b32 v253, 2, v252
v_max3_u32 v254, v192, v193, v194
v_min3_u32 v255, v192, v193, v194
v_mfma_f32_16x16x32_bf16 a[28:31], v[228:231], v[96:99], a[28:31]
s_waitcnt lgkmcnt(4)
v_max_u32 v254, v254, v195
v_min_u32 v255, v255, v195
v_mfma_f32_16x16x32_bf16 a[32:35], v[232:235], v[160:163], a[32:35]
ds_read_b64_tr_b16 v[224:225], v13 offset:33280
ds_read_b64_tr_b16 v[226:227], v13 offset:35328
v_mfma_f32_16x16x32_bf16 a[32:35], v[236:239], v[0:3], a[32:35]
s_mov_b64 exec, 0xffff
buffer_store_dword v192, v253, s[24:27], s48 offen offset:4 sc1
buffer_store_dword v193, v253, s[24:27], s48 offen offset:1028 sc1
buffer_store_dword v194, v253, s[24:27], s48 offen offset:2052 sc1
buffer_store_dword v195, v253, s[24:27], s48 offen offset:3076 sc1
v_cmp_lt_u32 s[50:51], s52, v254
v_cmp_gt_u32 vcc, s53, v255
s_mov_b64 exec, -1
v_mfma_f32_16x16x32_bf16 a[36:39], v[232:235], v[164:167], a[36:39]
v_accvgpr_read_b32 v192, a0
v_accvgpr_read_b32 v193, a1
v_mfma_f32_16x16x32_bf16 a[36:39], v[236:239], v[32:35], a[36:39]
v_accvgpr_read_b32 v194, a2
v_accvgpr_read_b32 v195, a3
v_mfma_f32_16x16x32_bf16 a[40:43], v[232:235], v[168:171], a[40:43]
ds_read_b64_tr_b16 v[228:229], v13 offset:49664
ds_read_b64_tr_b16 v[230:231], v13 offset:51712
v_mfma_f32_16x16x32_bf16 a[40:43], v[236:239], v[64:67], a[40:43]
v_cvt_pk_bf16_f32 v16, v192, v193
v_cvt_pk_bf16_f32 v17, v194, v195
v_mfma_f32_16x16x32_bf16 a[44:47], v[232:235], v[172:175], a[44:47]
v_accvgpr_read_b32 v200, a4
v_accvgpr_read_b32 v201, a5
v_mfma_f32_16x16x32_bf16 a[44:47], v[236:239], v[96:99], a[44:47]
s_waitcnt lgkmcnt(4)
v_accvgpr_read_b32 v202, a6
v_mfma_f32_16x16x32_bf16 a[48:51], v[240:243], v[128:131], a[48:51]
ds_read_b64_tr_b16 v[232:233], v249 offset:36864
ds_read_b64_tr_b16 v[234:235], v249 offset:38912
v_mfma_f32_16x16x32_bf16 a[48:51], v[244:247], v[144:147], a[48:51]
v_accvgpr_read_b32 v203, a7
v_cvt_pk_bf16_f32 v48, v200, v201
v_mfma_f32_16x16x32_bf16 a[52:55], v[240:243], v[132:135], a[52:55]
v_cvt_pk_bf16_f32 v49, v202, v203
v_accvgpr_read_b32 v208, a8
v_mfma_f32_16x16x32_bf16 a[52:55], v[244:247], v[148:151], a[52:55]
v_accvgpr_read_b32 v209, a9
v_accvgpr_read_b32 v210, a10
v_mfma_f32_16x16x32_bf16 a[56:59], v[240:243], v[136:139], a[56:59]
ds_read_b64_tr_b16 v[236:237], v249 offset:53248
ds_read_b64_tr_b16 v[238:239], v249 offset:55296
v_mfma_f32_16x16x32_bf16 a[56:59], v[244:247], v[152:155], a[56:59]
v_accvgpr_read_b32 v211, a11
v_cvt_pk_bf16_f32 v80, v208, v209
v_mfma_f32_16x16x32_bf16 a[60:63], v[240:243], v[140:143], a[60:63]
v_cvt_pk_bf16_f32 v81, v210, v211
v_accvgpr_read_b32 v216, a12
v_mfma_f32_16x16x32_bf16 a[60:63], v[244:247], v[156:159], a[60:63]
s_waitcnt lgkmcnt(4)
v_accvgpr_read_b32 v217, a13
v_mfma_f32_16x16x32_bf16 a[48:51], v[224:227], v[160:163], a[48:51]
ds_read_b64_tr_b16 v[240:241], v12 offset:4096
ds_read_b64_tr_b16 v[242:243], v12 offset:6144
v_mfma_f32_16x16x32_bf16 a[48:51], v[228:231], v[0:3], a[48:51]
v_accvgpr_read_b32 v218, a14
v_accvgpr_read_b32 v219, a15
v_mfma_f32_16x16x32_bf16 a[52:55], v[224:227], v[164:167], a[52:55]
v_cvt_pk_bf16_f32 v112, v216, v217
v_cvt_pk_bf16_f32 v113, v218, v219
v_mfma_f32_16x16x32_bf16 a[52:55], v[228:231], v[32:35], a[52:55]
v_accvgpr_read_b32 v196, a16
v_accvgpr_read_b32 v197, a17
v_mfma_f32_16x16x32_bf16 a[56:59], v[224:227], v[168:171], a[56:59]
ds_read_b64_tr_b16 v[244:245], v12 offset:20480
ds_read_b64_tr_b16 v[246:247], v12 offset:22528
v_mfma_f32_16x16x32_bf16 a[56:59], v[228:231], v[64:67], a[56:59]
v_accvgpr_read_b32 v198, a18
v_accvgpr_read_b32 v199, a19
v_mfma_f32_16x16x32_bf16 a[60:63], v[224:227], v[172:175], a[60:63]
v_cvt_pk_bf16_f32 v18, v196, v197
v_cvt_pk_bf16_f32 v19, v198, v199
v_mfma_f32_16x16x32_bf16 a[60:63], v[228:231], v[96:99], a[60:63]
s_waitcnt lgkmcnt(4)
buffer_store_dwordx4 v[16:19], v252, s[20:23], s40 offen offset:0 sc1
v_mfma_f32_16x16x32_bf16 a[64:67], v[232:235], v[4:7], a[64:67]
ds_read_b64_tr_b16 v[224:225], v12 offset:36864
ds_read_b64_tr_b16 v[226:227], v12 offset:38912
v_mfma_f32_16x16x32_bf16 a[64:67], v[236:239], v[176:179], a[64:67]
v_accvgpr_read_b32 v204, a20
v_accvgpr_read_b32 v205, a21
v_mfma_f32_16x16x32_bf16 a[68:71], v[232:235], v[36:39], a[68:71]
v_accvgpr_read_b32 v206, a22
v_accvgpr_read_b32 v207, a23
v_mfma_f32_16x16x32_bf16 a[68:71], v[236:239], v[180:183], a[68:71]
v_cvt_pk_bf16_f32 v50, v204, v205
v_cvt_pk_bf16_f32 v51, v206, v207
v_mfma_f32_16x16x32_bf16 a[72:75], v[232:235], v[68:71], a[72:75]
ds_read_b64_tr_b16 v[228:229], v12 offset:53248
ds_read_b64_tr_b16 v[230:231], v12 offset:55296
v_mfma_f32_16x16x32_bf16 a[72:75], v[236:239], v[184:187], a[72:75]
buffer_store_dwordx4 v[48:51], v252, s[20:23], s41 offen offset:0 sc1
v_accvgpr_read_b32 v212, a24
v_mfma_f32_16x16x32_bf16 a[76:79], v[232:235], v[100:103], a[76:79]
v_accvgpr_read_b32 v213, a25
v_accvgpr_read_b32 v214, a26
v_mfma_f32_16x16x32_bf16 a[76:79], v[236:239], v[188:191], a[76:79]
s_waitcnt lgkmcnt(4)
v_accvgpr_read_b32 v215, a27
v_mfma_f32_16x16x32_bf16 a[64:67], v[240:243], v[128:131], a[64:67]
ds_read_b64_tr_b16 v[232:233], v250 offset:36864
ds_read_b64_tr_b16 v[234:235], v250 offset:38912
v_mfma_f32_16x16x32_bf16 a[64:67], v[244:247], v[144:147], a[64:67]
v_cvt_pk_bf16_f32 v82, v212, v213
v_cvt_pk_bf16_f32 v83, v214, v215
v_mfma_f32_16x16x32_bf16 a[68:71], v[240:243], v[132:135], a[68:71]
buffer_store_dwordx4 v[80:83], v252, s[20:23], s42 offen offset:0 sc1
v_accvgpr_read_b32 v220, a28
v_mfma_f32_16x16x32_bf16 a[68:71], v[244:247], v[148:151], a[68:71]
v_accvgpr_read_b32 v221, a29
v_accvgpr_read_b32 v222, a30
v_mfma_f32_16x16x32_bf16 a[72:75], v[240:243], v[136:139], a[72:75]
ds_read_b64_tr_b16 v[236:237], v250 offset:53248
ds_read_b64_tr_b16 v[238:239], v250 offset:55296
v_mfma_f32_16x16x32_bf16 a[72:75], v[244:247], v[152:155], a[72:75]
v_accvgpr_read_b32 v223, a31
v_cvt_pk_bf16_f32 v114, v220, v221
v_mfma_f32_16x16x32_bf16 a[76:79], v[240:243], v[140:143], a[76:79]
v_cvt_pk_bf16_f32 v115, v222, v223
buffer_store_dwordx4 v[112:115], v252, s[20:23], s43 offen offset:0 sc1
v_mfma_f32_16x16x32_bf16 a[76:79], v[244:247], v[156:159], a[76:79]
s_waitcnt lgkmcnt(4)
v_accvgpr_read_b32 v192, a32
v_mfma_f32_16x16x32_bf16 a[64:67], v[224:227], v[160:163], a[64:67]
ds_read_b64_tr_b16 v[240:241], v13 offset:4096
ds_read_b64_tr_b16 v[242:243], v13 offset:6144
v_mfma_f32_16x16x32_bf16 a[64:67], v[228:231], v[0:3], a[64:67]
v_accvgpr_read_b32 v193, a33
v_accvgpr_read_b32 v194, a34
v_mfma_f32_16x16x32_bf16 a[68:71], v[224:227], v[164:167], a[68:71]
v_accvgpr_read_b32 v195, a35
v_cvt_pk_bf16_f32 v20, v192, v193
v_mfma_f32_16x16x32_bf16 a[68:71], v[228:231], v[32:35], a[68:71]
v_cvt_pk_bf16_f32 v21, v194, v195
v_accvgpr_read_b32 v200, a36
v_mfma_f32_16x16x32_bf16 a[72:75], v[224:227], v[168:171], a[72:75]
ds_read_b64_tr_b16 v[244:245], v13 offset:20480
ds_read_b64_tr_b16 v[246:247], v13 offset:22528
v_mfma_f32_16x16x32_bf16 a[72:75], v[228:231], v[64:67], a[72:75]
v_accvgpr_read_b32 v201, a37
v_accvgpr_read_b32 v202, a38
v_mfma_f32_16x16x32_bf16 a[76:79], v[224:227], v[172:175], a[76:79]
v_accvgpr_read_b32 v203, a39
v_cvt_pk_bf16_f32 v52, v200, v201
v_mfma_f32_16x16x32_bf16 a[76:79], v[228:231], v[96:99], a[76:79]
s_waitcnt lgkmcnt(4)
v_cvt_pk_bf16_f32 v53, v202, v203
v_mfma_f32_16x16x32_bf16 a[80:83], v[232:235], v[4:7], a[80:83]
ds_read_b64_tr_b16 v[224:225], v13 offset:36864
ds_read_b64_tr_b16 v[226:227], v13 offset:38912
v_mfma_f32_16x16x32_bf16 a[80:83], v[236:239], v[176:179], a[80:83]
v_accvgpr_read_b32 v208, a40
v_accvgpr_read_b32 v209, a41
v_mfma_f32_16x16x32_bf16 a[84:87], v[232:235], v[36:39], a[84:87]
v_accvgpr_read_b32 v210, a42
v_accvgpr_read_b32 v211, a43
v_mfma_f32_16x16x32_bf16 a[84:87], v[236:239], v[180:183], a[84:87]
v_cvt_pk_bf16_f32 v84, v208, v209
v_cvt_pk_bf16_f32 v85, v210, v211
v_mfma_f32_16x16x32_bf16 a[88:91], v[232:235], v[68:71], a[88:91]
ds_read_b64_tr_b16 v[228:229], v13 offset:53248
ds_read_b64_tr_b16 v[230:231], v13 offset:55296
v_mfma_f32_16x16x32_bf16 a[88:91], v[236:239], v[184:187], a[88:91]
v_accvgpr_read_b32 v216, a44
v_accvgpr_read_b32 v217, a45
v_mfma_f32_16x16x32_bf16 a[92:95], v[232:235], v[100:103], a[92:95]
v_accvgpr_read_b32 v218, a46
v_accvgpr_read_b32 v219, a47
v_mfma_f32_16x16x32_bf16 a[92:95], v[236:239], v[188:191], a[92:95]
s_waitcnt lgkmcnt(4)
v_cvt_pk_bf16_f32 v116, v216, v217
v_mfma_f32_16x16x32_bf16 a[80:83], v[240:243], v[128:131], a[80:83]
ds_read_b64_tr_b16 v[232:233], v249 offset:37376
ds_read_b64_tr_b16 v[234:235], v249 offset:39424
v_mfma_f32_16x16x32_bf16 a[80:83], v[244:247], v[144:147], a[80:83]
v_cvt_pk_bf16_f32 v117, v218, v219
v_accvgpr_read_b32 v196, a48
v_mfma_f32_16x16x32_bf16 a[84:87], v[240:243], v[132:135], a[84:87]
v_accvgpr_read_b32 v197, a49
v_accvgpr_read_b32 v198, a50
v_mfma_f32_16x16x32_bf16 a[84:87], v[244:247], v[148:151], a[84:87]
v_accvgpr_read_b32 v199, a51
v_cvt_pk_bf16_f32 v22, v196, v197
v_mfma_f32_16x16x32_bf16 a[88:91], v[240:243], v[136:139], a[88:91]
ds_read_b64_tr_b16 v[236:237], v249 offset:53760
ds_read_b64_tr_b16 v[238:239], v249 offset:55808
v_mfma_f32_16x16x32_bf16 a[88:91], v[244:247], v[152:155], a[88:91]
v_cvt_pk_bf16_f32 v23, v198, v199
buffer_store_dwordx4 v[20:23], v252, s[20:23], s40 offen offset:1024 sc1
v_mfma_f32_16x16x32_bf16 a[92:95], v[240:243], v[140:143], a[92:95]
v_accvgpr_read_b32 v204, a52
v_accvgpr_read_b32 v205, a53
v_mfma_f32_16x16x32_bf16 a[92:95], v[244:247], v[156:159], a[92:95]
s_waitcnt lgkmcnt(4)
v_accvgpr_read_b32 v206, a54
v_mfma_f32_16x16x32_bf16 a[80:83], v[224:227], v[160:163], a[80:83]
ds_read_b64_tr_b16 v[240:241], v12 offset:4608
ds_read_b64_tr_b16 v[242:243], v12 offset:6656
v_mfma_f32_16x16x32_bf16 a[80:83], v[228:231], v[0:3], a[80:83]
v_accvgpr_read_b32 v207, a55
v_cvt_pk_bf16_f32 v54, v204, v205
v_mfma_f32_16x16x32_bf16 a[84:87], v[224:227], v[164:167], a[84:87]
v_cvt_pk_bf16_f32 v55, v206, v207
buffer_store_dwordx4 v[52:55], v252, s[20:23], s41 offen offset:1024 sc1
v_mfma_f32_16x16x32_bf16 a[84:87], v[228:231], v[32:35], a[84:87]
v_accvgpr_read_b32 v212, a56
v_accvgpr_read_b32 v213, a57
v_mfma_f32_16x16x32_bf16 a[88:91], v[224:227], v[168:171], a[88:91]
ds_read_b64_tr_b16 v[244:245], v12 offset:20992
ds_read_b64_tr_b16 v[246:247], v12 offset:23040
v_mfma_f32_16x16x32_bf16 a[88:91], v[228:231], v[64:67], a[88:91]
v_accvgpr_read_b32 v214, a58
v_accvgpr_read_b32 v215, a59
v_mfma_f32_16x16x32_bf16 a[92:95], v[224:227], v[172:175], a[92:95]
v_cvt_pk_bf16_f32 v86, v212, v213
v_cvt_pk_bf16_f32 v87, v214, v215
v_mfma_f32_16x16x32_bf16 a[92:95], v[228:231], v[96:99], a[92:95]
s_waitcnt lgkmcnt(4)
buffer_store_dwordx4 v[84:87], v252, s[20:23], s42 offen offset:1024 sc1
v_mfma_f32_16x16x32_bf16 a[96:99], v[232:235], v[4:7], a[96:99]
ds_read_b64_tr_b16 v[224:225], v12 offset:37376
ds_read_b64_tr_b16 v[226:227], v12 offset:39424
v_mfma_f32_16x16x32_bf16 a[96:99], v[236:239], v[176:179], a[96:99]
v_accvgpr_read_b32 v220, a60
v_accvgpr_read_b32 v221, a61
v_mfma_f32_16x16x32_bf16 a[100:103], v[232:235], v[36:39], a[100:103]
v_accvgpr_read_b32 v222, a62
v_accvgpr_read_b32 v223, a63
v_mfma_f32_16x16x32_bf16 a[100:103], v[236:239], v[180:183], a[100:103]
v_cvt_pk_bf16_f32 v118, v220, v221
v_cvt_pk_bf16_f32 v119, v222, v223
v_mfma_f32_16x16x32_bf16 a[104:107], v[232:235], v[68:71], a[104:107]
ds_read_b64_tr_b16 v[228:229], v12 offset:53760
ds_read_b64_tr_b16 v[230:231], v12 offset:55808
v_mfma_f32_16x16x32_bf16 a[104:107], v[236:239], v[184:187], a[104:107]
buffer_store_dwordx4 v[116:119], v252, s[20:23], s43 offen offset:1024 sc1
v_accvgpr_read_b32 v192, a64
v_mfma_f32_16x16x32_bf16 a[108:111], v[232:235], v[100:103], a[108:111]
v_accvgpr_read_b32 v193, a65
v_accvgpr_read_b32 v194, a66
v_mfma_f32_16x16x32_bf16 a[108:111], v[236:239], v[188:191], a[108:111]
s_waitcnt lgkmcnt(4)
v_accvgpr_read_b32 v195, a67
v_mfma_f32_16x16x32_bf16 a[96:99], v[240:243], v[128:131], a[96:99]
ds_read_b64_tr_b16 v[232:233], v250 offset:37376
ds_read_b64_tr_b16 v[234:235], v250 offset:39424
v_mfma_f32_16x16x32_bf16 a[96:99], v[244:247], v[144:147], a[96:99]
v_cvt_pk_bf16_f32 v24, v192, v193
v_cvt_pk_bf16_f32 v25, v194, v195
v_mfma_f32_16x16x32_bf16 a[100:103], v[240:243], v[132:135], a[100:103]
v_accvgpr_read_b32 v200, a68
v_accvgpr_read_b32 v201, a69
v_mfma_f32_16x16x32_bf16 a[100:103], v[244:247], v[148:151], a[100:103]
v_accvgpr_read_b32 v202, a70
v_accvgpr_read_b32 v203, a71
v_mfma_f32_16x16x32_bf16 a[104:107], v[240:243], v[136:139], a[104:107]
ds_read_b64_tr_b16 v[236:237], v250 offset:53760
ds_read_b64_tr_b16 v[238:239], v250 offset:55808
v_mfma_f32_16x16x32_bf16 a[104:107], v[244:247], v[152:155], a[104:107]
v_cvt_pk_bf16_f32 v56, v200, v201
v_cvt_pk_bf16_f32 v57, v202, v203
v_mfma_f32_16x16x32_bf16 a[108:111], v[240:243], v[140:143], a[108:111]
v_accvgpr_read_b32 v208, a72
v_accvgpr_read_b32 v209, a73
v_mfma_f32_16x16x32_bf16 a[108:111], v[244:247], v[156:159], a[108:111]
s_waitcnt lgkmcnt(4)
v_accvgpr_read_b32 v210, a74
v_mfma_f32_16x16x32_bf16 a[96:99], v[224:227], v[160:163], a[96:99]
ds_read_b64_tr_b16 v[240:241], v13 offset:4608
ds_read_b64_tr_b16 v[242:243], v13 offset:6656
v_mfma_f32_16x16x32_bf16 a[96:99], v[228:231], v[0:3], a[96:99]
v_accvgpr_read_b32 v211, a75
v_cvt_pk_bf16_f32 v88, v208, v209
v_mfma_f32_16x16x32_bf16 a[100:103], v[224:227], v[164:167], a[100:103]
v_cvt_pk_bf16_f32 v89, v210, v211
v_accvgpr_read_b32 v216, a76
v_mfma_f32_16x16x32_bf16 a[100:103], v[228:231], v[32:35], a[100:103]
v_accvgpr_read_b32 v217, a77
v_accvgpr_read_b32 v218, a78
v_mfma_f32_16x16x32_bf16 a[104:107], v[224:227], v[168:171], a[104:107]
ds_read_b64_tr_b16 v[244:245], v13 offset:20992
ds_read_b64_tr_b16 v[246:247], v13 offset:23040
v_mfma_f32_16x16x32_bf16 a[104:107], v[228:231], v[64:67], a[104:107]
v_accvgpr_read_b32 v219, a79
v_cvt_pk_bf16_f32 v120, v216, v217
v_mfma_f32_16x16x32_bf16 a[108:111], v[224:227], v[172:175], a[108:111]
v_cvt_pk_bf16_f32 v121, v218, v219
v_accvgpr_read_b32 v196, a80
v_mfma_f32_16x16x32_bf16 a[108:111], v[228:231], v[96:99], a[108:111]
s_waitcnt lgkmcnt(4)
v_accvgpr_read_b32 v197, a81
v_mfma_f32_16x16x32_bf16 a[112:115], v[232:235], v[4:7], a[112:115]
ds_read_b64_tr_b16 v[224:225], v13 offset:37376
ds_read_b64_tr_b16 v[226:227], v13 offset:39424
v_mfma_f32_16x16x32_bf16 a[112:115], v[236:239], v[176:179], a[112:115]
v_accvgpr_read_b32 v198, a82
v_accvgpr_read_b32 v199, a83
v_mfma_f32_16x16x32_bf16 a[116:119], v[232:235], v[36:39], a[116:119]
v_cvt_pk_bf16_f32 v26, v196, v197
v_cvt_pk_bf16_f32 v27, v198, v199
v_mfma_f32_16x16x32_bf16 a[116:119], v[236:239], v[180:183], a[116:119]
buffer_store_dwordx4 v[24:27], v252, s[20:23], s40 offen offset:2048 sc1
v_accvgpr_read_b32 v204, a84
v_mfma_f32_16x16x32_bf16 a[120:123], v[232:235], v[68:71], a[120:123]
ds_read_b64_tr_b16 v[228:229], v13 offset:53760
ds_read_b64_tr_b16 v[230:231], v13 offset:55808
v_mfma_f32_16x16x32_bf16 a[120:123], v[236:239], v[184:187], a[120:123]
v_accvgpr_read_b32 v205, a85
v_accvgpr_read_b32 v206, a86
v_mfma_f32_16x16x32_bf16 a[124:127], v[232:235], v[100:103], a[124:127]
v_accvgpr_read_b32 v207, a87
v_cvt_pk_bf16_f32 v58, v204, v205
v_mfma_f32_16x16x32_bf16 a[124:127], v[236:239], v[188:191], a[124:127]
s_waitcnt lgkmcnt(4)
v_cvt_pk_bf16_f32 v59, v206, v207
v_mfma_f32_16x16x32_bf16 a[112:115], v[240:243], v[128:131], a[112:115]
ds_read_b64_tr_b16 v[232:233], v249 offset:40960
ds_read_b64_tr_b16 v[234:235], v249 offset:43008
v_mfma_f32_16x16x32_bf16 a[112:115], v[244:247], v[144:147], a[112:115]
buffer_store_dwordx4 v[56:59], v252, s[20:23], s41 offen offset:2048 sc1
v_accvgpr_read_b32 v212, a88
v_mfma_f32_16x16x32_bf16 a[116:119], v[240:243], v[132:135], a[116:119]
v_accvgpr_read_b32 v213, a89
v_accvgpr_read_b32 v214, a90
v_mfma_f32_16x16x32_bf16 a[116:119], v[244:247], v[148:151], a[116:119]
v_accvgpr_read_b32 v215, a91
v_cvt_pk_bf16_f32 v90, v212, v213
v_mfma_f32_16x16x32_bf16 a[120:123], v[240:243], v[136:139], a[120:123]
ds_read_b64_tr_b16 v[236:237], v249 offset:57344
ds_read_b64_tr_b16 v[238:239], v249 offset:59392
v_mfma_f32_16x16x32_bf16 a[120:123], v[244:247], v[152:155], a[120:123]
v_cvt_pk_bf16_f32 v91, v214, v215
buffer_store_dwordx4 v[88:91], v252, s[20:23], s42 offen offset:2048 sc1
v_mfma_f32_16x16x32_bf16 a[124:127], v[240:243], v[140:143], a[124:127]
v_accvgpr_read_b32 v220, a92
v_accvgpr_read_b32 v221, a93
v_mfma_f32_16x16x32_bf16 a[124:127], v[244:247], v[156:159], a[124:127]
s_waitcnt lgkmcnt(4)
v_accvgpr_read_b32 v222, a94
v_mfma_f32_16x16x32_bf16 a[112:115], v[224:227], v[160:163], a[112:115]
ds_read_b64_tr_b16 v[240:241], v12 offset:8192
ds_read_b64_tr_b16 v[242:243], v12 offset:10240
v_mfma_f32_16x16x32_bf16 a[112:115], v[228:231], v[0:3], a[112:115]
v_accvgpr_read_b32 v223, a95
v_cvt_pk_bf16_f32 v122, v220, v221
v_mfma_f32_16x16x32_bf16 a[116:119], v[224:227], v[164:167], a[116:119]
v_cvt_pk_bf16_f32 v123, v222, v223
buffer_store_dwordx4 v[120:123], v252, s[20:23], s43 offen offset:2048 sc1
v_mfma_f32_16x16x32_bf16 a[116:119], v[228:231], v[32:35], a[116:119]
v_accvgpr_read_b32 v192, a96
v_accvgpr_read_b32 v193, a97
v_mfma_f32_16x16x32_bf16 a[120:123], v[224:227], v[168:171], a[120:123]
ds_read_b64_tr_b16 v[244:245], v12 offset:24576
ds_read_b64_tr_b16 v[246:247], v12 offset:26624
v_mfma_f32_16x16x32_bf16 a[120:123], v[228:231], v[64:67], a[120:123]
v_accvgpr_read_b32 v194, a98
v_accvgpr_read_b32 v195, a99
v_mfma_f32_16x16x32_bf16 a[124:127], v[224:227], v[172:175], a[124:127]
v_cvt_pk_bf16_f32 v28, v192, v193
v_cvt_pk_bf16_f32 v29, v194, v195
v_mfma_f32_16x16x32_bf16 a[124:127], v[228:231], v[96:99], a[124:127]
s_waitcnt lgkmcnt(4)
v_accvgpr_read_b32 v200, a100
v_mfma_f32_16x16x32_bf16 a[128:131], v[232:235], v[4:7], a[128:131]
ds_read_b64_tr_b16 v[224:225], v12 offset:40960
ds_read_b64_tr_b16 v[226:227], v12 offset:43008
v_mfma_f32_16x16x32_bf16 a[128:131], v[236:239], v[176:179], a[128:131]
v_accvgpr_read_b32 v201, a101
v_accvgpr_read_b32 v202, a102
v_mfma_f32_16x16x32_bf16 a[132:135], v[232:235], v[36:39], a[132:135]
v_accvgpr_read_b32 v203, a103
v_cvt_pk_bf16_f32 v60, v200, v201
v_mfma_f32_16x16x32_bf16 a[132:135], v[236:239], v[180:183], a[132:135]
v_cvt_pk_bf16_f32 v61, v202, v203
v_accvgpr_read_b32 v208, a104
v_mfma_f32_16x16x32_bf16 a[136:139], v[232:235], v[68:71], a[136:139]
ds_read_b64_tr_b16 v[228:229], v12 offset:57344
ds_read_b64_tr_b16 v[230:231], v12 offset:59392
v_mfma_f32_16x16x32_bf16 a[136:139], v[236:239], v[184:187], a[136:139]
v_accvgpr_read_b32 v209, a105
v_accvgpr_read_b32 v210, a106
v_mfma_f32_16x16x32_bf16 a[140:143], v[232:235], v[100:103], a[140:143]
v_accvgpr_read_b32 v211, a107
v_cvt_pk_bf16_f32 v92, v208, v209
v_mfma_f32_16x16x32_bf16 a[140:143], v[236:239], v[188:191], a[140:143]
s_waitcnt lgkmcnt(4)
v_cvt_pk_bf16_f32 v93, v210, v211
v_mfma_f32_16x16x32_bf16 a[128:131], v[240:243], v[128:131], a[128:131]
ds_read_b64_tr_b16 v[232:233], v250 offset:40960
ds_read_b64_tr_b16 v[234:235], v250 offset:43008
v_mfma_f32_16x16x32_bf16 a[128:131], v[244:247], v[144:147], a[128:131]
v_accvgpr_read_b32 v216, a108
v_accvgpr_read_b32 v217, a109
v_mfma_f32_16x16x32_bf16 a[132:135], v[240:243], v[132:135], a[132:135]
v_accvgpr_read_b32 v218, a110
v_accvgpr_read_b32 v219, a111
v_mfma_f32_16x16x32_bf16 a[132:135], v[244:247], v[148:151], a[132:135]
v_cvt_pk_bf16_f32 v124, v216, v217
v_cvt_pk_bf16_f32 v125, v218, v219
v_mfma_f32_16x16x32_bf16 a[136:139], v[240:243], v[136:139], a[136:139]
ds_read_b64_tr_b16 v[236:237], v250 offset:57344
ds_read_b64_tr_b16 v[238:239], v250 offset:59392
v_mfma_f32_16x16x32_bf16 a[136:139], v[244:247], v[152:155], a[136:139]
v_accvgpr_read_b32 v196, a112
v_accvgpr_read_b32 v197, a113
v_mfma_f32_16x16x32_bf16 a[140:143], v[240:243], v[140:143], a[140:143]
v_accvgpr_read_b32 v198, a114
v_accvgpr_read_b32 v199, a115
v_mfma_f32_16x16x32_bf16 a[140:143], v[244:247], v[156:159], a[140:143]
s_waitcnt lgkmcnt(4)
v_cvt_pk_bf16_f32 v30, v196, v197
v_mfma_f32_16x16x32_bf16 a[128:131], v[224:227], v[160:163], a[128:131]
ds_read_b64_tr_b16 v[240:241], v13 offset:8192
ds_read_b64_tr_b16 v[242:243], v13 offset:10240
v_mfma_f32_16x16x32_bf16 a[128:131], v[228:231], v[0:3], a[128:131]
v_cvt_pk_bf16_f32 v31, v198, v199
buffer_store_dwordx4 v[28:31], v252, s[20:23], s40 offen offset:3072 sc1
v_mfma_f32_16x16x32_bf16 a[132:135], v[224:227], v[164:167], a[132:135]
v_accvgpr_read_b32 v204, a116
v_accvgpr_read_b32 v205, a117
v_mfma_f32_16x16x32_bf16 a[132:135], v[228:231], v[32:35], a[132:135]
v_accvgpr_read_b32 v206, a118
v_accvgpr_read_b32 v207, a119
v_mfma_f32_16x16x32_bf16 a[136:139], v[224:227], v[168:171], a[136:139]
ds_read_b64_tr_b16 v[244:245], v13 offset:24576
ds_read_b64_tr_b16 v[246:247], v13 offset:26624
v_mfma_f32_16x16x32_bf16 a[136:139], v[228:231], v[64:67], a[136:139]
v_cvt_pk_bf16_f32 v62, v204, v205
v_cvt_pk_bf16_f32 v63, v206, v207
v_mfma_f32_16x16x32_bf16 a[140:143], v[224:227], v[172:175], a[140:143]
buffer_store_dwordx4 v[60:63], v252, s[20:23], s41 offen offset:3072 sc1
v_accvgpr_read_b32 v212, a120
v_mfma_f32_16x16x32_bf16 a[140:143], v[228:231], v[96:99], a[140:143]
s_waitcnt lgkmcnt(4)
v_accvgpr_read_b32 v213, a121
v_mfma_f32_16x16x32_bf16 a[144:147], v[232:235], v[4:7], a[144:147]
ds_read_b64_tr_b16 v[224:225], v13 offset:40960
ds_read_b64_tr_b16 v[226:227], v13 offset:43008
v_mfma_f32_16x16x32_bf16 a[144:147], v[236:239], v[176:179], a[144:147]
v_accvgpr_read_b32 v214, a122
v_accvgpr_read_b32 v215, a123
v_mfma_f32_16x16x32_bf16 a[148:151], v[232:235], v[36:39], a[148:151]
v_cvt_pk_bf16_f32 v94, v212, v213
v_cvt_pk_bf16_f32 v95, v214, v215
v_mfma_f32_16x16x32_bf16 a[148:151], v[236:239], v[180:183], a[148:151]
buffer_store_dwordx4 v[92:95], v252, s[20:23], s42 offen offset:3072 sc1
v_accvgpr_read_b32 v220, a124
v_mfma_f32_16x16x32_bf16 a[152:155], v[232:235], v[68:71], a[152:155]
ds_read_b64_tr_b16 v[228:229], v13 offset:57344
ds_read_b64_tr_b16 v[230:231], v13 offset:59392
v_mfma_f32_16x16x32_bf16 a[152:155], v[236:239], v[184:187], a[152:155]
v_accvgpr_read_b32 v221, a125
v_accvgpr_read_b32 v222, a126
v_mfma_f32_16x16x32_bf16 a[156:159], v[232:235], v[100:103], a[156:159]
v_accvgpr_read_b32 v223, a127
v_cvt_pk_bf16_f32 v126, v220, v221
v_mfma_f32_16x16x32_bf16 a[156:159], v[236:239], v[188:191], a[156:159]
s_waitcnt lgkmcnt(4)
v_cvt_pk_bf16_f32 v127, v222, v223
v_mfma_f32_16x16x32_bf16 a[144:147], v[240:243], v[128:131], a[144:147]
ds_read_b64_tr_b16 v[232:233], v249 offset:41472
ds_read_b64_tr_b16 v[234:235], v249 offset:43520
v_mfma_f32_16x16x32_bf16 a[144:147], v[244:247], v[144:147], a[144:147]
buffer_store_dwordx4 v[124:127], v252, s[20:23], s43 offen offset:3072 sc1
v_accvgpr_read_b32 v192, a128
v_mfma_f32_16x16x32_bf16 a[148:151], v[240:243], v[132:135], a[148:151]
v_accvgpr_read_b32 v193, a129
v_accvgpr_read_b32 v194, a130
v_mfma_f32_16x16x32_bf16 a[148:151], v[244:247], v[148:151], a[148:151]
v_accvgpr_read_b32 v195, a131
v_cvt_pk_bf16_f32 v16, v192, v193
v_mfma_f32_16x16x32_bf16 a[152:155], v[240:243], v[136:139], a[152:155]
ds_read_b64_tr_b16 v[236:237], v249 offset:57856
ds_read_b64_tr_b16 v[238:239], v249 offset:59904
v_mfma_f32_16x16x32_bf16 a[152:155], v[244:247], v[152:155], a[152:155]
v_cvt_pk_bf16_f32 v17, v194, v195
v_accvgpr_read_b32 v200, a132
v_mfma_f32_16x16x32_bf16 a[156:159], v[240:243], v[140:143], a[156:159]
v_accvgpr_read_b32 v201, a133
v_accvgpr_read_b32 v202, a134
v_mfma_f32_16x16x32_bf16 a[156:159], v[244:247], v[156:159], a[156:159]
s_waitcnt lgkmcnt(4)
v_accvgpr_read_b32 v203, a135
v_mfma_f32_16x16x32_bf16 a[144:147], v[224:227], v[160:163], a[144:147]
ds_read_b64_tr_b16 v[240:241], v12 offset:8704
ds_read_b64_tr_b16 v[242:243], v12 offset:10752
v_mfma_f32_16x16x32_bf16 a[144:147], v[228:231], v[0:3], a[144:147]
v_cvt_pk_bf16_f32 v48, v200, v201
v_cvt_pk_bf16_f32 v49, v202, v203
v_mfma_f32_16x16x32_bf16 a[148:151], v[224:227], v[164:167], a[148:151]
v_accvgpr_read_b32 v208, a136
v_accvgpr_read_b32 v209, a137
v_mfma_f32_16x16x32_bf16 a[148:151], v[228:231], v[32:35], a[148:151]
v_accvgpr_read_b32 v210, a138
v_accvgpr_read_b32 v211, a139
v_mfma_f32_16x16x32_bf16 a[152:155], v[224:227], v[168:171], a[152:155]
ds_read_b64_tr_b16 v[244:245], v12 offset:25088
ds_read_b64_tr_b16 v[246:247], v12 offset:27136
v_mfma_f32_16x16x32_bf16 a[152:155], v[228:231], v[64:67], a[152:155]
v_cvt_pk_bf16_f32 v80, v208, v209
v_cvt_pk_bf16_f32 v81, v210, v211
v_mfma_f32_16x16x32_bf16 a[156:159], v[224:227], v[172:175], a[156:159]
v_accvgpr_read_b32 v216, a140
v_accvgpr_read_b32 v217, a141
v_mfma_f32_16x16x32_bf16 a[156:159], v[228:231], v[96:99], a[156:159]
s_waitcnt lgkmcnt(4)
v_accvgpr_read_b32 v218, a142
v_mfma_f32_16x16x32_bf16 a[160:163], v[232:235], v[4:7], a[160:163]
ds_read_b64_tr_b16 v[224:225], v12 offset:41472
ds_read_b64_tr_b16 v[226:227], v12 offset:43520
v_mfma_f32_16x16x32_bf16 a[160:163], v[236:239], v[176:179], a[160:163]
v_accvgpr_read_b32 v219, a143
v_cvt_pk_bf16_f32 v112, v216, v217
v_mfma_f32_16x16x32_bf16 a[164:167], v[232:235], v[36:39], a[164:167]
v_cvt_pk_bf16_f32 v113, v218, v219
v_accvgpr_read_b32 v196, a144
v_mfma_f32_16x16x32_bf16 a[164:167], v[236:239], v[180:183], a[164:167]
v_accvgpr_read_b32 v197, a145
v_accvgpr_read_b32 v198, a146
v_mfma_f32_16x16x32_bf16 a[168:171], v[232:235], v[68:71], a[168:171]
ds_read_b64_tr_b16 v[228:229], v12 offset:57856
ds_read_b64_tr_b16 v[230:231], v12 offset:59904
v_mfma_f32_16x16x32_bf16 a[168:171], v[236:239], v[184:187], a[168:171]
v_accvgpr_read_b32 v199, a147
v_cvt_pk_bf16_f32 v18, v196, v197
v_mfma_f32_16x16x32_bf16 a[172:175], v[232:235], v[100:103], a[172:175]
v_cvt_pk_bf16_f32 v19, v198, v199
buffer_store_dwordx4 v[16:19], v252, s[20:23], s44 offen offset:0 sc1
v_mfma_f32_16x16x32_bf16 a[172:175], v[236:239], v[188:191], a[172:175]
s_waitcnt lgkmcnt(4)
v_accvgpr_read_b32 v204, a148
v_mfma_f32_16x16x32_bf16 a[160:163], v[240:243], v[128:131], a[160:163]
ds_read_b64_tr_b16 v[232:233], v250 offset:41472
ds_read_b64_tr_b16 v[234:235], v250 offset:43520
v_mfma_f32_16x16x32_bf16 a[160:163], v[244:247], v[144:147], a[160:163]
v_accvgpr_read_b32 v205, a149
v_accvgpr_read_b32 v206, a150
v_mfma_f32_16x16x32_bf16 a[164:167], v[240:243], v[132:135], a[164:167]
v_accvgpr_read_b32 v207, a151
v_cvt_pk_bf16_f32 v50, v204, v205
v_mfma_f32_16x16x32_bf16 a[164:167], v[244:247], v[148:151], a[164:167]
v_cvt_pk_bf16_f32 v51, v206, v207
buffer_store_dwordx4 v[48:51], v252, s[20:23], s45 offen offset:0 sc1
v_mfma_f32_16x16x32_bf16 a[168:171], v[240:243], v[136:139], a[168:171]
ds_read_b64_tr_b16 v[236:237], v250 offset:57856
ds_read_b64_tr_b16 v[238:239], v250 offset:59904
v_mfma_f32_16x16x32_bf16 a[168:171], v[244:247], v[152:155], a[168:171]
v_accvgpr_read_b32 v212, a152
v_accvgpr_read_b32 v213, a153
v_mfma_f32_16x16x32_bf16 a[172:175], v[240:243], v[140:143], a[172:175]
v_accvgpr_read_b32 v214, a154
v_accvgpr_read_b32 v215, a155
v_mfma_f32_16x16x32_bf16 a[172:175], v[244:247], v[156:159], a[172:175]
s_waitcnt lgkmcnt(4)
v_cvt_pk_bf16_f32 v82, v212, v213
v_mfma_f32_16x16x32_bf16 a[160:163], v[224:227], v[160:163], a[160:163]
ds_read_b64_tr_b16 v[240:241], v13 offset:8704
ds_read_b64_tr_b16 v[242:243], v13 offset:10752
v_mfma_f32_16x16x32_bf16 a[160:163], v[228:231], v[0:3], a[160:163]
v_cvt_pk_bf16_f32 v83, v214, v215
buffer_store_dwordx4 v[80:83], v252, s[20:23], s46 offen offset:0 sc1
v_mfma_f32_16x16x32_bf16 a[164:167], v[224:227], v[164:167], a[164:167]
v_accvgpr_read_b32 v220, a156
v_accvgpr_read_b32 v221, a157
v_mfma_f32_16x16x32_bf16 a[164:167], v[228:231], v[32:35], a[164:167]
v_accvgpr_read_b32 v222, a158
v_accvgpr_read_b32 v223, a159
v_mfma_f32_16x16x32_bf16 a[168:171], v[224:227], v[168:171], a[168:171]
ds_read_b64_tr_b16 v[244:245], v13 offset:25088
ds_read_b64_tr_b16 v[246:247], v13 offset:27136
v_mfma_f32_16x16x32_bf16 a[168:171], v[228:231], v[64:67], a[168:171]
v_cvt_pk_bf16_f32 v114, v220, v221
v_cvt_pk_bf16_f32 v115, v222, v223
v_mfma_f32_16x16x32_bf16 a[172:175], v[224:227], v[172:175], a[172:175]
buffer_store_dwordx4 v[112:115], v252, s[20:23], s47 offen offset:0 sc1
v_accvgpr_read_b32 v192, a160
v_mfma_f32_16x16x32_bf16 a[172:175], v[228:231], v[96:99], a[172:175]
s_waitcnt lgkmcnt(4)
v_accvgpr_read_b32 v193, a161
v_mfma_f32_16x16x32_bf16 a[176:179], v[232:235], v[4:7], a[176:179]
ds_read_b64_tr_b16 v[224:225], v13 offset:41472
ds_read_b64_tr_b16 v[226:227], v13 offset:43520
v_mfma_f32_16x16x32_bf16 a[176:179], v[236:239], v[176:179], a[176:179]
v_accvgpr_read_b32 v194, a162
v_accvgpr_read_b32 v195, a163
v_mfma_f32_16x16x32_bf16 a[180:183], v[232:235], v[36:39], a[180:183]
v_cvt_pk_bf16_f32 v20, v192, v193
v_cvt_pk_bf16_f32 v21, v194, v195
v_mfma_f32_16x16x32_bf16 a[180:183], v[236:239], v[180:183], a[180:183]
v_accvgpr_read_b32 v200, a164
v_accvgpr_read_b32 v201, a165
v_mfma_f32_16x16x32_bf16 a[184:187], v[232:235], v[68:71], a[184:187]
ds_read_b64_tr_b16 v[228:229], v13 offset:57856
ds_read_b64_tr_b16 v[230:231], v13 offset:59904
v_mfma_f32_16x16x32_bf16 a[184:187], v[236:239], v[184:187], a[184:187]
v_accvgpr_read_b32 v202, a166
v_accvgpr_read_b32 v203, a167
v_mfma_f32_16x16x32_bf16 a[188:191], v[232:235], v[100:103], a[188:191]
v_cvt_pk_bf16_f32 v52, v200, v201
v_cvt_pk_bf16_f32 v53, v202, v203
v_mfma_f32_16x16x32_bf16 a[188:191], v[236:239], v[188:191], a[188:191]
s_waitcnt lgkmcnt(4)
v_accvgpr_read_b32 v208, a168
v_mfma_f32_16x16x32_bf16 a[176:179], v[240:243], v[128:131], a[176:179]
ds_read_b64_tr_b16 v[232:233], v249 offset:45056
ds_read_b64_tr_b16 v[234:235], v249 offset:47104
v_mfma_f32_16x16x32_bf16 a[176:179], v[244:247], v[144:147], a[176:179]
v_accvgpr_read_b32 v209, a169
v_accvgpr_read_b32 v210, a170
v_mfma_f32_16x16x32_bf16 a[180:183], v[240:243], v[132:135], a[180:183]
v_accvgpr_read_b32 v211, a171
v_cvt_pk_bf16_f32 v84, v208, v209
v_mfma_f32_16x16x32_bf16 a[180:183], v[244:247], v[148:151], a[180:183]
v_cvt_pk_bf16_f32 v85, v210, v211
v_accvgpr_read_b32 v216, a172
v_mfma_f32_16x16x32_bf16 a[184:187], v[240:243], v[136:139], a[184:187]
ds_read_b64_tr_b16 v[236:237], v249 offset:61440
ds_read_b64_tr_b16 v[238:239], v249 offset:63488
v_mfma_f32_16x16x32_bf16 a[184:187], v[244:247], v[152:155], a[184:187]
v_accvgpr_read_b32 v217, a173
v_accvgpr_read_b32 v218, a174
v_mfma_f32_16x16x32_bf16 a[188:191], v[240:243], v[140:143], a[188:191]
v_accvgpr_read_b32 v219, a175
v_cvt_pk_bf16_f32 v116, v216, v217
v_mfma_f32_16x16x32_bf16 a[188:191], v[244:247], v[156:159], a[188:191]
s_waitcnt lgkmcnt(4)
v_cvt_pk_bf16_f32 v117, v218, v219
v_mfma_f32_16x16x32_bf16 a[176:179], v[224:227], v[160:163], a[176:179]
ds_read_b64_tr_b16 v[240:241], v12 offset:12288
ds_read_b64_tr_b16 v[242:243], v12 offset:14336
v_mfma_f32_16x16x32_bf16 a[176:179], v[228:231], v[0:3], a[176:179]
v_mfma_f32_16x16x32_bf16 a[180:183], v[224:227], v[164:167], a[180:183]
v_mfma_f32_16x16x32_bf16 a[180:183], v[228:231], v[32:35], a[180:183]
v_mfma_f32_16x16x32_bf16 a[184:187], v[224:227], v[168:171], a[184:187]
ds_read_b64_tr_b16 v[244:245], v12 offset:28672
ds_read_b64_tr_b16 v[246:247], v12 offset:30720
v_mfma_f32_16x16x32_bf16 a[184:187], v[228:231], v[64:67], a[184:187]
v_mfma_f32_16x16x32_bf16 a[188:191], v[224:227], v[172:175], a[188:191]
s_nop 0
v_accvgpr_read_b32 v196, a176
v_accvgpr_read_b32 v197, a177
v_mfma_f32_16x16x32_bf16 a[188:191], v[228:231], v[96:99], a[188:191]
s_waitcnt lgkmcnt(4)
v_accvgpr_read_b32 v198, a178
v_mfma_f32_16x16x32_bf16 a[192:195], v[232:235], v[4:7], a[192:195]
ds_read_b64_tr_b16 v[224:225], v12 offset:45056
ds_read_b64_tr_b16 v[226:227], v12 offset:47104
v_mfma_f32_16x16x32_bf16 a[192:195], v[236:239], v[176:179], a[192:195]
v_accvgpr_read_b32 v199, a179
v_cvt_pk_bf16_f32 v22, v196, v197
v_mfma_f32_16x16x32_bf16 a[196:199], v[232:235], v[36:39], a[196:199]
v_cvt_pk_bf16_f32 v23, v198, v199
buffer_store_dwordx4 v[20:23], v252, s[20:23], s44 offen offset:1024 sc1
v_mfma_f32_16x16x32_bf16 a[196:199], v[236:239], v[180:183], a[196:199]
v_accvgpr_read_b32 v204, a180
v_accvgpr_read_b32 v205, a181
v_mfma_f32_16x16x32_bf16 a[200:203], v[232:235], v[68:71], a[200:203]
ds_read_b64_tr_b16 v[228:229], v12 offset:61440
ds_read_b64_tr_b16 v[230:231], v12 offset:63488
v_mfma_f32_16x16x32_bf16 a[200:203], v[236:239], v[184:187], a[200:203]
v_accvgpr_read_b32 v206, a182
v_accvgpr_read_b32 v207, a183
v_mfma_f32_16x16x32_bf16 a[204:207], v[232:235], v[100:103], a[204:207]
v_cvt_pk_bf16_f32 v54, v204, v205
v_cvt_pk_bf16_f32 v55, v206, v207
v_mfma_f32_16x16x32_bf16 a[204:207], v[236:239], v[188:191], a[204:207]
s_waitcnt lgkmcnt(4)
buffer_store_dwordx4 v[52:55], v252, s[20:23], s45 offen offset:1024 sc1
v_mfma_f32_16x16x32_bf16 a[192:195], v[240:243], v[128:131], a[192:195]
ds_read_b64_tr_b16 v[232:233], v250 offset:45056
ds_read_b64_tr_b16 v[234:235], v250 offset:47104
v_mfma_f32_16x16x32_bf16 a[192:195], v[244:247], v[144:147], a[192:195]
v_accvgpr_read_b32 v212, a184
v_accvgpr_read_b32 v213, a185
v_mfma_f32_16x16x32_bf16 a[196:199], v[240:243], v[132:135], a[196:199]
v_accvgpr_read_b32 v214, a186
v_accvgpr_read_b32 v215, a187
v_mfma_f32_16x16x32_bf16 a[196:199], v[244:247], v[148:151], a[196:199]
v_cvt_pk_bf16_f32 v86, v212, v213
v_cvt_pk_bf16_f32 v87, v214, v215
v_mfma_f32_16x16x32_bf16 a[200:203], v[240:243], v[136:139], a[200:203]
ds_read_b64_tr_b16 v[236:237], v250 offset:61440
ds_read_b64_tr_b16 v[238:239], v250 offset:63488
v_mfma_f32_16x16x32_bf16 a[200:203], v[244:247], v[152:155], a[200:203]
buffer_store_dwordx4 v[84:87], v252, s[20:23], s46 offen offset:1024 sc1
v_accvgpr_read_b32 v220, a188
v_mfma_f32_16x16x32_bf16 a[204:207], v[240:243], v[140:143], a[204:207]
v_accvgpr_read_b32 v221, a189
v_accvgpr_read_b32 v222, a190
v_mfma_f32_16x16x32_bf16 a[204:207], v[244:247], v[156:159], a[204:207]
s_waitcnt lgkmcnt(4)
v_accvgpr_read_b32 v223, a191
v_mfma_f32_16x16x32_bf16 a[192:195], v[224:227], v[160:163], a[192:195]
ds_read_b64_tr_b16 v[240:241], v13 offset:12288
ds_read_b64_tr_b16 v[242:243], v13 offset:14336
v_mfma_f32_16x16x32_bf16 a[192:195], v[228:231], v[0:3], a[192:195]
v_cvt_pk_bf16_f32 v118, v220, v221
v_cvt_pk_bf16_f32 v119, v222, v223
v_mfma_f32_16x16x32_bf16 a[196:199], v[224:227], v[164:167], a[196:199]
buffer_store_dwordx4 v[116:119], v252, s[20:23], s47 offen offset:1024 sc1
v_mfma_f32_16x16x32_bf16 a[196:199], v[228:231], v[32:35], a[196:199]
v_mfma_f32_16x16x32_bf16 a[200:203], v[224:227], v[168:171], a[200:203]
ds_read_b64_tr_b16 v[244:245], v13 offset:28672
ds_read_b64_tr_b16 v[246:247], v13 offset:30720
v_mfma_f32_16x16x32_bf16 a[200:203], v[228:231], v[64:67], a[200:203]
v_mfma_f32_16x16x32_bf16 a[204:207], v[224:227], v[172:175], a[204:207]
v_accvgpr_read_b32 v192, a192
v_accvgpr_read_b32 v193, a193
v_mfma_f32_16x16x32_bf16 a[204:207], v[228:231], v[96:99], a[204:207]
s_waitcnt lgkmcnt(4)
v_accvgpr_read_b32 v194, a194
v_mfma_f32_16x16x32_bf16 a[208:211], v[232:235], v[4:7], a[208:211]
ds_read_b64_tr_b16 v[224:225], v13 offset:45056
ds_read_b64_tr_b16 v[226:227], v13 offset:47104
v_mfma_f32_16x16x32_bf16 a[208:211], v[236:239], v[176:179], a[208:211]
v_accvgpr_read_b32 v195, a195
v_cvt_pk_bf16_f32 v24, v192, v193
v_mfma_f32_16x16x32_bf16 a[212:215], v[232:235], v[36:39], a[212:215]
v_cvt_pk_bf16_f32 v25, v194, v195
v_accvgpr_read_b32 v200, a196
v_mfma_f32_16x16x32_bf16 a[212:215], v[236:239], v[180:183], a[212:215]
v_accvgpr_read_b32 v201, a197
v_accvgpr_read_b32 v202, a198
v_mfma_f32_16x16x32_bf16 a[216:219], v[232:235], v[68:71], a[216:219]
ds_read_b64_tr_b16 v[228:229], v13 offset:61440
ds_read_b64_tr_b16 v[230:231], v13 offset:63488
v_mfma_f32_16x16x32_bf16 a[216:219], v[236:239], v[184:187], a[216:219]
v_accvgpr_read_b32 v203, a199
v_cvt_pk_bf16_f32 v56, v200, v201
v_mfma_f32_16x16x32_bf16 a[220:223], v[232:235], v[100:103], a[220:223]
v_cvt_pk_bf16_f32 v57, v202, v203
v_accvgpr_read_b32 v208, a200
v_mfma_f32_16x16x32_bf16 a[220:223], v[236:239], v[188:191], a[220:223]
s_waitcnt lgkmcnt(4)
v_accvgpr_read_b32 v209, a201
v_mfma_f32_16x16x32_bf16 a[208:211], v[240:243], v[128:131], a[208:211]
ds_read_b64_tr_b16 v[232:233], v249 offset:45568
ds_read_b64_tr_b16 v[234:235], v249 offset:47616
v_mfma_f32_16x16x32_bf16 a[208:211], v[244:247], v[144:147], a[208:211]
v_accvgpr_read_b32 v210, a202
v_accvgpr_read_b32 v211, a203
v_mfma_f32_16x16x32_bf16 a[212:215], v[240:243], v[132:135], a[212:215]
v_cvt_pk_bf16_f32 v88, v208, v209
v_cvt_pk_bf16_f32 v89, v210, v211
v_mfma_f32_16x16x32_bf16 a[212:215], v[244:247], v[148:151], a[212:215]
v_accvgpr_read_b32 v216, a204
v_accvgpr_read_b32 v217, a205
v_mfma_f32_16x16x32_bf16 a[216:219], v[240:243], v[136:139], a[216:219]
ds_read_b64_tr_b16 v[236:237], v249 offset:61952
ds_read_b64_tr_b16 v[238:239], v249 offset:64000
v_mfma_f32_16x16x32_bf16 a[216:219], v[244:247], v[152:155], a[216:219]
v_accvgpr_read_b32 v218, a206
v_accvgpr_read_b32 v219, a207
v_mfma_f32_16x16x32_bf16 a[220:223], v[240:243], v[140:143], a[220:223]
v_cvt_pk_bf16_f32 v120, v216, v217
v_cvt_pk_bf16_f32 v121, v218, v219
v_mfma_f32_16x16x32_bf16 a[220:223], v[244:247], v[156:159], a[220:223]
s_waitcnt lgkmcnt(4)
v_mfma_f32_16x16x32_bf16 a[208:211], v[224:227], v[160:163], a[208:211]
ds_read_b64_tr_b16 v[240:241], v12 offset:12800
ds_read_b64_tr_b16 v[242:243], v12 offset:14848
v_mfma_f32_16x16x32_bf16 a[208:211], v[228:231], v[0:3], a[208:211]
v_mfma_f32_16x16x32_bf16 a[212:215], v[224:227], v[164:167], a[212:215]
v_mfma_f32_16x16x32_bf16 a[212:215], v[228:231], v[32:35], a[212:215]
v_mfma_f32_16x16x32_bf16 a[216:219], v[224:227], v[168:171], a[216:219]
ds_read_b64_tr_b16 v[244:245], v12 offset:29184
ds_read_b64_tr_b16 v[246:247], v12 offset:31232
v_mfma_f32_16x16x32_bf16 a[216:219], v[228:231], v[64:67], a[216:219]
v_mfma_f32_16x16x32_bf16 a[220:223], v[224:227], v[172:175], a[220:223]
s_nop 0
v_accvgpr_read_b32 v196, a208
v_accvgpr_read_b32 v197, a209
v_mfma_f32_16x16x32_bf16 a[220:223], v[228:231], v[96:99], a[220:223]
s_waitcnt lgkmcnt(4)
v_accvgpr_read_b32 v198, a210
v_mfma_f32_16x16x32_bf16 a[224:227], v[232:235], v[4:7], a[224:227]
ds_read_b64_tr_b16 v[224:225], v12 offset:45568
ds_read_b64_tr_b16 v[226:227], v12 offset:47616
v_mfma_f32_16x16x32_bf16 a[224:227], v[236:239], v[176:179], a[224:227]
v_accvgpr_read_b32 v199, a211
v_cvt_pk_bf16_f32 v26, v196, v197
v_mfma_f32_16x16x32_bf16 a[228:231], v[232:235], v[36:39], a[228:231]
v_cvt_pk_bf16_f32 v27, v198, v199
buffer_store_dwordx4 v[24:27], v252, s[20:23], s44 offen offset:2048 sc1
v_mfma_f32_16x16x32_bf16 a[228:231], v[236:239], v[180:183], a[228:231]
v_accvgpr_read_b32 v204, a212
v_accvgpr_read_b32 v205, a213
v_mfma_f32_16x16x32_bf16 a[232:235], v[232:235], v[68:71], a[232:235]
ds_read_b64_tr_b16 v[228:229], v12 offset:61952
ds_read_b64_tr_b16 v[230:231], v12 offset:64000
v_mfma_f32_16x16x32_bf16 a[232:235], v[236:239], v[184:187], a[232:235]
v_accvgpr_read_b32 v206, a214
v_accvgpr_read_b32 v207, a215
v_mfma_f32_16x16x32_bf16 a[236:239], v[232:235], v[100:103], a[236:239]
v_cvt_pk_bf16_f32 v58, v204, v205
v_cvt_pk_bf16_f32 v59, v206, v207
v_mfma_f32_16x16x32_bf16 a[236:239], v[236:239], v[188:191], a[236:239]
s_waitcnt lgkmcnt(4)
buffer_store_dwordx4 v[56:59], v252, s[20:23], s45 offen offset:2048 sc1
v_mfma_f32_16x16x32_bf16 a[224:227], v[240:243], v[128:131], a[224:227]
ds_read_b64_tr_b16 v[232:233], v250 offset:45568
ds_read_b64_tr_b16 v[234:235], v250 offset:47616
v_mfma_f32_16x16x32_bf16 a[224:227], v[244:247], v[144:147], a[224:227]
v_accvgpr_read_b32 v212, a216
v_accvgpr_read_b32 v213, a217
v_mfma_f32_16x16x32_bf16 a[228:231], v[240:243], v[132:135], a[228:231]
v_accvgpr_read_b32 v214, a218
v_accvgpr_read_b32 v215, a219
v_mfma_f32_16x16x32_bf16 a[228:231], v[244:247], v[148:151], a[228:231]
v_cvt_pk_bf16_f32 v90, v212, v213
v_cvt_pk_bf16_f32 v91, v214, v215
v_mfma_f32_16x16x32_bf16 a[232:235], v[240:243], v[136:139], a[232:235]
ds_read_b64_tr_b16 v[236:237], v250 offset:61952
ds_read_b64_tr_b16 v[238:239], v250 offset:64000
v_mfma_f32_16x16x32_bf16 a[232:235], v[244:247], v[152:155], a[232:235]
buffer_store_dwordx4 v[88:91], v252, s[20:23], s46 offen offset:2048 sc1
v_accvgpr_read_b32 v220, a220
v_mfma_f32_16x16x32_bf16 a[236:239], v[240:243], v[140:143], a[236:239]
v_accvgpr_read_b32 v221, a221
v_accvgpr_read_b32 v222, a222
v_mfma_f32_16x16x32_bf16 a[236:239], v[244:247], v[156:159], a[236:239]
s_waitcnt lgkmcnt(4)
v_accvgpr_read_b32 v223, a223
v_mfma_f32_16x16x32_bf16 a[224:227], v[224:227], v[160:163], a[224:227]
ds_read_b64_tr_b16 v[240:241], v13 offset:12800
ds_read_b64_tr_b16 v[242:243], v13 offset:14848
v_mfma_f32_16x16x32_bf16 a[224:227], v[228:231], v[0:3], a[224:227]
v_cvt_pk_bf16_f32 v122, v220, v221
v_cvt_pk_bf16_f32 v123, v222, v223
v_mfma_f32_16x16x32_bf16 a[228:231], v[224:227], v[164:167], a[228:231]
buffer_store_dwordx4 v[120:123], v252, s[20:23], s47 offen offset:2048 sc1
v_mfma_f32_16x16x32_bf16 a[228:231], v[228:231], v[32:35], a[228:231]
v_mfma_f32_16x16x32_bf16 a[232:235], v[224:227], v[168:171], a[232:235]
ds_read_b64_tr_b16 v[244:245], v13 offset:29184
ds_read_b64_tr_b16 v[246:247], v13 offset:31232
v_mfma_f32_16x16x32_bf16 a[232:235], v[228:231], v[64:67], a[232:235]
v_mfma_f32_16x16x32_bf16 a[236:239], v[224:227], v[172:175], a[236:239]
v_accvgpr_read_b32 v192, a224
v_accvgpr_read_b32 v193, a225
v_mfma_f32_16x16x32_bf16 a[236:239], v[228:231], v[96:99], a[236:239]
s_waitcnt lgkmcnt(4)
v_accvgpr_read_b32 v194, a226
v_mfma_f32_16x16x32_bf16 a[240:243], v[232:235], v[4:7], a[240:243]
ds_read_b64_tr_b16 v[224:225], v13 offset:45568
ds_read_b64_tr_b16 v[226:227], v13 offset:47616
v_mfma_f32_16x16x32_bf16 a[240:243], v[236:239], v[176:179], a[240:243]
v_accvgpr_read_b32 v195, a227
v_cvt_pk_bf16_f32 v28, v192, v193
v_mfma_f32_16x16x32_bf16 a[244:247], v[232:235], v[36:39], a[244:247]
v_cvt_pk_bf16_f32 v29, v194, v195
v_accvgpr_read_b32 v200, a228
v_mfma_f32_16x16x32_bf16 a[244:247], v[236:239], v[180:183], a[244:247]
v_accvgpr_read_b32 v201, a229
v_accvgpr_read_b32 v202, a230
v_mfma_f32_16x16x32_bf16 a[248:251], v[232:235], v[68:71], a[248:251]
ds_read_b64_tr_b16 v[228:229], v13 offset:61952
ds_read_b64_tr_b16 v[230:231], v13 offset:64000
v_mfma_f32_16x16x32_bf16 a[248:251], v[236:239], v[184:187], a[248:251]
v_accvgpr_read_b32 v203, a231
v_cvt_pk_bf16_f32 v60, v200, v201
v_mfma_f32_16x16x32_bf16 a[252:255], v[232:235], v[100:103], a[252:255]
v_cvt_pk_bf16_f32 v61, v202, v203
v_accvgpr_read_b32 v208, a232
v_mfma_f32_16x16x32_bf16 a[252:255], v[236:239], v[188:191], a[252:255]
s_waitcnt lgkmcnt(4)
v_accvgpr_read_b32 v209, a233
v_mfma_f32_16x16x32_bf16 a[240:243], v[240:243], v[128:131], a[240:243]
v_accvgpr_read_b32 v210, a234
v_accvgpr_read_b32 v211, a235
v_mfma_f32_16x16x32_bf16 a[240:243], v[244:247], v[144:147], a[240:243]
v_cvt_pk_bf16_f32 v92, v208, v209
v_cvt_pk_bf16_f32 v93, v210, v211
v_mfma_f32_16x16x32_bf16 a[244:247], v[240:243], v[132:135], a[244:247]
v_accvgpr_read_b32 v216, a236
v_accvgpr_read_b32 v217, a237
v_mfma_f32_16x16x32_bf16 a[244:247], v[244:247], v[148:151], a[244:247]
v_accvgpr_read_b32 v218, a238
v_accvgpr_read_b32 v219, a239
v_mfma_f32_16x16x32_bf16 a[248:251], v[240:243], v[136:139], a[248:251]
v_cvt_pk_bf16_f32 v124, v216, v217
v_cvt_pk_bf16_f32 v125, v218, v219
v_mfma_f32_16x16x32_bf16 a[248:251], v[244:247], v[152:155], a[248:251]
v_mfma_f32_16x16x32_bf16 a[252:255], v[240:243], v[140:143], a[252:255]
v_mfma_f32_16x16x32_bf16 a[252:255], v[244:247], v[156:159], a[252:255]
s_waitcnt lgkmcnt(0)
v_mfma_f32_16x16x32_bf16 a[240:243], v[224:227], v[160:163], a[240:243]
v_mfma_f32_16x16x32_bf16 a[240:243], v[228:231], v[0:3], a[240:243]
v_mfma_f32_16x16x32_bf16 a[244:247], v[224:227], v[164:167], a[244:247]
v_mfma_f32_16x16x32_bf16 a[244:247], v[228:231], v[32:35], a[244:247]
v_mfma_f32_16x16x32_bf16 a[248:251], v[224:227], v[168:171], a[248:251]
v_mfma_f32_16x16x32_bf16 a[248:251], v[228:231], v[64:67], a[248:251]
v_mfma_f32_16x16x32_bf16 a[252:255], v[224:227], v[172:175], a[252:255]
s_nop 2
v_accvgpr_read_b32 v196, a240
v_accvgpr_read_b32 v197, a241
v_accvgpr_read_b32 v198, a242
v_accvgpr_read_b32 v199, a243
v_mfma_f32_16x16x32_bf16 a[252:255], v[228:231], v[96:99], a[252:255]
v_cvt_pk_bf16_f32 v30, v196, v197
v_cvt_pk_bf16_f32 v31, v198, v199
buffer_store_dwordx4 v[28:31], v252, s[20:23], s44 offen offset:3072 sc1
v_accvgpr_read_b32 v204, a244
v_accvgpr_read_b32 v205, a245
v_accvgpr_read_b32 v206, a246
v_accvgpr_read_b32 v207, a247
v_cvt_pk_bf16_f32 v62, v204, v205
v_cvt_pk_bf16_f32 v63, v206, v207
buffer_store_dwordx4 v[60:63], v252, s[20:23], s45 offen offset:3072 sc1
v_accvgpr_read_b32 v212, a248
v_accvgpr_read_b32 v213, a249
v_accvgpr_read_b32 v214, a250
v_accvgpr_read_b32 v215, a251
v_cvt_pk_bf16_f32 v94, v212, v213
v_cvt_pk_bf16_f32 v95, v214, v215
buffer_store_dwordx4 v[92:95], v252, s[20:23], s46 offen offset:3072 sc1
v_accvgpr_read_b32 v220, a252
v_accvgpr_read_b32 v221, a253
v_accvgpr_read_b32 v222, a254
v_accvgpr_read_b32 v223, a255
v_cvt_pk_bf16_f32 v126, v220, v221
v_cvt_pk_bf16_f32 v127, v222, v223
buffer_store_dwordx4 v[124:127], v252, s[20:23], s47 offen offset:3072 sc1
s_branch L2_chk
L2_tail_1_7:
s_waitcnt lgkmcnt(4)
v_mfma_f32_16x16x32_bf16 a[0:3], v[224:227], v[160:163], a[0:3]
ds_read_b128 v[240:243], v248 offset:2048
v_mfma_f32_16x16x32_bf16 a[0:3], v[228:231], v[176:179], a[0:3]
s_lshl_b32 s36, s34, 13
v_mfma_f32_16x16x32_bf16 a[4:7], v[224:227], v[164:167], a[4:7]
v_mfma_f32_16x16x32_bf16 a[4:7], v[228:231], v[180:183], a[4:7]
s_add_u32 s36, s36, 0x20000
v_mfma_f32_16x16x32_bf16 a[8:11], v[224:227], v[168:171], a[8:11]
ds_read_b128 v[244:247], v248 offset:2560
v_mfma_f32_16x16x32_bf16 a[8:11], v[228:231], v[184:187], a[8:11]
v_add_u32 v255, s36, v252
v_mfma_f32_16x16x32_bf16 a[12:15], v[224:227], v[172:175], a[12:15]
v_exp_f32 v192, v192
v_mfma_f32_16x16x32_bf16 a[12:15], v[228:231], v[188:191], a[12:15]
s_waitcnt lgkmcnt(2)
v_mfma_f32_16x16x32_bf16 a[16:19], v[232:235], v[160:163], a[16:19]
ds_read_b128 v[224:227], v248 offset:6144
ds_write_b128 v255, v[160:163] offset:0
v_mfma_f32_16x16x32_bf16 a[16:19], v[236:239], v[176:179], a[16:19]
v_exp_f32 v193, v193
v_mfma_f32_16x16x32_bf16 a[20:23], v[232:235], v[164:167], a[20:23]
v_exp_f32 v194, v194
v_mfma_f32_16x16x32_bf16 a[20:23], v[236:239], v[180:183], a[20:23]
v_exp_f32 v195, v195
v_mfma_f32_16x16x32_bf16 a[24:27], v[232:235], v[168:171], a[24:27]
ds_read_b128 v[228:231], v248 offset:6656
v_cvt_pk_bf16_f32 v128, v192, v193
v_mfma_f32_16x16x32_bf16 a[24:27], v[236:239], v[184:187], a[24:27]
v_cvt_pk_bf16_f32 v129, v194, v195
ds_write_b128 v255, v[164:167] offset:1024
v_mfma_f32_16x16x32_bf16 a[28:31], v[232:235], v[172:175], a[28:31]
v_exp_f32 v196, v196
v_mfma_f32_16x16x32_bf16 a[28:31], v[236:239], v[188:191], a[28:31]
s_waitcnt lgkmcnt(4)
ds_write_b128 v255, v[168:171] offset:2048
v_mfma_f32_16x16x32_bf16 v[208:211], v[240:243], v[0:3], 0
ds_read_b128 v[232:235], v248 offset:10240
ds_write_b128 v255, v[172:175] offset:3072
v_mfma_f32_16x16x32_bf16 v[208:211], v[244:247], v[4:7], v[208:211]
v_exp_f32 v197, v197
v_mfma_f32_16x16x32_bf16 v[212:215], v[240:243], v[32:35], 0
v_exp_f32 v198, v198
v_mfma_f32_16x16x32_bf16 v[212:215], v[244:247], v[36:39], v[212:215]
v_exp_f32 v199, v199
v_mfma_f32_16x16x32_bf16 v[216:219], v[240:243], v[64:67], 0
ds_read_b128 v[236:239], v248 offset:10752
v_cvt_pk_bf16_f32 v132, v196, v197
v_mfma_f32_16x16x32_bf16 v[216:219], v[244:247], v[68:71], v[216:219]
v_cvt_pk_bf16_f32 v133, v198, v199
ds_write_b128 v255, v[176:179] offset:4096
v_mfma_f32_16x16x32_bf16 v[220:223], v[240:243], v[96:99], 0
v_exp_f32 v200, v200
v_mfma_f32_16x16x32_bf16 v[220:223], v[244:247], v[100:103], v[220:223]
s_waitcnt lgkmcnt(6)
ds_write_b128 v255, v[180:183] offset:5120
v_mfma_f32_16x16x32_bf16 v[208:211], v[224:227], v[8:11], v[208:211]
ds_read_b128 v[240:243], v248 offset:14336
ds_write_b128 v255, v[184:187] offset:6144
v_mfma_f32_16x16x32_bf16 v[208:211], v[228:231], v[12:15], v[208:211]
v_exp_f32 v201, v201
v_mfma_f32_16x16x32_bf16 v[212:215], v[224:227], v[40:43], v[212:215]
v_exp_f32 v202, v202
v_mfma_f32_16x16x32_bf16 v[212:215], v[228:231], v[44:47], v[212:215]
v_exp_f32 v203, v203
v_mfma_f32_16x16x32_bf16 v[216:219], v[224:227], v[72:75], v[216:219]
ds_read_b128 v[244:247], v248 offset:14848
v_cvt_pk_bf16_f32 v136, v200, v201
v_mfma_f32_16x16x32_bf16 v[216:219], v[228:231], v[76:79], v[216:219]
v_cvt_pk_bf16_f32 v137, v202, v203
ds_write_b128 v255, v[188:191] offset:7168
v_mfma_f32_16x16x32_bf16 v[220:223], v[224:227], v[104:107], v[220:223]
v_exp_f32 v204, v204
v_mfma_f32_16x16x32_bf16 v[220:223], v[228:231], v[108:111], v[220:223]
s_waitcnt lgkmcnt(6)
s_waitcnt vmcnt(0)
s_barrier
v_mfma_f32_16x16x32_bf16 v[208:211], v[232:235], v[16:19], v[208:211]
ds_read_b128 v[224:227], v248 offset:16384
s_add_u32 m0, s30, 0xc000
v_mfma_f32_16x16x32_bf16 v[208:211], v[236:239], v[20:23], v[208:211]
v_exp_f32 v205, v205
v_mfma_f32_16x16x32_bf16 v[212:215], v[232:235], v[48:51], v[212:215]
v_exp_f32 v206, v206
v_mfma_f32_16x16x32_bf16 v[212:215], v[236:239], v[52:55], v[212:215]
v_exp_f32 v207, v207
v_mfma_f32_16x16x32_bf16 v[216:219], v[232:235], v[80:83], v[216:219]
ds_read_b128 v[228:231], v248 offset:16896
v_cvt_pk_bf16_f32 v140, v204, v205
v_mfma_f32_16x16x32_bf16 v[216:219], v[236:239], v[84:87], v[216:219]
v_cvt_pk_bf16_f32 v141, v206, v207
buffer_load_dwordx4 v251, s[12:15], s28 offen offset:0 lds
v_mfma_f32_16x16x32_bf16 v[220:223], v[232:235], v[112:115], v[220:223]
v_mfma_f32_16x16x32_bf16 v[220:223], v[236:239], v[116:119], v[220:223]
s_waitcnt lgkmcnt(3)
buffer_load_dwordx4 v251, s[12:15], s28 offen offset:1024 lds
v_mfma_f32_16x16x32_bf16 v[208:211], v[240:243], v[24:27], v[208:211]
ds_read_b128 v[232:235], v248 offset:20480
v_mfma_f32_16x16x32_bf16 v[208:211], v[244:247], v[28:31], v[208:211]
buffer_load_dwordx4 v251, s[12:15], s28 offen offset:2048 lds
v_mfma_f32_16x16x32_bf16 v[212:215], v[240:243], v[56:59], v[212:215]
v_mfma_f32_16x16x32_bf16 v[212:215], v[244:247], v[60:63], v[212:215]
buffer_load_dwordx4 v251, s[12:15], s28 offen offset:3072 lds
v_mfma_f32_16x16x32_bf16 v[216:219], v[240:243], v[88:91], v[216:219]
ds_read_b128 v[236:239], v248 offset:20992
v_mfma_f32_16x16x32_bf16 v[216:219], v[244:247], v[92:95], v[216:219]
s_add_u32 s28, s28, 0x4000
s_xor_b32 s30, s30, 0x10000
v_mfma_f32_16x16x32_bf16 v[220:223], v[240:243], v[120:123], v[220:223]
s_add_u32 m0, s30, 0x0
v_mfma_f32_16x16x32_bf16 v[220:223], v[244:247], v[124:127], v[220:223]
s_waitcnt lgkmcnt(2)
buffer_load_dwordx4 v251, s[12:15], s28 offen offset:0 lds
v_mfma_f32_16x16x32_bf16 v[192:195], v[224:227], v[0:3], 0
ds_read_b128 v[240:243], v248 offset:24576
v_mfma_f32_16x16x32_bf16 v[192:195], v[228:231], v[4:7], v[192:195]
v_exp_f32 v208, v208
v_mfma_f32_16x16x32_bf16 v[196:199], v[224:227], v[32:35], 0
v_exp_f32 v209, v209
v_mfma_f32_16x16x32_bf16 v[196:199], v[228:231], v[36:39], v[196:199]
v_exp_f32 v210, v210
v_mfma_f32_16x16x32_bf16 v[200:203], v[224:227], v[64:67], 0
ds_read_b128 v[244:247], v248 offset:25088
v_cvt_pk_bf16_f32 v130, v208, v209
v_mfma_f32_16x16x32_bf16 v[200:203], v[228:231], v[68:71], v[200:203]
v_exp_f32 v211, v211
v_mfma_f32_16x16x32_bf16 v[204:207], v[224:227], v[96:99], 0
v_exp_f32 v212, v212
v_mfma_f32_16x16x32_bf16 v[204:207], v[228:231], v[100:103], v[204:207]
s_waitcnt lgkmcnt(2)
v_cvt_pk_bf16_f32 v131, v210, v211
v_mfma_f32_16x16x32_bf16 v[192:195], v[232:235], v[8:11], v[192:195]
ds_read_b128 v[224:227], v248 offset:28672
buffer_load_dwordx4 v251, s[12:15], s28 offen offset:1024 lds
v_mfma_f32_16x16x32_bf16 v[192:195], v[236:239], v[12:15], v[192:195]
v_exp_f32 v213, v213
v_mfma_f32_16x16x32_bf16 v[196:199], v[232:235], v[40:43], v[196:199]
v_exp_f32 v214, v214
v_mfma_f32_16x16x32_bf16 v[196:199], v[236:239], v[44:47], v[196:199]
v_exp_f32 v215, v215
v_mfma_f32_16x16x32_bf16 v[200:203], v[232:235], v[72:75], v[200:203]
ds_read_b128 v[228:231], v248 offset:29184
v_cvt_pk_bf16_f32 v134, v212, v213
v_mfma_f32_16x16x32_bf16 v[200:203], v[236:239], v[76:79], v[200:203]
v_cvt_pk_bf16_f32 v135, v214, v215
buffer_load_dwordx4 v251, s[12:15], s28 offen offset:2048 lds
v_mfma_f32_16x16x32_bf16 v[204:207], v[232:235], v[104:107], v[204:207]
v_exp_f32 v216, v216
v_mfma_f32_16x16x32_bf16 v[204:207], v[236:239], v[108:111], v[204:207]
s_waitcnt lgkmcnt(2)
buffer_load_dwordx4 v251, s[12:15], s28 offen offset:3072 lds
v_mfma_f32_16x16x32_bf16 v[192:195], v[240:243], v[16:19], v[192:195]
ds_read_b128 v[232:235], v248 offset:18432
v_mfma_f32_16x16x32_bf16 v[192:195], v[244:247], v[20:23], v[192:195]
v_exp_f32 v217, v217
v_mfma_f32_16x16x32_bf16 v[196:199], v[240:243], v[48:51], v[196:199]
v_exp_f32 v218, v218
v_mfma_f32_16x16x32_bf16 v[196:199], v[244:247], v[52:55], v[196:199]
v_exp_f32 v219, v219
v_mfma_f32_16x16x32_bf16 v[200:203], v[240:243], v[80:83], v[200:203]
ds_read_b128 v[236:239], v248 offset:18944
v_cvt_pk_bf16_f32 v138, v216, v217
v_mfma_f32_16x16x32_bf16 v[200:203], v[244:247], v[84:87], v[200:203]
v_cvt_pk_bf16_f32 v139, v218, v219
s_add_u32 s28, s28, 0x4000
v_mfma_f32_16x16x32_bf16 v[204:207], v[240:243], v[112:115], v[204:207]
v_exp_f32 v220, v220
v_mfma_f32_16x16x32_bf16 v[204:207], v[244:247], v[116:119], v[204:207]
s_waitcnt lgkmcnt(2)
v_mfma_f32_16x16x32_bf16 v[192:195], v[224:227], v[24:27], v[192:195]
ds_read_b128 v[240:243], v248 offset:22528
v_mfma_f32_16x16x32_bf16 v[192:195], v[228:231], v[28:31], v[192:195]
v_exp_f32 v221, v221
v_mfma_f32_16x16x32_bf16 v[196:199], v[224:227], v[56:59], v[196:199]
v_exp_f32 v222, v222
v_mfma_f32_16x16x32_bf16 v[196:199], v[228:231], v[60:63], v[196:199]
v_exp_f32 v223, v223
v_mfma_f32_16x16x32_bf16 v[200:203], v[224:227], v[88:91], v[200:203]
ds_read_b128 v[244:247], v248 offset:23040
v_cvt_pk_bf16_f32 v142, v220, v221
v_mfma_f32_16x16x32_bf16 v[200:203], v[228:231], v[92:95], v[200:203]
v_cvt_pk_bf16_f32 v143, v222, v223
v_mfma_f32_16x16x32_bf16 v[204:207], v[224:227], v[120:123], v[204:207]
v_mfma_f32_16x16x32_bf16 v[204:207], v[228:231], v[124:127], v[204:207]
s_waitcnt lgkmcnt(2)
v_mfma_f32_16x16x32_bf16 v[208:211], v[232:235], v[0:3], 0
ds_read_b128 v[224:227], v248 offset:26624
v_mfma_f32_16x16x32_bf16 v[208:211], v[236:239], v[4:7], v[208:211]
v_exp_f32 v192, v192
v_mfma_f32_16x16x32_bf16 v[212:215], v[232:235], v[32:35], 0
v_exp_f32 v193, v193
v_mfma_f32_16x16x32_bf16 v[212:215], v[236:239], v[36:39], v[212:215]
v_exp_f32 v194, v194
v_mfma_f32_16x16x32_bf16 v[216:219], v[232:235], v[64:67], 0
ds_read_b128 v[228:231], v248 offset:27136
v_cvt_pk_bf16_f32 v144, v192, v193
v_mfma_f32_16x16x32_bf16 v[216:219], v[236:239], v[68:71], v[216:219]
v_exp_f32 v195, v195
v_mfma_f32_16x16x32_bf16 v[220:223], v[232:235], v[96:99], 0
v_exp_f32 v196, v196
v_mfma_f32_16x16x32_bf16 v[220:223], v[236:239], v[100:103], v[220:223]
s_waitcnt lgkmcnt(2)
v_cvt_pk_bf16_f32 v145, v194, v195
v_mfma_f32_16x16x32_bf16 v[208:211], v[240:243], v[8:11], v[208:211]
ds_read_b128 v[232:235], v248 offset:30720
v_mfma_f32_16x16x32_bf16 v[208:211], v[244:247], v[12:15], v[208:211]
v_exp_f32 v197, v197
v_mfma_f32_16x16x32_bf16 v[212:215], v[240:243], v[40:43], v[212:215]
v_exp_f32 v198, v198
v_mfma_f32_16x16x32_bf16 v[212:215], v[244:247], v[44:47], v[212:215]
v_exp_f32 v199, v199
v_mfma_f32_16x16x32_bf16 v[216:219], v[240:243], v[72:75], v[216:219]
ds_read_b128 v[236:239], v248 offset:31232
v_cvt_pk_bf16_f32 v148, v196, v197
v_mfma_f32_16x16x32_bf16 v[216:219], v[244:247], v[76:79], v[216:219]
v_cvt_pk_bf16_f32 v149, v198, v199
v_mfma_f32_16x16x32_bf16 v[220:223], v[240:243], v[104:107], v[220:223]
v_exp_f32 v200, v200
v_mfma_f32_16x16x32_bf16 v[220:223], v[244:247], v[108:111], v[220:223]
s_waitcnt lgkmcnt(2)
v_mfma_f32_16x16x32_bf16 v[208:211], v[224:227], v[16:19], v[208:211]
ds_read_b128 v[240:243], v248 offset:32768
v_mfma_f32_16x16x32_bf16 v[208:211], v[228:231], v[20:23], v[208:211]
v_exp_f32 v201, v201
v_mfma_f32_16x16x32_bf16 v[212:215], v[224:227], v[48:51], v[212:215]
v_exp_f32 v202, v202
v_mfma_f32_16x16x32_bf16 v[212:215], v[228:231], v[52:55], v[212:215]
v_exp_f32 v203, v203
v_mfma_f32_16x16x32_bf16 v[216:219], v[224:227], v[80:83], v[216:219]
ds_read_b128 v[244:247], v248 offset:33280
v_cvt_pk_bf16_f32 v152, v200, v201
v_mfma_f32_16x16x32_bf16 v[216:219], v[228:231], v[84:87], v[216:219]
v_cvt_pk_bf16_f32 v153, v202, v203
v_mfma_f32_16x16x32_bf16 v[220:223], v[224:227], v[112:115], v[220:223]
v_exp_f32 v204, v204
v_mfma_f32_16x16x32_bf16 v[220:223], v[228:231], v[116:119], v[220:223]
s_waitcnt lgkmcnt(2)
v_mfma_f32_16x16x32_bf16 v[208:211], v[232:235], v[24:27], v[208:211]
ds_read_b128 v[224:227], v248 offset:36864
v_mfma_f32_16x16x32_bf16 v[208:211], v[236:239], v[28:31], v[208:211]
v_exp_f32 v205, v205
v_mfma_f32_16x16x32_bf16 v[212:215], v[232:235], v[56:59], v[212:215]
v_exp_f32 v206, v206
v_mfma_f32_16x16x32_bf16 v[212:215], v[236:239], v[60:63], v[212:215]
v_exp_f32 v207, v207
v_mfma_f32_16x16x32_bf16 v[216:219], v[232:235], v[88:91], v[216:219]
ds_read_b128 v[228:231], v248 offset:37376
v_cvt_pk_bf16_f32 v156, v204, v205
v_mfma_f32_16x16x32_bf16 v[216:219], v[236:239], v[92:95], v[216:219]
v_cvt_pk_bf16_f32 v157, v206, v207
v_mfma_f32_16x16x32_bf16 v[220:223], v[232:235], v[120:123], v[220:223]
v_mfma_f32_16x16x32_bf16 v[220:223], v[236:239], v[124:127], v[220:223]
s_waitcnt lgkmcnt(2)
v_mfma_f32_16x16x32_bf16 v[192:195], v[240:243], v[0:3], 0
ds_read_b128 v[232:235], v248 offset:40960
v_mfma_f32_16x16x32_bf16 v[192:195], v[244:247], v[4:7], v[192:195]
v_exp_f32 v208, v208
v_mfma_f32_16x16x32_bf16 v[196:199], v[240:243], v[32:35], 0
v_exp_f32 v209, v209
v_mfma_f32_16x16x32_bf16 v[196:199], v[244:247], v[36:39], v[196:199]
v_exp_f32 v210, v210
v_mfma_f32_16x16x32_bf16 v[200:203], v[240:243], v[64:67], 0
ds_read_b128 v[236:239], v248 offset:41472
v_cvt_pk_bf16_f32 v146, v208, v209
v_mfma_f32_16x16x32_bf16 v[200:203], v[244:247], v[68:71], v[200:203]
v_exp_f32 v211, v211
v_mfma_f32_16x16x32_bf16 v[204:207], v[240:243], v[96:99], 0
v_exp_f32 v212, v212
v_mfma_f32_16x16x32_bf16 v[204:207], v[244:247], v[100:103], v[204:207]
s_waitcnt lgkmcnt(2)
v_cvt_pk_bf16_f32 v147, v210, v211
v_mfma_f32_16x16x32_bf16 v[192:195], v[224:227], v[8:11], v[192:195]
ds_read_b128 v[240:243], v248 offset:45056
v_mfma_f32_16x16x32_bf16 v[192:195], v[228:231], v[12:15], v[192:195]
v_exp_f32 v213, v213
v_mfma_f32_16x16x32_bf16 v[196:199], v[224:227], v[40:43], v[196:199]
v_exp_f32 v214, v214
v_mfma_f32_16x16x32_bf16 v[196:199], v[228:231], v[44:47], v[196:199]
v_exp_f32 v215, v215
v_mfma_f32_16x16x32_bf16 v[200:203], v[224:227], v[72:75], v[200:203]
ds_read_b128 v[244:247], v248 offset:45568
v_cvt_pk_bf16_f32 v150, v212, v213
v_mfma_f32_16x16x32_bf16 v[200:203], v[228:231], v[76:79], v[200:203]
v_cvt_pk_bf16_f32 v151, v214, v215
v_mfma_f32_16x16x32_bf16 v[204:207], v[224:227], v[104:107], v[204:207]
v_exp_f32 v216, v216
v_mfma_f32_16x16x32_bf16 v[204:207], v[228:231], v[108:111], v[204:207]
s_waitcnt lgkmcnt(2)
v_mfma_f32_16x16x32_bf16 v[192:195], v[232:235], v[16:19], v[192:195]
ds_read_b128 v[224:227], v248 offset:34816
v_mfma_f32_16x16x32_bf16 v[192:195], v[236:239], v[20:23], v[192:195]
v_exp_f32 v217, v217
v_mfma_f32_16x16x32_bf16 v[196:199], v[232:235], v[48:51], v[196:199]
v_exp_f32 v218, v218
v_mfma_f32_16x16x32_bf16 v[196:199], v[236:239], v[52:55], v[196:199]
v_exp_f32 v219, v219
v_mfma_f32_16x16x32_bf16 v[200:203], v[232:235], v[80:83], v[200:203]
ds_read_b128 v[228:231], v248 offset:35328
v_cvt_pk_bf16_f32 v154, v216, v217
v_mfma_f32_16x16x32_bf16 v[200:203], v[236:239], v[84:87], v[200:203]
v_cvt_pk_bf16_f32 v155, v218, v219
v_mfma_f32_16x16x32_bf16 v[204:207], v[232:235], v[112:115], v[204:207]
v_exp_f32 v220, v220
v_mfma_f32_16x16x32_bf16 v[204:207], v[236:239], v[116:119], v[204:207]
s_waitcnt lgkmcnt(2)
v_mfma_f32_16x16x32_bf16 v[192:195], v[240:243], v[24:27], v[192:195]
ds_read_b128 v[232:235], v248 offset:38912
v_mfma_f32_16x16x32_bf16 v[192:195], v[244:247], v[28:31], v[192:195]
v_exp_f32 v221, v221
v_mfma_f32_16x16x32_bf16 v[196:199], v[240:243], v[56:59], v[196:199]
v_exp_f32 v222, v222
v_mfma_f32_16x16x32_bf16 v[196:199], v[244:247], v[60:63], v[196:199]
v_exp_f32 v223, v223
v_mfma_f32_16x16x32_bf16 v[200:203], v[240:243], v[88:91], v[200:203]
ds_read_b128 v[236:239], v248 offset:39424
v_cvt_pk_bf16_f32 v158, v220, v221
v_mfma_f32_16x16x32_bf16 v[200:203], v[244:247], v[92:95], v[200:203]
v_cvt_pk_bf16_f32 v159, v222, v223
v_mfma_f32_16x16x32_bf16 v[204:207], v[240:243], v[120:123], v[204:207]
v_mfma_f32_16x16x32_bf16 v[204:207], v[244:247], v[124:127], v[204:207]
s_waitcnt lgkmcnt(2)
v_mfma_f32_16x16x32_bf16 v[208:211], v[224:227], v[0:3], 0
ds_read_b128 v[240:243], v248 offset:43008
v_mfma_f32_16x16x32_bf16 v[208:211], v[228:231], v[4:7], v[208:211]
v_exp_f32 v192, v192
v_mfma_f32_16x16x32_bf16 v[212:215], v[224:227], v[32:35], 0
v_exp_f32 v193, v193
v_mfma_f32_16x16x32_bf16 v[212:215], v[228:231], v[36:39], v[212:215]
v_exp_f32 v194, v194
v_mfma_f32_16x16x32_bf16 v[216:219], v[224:227], v[64:67], 0
ds_read_b128 v[244:247], v248 offset:43520
v_cvt_pk_bf16_f32 v160, v192, v193
v_mfma_f32_16x16x32_bf16 v[216:219], v[228:231], v[68:71], v[216:219]
v_exp_f32 v195, v195
v_mfma_f32_16x16x32_bf16 v[220:223], v[224:227], v[96:99], 0
v_exp_f32 v196, v196
v_mfma_f32_16x16x32_bf16 v[220:223], v[228:231], v[100:103], v[220:223]
s_waitcnt lgkmcnt(2)
v_cvt_pk_bf16_f32 v161, v194, v195
v_mfma_f32_16x16x32_bf16 v[208:211], v[232:235], v[8:11], v[208:211]
ds_read_b128 v[224:227], v248 offset:47104
v_mfma_f32_16x16x32_bf16 v[208:211], v[236:239], v[12:15], v[208:211]
v_exp_f32 v197, v197
v_mfma_f32_16x16x32_bf16 v[212:215], v[232:235], v[40:43], v[212:215]
v_exp_f32 v198, v198
v_mfma_f32_16x16x32_bf16 v[212:215], v[236:239], v[44:47], v[212:215]
v_exp_f32 v199, v199
v_mfma_f32_16x16x32_bf16 v[216:219], v[232:235], v[72:75], v[216:219]
ds_read_b128 v[228:231], v248 offset:47616
v_cvt_pk_bf16_f32 v164, v196, v197
v_mfma_f32_16x16x32_bf16 v[216:219], v[236:239], v[76:79], v[216:219]
v_cvt_pk_bf16_f32 v165, v198, v199
v_mfma_f32_16x16x32_bf16 v[220:223], v[232:235], v[104:107], v[220:223]
v_exp_f32 v200, v200
v_mfma_f32_16x16x32_bf16 v[220:223], v[236:239], v[108:111], v[220:223]
s_waitcnt lgkmcnt(2)
s_waitcnt vmcnt(0)
s_barrier
v_mfma_f32_16x16x32_bf16 v[208:211], v[240:243], v[16:19], v[208:211]
ds_read_b128 v[232:235], v248 offset:49152
v_mfma_f32_16x16x32_bf16 v[208:211], v[244:247], v[20:23], v[208:211]
v_exp_f32 v201, v201
v_mfma_f32_16x16x32_bf16 v[212:215], v[240:243], v[48:51], v[212:215]
v_exp_f32 v202, v202
v_mfma_f32_16x16x32_bf16 v[212:215], v[244:247], v[52:55], v[212:215]
v_exp_f32 v203, v203
v_mfma_f32_16x16x32_bf16 v[216:219], v[240:243], v[80:83], v[216:219]
ds_read_b128 v[236:239], v248 offset:49664
v_cvt_pk_bf16_f32 v168, v200, v201
v_mfma_f32_16x16x32_bf16 v[216:219], v[244:247], v[84:87], v[216:219]
v_cvt_pk_bf16_f32 v169, v202, v203
v_mfma_f32_16x16x32_bf16 v[220:223], v[240:243], v[112:115], v[220:223]
v_exp_f32 v204, v204
v_mfma_f32_16x16x32_bf16 v[220:223], v[244:247], v[116:119], v[220:223]
s_waitcnt lgkmcnt(2)
v_mfma_f32_16x16x32_bf16 v[208:211], v[224:227], v[24:27], v[208:211]
ds_read_b128 v[240:243], v248 offset:53248
v_mfma_f32_16x16x32_bf16 v[208:211], v[228:231], v[28:31], v[208:211]
v_exp_f32 v205, v205
v_mfma_f32_16x16x32_bf16 v[212:215], v[224:227], v[56:59], v[212:215]
v_exp_f32 v206, v206
v_mfma_f32_16x16x32_bf16 v[212:215], v[228:231], v[60:63], v[212:215]
v_exp_f32 v207, v207
v_mfma_f32_16x16x32_bf16 v[216:219], v[224:227], v[88:91], v[216:219]
ds_read_b128 v[244:247], v248 offset:53760
v_cvt_pk_bf16_f32 v172, v204, v205
v_mfma_f32_16x16x32_bf16 v[216:219], v[228:231], v[92:95], v[216:219]
v_cvt_pk_bf16_f32 v173, v206, v207
v_mfma_f32_16x16x32_bf16 v[220:223], v[224:227], v[120:123], v[220:223]
v_mfma_f32_16x16x32_bf16 v[220:223], v[228:231], v[124:127], v[220:223]
s_waitcnt lgkmcnt(2)
v_mfma_f32_16x16x32_bf16 v[192:195], v[232:235], v[0:3], 0
ds_read_b128 v[224:227], v248 offset:57344
v_mfma_f32_16x16x32_bf16 v[192:195], v[236:239], v[4:7], v[192:195]
v_exp_f32 v208, v208
v_mfma_f32_16x16x32_bf16 v[196:199], v[232:235], v[32:35], 0
v_exp_f32 v209, v209
v_mfma_f32_16x16x32_bf16 v[196:199], v[236:239], v[36:39], v[196:199]
v_exp_f32 v210, v210
v_mfma_f32_16x16x32_bf16 v[200:203], v[232:235], v[64:67], 0
ds_read_b128 v[228:231], v248 offset:57856
v_cvt_pk_bf16_f32 v162, v208, v209
v_mfma_f32_16x16x32_bf16 v[200:203], v[236:239], v[68:71], v[200:203]
v_exp_f32 v211, v211
v_mfma_f32_16x16x32_bf16 v[204:207], v[232:235], v[96:99], 0
v_exp_f32 v212, v212
v_mfma_f32_16x16x32_bf16 v[204:207], v[236:239], v[100:103], v[204:207]
s_waitcnt lgkmcnt(2)
v_cvt_pk_bf16_f32 v163, v210, v211
v_mfma_f32_16x16x32_bf16 v[192:195], v[240:243], v[8:11], v[192:195]
ds_read_b128 v[232:235], v248 offset:61440
v_mfma_f32_16x16x32_bf16 v[192:195], v[244:247], v[12:15], v[192:195]
v_exp_f32 v213, v213
v_mfma_f32_16x16x32_bf16 v[196:199], v[240:243], v[40:43], v[196:199]
v_exp_f32 v214, v214
v_mfma_f32_16x16x32_bf16 v[196:199], v[244:247], v[44:47], v[196:199]
v_exp_f32 v215, v215
v_mfma_f32_16x16x32_bf16 v[200:203], v[240:243], v[72:75], v[200:203]
ds_read_b128 v[236:239], v248 offset:61952
v_cvt_pk_bf16_f32 v166, v212, v213
v_mfma_f32_16x16x32_bf16 v[200:203], v[244:247], v[76:79], v[200:203]
v_cvt_pk_bf16_f32 v167, v214, v215
v_mfma_f32_16x16x32_bf16 v[204:207], v[240:243], v[104:107], v[204:207]
v_exp_f32 v216, v216
v_mfma_f32_16x16x32_bf16 v[204:207], v[244:247], v[108:111], v[204:207]
s_waitcnt lgkmcnt(2)
v_mfma_f32_16x16x32_bf16 v[192:195], v[224:227], v[16:19], v[192:195]
ds_read_b128 v[240:243], v248 offset:51200
v_mfma_f32_16x16x32_bf16 v[192:195], v[228:231], v[20:23], v[192:195]
v_exp_f32 v217, v217
v_mfma_f32_16x16x32_bf16 v[196:199], v[224:227], v[48:51], v[196:199]
v_exp_f32 v218, v218
v_mfma_f32_16x16x32_bf16 v[196:199], v[228:231], v[52:55], v[196:199]
v_exp_f32 v219, v219
v_mfma_f32_16x16x32_bf16 v[200:203], v[224:227], v[80:83], v[200:203]
ds_read_b128 v[244:247], v248 offset:51712
v_cvt_pk_bf16_f32 v170, v216, v217
v_mfma_f32_16x16x32_bf16 v[200:203], v[228:231], v[84:87], v[200:203]
v_cvt_pk_bf16_f32 v171, v218, v219
v_mfma_f32_16x16x32_bf16 v[204:207], v[224:227], v[112:115], v[204:207]
v_exp_f32 v220, v220
v_mfma_f32_16x16x32_bf16 v[204:207], v[228:231], v[116:119], v[204:207]
s_waitcnt lgkmcnt(2)
v_mfma_f32_16x16x32_bf16 v[192:195], v[232:235], v[24:27], v[192:195]
ds_read_b128 v[224:227], v248 offset:55296
v_mfma_f32_16x16x32_bf16 v[192:195], v[236:239], v[28:31], v[192:195]
v_exp_f32 v221, v221
v_mfma_f32_16x16x32_bf16 v[196:199], v[232:235], v[56:59], v[196:199]
v_exp_f32 v222, v222
v_mfma_f32_16x16x32_bf16 v[196:199], v[236:239], v[60:63], v[196:199]
v_exp_f32 v223, v223
v_mfma_f32_16x16x32_bf16 v[200:203], v[232:235], v[88:91], v[200:203]
ds_read_b128 v[228:231], v248 offset:55808
v_cvt_pk_bf16_f32 v174, v220, v221
v_mfma_f32_16x16x32_bf16 v[200:203], v[236:239], v[92:95], v[200:203]
v_cvt_pk_bf16_f32 v175, v222, v223
v_mfma_f32_16x16x32_bf16 v[204:207], v[232:235], v[120:123], v[204:207]
v_mfma_f32_16x16x32_bf16 v[204:207], v[236:239], v[124:127], v[204:207]
s_waitcnt lgkmcnt(2)
v_mfma_f32_16x16x32_bf16 v[208:211], v[240:243], v[0:3], 0
ds_read_b128 v[232:235], v248 offset:59392
v_mfma_f32_16x16x32_bf16 v[208:211], v[244:247], v[4:7], v[208:211]
v_exp_f32 v192, v192
v_mfma_f32_16x16x32_bf16 v[212:215], v[240:243], v[32:35], 0
v_exp_f32 v193, v193
v_mfma_f32_16x16x32_bf16 v[212:215], v[244:247], v[36:39], v[212:215]
v_exp_f32 v194, v194
v_mfma_f32_16x16x32_bf16 v[216:219], v[240:243], v[64:67], 0
ds_read_b128 v[236:239], v248 offset:59904
v_cvt_pk_bf16_f32 v176, v192, v193
v_mfma_f32_16x16x32_bf16 v[216:219], v[244:247], v[68:71], v[216:219]
v_exp_f32 v195, v195
v_mfma_f32_16x16x32_bf16 v[220:223], v[240:243], v[96:99], 0
v_exp_f32 v196, v196
v_mfma_f32_16x16x32_bf16 v[220:223], v[244:247], v[100:103], v[220:223]
s_waitcnt lgkmcnt(2)
v_cvt_pk_bf16_f32 v177, v194, v195
v_mfma_f32_16x16x32_bf16 v[208:211], v[224:227], v[8:11], v[208:211]
ds_read_b128 v[240:243], v248 offset:63488
v_mfma_f32_16x16x32_bf16 v[208:211], v[228:231], v[12:15], v[208:211]
v_exp_f32 v197, v197
v_mfma_f32_16x16x32_bf16 v[212:215], v[224:227], v[40:43], v[212:215]
v_exp_f32 v198, v198
v_mfma_f32_16x16x32_bf16 v[212:215], v[228:231], v[44:47], v[212:215]
v_exp_f32 v199, v199
v_mfma_f32_16x16x32_bf16 v[216:219], v[224:227], v[72:75], v[216:219]
ds_read_b128 v[244:247], v248 offset:64000
v_cvt_pk_bf16_f32 v180, v196, v197
v_mfma_f32_16x16x32_bf16 v[216:219], v[228:231], v[76:79], v[216:219]
v_cvt_pk_bf16_f32 v181, v198, v199
v_mfma_f32_16x16x32_bf16 v[220:223], v[224:227], v[104:107], v[220:223]
v_exp_f32 v200, v200
v_mfma_f32_16x16x32_bf16 v[220:223], v[228:231], v[108:111], v[220:223]
s_waitcnt lgkmcnt(2)
v_xor_b32 v248, 0x10000, v248
v_mfma_f32_16x16x32_bf16 v[208:211], v[232:235], v[16:19], v[208:211]
ds_read_b128 v[224:227], v248 offset:0
v_mfma_f32_16x16x32_bf16 v[208:211], v[236:239], v[20:23], v[208:211]
v_exp_f32 v201, v201
v_mfma_f32_16x16x32_bf16 v[212:215], v[232:235], v[48:51], v[212:215]
v_exp_f32 v202, v202
v_mfma_f32_16x16x32_bf16 v[212:215], v[236:239], v[52:55], v[212:215]
v_exp_f32 v203, v203
v_mfma_f32_16x16x32_bf16 v[216:219], v[232:235], v[80:83], v[216:219]
ds_read_b128 v[228:231], v248 offset:512
v_cvt_pk_bf16_f32 v184, v200, v201
v_mfma_f32_16x16x32_bf16 v[216:219], v[236:239], v[84:87], v[216:219]
v_cvt_pk_bf16_f32 v185, v202, v203
v_mfma_f32_16x16x32_bf16 v[220:223], v[232:235], v[112:115], v[220:223]
v_exp_f32 v204, v204
v_mfma_f32_16x16x32_bf16 v[220:223], v[236:239], v[116:119], v[220:223]
s_waitcnt lgkmcnt(2)
v_mfma_f32_16x16x32_bf16 v[208:211], v[240:243], v[24:27], v[208:211]
ds_read_b128 v[232:235], v248 offset:4096
v_mfma_f32_16x16x32_bf16 v[208:211], v[244:247], v[28:31], v[208:211]
v_exp_f32 v205, v205
v_mfma_f32_16x16x32_bf16 v[212:215], v[240:243], v[56:59], v[212:215]
v_exp_f32 v206, v206
v_mfma_f32_16x16x32_bf16 v[212:215], v[244:247], v[60:63], v[212:215]
v_exp_f32 v207, v207
v_mfma_f32_16x16x32_bf16 v[216:219], v[240:243], v[88:91], v[216:219]
ds_read_b128 v[236:239], v248 offset:4608
v_cvt_pk_bf16_f32 v188, v204, v205
v_mfma_f32_16x16x32_bf16 v[216:219], v[244:247], v[92:95], v[216:219]
v_cvt_pk_bf16_f32 v189, v206, v207
v_mfma_f32_16x16x32_bf16 v[220:223], v[240:243], v[120:123], v[220:223]
v_mfma_f32_16x16x32_bf16 v[220:223], v[244:247], v[124:127], v[220:223]
s_waitcnt lgkmcnt(2)
v_mfma_f32_16x16x32_bf16 v[192:195], v[224:227], v[0:3], 0
ds_read_b128 v[240:243], v248 offset:8192
v_mfma_f32_16x16x32_bf16 v[192:195], v[228:231], v[4:7], v[192:195]
v_exp_f32 v208, v208
v_mfma_f32_16x16x32_bf16 v[196:199], v[224:227], v[32:35], 0
v_exp_f32 v209, v209
v_mfma_f32_16x16x32_bf16 v[196:199], v[228:231], v[36:39], v[196:199]
v_exp_f32 v210, v210
v_mfma_f32_16x16x32_bf16 v[200:203], v[224:227], v[64:67], 0
ds_read_b128 v[244:247], v248 offset:8704
v_cvt_pk_bf16_f32 v178, v208, v209
v_mfma_f32_16x16x32_bf16 v[200:203], v[228:231], v[68:71], v[200:203]
v_exp_f32 v211, v211
v_mfma_f32_16x16x32_bf16 v[204:207], v[224:227], v[96:99], 0
v_exp_f32 v212, v212
v_mfma_f32_16x16x32_bf16 v[204:207], v[228:231], v[100:103], v[204:207]
s_waitcnt lgkmcnt(2)
v_cvt_pk_bf16_f32 v179, v210, v211
v_mfma_f32_16x16x32_bf16 v[192:195], v[232:235], v[8:11], v[192:195]
ds_read_b128 v[224:227], v248 offset:12288
v_mfma_f32_16x16x32_bf16 v[192:195], v[236:239], v[12:15], v[192:195]
v_exp_f32 v213, v213
v_mfma_f32_16x16x32_bf16 v[196:199], v[232:235], v[40:43], v[196:199]
v_exp_f32 v214, v214
v_mfma_f32_16x16x32_bf16 v[196:199], v[236:239], v[44:47], v[196:199]
v_exp_f32 v215, v215
v_mfma_f32_16x16x32_bf16 v[200:203], v[232:235], v[72:75], v[200:203]
ds_read_b128 v[228:231], v248 offset:12800
v_cvt_pk_bf16_f32 v182, v212, v213
v_mfma_f32_16x16x32_bf16 v[200:203], v[236:239], v[76:79], v[200:203]
v_cvt_pk_bf16_f32 v183, v214, v215
v_mfma_f32_16x16x32_bf16 v[204:207], v[232:235], v[104:107], v[204:207]
v_exp_f32 v216, v216
v_mfma_f32_16x16x32_bf16 v[204:207], v[236:239], v[108:111], v[204:207]
s_waitcnt lgkmcnt(2)
v_mfma_f32_16x16x32_bf16 v[192:195], v[240:243], v[16:19], v[192:195]
ds_read_b128 v[232:235], v248 offset:2048
v_mfma_f32_16x16x32_bf16 v[192:195], v[244:247], v[20:23], v[192:195]
v_exp_f32 v217, v217
v_mfma_f32_16x16x32_bf16 v[196:199], v[240:243], v[48:51], v[196:199]
v_exp_f32 v218, v218
v_mfma_f32_16x16x32_bf16 v[196:199], v[244:247], v[52:55], v[196:199]
v_exp_f32 v219, v219
v_mfma_f32_16x16x32_bf16 v[200:203], v[240:243], v[80:83], v[200:203]
ds_read_b128 v[236:239], v248 offset:2560
v_cvt_pk_bf16_f32 v186, v216, v217
v_mfma_f32_16x16x32_bf16 v[200:203], v[244:247], v[84:87], v[200:203]
v_cvt_pk_bf16_f32 v187, v218, v219
v_mfma_f32_16x16x32_bf16 v[204:207], v[240:243], v[112:115], v[204:207]
v_exp_f32 v220, v220
v_mfma_f32_16x16x32_bf16 v[204:207], v[244:247], v[116:119], v[204:207]
s_waitcnt lgkmcnt(2)
v_mfma_f32_16x16x32_bf16 v[192:195], v[224:227], v[24:27], v[192:195]
ds_read_b128 v[240:243], v248 offset:6144
v_mfma_f32_16x16x32_bf16 v[192:195], v[228:231], v[28:31], v[192:195]
v_exp_f32 v221, v221
v_mfma_f32_16x16x32_bf16 v[196:199], v[224:227], v[56:59], v[196:199]
v_exp_f32 v222, v222
v_mfma_f32_16x16x32_bf16 v[196:199], v[228:231], v[60:63], v[196:199]
v_exp_f32 v223, v223
v_mfma_f32_16x16x32_bf16 v[200:203], v[224:227], v[88:91], v[200:203]
ds_read_b128 v[244:247], v248 offset:6656
v_cvt_pk_bf16_f32 v190, v220, v221
v_mfma_f32_16x16x32_bf16 v[200:203], v[228:231], v[92:95], v[200:203]
v_cvt_pk_bf16_f32 v191, v222, v223
v_mfma_f32_16x16x32_bf16 v[204:207], v[224:227], v[120:123], v[204:207]
v_mfma_f32_16x16x32_bf16 v[204:207], v[228:231], v[124:127], v[204:207]
s_waitcnt lgkmcnt(2)
v_mfma_f32_16x16x32_bf16 v[208:211], v[232:235], v[0:3], 0
ds_read_b128 v[224:227], v248 offset:10240
v_mfma_f32_16x16x32_bf16 v[208:211], v[236:239], v[4:7], v[208:211]
v_exp_f32 v192, v192
v_mfma_f32_16x16x32_bf16 v[212:215], v[232:235], v[32:35], 0
v_exp_f32 v193, v193
v_mfma_f32_16x16x32_bf16 v[212:215], v[236:239], v[36:39], v[212:215]
v_exp_f32 v194, v194
v_mfma_f32_16x16x32_bf16 v[216:219], v[232:235], v[64:67], 0
ds_read_b128 v[228:231], v248 offset:10752
v_cvt_pk_bf16_f32 v0, v192, v193
v_mfma_f32_16x16x32_bf16 v[216:219], v[236:239], v[68:71], v[216:219]
v_exp_f32 v195, v195
v_mfma_f32_16x16x32_bf16 v[220:223], v[232:235], v[96:99], 0
v_exp_f32 v196, v196
v_mfma_f32_16x16x32_bf16 v[220:223], v[236:239], v[100:103], v[220:223]
s_waitcnt lgkmcnt(2)
v_cvt_pk_bf16_f32 v1, v194, v195
v_mfma_f32_16x16x32_bf16 v[208:211], v[240:243], v[8:11], v[208:211]
ds_read_b128 v[232:235], v248 offset:14336
v_mfma_f32_16x16x32_bf16 v[208:211], v[244:247], v[12:15], v[208:211]
v_exp_f32 v197, v197
v_mfma_f32_16x16x32_bf16 v[212:215], v[240:243], v[40:43], v[212:215]
ds_read_b128 v[4:7], v255 offset:0
ds_read_b128 v[36:39], v255 offset:1024
v_mfma_f32_16x16x32_bf16 v[212:215], v[244:247], v[44:47], v[212:215]
v_exp_f32 v198, v198
v_mfma_f32_16x16x32_bf16 v[216:219], v[240:243], v[72:75], v[216:219]
ds_read_b128 v[236:239], v248 offset:14848
v_xor_b32 v12, 0x10000, v249
v_mfma_f32_16x16x32_bf16 v[216:219], v[244:247], v[76:79], v[216:219]
v_xor_b32 v13, 0x10000, v250
v_cvt_pk_bf16_f32 v32, v196, v197
v_mfma_f32_16x16x32_bf16 v[220:223], v[240:243], v[104:107], v[220:223]
ds_read_b128 v[68:71], v255 offset:2048
ds_read_b128 v[100:103], v255 offset:3072
v_mfma_f32_16x16x32_bf16 v[220:223], v[244:247], v[108:111], v[220:223]
s_waitcnt lgkmcnt(6)
v_mfma_f32_16x16x32_bf16 v[208:211], v[224:227], v[16:19], v[208:211]
ds_read_b64_tr_b16 v[240:241], v12 offset:0
ds_read_b64_tr_b16 v[242:243], v12 offset:2048
v_mfma_f32_16x16x32_bf16 v[208:211], v[228:231], v[20:23], v[208:211]
v_exp_f32 v199, v199
v_mfma_f32_16x16x32_bf16 v[212:215], v[224:227], v[48:51], v[212:215]
ds_read_b128 v[8:11], v255 offset:4096
ds_read_b128 v[40:43], v255 offset:5120
v_mfma_f32_16x16x32_bf16 v[212:215], v[228:231], v[52:55], v[212:215]
v_cvt_pk_bf16_f32 v33, v198, v199
v_mfma_f32_16x16x32_bf16 v[216:219], v[224:227], v[80:83], v[216:219]
ds_read_b64_tr_b16 v[244:245], v12 offset:16384
ds_read_b64_tr_b16 v[246:247], v12 offset:18432
v_mfma_f32_16x16x32_bf16 v[216:219], v[228:231], v[84:87], v[216:219]
v_exp_f32 v200, v200
v_mfma_f32_16x16x32_bf16 v[220:223], v[224:227], v[112:115], v[220:223]
ds_read_b128 v[72:75], v255 offset:6144
ds_read_b128 v[104:107], v255 offset:7168
v_mfma_f32_16x16x32_bf16 v[220:223], v[228:231], v[116:119], v[220:223]
s_waitcnt lgkmcnt(10)
v_mfma_f32_16x16x32_bf16 v[208:211], v[232:235], v[24:27], v[208:211]
ds_read_b64_tr_b16 v[224:225], v12 offset:32768
ds_read_b64_tr_b16 v[226:227], v12 offset:34816
v_mfma_f32_16x16x32_bf16 v[208:211], v[236:239], v[28:31], v[208:211]
v_exp_f32 v201, v201
v_mfma_f32_16x16x32_bf16 v[212:215], v[232:235], v[56:59], v[212:215]
v_exp_f32 v202, v202
v_mfma_f32_16x16x32_bf16 v[212:215], v[236:239], v[60:63], v[212:215]
v_exp_f32 v203, v203
v_mfma_f32_16x16x32_bf16 v[216:219], v[232:235], v[88:91], v[216:219]
ds_read_b64_tr_b16 v[228:229], v12 offset:49152
ds_read_b64_tr_b16 v[230:231], v12 offset:51200
v_mfma_f32_16x16x32_bf16 v[216:219], v[236:239], v[92:95], v[216:219]
v_cvt_pk_bf16_f32 v64, v200, v201
v_cvt_pk_bf16_f32 v65, v202, v203
v_mfma_f32_16x16x32_bf16 v[220:223], v[232:235], v[120:123], v[220:223]
v_exp_f32 v204, v204
v_mfma_f32_16x16x32_bf16 v[220:223], v[236:239], v[124:127], v[220:223]
s_waitcnt lgkmcnt(6)
s_waitcnt lgkmcnt(4)
v_mfma_f32_16x16x32_bf16 a[0:3], v[240:243], v[128:131], a[0:3]
ds_read_b64_tr_b16 v[232:233], v13 offset:0
ds_read_b64_tr_b16 v[234:235], v13 offset:2048
v_mfma_f32_16x16x32_bf16 a[0:3], v[244:247], v[144:147], a[0:3]
v_exp_f32 v205, v205
v_mfma_f32_16x16x32_bf16 a[4:7], v[240:243], v[132:135], a[4:7]
v_exp_f32 v206, v206
v_mfma_f32_16x16x32_bf16 a[4:7], v[244:247], v[148:151], a[4:7]
v_exp_f32 v207, v207
v_mfma_f32_16x16x32_bf16 a[8:11], v[240:243], v[136:139], a[8:11]
ds_read_b64_tr_b16 v[236:237], v13 offset:16384
ds_read_b64_tr_b16 v[238:239], v13 offset:18432
v_mfma_f32_16x16x32_bf16 a[8:11], v[244:247], v[152:155], a[8:11]
v_cvt_pk_bf16_f32 v96, v204, v205
v_cvt_pk_bf16_f32 v97, v206, v207
v_mfma_f32_16x16x32_bf16 a[12:15], v[240:243], v[140:143], a[12:15]
v_exp_f32 v208, v208
v_mfma_f32_16x16x32_bf16 a[12:15], v[244:247], v[156:159], a[12:15]
s_waitcnt lgkmcnt(4)
v_mfma_f32_16x16x32_bf16 a[0:3], v[224:227], v[160:163], a[0:3]
ds_read_b64_tr_b16 v[240:241], v13 offset:32768
ds_read_b64_tr_b16 v[242:243], v13 offset:34816
v_mfma_f32_16x16x32_bf16 a[0:3], v[228:231], v[176:179], a[0:3]
v_exp_f32 v209, v209
v_mfma_f32_16x16x32_bf16 a[4:7], v[224:227], v[164:167], a[4:7]
v_exp_f32 v210, v210
v_mfma_f32_16x16x32_bf16 a[4:7], v[228:231], v[180:183], a[4:7]
v_exp_f32 v211, v211
v_mfma_f32_16x16x32_bf16 a[8:11], v[224:227], v[168:171], a[8:11]
ds_read_b64_tr_b16 v[244:245], v13 offset:49152
ds_read_b64_tr_b16 v[246:247], v13 offset:51200
v_mfma_f32_16x16x32_bf16 a[8:11], v[228:231], v[184:187], a[8:11]
v_cvt_pk_bf16_f32 v2, v208, v209
v_cvt_pk_bf16_f32 v3, v210, v211
v_mfma_f32_16x16x32_bf16 a[12:15], v[224:227], v[172:175], a[12:15]
v_exp_f32 v212, v212
v_mfma_f32_16x16x32_bf16 a[12:15], v[228:231], v[188:191], a[12:15]
s_waitcnt lgkmcnt(4)
v_mfma_f32_16x16x32_bf16 a[16:19], v[232:235], v[128:131], a[16:19]
ds_read_b64_tr_b16 v[224:225], v249 offset:33280
ds_read_b64_tr_b16 v[226:227], v249 offset:35328
v_mfma_f32_16x16x32_bf16 a[16:19], v[236:239], v[144:147], a[16:19]
v_exp_f32 v213, v213
v_mfma_f32_16x16x32_bf16 a[20:23], v[232:235], v[132:135], a[20:23]
v_exp_f32 v214, v214
v_mfma_f32_16x16x32_bf16 a[20:23], v[236:239], v[148:151], a[20:23]
v_exp_f32 v215, v215
v_mfma_f32_16x16x32_bf16 a[24:27], v[232:235], v[136:139], a[24:27]
ds_read_b64_tr_b16 v[228:229], v249 offset:49664
ds_read_b64_tr_b16 v[230:231], v249 offset:51712
v_mfma_f32_16x16x32_bf16 a[24:27], v[236:239], v[152:155], a[24:27]
v_cvt_pk_bf16_f32 v34, v212, v213
v_cvt_pk_bf16_f32 v35, v214, v215
v_mfma_f32_16x16x32_bf16 a[28:31], v[232:235], v[140:143], a[28:31]
v_exp_f32 v216, v216
v_mfma_f32_16x16x32_bf16 a[28:31], v[236:239], v[156:159], a[28:31]
s_waitcnt lgkmcnt(4)
v_mfma_f32_16x16x32_bf16 a[16:19], v[240:243], v[160:163], a[16:19]
ds_read_b64_tr_b16 v[232:233], v249 offset:0
ds_read_b64_tr_b16 v[234:235], v249 offset:2048
v_mfma_f32_16x16x32_bf16 a[16:19], v[244:247], v[176:179], a[16:19]
v_exp_f32 v217, v217
v_mfma_f32_16x16x32_bf16 a[20:23], v[240:243], v[164:167], a[20:23]
v_exp_f32 v218, v218
v_mfma_f32_16x16x32_bf16 a[20:23], v[244:247], v[180:183], a[20:23]
v_exp_f32 v219, v219
v_mfma_f32_16x16x32_bf16 a[24:27], v[240:243], v[168:171], a[24:27]
ds_read_b64_tr_b16 v[236:237], v250 offset:0
ds_read_b64_tr_b16 v[238:239], v250 offset:2048
v_mfma_f32_16x16x32_bf16 a[24:27], v[244:247], v[184:187], a[24:27]
v_cvt_pk_bf16_f32 v66, v216, v217
v_cvt_pk_bf16_f32 v67, v218, v219
v_mfma_f32_16x16x32_bf16 a[28:31], v[240:243], v[172:175], a[28:31]
v_exp_f32 v220, v220
v_mfma_f32_16x16x32_bf16 a[28:31], v[244:247], v[188:191], a[28:31]
s_waitcnt lgkmcnt(4)
v_mfma_f32_16x16x32_bf16 a[32:35], v[224:227], v[4:7], a[32:35]
ds_read_b64_tr_b16 v[240:241], v12 offset:512
ds_read_b64_tr_b16 v[242:243], v12 offset:2560
v_mfma_f32_16x16x32_bf16 a[32:35], v[228:231], v[8:11], a[32:35]
v_exp_f32 v221, v221
v_mfma_f32_16x16x32_bf16 a[36:39], v[224:227], v[36:39], a[36:39]
v_exp_f32 v222, v222
v_mfma_f32_16x16x32_bf16 a[36:39], v[228:231], v[40:43], a[36:39]
v_exp_f32 v223, v223
v_mfma_f32_16x16x32_bf16 a[40:43], v[224:227], v[68:71], a[40:43]
ds_read_b64_tr_b16 v[244:245], v12 offset:16896
ds_read_b64_tr_b16 v[246:247], v12 offset:18944
v_mfma_f32_16x16x32_bf16 a[40:43], v[228:231], v[72:75], a[40:43]
v_cvt_pk_bf16_f32 v98, v220, v221
v_cvt_pk_bf16_f32 v99, v222, v223
v_mfma_f32_16x16x32_bf16 a[44:47], v[224:227], v[100:103], a[44:47]
v_mfma_f32_16x16x32_bf16 a[44:47], v[228:231], v[104:107], a[44:47]
s_waitcnt lgkmcnt(4)
v_mfma_f32_16x16x32_bf16 a[0:3], v[232:235], v[0:3], a[0:3]
ds_read_b64_tr_b16 v[224:225], v12 offset:33280
ds_read_b64_tr_b16 v[226:227], v12 offset:35328
v_mfma_f32_16x16x32_bf16 a[4:7], v[232:235], v[32:35], a[4:7]
v_mfma_f32_16x16x32_bf16 a[8:11], v[232:235], v[64:67], a[8:11]
v_mfma_f32_16x16x32_bf16 a[12:15], v[232:235], v[96:99], a[12:15]
v_mfma_f32_16x16x32_bf16 a[16:19], v[236:239], v[0:3], a[16:19]
ds_read_b64_tr_b16 v[228:229], v12 offset:49664
ds_read_b64_tr_b16 v[230:231], v12 offset:51712
v_mfma_f32_16x16x32_bf16 a[20:23], v[236:239], v[32:35], a[20:23]
v_mfma_f32_16x16x32_bf16 a[24:27], v[236:239], v[64:67], a[24:27]
v_mfma_f32_16x16x32_bf16 a[28:31], v[236:239], v[96:99], a[28:31]
s_waitcnt lgkmcnt(4)
v_mfma_f32_16x16x32_bf16 a[32:35], v[240:243], v[128:131], a[32:35]
ds_read_b64_tr_b16 v[232:233], v249 offset:512
ds_read_b64_tr_b16 v[234:235], v249 offset:2560
v_mfma_f32_16x16x32_bf16 a[32:35], v[244:247], v[144:147], a[32:35]
v_mfma_f32_16x16x32_bf16 a[36:39], v[240:243], v[132:135], a[36:39]
v_mfma_f32_16x16x32_bf16 a[36:39], v[244:247], v[148:151], a[36:39]
v_mfma_f32_16x16x32_bf16 a[40:43], v[240:243], v[136:139], a[40:43]
ds_read_b64_tr_b16 v[236:237], v250 offset:512
ds_read_b64_tr_b16 v[238:239], v250 offset:2560
v_accvgpr_read_b32 v192, a0
v_mfma_f32_16x16x32_bf16 a[40:43], v[244:247], v[152:155], a[40:43]
v_accvgpr_read_b32 v193, a4
v_accvgpr_read_b32 v194, a8
v_accvgpr_read_b32 v195, a12
v_mfma_f32_16x16x32_bf16 a[44:47], v[240:243], v[140:143], a[44:47]
v_lshlrev_b32 v253, 2, v252
v_max3_u32 v254, v192, v193, v194
v_min3_u32 v255, v192, v193, v194
v_mfma_f32_16x16x32_bf16 a[44:47], v[244:247], v[156:159], a[44:47]
s_waitcnt lgkmcnt(4)
v_max_u32 v254, v254, v195
v_min_u32 v255, v255, v195
v_mfma_f32_16x16x32_bf16 a[32:35], v[224:227], v[160:163], a[32:35]
ds_read_b64_tr_b16 v[240:241], v250 offset:33280
ds_read_b64_tr_b16 v[242:243], v250 offset:35328
v_mfma_f32_16x16x32_bf16 a[32:35], v[228:231], v[176:179], a[32:35]
s_mov_b64 exec, 0xffff
buffer_store_dword v192, v253, s[24:27], s48 offen offset:4 sc1
buffer_store_dword v193, v253, s[24:27], s48 offen offset:1028 sc1
buffer_store_dword v194, v253, s[24:27], s48 offen offset:2052 sc1
buffer_store_dword v195, v253, s[24:27], s48 offen offset:3076 sc1
v_cmp_lt_u32 s[50:51], s52, v254
v_cmp_gt_u32 vcc, s53, v255
s_mov_b64 exec, -1
v_mfma_f32_16x16x32_bf16 a[36:39], v[224:227], v[164:167], a[36:39]
v_accvgpr_read_b32 v192, a0
v_accvgpr_read_b32 v193, a1
v_mfma_f32_16x16x32_bf16 a[36:39], v[228:231], v[180:183], a[36:39]
v_accvgpr_read_b32 v194, a2
v_accvgpr_read_b32 v195, a3
v_mfma_f32_16x16x32_bf16 a[40:43], v[224:227], v[168:171], a[40:43]
ds_read_b64_tr_b16 v[244:245], v250 offset:49664
ds_read_b64_tr_b16 v[246:247], v250 offset:51712
v_mfma_f32_16x16x32_bf16 a[40:43], v[228:231], v[184:187], a[40:43]
v_cvt_pk_bf16_f32 v16, v192, v193
v_cvt_pk_bf16_f32 v17, v194, v195
v_mfma_f32_16x16x32_bf16 a[44:47], v[224:227], v[172:175], a[44:47]
v_accvgpr_read_b32 v200, a4
v_accvgpr_read_b32 v201, a5
v_mfma_f32_16x16x32_bf16 a[44:47], v[228:231], v[188:191], a[44:47]
s_waitcnt lgkmcnt(4)
v_accvgpr_read_b32 v202, a6
v_mfma_f32_16x16x32_bf16 a[32:35], v[232:235], v[0:3], a[32:35]
ds_read_b64_tr_b16 v[224:225], v13 offset:512
ds_read_b64_tr_b16 v[226:227], v13 offset:2560
v_mfma_f32_16x16x32_bf16 a[36:39], v[232:235], v[32:35], a[36:39]
v_accvgpr_read_b32 v203, a7
v_cvt_pk_bf16_f32 v48, v200, v201
v_mfma_f32_16x16x32_bf16 a[40:43], v[232:235], v[64:67], a[40:43]
v_cvt_pk_bf16_f32 v49, v202, v203
v_accvgpr_read_b32 v208, a8
v_mfma_f32_16x16x32_bf16 a[44:47], v[232:235], v[96:99], a[44:47]
v_accvgpr_read_b32 v209, a9
v_accvgpr_read_b32 v210, a10
v_mfma_f32_16x16x32_bf16 a[48:51], v[236:239], v[0:3], a[48:51]
ds_read_b64_tr_b16 v[228:229], v13 offset:16896
ds_read_b64_tr_b16 v[230:231], v13 offset:18944
v_mfma_f32_16x16x32_bf16 a[52:55], v[236:239], v[32:35], a[52:55]
v_accvgpr_read_b32 v211, a11
v_cvt_pk_bf16_f32 v80, v208, v209
v_mfma_f32_16x16x32_bf16 a[56:59], v[236:239], v[64:67], a[56:59]
v_cvt_pk_bf16_f32 v81, v210, v211
v_accvgpr_read_b32 v216, a12
v_mfma_f32_16x16x32_bf16 a[60:63], v[236:239], v[96:99], a[60:63]
s_waitcnt lgkmcnt(4)
v_accvgpr_read_b32 v217, a13
v_mfma_f32_16x16x32_bf16 a[48:51], v[240:243], v[4:7], a[48:51]
ds_read_b64_tr_b16 v[232:233], v13 offset:33280
ds_read_b64_tr_b16 v[234:235], v13 offset:35328
v_mfma_f32_16x16x32_bf16 a[48:51], v[244:247], v[8:11], a[48:51]
v_accvgpr_read_b32 v218, a14
v_accvgpr_read_b32 v219, a15
v_mfma_f32_16x16x32_bf16 a[52:55], v[240:243], v[36:39], a[52:55]
v_cvt_pk_bf16_f32 v112, v216, v217
v_cvt_pk_bf16_f32 v113, v218, v219
v_mfma_f32_16x16x32_bf16 a[52:55], v[244:247], v[40:43], a[52:55]
v_accvgpr_read_b32 v196, a16
v_accvgpr_read_b32 v197, a17
v_mfma_f32_16x16x32_bf16 a[56:59], v[240:243], v[68:71], a[56:59]
ds_read_b64_tr_b16 v[236:237], v13 offset:49664
ds_read_b64_tr_b16 v[238:239], v13 offset:51712
v_mfma_f32_16x16x32_bf16 a[56:59], v[244:247], v[72:75], a[56:59]
v_accvgpr_read_b32 v198, a18
v_accvgpr_read_b32 v199, a19
v_mfma_f32_16x16x32_bf16 a[60:63], v[240:243], v[100:103], a[60:63]
v_cvt_pk_bf16_f32 v18, v196, v197
v_cvt_pk_bf16_f32 v19, v198, v199
v_mfma_f32_16x16x32_bf16 a[60:63], v[244:247], v[104:107], a[60:63]
s_waitcnt lgkmcnt(4)
buffer_store_dwordx4 v[16:19], v252, s[20:23], s40 offen offset:0 sc1
v_mfma_f32_16x16x32_bf16 a[48:51], v[224:227], v[128:131], a[48:51]
ds_read_b64_tr_b16 v[240:241], v249 offset:36864
ds_read_b64_tr_b16 v[242:243], v249 offset:38912
v_mfma_f32_16x16x32_bf16 a[48:51], v[228:231], v[144:147], a[48:51]
v_accvgpr_read_b32 v204, a20
v_accvgpr_read_b32 v205, a21
v_mfma_f32_16x16x32_bf16 a[52:55], v[224:227], v[132:135], a[52:55]
v_accvgpr_read_b32 v206, a22
v_accvgpr_read_b32 v207, a23
v_mfma_f32_16x16x32_bf16 a[52:55], v[228:231], v[148:151], a[52:55]
v_cvt_pk_bf16_f32 v50, v204, v205
v_cvt_pk_bf16_f32 v51, v206, v207
v_mfma_f32_16x16x32_bf16 a[56:59], v[224:227], v[136:139], a[56:59]
ds_read_b64_tr_b16 v[244:245], v249 offset:53248
ds_read_b64_tr_b16 v[246:247], v249 offset:55296
v_mfma_f32_16x16x32_bf16 a[56:59], v[228:231], v[152:155], a[56:59]
buffer_store_dwordx4 v[48:51], v252, s[20:23], s41 offen offset:0 sc1
v_accvgpr_read_b32 v212, a24
v_mfma_f32_16x16x32_bf16 a[60:63], v[224:227], v[140:143], a[60:63]
v_accvgpr_read_b32 v213, a25
v_accvgpr_read_b32 v214, a26
v_mfma_f32_16x16x32_bf16 a[60:63], v[228:231], v[156:159], a[60:63]
s_waitcnt lgkmcnt(4)
v_accvgpr_read_b32 v215, a27
v_mfma_f32_16x16x32_bf16 a[48:51], v[232:235], v[160:163], a[48:51]
ds_read_b64_tr_b16 v[224:225], v12 offset:4096
ds_read_b64_tr_b16 v[226:227], v12 offset:6144
v_mfma_f32_16x16x32_bf16 a[48:51], v[236:239], v[176:179], a[48:51]
v_cvt_pk_bf16_f32 v82, v212, v213
v_cvt_pk_bf16_f32 v83, v214, v215
v_mfma_f32_16x16x32_bf16 a[52:55], v[232:235], v[164:167], a[52:55]
buffer_store_dwordx4 v[80:83], v252, s[20:23], s42 offen offset:0 sc1
v_accvgpr_read_b32 v220, a28
v_mfma_f32_16x16x32_bf16 a[52:55], v[236:239], v[180:183], a[52:55]
v_accvgpr_read_b32 v221, a29
v_accvgpr_read_b32 v222, a30
v_mfma_f32_16x16x32_bf16 a[56:59], v[232:235], v[168:171], a[56:59]
ds_read_b64_tr_b16 v[228:229], v12 offset:20480
ds_read_b64_tr_b16 v[230:231], v12 offset:22528
v_mfma_f32_16x16x32_bf16 a[56:59], v[236:239], v[184:187], a[56:59]
v_accvgpr_read_b32 v223, a31
v_cvt_pk_bf16_f32 v114, v220, v221
v_mfma_f32_16x16x32_bf16 a[60:63], v[232:235], v[172:175], a[60:63]
v_cvt_pk_bf16_f32 v115, v222, v223
buffer_store_dwordx4 v[112:115], v252, s[20:23], s43 offen offset:0 sc1
v_mfma_f32_16x16x32_bf16 a[60:63], v[236:239], v[188:191], a[60:63]
s_waitcnt lgkmcnt(4)
v_accvgpr_read_b32 v192, a32
v_mfma_f32_16x16x32_bf16 a[64:67], v[240:243], v[4:7], a[64:67]
ds_read_b64_tr_b16 v[232:233], v12 offset:36864
ds_read_b64_tr_b16 v[234:235], v12 offset:38912
v_mfma_f32_16x16x32_bf16 a[64:67], v[244:247], v[8:11], a[64:67]
v_accvgpr_read_b32 v193, a33
v_accvgpr_read_b32 v194, a34
v_mfma_f32_16x16x32_bf16 a[68:71], v[240:243], v[36:39], a[68:71]
v_accvgpr_read_b32 v195, a35
v_cvt_pk_bf16_f32 v20, v192, v193
v_mfma_f32_16x16x32_bf16 a[68:71], v[244:247], v[40:43], a[68:71]
v_cvt_pk_bf16_f32 v21, v194, v195
v_accvgpr_read_b32 v200, a36
v_mfma_f32_16x16x32_bf16 a[72:75], v[240:243], v[68:71], a[72:75]
ds_read_b64_tr_b16 v[236:237], v12 offset:53248
ds_read_b64_tr_b16 v[238:239], v12 offset:55296
v_mfma_f32_16x16x32_bf16 a[72:75], v[244:247], v[72:75], a[72:75]
v_accvgpr_read_b32 v201, a37
v_accvgpr_read_b32 v202, a38
v_mfma_f32_16x16x32_bf16 a[76:79], v[240:243], v[100:103], a[76:79]
v_accvgpr_read_b32 v203, a39
v_cvt_pk_bf16_f32 v52, v200, v201
v_mfma_f32_16x16x32_bf16 a[76:79], v[244:247], v[104:107], a[76:79]
s_waitcnt lgkmcnt(4)
v_cvt_pk_bf16_f32 v53, v202, v203
v_mfma_f32_16x16x32_bf16 a[64:67], v[224:227], v[128:131], a[64:67]
ds_read_b64_tr_b16 v[240:241], v249 offset:4096
ds_read_b64_tr_b16 v[242:243], v249 offset:6144
v_mfma_f32_16x16x32_bf16 a[64:67], v[228:231], v[144:147], a[64:67]
v_accvgpr_read_b32 v208, a40
v_accvgpr_read_b32 v209, a41
v_mfma_f32_16x16x32_bf16 a[68:71], v[224:227], v[132:135], a[68:71]
v_accvgpr_read_b32 v210, a42
v_accvgpr_read_b32 v211, a43
v_mfma_f32_16x16x32_bf16 a[68:71], v[228:231], v[148:151], a[68:71]
v_cvt_pk_bf16_f32 v84, v208, v209
v_cvt_pk_bf16_f32 v85, v210, v211
v_mfma_f32_16x16x32_bf16 a[72:75], v[224:227], v[136:139], a[72:75]
ds_read_b64_tr_b16 v[244:245], v250 offset:4096
ds_read_b64_tr_b16 v[246:247], v250 offset:6144
v_mfma_f32_16x16x32_bf16 a[72:75], v[228:231], v[152:155], a[72:75]
v_accvgpr_read_b32 v216, a44
v_accvgpr_read_b32 v217, a45
v_mfma_f32_16x16x32_bf16 a[76:79], v[224:227], v[140:143], a[76:79]
v_accvgpr_read_b32 v218, a46
v_accvgpr_read_b32 v219, a47
v_mfma_f32_16x16x32_bf16 a[76:79], v[228:231], v[156:159], a[76:79]
s_waitcnt lgkmcnt(4)
v_cvt_pk_bf16_f32 v116, v216, v217
v_mfma_f32_16x16x32_bf16 a[64:67], v[232:235], v[160:163], a[64:67]
ds_read_b64_tr_b16 v[224:225], v250 offset:36864
ds_read_b64_tr_b16 v[226:227], v250 offset:38912
v_mfma_f32_16x16x32_bf16 a[64:67], v[236:239], v[176:179], a[64:67]
v_cvt_pk_bf16_f32 v117, v218, v219
v_accvgpr_read_b32 v196, a48
v_mfma_f32_16x16x32_bf16 a[68:71], v[232:235], v[164:167], a[68:71]
v_accvgpr_read_b32 v197, a49
v_accvgpr_read_b32 v198, a50
v_mfma_f32_16x16x32_bf16 a[68:71], v[236:239], v[180:183], a[68:71]
v_accvgpr_read_b32 v199, a51
v_cvt_pk_bf16_f32 v22, v196, v197
v_mfma_f32_16x16x32_bf16 a[72:75], v[232:235], v[168:171], a[72:75]
ds_read_b64_tr_b16 v[228:229], v250 offset:53248
ds_read_b64_tr_b16 v[230:231], v250 offset:55296
v_mfma_f32_16x16x32_bf16 a[72:75], v[236:239], v[184:187], a[72:75]
v_cvt_pk_bf16_f32 v23, v198, v199
buffer_store_dwordx4 v[20:23], v252, s[20:23], s40 offen offset:1024 sc1
v_mfma_f32_16x16x32_bf16 a[76:79], v[232:235], v[172:175], a[76:79]
v_accvgpr_read_b32 v204, a52
v_accvgpr_read_b32 v205, a53
v_mfma_f32_16x16x32_bf16 a[76:79], v[236:239], v[188:191], a[76:79]
s_waitcnt lgkmcnt(4)
v_accvgpr_read_b32 v206, a54
v_mfma_f32_16x16x32_bf16 a[64:67], v[240:243], v[0:3], a[64:67]
ds_read_b64_tr_b16 v[232:233], v13 offset:4096
ds_read_b64_tr_b16 v[234:235], v13 offset:6144
v_mfma_f32_16x16x32_bf16 a[68:71], v[240:243], v[32:35], a[68:71]
v_accvgpr_read_b32 v207, a55
v_cvt_pk_bf16_f32 v54, v204, v205
v_mfma_f32_16x16x32_bf16 a[72:75], v[240:243], v[64:67], a[72:75]
v_cvt_pk_bf16_f32 v55, v206, v207
buffer_store_dwordx4 v[52:55], v252, s[20:23], s41 offen offset:1024 sc1
v_mfma_f32_16x16x32_bf16 a[76:79], v[240:243], v[96:99], a[76:79]
v_accvgpr_read_b32 v212, a56
v_accvgpr_read_b32 v213, a57
v_mfma_f32_16x16x32_bf16 a[80:83], v[244:247], v[0:3], a[80:83]
ds_read_b64_tr_b16 v[236:237], v13 offset:20480
ds_read_b64_tr_b16 v[238:239], v13 offset:22528
v_mfma_f32_16x16x32_bf16 a[84:87], v[244:247], v[32:35], a[84:87]
v_accvgpr_read_b32 v214, a58
v_accvgpr_read_b32 v215, a59
v_mfma_f32_16x16x32_bf16 a[88:91], v[244:247], v[64:67], a[88:91]
v_cvt_pk_bf16_f32 v86, v212, v213
v_cvt_pk_bf16_f32 v87, v214, v215
v_mfma_f32_16x16x32_bf16 a[92:95], v[244:247], v[96:99], a[92:95]
s_waitcnt lgkmcnt(4)
buffer_store_dwordx4 v[84:87], v252, s[20:23], s42 offen offset:1024 sc1
v_mfma_f32_16x16x32_bf16 a[80:83], v[224:227], v[4:7], a[80:83]
ds_read_b64_tr_b16 v[240:241], v13 offset:36864
ds_read_b64_tr_b16 v[242:243], v13 offset:38912
v_mfma_f32_16x16x32_bf16 a[80:83], v[228:231], v[8:11], a[80:83]
v_accvgpr_read_b32 v220, a60
v_accvgpr_read_b32 v221, a61
v_mfma_f32_16x16x32_bf16 a[84:87], v[224:227], v[36:39], a[84:87]
v_accvgpr_read_b32 v222, a62
v_accvgpr_read_b32 v223, a63
v_mfma_f32_16x16x32_bf16 a[84:87], v[228:231], v[40:43], a[84:87]
v_cvt_pk_bf16_f32 v118, v220, v221
v_cvt_pk_bf16_f32 v119, v222, v223
v_mfma_f32_16x16x32_bf16 a[88:91], v[224:227], v[68:71], a[88:91]
ds_read_b64_tr_b16 v[244:245], v13 offset:53248
ds_read_b64_tr_b16 v[246:247], v13 offset:55296
v_mfma_f32_16x16x32_bf16 a[88:91], v[228:231], v[72:75], a[88:91]
buffer_store_dwordx4 v[116:119], v252, s[20:23], s43 offen offset:1024 sc1
v_accvgpr_read_b32 v192, a64
v_mfma_f32_16x16x32_bf16 a[92:95], v[224:227], v[100:103], a[92:95]
v_accvgpr_read_b32 v193, a65
v_accvgpr_read_b32 v194, a66
v_mfma_f32_16x16x32_bf16 a[92:95], v[228:231], v[104:107], a[92:95]
s_waitcnt lgkmcnt(4)
v_accvgpr_read_b32 v195, a67
v_mfma_f32_16x16x32_bf16 a[80:83], v[232:235], v[128:131], a[80:83]
ds_read_b64_tr_b16 v[224:225], v249 offset:37376
ds_read_b64_tr_b16 v[226:227], v249 offset:39424
v_mfma_f32_16x16x32_bf16 a[80:83], v[236:239], v[144:147], a[80:83]
v_cvt_pk_bf16_f32 v24, v192, v193
v_cvt_pk_bf16_f32 v25, v194, v195
v_mfma_f32_16x16x32_bf16 a[84:87], v[232:235], v[132:135], a[84:87]
v_accvgpr_read_b32 v200, a68
v_accvgpr_read_b32 v201, a69
v_mfma_f32_16x16x32_bf16 a[84:87], v[236:239], v[148:151], a[84:87]
v_accvgpr_read_b32 v202, a70
v_accvgpr_read_b32 v203, a71
v_mfma_f32_16x16x32_bf16 a[88:91], v[232:235], v[136:139], a[88:91]
ds_read_b64_tr_b16 v[228:229], v249 offset:53760
ds_read_b64_tr_b16 v[230:231], v249 offset:55808
v_mfma_f32_16x16x32_bf16 a[88:91], v[236:239], v[152:155], a[88:91]
v_cvt_pk_bf16_f32 v56, v200, v201
v_cvt_pk_bf16_f32 v57, v202, v203
v_mfma_f32_16x16x32_bf16 a[92:95], v[232:235], v[140:143], a[92:95]
v_accvgpr_read_b32 v208, a72
v_accvgpr_read_b32 v209, a73
v_mfma_f32_16x16x32_bf16 a[92:95], v[236:239], v[156:159], a[92:95]
s_waitcnt lgkmcnt(4)
v_accvgpr_read_b32 v210, a74
v_mfma_f32_16x16x32_bf16 a[80:83], v[240:243], v[160:163], a[80:83]
ds_read_b64_tr_b16 v[232:233], v12 offset:4608
ds_read_b64_tr_b16 v[234:235], v12 offset:6656
v_mfma_f32_16x16x32_bf16 a[80:83], v[244:247], v[176:179], a[80:83]
v_accvgpr_read_b32 v211, a75
v_cvt_pk_bf16_f32 v88, v208, v209
v_mfma_f32_16x16x32_bf16 a[84:87], v[240:243], v[164:167], a[84:87]
v_cvt_pk_bf16_f32 v89, v210, v211
v_accvgpr_read_b32 v216, a76
v_mfma_f32_16x16x32_bf16 a[84:87], v[244:247], v[180:183], a[84:87]
v_accvgpr_read_b32 v217, a77
v_accvgpr_read_b32 v218, a78
v_mfma_f32_16x16x32_bf16 a[88:91], v[240:243], v[168:171], a[88:91]
ds_read_b64_tr_b16 v[236:237], v12 offset:20992
ds_read_b64_tr_b16 v[238:239], v12 offset:23040
v_mfma_f32_16x16x32_bf16 a[88:91], v[244:247], v[184:187], a[88:91]
v_accvgpr_read_b32 v219, a79
v_cvt_pk_bf16_f32 v120, v216, v217
v_mfma_f32_16x16x32_bf16 a[92:95], v[240:243], v[172:175], a[92:95]
v_cvt_pk_bf16_f32 v121, v218, v219
v_accvgpr_read_b32 v196, a80
v_mfma_f32_16x16x32_bf16 a[92:95], v[244:247], v[188:191], a[92:95]
s_waitcnt lgkmcnt(4)
v_accvgpr_read_b32 v197, a81
v_mfma_f32_16x16x32_bf16 a[96:99], v[224:227], v[4:7], a[96:99]
ds_read_b64_tr_b16 v[240:241], v12 offset:37376
ds_read_b64_tr_b16 v[242:243], v12 offset:39424
v_mfma_f32_16x16x32_bf16 a[96:99], v[228:231], v[8:11], a[96:99]
v_accvgpr_read_b32 v198, a82
v_accvgpr_read_b32 v199, a83
v_mfma_f32_16x16x32_bf16 a[100:103], v[224:227], v[36:39], a[100:103]
v_cvt_pk_bf16_f32 v26, v196, v197
v_cvt_pk_bf16_f32 v27, v198, v199
v_mfma_f32_16x16x32_bf16 a[100:103], v[228:231], v[40:43], a[100:103]
buffer_store_dwordx4 v[24:27], v252, s[20:23], s40 offen offset:2048 sc1
v_accvgpr_read_b32 v204, a84
v_mfma_f32_16x16x32_bf16 a[104:107], v[224:227], v[68:71], a[104:107]
ds_read_b64_tr_b16 v[244:245], v12 offset:53760
ds_read_b64_tr_b16 v[246:247], v12 offset:55808
v_mfma_f32_16x16x32_bf16 a[104:107], v[228:231], v[72:75], a[104:107]
v_accvgpr_read_b32 v205, a85
v_accvgpr_read_b32 v206, a86
v_mfma_f32_16x16x32_bf16 a[108:111], v[224:227], v[100:103], a[108:111]
v_accvgpr_read_b32 v207, a87
v_cvt_pk_bf16_f32 v58, v204, v205
v_mfma_f32_16x16x32_bf16 a[108:111], v[228:231], v[104:107], a[108:111]
s_waitcnt lgkmcnt(4)
v_cvt_pk_bf16_f32 v59, v206, v207
v_mfma_f32_16x16x32_bf16 a[96:99], v[232:235], v[128:131], a[96:99]
ds_read_b64_tr_b16 v[224:225], v249 offset:4608
ds_read_b64_tr_b16 v[226:227], v249 offset:6656
v_mfma_f32_16x16x32_bf16 a[96:99], v[236:239], v[144:147], a[96:99]
buffer_store_dwordx4 v[56:59], v252, s[20:23], s41 offen offset:2048 sc1
v_accvgpr_read_b32 v212, a88
v_mfma_f32_16x16x32_bf16 a[100:103], v[232:235], v[132:135], a[100:103]
v_accvgpr_read_b32 v213, a89
v_accvgpr_read_b32 v214, a90
v_mfma_f32_16x16x32_bf16 a[100:103], v[236:239], v[148:151], a[100:103]
v_accvgpr_read_b32 v215, a91
v_cvt_pk_bf16_f32 v90, v212, v213
v_mfma_f32_16x16x32_bf16 a[104:107], v[232:235], v[136:139], a[104:107]
ds_read_b64_tr_b16 v[228:229], v250 offset:4608
ds_read_b64_tr_b16 v[230:231], v250 offset:6656
v_mfma_f32_16x16x32_bf16 a[104:107], v[236:239], v[152:155], a[104:107]
v_cvt_pk_bf16_f32 v91, v214, v215
buffer_store_dwordx4 v[88:91], v252, s[20:23], s42 offen offset:2048 sc1
v_mfma_f32_16x16x32_bf16 a[108:111], v[232:235], v[140:143], a[108:111]
v_accvgpr_read_b32 v220, a92
v_accvgpr_read_b32 v221, a93
v_mfma_f32_16x16x32_bf16 a[108:111], v[236:239], v[156:159], a[108:111]
s_waitcnt lgkmcnt(4)
v_accvgpr_read_b32 v222, a94
v_mfma_f32_16x16x32_bf16 a[96:99], v[240:243], v[160:163], a[96:99]
ds_read_b64_tr_b16 v[232:233], v250 offset:37376
ds_read_b64_tr_b16 v[234:235], v250 offset:39424
v_mfma_f32_16x16x32_bf16 a[96:99], v[244:247], v[176:179], a[96:99]
v_accvgpr_read_b32 v223, a95
v_cvt_pk_bf16_f32 v122, v220, v221
v_mfma_f32_16x16x32_bf16 a[100:103], v[240:243], v[164:167], a[100:103]
v_cvt_pk_bf16_f32 v123, v222, v223
buffer_store_dwordx4 v[120:123], v252, s[20:23], s43 offen offset:2048 sc1
v_mfma_f32_16x16x32_bf16 a[100:103], v[244:247], v[180:183], a[100:103]
v_mfma_f32_16x16x32_bf16 a[104:107], v[240:243], v[168:171], a[104:107]
ds_read_b64_tr_b16 v[236:237], v250 offset:53760
ds_read_b64_tr_b16 v[238:239], v250 offset:55808
v_mfma_f32_16x16x32_bf16 a[104:107], v[244:247], v[184:187], a[104:107]
v_mfma_f32_16x16x32_bf16 a[108:111], v[240:243], v[172:175], a[108:111]
v_mfma_f32_16x16x32_bf16 a[108:111], v[244:247], v[188:191], a[108:111]
s_waitcnt lgkmcnt(4)
v_mfma_f32_16x16x32_bf16 a[96:99], v[224:227], v[0:3], a[96:99]
ds_read_b64_tr_b16 v[240:241], v13 offset:4608
ds_read_b64_tr_b16 v[242:243], v13 offset:6656
v_mfma_f32_16x16x32_bf16 a[100:103], v[224:227], v[32:35], a[100:103]
v_mfma_f32_16x16x32_bf16 a[104:107], v[224:227], v[64:67], a[104:107]
v_mfma_f32_16x16x32_bf16 a[108:111], v[224:227], v[96:99], a[108:111]
v_mfma_f32_16x16x32_bf16 a[112:115], v[228:231], v[0:3], a[112:115]
ds_read_b64_tr_b16 v[244:245], v13 offset:20992
ds_read_b64_tr_b16 v[246:247], v13 offset:23040
v_mfma_f32_16x16x32_bf16 a[116:119], v[228:231], v[32:35], a[116:119]
v_accvgpr_read_b32 v192, a96
v_accvgpr_read_b32 v193, a97
v_mfma_f32_16x16x32_bf16 a[120:123], v[228:231], v[64:67], a[120:123]
v_accvgpr_read_b32 v194, a98
v_accvgpr_read_b32 v195, a99
v_mfma_f32_16x16x32_bf16 a[124:127], v[228:231], v[96:99], a[124:127]
s_waitcnt lgkmcnt(4)
v_cvt_pk_bf16_f32 v28, v192, v193
v_mfma_f32_16x16x32_bf16 a[112:115], v[232:235], v[4:7], a[112:115]
ds_read_b64_tr_b16 v[224:225], v13 offset:37376
ds_read_b64_tr_b16 v[226:227], v13 offset:39424
v_mfma_f32_16x16x32_bf16 a[112:115], v[236:239], v[8:11], a[112:115]
v_cvt_pk_bf16_f32 v29, v194, v195
v_accvgpr_read_b32 v200, a100
v_mfma_f32_16x16x32_bf16 a[116:119], v[232:235], v[36:39], a[116:119]
v_accvgpr_read_b32 v201, a101
v_accvgpr_read_b32 v202, a102
v_mfma_f32_16x16x32_bf16 a[116:119], v[236:239], v[40:43], a[116:119]
v_accvgpr_read_b32 v203, a103
v_cvt_pk_bf16_f32 v60, v200, v201
v_mfma_f32_16x16x32_bf16 a[120:123], v[232:235], v[68:71], a[120:123]
ds_read_b64_tr_b16 v[228:229], v13 offset:53760
ds_read_b64_tr_b16 v[230:231], v13 offset:55808
v_mfma_f32_16x16x32_bf16 a[120:123], v[236:239], v[72:75], a[120:123]
v_cvt_pk_bf16_f32 v61, v202, v203
v_accvgpr_read_b32 v208, a104
v_mfma_f32_16x16x32_bf16 a[124:127], v[232:235], v[100:103], a[124:127]
v_accvgpr_read_b32 v209, a105
v_accvgpr_read_b32 v210, a106
v_mfma_f32_16x16x32_bf16 a[124:127], v[236:239], v[104:107], a[124:127]
s_waitcnt lgkmcnt(4)
v_accvgpr_read_b32 v211, a107
v_mfma_f32_16x16x32_bf16 a[112:115], v[240:243], v[128:131], a[112:115]
ds_read_b64_tr_b16 v[232:233], v249 offset:40960
ds_read_b64_tr_b16 v[234:235], v249 offset:43008
v_mfma_f32_16x16x32_bf16 a[112:115], v[244:247], v[144:147], a[112:115]
v_cvt_pk_bf16_f32 v92, v208, v209
v_cvt_pk_bf16_f32 v93, v210, v211
v_mfma_f32_16x16x32_bf16 a[116:119], v[240:243], v[132:135], a[116:119]
v_accvgpr_read_b32 v216, a108
v_accvgpr_read_b32 v217, a109
v_mfma_f32_16x16x32_bf16 a[116:119], v[244:247], v[148:151], a[116:119]
v_accvgpr_read_b32 v218, a110
v_accvgpr_read_b32 v219, a111
v_mfma_f32_16x16x32_bf16 a[120:123], v[240:243], v[136:139], a[120:123]
ds_read_b64_tr_b16 v[236:237], v249 offset:57344
ds_read_b64_tr_b16 v[238:239], v249 offset:59392
v_mfma_f32_16x16x32_bf16 a[120:123], v[244:247], v[152:155], a[120:123]
v_cvt_pk_bf16_f32 v124, v216, v217
v_cvt_pk_bf16_f32 v125, v218, v219
v_mfma_f32_16x16x32_bf16 a[124:127], v[240:243], v[140:143], a[124:127]
v_mfma_f32_16x16x32_bf16 a[124:127], v[244:247], v[156:159], a[124:127]
s_waitcnt lgkmcnt(4)
v_mfma_f32_16x16x32_bf16 a[112:115], v[224:227], v[160:163], a[112:115]
ds_read_b64_tr_b16 v[240:241], v12 offset:8192
ds_read_b64_tr_b16 v[242:243], v12 offset:10240
v_mfma_f32_16x16x32_bf16 a[112:115], v[228:231], v[176:179], a[112:115]
v_mfma_f32_16x16x32_bf16 a[116:119], v[224:227], v[164:167], a[116:119]
v_mfma_f32_16x16x32_bf16 a[116:119], v[228:231], v[180:183], a[116:119]
v_mfma_f32_16x16x32_bf16 a[120:123], v[224:227], v[168:171], a[120:123]
ds_read_b64_tr_b16 v[244:245], v12 offset:24576
ds_read_b64_tr_b16 v[246:247], v12 offset:26624
v_mfma_f32_16x16x32_bf16 a[120:123], v[228:231], v[184:187], a[120:123]
v_mfma_f32_16x16x32_bf16 a[124:127], v[224:227], v[172:175], a[124:127]
s_nop 0
v_accvgpr_read_b32 v196, a112
v_accvgpr_read_b32 v197, a113
v_mfma_f32_16x16x32_bf16 a[124:127], v[228:231], v[188:191], a[124:127]
s_waitcnt lgkmcnt(4)
v_accvgpr_read_b32 v198, a114
v_mfma_f32_16x16x32_bf16 a[128:131], v[232:235], v[4:7], a[128:131]
ds_read_b64_tr_b16 v[224:225], v12 offset:40960
ds_read_b64_tr_b16 v[226:227], v12 offset:43008
v_mfma_f32_16x16x32_bf16 a[128:131], v[236:239], v[8:11], a[128:131]
v_accvgpr_read_b32 v199, a115
v_cvt_pk_bf16_f32 v30, v196, v197
v_mfma_f32_16x16x32_bf16 a[132:135], v[232:235], v[36:39], a[132:135]
v_cvt_pk_bf16_f32 v31, v198, v199
buffer_store_dwordx4 v[28:31], v252, s[20:23], s40 offen offset:3072 sc1
v_mfma_f32_16x16x32_bf16 a[132:135], v[236:239], v[40:43], a[132:135]
v_accvgpr_read_b32 v204, a116
v_accvgpr_read_b32 v205, a117
v_mfma_f32_16x16x32_bf16 a[136:139], v[232:235], v[68:71], a[136:139]
ds_read_b64_tr_b16 v[228:229], v12 offset:57344
ds_read_b64_tr_b16 v[230:231], v12 offset:59392
v_mfma_f32_16x16x32_bf16 a[136:139], v[236:239], v[72:75], a[136:139]
v_accvgpr_read_b32 v206, a118
v_accvgpr_read_b32 v207, a119
v_mfma_f32_16x16x32_bf16 a[140:143], v[232:235], v[100:103], a[140:143]
v_cvt_pk_bf16_f32 v62, v204, v205
v_cvt_pk_bf16_f32 v63, v206, v207
v_mfma_f32_16x16x32_bf16 a[140:143], v[236:239], v[104:107], a[140:143]
s_waitcnt lgkmcnt(4)
buffer_store_dwordx4 v[60:63], v252, s[20:23], s41 offen offset:3072 sc1
v_mfma_f32_16x16x32_bf16 a[128:131], v[240:243], v[128:131], a[128:131]
ds_read_b64_tr_b16 v[232:233], v249 offset:8192
ds_read_b64_tr_b16 v[234:235], v249 offset:10240
v_mfma_f32_16x16x32_bf16 a[128:131], v[244:247], v[144:147], a[128:131]
v_accvgpr_read_b32 v212, a120
v_accvgpr_read_b32 v213, a121
v_mfma_f32_16x16x32_bf16 a[132:135], v[240:243], v[132:135], a[132:135]
v_accvgpr_read_b32 v214, a122
v_accvgpr_read_b32 v215, a123
v_mfma_f32_16x16x32_bf16 a[132:135], v[244:247], v[148:151], a[132:135]
v_cvt_pk_bf16_f32 v94, v212, v213
v_cvt_pk_bf16_f32 v95, v214, v215
v_mfma_f32_16x16x32_bf16 a[136:139], v[240:243], v[136:139], a[136:139]
ds_read_b64_tr_b16 v[236:237], v250 offset:8192
ds_read_b64_tr_b16 v[238:239], v250 offset:10240
v_mfma_f32_16x16x32_bf16 a[136:139], v[244:247], v[152:155], a[136:139]
buffer_store_dwordx4 v[92:95], v252, s[20:23], s42 offen offset:3072 sc1
v_accvgpr_read_b32 v220, a124
v_mfma_f32_16x16x32_bf16 a[140:143], v[240:243], v[140:143], a[140:143]
v_accvgpr_read_b32 v221, a125
v_accvgpr_read_b32 v222, a126
v_mfma_f32_16x16x32_bf16 a[140:143], v[244:247], v[156:159], a[140:143]
s_waitcnt lgkmcnt(4)
v_accvgpr_read_b32 v223, a127
v_mfma_f32_16x16x32_bf16 a[128:131], v[224:227], v[160:163], a[128:131]
ds_read_b64_tr_b16 v[240:241], v250 offset:40960
ds_read_b64_tr_b16 v[242:243], v250 offset:43008
v_mfma_f32_16x16x32_bf16 a[128:131], v[228:231], v[176:179], a[128:131]
v_cvt_pk_bf16_f32 v126, v220, v221
v_cvt_pk_bf16_f32 v127, v222, v223
v_mfma_f32_16x16x32_bf16 a[132:135], v[224:227], v[164:167], a[132:135]
buffer_store_dwordx4 v[124:127], v252, s[20:23], s43 offen offset:3072 sc1
v_mfma_f32_16x16x32_bf16 a[132:135], v[228:231], v[180:183], a[132:135]
v_mfma_f32_16x16x32_bf16 a[136:139], v[224:227], v[168:171], a[136:139]
ds_read_b64_tr_b16 v[244:245], v250 offset:57344
ds_read_b64_tr_b16 v[246:247], v250 offset:59392
v_mfma_f32_16x16x32_bf16 a[136:139], v[228:231], v[184:187], a[136:139]
v_mfma_f32_16x16x32_bf16 a[140:143], v[224:227], v[172:175], a[140:143]
v_mfma_f32_16x16x32_bf16 a[140:143], v[228:231], v[188:191], a[140:143]
s_waitcnt lgkmcnt(4)
v_mfma_f32_16x16x32_bf16 a[128:131], v[232:235], v[0:3], a[128:131]
ds_read_b64_tr_b16 v[224:225], v13 offset:8192
ds_read_b64_tr_b16 v[226:227], v13 offset:10240
v_mfma_f32_16x16x32_bf16 a[132:135], v[232:235], v[32:35], a[132:135]
v_mfma_f32_16x16x32_bf16 a[136:139], v[232:235], v[64:67], a[136:139]
v_mfma_f32_16x16x32_bf16 a[140:143], v[232:235], v[96:99], a[140:143]
v_mfma_f32_16x16x32_bf16 a[144:147], v[236:239], v[0:3], a[144:147]
ds_read_b64_tr_b16 v[228:229], v13 offset:24576
ds_read_b64_tr_b16 v[230:231], v13 offset:26624
v_mfma_f32_16x16x32_bf16 a[148:151], v[236:239], v[32:35], a[148:151]
v_accvgpr_read_b32 v192, a128
v_accvgpr_read_b32 v193, a129
v_mfma_f32_16x16x32_bf16 a[152:155], v[236:239], v[64:67], a[152:155]
v_accvgpr_read_b32 v194, a130
v_accvgpr_read_b32 v195, a131
v_mfma_f32_16x16x32_bf16 a[156:159], v[236:239], v[96:99], a[156:159]
s_waitcnt lgkmcnt(4)
v_cvt_pk_bf16_f32 v16, v192, v193
v_mfma_f32_16x16x32_bf16 a[144:147], v[240:243], v[4:7], a[144:147]
ds_read_b64_tr_b16 v[232:233], v13 offset:40960
ds_read_b64_tr_b16 v[234:235], v13 offset:43008
v_mfma_f32_16x16x32_bf16 a[144:147], v[244:247], v[8:11], a[144:147]
v_cvt_pk_bf16_f32 v17, v194, v195
v_accvgpr_read_b32 v200, a132
v_mfma_f32_16x16x32_bf16 a[148:151], v[240:243], v[36:39], a[148:151]
v_accvgpr_read_b32 v201, a133
v_accvgpr_read_b32 v202, a134
v_mfma_f32_16x16x32_bf16 a[148:151], v[244:247], v[40:43], a[148:151]
v_accvgpr_read_b32 v203, a135
v_cvt_pk_bf16_f32 v48, v200, v201
v_mfma_f32_16x16x32_bf16 a[152:155], v[240:243], v[68:71], a[152:155]
ds_read_b64_tr_b16 v[236:237], v13 offset:57344
ds_read_b64_tr_b16 v[238:239], v13 offset:59392
v_mfma_f32_16x16x32_bf16 a[152:155], v[244:247], v[72:75], a[152:155]
v_cvt_pk_bf16_f32 v49, v202, v203
v_accvgpr_read_b32 v208, a136
v_mfma_f32_16x16x32_bf16 a[156:159], v[240:243], v[100:103], a[156:159]
v_accvgpr_read_b32 v209, a137
v_accvgpr_read_b32 v210, a138
v_mfma_f32_16x16x32_bf16 a[156:159], v[244:247], v[104:107], a[156:159]
s_waitcnt lgkmcnt(4)
v_accvgpr_read_b32 v211, a139
v_mfma_f32_16x16x32_bf16 a[144:147], v[224:227], v[128:131], a[144:147]
ds_read_b64_tr_b16 v[240:241], v249 offset:41472
ds_read_b64_tr_b16 v[242:243], v249 offset:43520
v_mfma_f32_16x16x32_bf16 a[144:147], v[228:231], v[144:147], a[144:147]
v_cvt_pk_bf16_f32 v80, v208, v209
v_cvt_pk_bf16_f32 v81, v210, v211
v_mfma_f32_16x16x32_bf16 a[148:151], v[224:227], v[132:135], a[148:151]
v_accvgpr_read_b32 v216, a140
v_accvgpr_read_b32 v217, a141
v_mfma_f32_16x16x32_bf16 a[148:151], v[228:231], v[148:151], a[148:151]
v_accvgpr_read_b32 v218, a142
v_accvgpr_read_b32 v219, a143
v_mfma_f32_16x16x32_bf16 a[152:155], v[224:227], v[136:139], a[152:155]
ds_read_b64_tr_b16 v[244:245], v249 offset:57856
ds_read_b64_tr_b16 v[246:247], v249 offset:59904
v_mfma_f32_16x16x32_bf16 a[152:155], v[228:231], v[152:155], a[152:155]
v_cvt_pk_bf16_f32 v112, v216, v217
v_cvt_pk_bf16_f32 v113, v218, v219
v_mfma_f32_16x16x32_bf16 a[156:159], v[224:227], v[140:143], a[156:159]
v_mfma_f32_16x16x32_bf16 a[156:159], v[228:231], v[156:159], a[156:159]
s_waitcnt lgkmcnt(4)
v_mfma_f32_16x16x32_bf16 a[144:147], v[232:235], v[160:163], a[144:147]
ds_read_b64_tr_b16 v[224:225], v12 offset:8704
ds_read_b64_tr_b16 v[226:227], v12 offset:10752
v_mfma_f32_16x16x32_bf16 a[144:147], v[236:239], v[176:179], a[144:147]
v_mfma_f32_16x16x32_bf16 a[148:151], v[232:235], v[164:167], a[148:151]
v_mfma_f32_16x16x32_bf16 a[148:151], v[236:239], v[180:183], a[148:151]
v_mfma_f32_16x16x32_bf16 a[152:155], v[232:235], v[168:171], a[152:155]
ds_read_b64_tr_b16 v[228:229], v12 offset:25088
ds_read_b64_tr_b16 v[230:231], v12 offset:27136
v_mfma_f32_16x16x32_bf16 a[152:155], v[236:239], v[184:187], a[152:155]
v_mfma_f32_16x16x32_bf16 a[156:159], v[232:235], v[172:175], a[156:159]
s_nop 0
v_accvgpr_read_b32 v196, a144
v_accvgpr_read_b32 v197, a145
v_mfma_f32_16x16x32_bf16 a[156:159], v[236:239], v[188:191], a[156:159]
s_waitcnt lgkmcnt(4)
v_accvgpr_read_b32 v198, a146
v_mfma_f32_16x16x32_bf16 a[160:163], v[240:243], v[4:7], a[160:163]
ds_read_b64_tr_b16 v[232:233], v12 offset:41472
ds_read_b64_tr_b16 v[234:235], v12 offset:43520
v_mfma_f32_16x16x32_bf16 a[160:163], v[244:247], v[8:11], a[160:163]
v_accvgpr_read_b32 v199, a147
v_cvt_pk_bf16_f32 v18, v196, v197
v_mfma_f32_16x16x32_bf16 a[164:167], v[240:243], v[36:39], a[164:167]
v_cvt_pk_bf16_f32 v19, v198, v199
buffer_store_dwordx4 v[16:19], v252, s[20:23], s44 offen offset:0 sc1
v_mfma_f32_16x16x32_bf16 a[164:167], v[244:247], v[40:43], a[164:167]
v_accvgpr_read_b32 v204, a148
v_accvgpr_read_b32 v205, a149
v_mfma_f32_16x16x32_bf16 a[168:171], v[240:243], v[68:71], a[168:171]
ds_read_b64_tr_b16 v[236:237], v12 offset:57856
ds_read_b64_tr_b16 v[238:239], v12 offset:59904
v_mfma_f32_16x16x32_bf16 a[168:171], v[244:247], v[72:75], a[168:171]
v_accvgpr_read_b32 v206, a150
v_accvgpr_read_b32 v207, a151
v_mfma_f32_16x16x32_bf16 a[172:175], v[240:243], v[100:103], a[172:175]
v_cvt_pk_bf16_f32 v50, v204, v205
v_cvt_pk_bf16_f32 v51, v206, v207
v_mfma_f32_16x16x32_bf16 a[172:175], v[244:247], v[104:107], a[172:175]
s_waitcnt lgkmcnt(4)
buffer_store_dwordx4 v[48:51], v252, s[20:23], s45 offen offset:0 sc1
v_mfma_f32_16x16x32_bf16 a[160:163], v[224:227], v[128:131], a[160:163]
ds_read_b64_tr_b16 v[240:241], v249 offset:8704
ds_read_b64_tr_b16 v[242:243], v249 offset:10752
v_mfma_f32_16x16x32_bf16 a[160:163], v[228:231], v[144:147], a[160:163]
v_accvgpr_read_b32 v212, a152
v_accvgpr_read_b32 v213, a153
v_mfma_f32_16x16x32_bf16 a[164:167], v[224:227], v[132:135], a[164:167]
v_accvgpr_read_b32 v214, a154
v_accvgpr_read_b32 v215, a155
v_mfma_f32_16x16x32_bf16 a[164:167], v[228:231], v[148:151], a[164:167]
v_cvt_pk_bf16_f32 v82, v212, v213
v_cvt_pk_bf16_f32 v83, v214, v215
v_mfma_f32_16x16x32_bf16 a[168:171], v[224:227], v[136:139], a[168:171]
ds_read_b64_tr_b16 v[244:245], v250 offset:8704
ds_read_b64_tr_b16 v[246:247], v250 offset:10752
v_mfma_f32_16x16x32_bf16 a[168:171], v[228:231], v[152:155], a[168:171]
buffer_store_dwordx4 v[80:83], v252, s[20:23], s46 offen offset:0 sc1
v_accvgpr_read_b32 v220, a156
v_mfma_f32_16x16x32_bf16 a[172:175], v[224:227], v[140:143], a[172:175]
v_accvgpr_read_b32 v221, a157
v_accvgpr_read_b32 v222, a158
v_mfma_f32_16x16x32_bf16 a[172:175], v[228:231], v[156:159], a[172:175]
s_waitcnt lgkmcnt(4)
v_accvgpr_read_b32 v223, a159
v_mfma_f32_16x16x32_bf16 a[160:163], v[232:235], v[160:163], a[160:163]
ds_read_b64_tr_b16 v[224:225], v250 offset:41472
ds_read_b64_tr_b16 v[226:227], v250 offset:43520
v_mfma_f32_16x16x32_bf16 a[160:163], v[236:239], v[176:179], a[160:163]
v_cvt_pk_bf16_f32 v114, v220, v221
v_cvt_pk_bf16_f32 v115, v222, v223
v_mfma_f32_16x16x32_bf16 a[164:167], v[232:235], v[164:167], a[164:167]
buffer_store_dwordx4 v[112:115], v252, s[20:23], s47 offen offset:0 sc1
v_mfma_f32_16x16x32_bf16 a[164:167], v[236:239], v[180:183], a[164:167]
v_mfma_f32_16x16x32_bf16 a[168:171], v[232:235], v[168:171], a[168:171]
ds_read_b64_tr_b16 v[228:229], v250 offset:57856
ds_read_b64_tr_b16 v[230:231], v250 offset:59904
v_mfma_f32_16x16x32_bf16 a[168:171], v[236:239], v[184:187], a[168:171]
v_mfma_f32_16x16x32_bf16 a[172:175], v[232:235], v[172:175], a[172:175]
v_mfma_f32_16x16x32_bf16 a[172:175], v[236:239], v[188:191], a[172:175]
s_waitcnt lgkmcnt(4)
v_mfma_f32_16x16x32_bf16 a[160:163], v[240:243], v[0:3], a[160:163]
ds_read_b64_tr_b16 v[232:233], v13 offset:8704
ds_read_b64_tr_b16 v[234:235], v13 offset:10752
v_mfma_f32_16x16x32_bf16 a[164:167], v[240:243], v[32:35], a[164:167]
v_mfma_f32_16x16x32_bf16 a[168:171], v[240:243], v[64:67], a[168:171]
v_mfma_f32_16x16x32_bf16 a[172:175], v[240:243], v[96:99], a[172:175]
v_mfma_f32_16x16x32_bf16 a[176:179], v[244:247], v[0:3], a[176:179]
ds_read_b64_tr_b16 v[236:237], v13 offset:25088
ds_read_b64_tr_b16 v[238:239], v13 offset:27136
v_mfma_f32_16x16x32_bf16 a[180:183], v[244:247], v[32:35], a[180:183]
v_accvgpr_read_b32 v192, a160
v_accvgpr_read_b32 v193, a161
v_mfma_f32_16x16x32_bf16 a[184:187], v[244:247], v[64:67], a[184:187]
v_accvgpr_read_b32 v194, a162
v_accvgpr_read_b32 v195, a163
v_mfma_f32_16x16x32_bf16 a[188:191], v[244:247], v[96:99], a[188:191]
s_waitcnt lgkmcnt(4)
v_cvt_pk_bf16_f32 v20, v192, v193
v_mfma_f32_16x16x32_bf16 a[176:179], v[224:227], v[4:7], a[176:179]
ds_read_b64_tr_b16 v[240:241], v13 offset:41472
ds_read_b64_tr_b16 v[242:243], v13 offset:43520
v_mfma_f32_16x16x32_bf16 a[176:179], v[228:231], v[8:11], a[176:179]
v_cvt_pk_bf16_f32 v21, v194, v195
v_accvgpr_read_b32 v200, a164
v_mfma_f32_16x16x32_bf16 a[180:183], v[224:227], v[36:39], a[180:183]
v_accvgpr_read_b32 v201, a165
v_accvgpr_read_b32 v202, a166
v_mfma_f32_16x16x32_bf16 a[180:183], v[228:231], v[40:43], a[180:183]
v_accvgpr_read_b32 v203, a167
v_cvt_pk_bf16_f32 v52, v200, v201
v_mfma_f32_16x16x32_bf16 a[184:187], v[224:227], v[68:71], a[184:187]
ds_read_b64_tr_b16 v[244:245], v13 offset:57856
ds_read_b64_tr_b16 v[246:247], v13 offset:59904
v_mfma_f32_16x16x32_bf16 a[184:187], v[228:231], v[72:75], a[184:187]
v_cvt_pk_bf16_f32 v53, v202, v203
v_accvgpr_read_b32 v208, a168
v_mfma_f32_16x16x32_bf16 a[188:191], v[224:227], v[100:103], a[188:191]
v_accvgpr_read_b32 v209, a169
v_accvgpr_read_b32 v210, a170
v_mfma_f32_16x16x32_bf16 a[188:191], v[228:231], v[104:107], a[188:191]
s_waitcnt lgkmcnt(4)
v_accvgpr_read_b32 v211, a171
v_mfma_f32_16x16x32_bf16 a[176:179], v[232:235], v[128:131], a[176:179]
ds_read_b64_tr_b16 v[224:225], v249 offset:45056
ds_read_b64_tr_b16 v[226:227], v249 offset:47104
v_mfma_f32_16x16x32_bf16 a[176:179], v[236:239], v[144:147], a[176:179]
v_cvt_pk_bf16_f32 v84, v208, v209
v_cvt_pk_bf16_f32 v85, v210, v211
v_mfma_f32_16x16x32_bf16 a[180:183], v[232:235], v[132:135], a[180:183]
v_accvgpr_read_b32 v216, a172
v_accvgpr_read_b32 v217, a173
v_mfma_f32_16x16x32_bf16 a[180:183], v[236:239], v[148:151], a[180:183]
v_accvgpr_read_b32 v218, a174
v_accvgpr_read_b32 v219, a175
v_mfma_f32_16x16x32_bf16 a[184:187], v[232:235], v[136:139], a[184:187]
ds_read_b64_tr_b16 v[228:229], v249 offset:61440
ds_read_b64_tr_b16 v[230:231], v249 offset:63488
v_mfma_f32_16x16x32_bf16 a[184:187], v[236:239], v[152:155], a[184:187]
v_cvt_pk_bf16_f32 v116, v216, v217
v_cvt_pk_bf16_f32 v117, v218, v219
v_mfma_f32_16x16x32_bf16 a[188:191], v[232:235], v[140:143], a[188:191]
v_mfma_f32_16x16x32_bf16 a[188:191], v[236:239], v[156:159], a[188:191]
s_waitcnt lgkmcnt(4)
v_mfma_f32_16x16x32_bf16 a[176:179], v[240:243], v[160:163], a[176:179]
ds_read_b64_tr_b16 v[232:233], v12 offset:12288
ds_read_b64_tr_b16 v[234:235], v12 offset:14336
v_mfma_f32_16x16x32_bf16 a[176:179], v[244:247], v[176:179], a[176:179]
v_mfma_f32_16x16x32_bf16 a[180:183], v[240:243], v[164:167], a[180:183]
v_mfma_f32_16x16x32_bf16 a[180:183], v[244:247], v[180:183], a[180:183]
v_mfma_f32_16x16x32_bf16 a[184:187], v[240:243], v[168:171], a[184:187]
ds_read_b64_tr_b16 v[236:237], v12 offset:28672
ds_read_b64_tr_b16 v[238:239], v12 offset:30720
v_mfma_f32_16x16x32_bf16 a[184:187], v[244:247], v[184:187], a[184:187]
v_mfma_f32_16x16x32_bf16 a[188:191], v[240:243], v[172:175], a[188:191]
s_nop 0
v_accvgpr_read_b32 v196, a176
v_accvgpr_read_b32 v197, a177
v_mfma_f32_16x16x32_bf16 a[188:191], v[244:247], v[188:191], a[188:191]
s_waitcnt lgkmcnt(4)
v_accvgpr_read_b32 v198, a178
v_mfma_f32_16x16x32_bf16 a[192:195], v[224:227], v[4:7], a[192:195]
ds_read_b64_tr_b16 v[240:241], v12 offset:45056
ds_read_b64_tr_b16 v[242:243], v12 offset:47104
v_mfma_f32_16x16x32_bf16 a[192:195], v[228:231], v[8:11], a[192:195]
v_accvgpr_read_b32 v199, a179
v_cvt_pk_bf16_f32 v22, v196, v197
v_mfma_f32_16x16x32_bf16 a[196:199], v[224:227], v[36:39], a[196:199]
v_cvt_pk_bf16_f32 v23, v198, v199
buffer_store_dwordx4 v[20:23], v252, s[20:23], s44 offen offset:1024 sc1
v_mfma_f32_16x16x32_bf16 a[196:199], v[228:231], v[40:43], a[196:199]
v_accvgpr_read_b32 v204, a180
v_accvgpr_read_b32 v205, a181
v_mfma_f32_16x16x32_bf16 a[200:203], v[224:227], v[68:71], a[200:203]
ds_read_b64_tr_b16 v[244:245], v12 offset:61440
ds_read_b64_tr_b16 v[246:247], v12 offset:63488
v_mfma_f32_16x16x32_bf16 a[200:203], v[228:231], v[72:75], a[200:203]
v_accvgpr_read_b32 v206, a182
v_accvgpr_read_b32 v207, a183
v_mfma_f32_16x16x32_bf16 a[204:207], v[224:227], v[100:103], a[204:207]
v_cvt_pk_bf16_f32 v54, v204, v205
v_cvt_pk_bf16_f32 v55, v206, v207
v_mfma_f32_16x16x32_bf16 a[204:207], v[228:231], v[104:107], a[204:207]
s_waitcnt lgkmcnt(4)
buffer_store_dwordx4 v[52:55], v252, s[20:23], s45 offen offset:1024 sc1
v_mfma_f32_16x16x32_bf16 a[192:195], v[232:235], v[128:131], a[192:195]
ds_read_b64_tr_b16 v[224:225], v249 offset:12288
ds_read_b64_tr_b16 v[226:227], v249 offset:14336
v_mfma_f32_16x16x32_bf16 a[192:195], v[236:239], v[144:147], a[192:195]
v_accvgpr_read_b32 v212, a184
v_accvgpr_read_b32 v213, a185
v_mfma_f32_16x16x32_bf16 a[196:199], v[232:235], v[132:135], a[196:199]
v_accvgpr_read_b32 v214, a186
v_accvgpr_read_b32 v215, a187
v_mfma_f32_16x16x32_bf16 a[196:199], v[236:239], v[148:151], a[196:199]
v_cvt_pk_bf16_f32 v86, v212, v213
v_cvt_pk_bf16_f32 v87, v214, v215
v_mfma_f32_16x16x32_bf16 a[200:203], v[232:235], v[136:139], a[200:203]
ds_read_b64_tr_b16 v[228:229], v250 offset:12288
ds_read_b64_tr_b16 v[230:231], v250 offset:14336
v_mfma_f32_16x16x32_bf16 a[200:203], v[236:239], v[152:155], a[200:203]
buffer_store_dwordx4 v[84:87], v252, s[20:23], s46 offen offset:1024 sc1
v_accvgpr_read_b32 v220, a188
v_mfma_f32_16x16x32_bf16 a[204:207], v[232:235], v[140:143], a[204:207]
v_accvgpr_read_b32 v221, a189
v_accvgpr_read_b32 v222, a190
v_mfma_f32_16x16x32_bf16 a[204:207], v[236:239], v[156:159], a[204:207]
s_waitcnt lgkmcnt(4)
v_accvgpr_read_b32 v223, a191
v_mfma_f32_16x16x32_bf16 a[192:195], v[240:243], v[160:163], a[192:195]
ds_read_b64_tr_b16 v[232:233], v250 offset:45056
ds_read_b64_tr_b16 v[234:235], v250 offset:47104
v_mfma_f32_16x16x32_bf16 a[192:195], v[244:247], v[176:179], a[192:195]
v_cvt_pk_bf16_f32 v118, v220, v221
v_cvt_pk_bf16_f32 v119, v222, v223
v_mfma_f32_16x16x32_bf16 a[196:199], v[240:243], v[164:167], a[196:199]
buffer_store_dwordx4 v[116:119], v252, s[20:23], s47 offen offset:1024 sc1
v_mfma_f32_16x16x32_bf16 a[196:199], v[244:247], v[180:183], a[196:199]
v_mfma_f32_16x16x32_bf16 a[200:203], v[240:243], v[168:171], a[200:203]
ds_read_b64_tr_b16 v[236:237], v250 offset:61440
ds_read_b64_tr_b16 v[238:239], v250 offset:63488
v_mfma_f32_16x16x32_bf16 a[200:203], v[244:247], v[184:187], a[200:203]
v_mfma_f32_16x16x32_bf16 a[204:207], v[240:243], v[172:175], a[204:207]
v_mfma_f32_16x16x32_bf16 a[204:207], v[244:247], v[188:191], a[204:207]
s_waitcnt lgkmcnt(4)
v_mfma_f32_16x16x32_bf16 a[192:195], v[224:227], v[0:3], a[192:195]
ds_read_b64_tr_b16 v[240:241], v13 offset:12288
ds_read_b64_tr_b16 v[242:243], v13 offset:14336
v_mfma_f32_16x16x32_bf16 a[196:199], v[224:227], v[32:35], a[196:199]
v_mfma_f32_16x16x32_bf16 a[200:203], v[224:227], v[64:67], a[200:203]
v_mfma_f32_16x16x32_bf16 a[204:207], v[224:227], v[96:99], a[204:207]
v_mfma_f32_16x16x32_bf16 a[208:211], v[228:231], v[0:3], a[208:211]
ds_read_b64_tr_b16 v[244:245], v13 offset:28672
ds_read_b64_tr_b16 v[246:247], v13 offset:30720
v_mfma_f32_16x16x32_bf16 a[212:215], v[228:231], v[32:35], a[212:215]
v_accvgpr_read_b32 v192, a192
v_accvgpr_read_b32 v193, a193
v_mfma_f32_16x16x32_bf16 a[216:219], v[228:231], v[64:67], a[216:219]
v_accvgpr_read_b32 v194, a194
v_accvgpr_read_b32 v195, a195
v_mfma_f32_16x16x32_bf16 a[220:223], v[228:231], v[96:99], a[220:223]
s_waitcnt lgkmcnt(4)
v_cvt_pk_bf16_f32 v24, v192, v193
v_mfma_f32_16x16x32_bf16 a[208:211], v[232:235], v[4:7], a[208:211]
ds_read_b64_tr_b16 v[224:225], v13 offset:45056
ds_read_b64_tr_b16 v[226:227], v13 offset:47104
v_mfma_f32_16x16x32_bf16 a[208:211], v[236:239], v[8:11], a[208:211]
v_cvt_pk_bf16_f32 v25, v194, v195
v_accvgpr_read_b32 v200, a196
v_mfma_f32_16x16x32_bf16 a[212:215], v[232:235], v[36:39], a[212:215]
v_accvgpr_read_b32 v201, a197
v_accvgpr_read_b32 v202, a198
v_mfma_f32_16x16x32_bf16 a[212:215], v[236:239], v[40:43], a[212:215]
v_accvgpr_read_b32 v203, a199
v_cvt_pk_bf16_f32 v56, v200, v201
v_mfma_f32_16x16x32_bf16 a[216:219], v[232:235], v[68:71], a[216:219]
ds_read_b64_tr_b16 v[228:229], v13 offset:61440
ds_read_b64_tr_b16 v[230:231], v13 offset:63488
v_mfma_f32_16x16x32_bf16 a[216:219], v[236:239], v[72:75], a[216:219]
v_cvt_pk_bf16_f32 v57, v202, v203
v_accvgpr_read_b32 v208, a200
v_mfma_f32_16x16x32_bf16 a[220:223], v[232:235], v[100:103], a[220:223]
v_accvgpr_read_b32 v209, a201
v_accvgpr_read_b32 v210, a202
v_mfma_f32_16x16x32_bf16 a[220:223], v[236:239], v[104:107], a[220:223]
s_waitcnt lgkmcnt(4)
v_accvgpr_read_b32 v211, a203
v_mfma_f32_16x16x32_bf16 a[208:211], v[240:243], v[128:131], a[208:211]
ds_read_b64_tr_b16 v[232:233], v249 offset:45568
ds_read_b64_tr_b16 v[234:235], v249 offset:47616
v_mfma_f32_16x16x32_bf16 a[208:211], v[244:247], v[144:147], a[208:211]
v_cvt_pk_bf16_f32 v88, v208, v209
v_cvt_pk_bf16_f32 v89, v210, v211
v_mfma_f32_16x16x32_bf16 a[212:215], v[240:243], v[132:135], a[212:215]
v_accvgpr_read_b32 v216, a204
v_accvgpr_read_b32 v217, a205
v_mfma_f32_16x16x32_bf16 a[212:215], v[244:247], v[148:151], a[212:215]
v_accvgpr_read_b32 v218, a206
v_accvgpr_read_b32 v219, a207
v_mfma_f32_16x16x32_bf16 a[216:219], v[240:243], v[136:139], a[216:219]
ds_read_b64_tr_b16 v[236:237], v249 offset:61952
ds_read_b64_tr_b16 v[238:239], v249 offset:64000
v_mfma_f32_16x16x32_bf16 a[216:219], v[244:247], v[152:155], a[216:219]
v_cvt_pk_bf16_f32 v120, v216, v217
v_cvt_pk_bf16_f32 v121, v218, v219
v_mfma_f32_16x16x32_bf16 a[220:223], v[240:243], v[140:143], a[220:223]
v_mfma_f32_16x16x32_bf16 a[220:223], v[244:247], v[156:159], a[220:223]
s_waitcnt lgkmcnt(4)
v_mfma_f32_16x16x32_bf16 a[208:211], v[224:227], v[160:163], a[208:211]
ds_read_b64_tr_b16 v[240:241], v12 offset:12800
ds_read_b64_tr_b16 v[242:243], v12 offset:14848
v_mfma_f32_16x16x32_bf16 a[208:211], v[228:231], v[176:179], a[208:211]
v_mfma_f32_16x16x32_bf16 a[212:215], v[224:227], v[164:167], a[212:215]
v_mfma_f32_16x16x32_bf16 a[212:215], v[228:231], v[180:183], a[212:215]
v_mfma_f32_16x16x32_bf16 a[216:219], v[224:227], v[168:171], a[216:219]
ds_read_b64_tr_b16 v[244:245], v12 offset:29184
ds_read_b64_tr_b16 v[246:247], v12 offset:31232
v_mfma_f32_16x16x32_bf16 a[216:219], v[228:231], v[184:187], a[216:219]
v_mfma_f32_16x16x32_bf16 a[220:223], v[224:227], v[172:175], a[220:223]
s_nop 0
v_accvgpr_read_b32 v196, a208
v_accvgpr_read_b32 v197, a209
v_mfma_f32_16x16x32_bf16 a[220:223], v[228:231], v[188:191], a[220:223]
s_waitcnt lgkmcnt(4)
v_accvgpr_read_b32 v198, a210
v_mfma_f32_16x16x32_bf16 a[224:227], v[232:235], v[4:7], a[224:227]
ds_read_b64_tr_b16 v[224:225], v12 offset:45568
ds_read_b64_tr_b16 v[226:227], v12 offset:47616
v_mfma_f32_16x16x32_bf16 a[224:227], v[236:239], v[8:11], a[224:227]
v_accvgpr_read_b32 v199, a211
v_cvt_pk_bf16_f32 v26, v196, v197
v_mfma_f32_16x16x32_bf16 a[228:231], v[232:235], v[36:39], a[228:231]
v_cvt_pk_bf16_f32 v27, v198, v199
buffer_store_dwordx4 v[24:27], v252, s[20:23], s44 offen offset:2048 sc1
v_mfma_f32_16x16x32_bf16 a[228:231], v[236:239], v[40:43], a[228:231]
v_accvgpr_read_b32 v204, a212
v_accvgpr_read_b32 v205, a213
v_mfma_f32_16x16x32_bf16 a[232:235], v[232:235], v[68:71], a[232:235]
ds_read_b64_tr_b16 v[228:229], v12 offset:61952
ds_read_b64_tr_b16 v[230:231], v12 offset:64000
v_mfma_f32_16x16x32_bf16 a[232:235], v[236:239], v[72:75], a[232:235]
v_accvgpr_read_b32 v206, a214
v_accvgpr_read_b32 v207, a215
v_mfma_f32_16x16x32_bf16 a[236:239], v[232:235], v[100:103], a[236:239]
v_cvt_pk_bf16_f32 v58, v204, v205
v_cvt_pk_bf16_f32 v59, v206, v207
v_mfma_f32_16x16x32_bf16 a[236:239], v[236:239], v[104:107], a[236:239]
s_waitcnt lgkmcnt(4)
buffer_store_dwordx4 v[56:59], v252, s[20:23], s45 offen offset:2048 sc1
v_mfma_f32_16x16x32_bf16 a[224:227], v[240:243], v[128:131], a[224:227]
ds_read_b64_tr_b16 v[232:233], v249 offset:12800
ds_read_b64_tr_b16 v[234:235], v249 offset:14848
v_mfma_f32_16x16x32_bf16 a[224:227], v[244:247], v[144:147], a[224:227]
v_accvgpr_read_b32 v212, a216
v_accvgpr_read_b32 v213, a217
v_mfma_f32_16x16x32_bf16 a[228:231], v[240:243], v[132:135], a[228:231]
v_accvgpr_read_b32 v214, a218
v_accvgpr_read_b32 v215, a219
v_mfma_f32_16x16x32_bf16 a[228:231], v[244:247], v[148:151], a[228:231]
v_cvt_pk_bf16_f32 v90, v212, v213
v_cvt_pk_bf16_f32 v91, v214, v215
v_mfma_f32_16x16x32_bf16 a[232:235], v[240:243], v[136:139], a[232:235]
ds_read_b64_tr_b16 v[236:237], v250 offset:12800
ds_read_b64_tr_b16 v[238:239], v250 offset:14848
v_mfma_f32_16x16x32_bf16 a[232:235], v[244:247], v[152:155], a[232:235]
buffer_store_dwordx4 v[88:91], v252, s[20:23], s46 offen offset:2048 sc1
v_accvgpr_read_b32 v220, a220
v_mfma_f32_16x16x32_bf16 a[236:239], v[240:243], v[140:143], a[236:239]
v_accvgpr_read_b32 v221, a221
v_accvgpr_read_b32 v222, a222
v_mfma_f32_16x16x32_bf16 a[236:239], v[244:247], v[156:159], a[236:239]
s_waitcnt lgkmcnt(4)
v_accvgpr_read_b32 v223, a223
v_mfma_f32_16x16x32_bf16 a[224:227], v[224:227], v[160:163], a[224:227]
ds_read_b64_tr_b16 v[240:241], v250 offset:45568
ds_read_b64_tr_b16 v[242:243], v250 offset:47616
v_mfma_f32_16x16x32_bf16 a[224:227], v[228:231], v[176:179], a[224:227]
v_cvt_pk_bf16_f32 v122, v220, v221
v_cvt_pk_bf16_f32 v123, v222, v223
v_mfma_f32_16x16x32_bf16 a[228:231], v[224:227], v[164:167], a[228:231]
buffer_store_dwordx4 v[120:123], v252, s[20:23], s47 offen offset:2048 sc1
v_mfma_f32_16x16x32_bf16 a[228:231], v[228:231], v[180:183], a[228:231]
v_mfma_f32_16x16x32_bf16 a[232:235], v[224:227], v[168:171], a[232:235]
ds_read_b64_tr_b16 v[244:245], v250 offset:61952
ds_read_b64_tr_b16 v[246:247], v250 offset:64000
v_mfma_f32_16x16x32_bf16 a[232:235], v[228:231], v[184:187], a[232:235]
v_mfma_f32_16x16x32_bf16 a[236:239], v[224:227], v[172:175], a[236:239]
v_mfma_f32_16x16x32_bf16 a[236:239], v[228:231], v[188:191], a[236:239]
s_waitcnt lgkmcnt(4)
v_mfma_f32_16x16x32_bf16 a[224:227], v[232:235], v[0:3], a[224:227]
ds_read_b64_tr_b16 v[224:225], v13 offset:12800
ds_read_b64_tr_b16 v[226:227], v13 offset:14848
v_mfma_f32_16x16x32_bf16 a[228:231], v[232:235], v[32:35], a[228:231]
v_mfma_f32_16x16x32_bf16 a[232:235], v[232:235], v[64:67], a[232:235]
v_mfma_f32_16x16x32_bf16 a[236:239], v[232:235], v[96:99], a[236:239]
v_mfma_f32_16x16x32_bf16 a[240:243], v[236:239], v[0:3], a[240:243]
ds_read_b64_tr_b16 v[228:229], v13 offset:29184
ds_read_b64_tr_b16 v[230:231], v13 offset:31232
v_mfma_f32_16x16x32_bf16 a[244:247], v[236:239], v[32:35], a[244:247]
v_accvgpr_read_b32 v192, a224
v_accvgpr_read_b32 v193, a225
v_mfma_f32_16x16x32_bf16 a[248:251], v[236:239], v[64:67], a[248:251]
v_accvgpr_read_b32 v194, a226
v_accvgpr_read_b32 v195, a227
v_mfma_f32_16x16x32_bf16 a[252:255], v[236:239], v[96:99], a[252:255]
s_waitcnt lgkmcnt(4)
v_cvt_pk_bf16_f32 v28, v192, v193
v_mfma_f32_16x16x32_bf16 a[240:243], v[240:243], v[4:7], a[240:243]
ds_read_b64_tr_b16 v[232:233], v13 offset:45568
ds_read_b64_tr_b16 v[234:235], v13 offset:47616
v_mfma_f32_16x16x32_bf16 a[240:243], v[244:247], v[8:11], a[240:243]
v_cvt_pk_bf16_f32 v29, v194, v195
v_accvgpr_read_b32 v200, a228
v_mfma_f32_16x16x32_bf16 a[244:247], v[240:243], v[36:39], a[244:247]
v_accvgpr_read_b32 v201, a229
v_accvgpr_read_b32 v202, a230
v_mfma_f32_16x16x32_bf16 a[244:247], v[244:247], v[40:43], a[244:247]
v_accvgpr_read_b32 v203, a231
v_cvt_pk_bf16_f32 v60, v200, v201
v_mfma_f32_16x16x32_bf16 a[248:251], v[240:243], v[68:71], a[248:251]
ds_read_b64_tr_b16 v[236:237], v13 offset:61952
ds_read_b64_tr_b16 v[238:239], v13 offset:64000
v_mfma_f32_16x16x32_bf16 a[248:251], v[244:247], v[72:75], a[248:251]
v_cvt_pk_bf16_f32 v61, v202, v203
v_accvgpr_read_b32 v208, a232
v_mfma_f32_16x16x32_bf16 a[252:255], v[240:243], v[100:103], a[252:255]
v_accvgpr_read_b32 v209, a233
v_accvgpr_read_b32 v210, a234
v_mfma_f32_16x16x32_bf16 a[252:255], v[244:247], v[104:107], a[252:255]
s_waitcnt lgkmcnt(4)
v_accvgpr_read_b32 v211, a235
v_mfma_f32_16x16x32_bf16 a[240:243], v[224:227], v[128:131], a[240:243]
v_cvt_pk_bf16_f32 v92, v208, v209
v_cvt_pk_bf16_f32 v93, v210, v211
v_mfma_f32_16x16x32_bf16 a[240:243], v[228:231], v[144:147], a[240:243]
v_accvgpr_read_b32 v216, a236
v_accvgpr_read_b32 v217, a237
v_mfma_f32_16x16x32_bf16 a[244:247], v[224:227], v[132:135], a[244:247]
v_accvgpr_read_b32 v218, a238
v_accvgpr_read_b32 v219, a239
v_mfma_f32_16x16x32_bf16 a[244:247], v[228:231], v[148:151], a[244:247]
v_cvt_pk_bf16_f32 v124, v216, v217
v_cvt_pk_bf16_f32 v125, v218, v219
v_mfma_f32_16x16x32_bf16 a[248:251], v[224:227], v[136:139], a[248:251]
v_mfma_f32_16x16x32_bf16 a[248:251], v[228:231], v[152:155], a[248:251]
v_mfma_f32_16x16x32_bf16 a[252:255], v[224:227], v[140:143], a[252:255]
v_mfma_f32_16x16x32_bf16 a[252:255], v[228:231], v[156:159], a[252:255]
s_waitcnt lgkmcnt(0)
v_mfma_f32_16x16x32_bf16 a[240:243], v[232:235], v[160:163], a[240:243]
v_mfma_f32_16x16x32_bf16 a[240:243], v[236:239], v[176:179], a[240:243]
v_mfma_f32_16x16x32_bf16 a[244:247], v[232:235], v[164:167], a[244:247]
v_mfma_f32_16x16x32_bf16 a[244:247], v[236:239], v[180:183], a[244:247]
v_mfma_f32_16x16x32_bf16 a[248:251], v[232:235], v[168:171], a[248:251]
v_mfma_f32_16x16x32_bf16 a[248:251], v[236:239], v[184:187], a[248:251]
v_mfma_f32_16x16x32_bf16 a[252:255], v[232:235], v[172:175], a[252:255]
s_nop 2
v_accvgpr_read_b32 v196, a240
v_accvgpr_read_b32 v197, a241
v_accvgpr_read_b32 v198, a242
v_accvgpr_read_b32 v199, a243
v_mfma_f32_16x16x32_bf16 a[252:255], v[236:239], v[188:191], a[252:255]
v_cvt_pk_bf16_f32 v30, v196, v197
v_cvt_pk_bf16_f32 v31, v198, v199
buffer_store_dwordx4 v[28:31], v252, s[20:23], s44 offen offset:3072 sc1
v_accvgpr_read_b32 v204, a244
v_accvgpr_read_b32 v205, a245
v_accvgpr_read_b32 v206, a246
v_accvgpr_read_b32 v207, a247
v_cvt_pk_bf16_f32 v62, v204, v205
v_cvt_pk_bf16_f32 v63, v206, v207
buffer_store_dwordx4 v[60:63], v252, s[20:23], s45 offen offset:3072 sc1
v_accvgpr_read_b32 v212, a248
v_accvgpr_read_b32 v213, a249
v_accvgpr_read_b32 v214, a250
v_accvgpr_read_b32 v215, a251
v_cvt_pk_bf16_f32 v94, v212, v213
v_cvt_pk_bf16_f32 v95, v214, v215
buffer_store_dwordx4 v[92:95], v252, s[20:23], s46 offen offset:3072 sc1
v_accvgpr_read_b32 v220, a252
v_accvgpr_read_b32 v221, a253
v_accvgpr_read_b32 v222, a254
v_accvgpr_read_b32 v223, a255
v_cvt_pk_bf16_f32 v126, v220, v221
v_cvt_pk_bf16_f32 v127, v222, v223
buffer_store_dwordx4 v[124:127], v252, s[20:23], s47 offen offset:3072 sc1
s_branch L2_chk
L2_chk:
s_or_b64 vcc, vcc, s[50:51]
s_barrier
s_cbranch_vccz L2_fin
s_waitcnt vmcnt(0)
v_bfe_u32 v248, v252, 4, 3
v_lshlrev_b32 v248, 6, v248
v_bfe_u32 v253, v252, 7, 1
v_lshl_or_b32 v248, v253, 10, v248
v_bfe_u32 v253, v252, 8, 2
v_lshl_or_b32 v248, v253, 4, v248
v_bfe_u32 v253, v252, 6, 1
v_lshlrev_b32 v253, 5, v253
v_xor_b32 v248, v248, v253
v_and_b32 v249, 0x1c0, v252
v_bfe_u32 v253, v252, 9, 1
v_lshl_or_b32 v249, v253, 10, v249
v_bfe_u32 v253, v252, 8, 1
v_lshl_or_b32 v249, v253, 5, v249
v_bfe_u32 v253, v252, 4, 2
v_lshl_or_b32 v249, v253, 3, v249
v_xor_b32 v250, 32, v249
v_and_b32 v251, 0xfffffe7f, v251
s_mul_i32 s36, s34, 0xa000
s_mov_b32 s56, s36
s_add_u32 s57, s56, 32768
s_mov_b32 s55, 4
v_bfe_i32 v188, v252, 8, 1
LS_q:
s_add_u32 s44, s40, 4096
buffer_load_dwordx4 v[0:3], v252, s[8:11], s40 offen offset:0
buffer_load_dwordx4 v[4:7], v252, s[8:11], s40 offen offset:1024
buffer_load_dwordx4 v[8:11], v252, s[8:11], s40 offen offset:2048
buffer_load_dwordx4 v[12:15], v252, s[8:11], s40 offen offset:3072
buffer_load_dwordx4 v[16:19], v252, s[8:11], s44 offen offset:0
buffer_load_dwordx4 v[20:23], v252, s[8:11], s44 offen offset:1024
buffer_load_dwordx4 v[24:27], v252, s[8:11], s44 offen offset:2048
buffer_load_dwordx4 v[28:31], v252, s[8:11], s44 offen offset:3072
s_mov_b32 s53, s56
s_mov_b32 s58, s39
s_add_u32 m0, s53, 0
s_add_u32 s54, s58, 0
buffer_load_dwordx4 v251, s[12:15], s54 offen offset:0 lds
buffer_load_dwordx4 v251, s[12:15], s54 offen offset:1024 lds
buffer_load_dwordx4 v251, s[12:15], s54 offen offset:2048 lds
buffer_load_dwordx4 v251, s[12:15], s54 offen offset:3072 lds
s_add_u32 m0, s53, 4096
s_add_u32 s54, s58, 128
buffer_load_dwordx4 v251, s[12:15], s54 offen offset:0 lds
buffer_load_dwordx4 v251, s[12:15], s54 offen offset:1024 lds
buffer_load_dwordx4 v251, s[12:15], s54 offen offset:2048 lds
buffer_load_dwordx4 v251, s[12:15], s54 offen offset:3072 lds
s_add_u32 m0, s53, 8192
s_add_u32 s54, s58, 256
buffer_load_dwordx4 v251, s[12:15], s54 offen offset:0 lds
buffer_load_dwordx4 v251, s[12:15], s54 offen offset:1024 lds
buffer_load_dwordx4 v251, s[12:15], s54 offen offset:2048 lds
buffer_load_dwordx4 v251, s[12:15], s54 offen offset:3072 lds
s_add_u32 m0, s53, 12288
s_add_u32 s54, s58, 384
buffer_load_dwordx4 v251, s[12:15], s54 offen offset:0 lds
buffer_load_dwordx4 v251, s[12:15], s54 offen offset:1024 lds
buffer_load_dwordx4 v251, s[12:15], s54 offen offset:2048 lds
buffer_load_dwordx4 v251, s[12:15], s54 offen offset:3072 lds
s_add_u32 s53, s53, 0x4000
s_cmp_eq_u32 s53, s57
s_cselect_b32 s53, s56, s53
s_add_u32 s58, s58, 0x4000
s_mov_b32 s51, s29
s_mov_b32 s52, s56
v_mov_b32 v172, 0xff800000
v_accvgpr_write_b32 a0, 0
v_accvgpr_write_b32 a1, 0
v_accvgpr_write_b32 a2, 0
v_accvgpr_write_b32 a3, 0
v_accvgpr_write_b32 a4, 0
v_accvgpr_write_b32 a5, 0
v_accvgpr_write_b32 a6, 0
v_accvgpr_write_b32 a7, 0
v_accvgpr_write_b32 a8, 0
v_accvgpr_write_b32 a9, 0
v_accvgpr_write_b32 a10, 0
v_accvgpr_write_b32 a11, 0
v_accvgpr_write_b32 a12, 0
v_accvgpr_write_b32 a13, 0
v_accvgpr_write_b32 a14, 0
v_accvgpr_write_b32 a15, 0
v_accvgpr_write_b32 a16, 0
v_accvgpr_write_b32 a17, 0
v_accvgpr_write_b32 a18, 0
v_accvgpr_write_b32 a19, 0
v_accvgpr_write_b32 a20, 0
v_accvgpr_write_b32 a21, 0
v_accvgpr_write_b32 a22, 0
v_accvgpr_write_b32 a23, 0
v_accvgpr_write_b32 a24, 0
v_accvgpr_write_b32 a25, 0
v_accvgpr_write_b32 a26, 0
v_accvgpr_write_b32 a27, 0
v_accvgpr_write_b32 a28, 0
v_accvgpr_write_b32 a29, 0
v_accvgpr_write_b32 a30, 0
v_accvgpr_write_b32 a31, 0
v_accvgpr_write_b32 a32, 0
v_accvgpr_write_b32 a33, 0
v_accvgpr_write_b32 a34, 0
v_accvgpr_write_b32 a35, 0
v_accvgpr_write_b32 a36, 0
v_accvgpr_write_b32 a37, 0
v_accvgpr_write_b32 a38, 0
v_accvgpr_write_b32 a39, 0
v_accvgpr_write_b32 a40, 0
v_accvgpr_write_b32 a41, 0
v_accvgpr_write_b32 a42, 0
v_accvgpr_write_b32 a43, 0
v_accvgpr_write_b32 a44, 0
v_accvgpr_write_b32 a45, 0
v_accvgpr_write_b32 a46, 0
v_accvgpr_write_b32 a47, 0
v_accvgpr_write_b32 a48, 0
v_accvgpr_write_b32 a49, 0
v_accvgpr_write_b32 a50, 0
v_accvgpr_write_b32 a51, 0
v_accvgpr_write_b32 a52, 0
v_accvgpr_write_b32 a53, 0
v_accvgpr_write_b32 a54, 0
v_accvgpr_write_b32 a55, 0
v_accvgpr_write_b32 a56, 0
v_accvgpr_write_b32 a57, 0
v_accvgpr_write_b32 a58, 0
v_accvgpr_write_b32 a59, 0
v_accvgpr_write_b32 a60, 0
v_accvgpr_write_b32 a61, 0
v_accvgpr_write_b32 a62, 0
v_accvgpr_write_b32 a63, 0
LS_loop:
s_add_u32 m0, s53, 0
s_add_u32 s54, s58, 0
buffer_load_dwordx4 v251, s[12:15], s54 offen offset:0 lds
buffer_load_dwordx4 v251, s[12:15], s54 offen offset:1024 lds
buffer_load_dwordx4 v251, s[12:15], s54 offen offset:2048 lds
buffer_load_dwordx4 v251, s[12:15], s54 offen offset:3072 lds
s_add_u32 m0, s53, 4096
s_add_u32 s54, s58, 128
buffer_load_dwordx4 v251, s[12:15], s54 offen offset:0 lds
buffer_load_dwordx4 v251, s[12:15], s54 offen offset:1024 lds
buffer_load_dwordx4 v251, s[12:15], s54 offen offset:2048 lds
buffer_load_dwordx4 v251, s[12:15], s54 offen offset:3072 lds
s_add_u32 m0, s53, 8192
s_add_u32 s54, s58, 256
buffer_load_dwordx4 v251, s[12:15], s54 offen offset:0 lds
buffer_load_dwordx4 v251, s[12:15], s54 offen offset:1024 lds
buffer_load_dwordx4 v251, s[12:15], s54 offen offset:2048 lds
buffer_load_dwordx4 v251, s[12:15], s54 offen offset:3072 lds
s_add_u32 m0, s53, 12288
s_add_u32 s54, s58, 384
buffer_load_dwordx4 v251, s[12:15], s54 offen offset:0 lds
buffer_load_dwordx4 v251, s[12:15], s54 offen offset:1024 lds
buffer_load_dwordx4 v251, s[12:15], s54 offen offset:2048 lds
buffer_load_dwordx4 v251, s[12:15], s54 offen offset:3072 lds
s_add_u32 s53, s53, 0x4000
s_cmp_eq_u32 s53, s57
s_cselect_b32 s53, s56, s53
s_add_u32 s58, s58, 0x4000
v_add_u32 v177, s52, v248
v_add_u32 v178, s52, v249
v_add_u32 v179, s52, v250
s_add_u32 s52, s52, 0x4000
s_cmp_eq_u32 s52, s57
s_cselect_b32 s52, s56, s52
s_cmp_eq_u32 s51, 1
s_cselect_b32 s54, s33, 0
v_and_b32 v192, s54, v188
v_and_b32 v193, s54, v188
v_and_b32 v194, s54, v188
v_and_b32 v195, s54, v188
s_waitcnt vmcnt(16)
ds_read_b128 v[32:35], v177 offset:0
ds_read_b128 v[64:67], v177 offset:2048
ds_read_b128 v[36:39], v177 offset:512
ds_read_b128 v[68:71], v177 offset:2560
ds_read_b128 v[40:43], v177 offset:4096
ds_read_b128 v[72:75], v177 offset:6144
ds_read_b128 v[44:47], v177 offset:4608
ds_read_b128 v[76:79], v177 offset:6656
ds_read_b128 v[48:51], v177 offset:8192
ds_read_b128 v[80:83], v177 offset:10240
ds_read_b128 v[52:55], v177 offset:8704
ds_read_b128 v[84:87], v177 offset:10752
ds_read_b128 v[56:59], v177 offset:12288
ds_read_b128 v[88:91], v177 offset:14336
ds_read_b128 v[60:63], v177 offset:12800
ds_read_b128 v[92:95], v177 offset:14848
s_waitcnt lgkmcnt(14)
v_mfma_f32_16x16x32_bf16 v[160:163], v[32:35], v[0:3], v[192:195]
v_mfma_f32_16x16x32_bf16 v[164:167], v[64:67], v[0:3], v[192:195]
s_waitcnt lgkmcnt(12)
v_mfma_f32_16x16x32_bf16 v[160:163], v[36:39], v[4:7], v[160:163]
v_mfma_f32_16x16x32_bf16 v[164:167], v[68:71], v[4:7], v[164:167]
s_waitcnt lgkmcnt(10)
v_mfma_f32_16x16x32_bf16 v[160:163], v[40:43], v[8:11], v[160:163]
v_mfma_f32_16x16x32_bf16 v[164:167], v[72:75], v[8:11], v[164:167]
s_waitcnt lgkmcnt(8)
v_mfma_f32_16x16x32_bf16 v[160:163], v[44:47], v[12:15], v[160:163]
v_mfma_f32_16x16x32_bf16 v[164:167], v[76:79], v[12:15], v[164:167]
s_waitcnt lgkmcnt(6)
v_mfma_f32_16x16x32_bf16 v[160:163], v[48:51], v[16:19], v[160:163]
v_mfma_f32_16x16x32_bf16 v[164:167], v[80:83], v[16:19], v[164:167]
s_waitcnt lgkmcnt(4)
v_mfma_f32_16x16x32_bf16 v[160:163], v[52:55], v[20:23], v[160:163]
v_mfma_f32_16x16x32_bf16 v[164:167], v[84:87], v[20:23], v[164:167]
s_waitcnt lgkmcnt(2)
v_mfma_f32_16x16x32_bf16 v[160:163], v[56:59], v[24:27], v[160:163]
v_mfma_f32_16x16x32_bf16 v[164:167], v[88:91], v[24:27], v[164:167]
s_waitcnt lgkmcnt(0)
v_mfma_f32_16x16x32_bf16 v[160:163], v[60:63], v[28:31], v[160:163]
v_mfma_f32_16x16x32_bf16 v[164:167], v[92:95], v[28:31], v[164:167]
ds_read_b64_tr_b16 v[96:97], v178 offset:0
ds_read_b64_tr_b16 v[98:99], v178 offset:2048
ds_read_b64_tr_b16 v[100:101], v179 offset:0
ds_read_b64_tr_b16 v[102:103], v179 offset:2048
ds_read_b64_tr_b16 v[104:105], v178 offset:512
ds_read_b64_tr_b16 v[106:107], v178 offset:2560
ds_read_b64_tr_b16 v[108:109], v179 offset:512
ds_read_b64_tr_b16 v[110:111], v179 offset:2560
ds_read_b64_tr_b16 v[112:113], v178 offset:4096
ds_read_b64_tr_b16 v[114:115], v178 offset:6144
ds_read_b64_tr_b16 v[116:117], v179 offset:4096
ds_read_b64_tr_b16 v[118:119], v179 offset:6144
ds_read_b64_tr_b16 v[120:121], v178 offset:4608
ds_read_b64_tr_b16 v[122:123], v178 offset:6656
ds_read_b64_tr_b16 v[124:125], v179 offset:4608
ds_read_b64_tr_b16 v[126:127], v179 offset:6656
ds_read_b64_tr_b16 v[128:129], v178 offset:8192
ds_read_b64_tr_b16 v[130:131], v178 offset:10240
ds_read_b64_tr_b16 v[132:133], v179 offset:8192
ds_read_b64_tr_b16 v[134:135], v179 offset:10240
ds_read_b64_tr_b16 v[136:137], v178 offset:8704
ds_read_b64_tr_b16 v[138:139], v178 offset:10752
ds_read_b64_tr_b16 v[140:141], v179 offset:8704
ds_read_b64_tr_b16 v[142:143], v179 offset:10752
ds_read_b64_tr_b16 v[144:145], v178 offset:12288
ds_read_b64_tr_b16 v[146:147], v178 offset:14336
ds_read_b64_tr_b16 v[148:149], v179 offset:12288
ds_read_b64_tr_b16 v[150:151], v179 offset:14336
ds_read_b64_tr_b16 v[152:153], v178 offset:12800
ds_read_b64_tr_b16 v[154:155], v178 offset:14848
ds_read_b64_tr_b16 v[156:157], v179 offset:12800
ds_read_b64_tr_b16 v[158:159], v179 offset:14848
s_nop 7
v_max3_f32 v175, v160, v161, v162
v_max3_f32 v175, v175, v163, v164
v_max3_f32 v175, v175, v165, v166
v_max3_f32 v175, v175, v167, v172
v_mov_b32 v176, v175
s_nop 1
v_permlane32_swap_b32 v175, v176
s_nop 1
v_max_f32 v175, v175, v176
v_mov_b32 v176, v175
s_nop 1
v_permlane16_swap_b32 v175, v176
s_nop 1
v_max_f32 v175, v175, v176
v_sub_f32 v174, v172, v175
v_exp_f32 v174, v174
v_mov_b32 v172, v175
v_sub_f32 v160, v160, v172
v_sub_f32 v161, v161, v172
v_sub_f32 v162, v162, v172
v_sub_f32 v163, v163, v172
v_sub_f32 v164, v164, v172
v_sub_f32 v165, v165, v172
v_sub_f32 v166, v166, v172
v_sub_f32 v167, v167, v172
v_exp_f32 v160, v160
v_exp_f32 v161, v161
v_exp_f32 v162, v162
v_exp_f32 v163, v163
v_exp_f32 v164, v164
v_exp_f32 v165, v165
v_exp_f32 v166, v166
v_exp_f32 v167, v167
v_cmp_neq_f32 vcc, 1.0, v174
v_cvt_pk_bf16_f32 v168, v160, v161
v_cvt_pk_bf16_f32 v169, v162, v163
v_cvt_pk_bf16_f32 v170, v164, v165
v_cvt_pk_bf16_f32 v171, v166, v167
s_cbranch_vccz LS_nors
v_accvgpr_read_b32 v180, a0
v_accvgpr_read_b32 v181, a1
v_accvgpr_read_b32 v182, a2
v_accvgpr_read_b32 v183, a3
v_accvgpr_read_b32 v184, a4
v_accvgpr_read_b32 v185, a5
v_accvgpr_read_b32 v186, a6
v_accvgpr_read_b32 v187, a7
v_mul_f32 v180, v180, v174
v_mul_f32 v181, v181, v174
v_mul_f32 v182, v182, v174
v_mul_f32 v183, v183, v174
v_mul_f32 v184, v184, v174
v_mul_f32 v185, v185, v174
v_mul_f32 v186, v186, v174
v_mul_f32 v187, v187, v174
v_accvgpr_write_b32 a0, v180
v_accvgpr_write_b32 a1, v181
v_accvgpr_write_b32 a2, v182
v_accvgpr_write_b32 a3, v183
v_accvgpr_write_b32 a4, v184
v_accvgpr_write_b32 a5, v185
v_accvgpr_write_b32 a6, v186
v_accvgpr_write_b32 a7, v187
v_accvgpr_read_b32 v180, a8
v_accvgpr_read_b32 v181, a9
v_accvgpr_read_b32 v182, a10
v_accvgpr_read_b32 v183, a11
v_accvgpr_read_b32 v184, a12
v_accvgpr_read_b32 v185, a13
v_accvgpr_read_b32 v186, a14
v_accvgpr_read_b32 v187, a15
v_mul_f32 v180, v180, v174
v_mul_f32 v181, v181, v174
v_mul_f32 v182, v182, v174
v_mul_f32 v183, v183, v174
v_mul_f32 v184, v184, v174
v_mul_f32 v185, v185, v174
v_mul_f32 v186, v186, v174
v_mul_f32 v187, v187, v174
v_accvgpr_write_b32 a8, v180
v_accvgpr_write_b32 a9, v181
v_accvgpr_write_b32 a10, v182
v_accvgpr_write_b32 a11, v183
v_accvgpr_write_b32 a12, v184
v_accvgpr_write_b32 a13, v185
v_accvgpr_write_b32 a14, v186
v_accvgpr_write_b32 a15, v187
v_accvgpr_read_b32 v180, a16
v_accvgpr_read_b32 v181, a17
v_accvgpr_read_b32 v182, a18
v_accvgpr_read_b32 v183, a19
v_accvgpr_read_b32 v184, a20
v_accvgpr_read_b32 v185, a21
v_accvgpr_read_b32 v186, a22
v_accvgpr_read_b32 v187, a23
v_mul_f32 v180, v180, v174
v_mul_f32 v181, v181, v174
v_mul_f32 v182, v182, v174
v_mul_f32 v183, v183, v174
v_mul_f32 v184, v184, v174
v_mul_f32 v185, v185, v174
v_mul_f32 v186, v186, v174
v_mul_f32 v187, v187, v174
v_accvgpr_write_b32 a16, v180
v_accvgpr_write_b32 a17, v181
v_accvgpr_write_b32 a18, v182
v_accvgpr_write_b32 a19, v183
v_accvgpr_write_b32 a20, v184
v_accvgpr_write_b32 a21, v185
v_accvgpr_write_b32 a22, v186
v_accvgpr_write_b32 a23, v187
v_accvgpr_read_b32 v180, a24
v_accvgpr_read_b32 v181, a25
v_accvgpr_read_b32 v182, a26
v_accvgpr_read_b32 v183, a27
v_accvgpr_read_b32 v184, a28
v_accvgpr_read_b32 v185, a29
v_accvgpr_read_b32 v186, a30
v_accvgpr_read_b32 v187, a31
v_mul_f32 v180, v180, v174
v_mul_f32 v181, v181, v174
v_mul_f32 v182, v182, v174
v_mul_f32 v183, v183, v174
v_mul_f32 v184, v184, v174
v_mul_f32 v185, v185, v174
v_mul_f32 v186, v186, v174
v_mul_f32 v187, v187, v174
v_accvgpr_write_b32 a24, v180
v_accvgpr_write_b32 a25, v181
v_accvgpr_write_b32 a26, v182
v_accvgpr_write_b32 a27, v183
v_accvgpr_write_b32 a28, v184
v_accvgpr_write_b32 a29, v185
v_accvgpr_write_b32 a30, v186
v_accvgpr_write_b32 a31, v187
v_accvgpr_read_b32 v180, a32
v_accvgpr_read_b32 v181, a33
v_accvgpr_read_b32 v182, a34
v_accvgpr_read_b32 v183, a35
v_accvgpr_read_b32 v184, a36
v_accvgpr_read_b32 v185, a37
v_accvgpr_read_b32 v186, a38
v_accvgpr_read_b32 v187, a39
v_mul_f32 v180, v180, v174
v_mul_f32 v181, v181, v174
v_mul_f32 v182, v182, v174
v_mul_f32 v183, v183, v174
v_mul_f32 v184, v184, v174
v_mul_f32 v185, v185, v174
v_mul_f32 v186, v186, v174
v_mul_f32 v187, v187, v174
v_accvgpr_write_b32 a32, v180
v_accvgpr_write_b32 a33, v181
v_accvgpr_write_b32 a34, v182
v_accvgpr_write_b32 a35, v183
v_accvgpr_write_b32 a36, v184
v_accvgpr_write_b32 a37, v185
v_accvgpr_write_b32 a38, v186
v_accvgpr_write_b32 a39, v187
v_accvgpr_read_b32 v180, a40
v_accvgpr_read_b32 v181, a41
v_accvgpr_read_b32 v182, a42
v_accvgpr_read_b32 v183, a43
v_accvgpr_read_b32 v184, a44
v_accvgpr_read_b32 v185, a45
v_accvgpr_read_b32 v186, a46
v_accvgpr_read_b32 v187, a47
v_mul_f32 v180, v180, v174
v_mul_f32 v181, v181, v174
v_mul_f32 v182, v182, v174
v_mul_f32 v183, v183, v174
v_mul_f32 v184, v184, v174
v_mul_f32 v185, v185, v174
v_mul_f32 v186, v186, v174
v_mul_f32 v187, v187, v174
v_accvgpr_write_b32 a40, v180
v_accvgpr_write_b32 a41, v181
v_accvgpr_write_b32 a42, v182
v_accvgpr_write_b32 a43, v183
v_accvgpr_write_b32 a44, v184
v_accvgpr_write_b32 a45, v185
v_accvgpr_write_b32 a46, v186
v_accvgpr_write_b32 a47, v187
v_accvgpr_read_b32 v180, a48
v_accvgpr_read_b32 v181, a49
v_accvgpr_read_b32 v182, a50
v_accvgpr_read_b32 v183, a51
v_accvgpr_read_b32 v184, a52
v_accvgpr_read_b32 v185, a53
v_accvgpr_read_b32 v186, a54
v_accvgpr_read_b32 v187, a55
v_mul_f32 v180, v180, v174
v_mul_f32 v181, v181, v174
v_mul_f32 v182, v182, v174
v_mul_f32 v183, v183, v174
v_mul_f32 v184, v184, v174
v_mul_f32 v185, v185, v174
v_mul_f32 v186, v186, v174
v_mul_f32 v187, v187, v174
v_accvgpr_write_b32 a48, v180
v_accvgpr_write_b32 a49, v181
v_accvgpr_write_b32 a50, v182
v_accvgpr_write_b32 a51, v183
v_accvgpr_write_b32 a52, v184
v_accvgpr_write_b32 a53, v185
v_accvgpr_write_b32 a54, v186
v_accvgpr_write_b32 a55, v187
v_accvgpr_read_b32 v180, a56
v_accvgpr_read_b32 v181, a57
v_accvgpr_read_b32 v182, a58
v_accvgpr_read_b32 v183, a59
v_accvgpr_read_b32 v184, a60
v_accvgpr_read_b32 v185, a61
v_accvgpr_read_b32 v186, a62
v_accvgpr_read_b32 v187, a63
v_mul_f32 v180, v180, v174
v_mul_f32 v181, v181, v174
v_mul_f32 v182, v182, v174
v_mul_f32 v183, v183, v174
v_mul_f32 v184, v184, v174
v_mul_f32 v185, v185, v174
v_mul_f32 v186, v186, v174
v_mul_f32 v187, v187, v174
v_accvgpr_write_b32 a56, v180
v_accvgpr_write_b32 a57, v181
v_accvgpr_write_b32 a58, v182
v_accvgpr_write_b32 a59, v183
v_accvgpr_write_b32 a60, v184
v_accvgpr_write_b32 a61, v185
v_accvgpr_write_b32 a62, v186
v_accvgpr_write_b32 a63, v187
LS_nors:
s_waitcnt lgkmcnt(0)
s_nop 1
v_mfma_f32_16x16x32_bf16 a[0:3], v[96:99], v[168:171], a[0:3]
v_mfma_f32_16x16x32_bf16 a[4:7], v[100:103], v[168:171], a[4:7]
v_mfma_f32_16x16x32_bf16 a[8:11], v[104:107], v[168:171], a[8:11]
v_mfma_f32_16x16x32_bf16 a[12:15], v[108:111], v[168:171], a[12:15]
v_mfma_f32_16x16x32_bf16 a[16:19], v[112:115], v[168:171], a[16:19]
v_mfma_f32_16x16x32_bf16 a[20:23], v[116:119], v[168:171], a[20:23]
v_mfma_f32_16x16x32_bf16 a[24:27], v[120:123], v[168:171], a[24:27]
v_mfma_f32_16x16x32_bf16 a[28:31], v[124:127], v[168:171], a[28:31]
v_mfma_f32_16x16x32_bf16 a[32:35], v[128:131], v[168:171], a[32:35]
v_mfma_f32_16x16x32_bf16 a[36:39], v[132:135], v[168:171], a[36:39]
v_mfma_f32_16x16x32_bf16 a[40:43], v[136:139], v[168:171], a[40:43]
v_mfma_f32_16x16x32_bf16 a[44:47], v[140:143], v[168:171], a[44:47]
v_mfma_f32_16x16x32_bf16 a[48:51], v[144:147], v[168:171], a[48:51]
v_mfma_f32_16x16x32_bf16 a[52:55], v[148:151], v[168:171], a[52:55]
v_mfma_f32_16x16x32_bf16 a[56:59], v[152:155], v[168:171], a[56:59]
v_mfma_f32_16x16x32_bf16 a[60:63], v[156:159], v[168:171], a[60:63]
s_sub_u32 s51, s51, 1
s_cmp_lg_u32 s51, 0
s_cbranch_scc1 LS_loop
s_nop 15
v_accvgpr_read_b32 v173, a0
v_accvgpr_read_b32 v180, a0
v_accvgpr_read_b32 v181, a1
v_accvgpr_read_b32 v182, a2
v_accvgpr_read_b32 v183, a3
v_accvgpr_read_b32 v184, a4
v_accvgpr_read_b32 v185, a5
v_accvgpr_read_b32 v186, a6
v_accvgpr_read_b32 v187, a7
v_cvt_pk_bf16_f32 v32, v180, v181
v_cvt_pk_bf16_f32 v33, v182, v183
v_cvt_pk_bf16_f32 v34, v184, v185
v_cvt_pk_bf16_f32 v35, v186, v187
buffer_store_dwordx4 v[32:35], v252, s[20:23], s40 offen offset:0 sc1
v_accvgpr_read_b32 v180, a8
v_accvgpr_read_b32 v181, a9
v_accvgpr_read_b32 v182, a10
v_accvgpr_read_b32 v183, a11
v_accvgpr_read_b32 v184, a12
v_accvgpr_read_b32 v185, a13
v_accvgpr_read_b32 v186, a14
v_accvgpr_read_b32 v187, a15
v_cvt_pk_bf16_f32 v36, v180, v181
v_cvt_pk_bf16_f32 v37, v182, v183
v_cvt_pk_bf16_f32 v38, v184, v185
v_cvt_pk_bf16_f32 v39, v186, v187
buffer_store_dwordx4 v[36:39], v252, s[20:23], s40 offen offset:1024 sc1
v_accvgpr_read_b32 v180, a16
v_accvgpr_read_b32 v181, a17
v_accvgpr_read_b32 v182, a18
v_accvgpr_read_b32 v183, a19
v_accvgpr_read_b32 v184, a20
v_accvgpr_read_b32 v185, a21
v_accvgpr_read_b32 v186, a22
v_accvgpr_read_b32 v187, a23
v_cvt_pk_bf16_f32 v40, v180, v181
v_cvt_pk_bf16_f32 v41, v182, v183
v_cvt_pk_bf16_f32 v42, v184, v185
v_cvt_pk_bf16_f32 v43, v186, v187
buffer_store_dwordx4 v[40:43], v252, s[20:23], s40 offen offset:2048 sc1
v_accvgpr_read_b32 v180, a24
v_accvgpr_read_b32 v181, a25
v_accvgpr_read_b32 v182, a26
v_accvgpr_read_b32 v183, a27
v_accvgpr_read_b32 v184, a28
v_accvgpr_read_b32 v185, a29
v_accvgpr_read_b32 v186, a30
v_accvgpr_read_b32 v187, a31
v_cvt_pk_bf16_f32 v44, v180, v181
v_cvt_pk_bf16_f32 v45, v182, v183
v_cvt_pk_bf16_f32 v46, v184, v185
v_cvt_pk_bf16_f32 v47, v186, v187
buffer_store_dwordx4 v[44:47], v252, s[20:23], s40 offen offset:3072 sc1
v_accvgpr_read_b32 v180, a32
v_accvgpr_read_b32 v181, a33
v_accvgpr_read_b32 v182, a34
v_accvgpr_read_b32 v183, a35
v_accvgpr_read_b32 v184, a36
v_accvgpr_read_b32 v185, a37
v_accvgpr_read_b32 v186, a38
v_accvgpr_read_b32 v187, a39
v_cvt_pk_bf16_f32 v48, v180, v181
v_cvt_pk_bf16_f32 v49, v182, v183
v_cvt_pk_bf16_f32 v50, v184, v185
v_cvt_pk_bf16_f32 v51, v186, v187
buffer_store_dwordx4 v[48:51], v252, s[20:23], s44 offen offset:0 sc1
v_accvgpr_read_b32 v180, a40
v_accvgpr_read_b32 v181, a41
v_accvgpr_read_b32 v182, a42
v_accvgpr_read_b32 v183, a43
v_accvgpr_read_b32 v184, a44
v_accvgpr_read_b32 v185, a45
v_accvgpr_read_b32 v186, a46
v_accvgpr_read_b32 v187, a47
v_cvt_pk_bf16_f32 v52, v180, v181
v_cvt_pk_bf16_f32 v53, v182, v183
v_cvt_pk_bf16_f32 v54, v184, v185
v_cvt_pk_bf16_f32 v55, v186, v187
buffer_store_dwordx4 v[52:55], v252, s[20:23], s44 offen offset:1024 sc1
v_accvgpr_read_b32 v180, a48
v_accvgpr_read_b32 v181, a49
v_accvgpr_read_b32 v182, a50
v_accvgpr_read_b32 v183, a51
v_accvgpr_read_b32 v184, a52
v_accvgpr_read_b32 v185, a53
v_accvgpr_read_b32 v186, a54
v_accvgpr_read_b32 v187, a55
v_cvt_pk_bf16_f32 v56, v180, v181
v_cvt_pk_bf16_f32 v57, v182, v183
v_cvt_pk_bf16_f32 v58, v184, v185
v_cvt_pk_bf16_f32 v59, v186, v187
buffer_store_dwordx4 v[56:59], v252, s[20:23], s44 offen offset:2048 sc1
v_accvgpr_read_b32 v180, a56
v_accvgpr_read_b32 v181, a57
v_accvgpr_read_b32 v182, a58
v_accvgpr_read_b32 v183, a59
v_accvgpr_read_b32 v184, a60
v_accvgpr_read_b32 v185, a61
v_accvgpr_read_b32 v186, a62
v_accvgpr_read_b32 v187, a63
v_cvt_pk_bf16_f32 v60, v180, v181
v_cvt_pk_bf16_f32 v61, v182, v183
v_cvt_pk_bf16_f32 v62, v184, v185
v_cvt_pk_bf16_f32 v63, v186, v187
buffer_store_dwordx4 v[60:63], v252, s[20:23], s44 offen offset:3072 sc1
v_lshlrev_b32 v175, 2, v252
s_mov_b64 exec, 0xffff
buffer_store_dwordx2 v[172:173], v175, s[24:27], s48 offen sc1
s_mov_b64 exec, -1
s_waitcnt vmcnt(0)
s_add_u32 s40, s40, 8192
s_add_u32 s48, s48, 1024
s_sub_u32 s55, s55, 1
s_cmp_lg_u32 s55, 0
s_cbranch_scc1 LS_q
s_branch L2_fin
LT_disp:
s_cmp_eq_u32 s34, 0
s_cbranch_scc1 LT_start
s_mov_b32 s41, s34
s_mul_i32 s40, s34, 6
s_add_u32 s40, s40, s37
s_add_u32 s40, s40, 42
s_cmp_lt_u32 s40, 60
s_cbranch_scc1 LE_common
s_branch L2_end
LT_start:
s_waitcnt lgkmcnt(0)
s_add_u32 s12, s4, 0x6800000
s_addc_u32 s13, s5, 0
s_mov_b32 s14, s49
s_mov_b32 s15, 0x00020000
s_add_u32 s8, s4, 0x0
s_addc_u32 s9, s5, 0
s_mov_b32 s10, 0x4e4000
s_mov_b32 s11, 0x00020000
s_mul_i32 s35, s37, 0x600000
s_add_u32 s20, s4, 0x2000000
s_addc_u32 s21, s5, 0
s_add_u32 s20, s20, s35
s_addc_u32 s21, s21, 0
s_mov_b32 s22, 0x4e4000
s_mov_b32 s23, 0x00020000
s_add_u32 s24, s4, 0x6000000
s_addc_u32 s25, s5, 0
s_mov_b32 s26, 0x9c800
s_mov_b32 s27, 0x00020000
s_lshl_b32 s35, s38, 4
s_lshl_b32 s41, s34, 2
s_add_u32 s35, s35, s41
s_lshl_b32 s40, s35, 13
s_lshl_b32 s48, s35, 10
s_lshl_b32 s35, s37, 3
s_add_u32 s48, s48, s35
v_bfe_u32 v248, v252, 4, 3
v_lshlrev_b32 v248, 6, v248
v_bfe_u32 v253, v252, 7, 1
v_lshl_or_b32 v248, v253, 10, v248
v_bfe_u32 v253, v252, 8, 2
v_lshl_or_b32 v248, v253, 4, v248
v_bfe_u32 v253, v252, 6, 1
v_lshlrev_b32 v253, 5, v253
v_xor_b32 v248, v248, v253
v_and_b32 v249, 0x1c0, v252
v_bfe_u32 v253, v252, 9, 1
v_lshl_or_b32 v249, v253, 10, v249
v_bfe_u32 v253, v252, 8, 1
v_lshl_or_b32 v249, v253, 5, v249
v_bfe_u32 v253, v252, 4, 2
v_lshl_or_b32 v249, v253, 3, v249
v_xor_b32 v250, 32, v249
s_mov_b32 s56, 90112
s_add_u32 s57, s56, 65536
s_mov_b32 s55, 1
v_bfe_i32 v188, v252, 8, 1
LT_q:
s_add_u32 s44, s40, 4096
buffer_load_dwordx4 v[0:3], v252, s[8:11], s40 offen offset:0
buffer_load_dwordx4 v[4:7], v252, s[8:11], s40 offen offset:1024
buffer_load_dwordx4 v[8:11], v252, s[8:11], s40 offen offset:2048
buffer_load_dwordx4 v[12:15], v252, s[8:11], s40 offen offset:3072
buffer_load_dwordx4 v[16:19], v252, s[8:11], s44 offen offset:0
buffer_load_dwordx4 v[20:23], v252, s[8:11], s44 offen offset:1024
buffer_load_dwordx4 v[24:27], v252, s[8:11], s44 offen offset:2048
buffer_load_dwordx4 v[28:31], v252, s[8:11], s44 offen offset:3072
s_mov_b32 s53, s56
s_mov_b32 s58, s39
s_add_u32 m0, s53, 0
s_add_u32 s54, s58, 0
buffer_load_dwordx4 v251, s[12:15], s54 offen offset:0 lds
buffer_load_dwordx4 v251, s[12:15], s54 offen offset:1024 lds
buffer_load_dwordx4 v251, s[12:15], s54 offen offset:2048 lds
buffer_load_dwordx4 v251, s[12:15], s54 offen offset:3072 lds
s_add_u32 m0, s53, 4096
s_add_u32 s54, s58, 128
buffer_load_dwordx4 v251, s[12:15], s54 offen offset:0 lds
buffer_load_dwordx4 v251, s[12:15], s54 offen offset:1024 lds
buffer_load_dwordx4 v251, s[12:15], s54 offen offset:2048 lds
buffer_load_dwordx4 v251, s[12:15], s54 offen offset:3072 lds
s_add_u32 m0, s53, 8192
s_add_u32 s54, s58, 256
buffer_load_dwordx4 v251, s[12:15], s54 offen offset:0 lds
buffer_load_dwordx4 v251, s[12:15], s54 offen offset:1024 lds
buffer_load_dwordx4 v251, s[12:15], s54 offen offset:2048 lds
buffer_load_dwordx4 v251, s[12:15], s54 offen offset:3072 lds
s_add_u32 m0, s53, 12288
s_add_u32 s54, s58, 384
buffer_load_dwordx4 v251, s[12:15], s54 offen offset:0 lds
buffer_load_dwordx4 v251, s[12:15], s54 offen offset:1024 lds
buffer_load_dwordx4 v251, s[12:15], s54 offen offset:2048 lds
buffer_load_dwordx4 v251, s[12:15], s54 offen offset:3072 lds
s_add_u32 s53, s53, 0x4000
s_cmp_eq_u32 s53, s57
s_cselect_b32 s53, s56, s53
s_add_u32 s58, s58, 0x4000
s_add_u32 m0, s53, 0
s_add_u32 s54, s58, 0
buffer_load_dwordx4 v251, s[12:15], s54 offen offset:0 lds
buffer_load_dwordx4 v251, s[12:15], s54 offen offset:1024 lds
buffer_load_dwordx4 v251, s[12:15], s54 offen offset:2048 lds
buffer_load_dwordx4 v251, s[12:15], s54 offen offset:3072 lds
s_add_u32 m0, s53, 4096
s_add_u32 s54, s58, 128
buffer_load_dwordx4 v251, s[12:15], s54 offen offset:0 lds
buffer_load_dwordx4 v251, s[12:15], s54 offen offset:1024 lds
buffer_load_dwordx4 v251, s[12:15], s54 offen offset:2048 lds
buffer_load_dwordx4 v251, s[12:15], s54 offen offset:3072 lds
s_add_u32 m0, s53, 8192
s_add_u32 s54, s58, 256
buffer_load_dwordx4 v251, s[12:15], s54 offen offset:0 lds
buffer_load_dwordx4 v251, s[12:15], s54 offen offset:1024 lds
buffer_load_dwordx4 v251, s[12:15], s54 offen offset:2048 lds
buffer_load_dwordx4 v251, s[12:15], s54 offen offset:3072 lds
s_add_u32 m0, s53, 12288
s_add_u32 s54, s58, 384
buffer_load_dwordx4 v251, s[12:15], s54 offen offset:0 lds
buffer_load_dwordx4 v251, s[12:15], s54 offen offset:1024 lds
buffer_load_dwordx4 v251, s[12:15], s54 offen offset:2048 lds
buffer_load_dwordx4 v251, s[12:15], s54 offen offset:3072 lds
s_add_u32 s53, s53, 0x4000
s_cmp_eq_u32 s53, s57
s_cselect_b32 s53, s56, s53
s_add_u32 s58, s58, 0x4000
s_add_u32 m0, s53, 0
s_add_u32 s54, s58, 0
buffer_load_dwordx4 v251, s[12:15], s54 offen offset:0 lds
buffer_load_dwordx4 v251, s[12:15], s54 offen offset:1024 lds
buffer_load_dwordx4 v251, s[12:15], s54 offen offset:2048 lds
buffer_load_dwordx4 v251, s[12:15], s54 offen offset:3072 lds
s_add_u32 m0, s53, 4096
s_add_u32 s54, s58, 128
buffer_load_dwordx4 v251, s[12:15], s54 offen offset:0 lds
buffer_load_dwordx4 v251, s[12:15], s54 offen offset:1024 lds
buffer_load_dwordx4 v251, s[12:15], s54 offen offset:2048 lds
buffer_load_dwordx4 v251, s[12:15], s54 offen offset:3072 lds
s_add_u32 m0, s53, 8192
s_add_u32 s54, s58, 256
buffer_load_dwordx4 v251, s[12:15], s54 offen offset:0 lds
buffer_load_dwordx4 v251, s[12:15], s54 offen offset:1024 lds
buffer_load_dwordx4 v251, s[12:15], s54 offen offset:2048 lds
buffer_load_dwordx4 v251, s[12:15], s54 offen offset:3072 lds
s_add_u32 m0, s53, 12288
s_add_u32 s54, s58, 384
buffer_load_dwordx4 v251, s[12:15], s54 offen offset:0 lds
buffer_load_dwordx4 v251, s[12:15], s54 offen offset:1024 lds
buffer_load_dwordx4 v251, s[12:15], s54 offen offset:2048 lds
buffer_load_dwordx4 v251, s[12:15], s54 offen offset:3072 lds
s_add_u32 s53, s53, 0x4000
s_cmp_eq_u32 s53, s57
s_cselect_b32 s53, s56, s53
s_add_u32 s58, s58, 0x4000
s_mov_b32 s51, s29
s_mov_b32 s52, s56
v_mov_b32 v172, 0xff800000
v_accvgpr_write_b32 a0, 0
v_accvgpr_write_b32 a1, 0
v_accvgpr_write_b32 a2, 0
v_accvgpr_write_b32 a3, 0
v_accvgpr_write_b32 a4, 0
v_accvgpr_write_b32 a5, 0
v_accvgpr_write_b32 a6, 0
v_accvgpr_write_b32 a7, 0
v_accvgpr_write_b32 a8, 0
v_accvgpr_write_b32 a9, 0
v_accvgpr_write_b32 a10, 0
v_accvgpr_write_b32 a11, 0
v_accvgpr_write_b32 a12, 0
v_accvgpr_write_b32 a13, 0
v_accvgpr_write_b32 a14, 0
v_accvgpr_write_b32 a15, 0
v_accvgpr_write_b32 a16, 0
v_accvgpr_write_b32 a17, 0
v_accvgpr_write_b32 a18, 0
v_accvgpr_write_b32 a19, 0
v_accvgpr_write_b32 a20, 0
v_accvgpr_write_b32 a21, 0
v_accvgpr_write_b32 a22, 0
v_accvgpr_write_b32 a23, 0
v_accvgpr_write_b32 a24, 0
v_accvgpr_write_b32 a25, 0
v_accvgpr_write_b32 a26, 0
v_accvgpr_write_b32 a27, 0
v_accvgpr_write_b32 a28, 0
v_accvgpr_write_b32 a29, 0
v_accvgpr_write_b32 a30, 0
v_accvgpr_write_b32 a31, 0
v_accvgpr_write_b32 a32, 0
v_accvgpr_write_b32 a33, 0
v_accvgpr_write_b32 a34, 0
v_accvgpr_write_b32 a35, 0
v_accvgpr_write_b32 a36, 0
v_accvgpr_write_b32 a37, 0
v_accvgpr_write_b32 a38, 0
v_accvgpr_write_b32 a39, 0
v_accvgpr_write_b32 a40, 0
v_accvgpr_write_b32 a41, 0
v_accvgpr_write_b32 a42, 0
v_accvgpr_write_b32 a43, 0
v_accvgpr_write_b32 a44, 0
v_accvgpr_write_b32 a45, 0
v_accvgpr_write_b32 a46, 0
v_accvgpr_write_b32 a47, 0
v_accvgpr_write_b32 a48, 0
v_accvgpr_write_b32 a49, 0
v_accvgpr_write_b32 a50, 0
v_accvgpr_write_b32 a51, 0
v_accvgpr_write_b32 a52, 0
v_accvgpr_write_b32 a53, 0
v_accvgpr_write_b32 a54, 0
v_accvgpr_write_b32 a55, 0
v_accvgpr_write_b32 a56, 0
v_accvgpr_write_b32 a57, 0
v_accvgpr_write_b32 a58, 0
v_accvgpr_write_b32 a59, 0
v_accvgpr_write_b32 a60, 0
v_accvgpr_write_b32 a61, 0
v_accvgpr_write_b32 a62, 0
v_accvgpr_write_b32 a63, 0
LT_loop:
s_add_u32 m0, s53, 0
s_add_u32 s54, s58, 0
buffer_load_dwordx4 v251, s[12:15], s54 offen offset:0 lds
buffer_load_dwordx4 v251, s[12:15], s54 offen offset:1024 lds
buffer_load_dwordx4 v251, s[12:15], s54 offen offset:2048 lds
buffer_load_dwordx4 v251, s[12:15], s54 offen offset:3072 lds
s_add_u32 m0, s53, 4096
s_add_u32 s54, s58, 128
buffer_load_dwordx4 v251, s[12:15], s54 offen offset:0 lds
buffer_load_dwordx4 v251, s[12:15], s54 offen offset:1024 lds
buffer_load_dwordx4 v251, s[12:15], s54 offen offset:2048 lds
buffer_load_dwordx4 v251, s[12:15], s54 offen offset:3072 lds
s_add_u32 m0, s53, 8192
s_add_u32 s54, s58, 256
buffer_load_dwordx4 v251, s[12:15], s54 offen offset:0 lds
buffer_load_dwordx4 v251, s[12:15], s54 offen offset:1024 lds
buffer_load_dwordx4 v251, s[12:15], s54 offen offset:2048 lds
buffer_load_dwordx4 v251, s[12:15], s54 offen offset:3072 lds
s_add_u32 m0, s53, 12288
s_add_u32 s54, s58, 384
buffer_load_dwordx4 v251, s[12:15], s54 offen offset:0 lds
buffer_load_dwordx4 v251, s[12:15], s54 offen offset:1024 lds
buffer_load_dwordx4 v251, s[12:15], s54 offen offset:2048 lds
buffer_load_dwordx4 v251, s[12:15], s54 offen offset:3072 lds
s_add_u32 s53, s53, 0x4000
s_cmp_eq_u32 s53, s57
s_cselect_b32 s53, s56, s53
s_add_u32 s58, s58, 0x4000
v_add_u32 v177, s52, v248
v_add_u32 v178, s52, v249
v_add_u32 v179, s52, v250
s_add_u32 s52, s52, 0x4000
s_cmp_eq_u32 s52, s57
s_cselect_b32 s52, s56, s52
s_cmp_eq_u32 s51, 1
s_cselect_b32 s54, s33, 0
v_and_b32 v192, s54, v188
v_and_b32 v193, s54, v188
v_and_b32 v194, s54, v188
v_and_b32 v195, s54, v188
s_waitcnt vmcnt(48)
ds_read_b128 v[32:35], v177 offset:0
ds_read_b128 v[64:67], v177 offset:2048
ds_read_b128 v[36:39], v177 offset:512
ds_read_b128 v[68:71], v177 offset:2560
ds_read_b128 v[40:43], v177 offset:4096
ds_read_b128 v[72:75], v177 offset:6144
ds_read_b128 v[44:47], v177 offset:4608
ds_read_b128 v[76:79], v177 offset:6656
ds_read_b128 v[48:51], v177 offset:8192
ds_read_b128 v[80:83], v177 offset:10240
ds_read_b128 v[52:55], v177 offset:8704
ds_read_b128 v[84:87], v177 offset:10752
ds_read_b128 v[56:59], v177 offset:12288
ds_read_b128 v[88:91], v177 offset:14336
ds_read_b128 v[60:63], v177 offset:12800
ds_read_b128 v[92:95], v177 offset:14848
s_waitcnt lgkmcnt(14)
v_mfma_f32_16x16x32_bf16 v[160:163], v[32:35], v[0:3], v[192:195]
v_mfma_f32_16x16x32_bf16 v[164:167], v[64:67], v[0:3], v[192:195]
s_waitcnt lgkmcnt(12)
v_mfma_f32_16x16x32_bf16 v[160:163], v[36:39], v[4:7], v[160:163]
v_mfma_f32_16x16x32_bf16 v[164:167], v[68:71], v[4:7], v[164:167]
s_waitcnt lgkmcnt(10)
v_mfma_f32_16x16x32_bf16 v[160:163], v[40:43], v[8:11], v[160:163]
v_mfma_f32_16x16x32_bf16 v[164:167], v[72:75], v[8:11], v[164:167]
s_waitcnt lgkmcnt(8)
v_mfma_f32_16x16x32_bf16 v[160:163], v[44:47], v[12:15], v[160:163]
v_mfma_f32_16x16x32_bf16 v[164:167], v[76:79], v[12:15], v[164:167]
s_waitcnt lgkmcnt(6)
v_mfma_f32_16x16x32_bf16 v[160:163], v[48:51], v[16:19], v[160:163]
v_mfma_f32_16x16x32_bf16 v[164:167], v[80:83], v[16:19], v[164:167]
s_waitcnt lgkmcnt(4)
v_mfma_f32_16x16x32_bf16 v[160:163], v[52:55], v[20:23], v[160:163]
v_mfma_f32_16x16x32_bf16 v[164:167], v[84:87], v[20:23], v[164:167]
s_waitcnt lgkmcnt(2)
v_mfma_f32_16x16x32_bf16 v[160:163], v[56:59], v[24:27], v[160:163]
v_mfma_f32_16x16x32_bf16 v[164:167], v[88:91], v[24:27], v[164:167]
s_waitcnt lgkmcnt(0)
v_mfma_f32_16x16x32_bf16 v[160:163], v[60:63], v[28:31], v[160:163]
v_mfma_f32_16x16x32_bf16 v[164:167], v[92:95], v[28:31], v[164:167]
ds_read_b64_tr_b16 v[96:97], v178 offset:0
ds_read_b64_tr_b16 v[98:99], v178 offset:2048
ds_read_b64_tr_b16 v[100:101], v179 offset:0
ds_read_b64_tr_b16 v[102:103], v179 offset:2048
ds_read_b64_tr_b16 v[104:105], v178 offset:512
ds_read_b64_tr_b16 v[106:107], v178 offset:2560
ds_read_b64_tr_b16 v[108:109], v179 offset:512
ds_read_b64_tr_b16 v[110:111], v179 offset:2560
ds_read_b64_tr_b16 v[112:113], v178 offset:4096
ds_read_b64_tr_b16 v[114:115], v178 offset:6144
ds_read_b64_tr_b16 v[116:117], v179 offset:4096
ds_read_b64_tr_b16 v[118:119], v179 offset:6144
ds_read_b64_tr_b16 v[120:121], v178 offset:4608
ds_read_b64_tr_b16 v[122:123], v178 offset:6656
ds_read_b64_tr_b16 v[124:125], v179 offset:4608
ds_read_b64_tr_b16 v[126:127], v179 offset:6656
ds_read_b64_tr_b16 v[128:129], v178 offset:8192
ds_read_b64_tr_b16 v[130:131], v178 offset:10240
ds_read_b64_tr_b16 v[132:133], v179 offset:8192
ds_read_b64_tr_b16 v[134:135], v179 offset:10240
ds_read_b64_tr_b16 v[136:137], v178 offset:8704
ds_read_b64_tr_b16 v[138:139], v178 offset:10752
ds_read_b64_tr_b16 v[140:141], v179 offset:8704
ds_read_b64_tr_b16 v[142:143], v179 offset:10752
ds_read_b64_tr_b16 v[144:145], v178 offset:12288
ds_read_b64_tr_b16 v[146:147], v178 offset:14336
ds_read_b64_tr_b16 v[148:149], v179 offset:12288
ds_read_b64_tr_b16 v[150:151], v179 offset:14336
ds_read_b64_tr_b16 v[152:153], v178 offset:12800
ds_read_b64_tr_b16 v[154:155], v178 offset:14848
ds_read_b64_tr_b16 v[156:157], v179 offset:12800
ds_read_b64_tr_b16 v[158:159], v179 offset:14848
s_nop 7
v_max3_f32 v175, v160, v161, v162
v_max3_f32 v175, v175, v163, v164
v_max3_f32 v175, v175, v165, v166
v_max3_f32 v175, v175, v167, v172
v_mov_b32 v176, v175
s_nop 1
v_permlane32_swap_b32 v175, v176
s_nop 1
v_max_f32 v175, v175, v176
v_mov_b32 v176, v175
s_nop 1
v_permlane16_swap_b32 v175, v176
s_nop 1
v_max_f32 v175, v175, v176
v_sub_f32 v174, v172, v175
v_exp_f32 v174, v174
v_mov_b32 v172, v175
v_sub_f32 v160, v160, v172
v_sub_f32 v161, v161, v172
v_sub_f32 v162, v162, v172
v_sub_f32 v163, v163, v172
v_sub_f32 v164, v164, v172
v_sub_f32 v165, v165, v172
v_sub_f32 v166, v166, v172
v_sub_f32 v167, v167, v172
v_exp_f32 v160, v160
v_exp_f32 v161, v161
v_exp_f32 v162, v162
v_exp_f32 v163, v163
v_exp_f32 v164, v164
v_exp_f32 v165, v165
v_exp_f32 v166, v166
v_exp_f32 v167, v167
v_cmp_neq_f32 vcc, 1.0, v174
v_cvt_pk_bf16_f32 v168, v160, v161
v_cvt_pk_bf16_f32 v169, v162, v163
v_cvt_pk_bf16_f32 v170, v164, v165
v_cvt_pk_bf16_f32 v171, v166, v167
s_cbranch_vccz LT_nors
v_accvgpr_read_b32 v180, a0
v_accvgpr_read_b32 v181, a1
v_accvgpr_read_b32 v182, a2
v_accvgpr_read_b32 v183, a3
v_accvgpr_read_b32 v184, a4
v_accvgpr_read_b32 v185, a5
v_accvgpr_read_b32 v186, a6
v_accvgpr_read_b32 v187, a7
v_mul_f32 v180, v180, v174
v_mul_f32 v181, v181, v174
v_mul_f32 v182, v182, v174
v_mul_f32 v183, v183, v174
v_mul_f32 v184, v184, v174
v_mul_f32 v185, v185, v174
v_mul_f32 v186, v186, v174
v_mul_f32 v187, v187, v174
v_accvgpr_write_b32 a0, v180
v_accvgpr_write_b32 a1, v181
v_accvgpr_write_b32 a2, v182
v_accvgpr_write_b32 a3, v183
v_accvgpr_write_b32 a4, v184
v_accvgpr_write_b32 a5, v185
v_accvgpr_write_b32 a6, v186
v_accvgpr_write_b32 a7, v187
v_accvgpr_read_b32 v180, a8
v_accvgpr_read_b32 v181, a9
v_accvgpr_read_b32 v182, a10
v_accvgpr_read_b32 v183, a11
v_accvgpr_read_b32 v184, a12
v_accvgpr_read_b32 v185, a13
v_accvgpr_read_b32 v186, a14
v_accvgpr_read_b32 v187, a15
v_mul_f32 v180, v180, v174
v_mul_f32 v181, v181, v174
v_mul_f32 v182, v182, v174
v_mul_f32 v183, v183, v174
v_mul_f32 v184, v184, v174
v_mul_f32 v185, v185, v174
v_mul_f32 v186, v186, v174
v_mul_f32 v187, v187, v174
v_accvgpr_write_b32 a8, v180
v_accvgpr_write_b32 a9, v181
v_accvgpr_write_b32 a10, v182
v_accvgpr_write_b32 a11, v183
v_accvgpr_write_b32 a12, v184
v_accvgpr_write_b32 a13, v185
v_accvgpr_write_b32 a14, v186
v_accvgpr_write_b32 a15, v187
v_accvgpr_read_b32 v180, a16
v_accvgpr_read_b32 v181, a17
v_accvgpr_read_b32 v182, a18
v_accvgpr_read_b32 v183, a19
v_accvgpr_read_b32 v184, a20
v_accvgpr_read_b32 v185, a21
v_accvgpr_read_b32 v186, a22
v_accvgpr_read_b32 v187, a23
v_mul_f32 v180, v180, v174
v_mul_f32 v181, v181, v174
v_mul_f32 v182, v182, v174
v_mul_f32 v183, v183, v174
v_mul_f32 v184, v184, v174
v_mul_f32 v185, v185, v174
v_mul_f32 v186, v186, v174
v_mul_f32 v187, v187, v174
v_accvgpr_write_b32 a16, v180
v_accvgpr_write_b32 a17, v181
v_accvgpr_write_b32 a18, v182
v_accvgpr_write_b32 a19, v183
v_accvgpr_write_b32 a20, v184
v_accvgpr_write_b32 a21, v185
v_accvgpr_write_b32 a22, v186
v_accvgpr_write_b32 a23, v187
v_accvgpr_read_b32 v180, a24
v_accvgpr_read_b32 v181, a25
v_accvgpr_read_b32 v182, a26
v_accvgpr_read_b32 v183, a27
v_accvgpr_read_b32 v184, a28
v_accvgpr_read_b32 v185, a29
v_accvgpr_read_b32 v186, a30
v_accvgpr_read_b32 v187, a31
v_mul_f32 v180, v180, v174
v_mul_f32 v181, v181, v174
v_mul_f32 v182, v182, v174
v_mul_f32 v183, v183, v174
v_mul_f32 v184, v184, v174
v_mul_f32 v185, v185, v174
v_mul_f32 v186, v186, v174
v_mul_f32 v187, v187, v174
v_accvgpr_write_b32 a24, v180
v_accvgpr_write_b32 a25, v181
v_accvgpr_write_b32 a26, v182
v_accvgpr_write_b32 a27, v183
v_accvgpr_write_b32 a28, v184
v_accvgpr_write_b32 a29, v185
v_accvgpr_write_b32 a30, v186
v_accvgpr_write_b32 a31, v187
v_accvgpr_read_b32 v180, a32
v_accvgpr_read_b32 v181, a33
v_accvgpr_read_b32 v182, a34
v_accvgpr_read_b32 v183, a35
v_accvgpr_read_b32 v184, a36
v_accvgpr_read_b32 v185, a37
v_accvgpr_read_b32 v186, a38
v_accvgpr_read_b32 v187, a39
v_mul_f32 v180, v180, v174
v_mul_f32 v181, v181, v174
v_mul_f32 v182, v182, v174
v_mul_f32 v183, v183, v174
v_mul_f32 v184, v184, v174
v_mul_f32 v185, v185, v174
v_mul_f32 v186, v186, v174
v_mul_f32 v187, v187, v174
v_accvgpr_write_b32 a32, v180
v_accvgpr_write_b32 a33, v181
v_accvgpr_write_b32 a34, v182
v_accvgpr_write_b32 a35, v183
v_accvgpr_write_b32 a36, v184
v_accvgpr_write_b32 a37, v185
v_accvgpr_write_b32 a38, v186
v_accvgpr_write_b32 a39, v187
v_accvgpr_read_b32 v180, a40
v_accvgpr_read_b32 v181, a41
v_accvgpr_read_b32 v182, a42
v_accvgpr_read_b32 v183, a43
v_accvgpr_read_b32 v184, a44
v_accvgpr_read_b32 v185, a45
v_accvgpr_read_b32 v186, a46
v_accvgpr_read_b32 v187, a47
v_mul_f32 v180, v180, v174
v_mul_f32 v181, v181, v174
v_mul_f32 v182, v182, v174
v_mul_f32 v183, v183, v174
v_mul_f32 v184, v184, v174
v_mul_f32 v185, v185, v174
v_mul_f32 v186, v186, v174
v_mul_f32 v187, v187, v174
v_accvgpr_write_b32 a40, v180
v_accvgpr_write_b32 a41, v181
v_accvgpr_write_b32 a42, v182
v_accvgpr_write_b32 a43, v183
v_accvgpr_write_b32 a44, v184
v_accvgpr_write_b32 a45, v185
v_accvgpr_write_b32 a46, v186
v_accvgpr_write_b32 a47, v187
v_accvgpr_read_b32 v180, a48
v_accvgpr_read_b32 v181, a49
v_accvgpr_read_b32 v182, a50
v_accvgpr_read_b32 v183, a51
v_accvgpr_read_b32 v184, a52
v_accvgpr_read_b32 v185, a53
v_accvgpr_read_b32 v186, a54
v_accvgpr_read_b32 v187, a55
v_mul_f32 v180, v180, v174
v_mul_f32 v181, v181, v174
v_mul_f32 v182, v182, v174
v_mul_f32 v183, v183, v174
v_mul_f32 v184, v184, v174
v_mul_f32 v185, v185, v174
v_mul_f32 v186, v186, v174
v_mul_f32 v187, v187, v174
v_accvgpr_write_b32 a48, v180
v_accvgpr_write_b32 a49, v181
v_accvgpr_write_b32 a50, v182
v_accvgpr_write_b32 a51, v183
v_accvgpr_write_b32 a52, v184
v_accvgpr_write_b32 a53, v185
v_accvgpr_write_b32 a54, v186
v_accvgpr_write_b32 a55, v187
v_accvgpr_read_b32 v180, a56
v_accvgpr_read_b32 v181, a57
v_accvgpr_read_b32 v182, a58
v_accvgpr_read_b32 v183, a59
v_accvgpr_read_b32 v184, a60
v_accvgpr_read_b32 v185, a61
v_accvgpr_read_b32 v186, a62
v_accvgpr_read_b32 v187, a63
v_mul_f32 v180, v180, v174
v_mul_f32 v181, v181, v174
v_mul_f32 v182, v182, v174
v_mul_f32 v183, v183, v174
v_mul_f32 v184, v184, v174
v_mul_f32 v185, v185, v174
v_mul_f32 v186, v186, v174
v_mul_f32 v187, v187, v174
v_accvgpr_write_b32 a56, v180
v_accvgpr_write_b32 a57, v181
v_accvgpr_write_b32 a58, v182
v_accvgpr_write_b32 a59, v183
v_accvgpr_write_b32 a60, v184
v_accvgpr_write_b32 a61, v185
v_accvgpr_write_b32 a62, v186
v_accvgpr_write_b32 a63, v187
LT_nors:
s_waitcnt lgkmcnt(0)
s_nop 1
v_mfma_f32_16x16x32_bf16 a[0:3], v[96:99], v[168:171], a[0:3]
v_mfma_f32_16x16x32_bf16 a[4:7], v[100:103], v[168:171], a[4:7]
v_mfma_f32_16x16x32_bf16 a[8:11], v[104:107], v[168:171], a[8:11]
v_mfma_f32_16x16x32_bf16 a[12:15], v[108:111], v[168:171], a[12:15]
v_mfma_f32_16x16x32_bf16 a[16:19], v[112:115], v[168:171], a[16:19]
v_mfma_f32_16x16x32_bf16 a[20:23], v[116:119], v[168:171], a[20:23]
v_mfma_f32_16x16x32_bf16 a[24:27], v[120:123], v[168:171], a[24:27]
v_mfma_f32_16x16x32_bf16 a[28:31], v[124:127], v[168:171], a[28:31]
v_mfma_f32_16x16x32_bf16 a[32:35], v[128:131], v[168:171], a[32:35]
v_mfma_f32_16x16x32_bf16 a[36:39], v[132:135], v[168:171], a[36:39]
v_mfma_f32_16x16x32_bf16 a[40:43], v[136:139], v[168:171], a[40:43]
v_mfma_f32_16x16x32_bf16 a[44:47], v[140:143], v[168:171], a[44:47]
v_mfma_f32_16x16x32_bf16 a[48:51], v[144:147], v[168:171], a[48:51]
v_mfma_f32_16x16x32_bf16 a[52:55], v[148:151], v[168:171], a[52:55]
v_mfma_f32_16x16x32_bf16 a[56:59], v[152:155], v[168:171], a[56:59]
v_mfma_f32_16x16x32_bf16 a[60:63], v[156:159], v[168:171], a[60:63]
s_sub_u32 s51, s51, 1
s_cmp_lg_u32 s51, 0
s_cbranch_scc1 LT_loop
s_nop 15
v_accvgpr_read_b32 v173, a0
v_accvgpr_read_b32 v180, a0
v_accvgpr_read_b32 v181, a1
v_accvgpr_read_b32 v182, a2
v_accvgpr_read_b32 v183, a3
v_accvgpr_read_b32 v184, a4
v_accvgpr_read_b32 v185, a5
v_accvgpr_read_b32 v186, a6
v_accvgpr_read_b32 v187, a7
v_cvt_pk_bf16_f32 v32, v180, v181
v_cvt_pk_bf16_f32 v33, v182, v183
v_cvt_pk_bf16_f32 v34, v184, v185
v_cvt_pk_bf16_f32 v35, v186, v187
buffer_store_dwordx4 v[32:35], v252, s[20:23], s40 offen offset:0 sc1
v_accvgpr_read_b32 v180, a8
v_accvgpr_read_b32 v181, a9
v_accvgpr_read_b32 v182, a10
v_accvgpr_read_b32 v183, a11
v_accvgpr_read_b32 v184, a12
v_accvgpr_read_b32 v185, a13
v_accvgpr_read_b32 v186, a14
v_accvgpr_read_b32 v187, a15
v_cvt_pk_bf16_f32 v36, v180, v181
v_cvt_pk_bf16_f32 v37, v182, v183
v_cvt_pk_bf16_f32 v38, v184, v185
v_cvt_pk_bf16_f32 v39, v186, v187
buffer_store_dwordx4 v[36:39], v252, s[20:23], s40 offen offset:1024 sc1
v_accvgpr_read_b32 v180, a16
v_accvgpr_read_b32 v181, a17
v_accvgpr_read_b32 v182, a18
v_accvgpr_read_b32 v183, a19
v_accvgpr_read_b32 v184, a20
v_accvgpr_read_b32 v185, a21
v_accvgpr_read_b32 v186, a22
v_accvgpr_read_b32 v187, a23
v_cvt_pk_bf16_f32 v40, v180, v181
v_cvt_pk_bf16_f32 v41, v182, v183
v_cvt_pk_bf16_f32 v42, v184, v185
v_cvt_pk_bf16_f32 v43, v186, v187
buffer_store_dwordx4 v[40:43], v252, s[20:23], s40 offen offset:2048 sc1
v_accvgpr_read_b32 v180, a24
v_accvgpr_read_b32 v181, a25
v_accvgpr_read_b32 v182, a26
v_accvgpr_read_b32 v183, a27
v_accvgpr_read_b32 v184, a28
v_accvgpr_read_b32 v185, a29
v_accvgpr_read_b32 v186, a30
v_accvgpr_read_b32 v187, a31
v_cvt_pk_bf16_f32 v44, v180, v181
v_cvt_pk_bf16_f32 v45, v182, v183
v_cvt_pk_bf16_f32 v46, v184, v185
v_cvt_pk_bf16_f32 v47, v186, v187
buffer_store_dwordx4 v[44:47], v252, s[20:23], s40 offen offset:3072 sc1
v_accvgpr_read_b32 v180, a32
v_accvgpr_read_b32 v181, a33
v_accvgpr_read_b32 v182, a34
v_accvgpr_read_b32 v183, a35
v_accvgpr_read_b32 v184, a36
v_accvgpr_read_b32 v185, a37
v_accvgpr_read_b32 v186, a38
v_accvgpr_read_b32 v187, a39
v_cvt_pk_bf16_f32 v48, v180, v181
v_cvt_pk_bf16_f32 v49, v182, v183
v_cvt_pk_bf16_f32 v50, v184, v185
v_cvt_pk_bf16_f32 v51, v186, v187
buffer_store_dwordx4 v[48:51], v252, s[20:23], s44 offen offset:0 sc1
v_accvgpr_read_b32 v180, a40
v_accvgpr_read_b32 v181, a41
v_accvgpr_read_b32 v182, a42
v_accvgpr_read_b32 v183, a43
v_accvgpr_read_b32 v184, a44
v_accvgpr_read_b32 v185, a45
v_accvgpr_read_b32 v186, a46
v_accvgpr_read_b32 v187, a47
v_cvt_pk_bf16_f32 v52, v180, v181
v_cvt_pk_bf16_f32 v53, v182, v183
v_cvt_pk_bf16_f32 v54, v184, v185
v_cvt_pk_bf16_f32 v55, v186, v187
buffer_store_dwordx4 v[52:55], v252, s[20:23], s44 offen offset:1024 sc1
v_accvgpr_read_b32 v180, a48
v_accvgpr_read_b32 v181, a49
v_accvgpr_read_b32 v182, a50
v_accvgpr_read_b32 v183, a51
v_accvgpr_read_b32 v184, a52
v_accvgpr_read_b32 v185, a53
v_accvgpr_read_b32 v186, a54
v_accvgpr_read_b32 v187, a55
v_cvt_pk_bf16_f32 v56, v180, v181
v_cvt_pk_bf16_f32 v57, v182, v183
v_cvt_pk_bf16_f32 v58, v184, v185
v_cvt_pk_bf16_f32 v59, v186, v187
buffer_store_dwordx4 v[56:59], v252, s[20:23], s44 offen offset:2048 sc1
v_accvgpr_read_b32 v180, a56
v_accvgpr_read_b32 v181, a57
v_accvgpr_read_b32 v182, a58
v_accvgpr_read_b32 v183, a59
v_accvgpr_read_b32 v184, a60
v_accvgpr_read_b32 v185, a61
v_accvgpr_read_b32 v186, a62
v_accvgpr_read_b32 v187, a63
v_cvt_pk_bf16_f32 v60, v180, v181
v_cvt_pk_bf16_f32 v61, v182, v183
v_cvt_pk_bf16_f32 v62, v184, v185
v_cvt_pk_bf16_f32 v63, v186, v187
buffer_store_dwordx4 v[60:63], v252, s[20:23], s44 offen offset:3072 sc1
v_lshlrev_b32 v175, 2, v252
s_mov_b64 exec, 0xffff
buffer_store_dwordx2 v[172:173], v175, s[24:27], s48 offen sc1
s_mov_b64 exec, -1
s_waitcnt vmcnt(0)
s_add_u32 s40, s40, 8192
s_add_u32 s48, s48, 1024
s_sub_u32 s55, s55, 1
s_cmp_lg_u32 s55, 0
s_cbranch_scc1 LT_q
s_branch L2_fin
LE_start:
s_cmp_ge_u32 s37, 32
s_cbranch_scc1 L2_end
v_lshrrev_b32 v1, 6, v0
s_sub_u32 s37, s37, 30
s_lshl_b32 s35, s35, 1
v_readfirstlane_b32 s41, v1
s_add_u32 s35, s35, s37
s_mul_i32 s35, s35, 3
s_add_u32 s40, s35, s41
s_cmp_ge_u32 s41, 3
s_cbranch_scc1 L2_end
LE_common:
v_and_b32 v1, 63, v0
s_mov_b32 s42, 0
s_mov_b32 s49, 512
v_lshrrev_b32 v33, 1, v1
v_and_b32 v34, 1, v1
v_mul_u32_u24 v6, 0x5000, v33
v_lshl_add_u32 v6, v34, 4, v6
v_lshlrev_b32 v33, 2, v33
s_mul_i32 s50, s40, 655360
s_mul_i32 s48, s40, 128
s_waitcnt lgkmcnt(0)
s_add_u32 s8, s4, 0x7800000
s_addc_u32 s9, s5, 0
s_mov_b32 s10, 0x2000
s_mov_b32 s11, 0x00020000
s_add_u32 s12, s4, 0x8000000
s_addc_u32 s13, s5, 0
s_mov_b32 s14, 0x2800000
s_mov_b32 s15, 0x00020000
buffer_load_dword v4, v33, s[8:11], s48 offen
buffer_load_dwordx4 v[192:195], v6, s[12:15], s50 offen offset:0
buffer_load_dwordx4 v[196:199], v6, s[12:15], s50 offen offset:32
buffer_load_dwordx4 v[200:203], v6, s[12:15], s50 offen offset:64
buffer_load_dwordx4 v[204:207], v6, s[12:15], s50 offen offset:96
buffer_load_dwordx4 v[208:211], v6, s[12:15], s50 offen offset:128
buffer_load_dwordx4 v[212:215], v6, s[12:15], s50 offen offset:160
buffer_load_dwordx4 v[216:219], v6, s[12:15], s50 offen offset:192
buffer_load_dwordx4 v[220:223], v6, s[12:15], s50 offen offset:224
buffer_load_dwordx4 v[224:227], v6, s[12:15], s50 offen offset:256
buffer_load_dwordx4 v[228:231], v6, s[12:15], s50 offen offset:288
buffer_load_dwordx4 v[232:235], v6, s[12:15], s50 offen offset:320
buffer_load_dwordx4 v[236:239], v6, s[12:15], s50 offen offset:352
buffer_load_dwordx4 v[240:243], v6, s[12:15], s50 offen offset:384
buffer_load_dwordx4 v[244:247], v6, s[12:15], s50 offen offset:416
buffer_load_dwordx4 v[248:251], v6, s[12:15], s50 offen offset:448
buffer_load_dwordx4 v[252:255], v6, s[12:15], s50 offen offset:480
s_add_u32 s16, s4, 0x6800000
s_addc_u32 s17, s5, 0
s_mov_b32 s18, 0x4e2000
s_mov_b32 s19, 0x00020000
s_add_u32 s20, s4, 0x7000000
s_addc_u32 s21, s5, 0
s_mov_b32 s22, 0x4e2000
s_mov_b32 s23, 0x00020000
v_lshlrev_b32 v5, 2, v34
v_and_b32 v2, 15, v1
v_lshrrev_b32 v3, 4, v1
v_mov_b32 v16, 1
v_mov_b32 v17, 4
v_and_b32 v33, 1, v2
v_lshlrev_b32 v33, 4, v33
v_lshlrev_b32 v33, v33, v16
v_mul_u32_u24 v33, 0x3f80, v33
v_lshrrev_b32 v34, 1, v2
v_cmp_eq_u32 vcc, 0, v34
s_nop 1
v_cndmask_b32 v40, 0, v33, vcc
v_cmp_eq_u32 vcc, 1, v34
s_nop 1
v_cndmask_b32 v41, 0, v33, vcc
v_cmp_eq_u32 vcc, 2, v34
s_nop 1
v_cndmask_b32 v42, 0, v33, vcc
v_cmp_eq_u32 vcc, 3, v34
s_nop 1
v_cndmask_b32 v43, 0, v33, vcc
v_cmp_eq_u32 vcc, 4, v34
s_nop 1
v_cndmask_b32 v44, 0, v33, vcc
v_cmp_eq_u32 vcc, 5, v34
s_nop 1
v_cndmask_b32 v45, 0, v33, vcc
v_cmp_eq_u32 vcc, 6, v34
s_nop 1
v_cndmask_b32 v46, 0, v33, vcc
v_cmp_eq_u32 vcc, 7, v34
s_nop 1
v_cndmask_b32 v47, 0, v33, vcc
v_lshlrev_b32 v39, 5, v2
v_lshl_add_u32 v39, v3, 3, v39
v_lshlrev_b32 v2, 4, v2
s_mul_i32 s48, s41, 21504
s_add_u32 s48, s48, 4096
v_mov_b32 v36, s48
v_lshl_add_u32 v38, v3, 2, v36
s_lshl_b32 s36, s41, 10
v_mov_b32 v7, s36
v_lshlrev_b32 v35, 4, v1
v_add_u32 v68, s48, v35
v_add_u32 v35, s36, v35
v_lshlrev_b32 v33, 2, v1
v_mov_b32 v72, 0xffff
v_mov_b32 v73, 0xffff
v_mov_b32 v74, 0xffff
v_mov_b32 v75, 0xffff
v_cmp_gt_u32 vcc, 167, v33
v_mov_b32 v48, 0
s_nop 0
v_cndmask_b32 v18, 0, v16, vcc
v_cmp_gt_u32 vcc, 166, v33
v_mov_b32 v49, 0
s_nop 0
v_cndmask_b32 v19, 0, v16, vcc
v_cmp_gt_u32 vcc, 165, v33
v_mov_b32 v50, 0
s_nop 0
v_cndmask_b32 v20, 0, v16, vcc
v_cmp_gt_u32 vcc, 164, v33
v_mov_b32 v51, 0
s_nop 0
v_cndmask_b32 v21, 0, v16, vcc
LE_pass:
ds_write_b128 v35, v[48:51]
ds_write_b128 v68, v[72:75] offset:0
ds_write_b128 v68, v[72:75] offset:1024
ds_write_b128 v68, v[72:75] offset:2048
ds_write_b128 v68, v[72:75] offset:3072
ds_write_b128 v68, v[72:75] offset:4096
ds_write_b128 v68, v[72:75] offset:5120
ds_write_b128 v68, v[72:75] offset:6144
ds_write_b128 v68, v[72:75] offset:7168
ds_write_b128 v68, v[72:75] offset:8192
ds_write_b128 v68, v[72:75] offset:9216
ds_write_b128 v68, v[72:75] offset:10240
ds_write_b128 v68, v[72:75] offset:11264
ds_write_b128 v68, v[72:75] offset:12288
ds_write_b128 v68, v[72:75] offset:13312
ds_write_b128 v68, v[72:75] offset:14336
ds_write_b128 v68, v[72:75] offset:15360
ds_write_b128 v68, v[72:75] offset:16384
ds_write_b128 v68, v[72:75] offset:17408
ds_write_b128 v68, v[72:75] offset:18432
ds_write_b128 v68, v[72:75] offset:19456
v_lshl_add_u32 v32, v1, 2, v36
ds_write_b32 v32, v48 offset:20480
s_waitcnt vmcnt(16)
v_sub_u32 v32, v4, v5
s_waitcnt vmcnt(15)
v_cmpx_lt_i32 vcc, 0, v32
s_cbranch_execz LE_c
v_mad_u32_u16 v128, v192, 1, v7 op_sel:[1,0,0,0]
ds_add_u32 v128, v16
v_cmpx_lt_i32 vcc, 1, v32
v_mad_u32_u16 v129, v193, 1, v7 op_sel:[1,0,0,0]
ds_add_u32 v129, v16
v_cmpx_lt_i32 vcc, 2, v32
v_mad_u32_u16 v130, v194, 1, v7 op_sel:[1,0,0,0]
ds_add_u32 v130, v16
v_cmpx_lt_i32 vcc, 3, v32
v_mad_u32_u16 v131, v195, 1, v7 op_sel:[1,0,0,0]
ds_add_u32 v131, v16
s_waitcnt vmcnt(14)
v_cmpx_lt_i32 vcc, 8, v32
s_cbranch_execz LE_c
v_mad_u32_u16 v132, v196, 1, v7 op_sel:[1,0,0,0]
ds_add_u32 v132, v16
v_cmpx_lt_i32 vcc, 9, v32
v_mad_u32_u16 v133, v197, 1, v7 op_sel:[1,0,0,0]
ds_add_u32 v133, v16
v_cmpx_lt_i32 vcc, 10, v32
v_mad_u32_u16 v134, v198, 1, v7 op_sel:[1,0,0,0]
ds_add_u32 v134, v16
v_cmpx_lt_i32 vcc, 11, v32
v_mad_u32_u16 v135, v199, 1, v7 op_sel:[1,0,0,0]
ds_add_u32 v135, v16
s_waitcnt vmcnt(13)
v_cmpx_lt_i32 vcc, 16, v32
s_cbranch_execz LE_c
v_mad_u32_u16 v136, v200, 1, v7 op_sel:[1,0,0,0]
ds_add_u32 v136, v16
v_cmpx_lt_i32 vcc, 17, v32
v_mad_u32_u16 v137, v201, 1, v7 op_sel:[1,0,0,0]
ds_add_u32 v137, v16
v_cmpx_lt_i32 vcc, 18, v32
v_mad_u32_u16 v138, v202, 1, v7 op_sel:[1,0,0,0]
ds_add_u32 v138, v16
v_cmpx_lt_i32 vcc, 19, v32
v_mad_u32_u16 v139, v203, 1, v7 op_sel:[1,0,0,0]
ds_add_u32 v139, v16
s_waitcnt vmcnt(12)
v_cmpx_lt_i32 vcc, 24, v32
s_cbranch_execz LE_c
v_mad_u32_u16 v140, v204, 1, v7 op_sel:[1,0,0,0]
ds_add_u32 v140, v16
v_cmpx_lt_i32 vcc, 25, v32
v_mad_u32_u16 v141, v205, 1, v7 op_sel:[1,0,0,0]
ds_add_u32 v141, v16
v_cmpx_lt_i32 vcc, 26, v32
v_mad_u32_u16 v142, v206, 1, v7 op_sel:[1,0,0,0]
ds_add_u32 v142, v16
v_cmpx_lt_i32 vcc, 27, v32
v_mad_u32_u16 v143, v207, 1, v7 op_sel:[1,0,0,0]
ds_add_u32 v143, v16
s_waitcnt vmcnt(11)
v_cmpx_lt_i32 vcc, 32, v32
s_cbranch_execz LE_c
v_mad_u32_u16 v144, v208, 1, v7 op_sel:[1,0,0,0]
ds_add_u32 v144, v16
v_cmpx_lt_i32 vcc, 33, v32
v_mad_u32_u16 v145, v209, 1, v7 op_sel:[1,0,0,0]
ds_add_u32 v145, v16
v_cmpx_lt_i32 vcc, 34, v32
v_mad_u32_u16 v146, v210, 1, v7 op_sel:[1,0,0,0]
ds_add_u32 v146, v16
v_cmpx_lt_i32 vcc, 35, v32
v_mad_u32_u16 v147, v211, 1, v7 op_sel:[1,0,0,0]
ds_add_u32 v147, v16
s_waitcnt vmcnt(10)
v_cmpx_lt_i32 vcc, 40, v32
s_cbranch_execz LE_c
v_mad_u32_u16 v148, v212, 1, v7 op_sel:[1,0,0,0]
ds_add_u32 v148, v16
v_cmpx_lt_i32 vcc, 41, v32
v_mad_u32_u16 v149, v213, 1, v7 op_sel:[1,0,0,0]
ds_add_u32 v149, v16
v_cmpx_lt_i32 vcc, 42, v32
v_mad_u32_u16 v150, v214, 1, v7 op_sel:[1,0,0,0]
ds_add_u32 v150, v16
v_cmpx_lt_i32 vcc, 43, v32
v_mad_u32_u16 v151, v215, 1, v7 op_sel:[1,0,0,0]
ds_add_u32 v151, v16
s_waitcnt vmcnt(9)
v_cmpx_lt_i32 vcc, 48, v32
s_cbranch_execz LE_c
v_mad_u32_u16 v152, v216, 1, v7 op_sel:[1,0,0,0]
ds_add_u32 v152, v16
v_cmpx_lt_i32 vcc, 49, v32
v_mad_u32_u16 v153, v217, 1, v7 op_sel:[1,0,0,0]
ds_add_u32 v153, v16
v_cmpx_lt_i32 vcc, 50, v32
v_mad_u32_u16 v154, v218, 1, v7 op_sel:[1,0,0,0]
ds_add_u32 v154, v16
v_cmpx_lt_i32 vcc, 51, v32
v_mad_u32_u16 v155, v219, 1, v7 op_sel:[1,0,0,0]
ds_add_u32 v155, v16
s_waitcnt vmcnt(8)
v_cmpx_lt_i32 vcc, 56, v32
s_cbranch_execz LE_c
v_mad_u32_u16 v156, v220, 1, v7 op_sel:[1,0,0,0]
ds_add_u32 v156, v16
v_cmpx_lt_i32 vcc, 57, v32
v_mad_u32_u16 v157, v221, 1, v7 op_sel:[1,0,0,0]
ds_add_u32 v157, v16
v_cmpx_lt_i32 vcc, 58, v32
v_mad_u32_u16 v158, v222, 1, v7 op_sel:[1,0,0,0]
ds_add_u32 v158, v16
v_cmpx_lt_i32 vcc, 59, v32
v_mad_u32_u16 v159, v223, 1, v7 op_sel:[1,0,0,0]
ds_add_u32 v159, v16
s_waitcnt vmcnt(7)
v_cmpx_lt_i32 vcc, 64, v32
s_cbranch_execz LE_c
v_mad_u32_u16 v160, v224, 1, v7 op_sel:[1,0,0,0]
ds_add_u32 v160, v16
v_cmpx_lt_i32 vcc, 65, v32
v_mad_u32_u16 v161, v225, 1, v7 op_sel:[1,0,0,0]
ds_add_u32 v161, v16
v_cmpx_lt_i32 vcc, 66, v32
v_mad_u32_u16 v162, v226, 1, v7 op_sel:[1,0,0,0]
ds_add_u32 v162, v16
v_cmpx_lt_i32 vcc, 67, v32
v_mad_u32_u16 v163, v227, 1, v7 op_sel:[1,0,0,0]
ds_add_u32 v163, v16
s_waitcnt vmcnt(6)
v_cmpx_lt_i32 vcc, 72, v32
s_cbranch_execz LE_c
v_mad_u32_u16 v164, v228, 1, v7 op_sel:[1,0,0,0]
ds_add_u32 v164, v16
v_cmpx_lt_i32 vcc, 73, v32
v_mad_u32_u16 v165, v229, 1, v7 op_sel:[1,0,0,0]
ds_add_u32 v165, v16
v_cmpx_lt_i32 vcc, 74, v32
v_mad_u32_u16 v166, v230, 1, v7 op_sel:[1,0,0,0]
ds_add_u32 v166, v16
v_cmpx_lt_i32 vcc, 75, v32
v_mad_u32_u16 v167, v231, 1, v7 op_sel:[1,0,0,0]
ds_add_u32 v167, v16
s_waitcnt vmcnt(5)
v_cmpx_lt_i32 vcc, 80, v32
s_cbranch_execz LE_c
v_mad_u32_u16 v168, v232, 1, v7 op_sel:[1,0,0,0]
ds_add_u32 v168, v16
v_cmpx_lt_i32 vcc, 81, v32
v_mad_u32_u16 v169, v233, 1, v7 op_sel:[1,0,0,0]
ds_add_u32 v169, v16
v_cmpx_lt_i32 vcc, 82, v32
v_mad_u32_u16 v170, v234, 1, v7 op_sel:[1,0,0,0]
ds_add_u32 v170, v16
v_cmpx_lt_i32 vcc, 83, v32
v_mad_u32_u16 v171, v235, 1, v7 op_sel:[1,0,0,0]
ds_add_u32 v171, v16
s_waitcnt vmcnt(4)
v_cmpx_lt_i32 vcc, 88, v32
s_cbranch_execz LE_c
v_mad_u32_u16 v172, v236, 1, v7 op_sel:[1,0,0,0]
ds_add_u32 v172, v16
v_cmpx_lt_i32 vcc, 89, v32
v_mad_u32_u16 v173, v237, 1, v7 op_sel:[1,0,0,0]
ds_add_u32 v173, v16
v_cmpx_lt_i32 vcc, 90, v32
v_mad_u32_u16 v174, v238, 1, v7 op_sel:[1,0,0,0]
ds_add_u32 v174, v16
v_cmpx_lt_i32 vcc, 91, v32
v_mad_u32_u16 v175, v239, 1, v7 op_sel:[1,0,0,0]
ds_add_u32 v175, v16
s_waitcnt vmcnt(3)
v_cmpx_lt_i32 vcc, 96, v32
s_cbranch_execz LE_c
v_mad_u32_u16 v176, v240, 1, v7 op_sel:[1,0,0,0]
ds_add_u32 v176, v16
v_cmpx_lt_i32 vcc, 97, v32
v_mad_u32_u16 v177, v241, 1, v7 op_sel:[1,0,0,0]
ds_add_u32 v177, v16
v_cmpx_lt_i32 vcc, 98, v32
v_mad_u32_u16 v178, v242, 1, v7 op_sel:[1,0,0,0]
ds_add_u32 v178, v16
v_cmpx_lt_i32 vcc, 99, v32
v_mad_u32_u16 v179, v243, 1, v7 op_sel:[1,0,0,0]
ds_add_u32 v179, v16
s_waitcnt vmcnt(2)
v_cmpx_lt_i32 vcc, 104, v32
s_cbranch_execz LE_c
v_mad_u32_u16 v180, v244, 1, v7 op_sel:[1,0,0,0]
ds_add_u32 v180, v16
v_cmpx_lt_i32 vcc, 105, v32
v_mad_u32_u16 v181, v245, 1, v7 op_sel:[1,0,0,0]
ds_add_u32 v181, v16
v_cmpx_lt_i32 vcc, 106, v32
v_mad_u32_u16 v182, v246, 1, v7 op_sel:[1,0,0,0]
ds_add_u32 v182, v16
v_cmpx_lt_i32 vcc, 107, v32
v_mad_u32_u16 v183, v247, 1, v7 op_sel:[1,0,0,0]
ds_add_u32 v183, v16
s_waitcnt vmcnt(1)
v_cmpx_lt_i32 vcc, 112, v32
s_cbranch_execz LE_c
v_mad_u32_u16 v184, v248, 1, v7 op_sel:[1,0,0,0]
ds_add_u32 v184, v16
v_cmpx_lt_i32 vcc, 113, v32
v_mad_u32_u16 v185, v249, 1, v7 op_sel:[1,0,0,0]
ds_add_u32 v185, v16
v_cmpx_lt_i32 vcc, 114, v32
v_mad_u32_u16 v186, v250, 1, v7 op_sel:[1,0,0,0]
ds_add_u32 v186, v16
v_cmpx_lt_i32 vcc, 115, v32
v_mad_u32_u16 v187, v251, 1, v7 op_sel:[1,0,0,0]
ds_add_u32 v187, v16
s_waitcnt vmcnt(0)
v_cmpx_lt_i32 vcc, 120, v32
s_cbranch_execz LE_c
v_mad_u32_u16 v188, v252, 1, v7 op_sel:[1,0,0,0]
ds_add_u32 v188, v16
v_cmpx_lt_i32 vcc, 121, v32
v_mad_u32_u16 v189, v253, 1, v7 op_sel:[1,0,0,0]
ds_add_u32 v189, v16
v_cmpx_lt_i32 vcc, 122, v32
v_mad_u32_u16 v190, v254, 1, v7 op_sel:[1,0,0,0]
ds_add_u32 v190, v16
v_cmpx_lt_i32 vcc, 123, v32
v_mad_u32_u16 v191, v255, 1, v7 op_sel:[1,0,0,0]
ds_add_u32 v191, v16
LE_c:
s_mov_b64 exec, -1
ds_read_b128 v[24:27], v35
s_waitcnt lgkmcnt(0)
v_add_u32 v24, 3, v24
v_lshrrev_b32 v24, 2, v24
v_max_u32 v24, v24, v18
v_add_u32 v25, 3, v25
v_lshrrev_b32 v25, 2, v25
v_max_u32 v25, v25, v19
v_add_u32 v26, 3, v26
v_lshrrev_b32 v26, 2, v26
v_max_u32 v26, v26, v20
v_add_u32 v27, 3, v27
v_lshrrev_b32 v27, 2, v27
v_max_u32 v27, v27, v21
v_add_u32 v33, v24, v25
v_add3_u32 v33, v33, v26, v27
v_mov_b32 v64, v33
s_nop 1
v_add_u32_dpp v64, v64, v64 row_shr:1 row_mask:0xf bank_mask:0xf
s_nop 1
v_add_u32_dpp v64, v64, v64 row_shr:2 row_mask:0xf bank_mask:0xf
s_nop 1
v_add_u32_dpp v64, v64, v64 row_shr:4 row_mask:0xf bank_mask:0xf
s_nop 1
v_add_u32_dpp v64, v64, v64 row_shr:8 row_mask:0xf bank_mask:0xf
s_nop 1
v_add_u32_dpp v64, v64, v64 row_bcast:15 row_mask:0xa bank_mask:0xf
s_nop 1
v_add_u32_dpp v64, v64, v64 row_bcast:31 row_mask:0xc bank_mask:0xf
s_nop 1
v_readlane_b32 s44, v64, 63
v_sub_u32 v28, v64, v33
v_add_u32 v29, v28, v24
v_add_u32 v30, v29, v25
v_add_u32 v31, v30, v26
v_add3_u32 v33, v28, v24, -1
v_lshlrev_b32 v34, v33, v18
v_lshrrev_b32 v33, 5, v33
v_lshl_add_u32 v33, v33, 2, v36
ds_or_b32 v33, v34 offset:20480
v_lshl_add_u32 v28, v28, 4, v36
v_add3_u32 v33, v29, v25, -1
v_lshlrev_b32 v34, v33, v19
v_lshrrev_b32 v33, 5, v33
v_lshl_add_u32 v33, v33, 2, v36
ds_or_b32 v33, v34 offset:20480
v_lshl_add_u32 v29, v29, 4, v36
v_add3_u32 v33, v30, v26, -1
v_lshlrev_b32 v34, v33, v20
v_lshrrev_b32 v33, 5, v33
v_lshl_add_u32 v33, v33, 2, v36
ds_or_b32 v33, v34 offset:20480
v_lshl_add_u32 v30, v30, 4, v36
v_add3_u32 v33, v31, v27, -1
v_lshlrev_b32 v34, v33, v21
v_lshrrev_b32 v33, 5, v33
v_lshl_add_u32 v33, v33, 2, v36
ds_or_b32 v33, v34 offset:20480
v_lshl_add_u32 v31, v31, 4, v36
ds_write_b128 v35, v[28:31]
s_add_u32 s44, s44, 31
s_lshr_b32 s44, s44, 5
v_cmpx_lt_i32 vcc, 0, v32
s_cbranch_execz LE_p
ds_add_rtn_u32 v128, v128, v17
v_cmpx_lt_i32 vcc, 1, v32
ds_add_rtn_u32 v129, v129, v17
v_cmpx_lt_i32 vcc, 2, v32
ds_add_rtn_u32 v130, v130, v17
v_cmpx_lt_i32 vcc, 3, v32
ds_add_rtn_u32 v131, v131, v17
v_cmpx_lt_i32 vcc, 8, v32
s_cbranch_execz LE_p
ds_add_rtn_u32 v132, v132, v17
v_cmpx_lt_i32 vcc, 9, v32
ds_add_rtn_u32 v133, v133, v17
v_cmpx_lt_i32 vcc, 10, v32
ds_add_rtn_u32 v134, v134, v17
v_cmpx_lt_i32 vcc, 11, v32
ds_add_rtn_u32 v135, v135, v17
v_cmpx_lt_i32 vcc, 16, v32
s_cbranch_execz LE_p
ds_add_rtn_u32 v136, v136, v17
v_cmpx_lt_i32 vcc, 17, v32
ds_add_rtn_u32 v137, v137, v17
v_cmpx_lt_i32 vcc, 18, v32
ds_add_rtn_u32 v138, v138, v17
v_cmpx_lt_i32 vcc, 19, v32
ds_add_rtn_u32 v139, v139, v17
v_cmpx_lt_i32 vcc, 24, v32
s_cbranch_execz LE_p
ds_add_rtn_u32 v140, v140, v17
v_cmpx_lt_i32 vcc, 25, v32
ds_add_rtn_u32 v141, v141, v17
v_cmpx_lt_i32 vcc, 26, v32
ds_add_rtn_u32 v142, v142, v17
v_cmpx_lt_i32 vcc, 27, v32
ds_add_rtn_u32 v143, v143, v17
v_cmpx_lt_i32 vcc, 32, v32
s_cbranch_execz LE_p
ds_add_rtn_u32 v144, v144, v17
v_cmpx_lt_i32 vcc, 33, v32
ds_add_rtn_u32 v145, v145, v17
v_cmpx_lt_i32 vcc, 34, v32
ds_add_rtn_u32 v146, v146, v17
v_cmpx_lt_i32 vcc, 35, v32
ds_add_rtn_u32 v147, v147, v17
v_cmpx_lt_i32 vcc, 40, v32
s_cbranch_execz LE_p
ds_add_rtn_u32 v148, v148, v17
v_cmpx_lt_i32 vcc, 41, v32
ds_add_rtn_u32 v149, v149, v17
v_cmpx_lt_i32 vcc, 42, v32
ds_add_rtn_u32 v150, v150, v17
v_cmpx_lt_i32 vcc, 43, v32
ds_add_rtn_u32 v151, v151, v17
v_cmpx_lt_i32 vcc, 48, v32
s_cbranch_execz LE_p
ds_add_rtn_u32 v152, v152, v17
v_cmpx_lt_i32 vcc, 49, v32
ds_add_rtn_u32 v153, v153, v17
v_cmpx_lt_i32 vcc, 50, v32
ds_add_rtn_u32 v154, v154, v17
v_cmpx_lt_i32 vcc, 51, v32
ds_add_rtn_u32 v155, v155, v17
v_cmpx_lt_i32 vcc, 56, v32
s_cbranch_execz LE_p
ds_add_rtn_u32 v156, v156, v17
v_cmpx_lt_i32 vcc, 57, v32
ds_add_rtn_u32 v157, v157, v17
v_cmpx_lt_i32 vcc, 58, v32
ds_add_rtn_u32 v158, v158, v17
v_cmpx_lt_i32 vcc, 59, v32
ds_add_rtn_u32 v159, v159, v17
v_cmpx_lt_i32 vcc, 64, v32
s_cbranch_execz LE_p
ds_add_rtn_u32 v160, v160, v17
v_cmpx_lt_i32 vcc, 65, v32
ds_add_rtn_u32 v161, v161, v17
v_cmpx_lt_i32 vcc, 66, v32
ds_add_rtn_u32 v162, v162, v17
v_cmpx_lt_i32 vcc, 67, v32
ds_add_rtn_u32 v163, v163, v17
v_cmpx_lt_i32 vcc, 72, v32
s_cbranch_execz LE_p
ds_add_rtn_u32 v164, v164, v17
v_cmpx_lt_i32 vcc, 73, v32
ds_add_rtn_u32 v165, v165, v17
v_cmpx_lt_i32 vcc, 74, v32
ds_add_rtn_u32 v166, v166, v17
v_cmpx_lt_i32 vcc, 75, v32
ds_add_rtn_u32 v167, v167, v17
v_cmpx_lt_i32 vcc, 80, v32
s_cbranch_execz LE_p
ds_add_rtn_u32 v168, v168, v17
v_cmpx_lt_i32 vcc, 81, v32
ds_add_rtn_u32 v169, v169, v17
v_cmpx_lt_i32 vcc, 82, v32
ds_add_rtn_u32 v170, v170, v17
v_cmpx_lt_i32 vcc, 83, v32
ds_add_rtn_u32 v171, v171, v17
v_cmpx_lt_i32 vcc, 88, v32
s_cbranch_execz LE_p
ds_add_rtn_u32 v172, v172, v17
v_cmpx_lt_i32 vcc, 89, v32
ds_add_rtn_u32 v173, v173, v17
v_cmpx_lt_i32 vcc, 90, v32
ds_add_rtn_u32 v174, v174, v17
v_cmpx_lt_i32 vcc, 91, v32
ds_add_rtn_u32 v175, v175, v17
v_cmpx_lt_i32 vcc, 96, v32
s_cbranch_execz LE_p
ds_add_rtn_u32 v176, v176, v17
v_cmpx_lt_i32 vcc, 97, v32
ds_add_rtn_u32 v177, v177, v17
v_cmpx_lt_i32 vcc, 98, v32
ds_add_rtn_u32 v178, v178, v17
v_cmpx_lt_i32 vcc, 99, v32
ds_add_rtn_u32 v179, v179, v17
v_cmpx_lt_i32 vcc, 104, v32
s_cbranch_execz LE_p
ds_add_rtn_u32 v180, v180, v17
v_cmpx_lt_i32 vcc, 105, v32
ds_add_rtn_u32 v181, v181, v17
v_cmpx_lt_i32 vcc, 106, v32
ds_add_rtn_u32 v182, v182, v17
v_cmpx_lt_i32 vcc, 107, v32
ds_add_rtn_u32 v183, v183, v17
v_cmpx_lt_i32 vcc, 112, v32
s_cbranch_execz LE_p
ds_add_rtn_u32 v184, v184, v17
v_cmpx_lt_i32 vcc, 113, v32
ds_add_rtn_u32 v185, v185, v17
v_cmpx_lt_i32 vcc, 114, v32
ds_add_rtn_u32 v186, v186, v17
v_cmpx_lt_i32 vcc, 115, v32
ds_add_rtn_u32 v187, v187, v17
v_cmpx_lt_i32 vcc, 120, v32
s_cbranch_execz LE_p
ds_add_rtn_u32 v188, v188, v17
v_cmpx_lt_i32 vcc, 121, v32
ds_add_rtn_u32 v189, v189, v17
v_cmpx_lt_i32 vcc, 122, v32
ds_add_rtn_u32 v190, v190, v17
v_cmpx_lt_i32 vcc, 123, v32
ds_add_rtn_u32 v191, v191, v17
LE_p:
s_mov_b64 exec, -1
v_lshl_add_u32 v33, v1, 2, v36
ds_read_b32 v37, v33 offset:20480
s_waitcnt lgkmcnt(0)
v_cmpx_lt_i32 vcc, 0, v32
s_cbranch_execz LE_w
ds_write_b32 v128, v192
v_cmpx_lt_i32 vcc, 1, v32
ds_write_b32 v129, v193
v_cmpx_lt_i32 vcc, 2, v32
ds_write_b32 v130, v194
v_cmpx_lt_i32 vcc, 3, v32
ds_write_b32 v131, v195
v_cmpx_lt_i32 vcc, 8, v32
s_cbranch_execz LE_w
ds_write_b32 v132, v196
v_cmpx_lt_i32 vcc, 9, v32
ds_write_b32 v133, v197
v_cmpx_lt_i32 vcc, 10, v32
ds_write_b32 v134, v198
v_cmpx_lt_i32 vcc, 11, v32
ds_write_b32 v135, v199
v_cmpx_lt_i32 vcc, 16, v32
s_cbranch_execz LE_w
ds_write_b32 v136, v200
v_cmpx_lt_i32 vcc, 17, v32
ds_write_b32 v137, v201
v_cmpx_lt_i32 vcc, 18, v32
ds_write_b32 v138, v202
v_cmpx_lt_i32 vcc, 19, v32
ds_write_b32 v139, v203
v_cmpx_lt_i32 vcc, 24, v32
s_cbranch_execz LE_w
ds_write_b32 v140, v204
v_cmpx_lt_i32 vcc, 25, v32
ds_write_b32 v141, v205
v_cmpx_lt_i32 vcc, 26, v32
ds_write_b32 v142, v206
v_cmpx_lt_i32 vcc, 27, v32
ds_write_b32 v143, v207
v_cmpx_lt_i32 vcc, 32, v32
s_cbranch_execz LE_w
ds_write_b32 v144, v208
v_cmpx_lt_i32 vcc, 33, v32
ds_write_b32 v145, v209
v_cmpx_lt_i32 vcc, 34, v32
ds_write_b32 v146, v210
v_cmpx_lt_i32 vcc, 35, v32
ds_write_b32 v147, v211
v_cmpx_lt_i32 vcc, 40, v32
s_cbranch_execz LE_w
ds_write_b32 v148, v212
v_cmpx_lt_i32 vcc, 41, v32
ds_write_b32 v149, v213
v_cmpx_lt_i32 vcc, 42, v32
ds_write_b32 v150, v214
v_cmpx_lt_i32 vcc, 43, v32
ds_write_b32 v151, v215
v_cmpx_lt_i32 vcc, 48, v32
s_cbranch_execz LE_w
ds_write_b32 v152, v216
v_cmpx_lt_i32 vcc, 49, v32
ds_write_b32 v153, v217
v_cmpx_lt_i32 vcc, 50, v32
ds_write_b32 v154, v218
v_cmpx_lt_i32 vcc, 51, v32
ds_write_b32 v155, v219
v_cmpx_lt_i32 vcc, 56, v32
s_cbranch_execz LE_w
ds_write_b32 v156, v220
v_cmpx_lt_i32 vcc, 57, v32
ds_write_b32 v157, v221
v_cmpx_lt_i32 vcc, 58, v32
ds_write_b32 v158, v222
v_cmpx_lt_i32 vcc, 59, v32
ds_write_b32 v159, v223
v_cmpx_lt_i32 vcc, 64, v32
s_cbranch_execz LE_w
ds_write_b32 v160, v224
v_cmpx_lt_i32 vcc, 65, v32
ds_write_b32 v161, v225
v_cmpx_lt_i32 vcc, 66, v32
ds_write_b32 v162, v226
v_cmpx_lt_i32 vcc, 67, v32
ds_write_b32 v163, v227
v_cmpx_lt_i32 vcc, 72, v32
s_cbranch_execz LE_w
ds_write_b32 v164, v228
v_cmpx_lt_i32 vcc, 73, v32
ds_write_b32 v165, v229
v_cmpx_lt_i32 vcc, 74, v32
ds_write_b32 v166, v230
v_cmpx_lt_i32 vcc, 75, v32
ds_write_b32 v167, v231
v_cmpx_lt_i32 vcc, 80, v32
s_cbranch_execz LE_w
ds_write_b32 v168, v232
v_cmpx_lt_i32 vcc, 81, v32
ds_write_b32 v169, v233
v_cmpx_lt_i32 vcc, 82, v32
ds_write_b32 v170, v234
v_cmpx_lt_i32 vcc, 83, v32
ds_write_b32 v171, v235
v_cmpx_lt_i32 vcc, 88, v32
s_cbranch_execz LE_w
ds_write_b32 v172, v236
v_cmpx_lt_i32 vcc, 89, v32
ds_write_b32 v173, v237
v_cmpx_lt_i32 vcc, 90, v32
ds_write_b32 v174, v238
v_cmpx_lt_i32 vcc, 91, v32
ds_write_b32 v175, v239
v_cmpx_lt_i32 vcc, 96, v32
s_cbranch_execz LE_w
ds_write_b32 v176, v240
v_cmpx_lt_i32 vcc, 97, v32
ds_write_b32 v177, v241
v_cmpx_lt_i32 vcc, 98, v32
ds_write_b32 v178, v242
v_cmpx_lt_i32 vcc, 99, v32
ds_write_b32 v179, v243
v_cmpx_lt_i32 vcc, 104, v32
s_cbranch_execz LE_w
ds_write_b32 v180, v244
v_cmpx_lt_i32 vcc, 105, v32
ds_write_b32 v181, v245
v_cmpx_lt_i32 vcc, 106, v32
ds_write_b32 v182, v246
v_cmpx_lt_i32 vcc, 107, v32
ds_write_b32 v183, v247
v_cmpx_lt_i32 vcc, 112, v32
s_cbranch_execz LE_w
ds_write_b32 v184, v248
v_cmpx_lt_i32 vcc, 113, v32
ds_write_b32 v185, v249
v_cmpx_lt_i32 vcc, 114, v32
ds_write_b32 v186, v250
v_cmpx_lt_i32 vcc, 115, v32
ds_write_b32 v187, v251
v_cmpx_lt_i32 vcc, 120, v32
s_cbranch_execz LE_w
ds_write_b32 v188, v252
v_cmpx_lt_i32 vcc, 121, v32
ds_write_b32 v189, v253
v_cmpx_lt_i32 vcc, 122, v32
ds_write_b32 v190, v254
v_cmpx_lt_i32 vcc, 123, v32
ds_write_b32 v191, v255
LE_w:
s_mov_b64 exec, -1
v_mov_b32 v34, v38
ds_read2_b32 v[52:53], v34 offset0:0 offset1:4
ds_read2_b32 v[54:55], v34 offset0:8 offset1:12
s_waitcnt lgkmcnt(0)
ds_read2_b32 v[56:57], v34 offset0:16 offset1:20
ds_read2_b32 v[58:59], v34 offset0:24 offset1:28
v_mad_u32_u16 v60, v52, s49, v2
v_mad_u32_u16 v61, v53, s49, v2
v_mad_u32_u16 v62, v54, s49, v2
v_mad_u32_u16 v63, v55, s49, v2
buffer_load_dwordx4 a[0:3], v60, s[16:19], 0 offen
buffer_load_dwordx4 a[4:7], v60, s[16:19], 0 offen offset:256
buffer_load_dwordx4 a[8:11], v61, s[16:19], 0 offen
buffer_load_dwordx4 a[12:15], v61, s[16:19], 0 offen offset:256
buffer_load_dwordx4 a[16:19], v62, s[16:19], 0 offen
buffer_load_dwordx4 a[20:23], v62, s[16:19], 0 offen offset:256
buffer_load_dwordx4 a[24:27], v63, s[16:19], 0 offen
buffer_load_dwordx4 a[28:31], v63, s[16:19], 0 offen offset:256
s_waitcnt lgkmcnt(0)
ds_read2_b32 v[52:53], v34 offset0:32 offset1:36
ds_read2_b32 v[54:55], v34 offset0:40 offset1:44
v_mad_u32_u16 v60, v56, s49, v2
v_mad_u32_u16 v61, v57, s49, v2
v_mad_u32_u16 v62, v58, s49, v2
v_mad_u32_u16 v63, v59, s49, v2
buffer_load_dwordx4 a[32:35], v60, s[16:19], 0 offen
buffer_load_dwordx4 a[36:39], v60, s[16:19], 0 offen offset:256
buffer_load_dwordx4 a[40:43], v61, s[16:19], 0 offen
buffer_load_dwordx4 a[44:47], v61, s[16:19], 0 offen offset:256
buffer_load_dwordx4 a[48:51], v62, s[16:19], 0 offen
buffer_load_dwordx4 a[52:55], v62, s[16:19], 0 offen offset:256
buffer_load_dwordx4 a[56:59], v63, s[16:19], 0 offen
buffer_load_dwordx4 a[60:63], v63, s[16:19], 0 offen offset:256
s_waitcnt lgkmcnt(0)
ds_read2_b32 v[56:57], v34 offset0:48 offset1:52
ds_read2_b32 v[58:59], v34 offset0:56 offset1:60
v_mad_u32_u16 v60, v52, s49, v2
v_mad_u32_u16 v61, v53, s49, v2
v_mad_u32_u16 v62, v54, s49, v2
v_mad_u32_u16 v63, v55, s49, v2
buffer_load_dwordx4 a[64:67], v60, s[16:19], 0 offen
buffer_load_dwordx4 a[68:71], v60, s[16:19], 0 offen offset:256
buffer_load_dwordx4 a[72:75], v61, s[16:19], 0 offen
buffer_load_dwordx4 a[76:79], v61, s[16:19], 0 offen offset:256
buffer_load_dwordx4 a[80:83], v62, s[16:19], 0 offen
buffer_load_dwordx4 a[84:87], v62, s[16:19], 0 offen offset:256
buffer_load_dwordx4 a[88:91], v63, s[16:19], 0 offen
buffer_load_dwordx4 a[92:95], v63, s[16:19], 0 offen offset:256
s_waitcnt lgkmcnt(0)
ds_read2_b32 v[52:53], v34 offset0:64 offset1:68
ds_read2_b32 v[54:55], v34 offset0:72 offset1:76
v_mad_u32_u16 v60, v56, s49, v2
v_mad_u32_u16 v61, v57, s49, v2
v_mad_u32_u16 v62, v58, s49, v2
v_mad_u32_u16 v63, v59, s49, v2
buffer_load_dwordx4 a[96:99], v60, s[16:19], 0 offen
buffer_load_dwordx4 a[100:103], v60, s[16:19], 0 offen offset:256
buffer_load_dwordx4 a[104:107], v61, s[16:19], 0 offen
buffer_load_dwordx4 a[108:111], v61, s[16:19], 0 offen offset:256
buffer_load_dwordx4 a[112:115], v62, s[16:19], 0 offen
buffer_load_dwordx4 a[116:119], v62, s[16:19], 0 offen offset:256
buffer_load_dwordx4 a[120:123], v63, s[16:19], 0 offen
buffer_load_dwordx4 a[124:127], v63, s[16:19], 0 offen offset:256
s_waitcnt lgkmcnt(0)
ds_read2_b32 v[56:57], v34 offset0:80 offset1:84
ds_read2_b32 v[58:59], v34 offset0:88 offset1:92
v_mad_u32_u16 v60, v52, s49, v2
v_mad_u32_u16 v61, v53, s49, v2
v_mad_u32_u16 v62, v54, s49, v2
v_mad_u32_u16 v63, v55, s49, v2
buffer_load_dwordx4 a[128:131], v60, s[16:19], 0 offen
buffer_load_dwordx4 a[132:135], v60, s[16:19], 0 offen offset:256
buffer_load_dwordx4 a[136:139], v61, s[16:19], 0 offen
buffer_load_dwordx4 a[140:143], v61, s[16:19], 0 offen offset:256
buffer_load_dwordx4 a[144:147], v62, s[16:19], 0 offen
buffer_load_dwordx4 a[148:151], v62, s[16:19], 0 offen offset:256
buffer_load_dwordx4 a[152:155], v63, s[16:19], 0 offen
buffer_load_dwordx4 a[156:159], v63, s[16:19], 0 offen offset:256
s_waitcnt lgkmcnt(0)
ds_read2_b32 v[52:53], v34 offset0:96 offset1:100
ds_read2_b32 v[54:55], v34 offset0:104 offset1:108
v_mad_u32_u16 v60, v56, s49, v2
v_mad_u32_u16 v61, v57, s49, v2
v_mad_u32_u16 v62, v58, s49, v2
v_mad_u32_u16 v63, v59, s49, v2
buffer_load_dwordx4 a[160:163], v60, s[16:19], 0 offen
buffer_load_dwordx4 a[164:167], v60, s[16:19], 0 offen offset:256
buffer_load_dwordx4 a[168:171], v61, s[16:19], 0 offen
buffer_load_dwordx4 a[172:175], v61, s[16:19], 0 offen offset:256
buffer_load_dwordx4 a[176:179], v62, s[16:19], 0 offen
buffer_load_dwordx4 a[180:183], v62, s[16:19], 0 offen offset:256
buffer_load_dwordx4 a[184:187], v63, s[16:19], 0 offen
buffer_load_dwordx4 a[188:191], v63, s[16:19], 0 offen offset:256
s_waitcnt lgkmcnt(0)
ds_read2_b32 v[56:57], v34 offset0:112 offset1:116
ds_read2_b32 v[58:59], v34 offset0:120 offset1:124
v_mad_u32_u16 v60, v52, s49, v2
v_mad_u32_u16 v61, v53, s49, v2
v_mad_u32_u16 v62, v54, s49, v2
v_mad_u32_u16 v63, v55, s49, v2
buffer_load_dwordx4 a[192:195], v60, s[16:19], 0 offen
buffer_load_dwordx4 a[196:199], v60, s[16:19], 0 offen offset:256
buffer_load_dwordx4 a[200:203], v61, s[16:19], 0 offen
buffer_load_dwordx4 a[204:207], v61, s[16:19], 0 offen offset:256
buffer_load_dwordx4 a[208:211], v62, s[16:19], 0 offen
buffer_load_dwordx4 a[212:215], v62, s[16:19], 0 offen offset:256
buffer_load_dwordx4 a[216:219], v63, s[16:19], 0 offen
buffer_load_dwordx4 a[220:223], v63, s[16:19], 0 offen offset:256
s_waitcnt lgkmcnt(0)
ds_read2_b32 v[52:53], v34 offset0:128 offset1:132
ds_read2_b32 v[54:55], v34 offset0:136 offset1:140
v_mad_u32_u16 v60, v56, s49, v2
v_mad_u32_u16 v61, v57, s49, v2
v_mad_u32_u16 v62, v58, s49, v2
v_mad_u32_u16 v63, v59, s49, v2
buffer_load_dwordx4 a[224:227], v60, s[16:19], 0 offen
buffer_load_dwordx4 a[228:231], v60, s[16:19], 0 offen offset:256
buffer_load_dwordx4 a[232:235], v61, s[16:19], 0 offen
buffer_load_dwordx4 a[236:239], v61, s[16:19], 0 offen offset:256
buffer_load_dwordx4 a[240:243], v62, s[16:19], 0 offen
buffer_load_dwordx4 a[244:247], v62, s[16:19], 0 offen offset:256
buffer_load_dwordx4 a[248:251], v63, s[16:19], 0 offen
buffer_load_dwordx4 a[252:255], v63, s[16:19], 0 offen offset:256
v_add_u32 v34, 512, v34
s_mov_b32 s45, 0
s_mul_i32 s47, s40, 85504
LE_loop:
v_readlane_b32 s46, v37, s45
s_add_u32 s45, s45, 1
s_waitcnt vmcnt(56)
v_mfma_f32_16x16x32_bf16 v[48:51], a[0:3], v[40:43], v[48:51]
v_mfma_f32_16x16x32_bf16 v[48:51], a[4:7], v[44:47], v[48:51]
s_bitcmp1_b32 s46, 0
s_cbranch_scc0 LE_nf0
s_cmp_eq_u32 s42, 0
s_cbranch_scc1 LE_fl0
buffer_load_dwordx2 v[66:67], v39, s[20:23], s47 offen sc1
s_waitcnt vmcnt(0)
v_lshlrev_b32 v64, 16, v66
v_and_b32 v65, 0xffff0000, v66
v_add_f32 v48, v48, v64
v_add_f32 v49, v49, v65
v_lshlrev_b32 v64, 16, v67
v_and_b32 v65, 0xffff0000, v67
v_add_f32 v50, v50, v64
v_add_f32 v51, v51, v65
LE_fl0:
s_nop 3
v_cvt_pk_bf16_f32 v64, v48, v49
v_cvt_pk_bf16_f32 v65, v50, v51
v_mov_b32 v48, 0
v_mov_b32 v49, 0
v_mov_b32 v50, 0
v_mov_b32 v51, 0
buffer_store_dwordx2 v[64:65], v39, s[20:23], s47 offen
s_add_u32 s47, s47, 512
LE_nf0:
v_mfma_f32_16x16x32_bf16 v[48:51], a[8:11], v[40:43], v[48:51]
v_mfma_f32_16x16x32_bf16 v[48:51], a[12:15], v[44:47], v[48:51]
s_bitcmp1_b32 s46, 1
s_cbranch_scc0 LE_nf1
s_cmp_eq_u32 s42, 0
s_cbranch_scc1 LE_fl1
buffer_load_dwordx2 v[66:67], v39, s[20:23], s47 offen sc1
s_waitcnt vmcnt(0)
v_lshlrev_b32 v64, 16, v66
v_and_b32 v65, 0xffff0000, v66
v_add_f32 v48, v48, v64
v_add_f32 v49, v49, v65
v_lshlrev_b32 v64, 16, v67
v_and_b32 v65, 0xffff0000, v67
v_add_f32 v50, v50, v64
v_add_f32 v51, v51, v65
LE_fl1:
s_nop 3
v_cvt_pk_bf16_f32 v64, v48, v49
v_cvt_pk_bf16_f32 v65, v50, v51
v_mov_b32 v48, 0
v_mov_b32 v49, 0
v_mov_b32 v50, 0
v_mov_b32 v51, 0
buffer_store_dwordx2 v[64:65], v39, s[20:23], s47 offen
s_add_u32 s47, s47, 512
LE_nf1:
v_mfma_f32_16x16x32_bf16 v[48:51], a[16:19], v[40:43], v[48:51]
v_mfma_f32_16x16x32_bf16 v[48:51], a[20:23], v[44:47], v[48:51]
s_bitcmp1_b32 s46, 2
s_cbranch_scc0 LE_nf2
s_cmp_eq_u32 s42, 0
s_cbranch_scc1 LE_fl2
buffer_load_dwordx2 v[66:67], v39, s[20:23], s47 offen sc1
s_waitcnt vmcnt(0)
v_lshlrev_b32 v64, 16, v66
v_and_b32 v65, 0xffff0000, v66
v_add_f32 v48, v48, v64
v_add_f32 v49, v49, v65
v_lshlrev_b32 v64, 16, v67
v_and_b32 v65, 0xffff0000, v67
v_add_f32 v50, v50, v64
v_add_f32 v51, v51, v65
LE_fl2:
s_nop 3
v_cvt_pk_bf16_f32 v64, v48, v49
v_cvt_pk_bf16_f32 v65, v50, v51
v_mov_b32 v48, 0
v_mov_b32 v49, 0
v_mov_b32 v50, 0
v_mov_b32 v51, 0
buffer_store_dwordx2 v[64:65], v39, s[20:23], s47 offen
s_add_u32 s47, s47, 512
LE_nf2:
v_mfma_f32_16x16x32_bf16 v[48:51], a[24:27], v[40:43], v[48:51]
v_mfma_f32_16x16x32_bf16 v[48:51], a[28:31], v[44:47], v[48:51]
s_bitcmp1_b32 s46, 3
s_cbranch_scc0 LE_nf3
s_cmp_eq_u32 s42, 0
s_cbranch_scc1 LE_fl3
buffer_load_dwordx2 v[66:67], v39, s[20:23], s47 offen sc1
s_waitcnt vmcnt(0)
v_lshlrev_b32 v64, 16, v66
v_and_b32 v65, 0xffff0000, v66
v_add_f32 v48, v48, v64
v_add_f32 v49, v49, v65
v_lshlrev_b32 v64, 16, v67
v_and_b32 v65, 0xffff0000, v67
v_add_f32 v50, v50, v64
v_add_f32 v51, v51, v65
LE_fl3:
s_nop 3
v_cvt_pk_bf16_f32 v64, v48, v49
v_cvt_pk_bf16_f32 v65, v50, v51
v_mov_b32 v48, 0
v_mov_b32 v49, 0
v_mov_b32 v50, 0
v_mov_b32 v51, 0
buffer_store_dwordx2 v[64:65], v39, s[20:23], s47 offen
s_add_u32 s47, s47, 512
LE_nf3:
s_waitcnt lgkmcnt(0)
ds_read2_b32 v[56:57], v34 offset0:16 offset1:20
ds_read2_b32 v[58:59], v34 offset0:24 offset1:28
v_mad_u32_u16 v60, v52, s49, v2
v_mad_u32_u16 v61, v53, s49, v2
v_mad_u32_u16 v62, v54, s49, v2
v_mad_u32_u16 v63, v55, s49, v2
buffer_load_dwordx4 a[0:3], v60, s[16:19], 0 offen
buffer_load_dwordx4 a[4:7], v60, s[16:19], 0 offen offset:256
buffer_load_dwordx4 a[8:11], v61, s[16:19], 0 offen
buffer_load_dwordx4 a[12:15], v61, s[16:19], 0 offen offset:256
buffer_load_dwordx4 a[16:19], v62, s[16:19], 0 offen
buffer_load_dwordx4 a[20:23], v62, s[16:19], 0 offen offset:256
buffer_load_dwordx4 a[24:27], v63, s[16:19], 0 offen
buffer_load_dwordx4 a[28:31], v63, s[16:19], 0 offen offset:256
s_waitcnt vmcnt(56)
v_mfma_f32_16x16x32_bf16 v[48:51], a[32:35], v[40:43], v[48:51]
v_mfma_f32_16x16x32_bf16 v[48:51], a[36:39], v[44:47], v[48:51]
s_bitcmp1_b32 s46, 4
s_cbranch_scc0 LE_nf4
s_cmp_eq_u32 s42, 0
s_cbranch_scc1 LE_fl4
buffer_load_dwordx2 v[66:67], v39, s[20:23], s47 offen sc1
s_waitcnt vmcnt(0)
v_lshlrev_b32 v64, 16, v66
v_and_b32 v65, 0xffff0000, v66
v_add_f32 v48, v48, v64
v_add_f32 v49, v49, v65
v_lshlrev_b32 v64, 16, v67
v_and_b32 v65, 0xffff0000, v67
v_add_f32 v50, v50, v64
v_add_f32 v51, v51, v65
LE_fl4:
s_nop 3
v_cvt_pk_bf16_f32 v64, v48, v49
v_cvt_pk_bf16_f32 v65, v50, v51
v_mov_b32 v48, 0
v_mov_b32 v49, 0
v_mov_b32 v50, 0
v_mov_b32 v51, 0
buffer_store_dwordx2 v[64:65], v39, s[20:23], s47 offen
s_add_u32 s47, s47, 512
LE_nf4:
v_mfma_f32_16x16x32_bf16 v[48:51], a[40:43], v[40:43], v[48:51]
v_mfma_f32_16x16x32_bf16 v[48:51], a[44:47], v[44:47], v[48:51]
s_bitcmp1_b32 s46, 5
s_cbranch_scc0 LE_nf5
s_cmp_eq_u32 s42, 0
s_cbranch_scc1 LE_fl5
buffer_load_dwordx2 v[66:67], v39, s[20:23], s47 offen sc1
s_waitcnt vmcnt(0)
v_lshlrev_b32 v64, 16, v66
v_and_b32 v65, 0xffff0000, v66
v_add_f32 v48, v48, v64
v_add_f32 v49, v49, v65
v_lshlrev_b32 v64, 16, v67
v_and_b32 v65, 0xffff0000, v67
v_add_f32 v50, v50, v64
v_add_f32 v51, v51, v65
LE_fl5:
s_nop 3
v_cvt_pk_bf16_f32 v64, v48, v49
v_cvt_pk_bf16_f32 v65, v50, v51
v_mov_b32 v48, 0
v_mov_b32 v49, 0
v_mov_b32 v50, 0
v_mov_b32 v51, 0
buffer_store_dwordx2 v[64:65], v39, s[20:23], s47 offen
s_add_u32 s47, s47, 512
LE_nf5:
v_mfma_f32_16x16x32_bf16 v[48:51], a[48:51], v[40:43], v[48:51]
v_mfma_f32_16x16x32_bf16 v[48:51], a[52:55], v[44:47], v[48:51]
s_bitcmp1_b32 s46, 6
s_cbranch_scc0 LE_nf6
s_cmp_eq_u32 s42, 0
s_cbranch_scc1 LE_fl6
buffer_load_dwordx2 v[66:67], v39, s[20:23], s47 offen sc1
s_waitcnt vmcnt(0)
v_lshlrev_b32 v64, 16, v66
v_and_b32 v65, 0xffff0000, v66
v_add_f32 v48, v48, v64
v_add_f32 v49, v49, v65
v_lshlrev_b32 v64, 16, v67
v_and_b32 v65, 0xffff0000, v67
v_add_f32 v50, v50, v64
v_add_f32 v51, v51, v65
LE_fl6:
s_nop 3
v_cvt_pk_bf16_f32 v64, v48, v49
v_cvt_pk_bf16_f32 v65, v50, v51
v_mov_b32 v48, 0
v_mov_b32 v49, 0
v_mov_b32 v50, 0
v_mov_b32 v51, 0
buffer_store_dwordx2 v[64:65], v39, s[20:23], s47 offen
s_add_u32 s47, s47, 512
LE_nf6:
v_mfma_f32_16x16x32_bf16 v[48:51], a[56:59], v[40:43], v[48:51]
v_mfma_f32_16x16x32_bf16 v[48:51], a[60:63], v[44:47], v[48:51]
s_bitcmp1_b32 s46, 7
s_cbranch_scc0 LE_nf7
s_cmp_eq_u32 s42, 0
s_cbranch_scc1 LE_fl7
buffer_load_dwordx2 v[66:67], v39, s[20:23], s47 offen sc1
s_waitcnt vmcnt(0)
v_lshlrev_b32 v64, 16, v66
v_and_b32 v65, 0xffff0000, v66
v_add_f32 v48, v48, v64
v_add_f32 v49, v49, v65
v_lshlrev_b32 v64, 16, v67
v_and_b32 v65, 0xffff0000, v67
v_add_f32 v50, v50, v64
v_add_f32 v51, v51, v65
LE_fl7:
s_nop 3
v_cvt_pk_bf16_f32 v64, v48, v49
v_cvt_pk_bf16_f32 v65, v50, v51
v_mov_b32 v48, 0
v_mov_b32 v49, 0
v_mov_b32 v50, 0
v_mov_b32 v51, 0
buffer_store_dwordx2 v[64:65], v39, s[20:23], s47 offen
s_add_u32 s47, s47, 512
LE_nf7:
s_waitcnt lgkmcnt(0)
ds_read2_b32 v[52:53], v34 offset0:32 offset1:36
ds_read2_b32 v[54:55], v34 offset0:40 offset1:44
v_mad_u32_u16 v60, v56, s49, v2
v_mad_u32_u16 v61, v57, s49, v2
v_mad_u32_u16 v62, v58, s49, v2
v_mad_u32_u16 v63, v59, s49, v2
buffer_load_dwordx4 a[32:35], v60, s[16:19], 0 offen
buffer_load_dwordx4 a[36:39], v60, s[16:19], 0 offen offset:256
buffer_load_dwordx4 a[40:43], v61, s[16:19], 0 offen
buffer_load_dwordx4 a[44:47], v61, s[16:19], 0 offen offset:256
buffer_load_dwordx4 a[48:51], v62, s[16:19], 0 offen
buffer_load_dwordx4 a[52:55], v62, s[16:19], 0 offen offset:256
buffer_load_dwordx4 a[56:59], v63, s[16:19], 0 offen
buffer_load_dwordx4 a[60:63], v63, s[16:19], 0 offen offset:256
s_waitcnt vmcnt(56)
v_mfma_f32_16x16x32_bf16 v[48:51], a[64:67], v[40:43], v[48:51]
v_mfma_f32_16x16x32_bf16 v[48:51], a[68:71], v[44:47], v[48:51]
s_bitcmp1_b32 s46, 8
s_cbranch_scc0 LE_nf8
s_cmp_eq_u32 s42, 0
s_cbranch_scc1 LE_fl8
buffer_load_dwordx2 v[66:67], v39, s[20:23], s47 offen sc1
s_waitcnt vmcnt(0)
v_lshlrev_b32 v64, 16, v66
v_and_b32 v65, 0xffff0000, v66
v_add_f32 v48, v48, v64
v_add_f32 v49, v49, v65
v_lshlrev_b32 v64, 16, v67
v_and_b32 v65, 0xffff0000, v67
v_add_f32 v50, v50, v64
v_add_f32 v51, v51, v65
LE_fl8:
s_nop 3
v_cvt_pk_bf16_f32 v64, v48, v49
v_cvt_pk_bf16_f32 v65, v50, v51
v_mov_b32 v48, 0
v_mov_b32 v49, 0
v_mov_b32 v50, 0
v_mov_b32 v51, 0
buffer_store_dwordx2 v[64:65], v39, s[20:23], s47 offen
s_add_u32 s47, s47, 512
LE_nf8:
v_mfma_f32_16x16x32_bf16 v[48:51], a[72:75], v[40:43], v[48:51]
v_mfma_f32_16x16x32_bf16 v[48:51], a[76:79], v[44:47], v[48:51]
s_bitcmp1_b32 s46, 9
s_cbranch_scc0 LE_nf9
s_cmp_eq_u32 s42, 0
s_cbranch_scc1 LE_fl9
buffer_load_dwordx2 v[66:67], v39, s[20:23], s47 offen sc1
s_waitcnt vmcnt(0)
v_lshlrev_b32 v64, 16, v66
v_and_b32 v65, 0xffff0000, v66
v_add_f32 v48, v48, v64
v_add_f32 v49, v49, v65
v_lshlrev_b32 v64, 16, v67
v_and_b32 v65, 0xffff0000, v67
v_add_f32 v50, v50, v64
v_add_f32 v51, v51, v65
LE_fl9:
s_nop 3
v_cvt_pk_bf16_f32 v64, v48, v49
v_cvt_pk_bf16_f32 v65, v50, v51
v_mov_b32 v48, 0
v_mov_b32 v49, 0
v_mov_b32 v50, 0
v_mov_b32 v51, 0
buffer_store_dwordx2 v[64:65], v39, s[20:23], s47 offen
s_add_u32 s47, s47, 512
LE_nf9:
v_mfma_f32_16x16x32_bf16 v[48:51], a[80:83], v[40:43], v[48:51]
v_mfma_f32_16x16x32_bf16 v[48:51], a[84:87], v[44:47], v[48:51]
s_bitcmp1_b32 s46, 10
s_cbranch_scc0 LE_nf10
s_cmp_eq_u32 s42, 0
s_cbranch_scc1 LE_fl10
buffer_load_dwordx2 v[66:67], v39, s[20:23], s47 offen sc1
s_waitcnt vmcnt(0)
v_lshlrev_b32 v64, 16, v66
v_and_b32 v65, 0xffff0000, v66
v_add_f32 v48, v48, v64
v_add_f32 v49, v49, v65
v_lshlrev_b32 v64, 16, v67
v_and_b32 v65, 0xffff0000, v67
v_add_f32 v50, v50, v64
v_add_f32 v51, v51, v65
LE_fl10:
s_nop 3
v_cvt_pk_bf16_f32 v64, v48, v49
v_cvt_pk_bf16_f32 v65, v50, v51
v_mov_b32 v48, 0
v_mov_b32 v49, 0
v_mov_b32 v50, 0
v_mov_b32 v51, 0
buffer_store_dwordx2 v[64:65], v39, s[20:23], s47 offen
s_add_u32 s47, s47, 512
LE_nf10:
v_mfma_f32_16x16x32_bf16 v[48:51], a[88:91], v[40:43], v[48:51]
v_mfma_f32_16x16x32_bf16 v[48:51], a[92:95], v[44:47], v[48:51]
s_bitcmp1_b32 s46, 11
s_cbranch_scc0 LE_nf11
s_cmp_eq_u32 s42, 0
s_cbranch_scc1 LE_fl11
buffer_load_dwordx2 v[66:67], v39, s[20:23], s47 offen sc1
s_waitcnt vmcnt(0)
v_lshlrev_b32 v64, 16, v66
v_and_b32 v65, 0xffff0000, v66
v_add_f32 v48, v48, v64
v_add_f32 v49, v49, v65
v_lshlrev_b32 v64, 16, v67
v_and_b32 v65, 0xffff0000, v67
v_add_f32 v50, v50, v64
v_add_f32 v51, v51, v65
LE_fl11:
s_nop 3
v_cvt_pk_bf16_f32 v64, v48, v49
v_cvt_pk_bf16_f32 v65, v50, v51
v_mov_b32 v48, 0
v_mov_b32 v49, 0
v_mov_b32 v50, 0
v_mov_b32 v51, 0
buffer_store_dwordx2 v[64:65], v39, s[20:23], s47 offen
s_add_u32 s47, s47, 512
LE_nf11:
s_waitcnt lgkmcnt(0)
ds_read2_b32 v[56:57], v34 offset0:48 offset1:52
ds_read2_b32 v[58:59], v34 offset0:56 offset1:60
v_mad_u32_u16 v60, v52, s49, v2
v_mad_u32_u16 v61, v53, s49, v2
v_mad_u32_u16 v62, v54, s49, v2
v_mad_u32_u16 v63, v55, s49, v2
buffer_load_dwordx4 a[64:67], v60, s[16:19], 0 offen
buffer_load_dwordx4 a[68:71], v60, s[16:19], 0 offen offset:256
buffer_load_dwordx4 a[72:75], v61, s[16:19], 0 offen
buffer_load_dwordx4 a[76:79], v61, s[16:19], 0 offen offset:256
buffer_load_dwordx4 a[80:83], v62, s[16:19], 0 offen
buffer_load_dwordx4 a[84:87], v62, s[16:19], 0 offen offset:256
buffer_load_dwordx4 a[88:91], v63, s[16:19], 0 offen
buffer_load_dwordx4 a[92:95], v63, s[16:19], 0 offen offset:256
s_waitcnt vmcnt(56)
v_mfma_f32_16x16x32_bf16 v[48:51], a[96:99], v[40:43], v[48:51]
v_mfma_f32_16x16x32_bf16 v[48:51], a[100:103], v[44:47], v[48:51]
s_bitcmp1_b32 s46, 12
s_cbranch_scc0 LE_nf12
s_cmp_eq_u32 s42, 0
s_cbranch_scc1 LE_fl12
buffer_load_dwordx2 v[66:67], v39, s[20:23], s47 offen sc1
s_waitcnt vmcnt(0)
v_lshlrev_b32 v64, 16, v66
v_and_b32 v65, 0xffff0000, v66
v_add_f32 v48, v48, v64
v_add_f32 v49, v49, v65
v_lshlrev_b32 v64, 16, v67
v_and_b32 v65, 0xffff0000, v67
v_add_f32 v50, v50, v64
v_add_f32 v51, v51, v65
LE_fl12:
s_nop 3
v_cvt_pk_bf16_f32 v64, v48, v49
v_cvt_pk_bf16_f32 v65, v50, v51
v_mov_b32 v48, 0
v_mov_b32 v49, 0
v_mov_b32 v50, 0
v_mov_b32 v51, 0
buffer_store_dwordx2 v[64:65], v39, s[20:23], s47 offen
s_add_u32 s47, s47, 512
LE_nf12:
v_mfma_f32_16x16x32_bf16 v[48:51], a[104:107], v[40:43], v[48:51]
v_mfma_f32_16x16x32_bf16 v[48:51], a[108:111], v[44:47], v[48:51]
s_bitcmp1_b32 s46, 13
s_cbranch_scc0 LE_nf13
s_cmp_eq_u32 s42, 0
s_cbranch_scc1 LE_fl13
buffer_load_dwordx2 v[66:67], v39, s[20:23], s47 offen sc1
s_waitcnt vmcnt(0)
v_lshlrev_b32 v64, 16, v66
v_and_b32 v65, 0xffff0000, v66
v_add_f32 v48, v48, v64
v_add_f32 v49, v49, v65
v_lshlrev_b32 v64, 16, v67
v_and_b32 v65, 0xffff0000, v67
v_add_f32 v50, v50, v64
v_add_f32 v51, v51, v65
LE_fl13:
s_nop 3
v_cvt_pk_bf16_f32 v64, v48, v49
v_cvt_pk_bf16_f32 v65, v50, v51
v_mov_b32 v48, 0
v_mov_b32 v49, 0
v_mov_b32 v50, 0
v_mov_b32 v51, 0
buffer_store_dwordx2 v[64:65], v39, s[20:23], s47 offen
s_add_u32 s47, s47, 512
LE_nf13:
v_mfma_f32_16x16x32_bf16 v[48:51], a[112:115], v[40:43], v[48:51]
v_mfma_f32_16x16x32_bf16 v[48:51], a[116:119], v[44:47], v[48:51]
s_bitcmp1_b32 s46, 14
s_cbranch_scc0 LE_nf14
s_cmp_eq_u32 s42, 0
s_cbranch_scc1 LE_fl14
buffer_load_dwordx2 v[66:67], v39, s[20:23], s47 offen sc1
s_waitcnt vmcnt(0)
v_lshlrev_b32 v64, 16, v66
v_and_b32 v65, 0xffff0000, v66
v_add_f32 v48, v48, v64
v_add_f32 v49, v49, v65
v_lshlrev_b32 v64, 16, v67
v_and_b32 v65, 0xffff0000, v67
v_add_f32 v50, v50, v64
v_add_f32 v51, v51, v65
LE_fl14:
s_nop 3
v_cvt_pk_bf16_f32 v64, v48, v49
v_cvt_pk_bf16_f32 v65, v50, v51
v_mov_b32 v48, 0
v_mov_b32 v49, 0
v_mov_b32 v50, 0
v_mov_b32 v51, 0
buffer_store_dwordx2 v[64:65], v39, s[20:23], s47 offen
s_add_u32 s47, s47, 512
LE_nf14:
v_mfma_f32_16x16x32_bf16 v[48:51], a[120:123], v[40:43], v[48:51]
v_mfma_f32_16x16x32_bf16 v[48:51], a[124:127], v[44:47], v[48:51]
s_bitcmp1_b32 s46, 15
s_cbranch_scc0 LE_nf15
s_cmp_eq_u32 s42, 0
s_cbranch_scc1 LE_fl15
buffer_load_dwordx2 v[66:67], v39, s[20:23], s47 offen sc1
s_waitcnt vmcnt(0)
v_lshlrev_b32 v64, 16, v66
v_and_b32 v65, 0xffff0000, v66
v_add_f32 v48, v48, v64
v_add_f32 v49, v49, v65
v_lshlrev_b32 v64, 16, v67
v_and_b32 v65, 0xffff0000, v67
v_add_f32 v50, v50, v64
v_add_f32 v51, v51, v65
LE_fl15:
s_nop 3
v_cvt_pk_bf16_f32 v64, v48, v49
v_cvt_pk_bf16_f32 v65, v50, v51
v_mov_b32 v48, 0
v_mov_b32 v49, 0
v_mov_b32 v50, 0
v_mov_b32 v51, 0
buffer_store_dwordx2 v[64:65], v39, s[20:23], s47 offen
s_add_u32 s47, s47, 512
LE_nf15:
s_waitcnt lgkmcnt(0)
ds_read2_b32 v[52:53], v34 offset0:64 offset1:68
ds_read2_b32 v[54:55], v34 offset0:72 offset1:76
v_mad_u32_u16 v60, v56, s49, v2
v_mad_u32_u16 v61, v57, s49, v2
v_mad_u32_u16 v62, v58, s49, v2
v_mad_u32_u16 v63, v59, s49, v2
buffer_load_dwordx4 a[96:99], v60, s[16:19], 0 offen
buffer_load_dwordx4 a[100:103], v60, s[16:19], 0 offen offset:256
buffer_load_dwordx4 a[104:107], v61, s[16:19], 0 offen
buffer_load_dwordx4 a[108:111], v61, s[16:19], 0 offen offset:256
buffer_load_dwordx4 a[112:115], v62, s[16:19], 0 offen
buffer_load_dwordx4 a[116:119], v62, s[16:19], 0 offen offset:256
buffer_load_dwordx4 a[120:123], v63, s[16:19], 0 offen
buffer_load_dwordx4 a[124:127], v63, s[16:19], 0 offen offset:256
s_waitcnt vmcnt(56)
v_mfma_f32_16x16x32_bf16 v[48:51], a[128:131], v[40:43], v[48:51]
v_mfma_f32_16x16x32_bf16 v[48:51], a[132:135], v[44:47], v[48:51]
s_bitcmp1_b32 s46, 16
s_cbranch_scc0 LE_nf16
s_cmp_eq_u32 s42, 0
s_cbranch_scc1 LE_fl16
buffer_load_dwordx2 v[66:67], v39, s[20:23], s47 offen sc1
s_waitcnt vmcnt(0)
v_lshlrev_b32 v64, 16, v66
v_and_b32 v65, 0xffff0000, v66
v_add_f32 v48, v48, v64
v_add_f32 v49, v49, v65
v_lshlrev_b32 v64, 16, v67
v_and_b32 v65, 0xffff0000, v67
v_add_f32 v50, v50, v64
v_add_f32 v51, v51, v65
LE_fl16:
s_nop 3
v_cvt_pk_bf16_f32 v64, v48, v49
v_cvt_pk_bf16_f32 v65, v50, v51
v_mov_b32 v48, 0
v_mov_b32 v49, 0
v_mov_b32 v50, 0
v_mov_b32 v51, 0
buffer_store_dwordx2 v[64:65], v39, s[20:23], s47 offen
s_add_u32 s47, s47, 512
LE_nf16:
v_mfma_f32_16x16x32_bf16 v[48:51], a[136:139], v[40:43], v[48:51]
v_mfma_f32_16x16x32_bf16 v[48:51], a[140:143], v[44:47], v[48:51]
s_bitcmp1_b32 s46, 17
s_cbranch_scc0 LE_nf17
s_cmp_eq_u32 s42, 0
s_cbranch_scc1 LE_fl17
buffer_load_dwordx2 v[66:67], v39, s[20:23], s47 offen sc1
s_waitcnt vmcnt(0)
v_lshlrev_b32 v64, 16, v66
v_and_b32 v65, 0xffff0000, v66
v_add_f32 v48, v48, v64
v_add_f32 v49, v49, v65
v_lshlrev_b32 v64, 16, v67
v_and_b32 v65, 0xffff0000, v67
v_add_f32 v50, v50, v64
v_add_f32 v51, v51, v65
LE_fl17:
s_nop 3
v_cvt_pk_bf16_f32 v64, v48, v49
v_cvt_pk_bf16_f32 v65, v50, v51
v_mov_b32 v48, 0
v_mov_b32 v49, 0
v_mov_b32 v50, 0
v_mov_b32 v51, 0
buffer_store_dwordx2 v[64:65], v39, s[20:23], s47 offen
s_add_u32 s47, s47, 512
LE_nf17:
v_mfma_f32_16x16x32_bf16 v[48:51], a[144:147], v[40:43], v[48:51]
v_mfma_f32_16x16x32_bf16 v[48:51], a[148:151], v[44:47], v[48:51]
s_bitcmp1_b32 s46, 18
s_cbranch_scc0 LE_nf18
s_cmp_eq_u32 s42, 0
s_cbranch_scc1 LE_fl18
buffer_load_dwordx2 v[66:67], v39, s[20:23], s47 offen sc1
s_waitcnt vmcnt(0)
v_lshlrev_b32 v64, 16, v66
v_and_b32 v65, 0xffff0000, v66
v_add_f32 v48, v48, v64
v_add_f32 v49, v49, v65
v_lshlrev_b32 v64, 16, v67
v_and_b32 v65, 0xffff0000, v67
v_add_f32 v50, v50, v64
v_add_f32 v51, v51, v65
LE_fl18:
s_nop 3
v_cvt_pk_bf16_f32 v64, v48, v49
v_cvt_pk_bf16_f32 v65, v50, v51
v_mov_b32 v48, 0
v_mov_b32 v49, 0
v_mov_b32 v50, 0
v_mov_b32 v51, 0
buffer_store_dwordx2 v[64:65], v39, s[20:23], s47 offen
s_add_u32 s47, s47, 512
LE_nf18:
v_mfma_f32_16x16x32_bf16 v[48:51], a[152:155], v[40:43], v[48:51]
v_mfma_f32_16x16x32_bf16 v[48:51], a[156:159], v[44:47], v[48:51]
s_bitcmp1_b32 s46, 19
s_cbranch_scc0 LE_nf19
s_cmp_eq_u32 s42, 0
s_cbranch_scc1 LE_fl19
buffer_load_dwordx2 v[66:67], v39, s[20:23], s47 offen sc1
s_waitcnt vmcnt(0)
v_lshlrev_b32 v64, 16, v66
v_and_b32 v65, 0xffff0000, v66
v_add_f32 v48, v48, v64
v_add_f32 v49, v49, v65
v_lshlrev_b32 v64, 16, v67
v_and_b32 v65, 0xffff0000, v67
v_add_f32 v50, v50, v64
v_add_f32 v51, v51, v65
LE_fl19:
s_nop 3
v_cvt_pk_bf16_f32 v64, v48, v49
v_cvt_pk_bf16_f32 v65, v50, v51
v_mov_b32 v48, 0
v_mov_b32 v49, 0
v_mov_b32 v50, 0
v_mov_b32 v51, 0
buffer_store_dwordx2 v[64:65], v39, s[20:23], s47 offen
s_add_u32 s47, s47, 512
LE_nf19:
s_waitcnt lgkmcnt(0)
ds_read2_b32 v[56:57], v34 offset0:80 offset1:84
ds_read2_b32 v[58:59], v34 offset0:88 offset1:92
v_mad_u32_u16 v60, v52, s49, v2
v_mad_u32_u16 v61, v53, s49, v2
v_mad_u32_u16 v62, v54, s49, v2
v_mad_u32_u16 v63, v55, s49, v2
buffer_load_dwordx4 a[128:131], v60, s[16:19], 0 offen
buffer_load_dwordx4 a[132:135], v60, s[16:19], 0 offen offset:256
buffer_load_dwordx4 a[136:139], v61, s[16:19], 0 offen
buffer_load_dwordx4 a[140:143], v61, s[16:19], 0 offen offset:256
buffer_load_dwordx4 a[144:147], v62, s[16:19], 0 offen
buffer_load_dwordx4 a[148:151], v62, s[16:19], 0 offen offset:256
buffer_load_dwordx4 a[152:155], v63, s[16:19], 0 offen
buffer_load_dwordx4 a[156:159], v63, s[16:19], 0 offen offset:256
s_waitcnt vmcnt(56)
v_mfma_f32_16x16x32_bf16 v[48:51], a[160:163], v[40:43], v[48:51]
v_mfma_f32_16x16x32_bf16 v[48:51], a[164:167], v[44:47], v[48:51]
s_bitcmp1_b32 s46, 20
s_cbranch_scc0 LE_nf20
s_cmp_eq_u32 s42, 0
s_cbranch_scc1 LE_fl20
buffer_load_dwordx2 v[66:67], v39, s[20:23], s47 offen sc1
s_waitcnt vmcnt(0)
v_lshlrev_b32 v64, 16, v66
v_and_b32 v65, 0xffff0000, v66
v_add_f32 v48, v48, v64
v_add_f32 v49, v49, v65
v_lshlrev_b32 v64, 16, v67
v_and_b32 v65, 0xffff0000, v67
v_add_f32 v50, v50, v64
v_add_f32 v51, v51, v65
LE_fl20:
s_nop 3
v_cvt_pk_bf16_f32 v64, v48, v49
v_cvt_pk_bf16_f32 v65, v50, v51
v_mov_b32 v48, 0
v_mov_b32 v49, 0
v_mov_b32 v50, 0
v_mov_b32 v51, 0
buffer_store_dwordx2 v[64:65], v39, s[20:23], s47 offen
s_add_u32 s47, s47, 512
LE_nf20:
v_mfma_f32_16x16x32_bf16 v[48:51], a[168:171], v[40:43], v[48:51]
v_mfma_f32_16x16x32_bf16 v[48:51], a[172:175], v[44:47], v[48:51]
s_bitcmp1_b32 s46, 21
s_cbranch_scc0 LE_nf21
s_cmp_eq_u32 s42, 0
s_cbranch_scc1 LE_fl21
buffer_load_dwordx2 v[66:67], v39, s[20:23], s47 offen sc1
s_waitcnt vmcnt(0)
v_lshlrev_b32 v64, 16, v66
v_and_b32 v65, 0xffff0000, v66
v_add_f32 v48, v48, v64
v_add_f32 v49, v49, v65
v_lshlrev_b32 v64, 16, v67
v_and_b32 v65, 0xffff0000, v67
v_add_f32 v50, v50, v64
v_add_f32 v51, v51, v65
LE_fl21:
s_nop 3
v_cvt_pk_bf16_f32 v64, v48, v49
v_cvt_pk_bf16_f32 v65, v50, v51
v_mov_b32 v48, 0
v_mov_b32 v49, 0
v_mov_b32 v50, 0
v_mov_b32 v51, 0
buffer_store_dwordx2 v[64:65], v39, s[20:23], s47 offen
s_add_u32 s47, s47, 512
LE_nf21:
v_mfma_f32_16x16x32_bf16 v[48:51], a[176:179], v[40:43], v[48:51]
v_mfma_f32_16x16x32_bf16 v[48:51], a[180:183], v[44:47], v[48:51]
s_bitcmp1_b32 s46, 22
s_cbranch_scc0 LE_nf22
s_cmp_eq_u32 s42, 0
s_cbranch_scc1 LE_fl22
buffer_load_dwordx2 v[66:67], v39, s[20:23], s47 offen sc1
s_waitcnt vmcnt(0)
v_lshlrev_b32 v64, 16, v66
v_and_b32 v65, 0xffff0000, v66
v_add_f32 v48, v48, v64
v_add_f32 v49, v49, v65
v_lshlrev_b32 v64, 16, v67
v_and_b32 v65, 0xffff0000, v67
v_add_f32 v50, v50, v64
v_add_f32 v51, v51, v65
LE_fl22:
s_nop 3
v_cvt_pk_bf16_f32 v64, v48, v49
v_cvt_pk_bf16_f32 v65, v50, v51
v_mov_b32 v48, 0
v_mov_b32 v49, 0
v_mov_b32 v50, 0
v_mov_b32 v51, 0
buffer_store_dwordx2 v[64:65], v39, s[20:23], s47 offen
s_add_u32 s47, s47, 512
LE_nf22:
v_mfma_f32_16x16x32_bf16 v[48:51], a[184:187], v[40:43], v[48:51]
v_mfma_f32_16x16x32_bf16 v[48:51], a[188:191], v[44:47], v[48:51]
s_bitcmp1_b32 s46, 23
s_cbranch_scc0 LE_nf23
s_cmp_eq_u32 s42, 0
s_cbranch_scc1 LE_fl23
buffer_load_dwordx2 v[66:67], v39, s[20:23], s47 offen sc1
s_waitcnt vmcnt(0)
v_lshlrev_b32 v64, 16, v66
v_and_b32 v65, 0xffff0000, v66
v_add_f32 v48, v48, v64
v_add_f32 v49, v49, v65
v_lshlrev_b32 v64, 16, v67
v_and_b32 v65, 0xffff0000, v67
v_add_f32 v50, v50, v64
v_add_f32 v51, v51, v65
LE_fl23:
s_nop 3
v_cvt_pk_bf16_f32 v64, v48, v49
v_cvt_pk_bf16_f32 v65, v50, v51
v_mov_b32 v48, 0
v_mov_b32 v49, 0
v_mov_b32 v50, 0
v_mov_b32 v51, 0
buffer_store_dwordx2 v[64:65], v39, s[20:23], s47 offen
s_add_u32 s47, s47, 512
LE_nf23:
s_waitcnt lgkmcnt(0)
ds_read2_b32 v[52:53], v34 offset0:96 offset1:100
ds_read2_b32 v[54:55], v34 offset0:104 offset1:108
v_mad_u32_u16 v60, v56, s49, v2
v_mad_u32_u16 v61, v57, s49, v2
v_mad_u32_u16 v62, v58, s49, v2
v_mad_u32_u16 v63, v59, s49, v2
buffer_load_dwordx4 a[160:163], v60, s[16:19], 0 offen
buffer_load_dwordx4 a[164:167], v60, s[16:19], 0 offen offset:256
buffer_load_dwordx4 a[168:171], v61, s[16:19], 0 offen
buffer_load_dwordx4 a[172:175], v61, s[16:19], 0 offen offset:256
buffer_load_dwordx4 a[176:179], v62, s[16:19], 0 offen
buffer_load_dwordx4 a[180:183], v62, s[16:19], 0 offen offset:256
buffer_load_dwordx4 a[184:187], v63, s[16:19], 0 offen
buffer_load_dwordx4 a[188:191], v63, s[16:19], 0 offen offset:256
s_waitcnt vmcnt(56)
v_mfma_f32_16x16x32_bf16 v[48:51], a[192:195], v[40:43], v[48:51]
v_mfma_f32_16x16x32_bf16 v[48:51], a[196:199], v[44:47], v[48:51]
s_bitcmp1_b32 s46, 24
s_cbranch_scc0 LE_nf24
s_cmp_eq_u32 s42, 0
s_cbranch_scc1 LE_fl24
buffer_load_dwordx2 v[66:67], v39, s[20:23], s47 offen sc1
s_waitcnt vmcnt(0)
v_lshlrev_b32 v64, 16, v66
v_and_b32 v65, 0xffff0000, v66
v_add_f32 v48, v48, v64
v_add_f32 v49, v49, v65
v_lshlrev_b32 v64, 16, v67
v_and_b32 v65, 0xffff0000, v67
v_add_f32 v50, v50, v64
v_add_f32 v51, v51, v65
LE_fl24:
s_nop 3
v_cvt_pk_bf16_f32 v64, v48, v49
v_cvt_pk_bf16_f32 v65, v50, v51
v_mov_b32 v48, 0
v_mov_b32 v49, 0
v_mov_b32 v50, 0
v_mov_b32 v51, 0
buffer_store_dwordx2 v[64:65], v39, s[20:23], s47 offen
s_add_u32 s47, s47, 512
LE_nf24:
v_mfma_f32_16x16x32_bf16 v[48:51], a[200:203], v[40:43], v[48:51]
v_mfma_f32_16x16x32_bf16 v[48:51], a[204:207], v[44:47], v[48:51]
s_bitcmp1_b32 s46, 25
s_cbranch_scc0 LE_nf25
s_cmp_eq_u32 s42, 0
s_cbranch_scc1 LE_fl25
buffer_load_dwordx2 v[66:67], v39, s[20:23], s47 offen sc1
s_waitcnt vmcnt(0)
v_lshlrev_b32 v64, 16, v66
v_and_b32 v65, 0xffff0000, v66
v_add_f32 v48, v48, v64
v_add_f32 v49, v49, v65
v_lshlrev_b32 v64, 16, v67
v_and_b32 v65, 0xffff0000, v67
v_add_f32 v50, v50, v64
v_add_f32 v51, v51, v65
LE_fl25:
s_nop 3
v_cvt_pk_bf16_f32 v64, v48, v49
v_cvt_pk_bf16_f32 v65, v50, v51
v_mov_b32 v48, 0
v_mov_b32 v49, 0
v_mov_b32 v50, 0
v_mov_b32 v51, 0
buffer_store_dwordx2 v[64:65], v39, s[20:23], s47 offen
s_add_u32 s47, s47, 512
LE_nf25:
v_mfma_f32_16x16x32_bf16 v[48:51], a[208:211], v[40:43], v[48:51]
v_mfma_f32_16x16x32_bf16 v[48:51], a[212:215], v[44:47], v[48:51]
s_bitcmp1_b32 s46, 26
s_cbranch_scc0 LE_nf26
s_cmp_eq_u32 s42, 0
s_cbranch_scc1 LE_fl26
buffer_load_dwordx2 v[66:67], v39, s[20:23], s47 offen sc1
s_waitcnt vmcnt(0)
v_lshlrev_b32 v64, 16, v66
v_and_b32 v65, 0xffff0000, v66
v_add_f32 v48, v48, v64
v_add_f32 v49, v49, v65
v_lshlrev_b32 v64, 16, v67
v_and_b32 v65, 0xffff0000, v67
v_add_f32 v50, v50, v64
v_add_f32 v51, v51, v65
LE_fl26:
s_nop 3
v_cvt_pk_bf16_f32 v64, v48, v49
v_cvt_pk_bf16_f32 v65, v50, v51
v_mov_b32 v48, 0
v_mov_b32 v49, 0
v_mov_b32 v50, 0
v_mov_b32 v51, 0
buffer_store_dwordx2 v[64:65], v39, s[20:23], s47 offen
s_add_u32 s47, s47, 512
LE_nf26:
v_mfma_f32_16x16x32_bf16 v[48:51], a[216:219], v[40:43], v[48:51]
v_mfma_f32_16x16x32_bf16 v[48:51], a[220:223], v[44:47], v[48:51]
s_bitcmp1_b32 s46, 27
s_cbranch_scc0 LE_nf27
s_cmp_eq_u32 s42, 0
s_cbranch_scc1 LE_fl27
buffer_load_dwordx2 v[66:67], v39, s[20:23], s47 offen sc1
s_waitcnt vmcnt(0)
v_lshlrev_b32 v64, 16, v66
v_and_b32 v65, 0xffff0000, v66
v_add_f32 v48, v48, v64
v_add_f32 v49, v49, v65
v_lshlrev_b32 v64, 16, v67
v_and_b32 v65, 0xffff0000, v67
v_add_f32 v50, v50, v64
v_add_f32 v51, v51, v65
LE_fl27:
s_nop 3
v_cvt_pk_bf16_f32 v64, v48, v49
v_cvt_pk_bf16_f32 v65, v50, v51
v_mov_b32 v48, 0
v_mov_b32 v49, 0
v_mov_b32 v50, 0
v_mov_b32 v51, 0
buffer_store_dwordx2 v[64:65], v39, s[20:23], s47 offen
s_add_u32 s47, s47, 512
LE_nf27:
s_waitcnt lgkmcnt(0)
ds_read2_b32 v[56:57], v34 offset0:112 offset1:116
ds_read2_b32 v[58:59], v34 offset0:120 offset1:124
v_mad_u32_u16 v60, v52, s49, v2
v_mad_u32_u16 v61, v53, s49, v2
v_mad_u32_u16 v62, v54, s49, v2
v_mad_u32_u16 v63, v55, s49, v2
buffer_load_dwordx4 a[192:195], v60, s[16:19], 0 offen
buffer_load_dwordx4 a[196:199], v60, s[16:19], 0 offen offset:256
buffer_load_dwordx4 a[200:203], v61, s[16:19], 0 offen
buffer_load_dwordx4 a[204:207], v61, s[16:19], 0 offen offset:256
buffer_load_dwordx4 a[208:211], v62, s[16:19], 0 offen
buffer_load_dwordx4 a[212:215], v62, s[16:19], 0 offen offset:256
buffer_load_dwordx4 a[216:219], v63, s[16:19], 0 offen
buffer_load_dwordx4 a[220:223], v63, s[16:19], 0 offen offset:256
s_waitcnt vmcnt(56)
v_mfma_f32_16x16x32_bf16 v[48:51], a[224:227], v[40:43], v[48:51]
v_mfma_f32_16x16x32_bf16 v[48:51], a[228:231], v[44:47], v[48:51]
s_bitcmp1_b32 s46, 28
s_cbranch_scc0 LE_nf28
s_cmp_eq_u32 s42, 0
s_cbranch_scc1 LE_fl28
buffer_load_dwordx2 v[66:67], v39, s[20:23], s47 offen sc1
s_waitcnt vmcnt(0)
v_lshlrev_b32 v64, 16, v66
v_and_b32 v65, 0xffff0000, v66
v_add_f32 v48, v48, v64
v_add_f32 v49, v49, v65
v_lshlrev_b32 v64, 16, v67
v_and_b32 v65, 0xffff0000, v67
v_add_f32 v50, v50, v64
v_add_f32 v51, v51, v65
LE_fl28:
s_nop 3
v_cvt_pk_bf16_f32 v64, v48, v49
v_cvt_pk_bf16_f32 v65, v50, v51
v_mov_b32 v48, 0
v_mov_b32 v49, 0
v_mov_b32 v50, 0
v_mov_b32 v51, 0
buffer_store_dwordx2 v[64:65], v39, s[20:23], s47 offen
s_add_u32 s47, s47, 512
LE_nf28:
v_mfma_f32_16x16x32_bf16 v[48:51], a[232:235], v[40:43], v[48:51]
v_mfma_f32_16x16x32_bf16 v[48:51], a[236:239], v[44:47], v[48:51]
s_bitcmp1_b32 s46, 29
s_cbranch_scc0 LE_nf29
s_cmp_eq_u32 s42, 0
s_cbranch_scc1 LE_fl29
buffer_load_dwordx2 v[66:67], v39, s[20:23], s47 offen sc1
s_waitcnt vmcnt(0)
v_lshlrev_b32 v64, 16, v66
v_and_b32 v65, 0xffff0000, v66
v_add_f32 v48, v48, v64
v_add_f32 v49, v49, v65
v_lshlrev_b32 v64, 16, v67
v_and_b32 v65, 0xffff0000, v67
v_add_f32 v50, v50, v64
v_add_f32 v51, v51, v65
LE_fl29:
s_nop 3
v_cvt_pk_bf16_f32 v64, v48, v49
v_cvt_pk_bf16_f32 v65, v50, v51
v_mov_b32 v48, 0
v_mov_b32 v49, 0
v_mov_b32 v50, 0
v_mov_b32 v51, 0
buffer_store_dwordx2 v[64:65], v39, s[20:23], s47 offen
s_add_u32 s47, s47, 512
LE_nf29:
v_mfma_f32_16x16x32_bf16 v[48:51], a[240:243], v[40:43], v[48:51]
v_mfma_f32_16x16x32_bf16 v[48:51], a[244:247], v[44:47], v[48:51]
s_bitcmp1_b32 s46, 30
s_cbranch_scc0 LE_nf30
s_cmp_eq_u32 s42, 0
s_cbranch_scc1 LE_fl30
buffer_load_dwordx2 v[66:67], v39, s[20:23], s47 offen sc1
s_waitcnt vmcnt(0)
v_lshlrev_b32 v64, 16, v66
v_and_b32 v65, 0xffff0000, v66
v_add_f32 v48, v48, v64
v_add_f32 v49, v49, v65
v_lshlrev_b32 v64, 16, v67
v_and_b32 v65, 0xffff0000, v67
v_add_f32 v50, v50, v64
v_add_f32 v51, v51, v65
LE_fl30:
s_nop 3
v_cvt_pk_bf16_f32 v64, v48, v49
v_cvt_pk_bf16_f32 v65, v50, v51
v_mov_b32 v48, 0
v_mov_b32 v49, 0
v_mov_b32 v50, 0
v_mov_b32 v51, 0
buffer_store_dwordx2 v[64:65], v39, s[20:23], s47 offen
s_add_u32 s47, s47, 512
LE_nf30:
v_mfma_f32_16x16x32_bf16 v[48:51], a[248:251], v[40:43], v[48:51]
v_mfma_f32_16x16x32_bf16 v[48:51], a[252:255], v[44:47], v[48:51]
s_bitcmp1_b32 s46, 31
s_cbranch_scc0 LE_nf31
s_cmp_eq_u32 s42, 0
s_cbranch_scc1 LE_fl31
buffer_load_dwordx2 v[66:67], v39, s[20:23], s47 offen sc1
s_waitcnt vmcnt(0)
v_lshlrev_b32 v64, 16, v66
v_and_b32 v65, 0xffff0000, v66
v_add_f32 v48, v48, v64
v_add_f32 v49, v49, v65
v_lshlrev_b32 v64, 16, v67
v_and_b32 v65, 0xffff0000, v67
v_add_f32 v50, v50, v64
v_add_f32 v51, v51, v65
LE_fl31:
s_nop 3
v_cvt_pk_bf16_f32 v64, v48, v49
v_cvt_pk_bf16_f32 v65, v50, v51
v_mov_b32 v48, 0
v_mov_b32 v49, 0
v_mov_b32 v50, 0
v_mov_b32 v51, 0
buffer_store_dwordx2 v[64:65], v39, s[20:23], s47 offen
s_add_u32 s47, s47, 512
LE_nf31:
s_waitcnt lgkmcnt(0)
ds_read2_b32 v[52:53], v34 offset0:128 offset1:132
ds_read2_b32 v[54:55], v34 offset0:136 offset1:140
v_mad_u32_u16 v60, v56, s49, v2
v_mad_u32_u16 v61, v57, s49, v2
v_mad_u32_u16 v62, v58, s49, v2
v_mad_u32_u16 v63, v59, s49, v2
buffer_load_dwordx4 a[224:227], v60, s[16:19], 0 offen
buffer_load_dwordx4 a[228:231], v60, s[16:19], 0 offen offset:256
buffer_load_dwordx4 a[232:235], v61, s[16:19], 0 offen
buffer_load_dwordx4 a[236:239], v61, s[16:19], 0 offen offset:256
buffer_load_dwordx4 a[240:243], v62, s[16:19], 0 offen
buffer_load_dwordx4 a[244:247], v62, s[16:19], 0 offen offset:256
buffer_load_dwordx4 a[248:251], v63, s[16:19], 0 offen
buffer_load_dwordx4 a[252:255], v63, s[16:19], 0 offen offset:256
v_add_u32 v34, 512, v34
s_cmp_lt_u32 s45, s44
s_cbranch_scc1 LE_loop
s_add_u32 s42, s42, 1
s_mul_i32 s43, s42, 128
v_cmp_lt_u32 vcc, s43, v4
s_cbranch_vccz LE_done
s_cmp_ge_u32 s42, 40
s_cbranch_scc1 LE_done
s_waitcnt vmcnt(0) lgkmcnt(0)
s_add_u32 s50, s50, 512
v_add_u32 v5, 0x80, v5
buffer_load_dwordx4 v[192:195], v6, s[12:15], s50 offen offset:0
buffer_load_dwordx4 v[196:199], v6, s[12:15], s50 offen offset:32
buffer_load_dwordx4 v[200:203], v6, s[12:15], s50 offen offset:64
buffer_load_dwordx4 v[204:207], v6, s[12:15], s50 offen offset:96
buffer_load_dwordx4 v[208:211], v6, s[12:15], s50 offen offset:128
buffer_load_dwordx4 v[212:215], v6, s[12:15], s50 offen offset:160
buffer_load_dwordx4 v[216:219], v6, s[12:15], s50 offen offset:192
buffer_load_dwordx4 v[220:223], v6, s[12:15], s50 offen offset:224
buffer_load_dwordx4 v[224:227], v6, s[12:15], s50 offen offset:256
buffer_load_dwordx4 v[228:231], v6, s[12:15], s50 offen offset:288
buffer_load_dwordx4 v[232:235], v6, s[12:15], s50 offen offset:320
buffer_load_dwordx4 v[236:239], v6, s[12:15], s50 offen offset:352
buffer_load_dwordx4 v[240:243], v6, s[12:15], s50 offen offset:384
buffer_load_dwordx4 v[244:247], v6, s[12:15], s50 offen offset:416
buffer_load_dwordx4 v[248:251], v6, s[12:15], s50 offen offset:448
buffer_load_dwordx4 v[252:255], v6, s[12:15], s50 offen offset:480
s_branch LE_pass
LE_done:
s_branch L2_end
L2_fin:
L2_end:
s_endpgm
.globl k3_kernel
.p2align 8
.type k3_kernel,@function
k3_kernel:
s_load_dwordx2 s[4:5], s[0:1], 0
s_load_dwordx2 s[6:7], s[0:1], 24
s_load_dwordx2 s[8:9], s[0:1], 72
s_load_dwordx2 s[10:11], s[0:1], 88
s_cmp_ge_u32 s2, 256
s_cbranch_scc1 L3_end
v_lshrrev_b32 v1, 6, v0
v_and_b32 v0, 63, v0
s_and_b32 s3, s2, 7
v_readfirstlane_b32 s44, v1
s_lshr_b32 s12, s2, 3
s_mul_i32 s3, s3, 1280
s_mul_i32 s13, s12, 40
s_add_u32 s45, s3, s13
v_and_b32 v2, 15, v0
v_lshrrev_b32 v3, 4, v0
v_lshlrev_b32 v4, 4, v0
v_lshlrev_b32 v68, 7, v0
s_lshl_b32 s81, s12, 13
s_cmp_eq_u32 s44, 7
s_cselect_b32 s81, s81, 0x7fff0000
s_lshr_b32 s14, s44, 2
s_lshl_b32 s15, s14, 2
v_add_u32 v1, s15, v3
v_and_b32 v5, 7, v0
v_xor_b32 v1, v1, v5
v_lshrrev_b32 v5, 3, v0
v_lshlrev_b32 v5, 9, v5
v_lshl_add_u32 v5, v1, 4, v5
s_lshl_b32 s46, s45, 9
s_add_u32 s47, s46, 8192
s_add_u32 s48, s46, 16384
s_lshl_b32 s15, s14, 12
s_and_b32 s3, s44, 3
s_lshl_b32 s3, s3, 7
s_add_u32 s15, s15, s3
s_add_u32 s50, s46, s15
s_add_u32 s51, s47, s15
s_add_u32 s52, s48, s15
s_cmp_eq_u32 s14, 0
s_cselect_b32 s52, s52, 0x7fff0000
s_lshl_b32 s53, s44, 10
v_lshlrev_b32 v6, 6, v0
v_lshlrev_b32 v7, 1, v0
s_lshl_b32 s14, s45, 6
s_lshl_b32 s15, s45, 1
s_lshl_b32 s3, s44, 6
v_lshrrev_b32 v1, 2, v0
v_xor_b32 v8, v0, v3
v_and_b32 v8, 3, v8
v_lshl_add_u32 v1, v1, 9, s3
v_lshl_add_u32 v8, v8, 4, v1
s_and_b32 s3, s45, 8
v_add_u32 v1, s3, v2
v_lshrrev_b32 v9, 4, v1
v_and_b32 v1, 15, v1
v_lshlrev_b32 v9, 13, v9
v_lshl_add_u32 v9, v1, 4, v9
v_lshl_add_u32 v9, v3, 8, v9
v_add_u32 v9, s53, v9
s_lshr_b32 s3, s45, 4
s_lshl_b32 s3, s3, 13
s_waitcnt lgkmcnt(0)
s_add_u32 s40, s10, 0x1000000
s_addc_u32 s41, s11, 0
s_mov_b32 s42, 0x40000
s_mov_b32 s43, 0x00020000
buffer_load_dword v68, v68, s[40:43], s81 offen
s_cmp_ge_u32 s45, 10000
s_cbranch_scc1 L3_end
s_add_u32 s36, s10, 0x7000000
s_addc_u32 s37, s11, 0
s_mov_b32 s38, 0x4e2000
s_mov_b32 s39, 0x00020000
s_add_u32 s32, s10, 0x6000000
s_addc_u32 s33, s11, 0
s_mov_b32 s34, 0x9c800
s_mov_b32 s35, 0x00020000
s_add_u32 s20, s6, 0x0
s_addc_u32 s21, s7, 0
s_mov_b32 s22, 0x4e20
s_mov_b32 s23, 0x00020000
s_add_u32 s28, s10, 0x2000000
s_addc_u32 s29, s11, 0
s_mov_b32 s30, 0x22e4000
s_mov_b32 s31, 0x00020000
s_add_u32 s16, s4, 0x0
s_addc_u32 s17, s5, 0
s_mov_b32 s18, 0x4e2000
s_mov_b32 s19, 0x00020000
s_mul_i32 s81, s44, 3072
s_add_u32 s81, s81, 65536
s_lshl_b32 s72, s44, 14
s_add_u32 s73, s72, 0x1000
s_add_u32 s74, s72, 0x2000
s_add_u32 s75, s72, 0x3000
s_add_u32 s76, s72, 0x20000
s_add_u32 s77, s72, 0x21000
s_add_u32 s78, s72, 0x22000
s_add_u32 s79, s72, 0x23000
s_mov_b32 exec_hi, 0xff
buffer_load_dwordx4 v[100:103], v6, s[32:35], s14 offen offset:0
s_mov_b32 exec_hi, -1
s_mov_b32 exec_hi, 0xff
buffer_load_dwordx4 v[104:107], v6, s[32:35], s14 offen offset:16
s_mov_b32 exec_hi, -1
s_mov_b32 exec_hi, 0xff
buffer_load_dwordx4 v[108:111], v6, s[32:35], s14 offen offset:32
s_mov_b32 exec_hi, -1
s_mov_b32 exec_hi, 0xff
buffer_load_ushort v112, v7, s[20:23], s15 offen
s_mov_b32 exec_hi, -1
s_add_u32 m0, s53, 0
s_nop 0
buffer_load_dwordx4 v5, s[36:39], s50 offen lds
s_add_u32 m0, s53, 8192
s_nop 0
buffer_load_dwordx4 v5, s[36:39], s51 offen lds
s_and_b32 s12, s45, 8
v_and_b32 v1, 7, v2
v_add_u32 v1, s12, v1
v_lshl_add_u32 v17, v3, 8, s53
v_lshl_add_u32 v17, v1, 4, v17
v_lshrrev_b32 v1, 3, v2
s_mov_b32 s12, 0x1200000
v_mul_lo_u32 v1, v1, s12
v_add_u32 v17, v1, v17
v_lshrrev_b32 v1, 1, v2
v_xor_b32 v1, v1, v3
v_lshrrev_b32 v10, 3, v2
v_lshlrev_b32 v10, 12, v10
v_lshl_add_u32 v10, v1, 4, v10
v_and_b32 v1, 7, v2
v_lshl_add_u32 v10, v1, 7, v10
v_xor_b32 v11, 64, v10
s_lshl_b32 s12, s44, 11
s_add_u32 s12, s12, 49152
v_lshl_add_u32 v12, v0, 5, s12
v_lshl_add_u32 v13, v2, 5, s12
v_lshl_add_u32 v18, v1, 5, s12
v_lshrrev_b32 v1, 3, v2
v_lshl_add_u32 v18, v1, 4, v18
v_lshrrev_b32 v1, 2, v2
v_xor_b32 v1, v1, v3
v_lshl_add_u32 v14, v2, 6, s81
v_lshl_add_u32 v14, v1, 4, v14
v_add_u32 v15, s81, v4
s_add_u32 s12, s53, 24576
v_add_u32 v16, s12, v4
s_mov_b32 s80, 0xffff0000
s_add_u32 s24, s8, 0x0
s_addc_u32 s25, s9, 0
s_mov_b32 s26, 0x4e2000
s_mov_b32 s27, 0x00020000
s_waitcnt vmcnt(5)
s_add_u32 m0, s53, 16384
s_nop 0
buffer_load_dwordx4 v5, s[36:39], s52 offen lds
s_waitcnt vmcnt(5)
s_add_u32 s54, s3, 0x0
buffer_load_dwordx4 v[116:119], v9, s[28:31], s54 offen
s_waitcnt vmcnt(5)
s_add_u32 s55, s3, 0x600000
buffer_load_dwordx4 v[120:123], v9, s[28:31], s55 offen
s_waitcnt vmcnt(5)
s_add_u32 s56, s3, 0xc00000
buffer_load_dwordx4 v[124:127], v9, s[28:31], s56 offen
v_max3_f32 v1, v100, v102, v104
v_max3_f32 v69, v106, v108, v110
v_max_f32 v1, v1, v69
v_sub_f32 v100, v100, v1
v_sub_f32 v102, v102, v1
v_sub_f32 v104, v104, v1
v_sub_f32 v106, v106, v1
v_sub_f32 v108, v108, v1
v_sub_f32 v110, v110, v1
v_exp_f32 v100, v100
v_exp_f32 v102, v102
v_exp_f32 v104, v104
v_exp_f32 v106, v106
v_exp_f32 v108, v108
v_exp_f32 v110, v110
v_lshlrev_b32 v63, 16, v112
v_mul_f32 v1, v100, v101
v_fmac_f32 v1, v102, v103
v_fmac_f32 v1, v104, v105
v_fmac_f32 v1, v106, v107
v_fmac_f32 v1, v108, v109
v_fmac_f32 v1, v110, v111
v_rcp_f32 v1, v1
v_mov_b32 v67, v63
v_mul_f32 v60, v100, v1
v_mul_f32 v61, v102, v1
v_mul_f32 v62, v104, v1
v_mul_f32 v64, v106, v1
v_mul_f32 v65, v108, v1
v_mul_f32 v66, v110, v1
ds_write_b128 v12, v[60:63]
ds_write_b128 v12, v[64:67] offset:16
ds_read_b32 v19, v13 offset:12
ds_read_b32 v20, v13 offset:524
ds_read_b32 v21, v13 offset:1036
ds_read_b128 v[52:55], v13 offset:0
ds_read_b128 v[56:59], v13 offset:16
s_waitcnt vmcnt(5)
buffer_load_dwordx4 v[128:131], v4, s[40:43], s72 offen offset:0
s_waitcnt vmcnt(5)
buffer_load_dwordx4 v[132:135], v4, s[40:43], s72 offen offset:1024
s_waitcnt vmcnt(5)
buffer_load_dwordx4 v[136:139], v4, s[40:43], s72 offen offset:2048
s_waitcnt vmcnt(5)
s_add_u32 s57, s3, 0x1200000
buffer_load_dwordx4 v[140:143], v9, s[28:31], s57 offen
s_waitcnt lgkmcnt(0)
v_lshlrev_b32 v70, 16, v116
v_and_b32 v71, s80, v116
v_mul_f32 v60, v70, v52
v_mul_f32 v61, v71, v52
v_lshlrev_b32 v72, 16, v117
v_and_b32 v73, s80, v117
v_mul_f32 v62, v72, v52
v_mul_f32 v63, v73, v52
v_lshlrev_b32 v74, 16, v118
v_and_b32 v75, s80, v118
v_mul_f32 v64, v74, v52
v_mul_f32 v65, v75, v52
v_lshlrev_b32 v68, 16, v119
v_and_b32 v69, s80, v119
v_mul_f32 v66, v68, v52
v_mul_f32 v67, v69, v52
s_barrier
ds_read_b128 v[76:79], v10 offset:0
ds_read_b128 v[80:83], v10 offset:8192
ds_read_b128 v[84:87], v10 offset:16384
ds_read_b128 v[88:91], v11 offset:0
ds_read_b128 v[92:95], v11 offset:8192
s_waitcnt vmcnt(5)
buffer_load_dwordx4 v[144:147], v4, s[40:43], s72 offen offset:3072
v_lshlrev_b32 v70, 16, v120
v_and_b32 v71, s80, v120
v_fmac_f32 v60, v70, v53
v_fmac_f32 v61, v71, v53
v_lshlrev_b32 v72, 16, v121
v_and_b32 v73, s80, v121
v_fmac_f32 v62, v72, v53
v_fmac_f32 v63, v73, v53
v_lshlrev_b32 v74, 16, v122
v_and_b32 v75, s80, v122
v_fmac_f32 v64, v74, v53
v_fmac_f32 v65, v75, v53
v_lshlrev_b32 v68, 16, v123
v_and_b32 v69, s80, v123
v_fmac_f32 v66, v68, v53
v_fmac_f32 v67, v69, v53
s_waitcnt vmcnt(5)
buffer_load_dwordx4 v[148:151], v4, s[40:43], s73 offen offset:0
v_lshlrev_b32 v70, 16, v124
v_and_b32 v71, s80, v124
v_fmac_f32 v60, v70, v54
v_fmac_f32 v61, v71, v54
v_lshlrev_b32 v72, 16, v125
v_and_b32 v73, s80, v125
v_fmac_f32 v62, v72, v54
v_fmac_f32 v63, v73, v54
v_lshlrev_b32 v74, 16, v126
v_and_b32 v75, s80, v126
v_fmac_f32 v64, v74, v54
v_fmac_f32 v65, v75, v54
v_lshlrev_b32 v68, 16, v127
v_and_b32 v69, s80, v127
v_fmac_f32 v66, v68, v54
v_fmac_f32 v67, v69, v54
s_waitcnt vmcnt(5)
buffer_load_dwordx4 v[152:155], v4, s[40:43], s73 offen offset:1024
s_waitcnt vmcnt(5)
s_add_u32 s54, s3, 0x1800000
buffer_load_dwordx4 v[156:159], v9, s[28:31], s54 offen
s_waitcnt lgkmcnt(4)
v_mfma_f32_16x16x32_bf16 v[24:27], v[128:131], v[76:79], 0
ds_read_b128 v[96:99], v11 offset:16384
v_mfma_f32_16x16x32_bf16 v[28:31], v[132:135], v[76:79], 0
s_waitcnt lgkmcnt(4)
v_mfma_f32_16x16x32_bf16 v[32:35], v[128:131], v[80:83], 0
ds_read_b128 v[76:79], v10 offset:1024
v_mfma_f32_16x16x32_bf16 v[36:39], v[132:135], v[80:83], 0
s_waitcnt lgkmcnt(4)
v_mfma_f32_16x16x32_bf16 v[40:43], v[128:131], v[84:87], 0
ds_read_b128 v[80:83], v10 offset:9216
v_mfma_f32_16x16x32_bf16 v[44:47], v[132:135], v[84:87], 0
s_waitcnt vmcnt(5)
buffer_load_dwordx4 v[160:163], v4, s[40:43], s73 offen offset:2048
s_waitcnt vmcnt(5)
buffer_load_dwordx4 v[164:167], v4, s[40:43], s73 offen offset:3072
v_lshlrev_b32 v70, 16, v140
v_and_b32 v71, s80, v140
v_fmac_f32 v60, v70, v56
v_fmac_f32 v61, v71, v56
v_lshlrev_b32 v72, 16, v141
v_and_b32 v73, s80, v141
v_fmac_f32 v62, v72, v56
v_fmac_f32 v63, v73, v56
v_lshlrev_b32 v74, 16, v142
v_and_b32 v75, s80, v142
v_fmac_f32 v64, v74, v56
v_fmac_f32 v65, v75, v56
v_lshlrev_b32 v68, 16, v143
v_and_b32 v69, s80, v143
v_fmac_f32 v66, v68, v56
v_fmac_f32 v67, v69, v56
s_waitcnt vmcnt(5)
buffer_load_dwordx4 v[168:171], v4, s[40:43], s74 offen offset:0
s_waitcnt lgkmcnt(4)
v_mfma_f32_16x16x32_bf16 v[24:27], v[136:139], v[88:91], v[24:27]
ds_read_b128 v[84:87], v10 offset:17408
v_mfma_f32_16x16x32_bf16 v[28:31], v[144:147], v[88:91], v[28:31]
s_waitcnt lgkmcnt(4)
v_mfma_f32_16x16x32_bf16 v[32:35], v[136:139], v[92:95], v[32:35]
ds_read_b128 v[88:91], v11 offset:1024
v_mfma_f32_16x16x32_bf16 v[36:39], v[144:147], v[92:95], v[36:39]
s_waitcnt lgkmcnt(4)
v_mfma_f32_16x16x32_bf16 v[40:43], v[136:139], v[96:99], v[40:43]
ds_read_b128 v[92:95], v11 offset:9216
v_mfma_f32_16x16x32_bf16 v[44:47], v[144:147], v[96:99], v[44:47]
s_waitcnt vmcnt(5)
s_add_u32 s55, s3, 0x1e00000
buffer_load_dwordx4 v[172:175], v9, s[28:31], s55 offen
s_waitcnt vmcnt(5)
buffer_load_dwordx4 v[176:179], v4, s[40:43], s74 offen offset:1024
s_waitcnt lgkmcnt(4)
v_mfma_f32_16x16x32_bf16 v[24:27], v[148:151], v[76:79], v[24:27]
ds_read_b128 v[96:99], v11 offset:17408
v_mfma_f32_16x16x32_bf16 v[28:31], v[152:155], v[76:79], v[28:31]
s_waitcnt lgkmcnt(4)
v_mfma_f32_16x16x32_bf16 v[32:35], v[148:151], v[80:83], v[32:35]
ds_read_b128 v[76:79], v10 offset:2048
v_mfma_f32_16x16x32_bf16 v[36:39], v[152:155], v[80:83], v[36:39]
s_waitcnt lgkmcnt(4)
v_mfma_f32_16x16x32_bf16 v[40:43], v[148:151], v[84:87], v[40:43]
ds_read_b128 v[80:83], v10 offset:10240
v_mfma_f32_16x16x32_bf16 v[44:47], v[152:155], v[84:87], v[44:47]
s_waitcnt vmcnt(5)
buffer_load_dwordx4 v[180:183], v4, s[40:43], s74 offen offset:2048
v_lshlrev_b32 v70, 16, v156
v_and_b32 v71, s80, v156
v_fmac_f32 v60, v70, v57
v_fmac_f32 v61, v71, v57
v_lshlrev_b32 v72, 16, v157
v_and_b32 v73, s80, v157
v_fmac_f32 v62, v72, v57
v_fmac_f32 v63, v73, v57
v_lshlrev_b32 v74, 16, v158
v_and_b32 v75, s80, v158
v_fmac_f32 v64, v74, v57
v_fmac_f32 v65, v75, v57
v_lshlrev_b32 v68, 16, v159
v_and_b32 v69, s80, v159
v_fmac_f32 v66, v68, v57
v_fmac_f32 v67, v69, v57
s_waitcnt vmcnt(5)
buffer_load_dwordx4 v[184:187], v4, s[40:43], s74 offen offset:3072
s_waitcnt vmcnt(5)
s_add_u32 m0, s81, 0
s_nop 0
buffer_load_dwordx4 v8, s[16:19], s46 offen lds
s_waitcnt lgkmcnt(4)
v_mfma_f32_16x16x32_bf16 v[24:27], v[160:163], v[88:91], v[24:27]
ds_read_b128 v[84:87], v10 offset:18432
v_mfma_f32_16x16x32_bf16 v[28:31], v[164:167], v[88:91], v[28:31]
s_waitcnt lgkmcnt(4)
v_mfma_f32_16x16x32_bf16 v[32:35], v[160:163], v[92:95], v[32:35]
ds_read_b128 v[88:91], v11 offset:2048
v_mfma_f32_16x16x32_bf16 v[36:39], v[164:167], v[92:95], v[36:39]
s_waitcnt lgkmcnt(4)
v_mfma_f32_16x16x32_bf16 v[40:43], v[160:163], v[96:99], v[40:43]
ds_read_b128 v[92:95], v11 offset:10240
v_mfma_f32_16x16x32_bf16 v[44:47], v[164:167], v[96:99], v[44:47]
s_waitcnt vmcnt(5)
buffer_load_dwordx4 v[188:191], v4, s[40:43], s75 offen offset:0
s_waitcnt vmcnt(5)
s_add_u32 m0, s81, 1024
s_nop 0
buffer_load_dwordx4 v8, s[16:19], s47 offen lds
v_lshlrev_b32 v70, 16, v172
v_and_b32 v71, s80, v172
v_fmac_f32 v60, v70, v58
v_fmac_f32 v61, v71, v58
v_lshlrev_b32 v72, 16, v173
v_and_b32 v73, s80, v173
v_fmac_f32 v62, v72, v58
v_fmac_f32 v63, v73, v58
v_lshlrev_b32 v74, 16, v174
v_and_b32 v75, s80, v174
v_fmac_f32 v64, v74, v58
v_fmac_f32 v65, v75, v58
v_lshlrev_b32 v68, 16, v175
v_and_b32 v69, s80, v175
v_fmac_f32 v66, v68, v58
v_fmac_f32 v67, v69, v58
ds_read_b128 v[52:55], v18 offset:1024
v_cvt_pk_bf16_f32 v68, v60, v61
v_cvt_pk_bf16_f32 v69, v62, v63
v_cvt_pk_bf16_f32 v70, v64, v65
v_cvt_pk_bf16_f32 v71, v66, v67
ds_write_b128 v16, v[68:71] offset:0
s_waitcnt vmcnt(5)
buffer_load_dwordx4 v[192:195], v4, s[40:43], s75 offen offset:1024
s_waitcnt lgkmcnt(6)
v_mfma_f32_16x16x32_bf16 v[24:27], v[168:171], v[76:79], v[24:27]
ds_read_b128 v[96:99], v11 offset:18432
v_mfma_f32_16x16x32_bf16 v[28:31], v[176:179], v[76:79], v[28:31]
s_waitcnt lgkmcnt(6)
v_mfma_f32_16x16x32_bf16 v[32:35], v[168:171], v[80:83], v[32:35]
ds_read_b128 v[76:79], v10 offset:3072
v_mfma_f32_16x16x32_bf16 v[36:39], v[176:179], v[80:83], v[36:39]
s_waitcnt lgkmcnt(6)
v_mfma_f32_16x16x32_bf16 v[40:43], v[168:171], v[84:87], v[40:43]
ds_read_b128 v[80:83], v10 offset:11264
v_mfma_f32_16x16x32_bf16 v[44:47], v[176:179], v[84:87], v[44:47]
s_waitcnt vmcnt(5)
s_add_u32 m0, s81, 2048
s_mov_b32 exec_hi, 0
buffer_load_dwordx4 v8, s[16:19], s48 offen lds
s_mov_b32 exec_hi, -1
s_waitcnt vmcnt(5)
buffer_load_dwordx4 v[196:199], v4, s[40:43], s75 offen offset:2048
s_waitcnt lgkmcnt(6)
v_mfma_f32_16x16x32_bf16 v[24:27], v[180:183], v[88:91], v[24:27]
ds_read_b128 v[84:87], v10 offset:19456
v_mfma_f32_16x16x32_bf16 v[28:31], v[184:187], v[88:91], v[28:31]
s_waitcnt lgkmcnt(6)
v_mfma_f32_16x16x32_bf16 v[32:35], v[180:183], v[92:95], v[32:35]
ds_read_b128 v[88:91], v11 offset:3072
v_mfma_f32_16x16x32_bf16 v[36:39], v[184:187], v[92:95], v[36:39]
s_waitcnt lgkmcnt(4)
v_mfma_f32_16x16x32_bf16 v[40:43], v[180:183], v[96:99], v[40:43]
ds_read_b128 v[92:95], v11 offset:11264
v_mfma_f32_16x16x32_bf16 v[44:47], v[184:187], v[96:99], v[44:47]
s_waitcnt vmcnt(5)
buffer_load_dwordx4 v[200:203], v4, s[40:43], s75 offen offset:3072
s_waitcnt vmcnt(5)
s_add_u32 s54, s3, 0x4000
buffer_load_dwordx4 v[204:207], v17, s[28:31], s54 offen
s_waitcnt vmcnt(5)
buffer_load_dwordx4 v[208:211], v4, s[40:43], s76 offen offset:0
s_waitcnt vmcnt(5)
buffer_load_dwordx4 v[212:215], v4, s[40:43], s76 offen offset:1024
s_waitcnt lgkmcnt(4)
v_mfma_f32_16x16x32_bf16 v[24:27], v[188:191], v[76:79], v[24:27]
ds_read_b128 v[96:99], v11 offset:19456
v_mfma_f32_16x16x32_bf16 v[28:31], v[192:195], v[76:79], v[28:31]
s_waitcnt lgkmcnt(4)
v_mfma_f32_16x16x32_bf16 v[32:35], v[188:191], v[80:83], v[32:35]
v_mfma_f32_16x16x32_bf16 v[36:39], v[192:195], v[80:83], v[36:39]
s_waitcnt lgkmcnt(3)
v_mfma_f32_16x16x32_bf16 v[40:43], v[188:191], v[84:87], v[40:43]
v_mfma_f32_16x16x32_bf16 v[44:47], v[192:195], v[84:87], v[44:47]
s_waitcnt vmcnt(5)
buffer_load_dwordx4 v[216:219], v4, s[40:43], s76 offen offset:2048
s_waitcnt vmcnt(5)
s_add_u32 s55, s3, 0x604000
buffer_load_dwordx4 v[220:223], v17, s[28:31], s55 offen
s_waitcnt vmcnt(5)
buffer_load_dwordx4 v[224:227], v4, s[40:43], s76 offen offset:3072
s_waitcnt lgkmcnt(2)
v_mfma_f32_16x16x32_bf16 v[24:27], v[196:199], v[88:91], v[24:27]
v_mfma_f32_16x16x32_bf16 v[28:31], v[200:203], v[88:91], v[28:31]
s_waitcnt lgkmcnt(1)
v_mfma_f32_16x16x32_bf16 v[32:35], v[196:199], v[92:95], v[32:35]
v_mfma_f32_16x16x32_bf16 v[36:39], v[200:203], v[92:95], v[36:39]
ds_read_b128 v[48:51], v14 offset:0
s_waitcnt lgkmcnt(0)
v_lshlrev_b32 v70, 16, v48
v_and_b32 v71, s80, v48
v_fma_f32 v24, v24, v19, v70
v_fma_f32 v25, v25, v19, v71
v_lshlrev_b32 v72, 16, v49
v_and_b32 v73, s80, v49
v_fma_f32 v26, v26, v19, v72
v_fma_f32 v27, v27, v19, v73
v_lshlrev_b32 v74, 16, v50
v_and_b32 v75, s80, v50
v_fma_f32 v28, v28, v19, v74
v_fma_f32 v29, v29, v19, v75
v_lshlrev_b32 v68, 16, v51
v_and_b32 v69, s80, v51
v_fma_f32 v30, v30, v19, v68
v_fma_f32 v31, v31, v19, v69
v_mfma_f32_16x16x32_bf16 v[40:43], v[196:199], v[96:99], v[40:43]
v_mfma_f32_16x16x32_bf16 v[44:47], v[200:203], v[96:99], v[44:47]
ds_read_b128 v[48:51], v14 offset:1024
s_waitcnt lgkmcnt(0)
v_lshlrev_b32 v70, 16, v48
v_and_b32 v71, s80, v48
v_fma_f32 v32, v32, v20, v70
v_fma_f32 v33, v33, v20, v71
v_lshlrev_b32 v72, 16, v49
v_and_b32 v73, s80, v49
v_fma_f32 v34, v34, v20, v72
v_fma_f32 v35, v35, v20, v73
v_lshlrev_b32 v74, 16, v50
v_and_b32 v75, s80, v50
v_fma_f32 v36, v36, v20, v74
v_fma_f32 v37, v37, v20, v75
v_lshlrev_b32 v68, 16, v51
v_and_b32 v69, s80, v51
v_fma_f32 v38, v38, v20, v68
v_fma_f32 v39, v39, v20, v69
s_waitcnt vmcnt(5)
buffer_load_dwordx4 v[228:231], v4, s[40:43], s77 offen offset:0
ds_read_b128 v[48:51], v14 offset:2048
s_waitcnt lgkmcnt(0)
v_lshlrev_b32 v70, 16, v48
v_and_b32 v71, s80, v48
v_fma_f32 v40, v40, v21, v70
v_fma_f32 v41, v41, v21, v71
v_lshlrev_b32 v72, 16, v49
v_and_b32 v73, s80, v49
v_fma_f32 v42, v42, v21, v72
v_fma_f32 v43, v43, v21, v73
v_lshlrev_b32 v74, 16, v50
v_and_b32 v75, s80, v50
v_fma_f32 v44, v44, v21, v74
v_fma_f32 v45, v45, v21, v75
v_lshlrev_b32 v68, 16, v51
v_and_b32 v69, s80, v51
v_fma_f32 v46, v46, v21, v68
v_fma_f32 v47, v47, v21, v69
v_lshlrev_b32 v70, 16, v204
v_and_b32 v71, s80, v204
v_mul_f32 v60, v70, v52
v_mul_f32 v61, v71, v52
v_lshlrev_b32 v72, 16, v205
v_and_b32 v73, s80, v205
v_mul_f32 v62, v72, v52
v_mul_f32 v63, v73, v52
v_lshlrev_b32 v74, 16, v206
v_and_b32 v75, s80, v206
v_mul_f32 v64, v74, v52
v_mul_f32 v65, v75, v52
v_lshlrev_b32 v68, 16, v207
v_and_b32 v69, s80, v207
v_mul_f32 v66, v68, v52
v_mul_f32 v67, v69, v52
s_waitcnt vmcnt(5)
buffer_load_dwordx4 v[232:235], v4, s[40:43], s77 offen offset:1024
s_waitcnt vmcnt(5)
s_add_u32 s56, s3, 0xc04000
buffer_load_dwordx4 v[236:239], v17, s[28:31], s56 offen
s_waitcnt vmcnt(5)
buffer_load_dwordx4 v[240:243], v4, s[40:43], s77 offen offset:2048
s_waitcnt vmcnt(5)
buffer_load_dwordx4 v[244:247], v4, s[40:43], s77 offen offset:3072
v_lshlrev_b32 v70, 16, v220
v_and_b32 v71, s80, v220
v_fmac_f32 v60, v70, v53
v_fmac_f32 v61, v71, v53
v_lshlrev_b32 v72, 16, v221
v_and_b32 v73, s80, v221
v_fmac_f32 v62, v72, v53
v_fmac_f32 v63, v73, v53
v_lshlrev_b32 v74, 16, v222
v_and_b32 v75, s80, v222
v_fmac_f32 v64, v74, v53
v_fmac_f32 v65, v75, v53
v_lshlrev_b32 v68, 16, v223
v_and_b32 v69, s80, v223
v_fmac_f32 v66, v68, v53
v_fmac_f32 v67, v69, v53
s_waitcnt vmcnt(5)
buffer_load_dwordx4 v[248:251], v4, s[40:43], s78 offen offset:0
s_waitcnt vmcnt(5)
s_add_u32 s56, s3, 0x2000
buffer_load_dwordx4 v[252:255], v9, s[28:31], s56 offen
s_waitcnt vmcnt(5)
buffer_load_dwordx4 v[100:103], v4, s[40:43], s78 offen offset:1024
s_waitcnt vmcnt(5)
buffer_load_dwordx4 v[104:107], v4, s[40:43], s78 offen offset:2048
v_lshlrev_b32 v70, 16, v236
v_and_b32 v71, s80, v236
v_fmac_f32 v60, v70, v54
v_fmac_f32 v61, v71, v54
v_lshlrev_b32 v72, 16, v237
v_and_b32 v73, s80, v237
v_fmac_f32 v62, v72, v54
v_fmac_f32 v63, v73, v54
v_lshlrev_b32 v74, 16, v238
v_and_b32 v75, s80, v238
v_fmac_f32 v64, v74, v54
v_fmac_f32 v65, v75, v54
v_lshlrev_b32 v68, 16, v239
v_and_b32 v69, s80, v239
v_fmac_f32 v66, v68, v54
v_fmac_f32 v67, v69, v54
ds_read_b128 v[52:55], v13 offset:512
ds_read_b128 v[56:59], v13 offset:528
v_add_f32_dpp v60, v60, v60 row_ror:8 row_mask:0xf bank_mask:0xf
v_add_f32_dpp v61, v61, v61 row_ror:8 row_mask:0xf bank_mask:0xf
v_add_f32_dpp v62, v62, v62 row_ror:8 row_mask:0xf bank_mask:0xf
v_add_f32_dpp v63, v63, v63 row_ror:8 row_mask:0xf bank_mask:0xf
v_add_f32_dpp v64, v64, v64 row_ror:8 row_mask:0xf bank_mask:0xf
v_add_f32_dpp v65, v65, v65 row_ror:8 row_mask:0xf bank_mask:0xf
v_add_f32_dpp v66, v66, v66 row_ror:8 row_mask:0xf bank_mask:0xf
v_add_f32_dpp v67, v67, v67 row_ror:8 row_mask:0xf bank_mask:0xf
v_cvt_pk_bf16_f32 v68, v60, v61
v_cvt_pk_bf16_f32 v69, v62, v63
v_cvt_pk_bf16_f32 v70, v64, v65
v_cvt_pk_bf16_f32 v71, v66, v67
ds_write_b128 v16, v[68:71] offset:16384
s_waitcnt lgkmcnt(0)
s_barrier
ds_read_b128 v[76:79], v4 offset:24576
ds_read_b128 v[80:83], v4 offset:40960
ds_read_b128 v[84:87], v4 offset:25600
ds_read_b128 v[88:91], v4 offset:41984
ds_read_b128 v[92:95], v4 offset:26624
s_waitcnt lgkmcnt(4)
v_mfma_f32_16x16x32_bf16 v[24:27], v[208:211], v[76:79], v[24:27]
ds_read_b128 v[96:99], v4 offset:43008
v_mfma_f32_16x16x32_bf16 v[28:31], v[212:215], v[76:79], v[28:31]
s_waitcnt lgkmcnt(4)
v_mfma_f32_16x16x32_bf16 v[40:43], v[208:211], v[80:83], v[40:43]
ds_read_b128 v[76:79], v4 offset:27648
v_mfma_f32_16x16x32_bf16 v[44:47], v[212:215], v[80:83], v[44:47]
s_waitcnt lgkmcnt(4)
v_mfma_f32_16x16x32_bf16 v[24:27], v[216:219], v[84:87], v[24:27]
ds_read_b128 v[80:83], v4 offset:44032
v_mfma_f32_16x16x32_bf16 v[28:31], v[224:227], v[84:87], v[28:31]
s_waitcnt lgkmcnt(4)
v_mfma_f32_16x16x32_bf16 v[40:43], v[216:219], v[88:91], v[40:43]
ds_read_b128 v[84:87], v4 offset:28672
v_mfma_f32_16x16x32_bf16 v[44:47], v[224:227], v[88:91], v[44:47]
s_waitcnt vmcnt(5)
s_add_u32 s57, s3, 0x602000
buffer_load_dwordx4 v[108:111], v9, s[28:31], s57 offen
s_waitcnt lgkmcnt(4)
v_mfma_f32_16x16x32_bf16 v[24:27], v[228:231], v[92:95], v[24:27]
ds_read_b128 v[88:91], v4 offset:45056
v_mfma_f32_16x16x32_bf16 v[28:31], v[232:235], v[92:95], v[28:31]
s_waitcnt lgkmcnt(4)
v_mfma_f32_16x16x32_bf16 v[40:43], v[228:231], v[96:99], v[40:43]
ds_read_b128 v[92:95], v4 offset:29696
v_mfma_f32_16x16x32_bf16 v[44:47], v[232:235], v[96:99], v[44:47]
s_waitcnt vmcnt(5)
buffer_load_dwordx4 v[112:115], v4, s[40:43], s78 offen offset:3072
s_waitcnt lgkmcnt(4)
v_mfma_f32_16x16x32_bf16 v[24:27], v[240:243], v[76:79], v[24:27]
ds_read_b128 v[96:99], v4 offset:46080
v_mfma_f32_16x16x32_bf16 v[28:31], v[244:247], v[76:79], v[28:31]
s_waitcnt lgkmcnt(4)
v_mfma_f32_16x16x32_bf16 v[40:43], v[240:243], v[80:83], v[40:43]
ds_read_b128 v[76:79], v4 offset:30720
v_mfma_f32_16x16x32_bf16 v[44:47], v[244:247], v[80:83], v[44:47]
s_waitcnt vmcnt(5)
buffer_load_dwordx4 v[116:119], v4, s[40:43], s79 offen offset:0
s_waitcnt vmcnt(5)
s_add_u32 s54, s3, 0xc02000
buffer_load_dwordx4 v[120:123], v9, s[28:31], s54 offen
v_lshlrev_b32 v70, 16, v252
v_and_b32 v71, s80, v252
v_mul_f32 v60, v70, v52
v_mul_f32 v61, v71, v52
v_lshlrev_b32 v72, 16, v253
v_and_b32 v73, s80, v253
v_mul_f32 v62, v72, v52
v_mul_f32 v63, v73, v52
v_lshlrev_b32 v74, 16, v254
v_and_b32 v75, s80, v254
v_mul_f32 v64, v74, v52
v_mul_f32 v65, v75, v52
v_lshlrev_b32 v68, 16, v255
v_and_b32 v69, s80, v255
v_mul_f32 v66, v68, v52
v_mul_f32 v67, v69, v52
s_waitcnt vmcnt(5)
buffer_load_dwordx4 v[124:127], v4, s[40:43], s79 offen offset:1024
s_waitcnt lgkmcnt(4)
v_mfma_f32_16x16x32_bf16 v[24:27], v[248:251], v[84:87], v[24:27]
ds_read_b128 v[80:83], v4 offset:47104
v_mfma_f32_16x16x32_bf16 v[28:31], v[100:103], v[84:87], v[28:31]
s_waitcnt lgkmcnt(4)
v_mfma_f32_16x16x32_bf16 v[40:43], v[248:251], v[88:91], v[40:43]
ds_read_b128 v[84:87], v4 offset:31744
v_mfma_f32_16x16x32_bf16 v[44:47], v[100:103], v[88:91], v[44:47]
s_waitcnt vmcnt(5)
s_add_u32 s55, s3, 0x1202000
buffer_load_dwordx4 v[128:131], v9, s[28:31], s55 offen
s_waitcnt vmcnt(5)
buffer_load_dwordx4 v[132:135], v4, s[40:43], s79 offen offset:2048
v_lshlrev_b32 v70, 16, v108
v_and_b32 v71, s80, v108
v_fmac_f32 v60, v70, v53
v_fmac_f32 v61, v71, v53
v_lshlrev_b32 v72, 16, v109
v_and_b32 v73, s80, v109
v_fmac_f32 v62, v72, v53
v_fmac_f32 v63, v73, v53
v_lshlrev_b32 v74, 16, v110
v_and_b32 v75, s80, v110
v_fmac_f32 v64, v74, v53
v_fmac_f32 v65, v75, v53
v_lshlrev_b32 v68, 16, v111
v_and_b32 v69, s80, v111
v_fmac_f32 v66, v68, v53
v_fmac_f32 v67, v69, v53
s_waitcnt vmcnt(5)
s_add_u32 s56, s3, 0x1802000
buffer_load_dwordx4 v[140:143], v9, s[28:31], s56 offen
s_waitcnt lgkmcnt(4)
v_mfma_f32_16x16x32_bf16 v[24:27], v[104:107], v[92:95], v[24:27]
ds_read_b128 v[88:91], v4 offset:48128
v_mfma_f32_16x16x32_bf16 v[28:31], v[112:115], v[92:95], v[28:31]
s_waitcnt lgkmcnt(4)
v_mfma_f32_16x16x32_bf16 v[40:43], v[104:107], v[96:99], v[40:43]
v_mfma_f32_16x16x32_bf16 v[44:47], v[112:115], v[96:99], v[44:47]
s_waitcnt vmcnt(5)
buffer_load_dwordx4 v[136:139], v4, s[40:43], s79 offen offset:3072
s_waitcnt vmcnt(5)
s_add_u32 s57, s3, 0x1e02000
buffer_load_dwordx4 v[144:147], v9, s[28:31], s57 offen
v_lshlrev_b32 v70, 16, v120
v_and_b32 v71, s80, v120
v_fmac_f32 v60, v70, v54
v_fmac_f32 v61, v71, v54
v_lshlrev_b32 v72, 16, v121
v_and_b32 v73, s80, v121
v_fmac_f32 v62, v72, v54
v_fmac_f32 v63, v73, v54
v_lshlrev_b32 v74, 16, v122
v_and_b32 v75, s80, v122
v_fmac_f32 v64, v74, v54
v_fmac_f32 v65, v75, v54
v_lshlrev_b32 v68, 16, v123
v_and_b32 v69, s80, v123
v_fmac_f32 v66, v68, v54
v_fmac_f32 v67, v69, v54
s_waitcnt vmcnt(5)
s_waitcnt lgkmcnt(3)
v_mfma_f32_16x16x32_bf16 v[24:27], v[116:119], v[76:79], v[24:27]
v_mfma_f32_16x16x32_bf16 v[28:31], v[124:127], v[76:79], v[28:31]
s_waitcnt lgkmcnt(2)
v_mfma_f32_16x16x32_bf16 v[40:43], v[116:119], v[80:83], v[40:43]
v_mfma_f32_16x16x32_bf16 v[44:47], v[124:127], v[80:83], v[44:47]
s_waitcnt vmcnt(4)
v_lshlrev_b32 v70, 16, v128
v_and_b32 v71, s80, v128
v_fmac_f32 v60, v70, v56
v_fmac_f32 v61, v71, v56
v_lshlrev_b32 v72, 16, v129
v_and_b32 v73, s80, v129
v_fmac_f32 v62, v72, v56
v_fmac_f32 v63, v73, v56
v_lshlrev_b32 v74, 16, v130
v_and_b32 v75, s80, v130
v_fmac_f32 v64, v74, v56
v_fmac_f32 v65, v75, v56
v_lshlrev_b32 v68, 16, v131
v_and_b32 v69, s80, v131
v_fmac_f32 v66, v68, v56
v_fmac_f32 v67, v69, v56
s_waitcnt vmcnt(3)
s_waitcnt vmcnt(2)
v_lshlrev_b32 v70, 16, v140
v_and_b32 v71, s80, v140
v_fmac_f32 v60, v70, v57
v_fmac_f32 v61, v71, v57
v_lshlrev_b32 v72, 16, v141
v_and_b32 v73, s80, v141
v_fmac_f32 v62, v72, v57
v_fmac_f32 v63, v73, v57
v_lshlrev_b32 v74, 16, v142
v_and_b32 v75, s80, v142
v_fmac_f32 v64, v74, v57
v_fmac_f32 v65, v75, v57
v_lshlrev_b32 v68, 16, v143
v_and_b32 v69, s80, v143
v_fmac_f32 v66, v68, v57
v_fmac_f32 v67, v69, v57
s_waitcnt vmcnt(1)
s_waitcnt lgkmcnt(1)
v_mfma_f32_16x16x32_bf16 v[24:27], v[132:135], v[84:87], v[24:27]
v_mfma_f32_16x16x32_bf16 v[28:31], v[136:139], v[84:87], v[28:31]
s_waitcnt lgkmcnt(0)
v_mfma_f32_16x16x32_bf16 v[40:43], v[132:135], v[88:91], v[40:43]
v_mfma_f32_16x16x32_bf16 v[44:47], v[136:139], v[88:91], v[44:47]
s_nop 3
v_cvt_pk_bf16_f32 v24, v24, v25
v_cvt_pk_bf16_f32 v25, v26, v27
v_cvt_pk_bf16_f32 v26, v28, v29
v_cvt_pk_bf16_f32 v27, v30, v31
ds_write_b128 v14, v[24:27] offset:0
ds_read_b128 v[28:31], v15 offset:0
s_waitcnt vmcnt(0)
s_waitcnt lgkmcnt(0)
buffer_store_dwordx4 v[28:31], v8, s[24:27], s46 offen
v_cvt_pk_bf16_f32 v40, v40, v41
v_cvt_pk_bf16_f32 v41, v42, v43
v_cvt_pk_bf16_f32 v42, v44, v45
v_cvt_pk_bf16_f32 v43, v46, v47
ds_write_b128 v14, v[40:43] offset:2048
ds_read_b128 v[44:47], v15 offset:2048
v_lshlrev_b32 v70, 16, v144
v_and_b32 v71, s80, v144
v_fmac_f32 v60, v70, v58
v_fmac_f32 v61, v71, v58
v_lshlrev_b32 v72, 16, v145
v_and_b32 v73, s80, v145
v_fmac_f32 v62, v72, v58
v_fmac_f32 v63, v73, v58
v_lshlrev_b32 v74, 16, v146
v_and_b32 v75, s80, v146
v_fmac_f32 v64, v74, v58
v_fmac_f32 v65, v75, v58
v_lshlrev_b32 v68, 16, v147
v_and_b32 v69, s80, v147
v_fmac_f32 v66, v68, v58
v_fmac_f32 v67, v69, v58
v_cvt_pk_bf16_f32 v68, v60, v61
v_cvt_pk_bf16_f32 v69, v62, v63
v_cvt_pk_bf16_f32 v70, v64, v65
v_cvt_pk_bf16_f32 v71, v66, v67
ds_write_b128 v16, v[68:71] offset:8192
s_waitcnt lgkmcnt(0)
s_barrier
ds_read_b128 v[92:95], v4 offset:32768
ds_read_b128 v[96:99], v4 offset:33792
ds_read_b128 v[76:79], v4 offset:34816
ds_read_b128 v[80:83], v4 offset:35840
ds_read_b128 v[84:87], v4 offset:36864
s_waitcnt lgkmcnt(4)
v_mfma_f32_16x16x32_bf16 v[32:35], v[208:211], v[92:95], v[32:35]
ds_read_b128 v[88:91], v4 offset:37888
v_mfma_f32_16x16x32_bf16 v[36:39], v[212:215], v[92:95], v[36:39]
s_waitcnt lgkmcnt(4)
v_mfma_f32_16x16x32_bf16 v[32:35], v[216:219], v[96:99], v[32:35]
ds_read_b128 v[92:95], v4 offset:38912
v_mfma_f32_16x16x32_bf16 v[36:39], v[224:227], v[96:99], v[36:39]
s_waitcnt lgkmcnt(4)
v_mfma_f32_16x16x32_bf16 v[32:35], v[228:231], v[76:79], v[32:35]
ds_read_b128 v[96:99], v4 offset:39936
v_mfma_f32_16x16x32_bf16 v[36:39], v[232:235], v[76:79], v[36:39]
s_waitcnt lgkmcnt(4)
v_mfma_f32_16x16x32_bf16 v[32:35], v[240:243], v[80:83], v[32:35]
v_mfma_f32_16x16x32_bf16 v[36:39], v[244:247], v[80:83], v[36:39]
s_waitcnt lgkmcnt(3)
v_mfma_f32_16x16x32_bf16 v[32:35], v[248:251], v[84:87], v[32:35]
v_mfma_f32_16x16x32_bf16 v[36:39], v[100:103], v[84:87], v[36:39]
s_waitcnt lgkmcnt(2)
v_mfma_f32_16x16x32_bf16 v[32:35], v[104:107], v[88:91], v[32:35]
v_mfma_f32_16x16x32_bf16 v[36:39], v[112:115], v[88:91], v[36:39]
s_waitcnt lgkmcnt(1)
v_mfma_f32_16x16x32_bf16 v[32:35], v[116:119], v[92:95], v[32:35]
v_mfma_f32_16x16x32_bf16 v[36:39], v[124:127], v[92:95], v[36:39]
s_waitcnt lgkmcnt(0)
v_mfma_f32_16x16x32_bf16 v[32:35], v[132:135], v[96:99], v[32:35]
v_mfma_f32_16x16x32_bf16 v[36:39], v[136:139], v[96:99], v[36:39]
s_nop 6
v_cvt_pk_bf16_f32 v32, v32, v33
v_cvt_pk_bf16_f32 v33, v34, v35
v_cvt_pk_bf16_f32 v34, v36, v37
v_cvt_pk_bf16_f32 v35, v38, v39
ds_write_b128 v14, v[32:35] offset:1024
ds_read_b128 v[36:39], v15 offset:1024
s_mov_b32 exec_hi, 0
buffer_store_dwordx4 v[44:47], v8, s[24:27], s48 offen
s_mov_b32 exec_hi, -1
s_waitcnt lgkmcnt(0)
buffer_store_dwordx4 v[36:39], v8, s[24:27], s47 offen
L3_end:
s_endpgm
.section .rodata,"a"
.p2align 6
.amdhsa_kernel k1_kernel
  .amdhsa_next_free_vgpr 256
  .amdhsa_next_free_sgpr 102
  .amdhsa_accum_offset 256
  .amdhsa_group_segment_fixed_size 0
  .amdhsa_kernarg_size 96
  .amdhsa_user_sgpr_count 2
  .amdhsa_user_sgpr_kernarg_segment_ptr 1
  .amdhsa_system_sgpr_workgroup_id_x 1
.end_amdhsa_kernel
.p2align 6
.amdhsa_kernel k2_kernel
  .amdhsa_next_free_vgpr 512
  .amdhsa_next_free_sgpr 102
  .amdhsa_accum_offset 256
  .amdhsa_group_segment_fixed_size 0
  .amdhsa_kernarg_size 96
  .amdhsa_user_sgpr_count 2
  .amdhsa_user_sgpr_kernarg_segment_ptr 1
  .amdhsa_system_sgpr_workgroup_id_x 1
.end_amdhsa_kernel
.p2align 6
.amdhsa_kernel k3_kernel
  .amdhsa_next_free_vgpr 256
  .amdhsa_next_free_sgpr 102
  .amdhsa_accum_offset 256
  .amdhsa_group_segment_fixed_size 0
  .amdhsa_kernarg_size 96
  .amdhsa_user_sgpr_count 2
  .amdhsa_user_sgpr_kernarg_segment_ptr 1
  .amdhsa_system_sgpr_workgroup_id_x 1
.end_amdhsa_kernel
```

```asm
; @launch kernel=k1_kernel grid=(249,1,1) block=(512,1,1) lds=163840
; @launch kernel=k2_kernel grid=(256,1,1) block=(256,1,1) lds=163840
.amdgcn_target "amdgcn-amd-amdhsa--gfx950"
.text
.globl k1_kernel
.p2align 8
.type k1_kernel,@function
k1_kernel:
s_getpc_b64 s[56:57]
s_load_dwordx16 s[16:31], s[0:1], 0
s_load_dwordx8 s[32:39], s[0:1], 64
s_cmp_ge_u32 s2, 249
s_cbranch_scc1 L1_end
v_lshrrev_b32 v1, 6, v0
v_and_b32 v2, 63, v0
s_lshr_b32 s3, s2, 3
v_readfirstlane_b32 s60, v1
s_mul_i32 s5, s3, 8
s_add_u32 s5, s5, s60
s_and_b32 s56, s56, 0xffffff00
s_mov_b32 s58, L2_end-k1_kernel
s_mov_b32 s59, 0x00020000
s_and_b32 s6, s5, 15
s_lshl_b32 s6, s6, 13
v_lshlrev_b32 v10, 7, v2
buffer_load_dword v255, v10, s[56:59], s6 offen
v_and_b32 v3, 15, v2
v_lshrrev_b32 v4, 4, v2
s_and_b32 s62, s3, 7
s_sub_u32 s4, s2, 40
s_cmp_lt_u32 s2, 40
s_cbranch_scc1 L1_notq
s_mov_b32 s61, 0
v_lshlrev_b32 v16, 4, v2
s_mul_i32 s63, s60, 6144
s_mul_i32 s6, s4, 24576
s_mul_i32 s7, s60, 3072
s_add_u32 s64, s6, s7
s_add_u32 s65, s64, 4096
s_lshl_b32 s7, s60, 6
v_lshrrev_b32 v5, 2, v2
v_and_b32 v6, 3, v2
v_lshrrev_b32 v7, 5, v2
v_lshlrev_b32 v7, 1, v7
v_xor_b32 v6, v6, v7
v_lshl_add_u32 v5, v5, 9, s7
v_lshl_add_u32 v17, v6, 4, v5
v_add_u32 v18, 0x1c00, v17
s_xor_b32 s6, s62, 0
s_lshl_b32 s66, s6, 14
s_xor_b32 s6, s62, 1
s_lshl_b32 s67, s6, 14
s_xor_b32 s6, s62, 2
s_lshl_b32 s68, s6, 14
s_xor_b32 s6, s62, 3
s_lshl_b32 s69, s6, 14
s_xor_b32 s6, s62, 4
s_lshl_b32 s70, s6, 14
s_xor_b32 s6, s62, 5
s_lshl_b32 s71, s6, 14
s_xor_b32 s6, s62, 6
s_lshl_b32 s72, s6, 14
s_xor_b32 s6, s62, 7
s_lshl_b32 s73, s6, 14
s_waitcnt lgkmcnt(0)
s_add_u32 s40, s16, 0x0
s_addc_u32 s41, s17, 0
s_mov_b32 s42, 0x4e2000
s_mov_b32 s43, 0x00020000
s_add_u32 s44, s26, 0x0
s_addc_u32 s45, s27, 0
s_mov_b32 s46, 0x20000
s_mov_b32 s47, 0x00020000
buffer_load_dwordx4 v[40:43], v16, s[40:43], s64 offen offset:0
buffer_load_dwordx4 v[44:47], v16, s[40:43], s64 offen offset:1024
buffer_load_dwordx4 v[48:51], v16, s[40:43], s64 offen offset:2048
s_add_u32 m0, s63, 0x0
s_nop 0
buffer_load_dwordx4 v17, s[44:47], s66 offen offset:0 lds
buffer_load_dwordx4 v18, s[44:47], s66 offen offset:1024 lds
s_add_u32 m0, s63, 0x800
s_nop 0
buffer_load_dwordx4 v17, s[44:47], s67 offen offset:0 lds
buffer_load_dwordx4 v18, s[44:47], s67 offen offset:1024 lds
v_bfe_u32 v5, v2, 2, 3
v_xor_b32 v5, s62, v5
v_and_b32 v6, 3, v2
v_lshlrev_b32 v7, 10, v5
v_lshl_add_u32 v7, v6, 8, v7
v_add_u32 v7, 0xc000, v7
v_and_b32 v5, 1, v5
v_lshl_or_b32 v6, v5, 2, v6
v_lshrrev_b32 v5, 5, v2
s_mul_i32 s6, s60, 6
v_add3_u32 v8, v5, s6, 0
v_lshrrev_b32 v9, 4, v8
v_lshl_add_u32 v9, v9, 13, v7
v_and_b32 v8, 15, v8
v_xor_b32 v8, v8, v6
v_lshl_add_u32 v36, v8, 4, v9
v_add3_u32 v8, v5, s6, 2
v_lshrrev_b32 v9, 4, v8
v_lshl_add_u32 v9, v9, 13, v7
v_and_b32 v8, 15, v8
v_xor_b32 v8, v8, v6
v_lshl_add_u32 v37, v8, 4, v9
v_add3_u32 v8, v5, s6, 4
v_lshrrev_b32 v9, 4, v8
v_lshl_add_u32 v9, v9, 13, v7
v_and_b32 v8, 15, v8
v_xor_b32 v8, v8, v6
v_lshl_add_u32 v38, v8, 4, v9
v_xor_b32 v5, v3, v4
v_lshlrev_b32 v5, 4, v5
v_lshl_add_u32 v5, v4, 8, v5
v_add_u32 v31, 0xc000, v5
v_xor_b32 v32, 64, v31
v_lshrrev_b32 v5, 2, v3
v_and_b32 v6, 3, v3
v_and_b32 v7, 1, v4
v_lshlrev_b32 v7, 1, v7
v_lshl_add_u32 v8, v4, 3, v5
v_lshlrev_b32 v8, 6, v8
v_add_u32 v8, s63, v8
v_and_b32 v9, 1, v6
v_lshl_add_u32 v8, v9, 3, v8
v_lshrrev_b32 v6, 1, v6
v_xor_b32 v6, v6, v7
v_xor_b32 v9, 0, v6
v_lshl_add_u32 v25, v9, 4, v8
v_xor_b32 v9, 2, v6
v_lshl_add_u32 v26, v9, 4, v8
v_lshrrev_b32 v5, 3, v2
v_and_b32 v6, 7, v2
v_lshrrev_b32 v7, 1, v5
v_xor_b32 v6, v6, v7
v_and_b32 v7, 4, v5
v_add_u32 v5, v5, v7
s_mul_i32 s6, s60, 16384
v_lshl_add_u32 v5, v5, 9, s6
v_lshl_add_u32 v21, v6, 4, v5
v_xor_b32 v6, 4, v6
v_lshl_add_u32 v22, v6, 4, v5
v_add_u32 v22, 0x1c00, v22
s_lshr_b32 s7, s62, 1
s_xor_b32 s6, s7, 0
s_lshl_b32 s74, s6, 7
s_add_u32 s75, s74, 2048
s_xor_b32 s6, s7, 1
s_lshl_b32 s76, s6, 7
s_add_u32 s77, s76, 2048
s_xor_b32 s6, s7, 2
s_lshl_b32 s78, s6, 7
s_add_u32 s79, s78, 2048
s_xor_b32 s6, s7, 3
s_lshl_b32 s80, s6, 7
s_add_u32 s81, s80, 2048
s_and_b32 s6, s62, 1
s_lshl_b32 s6, s6, 2
v_lshrrev_b32 v5, 1, v3
v_xor_b32 v5, v5, v4
v_xor_b32 v5, s6, v5
v_lshl_add_u32 v6, v3, 7, s63
v_lshl_add_u32 v29, v5, 4, v6
v_xor_b32 v30, 64, v29
s_mul_i32 s6, s60, 1
s_xor_b32 s6, s6, s62
s_lshl_b32 s6, s6, 10
s_add_u32 s6, s6, 0x12000
v_lshrrev_b32 v5, 1, v4
v_and_b32 v6, 1, v4
v_lshl_add_u32 v5, v5, 8, s6
v_lshl_add_u32 v5, v6, 3, v5
v_lshl_add_u32 v33, v3, 4, v5
v_xor_b32 v34, 0x400, v33
v_add_u32 v35, 0x12000, v16
s_mul_i32 s6, s4, 24576
s_mul_i32 s7, s60, 1024
s_add_u32 s82, s6, s7
s_add_u32 s83, s82, 8192
s_add_u32 s84, s82, 16384
s_mov_b32 s86, 0x3db8aa3b
s_mov_b32 s87, 0x3db8aa3b
s_mov_b32 s88, 0x3727c5ac
s_mov_b32 s89, 0x3b800000
s_mov_b32 s90, 0xffff0000
s_add_u32 s48, s28, 0x0
s_addc_u32 s49, s29, 0
s_mov_b32 s50, 0x20000
s_mov_b32 s51, 0x00020000
s_add_u32 s52, s38, 0x0
s_addc_u32 s53, s39, 0
s_mov_b32 s54, 0x4e4000
s_mov_b32 s55, 0x00020000
s_add_u32 s56, s38, 0x6800000
s_addc_u32 s57, s39, 0
s_mov_b32 s58, 0x4e4000
s_mov_b32 s59, 0x00020000
v_lshlrev_b32 v5, 4, v4
s_lshr_b32 s6, s66, 8
buffer_load_dwordx4 v[172:175], v5, s[48:51], s6 offen
s_lshr_b32 s6, s67, 8
buffer_load_dwordx4 v[176:179], v5, s[48:51], s6 offen
s_lshr_b32 s6, s68, 8
buffer_load_dwordx4 v[180:183], v5, s[48:51], s6 offen
s_lshr_b32 s6, s69, 8
buffer_load_dwordx4 v[184:187], v5, s[48:51], s6 offen
s_lshr_b32 s6, s70, 8
buffer_load_dwordx4 v[188:191], v5, s[48:51], s6 offen
s_lshr_b32 s6, s71, 8
buffer_load_dwordx4 v[192:195], v5, s[48:51], s6 offen
s_lshr_b32 s6, s72, 8
buffer_load_dwordx4 v[196:199], v5, s[48:51], s6 offen
s_lshr_b32 s6, s73, 8
buffer_load_dwordx4 v[200:203], v5, s[48:51], s6 offen
s_waitcnt vmcnt(14)
v_lshlrev_b32 v76, 16, v40
v_and_b32 v77, s90, v40
v_lshlrev_b32 v78, 16, v41
v_and_b32 v79, s90, v41
v_lshlrev_b32 v80, 16, v42
v_and_b32 v81, s90, v42
v_lshlrev_b32 v82, 16, v43
v_and_b32 v83, s90, v43
v_pk_add_f32 v[100:101], v[76:77], v[78:79]
v_pk_mul_f32 v[102:103], v[76:77], v[76:77]
v_pk_add_f32 v[40:41], v[80:81], v[82:83]
v_pk_fma_f32 v[102:103], v[78:79], v[78:79], v[102:103]
v_pk_add_f32 v[100:101], v[100:101], v[40:41]
v_pk_fma_f32 v[102:103], v[80:81], v[80:81], v[102:103]
v_add_f32 v100, v100, v101
v_pk_fma_f32 v[102:103], v[82:83], v[82:83], v[102:103]
v_add_f32 v102, v102, v103
s_waitcnt vmcnt(13)
v_lshlrev_b32 v84, 16, v44
v_and_b32 v85, s90, v44
v_lshlrev_b32 v86, 16, v45
v_and_b32 v87, s90, v45
v_lshlrev_b32 v88, 16, v46
v_and_b32 v89, s90, v46
v_lshlrev_b32 v90, 16, v47
v_and_b32 v91, s90, v47
v_pk_add_f32 v[104:105], v[84:85], v[86:87]
v_pk_mul_f32 v[106:107], v[84:85], v[84:85]
v_pk_add_f32 v[44:45], v[88:89], v[90:91]
v_pk_fma_f32 v[106:107], v[86:87], v[86:87], v[106:107]
v_pk_add_f32 v[104:105], v[104:105], v[44:45]
v_pk_fma_f32 v[106:107], v[88:89], v[88:89], v[106:107]
v_add_f32 v104, v104, v105
v_pk_fma_f32 v[106:107], v[90:91], v[90:91], v[106:107]
v_add_f32 v106, v106, v107
s_waitcnt vmcnt(12)
v_lshlrev_b32 v92, 16, v48
v_and_b32 v93, s90, v48
v_lshlrev_b32 v94, 16, v49
v_and_b32 v95, s90, v49
v_lshlrev_b32 v96, 16, v50
v_and_b32 v97, s90, v50
v_lshlrev_b32 v98, 16, v51
v_and_b32 v99, s90, v51
v_pk_add_f32 v[108:109], v[92:93], v[94:95]
v_pk_mul_f32 v[110:111], v[92:93], v[92:93]
v_pk_add_f32 v[48:49], v[96:97], v[98:99]
v_pk_fma_f32 v[110:111], v[94:95], v[94:95], v[110:111]
v_pk_add_f32 v[108:109], v[108:109], v[48:49]
v_pk_fma_f32 v[110:111], v[96:97], v[96:97], v[110:111]
v_add_f32 v108, v108, v109
v_pk_fma_f32 v[110:111], v[98:99], v[98:99], v[110:111]
v_add_f32 v110, v110, v111
v_permlane16_swap_b32 v100, v102
v_permlane16_swap_b32 v104, v106
v_permlane16_swap_b32 v108, v110
v_add_f32 v100, v100, v102
v_add_f32 v104, v104, v106
v_add_f32 v108, v108, v110
v_add_f32_dpp v101, v100, v100 row_ror:8 row_mask:0xf bank_mask:0x3
v_add_f32_dpp v101, v104, v104 row_ror:8 row_mask:0xf bank_mask:0xc
v_add_f32_dpp v109, v108, v108 row_ror:8 row_mask:0xf bank_mask:0xf
s_nop 0
v_add_f32_dpp v102, v101, v101 row_half_mirror row_mask:0xf bank_mask:0x5
v_add_f32_dpp v102, v109, v109 row_half_mirror row_mask:0xf bank_mask:0xa
s_nop 1
v_add_f32_dpp v102, v102, v102 quad_perm:[1,0,3,2] row_mask:0xf bank_mask:0xf
s_nop 1
v_add_f32_dpp v102, v102, v102 quad_perm:[2,3,0,1] row_mask:0xf bank_mask:0xf
v_mov_b32 v103, v102
s_nop 1
v_permlane16_swap_b32 v103, v102
v_mul_f32 v103, s89, v103
v_mul_f32 v102, s89, v102
v_fma_f32 v102, -v103, v103, v102
v_max_f32 v102, 0, v102
v_cvt_pk_bf16_f32 v102, v102, v102
v_and_b32 v102, s90, v102
v_add_f32 v102, s88, v102
v_cvt_pk_bf16_f32 v102, v102, v102
v_and_b32 v102, s90, v102
v_sqrt_f32 v102, v102
s_nop 0
v_cvt_pk_bf16_f32 v102, v102, v102
v_and_b32 v102, s90, v102
v_rcp_f32 v102, v102
s_nop 0
v_mul_f32 v103, -v103, v102
s_nop 1
v_mov_b64_dpp v[100:101], v[102:103] row_newbcast:0 row_mask:0xf bank_mask:0xf
v_mov_b64_dpp v[104:105], v[102:103] row_newbcast:8 row_mask:0xf bank_mask:0xf
v_mov_b64_dpp v[108:109], v[102:103] row_newbcast:4 row_mask:0xf bank_mask:0xf
v_fma_f32 v76, v76, v100, v101
v_fma_f32 v77, v77, v100, v101
v_fma_f32 v78, v78, v100, v101
v_fma_f32 v79, v79, v100, v101
v_fma_f32 v80, v80, v100, v101
v_fma_f32 v81, v81, v100, v101
v_fma_f32 v82, v82, v100, v101
v_fma_f32 v83, v83, v100, v101
v_cvt_pk_bf16_f32 v40, v76, v77
v_cvt_pk_bf16_f32 v41, v78, v79
v_cvt_pk_bf16_f32 v42, v80, v81
v_cvt_pk_bf16_f32 v43, v82, v83
ds_write_b128 v36, v[40:43]
v_fma_f32 v84, v84, v104, v105
v_fma_f32 v85, v85, v104, v105
v_fma_f32 v86, v86, v104, v105
v_fma_f32 v87, v87, v104, v105
v_fma_f32 v88, v88, v104, v105
v_fma_f32 v89, v89, v104, v105
v_fma_f32 v90, v90, v104, v105
v_fma_f32 v91, v91, v104, v105
v_cvt_pk_bf16_f32 v44, v84, v85
v_cvt_pk_bf16_f32 v45, v86, v87
v_cvt_pk_bf16_f32 v46, v88, v89
v_cvt_pk_bf16_f32 v47, v90, v91
ds_write_b128 v37, v[44:47]
v_fma_f32 v92, v92, v108, v109
v_fma_f32 v93, v93, v108, v109
v_fma_f32 v94, v94, v108, v109
v_fma_f32 v95, v95, v108, v109
v_fma_f32 v96, v96, v108, v109
v_fma_f32 v97, v97, v108, v109
v_fma_f32 v98, v98, v108, v109
v_fma_f32 v99, v99, v108, v109
v_cvt_pk_bf16_f32 v48, v92, v93
v_cvt_pk_bf16_f32 v49, v94, v95
v_cvt_pk_bf16_f32 v50, v96, v97
v_cvt_pk_bf16_f32 v51, v98, v99
ds_write_b128 v38, v[48:51]
s_add_u32 m0, s63, 0x1000
s_nop 0
buffer_load_dwordx4 v17, s[44:47], s68 offen offset:0 lds
buffer_load_dwordx4 v18, s[44:47], s68 offen offset:1024 lds
s_waitcnt vmcnt(12)
ds_read_b64_tr_b16 v[100:101], v25 offset:0
ds_read_b64_tr_b16 v[102:103], v25 offset:256
ds_read_b64_tr_b16 v[104:105], v26 offset:0
ds_read_b64_tr_b16 v[106:107], v26 offset:256
s_waitcnt lgkmcnt(4)
s_barrier
ds_read_b128 v[124:127], v31 offset:0
ds_read_b128 v[128:131], v31 offset:8192
ds_read_b128 v[132:135], v31 offset:16384
ds_read_b128 v[136:139], v32 offset:1024
s_waitcnt vmcnt(10)
ds_read_b64_tr_b16 v[108:109], v25 offset:2048
ds_read_b64_tr_b16 v[110:111], v25 offset:2304
s_waitcnt lgkmcnt(5)
v_mfma_f32_16x16x32_bf16 v[52:55], v[100:103], v[124:127], 0
ds_read_b128 v[140:143], v32 offset:9216
s_waitcnt lgkmcnt(5)
v_mfma_f32_16x16x32_bf16 v[56:59], v[100:103], v[128:131], 0
ds_read_b128 v[144:147], v32 offset:17408
s_waitcnt lgkmcnt(5)
v_mfma_f32_16x16x32_bf16 v[60:63], v[100:103], v[132:135], 0
ds_read_b64_tr_b16 v[112:113], v26 offset:2048
ds_read_b64_tr_b16 v[114:115], v26 offset:2304
v_mfma_f32_16x16x32_bf16 v[64:67], v[104:107], v[124:127], 0
s_add_u32 m0, s63, 0x0
s_nop 0
buffer_load_dwordx4 v17, s[44:47], s69 offen offset:0 lds
buffer_load_dwordx4 v18, s[44:47], s69 offen offset:1024 lds
v_mfma_f32_16x16x32_bf16 v[68:71], v[104:107], v[128:131], 0
v_and_b32 v5, 31, v2
v_lshrrev_b32 v6, 5, v2
v_mfma_f32_16x16x32_bf16 v[72:75], v[104:107], v[132:135], 0
ds_read_b128 v[148:151], v31 offset:2048
s_waitcnt vmcnt(2)
ds_read_b64_tr_b16 v[116:117], v25 offset:4096
ds_read_b64_tr_b16 v[118:119], v25 offset:4352
s_waitcnt lgkmcnt(7)
v_mfma_f32_16x16x32_bf16 v[52:55], v[108:111], v[136:139], v[52:55]
ds_read_b128 v[152:155], v31 offset:10240
s_lshr_b32 s6, s64, 9
s_waitcnt lgkmcnt(7)
v_mfma_f32_16x16x32_bf16 v[56:59], v[108:111], v[140:143], v[56:59]
ds_read_b128 v[156:159], v31 offset:18432
v_cmp_eq_u32 vcc, 0, v5
s_waitcnt lgkmcnt(7)
v_mfma_f32_16x16x32_bf16 v[60:63], v[108:111], v[144:147], v[60:63]
ds_read_b64_tr_b16 v[120:121], v26 offset:4096
ds_read_b64_tr_b16 v[122:123], v26 offset:4352
s_waitcnt lgkmcnt(7)
v_mfma_f32_16x16x32_bf16 v[64:67], v[112:115], v[136:139], v[64:67]
s_add_u32 m0, s63, 0x800
s_nop 0
buffer_load_dwordx4 v17, s[44:47], s70 offen offset:0 lds
buffer_load_dwordx4 v18, s[44:47], s70 offen offset:1024 lds
v_mfma_f32_16x16x32_bf16 v[68:71], v[112:115], v[140:143], v[68:71]
s_sub_u32 s6, 10000, s6
v_mov_b32 v7, 0x7fffffff
v_mfma_f32_16x16x32_bf16 v[72:75], v[112:115], v[144:147], v[72:75]
ds_read_b128 v[160:163], v32 offset:3072
s_waitcnt vmcnt(2)
ds_read_b64_tr_b16 v[100:101], v25 offset:0
ds_read_b64_tr_b16 v[102:103], v25 offset:256
s_waitcnt lgkmcnt(7)
v_mfma_f32_16x16x32_bf16 v[52:55], v[116:119], v[148:151], v[52:55]
ds_read_b128 v[164:167], v32 offset:11264
v_cndmask_b32 v6, v7, v6, vcc
s_waitcnt lgkmcnt(7)
v_mfma_f32_16x16x32_bf16 v[56:59], v[116:119], v[152:155], v[56:59]
ds_read_b128 v[168:171], v32 offset:19456
v_cmp_gt_i32 vcc, s6, v6
s_waitcnt lgkmcnt(7)
v_mfma_f32_16x16x32_bf16 v[60:63], v[116:119], v[156:159], v[60:63]
ds_read_b64_tr_b16 v[104:105], v26 offset:0
ds_read_b64_tr_b16 v[106:107], v26 offset:256
s_waitcnt lgkmcnt(7)
v_mfma_f32_16x16x32_bf16 v[64:67], v[120:123], v[148:151], v[64:67]
s_add_u32 m0, s63, 0x1000
s_nop 0
buffer_load_dwordx4 v17, s[44:47], s71 offen offset:0 lds
buffer_load_dwordx4 v18, s[44:47], s71 offen offset:1024 lds
v_mfma_f32_16x16x32_bf16 v[68:71], v[120:123], v[152:155], v[68:71]
v_and_b32 v5, s90, v40
v_or_b32 v5, 0x3f80, v5
v_mfma_f32_16x16x32_bf16 v[72:75], v[120:123], v[156:159], v[72:75]
ds_read_b128 v[124:127], v31 offset:4096
s_waitcnt vmcnt(2)
ds_read_b64_tr_b16 v[108:109], v25 offset:2048
ds_read_b64_tr_b16 v[110:111], v25 offset:2304
s_waitcnt lgkmcnt(7)
v_mfma_f32_16x16x32_bf16 v[52:55], v[100:103], v[160:163], v[52:55]
ds_read_b128 v[128:131], v31 offset:12288
s_sub_u32 s6, s6, 2
s_waitcnt lgkmcnt(7)
v_mfma_f32_16x16x32_bf16 v[56:59], v[100:103], v[164:167], v[56:59]
ds_read_b128 v[132:135], v31 offset:20480
v_cndmask_b32 v40, v40, v5, vcc
s_waitcnt lgkmcnt(7)
v_mfma_f32_16x16x32_bf16 v[60:63], v[100:103], v[168:171], v[60:63]
ds_read_b64_tr_b16 v[112:113], v26 offset:2048
ds_read_b64_tr_b16 v[114:115], v26 offset:2304
s_waitcnt lgkmcnt(7)
v_mfma_f32_16x16x32_bf16 v[64:67], v[104:107], v[160:163], v[64:67]
s_add_u32 m0, s63, 0x0
s_nop 0
buffer_load_dwordx4 v17, s[44:47], s72 offen offset:0 lds
buffer_load_dwordx4 v18, s[44:47], s72 offen offset:1024 lds
v_mfma_f32_16x16x32_bf16 v[68:71], v[104:107], v[164:167], v[68:71]
v_cmp_gt_i32 vcc, s6, v6
v_and_b32 v5, s90, v44
v_mfma_f32_16x16x32_bf16 v[72:75], v[104:107], v[168:171], v[72:75]
ds_read_b128 v[136:139], v32 offset:5120
s_waitcnt vmcnt(2)
ds_read_b64_tr_b16 v[116:117], v25 offset:4096
ds_read_b64_tr_b16 v[118:119], v25 offset:4352
s_waitcnt lgkmcnt(7)
v_mfma_f32_16x16x32_bf16 v[52:55], v[108:111], v[124:127], v[52:55]
ds_read_b128 v[140:143], v32 offset:13312
v_or_b32 v5, 0x3f80, v5
s_waitcnt lgkmcnt(7)
v_mfma_f32_16x16x32_bf16 v[56:59], v[108:111], v[128:131], v[56:59]
ds_read_b128 v[144:147], v32 offset:21504
s_sub_u32 s6, s6, 2
s_waitcnt lgkmcnt(7)
v_mfma_f32_16x16x32_bf16 v[60:63], v[108:111], v[132:135], v[60:63]
ds_read_b64_tr_b16 v[120:121], v26 offset:4096
ds_read_b64_tr_b16 v[122:123], v26 offset:4352
s_waitcnt lgkmcnt(7)
v_mfma_f32_16x16x32_bf16 v[64:67], v[112:115], v[124:127], v[64:67]
s_add_u32 m0, s63, 0x800
s_nop 0
buffer_load_dwordx4 v17, s[44:47], s73 offen offset:0 lds
buffer_load_dwordx4 v18, s[44:47], s73 offen offset:1024 lds
v_mfma_f32_16x16x32_bf16 v[68:71], v[112:115], v[128:131], v[68:71]
v_cndmask_b32 v44, v44, v5, vcc
v_cmp_gt_i32 vcc, s6, v6
v_mfma_f32_16x16x32_bf16 v[72:75], v[112:115], v[132:135], v[72:75]
ds_read_b128 v[148:151], v31 offset:6144
s_waitcnt vmcnt(2)
ds_read_b64_tr_b16 v[100:101], v25 offset:0
ds_read_b64_tr_b16 v[102:103], v25 offset:256
s_waitcnt lgkmcnt(7)
v_mfma_f32_16x16x32_bf16 v[52:55], v[116:119], v[136:139], v[52:55]
ds_read_b128 v[152:155], v31 offset:14336
v_and_b32 v5, s90, v48
s_waitcnt lgkmcnt(7)
v_mfma_f32_16x16x32_bf16 v[56:59], v[116:119], v[140:143], v[56:59]
ds_read_b128 v[156:159], v31 offset:22528
v_or_b32 v5, 0x3f80, v5
s_waitcnt lgkmcnt(7)
v_mfma_f32_16x16x32_bf16 v[60:63], v[116:119], v[144:147], v[60:63]
ds_read_b64_tr_b16 v[104:105], v26 offset:0
ds_read_b64_tr_b16 v[106:107], v26 offset:256
s_waitcnt lgkmcnt(7)
v_mfma_f32_16x16x32_bf16 v[64:67], v[120:123], v[136:139], v[64:67]
s_add_u32 m0, s63, 0x1000
s_nop 0
buffer_load_dwordx4 v21, s[48:51], s74 offen offset:0 lds
buffer_load_dwordx4 v22, s[48:51], s74 offen offset:1024 lds
v_mfma_f32_16x16x32_bf16 v[68:71], v[120:123], v[140:143], v[68:71]
s_sub_u32 s6, s6, 2
v_cndmask_b32 v48, v48, v5, vcc
v_mfma_f32_16x16x32_bf16 v[72:75], v[120:123], v[144:147], v[72:75]
ds_read_b128 v[160:163], v32 offset:7168
s_waitcnt vmcnt(2)
ds_read_b64_tr_b16 v[108:109], v25 offset:2048
ds_read_b64_tr_b16 v[110:111], v25 offset:2304
s_waitcnt lgkmcnt(7)
v_mfma_f32_16x16x32_bf16 v[52:55], v[100:103], v[148:151], v[52:55]
ds_read_b128 v[164:167], v32 offset:15360
s_waitcnt lgkmcnt(7)
v_mfma_f32_16x16x32_bf16 v[56:59], v[100:103], v[152:155], v[56:59]
ds_read_b128 v[168:171], v32 offset:23552
s_waitcnt lgkmcnt(7)
v_mfma_f32_16x16x32_bf16 v[60:63], v[100:103], v[156:159], v[60:63]
ds_read_b64_tr_b16 v[112:113], v26 offset:2048
ds_read_b64_tr_b16 v[114:115], v26 offset:2304
s_waitcnt lgkmcnt(7)
v_mfma_f32_16x16x32_bf16 v[64:67], v[104:107], v[148:151], v[64:67]
s_add_u32 m0, s63, 0x0
s_nop 0
buffer_load_dwordx4 v21, s[48:51], s75 offen offset:0 lds
buffer_load_dwordx4 v22, s[48:51], s75 offen offset:1024 lds
v_mfma_f32_16x16x32_bf16 v[68:71], v[104:107], v[152:155], v[68:71]
v_mfma_f32_16x16x32_bf16 v[72:75], v[104:107], v[156:159], v[72:75]
s_waitcnt lgkmcnt(4)
v_mfma_f32_16x16x32_bf16 v[52:55], v[108:111], v[160:163], v[52:55]
s_waitcnt lgkmcnt(3)
v_mfma_f32_16x16x32_bf16 v[56:59], v[108:111], v[164:167], v[56:59]
s_waitcnt lgkmcnt(2)
v_mfma_f32_16x16x32_bf16 v[60:63], v[108:111], v[168:171], v[60:63]
s_waitcnt lgkmcnt(0)
v_mfma_f32_16x16x32_bf16 v[64:67], v[112:115], v[160:163], v[64:67]
s_nop 1
v_cvt_pk_bf16_f32 v52, v52, v53
v_cvt_pk_bf16_f32 v53, v54, v55
ds_write_b64 v33, v[52:53] offset:0
s_add_u32 m0, s63, 0x800
s_nop 0
buffer_load_dwordx4 v21, s[48:51], s76 offen offset:0 lds
buffer_load_dwordx4 v22, s[48:51], s76 offen offset:1024 lds
v_mfma_f32_16x16x32_bf16 v[68:71], v[112:115], v[164:167], v[68:71]
v_cvt_pk_bf16_f32 v56, v56, v57
v_cvt_pk_bf16_f32 v57, v58, v59
ds_write_b64 v33, v[56:57] offset:8192
v_mfma_f32_16x16x32_bf16 v[72:75], v[112:115], v[168:171], v[72:75]
v_cvt_pk_bf16_f32 v60, v60, v61
v_cvt_pk_bf16_f32 v61, v62, v63
ds_write_b64 v33, v[60:61] offset:16384
v_cvt_pk_bf16_f32 v64, v64, v65
v_cvt_pk_bf16_f32 v65, v66, v67
ds_write_b64 v33, v[64:65] offset:512
v_cvt_pk_bf16_f32 v68, v68, v69
v_cvt_pk_bf16_f32 v69, v70, v71
ds_write_b64 v33, v[68:69] offset:8704
v_cvt_pk_bf16_f32 v72, v72, v73
v_cvt_pk_bf16_f32 v73, v74, v75
ds_write_b64 v33, v[72:73] offset:16896
s_waitcnt vmcnt(4)
ds_read_b128 v[116:119], v29 offset:4096
ds_read_b128 v[120:123], v30 offset:4096
s_waitcnt lgkmcnt(2)
s_barrier
ds_read_b128 v[124:127], v35 offset:0
ds_read_b128 v[128:131], v35 offset:8192
ds_read_b128 v[132:135], v35 offset:16384
ds_read_b128 v[136:139], v35 offset:1024
s_waitcnt lgkmcnt(3)
v_mfma_f32_16x16x32_bf16 v[76:79], v[116:119], v[124:127], 0
ds_read_b128 v[140:143], v35 offset:9216
s_waitcnt lgkmcnt(3)
v_mfma_f32_16x16x32_bf16 v[84:87], v[116:119], v[128:131], 0
ds_read_b128 v[144:147], v35 offset:17408
s_waitcnt lgkmcnt(3)
v_mfma_f32_16x16x32_bf16 v[92:95], v[116:119], v[132:135], 0
v_mfma_f32_16x16x32_bf16 v[204:207], v[172:175], v[124:127], 0
v_mfma_f32_16x16x32_bf16 v[208:211], v[172:175], v[128:131], 0
v_mfma_f32_16x16x32_bf16 v[212:215], v[172:175], v[132:135], 0
s_waitcnt vmcnt(2)
ds_read_b128 v[100:103], v29 offset:0
s_waitcnt lgkmcnt(3)
v_mfma_f32_16x16x32_bf16 v[76:79], v[120:123], v[136:139], v[76:79]
s_add_u32 m0, s63, 0x1000
s_nop 0
buffer_load_dwordx4 v21, s[48:51], s77 offen offset:0 lds
buffer_load_dwordx4 v22, s[48:51], s77 offen offset:1024 lds
s_waitcnt lgkmcnt(2)
v_mfma_f32_16x16x32_bf16 v[84:87], v[120:123], v[140:143], v[84:87]
s_waitcnt lgkmcnt(1)
v_mfma_f32_16x16x32_bf16 v[92:95], v[120:123], v[144:147], v[92:95]
ds_read_b128 v[104:107], v30 offset:0
v_mfma_f32_16x16x32_bf16 v[204:207], v[176:179], v[136:139], v[204:207]
v_mfma_f32_16x16x32_bf16 v[208:211], v[176:179], v[140:143], v[208:211]
v_mfma_f32_16x16x32_bf16 v[212:215], v[176:179], v[144:147], v[212:215]
ds_read_b128 v[148:151], v35 offset:2048
s_waitcnt vmcnt(2)
ds_read_b128 v[108:111], v29 offset:2048
s_waitcnt lgkmcnt(3)
v_mfma_f32_16x16x32_bf16 v[80:83], v[100:103], v[124:127], 0
ds_read_b128 v[152:155], v35 offset:10240
v_mfma_f32_16x16x32_bf16 v[88:91], v[100:103], v[128:131], 0
ds_read_b128 v[156:159], v35 offset:18432
v_mfma_f32_16x16x32_bf16 v[96:99], v[100:103], v[132:135], 0
s_waitcnt lgkmcnt(4)
v_mfma_f32_16x16x32_bf16 v[80:83], v[104:107], v[136:139], v[80:83]
s_add_u32 m0, s63, 0x0
s_nop 0
buffer_load_dwordx4 v21, s[48:51], s78 offen offset:0 lds
buffer_load_dwordx4 v22, s[48:51], s78 offen offset:1024 lds
v_mfma_f32_16x16x32_bf16 v[88:91], v[104:107], v[140:143], v[88:91]
v_mfma_f32_16x16x32_bf16 v[96:99], v[104:107], v[144:147], v[96:99]
ds_read_b128 v[160:163], v35 offset:3072
ds_read_b128 v[112:115], v30 offset:2048
s_waitcnt lgkmcnt(4)
v_mfma_f32_16x16x32_bf16 v[76:79], v[108:111], v[148:151], v[76:79]
ds_read_b128 v[164:167], v35 offset:11264
s_waitcnt lgkmcnt(4)
v_mfma_f32_16x16x32_bf16 v[84:87], v[108:111], v[152:155], v[84:87]
ds_read_b128 v[168:171], v35 offset:19456
s_waitcnt lgkmcnt(4)
v_mfma_f32_16x16x32_bf16 v[92:95], v[108:111], v[156:159], v[92:95]
v_mfma_f32_16x16x32_bf16 v[204:207], v[180:183], v[148:151], v[204:207]
v_mfma_f32_16x16x32_bf16 v[208:211], v[180:183], v[152:155], v[208:211]
v_mfma_f32_16x16x32_bf16 v[212:215], v[180:183], v[156:159], v[212:215]
s_waitcnt vmcnt(2)
ds_read_b128 v[116:119], v29 offset:4096
s_waitcnt lgkmcnt(3)
v_mfma_f32_16x16x32_bf16 v[76:79], v[112:115], v[160:163], v[76:79]
s_add_u32 m0, s63, 0x800
s_nop 0
buffer_load_dwordx4 v21, s[48:51], s79 offen offset:0 lds
buffer_load_dwordx4 v22, s[48:51], s79 offen offset:1024 lds
s_waitcnt lgkmcnt(2)
v_mfma_f32_16x16x32_bf16 v[84:87], v[112:115], v[164:167], v[84:87]
s_waitcnt lgkmcnt(1)
v_mfma_f32_16x16x32_bf16 v[92:95], v[112:115], v[168:171], v[92:95]
ds_read_b128 v[120:123], v30 offset:4096
v_mfma_f32_16x16x32_bf16 v[204:207], v[184:187], v[160:163], v[204:207]
v_mfma_f32_16x16x32_bf16 v[208:211], v[184:187], v[164:167], v[208:211]
v_mfma_f32_16x16x32_bf16 v[212:215], v[184:187], v[168:171], v[212:215]
ds_read_b128 v[124:127], v35 offset:4096
s_waitcnt vmcnt(2)
ds_read_b128 v[100:103], v29 offset:0
s_waitcnt lgkmcnt(3)
v_mfma_f32_16x16x32_bf16 v[80:83], v[116:119], v[148:151], v[80:83]
ds_read_b128 v[128:131], v35 offset:12288
v_mfma_f32_16x16x32_bf16 v[88:91], v[116:119], v[152:155], v[88:91]
ds_read_b128 v[132:135], v35 offset:20480
v_mfma_f32_16x16x32_bf16 v[96:99], v[116:119], v[156:159], v[96:99]
s_waitcnt lgkmcnt(4)
v_mfma_f32_16x16x32_bf16 v[80:83], v[120:123], v[160:163], v[80:83]
s_add_u32 m0, s63, 0x1000
s_nop 0
buffer_load_dwordx4 v21, s[48:51], s80 offen offset:0 lds
buffer_load_dwordx4 v22, s[48:51], s80 offen offset:1024 lds
v_mfma_f32_16x16x32_bf16 v[88:91], v[120:123], v[164:167], v[88:91]
v_mfma_f32_16x16x32_bf16 v[96:99], v[120:123], v[168:171], v[96:99]
ds_read_b128 v[136:139], v35 offset:5120
ds_read_b128 v[104:107], v30 offset:0
s_waitcnt lgkmcnt(4)
v_mfma_f32_16x16x32_bf16 v[76:79], v[100:103], v[124:127], v[76:79]
ds_read_b128 v[140:143], v35 offset:13312
s_waitcnt lgkmcnt(4)
v_mfma_f32_16x16x32_bf16 v[84:87], v[100:103], v[128:131], v[84:87]
ds_read_b128 v[144:147], v35 offset:21504
s_waitcnt lgkmcnt(4)
v_mfma_f32_16x16x32_bf16 v[92:95], v[100:103], v[132:135], v[92:95]
v_mfma_f32_16x16x32_bf16 v[204:207], v[188:191], v[124:127], v[204:207]
v_mfma_f32_16x16x32_bf16 v[208:211], v[188:191], v[128:131], v[208:211]
v_mfma_f32_16x16x32_bf16 v[212:215], v[188:191], v[132:135], v[212:215]
s_waitcnt vmcnt(2)
ds_read_b128 v[108:111], v29 offset:2048
s_waitcnt lgkmcnt(3)
v_mfma_f32_16x16x32_bf16 v[76:79], v[104:107], v[136:139], v[76:79]
s_add_u32 m0, s63, 0x0
s_nop 0
buffer_load_dwordx4 v21, s[48:51], s81 offen offset:0 lds
buffer_load_dwordx4 v22, s[48:51], s81 offen offset:1024 lds
s_waitcnt lgkmcnt(2)
v_mfma_f32_16x16x32_bf16 v[84:87], v[104:107], v[140:143], v[84:87]
buffer_store_dwordx4 v[40:43], v16, s[56:59], s64 offen offset:0 sc1
buffer_store_dwordx4 v[44:47], v16, s[56:59], s64 offen offset:1024 sc1
s_waitcnt lgkmcnt(1)
v_mfma_f32_16x16x32_bf16 v[92:95], v[104:107], v[144:147], v[92:95]
ds_read_b128 v[112:115], v30 offset:2048
buffer_store_dwordx4 v[48:51], v16, s[56:59], s64 offen offset:2048 sc1
v_mfma_f32_16x16x32_bf16 v[204:207], v[192:195], v[136:139], v[204:207]
v_mfma_f32_16x16x32_bf16 v[208:211], v[192:195], v[140:143], v[208:211]
v_mfma_f32_16x16x32_bf16 v[212:215], v[192:195], v[144:147], v[212:215]
ds_read_b128 v[148:151], v35 offset:6144
s_waitcnt vmcnt(5)
ds_read_b128 v[116:119], v29 offset:4096
s_waitcnt lgkmcnt(3)
v_mfma_f32_16x16x32_bf16 v[80:83], v[108:111], v[124:127], v[80:83]
ds_read_b128 v[152:155], v35 offset:14336
v_mfma_f32_16x16x32_bf16 v[88:91], v[108:111], v[128:131], v[88:91]
ds_read_b128 v[156:159], v35 offset:22528
v_mfma_f32_16x16x32_bf16 v[96:99], v[108:111], v[132:135], v[96:99]
s_waitcnt lgkmcnt(4)
v_mfma_f32_16x16x32_bf16 v[80:83], v[112:115], v[136:139], v[80:83]
v_mfma_f32_16x16x32_bf16 v[88:91], v[112:115], v[140:143], v[88:91]
v_mfma_f32_16x16x32_bf16 v[96:99], v[112:115], v[144:147], v[96:99]
ds_read_b128 v[160:163], v35 offset:7168
ds_read_b128 v[120:123], v30 offset:4096
s_waitcnt lgkmcnt(4)
v_mfma_f32_16x16x32_bf16 v[76:79], v[116:119], v[148:151], v[76:79]
ds_read_b128 v[164:167], v35 offset:15360
s_waitcnt lgkmcnt(4)
v_mfma_f32_16x16x32_bf16 v[84:87], v[116:119], v[152:155], v[84:87]
ds_read_b128 v[168:171], v35 offset:23552
s_waitcnt lgkmcnt(4)
v_mfma_f32_16x16x32_bf16 v[92:95], v[116:119], v[156:159], v[92:95]
v_mfma_f32_16x16x32_bf16 v[204:207], v[196:199], v[148:151], v[204:207]
v_mfma_f32_16x16x32_bf16 v[208:211], v[196:199], v[152:155], v[208:211]
v_mfma_f32_16x16x32_bf16 v[212:215], v[196:199], v[156:159], v[212:215]
s_waitcnt vmcnt(3)
ds_read_b128 v[100:103], v29 offset:0
s_waitcnt lgkmcnt(3)
v_mfma_f32_16x16x32_bf16 v[76:79], v[120:123], v[160:163], v[76:79]
s_waitcnt lgkmcnt(2)
v_mfma_f32_16x16x32_bf16 v[84:87], v[120:123], v[164:167], v[84:87]
s_waitcnt lgkmcnt(1)
v_mfma_f32_16x16x32_bf16 v[92:95], v[120:123], v[168:171], v[92:95]
ds_read_b128 v[104:107], v30 offset:0
v_mfma_f32_16x16x32_bf16 v[204:207], v[200:203], v[160:163], v[204:207]
v_mfma_f32_16x16x32_bf16 v[208:211], v[200:203], v[164:167], v[208:211]
v_mfma_f32_16x16x32_bf16 v[212:215], v[200:203], v[168:171], v[212:215]
s_waitcnt lgkmcnt(1)
v_mfma_f32_16x16x32_bf16 v[80:83], v[100:103], v[148:151], v[80:83]
s_nop 3
v_mul_f32 v204, -v204, s86
v_mfma_f32_16x16x32_bf16 v[88:91], v[100:103], v[152:155], v[88:91]
v_mul_f32 v208, -v208, s86
v_mfma_f32_16x16x32_bf16 v[96:99], v[100:103], v[156:159], v[96:99]
v_mul_f32 v212, -v212, s86
s_waitcnt lgkmcnt(0)
v_mfma_f32_16x16x32_bf16 v[80:83], v[104:107], v[160:163], v[80:83]
v_mfma_f32_16x16x32_bf16 v[88:91], v[104:107], v[164:167], v[88:91]
v_mfma_f32_16x16x32_bf16 v[96:99], v[104:107], v[168:171], v[96:99]
v_fma_f32 v76, v76, s86, v204
v_fma_f32 v77, v77, s86, v204
v_fma_f32 v78, v78, s86, v204
v_fma_f32 v79, v79, s86, v204
s_nop 1
v_fma_f32 v80, v80, s86, v204
v_fma_f32 v81, v81, s86, v204
v_fma_f32 v82, v82, s86, v204
v_fma_f32 v83, v83, s86, v204
v_cvt_pk_bf16_f32 v76, v76, v77
v_cvt_pk_bf16_f32 v77, v78, v79
v_cvt_pk_bf16_f32 v78, v80, v81
v_cvt_pk_bf16_f32 v79, v82, v83
buffer_store_dwordx4 v[76:79], v16, s[52:55], s82 offen offset:0 sc1
v_fma_f32 v84, v84, s86, v208
v_fma_f32 v85, v85, s86, v208
v_fma_f32 v86, v86, s86, v208
v_fma_f32 v87, v87, s86, v208
v_fma_f32 v88, v88, s86, v208
v_fma_f32 v89, v89, s86, v208
v_fma_f32 v90, v90, s86, v208
v_fma_f32 v91, v91, s86, v208
v_cvt_pk_bf16_f32 v84, v84, v85
v_cvt_pk_bf16_f32 v85, v86, v87
v_cvt_pk_bf16_f32 v86, v88, v89
v_cvt_pk_bf16_f32 v87, v90, v91
buffer_store_dwordx4 v[84:87], v16, s[52:55], s83 offen offset:0 sc1
v_fma_f32 v92, v92, s86, v212
v_fma_f32 v93, v93, s86, v212
v_fma_f32 v94, v94, s86, v212
v_fma_f32 v95, v95, s86, v212
v_fma_f32 v96, v96, s86, v212
v_fma_f32 v97, v97, s86, v212
v_fma_f32 v98, v98, s86, v212
v_fma_f32 v99, v99, s86, v212
v_cvt_pk_bf16_f32 v92, v92, v93
v_cvt_pk_bf16_f32 v93, v94, v95
v_cvt_pk_bf16_f32 v94, v96, v97
v_cvt_pk_bf16_f32 v95, v98, v99
buffer_store_dwordx4 v[92:95], v16, s[52:55], s84 offen offset:0 sc1
s_branch L1_fin
L1_notq:
s_sub_u32 s4, s2, 32
s_cmp_lt_u32 s2, 32
s_cbranch_scc1 L1_edge
s_mov_b32 s61, 1
v_lshlrev_b32 v16, 4, v2
s_mul_i32 s63, s60, 6144
s_and_b32 s6, s4, 3
s_lshl_b32 s6, s6, 6
s_mul_i32 s7, s60, 8
s_add_u32 s6, s6, s7
v_lshrrev_b32 v5, 5, v2
v_and_b32 v6, 31, v2
v_lshlrev_b32 v6, 4, v6
v_mov_b32 v176, v6
s_cmp_ge_u32 s4, 4
s_cselect_b64 vcc, -1, 0
v_add3_u32 v7, v5, s6, 0
v_and_b32 v8, 0x80, v7
v_bfe_u32 v9, v7, 2, 1
v_lshl_or_b32 v8, v9, 6, v8
v_bfe_u32 v9, v7, 4, 1
v_lshl_or_b32 v8, v9, 5, v8
v_and_b32 v9, 3, v7
v_lshl_or_b32 v8, v9, 3, v8
v_bfe_u32 v9, v7, 5, 2
v_lshl_or_b32 v8, v9, 1, v8
v_bfe_u32 v9, v7, 3, 1
v_or_b32 v8, v9, v8
v_cndmask_b32 v8, v8, v7, vcc
v_lshl_add_u32 v40, v8, 9, v6
v_add3_u32 v7, v5, s6, 2
v_and_b32 v8, 0x80, v7
v_bfe_u32 v9, v7, 2, 1
v_lshl_or_b32 v8, v9, 6, v8
v_bfe_u32 v9, v7, 4, 1
v_lshl_or_b32 v8, v9, 5, v8
v_and_b32 v9, 3, v7
v_lshl_or_b32 v8, v9, 3, v8
v_bfe_u32 v9, v7, 5, 2
v_lshl_or_b32 v8, v9, 1, v8
v_bfe_u32 v9, v7, 3, 1
v_or_b32 v8, v9, v8
v_cndmask_b32 v8, v8, v7, vcc
v_lshl_add_u32 v44, v8, 9, v6
v_add3_u32 v7, v5, s6, 4
v_and_b32 v8, 0x80, v7
v_bfe_u32 v9, v7, 2, 1
v_lshl_or_b32 v8, v9, 6, v8
v_bfe_u32 v9, v7, 4, 1
v_lshl_or_b32 v8, v9, 5, v8
v_and_b32 v9, 3, v7
v_lshl_or_b32 v8, v9, 3, v8
v_bfe_u32 v9, v7, 5, 2
v_lshl_or_b32 v8, v9, 1, v8
v_bfe_u32 v9, v7, 3, 1
v_or_b32 v8, v9, v8
v_cndmask_b32 v8, v8, v7, vcc
v_lshl_add_u32 v48, v8, 9, v6
v_add3_u32 v7, v5, s6, 6
v_and_b32 v8, 0x80, v7
v_bfe_u32 v9, v7, 2, 1
v_lshl_or_b32 v8, v9, 6, v8
v_bfe_u32 v9, v7, 4, 1
v_lshl_or_b32 v8, v9, 5, v8
v_and_b32 v9, 3, v7
v_lshl_or_b32 v8, v9, 3, v8
v_bfe_u32 v9, v7, 5, 2
v_lshl_or_b32 v8, v9, 1, v8
v_bfe_u32 v9, v7, 3, 1
v_or_b32 v8, v9, v8
v_cndmask_b32 v8, v8, v7, vcc
v_lshl_add_u32 v52, v8, 9, v6
s_lshl_b32 s7, s60, 6
v_lshrrev_b32 v5, 2, v2
v_and_b32 v6, 3, v2
v_lshrrev_b32 v7, 5, v2
v_lshlrev_b32 v7, 1, v7
v_xor_b32 v6, v6, v7
v_lshl_add_u32 v5, v5, 9, s7
v_lshl_add_u32 v17, v6, 4, v5
v_add_u32 v18, 0x1c00, v17
s_xor_b32 s6, s62, 0
s_lshl_b32 s66, s6, 14
s_xor_b32 s6, s62, 1
s_lshl_b32 s67, s6, 14
s_xor_b32 s6, s62, 2
s_lshl_b32 s68, s6, 14
s_xor_b32 s6, s62, 3
s_lshl_b32 s69, s6, 14
s_xor_b32 s6, s62, 4
s_lshl_b32 s70, s6, 14
s_xor_b32 s6, s62, 5
s_lshl_b32 s71, s6, 14
s_xor_b32 s6, s62, 6
s_lshl_b32 s72, s6, 14
s_xor_b32 s6, s62, 7
s_lshl_b32 s73, s6, 14
s_waitcnt lgkmcnt(0)
s_cmp_ge_u32 s4, 4
s_cselect_b32 s6, s30, s24
s_cselect_b32 s7, s31, s25
s_add_u32 s40, s6, 0x0
s_addc_u32 s41, s7, 0
s_mov_b32 s42, 0x20000
s_mov_b32 s43, 0x00020000
s_add_u32 s44, s32, 0x0
s_addc_u32 s45, s33, 0
s_mov_b32 s46, 0x20000
s_mov_b32 s47, 0x00020000
buffer_load_dwordx4 v[40:43], v40, s[40:43], 0 offen
buffer_load_dwordx4 v[44:47], v44, s[40:43], 0 offen
buffer_load_dwordx4 v[48:51], v48, s[40:43], 0 offen
buffer_load_dwordx4 v[52:55], v52, s[40:43], 0 offen
buffer_load_dwordx4 v[176:179], v176, s[40:43], 0 offen
s_add_u32 m0, s63, 0x0
s_nop 0
buffer_load_dwordx4 v17, s[44:47], s66 offen offset:0 lds
buffer_load_dwordx4 v18, s[44:47], s66 offen offset:1024 lds
s_add_u32 m0, s63, 0x800
s_nop 0
buffer_load_dwordx4 v17, s[44:47], s67 offen offset:0 lds
buffer_load_dwordx4 v18, s[44:47], s67 offen offset:1024 lds
v_bfe_u32 v5, v2, 2, 3
v_xor_b32 v5, s62, v5
v_and_b32 v6, 3, v2
v_lshlrev_b32 v7, 10, v5
v_lshl_add_u32 v7, v6, 8, v7
v_add_u32 v7, 0xc000, v7
v_and_b32 v5, 1, v5
v_lshl_or_b32 v6, v5, 2, v6
v_lshrrev_b32 v5, 5, v2
s_mul_i32 s6, s60, 8
v_add3_u32 v8, v5, s6, 0
v_lshrrev_b32 v9, 4, v8
v_lshl_add_u32 v9, v9, 13, v7
v_and_b32 v8, 15, v8
v_xor_b32 v8, v8, v6
v_lshl_add_u32 v36, v8, 4, v9
v_add3_u32 v8, v5, s6, 2
v_lshrrev_b32 v9, 4, v8
v_lshl_add_u32 v9, v9, 13, v7
v_and_b32 v8, 15, v8
v_xor_b32 v8, v8, v6
v_lshl_add_u32 v37, v8, 4, v9
v_add3_u32 v8, v5, s6, 4
v_lshrrev_b32 v9, 4, v8
v_lshl_add_u32 v9, v9, 13, v7
v_and_b32 v8, 15, v8
v_xor_b32 v8, v8, v6
v_lshl_add_u32 v38, v8, 4, v9
v_add3_u32 v8, v5, s6, 6
v_lshrrev_b32 v9, 4, v8
v_lshl_add_u32 v9, v9, 13, v7
v_and_b32 v8, 15, v8
v_xor_b32 v8, v8, v6
v_lshl_add_u32 v39, v8, 4, v9
v_xor_b32 v5, v3, v4
v_lshlrev_b32 v5, 4, v5
v_lshl_add_u32 v5, v4, 8, v5
v_add_u32 v31, 0xc000, v5
v_xor_b32 v32, 64, v31
v_lshrrev_b32 v5, 2, v3
v_and_b32 v6, 3, v3
v_and_b32 v7, 1, v4
v_lshlrev_b32 v7, 1, v7
v_lshl_add_u32 v8, v4, 3, v5
v_lshlrev_b32 v8, 6, v8
v_add_u32 v8, s63, v8
v_xor_b32 v6, v6, v7
v_xor_b32 v9, 0, v6
v_lshl_add_u32 v25, v9, 4, v8
v_add_u32 v26, 8, v25
s_lshr_b32 s6, s4, 2
s_lshl_b32 s6, s6, 17
s_and_b32 s7, s4, 3
s_lshl_b32 s7, s7, 12
s_add_u32 s6, s6, s7
s_mul_i32 s7, s60, 16384
s_add_u32 s82, s6, s7
s_add_u32 s83, s82, 16384
s_add_u32 s52, s38, 0x1000000
s_addc_u32 s53, s39, 0
s_mov_b32 s54, 0x40000
s_mov_b32 s55, 0x00020000
s_mov_b32 s90, 0xffff0000
s_waitcnt vmcnt(4)
v_lshlrev_b32 v180, 16, v176
v_and_b32 v181, s90, v176
v_lshlrev_b32 v182, 16, v177
v_and_b32 v183, s90, v177
v_lshlrev_b32 v184, 16, v178
v_and_b32 v185, s90, v178
v_lshlrev_b32 v186, 16, v179
v_and_b32 v187, s90, v179
v_lshlrev_b32 v176, 16, v40
v_and_b32 v177, s90, v40
v_sub_f32 v176, v176, v180
v_sub_f32 v177, v177, v181
v_cvt_pk_bf16_f32 v40, v176, v177
v_lshlrev_b32 v176, 16, v41
v_and_b32 v177, s90, v41
v_sub_f32 v176, v176, v182
v_sub_f32 v177, v177, v183
v_cvt_pk_bf16_f32 v41, v176, v177
v_lshlrev_b32 v176, 16, v42
v_and_b32 v177, s90, v42
v_sub_f32 v176, v176, v184
v_sub_f32 v177, v177, v185
v_cvt_pk_bf16_f32 v42, v176, v177
v_lshlrev_b32 v176, 16, v43
v_and_b32 v177, s90, v43
v_sub_f32 v176, v176, v186
v_sub_f32 v177, v177, v187
v_cvt_pk_bf16_f32 v43, v176, v177
v_lshlrev_b32 v176, 16, v44
v_and_b32 v177, s90, v44
v_sub_f32 v176, v176, v180
v_sub_f32 v177, v177, v181
v_cvt_pk_bf16_f32 v44, v176, v177
v_lshlrev_b32 v176, 16, v45
v_and_b32 v177, s90, v45
v_sub_f32 v176, v176, v182
v_sub_f32 v177, v177, v183
v_cvt_pk_bf16_f32 v45, v176, v177
v_lshlrev_b32 v176, 16, v46
v_and_b32 v177, s90, v46
v_sub_f32 v176, v176, v184
v_sub_f32 v177, v177, v185
v_cvt_pk_bf16_f32 v46, v176, v177
v_lshlrev_b32 v176, 16, v47
v_and_b32 v177, s90, v47
v_sub_f32 v176, v176, v186
v_sub_f32 v177, v177, v187
v_cvt_pk_bf16_f32 v47, v176, v177
v_lshlrev_b32 v176, 16, v48
v_and_b32 v177, s90, v48
v_sub_f32 v176, v176, v180
v_sub_f32 v177, v177, v181
v_cvt_pk_bf16_f32 v48, v176, v177
v_lshlrev_b32 v176, 16, v49
v_and_b32 v177, s90, v49
v_sub_f32 v176, v176, v182
v_sub_f32 v177, v177, v183
v_cvt_pk_bf16_f32 v49, v176, v177
v_lshlrev_b32 v176, 16, v50
v_and_b32 v177, s90, v50
v_sub_f32 v176, v176, v184
v_sub_f32 v177, v177, v185
v_cvt_pk_bf16_f32 v50, v176, v177
v_lshlrev_b32 v176, 16, v51
v_and_b32 v177, s90, v51
v_sub_f32 v176, v176, v186
v_sub_f32 v177, v177, v187
v_cvt_pk_bf16_f32 v51, v176, v177
v_lshlrev_b32 v176, 16, v52
v_and_b32 v177, s90, v52
v_sub_f32 v176, v176, v180
v_sub_f32 v177, v177, v181
v_cvt_pk_bf16_f32 v52, v176, v177
v_lshlrev_b32 v176, 16, v53
v_and_b32 v177, s90, v53
v_sub_f32 v176, v176, v182
v_sub_f32 v177, v177, v183
v_cvt_pk_bf16_f32 v53, v176, v177
v_lshlrev_b32 v176, 16, v54
v_and_b32 v177, s90, v54
v_sub_f32 v176, v176, v184
v_sub_f32 v177, v177, v185
v_cvt_pk_bf16_f32 v54, v176, v177
v_lshlrev_b32 v176, 16, v55
v_and_b32 v177, s90, v55
v_sub_f32 v176, v176, v186
v_sub_f32 v177, v177, v187
v_cvt_pk_bf16_f32 v55, v176, v177
ds_write_b128 v36, v[40:43]
ds_write_b128 v37, v[44:47]
ds_write_b128 v38, v[48:51]
ds_write_b128 v39, v[52:55]
s_add_u32 m0, s63, 0x1000
s_nop 0
buffer_load_dwordx4 v17, s[44:47], s68 offen offset:0 lds
buffer_load_dwordx4 v18, s[44:47], s68 offen offset:1024 lds
s_waitcnt vmcnt(4)
ds_read_b64_tr_b16 v[88:89], v25 offset:0
ds_read_b64_tr_b16 v[90:91], v25 offset:256
ds_read_b64_tr_b16 v[92:93], v26 offset:0
ds_read_b64_tr_b16 v[94:95], v26 offset:256
s_waitcnt lgkmcnt(4)
s_barrier
ds_read_b128 v[112:115], v31 offset:0
ds_read_b128 v[116:119], v31 offset:8192
ds_read_b128 v[120:123], v31 offset:16384
ds_read_b128 v[124:127], v31 offset:24576
ds_read_b128 v[128:131], v32 offset:1024
s_waitcnt vmcnt(2)
ds_read_b64_tr_b16 v[96:97], v25 offset:2048
ds_read_b64_tr_b16 v[98:99], v25 offset:2304
s_waitcnt lgkmcnt(6)
v_mfma_f32_16x16x32_bf16 v[56:59], v[112:115], v[88:91], 0
ds_read_b128 v[132:135], v32 offset:9216
s_waitcnt lgkmcnt(6)
v_mfma_f32_16x16x32_bf16 v[60:63], v[116:119], v[88:91], 0
ds_read_b128 v[136:139], v32 offset:17408
s_waitcnt lgkmcnt(6)
v_mfma_f32_16x16x32_bf16 v[64:67], v[120:123], v[88:91], 0
ds_read_b128 v[140:143], v32 offset:25600
s_waitcnt lgkmcnt(6)
v_mfma_f32_16x16x32_bf16 v[68:71], v[124:127], v[88:91], 0
ds_read_b64_tr_b16 v[100:101], v26 offset:2048
ds_read_b64_tr_b16 v[102:103], v26 offset:2304
v_mfma_f32_16x16x32_bf16 v[72:75], v[112:115], v[92:95], 0
s_add_u32 m0, s63, 0x0
s_nop 0
buffer_load_dwordx4 v17, s[44:47], s69 offen offset:0 lds
buffer_load_dwordx4 v18, s[44:47], s69 offen offset:1024 lds
v_mfma_f32_16x16x32_bf16 v[76:79], v[116:119], v[92:95], 0
v_mfma_f32_16x16x32_bf16 v[80:83], v[120:123], v[92:95], 0
v_mfma_f32_16x16x32_bf16 v[84:87], v[124:127], v[92:95], 0
ds_read_b128 v[144:147], v31 offset:2048
s_waitcnt vmcnt(2)
ds_read_b64_tr_b16 v[104:105], v25 offset:4096
ds_read_b64_tr_b16 v[106:107], v25 offset:4352
s_waitcnt lgkmcnt(8)
v_mfma_f32_16x16x32_bf16 v[56:59], v[128:131], v[96:99], v[56:59]
ds_read_b128 v[148:151], v31 offset:10240
s_waitcnt lgkmcnt(8)
v_mfma_f32_16x16x32_bf16 v[60:63], v[132:135], v[96:99], v[60:63]
ds_read_b128 v[152:155], v31 offset:18432
s_waitcnt lgkmcnt(8)
v_mfma_f32_16x16x32_bf16 v[64:67], v[136:139], v[96:99], v[64:67]
ds_read_b128 v[156:159], v31 offset:26624
s_waitcnt lgkmcnt(8)
v_mfma_f32_16x16x32_bf16 v[68:71], v[140:143], v[96:99], v[68:71]
ds_read_b64_tr_b16 v[108:109], v26 offset:4096
ds_read_b64_tr_b16 v[110:111], v26 offset:4352
s_waitcnt lgkmcnt(8)
v_mfma_f32_16x16x32_bf16 v[72:75], v[128:131], v[100:103], v[72:75]
s_add_u32 m0, s63, 0x800
s_nop 0
buffer_load_dwordx4 v17, s[44:47], s70 offen offset:0 lds
buffer_load_dwordx4 v18, s[44:47], s70 offen offset:1024 lds
v_mfma_f32_16x16x32_bf16 v[76:79], v[132:135], v[100:103], v[76:79]
v_mfma_f32_16x16x32_bf16 v[80:83], v[136:139], v[100:103], v[80:83]
v_mfma_f32_16x16x32_bf16 v[84:87], v[140:143], v[100:103], v[84:87]
ds_read_b128 v[160:163], v32 offset:3072
s_waitcnt vmcnt(2)
ds_read_b64_tr_b16 v[88:89], v25 offset:0
ds_read_b64_tr_b16 v[90:91], v25 offset:256
s_waitcnt lgkmcnt(8)
v_mfma_f32_16x16x32_bf16 v[56:59], v[144:147], v[104:107], v[56:59]
ds_read_b128 v[164:167], v32 offset:11264
s_waitcnt lgkmcnt(8)
v_mfma_f32_16x16x32_bf16 v[60:63], v[148:151], v[104:107], v[60:63]
ds_read_b128 v[168:171], v32 offset:19456
s_waitcnt lgkmcnt(8)
v_mfma_f32_16x16x32_bf16 v[64:67], v[152:155], v[104:107], v[64:67]
ds_read_b128 v[172:175], v32 offset:27648
s_waitcnt lgkmcnt(8)
v_mfma_f32_16x16x32_bf16 v[68:71], v[156:159], v[104:107], v[68:71]
ds_read_b64_tr_b16 v[92:93], v26 offset:0
ds_read_b64_tr_b16 v[94:95], v26 offset:256
s_waitcnt lgkmcnt(8)
v_mfma_f32_16x16x32_bf16 v[72:75], v[144:147], v[108:111], v[72:75]
s_add_u32 m0, s63, 0x1000
s_nop 0
buffer_load_dwordx4 v17, s[44:47], s71 offen offset:0 lds
buffer_load_dwordx4 v18, s[44:47], s71 offen offset:1024 lds
v_mfma_f32_16x16x32_bf16 v[76:79], v[148:151], v[108:111], v[76:79]
v_mfma_f32_16x16x32_bf16 v[80:83], v[152:155], v[108:111], v[80:83]
v_mfma_f32_16x16x32_bf16 v[84:87], v[156:159], v[108:111], v[84:87]
ds_read_b128 v[112:115], v31 offset:4096
s_waitcnt vmcnt(2)
ds_read_b64_tr_b16 v[96:97], v25 offset:2048
ds_read_b64_tr_b16 v[98:99], v25 offset:2304
s_waitcnt lgkmcnt(8)
v_mfma_f32_16x16x32_bf16 v[56:59], v[160:163], v[88:91], v[56:59]
ds_read_b128 v[116:119], v31 offset:12288
s_waitcnt lgkmcnt(8)
v_mfma_f32_16x16x32_bf16 v[60:63], v[164:167], v[88:91], v[60:63]
ds_read_b128 v[120:123], v31 offset:20480
s_waitcnt lgkmcnt(8)
v_mfma_f32_16x16x32_bf16 v[64:67], v[168:171], v[88:91], v[64:67]
ds_read_b128 v[124:127], v31 offset:28672
s_waitcnt lgkmcnt(8)
v_mfma_f32_16x16x32_bf16 v[68:71], v[172:175], v[88:91], v[68:71]
ds_read_b64_tr_b16 v[100:101], v26 offset:2048
ds_read_b64_tr_b16 v[102:103], v26 offset:2304
s_waitcnt lgkmcnt(8)
v_mfma_f32_16x16x32_bf16 v[72:75], v[160:163], v[92:95], v[72:75]
s_add_u32 m0, s63, 0x0
s_nop 0
buffer_load_dwordx4 v17, s[44:47], s72 offen offset:0 lds
buffer_load_dwordx4 v18, s[44:47], s72 offen offset:1024 lds
v_mfma_f32_16x16x32_bf16 v[76:79], v[164:167], v[92:95], v[76:79]
v_mfma_f32_16x16x32_bf16 v[80:83], v[168:171], v[92:95], v[80:83]
v_mfma_f32_16x16x32_bf16 v[84:87], v[172:175], v[92:95], v[84:87]
ds_read_b128 v[128:131], v32 offset:5120
s_waitcnt vmcnt(2)
ds_read_b64_tr_b16 v[104:105], v25 offset:4096
ds_read_b64_tr_b16 v[106:107], v25 offset:4352
s_waitcnt lgkmcnt(8)
v_mfma_f32_16x16x32_bf16 v[56:59], v[112:115], v[96:99], v[56:59]
ds_read_b128 v[132:135], v32 offset:13312
s_waitcnt lgkmcnt(8)
v_mfma_f32_16x16x32_bf16 v[60:63], v[116:119], v[96:99], v[60:63]
ds_read_b128 v[136:139], v32 offset:21504
s_waitcnt lgkmcnt(8)
v_mfma_f32_16x16x32_bf16 v[64:67], v[120:123], v[96:99], v[64:67]
ds_read_b128 v[140:143], v32 offset:29696
s_waitcnt lgkmcnt(8)
v_mfma_f32_16x16x32_bf16 v[68:71], v[124:127], v[96:99], v[68:71]
ds_read_b64_tr_b16 v[108:109], v26 offset:4096
ds_read_b64_tr_b16 v[110:111], v26 offset:4352
s_waitcnt lgkmcnt(8)
v_mfma_f32_16x16x32_bf16 v[72:75], v[112:115], v[100:103], v[72:75]
s_add_u32 m0, s63, 0x800
s_nop 0
buffer_load_dwordx4 v17, s[44:47], s73 offen offset:0 lds
buffer_load_dwordx4 v18, s[44:47], s73 offen offset:1024 lds
v_mfma_f32_16x16x32_bf16 v[76:79], v[116:119], v[100:103], v[76:79]
v_mfma_f32_16x16x32_bf16 v[80:83], v[120:123], v[100:103], v[80:83]
v_mfma_f32_16x16x32_bf16 v[84:87], v[124:127], v[100:103], v[84:87]
ds_read_b128 v[144:147], v31 offset:6144
s_waitcnt vmcnt(2)
ds_read_b64_tr_b16 v[88:89], v25 offset:0
ds_read_b64_tr_b16 v[90:91], v25 offset:256
s_waitcnt lgkmcnt(8)
v_mfma_f32_16x16x32_bf16 v[56:59], v[128:131], v[104:107], v[56:59]
ds_read_b128 v[148:151], v31 offset:14336
s_waitcnt lgkmcnt(8)
v_mfma_f32_16x16x32_bf16 v[60:63], v[132:135], v[104:107], v[60:63]
ds_read_b128 v[152:155], v31 offset:22528
s_waitcnt lgkmcnt(8)
v_mfma_f32_16x16x32_bf16 v[64:67], v[136:139], v[104:107], v[64:67]
ds_read_b128 v[156:159], v31 offset:30720
s_waitcnt lgkmcnt(8)
v_mfma_f32_16x16x32_bf16 v[68:71], v[140:143], v[104:107], v[68:71]
ds_read_b64_tr_b16 v[92:93], v26 offset:0
ds_read_b64_tr_b16 v[94:95], v26 offset:256
s_waitcnt lgkmcnt(8)
v_mfma_f32_16x16x32_bf16 v[72:75], v[128:131], v[108:111], v[72:75]
v_mfma_f32_16x16x32_bf16 v[76:79], v[132:135], v[108:111], v[76:79]
v_mfma_f32_16x16x32_bf16 v[80:83], v[136:139], v[108:111], v[80:83]
v_mfma_f32_16x16x32_bf16 v[84:87], v[140:143], v[108:111], v[84:87]
ds_read_b128 v[160:163], v32 offset:7168
s_waitcnt vmcnt(0)
ds_read_b64_tr_b16 v[96:97], v25 offset:2048
ds_read_b64_tr_b16 v[98:99], v25 offset:2304
s_waitcnt lgkmcnt(8)
v_mfma_f32_16x16x32_bf16 v[56:59], v[144:147], v[88:91], v[56:59]
ds_read_b128 v[164:167], v32 offset:15360
s_waitcnt lgkmcnt(8)
v_mfma_f32_16x16x32_bf16 v[60:63], v[148:151], v[88:91], v[60:63]
ds_read_b128 v[168:171], v32 offset:23552
s_waitcnt lgkmcnt(8)
v_mfma_f32_16x16x32_bf16 v[64:67], v[152:155], v[88:91], v[64:67]
ds_read_b128 v[172:175], v32 offset:31744
s_waitcnt lgkmcnt(8)
v_mfma_f32_16x16x32_bf16 v[68:71], v[156:159], v[88:91], v[68:71]
ds_read_b64_tr_b16 v[100:101], v26 offset:2048
ds_read_b64_tr_b16 v[102:103], v26 offset:2304
s_waitcnt lgkmcnt(8)
v_mfma_f32_16x16x32_bf16 v[72:75], v[144:147], v[92:95], v[72:75]
v_mfma_f32_16x16x32_bf16 v[76:79], v[148:151], v[92:95], v[76:79]
v_mfma_f32_16x16x32_bf16 v[80:83], v[152:155], v[92:95], v[80:83]
v_mfma_f32_16x16x32_bf16 v[84:87], v[156:159], v[92:95], v[84:87]
s_waitcnt lgkmcnt(5)
v_mfma_f32_16x16x32_bf16 v[56:59], v[160:163], v[96:99], v[56:59]
s_waitcnt lgkmcnt(4)
v_mfma_f32_16x16x32_bf16 v[60:63], v[164:167], v[96:99], v[60:63]
s_waitcnt lgkmcnt(3)
v_mfma_f32_16x16x32_bf16 v[64:67], v[168:171], v[96:99], v[64:67]
s_waitcnt lgkmcnt(2)
v_mfma_f32_16x16x32_bf16 v[68:71], v[172:175], v[96:99], v[68:71]
s_waitcnt lgkmcnt(0)
v_mfma_f32_16x16x32_bf16 v[72:75], v[160:163], v[100:103], v[72:75]
v_cvt_pk_bf16_f32 v56, v56, v57
v_cvt_pk_bf16_f32 v57, v58, v59
v_cvt_pk_bf16_f32 v58, v60, v61
v_cvt_pk_bf16_f32 v59, v62, v63
buffer_store_dwordx4 v[56:59], v16, s[52:55], s82 offen offset:0 sc1
v_mfma_f32_16x16x32_bf16 v[76:79], v[164:167], v[100:103], v[76:79]
v_mfma_f32_16x16x32_bf16 v[80:83], v[168:171], v[100:103], v[80:83]
v_cvt_pk_bf16_f32 v64, v64, v65
v_cvt_pk_bf16_f32 v65, v66, v67
v_cvt_pk_bf16_f32 v66, v68, v69
v_cvt_pk_bf16_f32 v67, v70, v71
buffer_store_dwordx4 v[64:67], v16, s[52:55], s82 offen offset:2048 sc1
v_mfma_f32_16x16x32_bf16 v[84:87], v[172:175], v[100:103], v[84:87]
v_cvt_pk_bf16_f32 v72, v72, v73
v_cvt_pk_bf16_f32 v73, v74, v75
v_cvt_pk_bf16_f32 v74, v76, v77
v_cvt_pk_bf16_f32 v75, v78, v79
buffer_store_dwordx4 v[72:75], v16, s[52:55], s82 offen offset:1024 sc1
v_cvt_pk_bf16_f32 v80, v80, v81
v_cvt_pk_bf16_f32 v81, v82, v83
s_nop 0
v_cvt_pk_bf16_f32 v82, v84, v85
v_cvt_pk_bf16_f32 v83, v86, v87
buffer_store_dwordx4 v[80:83], v16, s[52:55], s82 offen offset:3072 sc1
s_branch L1_fin
L1_edge:
s_mov_b32 s61, 4
s_mov_b32 s4, s2
s_mul_i32 s6, s4, 20000
v_lshlrev_b32 v5, 4, v0
v_lshlrev_b32 v6, 2, v2
v_add_u32 v6, 0x10000, v6
v_mov_b32 v7, 0
ds_write_b32 v6, v7
s_mov_b32 s66, 0
s_mov_b32 s67, 8192
s_mov_b32 s68, 16384
s_waitcnt lgkmcnt(0)
s_add_u32 s56, s38, 0x7c00000
s_addc_u32 s57, s39, 0
s_mov_b32 s58, 0x2000
s_mov_b32 s59, 0x00020000
s_cmp_eq_u32 s4, 0
s_cselect_b32 s9, 0, 0x7fff0000
v_mov_b32 v8, 0
v_mov_b32 v9, 0
v_mov_b32 v10, 0
v_mov_b32 v11, 0
buffer_store_dwordx4 v[8:11], v5, s[56:59], s9 offen
s_add_u32 s40, s20, 0x0
s_addc_u32 s41, s21, 0
s_add_u32 s40, s40, s6
s_addc_u32 s41, s41, 0
s_mov_b32 s42, 0x4e20
s_mov_b32 s43, 0x00020000
s_add_u32 s44, s18, 0x0
s_addc_u32 s45, s19, 0
s_add_u32 s44, s44, s6
s_addc_u32 s45, s45, 0
s_mov_b32 s46, 0x4e20
s_mov_b32 s47, 0x00020000
buffer_load_dwordx4 v[16:19], v5, s[40:43], s66 offen
buffer_load_dwordx4 v[20:23], v5, s[40:43], s67 offen
buffer_load_dwordx4 v[24:27], v5, s[40:43], s68 offen
buffer_load_dwordx4 v[28:31], v5, s[44:47], s66 offen
buffer_load_dwordx4 v[32:35], v5, s[44:47], s67 offen
buffer_load_dwordx4 v[36:39], v5, s[44:47], s68 offen
s_add_u32 s48, s38, 0x8000000
s_addc_u32 s49, s39, 0
s_mov_b32 s50, 0x2800000
s_mov_b32 s51, 0x00020000
s_add_u32 s52, s38, 0x7800000
s_addc_u32 s53, s39, 0
s_mov_b32 s54, 0x2000
s_mov_b32 s55, 0x00020000
s_mov_b32 s9, 6279
s_mov_b32 s10, 4294967129
s_mov_b32 s11, 0x10000
v_mov_b32 v7, 1
v_cmp_gt_u32 vcc, 0xe2, v0
s_mov_b64 s[12:13], vcc
s_barrier
s_waitcnt vmcnt(5)
v_mul_u32_u24 v40, s9, v16
v_lshrrev_b32 v40, 20, v40
v_lshl_add_u32 v52, v40, 2, s11
ds_add_rtn_u32 v52, v52, v7
v_mad_i32_i24 v16, v40, s10, v16
v_mul_u32_u24 v41, s9, v17
v_lshrrev_b32 v41, 20, v41
v_lshl_add_u32 v53, v41, 2, s11
ds_add_rtn_u32 v53, v53, v7
v_mad_i32_i24 v17, v41, s10, v17
v_mul_u32_u24 v42, s9, v18
v_lshrrev_b32 v42, 20, v42
v_lshl_add_u32 v54, v42, 2, s11
ds_add_rtn_u32 v54, v54, v7
v_mad_i32_i24 v18, v42, s10, v18
v_mul_u32_u24 v43, s9, v19
v_lshrrev_b32 v43, 20, v43
v_lshl_add_u32 v55, v43, 2, s11
ds_add_rtn_u32 v55, v55, v7
v_mad_i32_i24 v19, v43, s10, v19
s_waitcnt vmcnt(4)
v_mul_u32_u24 v44, s9, v20
v_lshrrev_b32 v44, 20, v44
v_lshl_add_u32 v56, v44, 2, s11
ds_add_rtn_u32 v56, v56, v7
v_mad_i32_i24 v20, v44, s10, v20
v_mul_u32_u24 v45, s9, v21
v_lshrrev_b32 v45, 20, v45
v_lshl_add_u32 v57, v45, 2, s11
ds_add_rtn_u32 v57, v57, v7
v_mad_i32_i24 v21, v45, s10, v21
v_mul_u32_u24 v46, s9, v22
v_lshrrev_b32 v46, 20, v46
v_lshl_add_u32 v58, v46, 2, s11
ds_add_rtn_u32 v58, v58, v7
v_mad_i32_i24 v22, v46, s10, v22
v_mul_u32_u24 v47, s9, v23
v_lshrrev_b32 v47, 20, v47
v_lshl_add_u32 v59, v47, 2, s11
ds_add_rtn_u32 v59, v59, v7
v_mad_i32_i24 v23, v47, s10, v23
s_waitcnt vmcnt(3)
s_mov_b64 exec, s[12:13]
v_mul_u32_u24 v48, s9, v24
v_lshrrev_b32 v48, 20, v48
v_lshl_add_u32 v60, v48, 2, s11
ds_add_rtn_u32 v60, v60, v7
v_mad_i32_i24 v24, v48, s10, v24
v_mul_u32_u24 v49, s9, v25
v_lshrrev_b32 v49, 20, v49
v_lshl_add_u32 v61, v49, 2, s11
ds_add_rtn_u32 v61, v61, v7
v_mad_i32_i24 v25, v49, s10, v25
v_mul_u32_u24 v50, s9, v26
v_lshrrev_b32 v50, 20, v50
v_lshl_add_u32 v62, v50, 2, s11
ds_add_rtn_u32 v62, v62, v7
v_mad_i32_i24 v26, v50, s10, v26
v_mul_u32_u24 v51, s9, v27
v_lshrrev_b32 v51, 20, v51
v_lshl_add_u32 v63, v51, 2, s11
ds_add_rtn_u32 v63, v63, v7
v_mad_i32_i24 v27, v51, s10, v27
s_mov_b64 exec, -1
s_waitcnt vmcnt(2) lgkmcnt(4)
v_and_b32 v8, 0x7f, v52
v_lshl_or_b32 v28, v16, 18, v28
v_lshlrev_b32 v8, 2, v8
v_lshl_add_u32 v8, v40, 9, v8
ds_write_b32 v8, v28
v_and_b32 v8, 0x7f, v53
v_lshl_or_b32 v29, v17, 18, v29
v_lshlrev_b32 v8, 2, v8
v_lshl_add_u32 v8, v41, 9, v8
ds_write_b32 v8, v29
v_and_b32 v8, 0x7f, v54
v_lshl_or_b32 v30, v18, 18, v30
v_lshlrev_b32 v8, 2, v8
v_lshl_add_u32 v8, v42, 9, v8
ds_write_b32 v8, v30
v_and_b32 v8, 0x7f, v55
v_lshl_or_b32 v31, v19, 18, v31
v_lshlrev_b32 v8, 2, v8
v_lshl_add_u32 v8, v43, 9, v8
ds_write_b32 v8, v31
s_waitcnt vmcnt(1) lgkmcnt(4)
v_and_b32 v8, 0x7f, v56
v_lshl_or_b32 v32, v20, 18, v32
v_lshlrev_b32 v8, 2, v8
v_lshl_add_u32 v8, v44, 9, v8
ds_write_b32 v8, v32
v_and_b32 v8, 0x7f, v57
v_lshl_or_b32 v33, v21, 18, v33
v_lshlrev_b32 v8, 2, v8
v_lshl_add_u32 v8, v45, 9, v8
ds_write_b32 v8, v33
v_and_b32 v8, 0x7f, v58
v_lshl_or_b32 v34, v22, 18, v34
v_lshlrev_b32 v8, 2, v8
v_lshl_add_u32 v8, v46, 9, v8
ds_write_b32 v8, v34
v_and_b32 v8, 0x7f, v59
v_lshl_or_b32 v35, v23, 18, v35
v_lshlrev_b32 v8, 2, v8
v_lshl_add_u32 v8, v47, 9, v8
ds_write_b32 v8, v35
s_waitcnt vmcnt(0) lgkmcnt(8)
s_mov_b64 exec, s[12:13]
v_and_b32 v8, 0x7f, v60
v_lshl_or_b32 v36, v24, 18, v36
v_lshlrev_b32 v8, 2, v8
v_lshl_add_u32 v8, v48, 9, v8
ds_write_b32 v8, v36
v_and_b32 v8, 0x7f, v61
v_lshl_or_b32 v37, v25, 18, v37
v_lshlrev_b32 v8, 2, v8
v_lshl_add_u32 v8, v49, 9, v8
ds_write_b32 v8, v37
v_and_b32 v8, 0x7f, v62
v_lshl_or_b32 v38, v26, 18, v38
v_lshlrev_b32 v8, 2, v8
v_lshl_add_u32 v8, v50, 9, v8
ds_write_b32 v8, v38
v_and_b32 v8, 0x7f, v63
v_lshl_or_b32 v39, v27, 18, v39
v_lshlrev_b32 v8, 2, v8
v_lshl_add_u32 v8, v51, 9, v8
ds_write_b32 v8, v39
s_mov_b64 exec, -1
s_waitcnt lgkmcnt(0)
s_barrier
ds_read_b32 v8, v6
s_mul_i32 s6, s60, 4096
v_lshlrev_b32 v10, 4, v2
v_add_u32 v9, s6, v10
ds_read_b128 v[64:67], v9 offset:0
ds_read_b128 v[68:71], v9 offset:1024
ds_read_b128 v[72:75], v9 offset:2048
ds_read_b128 v[76:79], v9 offset:3072
v_lshrrev_b32 v11, 5, v2
v_mul_u32_u24 v11, 0x9fe00, v11
v_add_u32 v10, v10, v11
s_mul_i32 s6, s60, 5242880
s_mul_i32 s7, s4, 20480
s_add_u32 s6, s6, s7
v_lshlrev_b32 v9, 7, v2
s_lshl_b32 s8, s4, 2
s_cmp_eq_u32 s60, 0
s_cselect_b32 s8, s8, 0x7fff0000
s_waitcnt lgkmcnt(4)
buffer_store_dword v8, v9, s[52:55], s8 offen sc1
v_cmp_lt_u32 vcc, 0x80, v8
s_cbranch_vccnz L1_eslow
s_waitcnt lgkmcnt(3)
buffer_store_dwordx4 v[64:67], v10, s[48:51], s6 offen sc1
s_add_u32 s6, s6, 1310720
s_waitcnt lgkmcnt(2)
buffer_store_dwordx4 v[68:71], v10, s[48:51], s6 offen sc1
s_add_u32 s6, s6, 1310720
s_waitcnt lgkmcnt(1)
buffer_store_dwordx4 v[72:75], v10, s[48:51], s6 offen sc1
s_add_u32 s6, s6, 1310720
s_waitcnt lgkmcnt(0)
buffer_store_dwordx4 v[76:79], v10, s[48:51], s6 offen sc1
s_add_u32 s6, s6, 1310720
s_branch L1_fin
L1_eslow:
s_mov_b32 s9, 655360
v_mul_u32_u24 v40, s9, v40
v_lshl_add_u32 v40, v52, 2, v40
v_mul_u32_u24 v41, s9, v41
v_lshl_add_u32 v41, v53, 2, v41
v_mul_u32_u24 v42, s9, v42
v_lshl_add_u32 v42, v54, 2, v42
v_mul_u32_u24 v43, s9, v43
v_lshl_add_u32 v43, v55, 2, v43
v_mul_u32_u24 v44, s9, v44
v_lshl_add_u32 v44, v56, 2, v44
v_mul_u32_u24 v45, s9, v45
v_lshl_add_u32 v45, v57, 2, v45
v_mul_u32_u24 v46, s9, v46
v_lshl_add_u32 v46, v58, 2, v46
v_mul_u32_u24 v47, s9, v47
v_lshl_add_u32 v47, v59, 2, v47
v_mul_u32_u24 v48, s9, v48
v_lshl_add_u32 v48, v60, 2, v48
v_mul_u32_u24 v49, s9, v49
v_lshl_add_u32 v49, v61, 2, v49
v_mul_u32_u24 v50, s9, v50
v_lshl_add_u32 v50, v62, 2, v50
v_mul_u32_u24 v51, s9, v51
v_lshl_add_u32 v51, v63, 2, v51
buffer_store_dword v28, v40, s[48:51], s7 offen
buffer_store_dword v29, v41, s[48:51], s7 offen
buffer_store_dword v30, v42, s[48:51], s7 offen
buffer_store_dword v31, v43, s[48:51], s7 offen
buffer_store_dword v32, v44, s[48:51], s7 offen
buffer_store_dword v33, v45, s[48:51], s7 offen
buffer_store_dword v34, v46, s[48:51], s7 offen
buffer_store_dword v35, v47, s[48:51], s7 offen
s_mov_b64 exec, s[12:13]
buffer_store_dword v36, v48, s[48:51], s7 offen
buffer_store_dword v37, v49, s[48:51], s7 offen
buffer_store_dword v38, v50, s[48:51], s7 offen
buffer_store_dword v39, v51, s[48:51], s7 offen
s_mov_b64 exec, -1
L1_fin:
L1_end:
s_endpgm
.globl k2_kernel
.p2align 8
.type k2_kernel,@function
k2_kernel:
s_load_dwordx2 s[4:5], s[0:1], 88
s_load_dwordx2 s[6:7], s[0:1], 0
s_load_dwordx2 s[16:17], s[0:1], 24
s_load_dwordx2 s[18:19], s[0:1], 72
s_and_b32 s35, s2, 7
s_lshr_b32 s37, s2, 3
s_cmp_ge_u32 s37, 30
s_cbranch_scc1 LE_start
s_mul_i32 s38, s37, 52
s_lshr_b32 s38, s38, 8
s_mul_i32 s39, s38, 5
s_sub_u32 s39, s37, s39
s_mov_b32 s37, s38
s_mul_i32 s38, s35, 5
s_add_u32 s38, s38, s39
v_lshrrev_b32 v1, 6, v0
v_and_b32 v252, 63, v0
v_lshlrev_b32 v252, 4, v252
v_readfirstlane_b32 s34, v1
s_mov_b32 s50, 0xe1a06800
s_mov_b32 s51, 0x4e608d04
s_mul_i32 s39, s37, 9
s_lshr_b64 s[50:51], s[50:51], s39
s_and_b32 s39, s50, 0x1ff
s_bfe_u32 s49, s50, 0x90009
s_sub_u32 s29, s49, s39
s_lshl_b32 s50, s37, 2
s_lshr_b32 s59, 0x766666, s50
s_and_b32 s59, s59, 15
s_sub_u32 s31, s29, s59
s_lshr_b32 s31, s31, 1
s_sub_u32 s31, s31, 1
s_lshl_b32 s39, s39, 14
s_lshl_b32 s49, s49, 14
s_add_u32 s28, s39, 0x4000
s_cmp_eq_u32 s37, 5
s_cselect_b32 s33, 0xff800000, 0
s_mov_b32 s32, 0xffff
v_and_b32 v2, 63, v0
v_bfe_u32 v3, v2, 3, 2
v_bfe_u32 v4, v2, 2, 1
v_lshlrev_b32 v251, 12, v3
v_lshl_or_b32 v251, v4, 9, v251
v_lshl_or_b32 v251, v1, 7, v251
v_lshrrev_b32 v4, 5, v2
v_lshl_or_b32 v251, v4, 6, v251
v_and_b32 v3, 2, v3
v_and_b32 v4, 3, v2
v_xor_b32 v3, v3, v4
v_lshl_or_b32 v251, v3, 4, v251
s_cmp_eq_u32 s38, 39
s_cbranch_scc1 LT_disp
s_lshl_b32 s30, s34, 12
s_mov_b32 m0, s30
s_waitcnt lgkmcnt(0)
s_add_u32 s12, s4, 0x6800000
s_addc_u32 s13, s5, 0
s_mov_b32 s14, s49
s_mov_b32 s15, 0x00020000
buffer_load_dwordx4 v251, s[12:15], s39 offen offset:0 lds
buffer_load_dwordx4 v251, s[12:15], s39 offen offset:1024 lds
buffer_load_dwordx4 v251, s[12:15], s39 offen offset:2048 lds
buffer_load_dwordx4 v251, s[12:15], s39 offen offset:3072 lds
s_add_u32 m0, s30, 0x4000
s_nop 0
buffer_load_dwordx4 v251, s[12:15], s28 offen offset:0 lds
buffer_load_dwordx4 v251, s[12:15], s28 offen offset:1024 lds
s_add_u32 s8, s4, 0x0
s_addc_u32 s9, s5, 0
s_mov_b32 s10, 0x4e4000
s_mov_b32 s11, 0x00020000
s_mul_i32 s35, s37, 0x600000
s_add_u32 s20, s4, 0x2000000
s_addc_u32 s21, s5, 0
s_add_u32 s20, s20, s35
s_addc_u32 s21, s21, 0
s_mov_b32 s22, 0x4e4000
s_mov_b32 s23, 0x00020000
s_add_u32 s24, s4, 0x6000000
s_addc_u32 s25, s5, 0
s_mov_b32 s26, 0x9c800
s_mov_b32 s27, 0x00020000
s_lshl_b32 s35, s38, 4
s_lshl_b32 s41, s34, 2
s_add_u32 s35, s35, s41
s_lshl_b32 s40, s35, 13
s_lshl_b32 s48, s35, 10
s_lshl_b32 s35, s37, 3
s_add_u32 s48, s48, s35
s_add_u32 s41, s40, 8192
s_add_u32 s42, s40, 16384
s_add_u32 s43, s40, 24576
s_add_u32 s44, s40, 4096
s_add_u32 s45, s41, 4096
s_add_u32 s46, s42, 4096
s_add_u32 s47, s43, 4096
s_mov_b32 s52, 0x71800000
s_mov_b32 s53, 0x0d800000
v_mov_b32 v208, 0
v_mov_b32 v209, 0
v_mov_b32 v210, 0
v_mov_b32 v211, 0
buffer_load_dwordx4 v[0:3], v252, s[8:11], s40 offen offset:0
buffer_load_dwordx4 v[32:35], v252, s[8:11], s41 offen offset:0
v_mfma_f32_32x32x16_bf16 a[0:15], v[208:211], v[208:211], 0
buffer_load_dwordx4 v[64:67], v252, s[8:11], s42 offen offset:0
buffer_load_dwordx4 v[96:99], v252, s[8:11], s43 offen offset:0
v_mfma_f32_32x32x16_bf16 a[16:31], v[208:211], v[208:211], 0
buffer_load_dwordx4 v[4:7], v252, s[8:11], s40 offen offset:1024
buffer_load_dwordx4 v[36:39], v252, s[8:11], s41 offen offset:1024
v_mfma_f32_32x32x16_bf16 a[32:47], v[208:211], v[208:211], 0
buffer_load_dwordx4 v[68:71], v252, s[8:11], s42 offen offset:1024
buffer_load_dwordx4 v[100:103], v252, s[8:11], s43 offen offset:1024
v_mfma_f32_32x32x16_bf16 a[48:63], v[208:211], v[208:211], 0
buffer_load_dwordx4 v[8:11], v252, s[8:11], s40 offen offset:2048
buffer_load_dwordx4 v[40:43], v252, s[8:11], s41 offen offset:2048
v_mfma_f32_32x32x16_bf16 a[64:79], v[208:211], v[208:211], 0
buffer_load_dwordx4 v[72:75], v252, s[8:11], s42 offen offset:2048
buffer_load_dwordx4 v[104:107], v252, s[8:11], s43 offen offset:2048
v_mfma_f32_32x32x16_bf16 a[80:95], v[208:211], v[208:211], 0
buffer_load_dwordx4 v[12:15], v252, s[8:11], s40 offen offset:3072
buffer_load_dwordx4 v[44:47], v252, s[8:11], s41 offen offset:3072
v_mfma_f32_32x32x16_bf16 a[96:111], v[208:211], v[208:211], 0
buffer_load_dwordx4 v[76:79], v252, s[8:11], s42 offen offset:3072
buffer_load_dwordx4 v[108:111], v252, s[8:11], s43 offen offset:3072
v_mfma_f32_32x32x16_bf16 a[112:127], v[208:211], v[208:211], 0
buffer_load_dwordx4 v[16:19], v252, s[8:11], s44 offen offset:0
buffer_load_dwordx4 v[48:51], v252, s[8:11], s45 offen offset:0
v_mfma_f32_32x32x16_bf16 a[128:143], v[208:211], v[208:211], 0
buffer_load_dwordx4 v[80:83], v252, s[8:11], s46 offen offset:0
buffer_load_dwordx4 v[112:115], v252, s[8:11], s47 offen offset:0
v_mfma_f32_32x32x16_bf16 a[144:159], v[208:211], v[208:211], 0
buffer_load_dwordx4 v[20:23], v252, s[8:11], s44 offen offset:1024
buffer_load_dwordx4 v[52:55], v252, s[8:11], s45 offen offset:1024
v_mfma_f32_32x32x16_bf16 a[160:175], v[208:211], v[208:211], 0
buffer_load_dwordx4 v[84:87], v252, s[8:11], s46 offen offset:1024
buffer_load_dwordx4 v[116:119], v252, s[8:11], s47 offen offset:1024
v_mfma_f32_32x32x16_bf16 a[176:191], v[208:211], v[208:211], 0
buffer_load_dwordx4 v[24:27], v252, s[8:11], s44 offen offset:2048
buffer_load_dwordx4 v[56:59], v252, s[8:11], s45 offen offset:2048
v_mfma_f32_32x32x16_bf16 a[192:207], v[208:211], v[208:211], 0
buffer_load_dwordx4 v[88:91], v252, s[8:11], s46 offen offset:2048
buffer_load_dwordx4 v[120:123], v252, s[8:11], s47 offen offset:2048
v_mfma_f32_32x32x16_bf16 a[208:223], v[208:211], v[208:211], 0
buffer_load_dwordx4 v[28:31], v252, s[8:11], s44 offen offset:3072
buffer_load_dwordx4 v[60:63], v252, s[8:11], s45 offen offset:3072
v_mfma_f32_32x32x16_bf16 a[224:239], v[208:211], v[208:211], 0
buffer_load_dwordx4 v[92:95], v252, s[8:11], s46 offen offset:3072
buffer_load_dwordx4 v[124:127], v252, s[8:11], s47 offen offset:3072
v_mfma_f32_32x32x16_bf16 a[240:255], v[208:211], v[208:211], 0
v_bfe_u32 v248, v252, 4, 3
v_lshlrev_b32 v248, 6, v248
v_bfe_u32 v253, v252, 7, 1
v_lshl_or_b32 v248, v253, 10, v248
v_bfe_u32 v253, v252, 8, 2
v_lshl_or_b32 v248, v253, 4, v248
v_bfe_u32 v253, v252, 6, 1
v_lshlrev_b32 v253, 5, v253
v_xor_b32 v248, v248, v253
v_and_b32 v249, 0x1c0, v252
v_bfe_u32 v253, v252, 9, 1
v_lshl_or_b32 v249, v253, 10, v249
v_bfe_u32 v253, v252, 8, 1
v_lshl_or_b32 v249, v253, 5, v249
v_bfe_u32 v253, v252, 4, 2
v_lshl_or_b32 v249, v253, 3, v249
v_xor_b32 v250, 32, v249
s_waitcnt vmcnt(32)
s_barrier
ds_read_b128 v[224:227], v248 offset:0
ds_read_b128 v[228:231], v248 offset:512
ds_read_b128 v[232:235], v248 offset:2048
ds_read_b128 v[236:239], v248 offset:2560
s_waitcnt lgkmcnt(2)
s_waitcnt vmcnt(24)
v_mfma_f32_16x16x32_bf16 v[160:163], v[224:227], v[0:3], 0
ds_read_b128 v[240:243], v248 offset:16384
v_mfma_f32_16x16x32_bf16 v[160:163], v[228:231], v[4:7], v[160:163]
buffer_load_dwordx4 v251, s[12:15], s28 offen offset:2048 lds
v_mfma_f32_16x16x32_bf16 v[164:167], v[224:227], v[32:35], 0
v_mfma_f32_16x16x32_bf16 v[164:167], v[228:231], v[36:39], v[164:167]
buffer_load_dwordx4 v251, s[12:15], s28 offen offset:3072 lds
v_mfma_f32_16x16x32_bf16 v[168:171], v[224:227], v[64:67], 0
ds_read_b128 v[244:247], v248 offset:16896
v_mfma_f32_16x16x32_bf16 v[168:171], v[228:231], v[68:71], v[168:171]
s_add_u32 s28, s28, 0x4000
s_add_u32 m0, s30, 0x8000
s_nop 0
v_mfma_f32_16x16x32_bf16 v[172:175], v[224:227], v[96:99], 0
v_mfma_f32_16x16x32_bf16 v[172:175], v[228:231], v[100:103], v[172:175]
s_waitcnt lgkmcnt(2)
buffer_load_dwordx4 v251, s[12:15], s28 offen offset:0 lds
v_mfma_f32_16x16x32_bf16 v[176:179], v[232:235], v[0:3], 0
ds_read_b128 v[224:227], v248 offset:4096
v_mfma_f32_16x16x32_bf16 v[176:179], v[236:239], v[4:7], v[176:179]
buffer_load_dwordx4 v251, s[12:15], s28 offen offset:1024 lds
v_mfma_f32_16x16x32_bf16 v[180:183], v[232:235], v[32:35], 0
v_mfma_f32_16x16x32_bf16 v[180:183], v[236:239], v[36:39], v[180:183]
v_mfma_f32_16x16x32_bf16 v[184:187], v[232:235], v[64:67], 0
ds_read_b128 v[228:231], v248 offset:4608
v_mfma_f32_16x16x32_bf16 v[184:187], v[236:239], v[68:71], v[184:187]
v_mfma_f32_16x16x32_bf16 v[188:191], v[232:235], v[96:99], 0
v_mfma_f32_16x16x32_bf16 v[188:191], v[236:239], v[100:103], v[188:191]
s_waitcnt lgkmcnt(2)
v_mfma_f32_16x16x32_bf16 v[192:195], v[240:243], v[0:3], 0
ds_read_b128 v[232:235], v248 offset:6144
v_mfma_f32_16x16x32_bf16 v[192:195], v[244:247], v[4:7], v[192:195]
v_mfma_f32_16x16x32_bf16 v[196:199], v[240:243], v[32:35], 0
v_mfma_f32_16x16x32_bf16 v[196:199], v[244:247], v[36:39], v[196:199]
v_mfma_f32_16x16x32_bf16 v[200:203], v[240:243], v[64:67], 0
ds_read_b128 v[236:239], v248 offset:6656
v_mfma_f32_16x16x32_bf16 v[200:203], v[244:247], v[68:71], v[200:203]
v_mfma_f32_16x16x32_bf16 v[204:207], v[240:243], v[96:99], 0
v_mfma_f32_16x16x32_bf16 v[204:207], v[244:247], v[100:103], v[204:207]
s_waitcnt lgkmcnt(2)
s_waitcnt vmcnt(20)
v_mfma_f32_16x16x32_bf16 v[160:163], v[224:227], v[8:11], v[160:163]
ds_read_b128 v[240:243], v248 offset:20480
v_mfma_f32_16x16x32_bf16 v[160:163], v[228:231], v[12:15], v[160:163]
buffer_load_dwordx4 v251, s[12:15], s28 offen offset:2048 lds
v_mfma_f32_16x16x32_bf16 v[164:167], v[224:227], v[40:43], v[164:167]
v_mfma_f32_16x16x32_bf16 v[164:167], v[228:231], v[44:47], v[164:167]
buffer_load_dwordx4 v251, s[12:15], s28 offen offset:3072 lds
v_mfma_f32_16x16x32_bf16 v[168:171], v[224:227], v[72:75], v[168:171]
ds_read_b128 v[244:247], v248 offset:20992
v_mfma_f32_16x16x32_bf16 v[168:171], v[228:231], v[76:79], v[168:171]
s_add_u32 s28, s28, 0x4000
s_add_u32 m0, s30, 0xc000
s_nop 0
v_mfma_f32_16x16x32_bf16 v[172:175], v[224:227], v[104:107], v[172:175]
v_mfma_f32_16x16x32_bf16 v[172:175], v[228:231], v[108:111], v[172:175]
s_waitcnt lgkmcnt(2)
buffer_load_dwordx4 v251, s[12:15], s28 offen offset:0 lds
v_mfma_f32_16x16x32_bf16 v[176:179], v[232:235], v[8:11], v[176:179]
ds_read_b128 v[224:227], v248 offset:8192
v_mfma_f32_16x16x32_bf16 v[176:179], v[236:239], v[12:15], v[176:179]
buffer_load_dwordx4 v251, s[12:15], s28 offen offset:1024 lds
v_mfma_f32_16x16x32_bf16 v[180:183], v[232:235], v[40:43], v[180:183]
v_mfma_f32_16x16x32_bf16 v[180:183], v[236:239], v[44:47], v[180:183]
v_mfma_f32_16x16x32_bf16 v[184:187], v[232:235], v[72:75], v[184:187]
ds_read_b128 v[228:231], v248 offset:8704
v_mfma_f32_16x16x32_bf16 v[184:187], v[236:239], v[76:79], v[184:187]
v_mfma_f32_16x16x32_bf16 v[188:191], v[232:235], v[104:107], v[188:191]
v_mfma_f32_16x16x32_bf16 v[188:191], v[236:239], v[108:111], v[188:191]
s_waitcnt lgkmcnt(2)
v_mfma_f32_16x16x32_bf16 v[192:195], v[240:243], v[8:11], v[192:195]
ds_read_b128 v[232:235], v248 offset:10240
v_mfma_f32_16x16x32_bf16 v[192:195], v[244:247], v[12:15], v[192:195]
v_mfma_f32_16x16x32_bf16 v[196:199], v[240:243], v[40:43], v[196:199]
v_mfma_f32_16x16x32_bf16 v[196:199], v[244:247], v[44:47], v[196:199]
v_mfma_f32_16x16x32_bf16 v[200:203], v[240:243], v[72:75], v[200:203]
ds_read_b128 v[236:239], v248 offset:10752
v_mfma_f32_16x16x32_bf16 v[200:203], v[244:247], v[76:79], v[200:203]
v_mfma_f32_16x16x32_bf16 v[204:207], v[240:243], v[104:107], v[204:207]
v_mfma_f32_16x16x32_bf16 v[204:207], v[244:247], v[108:111], v[204:207]
s_waitcnt lgkmcnt(2)
s_waitcnt vmcnt(16)
v_mfma_f32_16x16x32_bf16 v[160:163], v[224:227], v[16:19], v[160:163]
ds_read_b128 v[240:243], v248 offset:24576
v_mfma_f32_16x16x32_bf16 v[160:163], v[228:231], v[20:23], v[160:163]
buffer_load_dwordx4 v251, s[12:15], s28 offen offset:2048 lds
v_mfma_f32_16x16x32_bf16 v[164:167], v[224:227], v[48:51], v[164:167]
v_mfma_f32_16x16x32_bf16 v[164:167], v[228:231], v[52:55], v[164:167]
buffer_load_dwordx4 v251, s[12:15], s28 offen offset:3072 lds
v_mfma_f32_16x16x32_bf16 v[168:171], v[224:227], v[80:83], v[168:171]
ds_read_b128 v[244:247], v248 offset:25088
v_mfma_f32_16x16x32_bf16 v[168:171], v[228:231], v[84:87], v[168:171]
s_add_u32 s28, s28, 0x4000
s_add_u32 m0, s30, 0x10000
s_nop 0
v_mfma_f32_16x16x32_bf16 v[172:175], v[224:227], v[112:115], v[172:175]
v_mfma_f32_16x16x32_bf16 v[172:175], v[228:231], v[116:119], v[172:175]
s_waitcnt lgkmcnt(2)
buffer_load_dwordx4 v251, s[12:15], s28 offen offset:0 lds
v_mfma_f32_16x16x32_bf16 v[176:179], v[232:235], v[16:19], v[176:179]
ds_read_b128 v[224:227], v248 offset:12288
v_mfma_f32_16x16x32_bf16 v[176:179], v[236:239], v[20:23], v[176:179]
buffer_load_dwordx4 v251, s[12:15], s28 offen offset:1024 lds
v_mfma_f32_16x16x32_bf16 v[180:183], v[232:235], v[48:51], v[180:183]
v_mfma_f32_16x16x32_bf16 v[180:183], v[236:239], v[52:55], v[180:183]
v_mfma_f32_16x16x32_bf16 v[184:187], v[232:235], v[80:83], v[184:187]
ds_read_b128 v[228:231], v248 offset:12800
v_mfma_f32_16x16x32_bf16 v[184:187], v[236:239], v[84:87], v[184:187]
v_mfma_f32_16x16x32_bf16 v[188:191], v[232:235], v[112:115], v[188:191]
v_mfma_f32_16x16x32_bf16 v[188:191], v[236:239], v[116:119], v[188:191]
s_waitcnt lgkmcnt(2)
v_mfma_f32_16x16x32_bf16 v[192:195], v[240:243], v[16:19], v[192:195]
ds_read_b128 v[232:235], v248 offset:14336
v_mfma_f32_16x16x32_bf16 v[192:195], v[244:247], v[20:23], v[192:195]
v_mfma_f32_16x16x32_bf16 v[196:199], v[240:243], v[48:51], v[196:199]
v_mfma_f32_16x16x32_bf16 v[196:199], v[244:247], v[52:55], v[196:199]
v_mfma_f32_16x16x32_bf16 v[200:203], v[240:243], v[80:83], v[200:203]
ds_read_b128 v[236:239], v248 offset:14848
v_mfma_f32_16x16x32_bf16 v[200:203], v[244:247], v[84:87], v[200:203]
v_mfma_f32_16x16x32_bf16 v[204:207], v[240:243], v[112:115], v[204:207]
v_mfma_f32_16x16x32_bf16 v[204:207], v[244:247], v[116:119], v[204:207]
s_waitcnt lgkmcnt(2)
s_waitcnt vmcnt(12)
v_mfma_f32_16x16x32_bf16 v[160:163], v[224:227], v[24:27], v[160:163]
ds_read_b128 v[240:243], v248 offset:28672
v_mfma_f32_16x16x32_bf16 v[160:163], v[228:231], v[28:31], v[160:163]
buffer_load_dwordx4 v251, s[12:15], s28 offen offset:2048 lds
v_mfma_f32_16x16x32_bf16 v[164:167], v[224:227], v[56:59], v[164:167]
v_mfma_f32_16x16x32_bf16 v[164:167], v[228:231], v[60:63], v[164:167]
buffer_load_dwordx4 v251, s[12:15], s28 offen offset:3072 lds
v_mfma_f32_16x16x32_bf16 v[168:171], v[224:227], v[88:91], v[168:171]
ds_read_b128 v[244:247], v248 offset:29184
v_mfma_f32_16x16x32_bf16 v[168:171], v[228:231], v[92:95], v[168:171]
s_add_u32 s28, s28, 0x4000
s_xor_b32 s30, s30, 0x10000
v_mfma_f32_16x16x32_bf16 v[172:175], v[224:227], v[120:123], v[172:175]
v_mfma_f32_16x16x32_bf16 v[172:175], v[228:231], v[124:127], v[172:175]
s_waitcnt lgkmcnt(2)
v_mfma_f32_16x16x32_bf16 v[176:179], v[232:235], v[24:27], v[176:179]
v_mfma_f32_16x16x32_bf16 v[176:179], v[236:239], v[28:31], v[176:179]
v_mfma_f32_16x16x32_bf16 v[180:183], v[232:235], v[56:59], v[180:183]
v_mfma_f32_16x16x32_bf16 v[180:183], v[236:239], v[60:63], v[180:183]
v_mfma_f32_16x16x32_bf16 v[184:187], v[232:235], v[88:91], v[184:187]
v_mfma_f32_16x16x32_bf16 v[184:187], v[236:239], v[92:95], v[184:187]
v_mfma_f32_16x16x32_bf16 v[188:191], v[232:235], v[120:123], v[188:191]
v_mfma_f32_16x16x32_bf16 v[188:191], v[236:239], v[124:127], v[188:191]
s_waitcnt lgkmcnt(0)
v_mfma_f32_16x16x32_bf16 v[192:195], v[240:243], v[24:27], v[192:195]
v_mfma_f32_16x16x32_bf16 v[192:195], v[244:247], v[28:31], v[192:195]
v_mfma_f32_16x16x32_bf16 v[196:199], v[240:243], v[56:59], v[196:199]
v_mfma_f32_16x16x32_bf16 v[196:199], v[244:247], v[60:63], v[196:199]
v_mfma_f32_16x16x32_bf16 v[200:203], v[240:243], v[88:91], v[200:203]
v_mfma_f32_16x16x32_bf16 v[200:203], v[244:247], v[92:95], v[200:203]
v_mfma_f32_16x16x32_bf16 v[204:207], v[240:243], v[120:123], v[204:207]
v_mfma_f32_16x16x32_bf16 v[204:207], v[244:247], v[124:127], v[204:207]
s_nop 3
v_max3_f32 v224, v160, v161, v162
v_max3_f32 v225, v164, v165, v166
v_max3_f32 v226, v168, v169, v170
v_max3_f32 v227, v172, v173, v174
v_max3_f32 v224, v224, v163, v176
v_max3_f32 v225, v225, v167, v180
v_max3_f32 v226, v226, v171, v184
v_max3_f32 v227, v227, v175, v188
v_max3_f32 v224, v224, v177, v178
v_max3_f32 v225, v225, v181, v182
v_max3_f32 v226, v226, v185, v186
v_max3_f32 v227, v227, v189, v190
v_max_f32 v224, v224, v179
v_max_f32 v225, v225, v183
v_max_f32 v226, v226, v187
v_max_f32 v227, v227, v191
v_mov_b32 v228, v224
v_mov_b32 v229, v225
v_mov_b32 v230, v226
v_mov_b32 v231, v227
v_permlane32_swap_b32 v224, v228
v_permlane32_swap_b32 v225, v229
v_permlane32_swap_b32 v226, v230
v_permlane32_swap_b32 v227, v231
v_max_f32 v224, v224, v228
v_max_f32 v225, v225, v229
v_max_f32 v226, v226, v230
v_max_f32 v227, v227, v231
v_mov_b32 v228, v224
v_mov_b32 v229, v225
v_mov_b32 v230, v226
v_mov_b32 v231, v227
v_permlane16_swap_b32 v224, v228
v_permlane16_swap_b32 v225, v229
v_permlane16_swap_b32 v226, v230
v_permlane16_swap_b32 v227, v231
v_max_f32 v224, v224, v228
v_max_f32 v225, v225, v229
v_max_f32 v226, v226, v230
v_max_f32 v227, v227, v231
s_waitcnt vmcnt(8)
s_barrier
ds_read_b128 v[232:235], v248 offset:18432
ds_read_b128 v[236:239], v248 offset:18944
ds_read_b128 v[240:243], v248 offset:22528
ds_read_b128 v[244:247], v248 offset:23040
v_cvt_pk_bf16_f32 v228, -v224, -v224
v_cvt_pk_bf16_f32 v229, -v225, -v225
v_cvt_pk_bf16_f32 v230, -v226, -v226
v_cvt_pk_bf16_f32 v231, -v227, -v227
v_lshlrev_b32 v253, 2, v252
v_lshlrev_b32 v147, 16, v228
v_lshlrev_b32 v151, 16, v229
v_lshlrev_b32 v155, 16, v230
v_lshlrev_b32 v159, 16, v231
s_mov_b64 exec, 0xffff
v_bfi_b32 v0, s32, v228, v0
v_bfi_b32 v32, s32, v229, v32
v_bfi_b32 v64, s32, v230, v64
v_bfi_b32 v96, s32, v231, v96
v_xor_b32 v224, 0x80000000, v147
v_xor_b32 v225, 0x80000000, v151
v_xor_b32 v226, 0x80000000, v155
v_xor_b32 v227, 0x80000000, v159
buffer_store_dword v224, v253, s[24:27], s48 offen offset:0 sc1
buffer_store_dword v225, v253, s[24:27], s48 offen offset:1024 sc1
buffer_store_dword v226, v253, s[24:27], s48 offen offset:2048 sc1
buffer_store_dword v227, v253, s[24:27], s48 offen offset:3072 sc1
s_mov_b64 exec, -1
s_waitcnt lgkmcnt(2)
v_mfma_f32_16x16x32_bf16 v[208:211], v[232:235], v[0:3], 0
ds_read_b128 v[224:227], v248 offset:26624
v_add_f32 v192, v192, v147
v_add_f32 v193, v193, v147
v_add_f32 v194, v194, v147
v_mfma_f32_16x16x32_bf16 v[208:211], v[236:239], v[4:7], v[208:211]
v_add_f32 v195, v195, v147
v_exp_f32 v192, v192
v_mfma_f32_16x16x32_bf16 v[212:215], v[232:235], v[32:35], 0
v_exp_f32 v193, v193
v_exp_f32 v194, v194
v_mfma_f32_16x16x32_bf16 v[212:215], v[236:239], v[36:39], v[212:215]
v_exp_f32 v195, v195
v_add_f32 v196, v196, v151
v_add_f32 v197, v197, v151
v_mfma_f32_16x16x32_bf16 v[216:219], v[232:235], v[64:67], 0
ds_read_b128 v[228:231], v248 offset:27136
v_cvt_pk_bf16_f32 v144, v192, v193
v_cvt_pk_bf16_f32 v145, v194, v195
v_add_f32 v198, v198, v151
v_mfma_f32_16x16x32_bf16 v[216:219], v[236:239], v[68:71], v[216:219]
v_add_f32 v199, v199, v151
v_exp_f32 v196, v196
v_mfma_f32_16x16x32_bf16 v[220:223], v[232:235], v[96:99], 0
v_exp_f32 v197, v197
v_exp_f32 v198, v198
v_mfma_f32_16x16x32_bf16 v[220:223], v[236:239], v[100:103], v[220:223]
s_waitcnt lgkmcnt(2)
v_exp_f32 v199, v199
v_cvt_pk_bf16_f32 v148, v196, v197
v_mfma_f32_16x16x32_bf16 v[208:211], v[240:243], v[8:11], v[208:211]
ds_read_b128 v[232:235], v248 offset:30720
v_cvt_pk_bf16_f32 v149, v198, v199
v_add_f32 v200, v200, v155
v_add_f32 v201, v201, v155
v_mfma_f32_16x16x32_bf16 v[208:211], v[244:247], v[12:15], v[208:211]
v_add_f32 v202, v202, v155
v_add_f32 v203, v203, v155
v_exp_f32 v200, v200
v_mfma_f32_16x16x32_bf16 v[212:215], v[240:243], v[40:43], v[212:215]
v_exp_f32 v201, v201
v_exp_f32 v202, v202
v_mfma_f32_16x16x32_bf16 v[212:215], v[244:247], v[44:47], v[212:215]
v_exp_f32 v203, v203
v_add_f32 v204, v204, v159
v_add_f32 v205, v205, v159
v_mfma_f32_16x16x32_bf16 v[216:219], v[240:243], v[72:75], v[216:219]
ds_read_b128 v[236:239], v248 offset:31232
v_cvt_pk_bf16_f32 v152, v200, v201
v_cvt_pk_bf16_f32 v153, v202, v203
v_add_f32 v206, v206, v159
v_mfma_f32_16x16x32_bf16 v[216:219], v[244:247], v[76:79], v[216:219]
v_add_f32 v207, v207, v159
v_exp_f32 v204, v204
v_mfma_f32_16x16x32_bf16 v[220:223], v[240:243], v[104:107], v[220:223]
v_exp_f32 v205, v205
v_exp_f32 v206, v206
v_mfma_f32_16x16x32_bf16 v[220:223], v[244:247], v[108:111], v[220:223]
s_waitcnt lgkmcnt(2)
v_exp_f32 v207, v207
v_cvt_pk_bf16_f32 v156, v204, v205
v_mfma_f32_16x16x32_bf16 v[208:211], v[224:227], v[16:19], v[208:211]
ds_read_b128 v[240:243], v248 offset:32768
v_cvt_pk_bf16_f32 v157, v206, v207
v_add_f32 v160, v160, v147
v_add_f32 v161, v161, v147
v_mfma_f32_16x16x32_bf16 v[208:211], v[228:231], v[20:23], v[208:211]
v_add_f32 v162, v162, v147
v_add_f32 v163, v163, v147
v_exp_f32 v160, v160
v_mfma_f32_16x16x32_bf16 v[212:215], v[224:227], v[48:51], v[212:215]
v_exp_f32 v161, v161
v_exp_f32 v162, v162
v_mfma_f32_16x16x32_bf16 v[212:215], v[228:231], v[52:55], v[212:215]
v_exp_f32 v163, v163
v_add_f32 v164, v164, v151
v_add_f32 v165, v165, v151
v_mfma_f32_16x16x32_bf16 v[216:219], v[224:227], v[80:83], v[216:219]
ds_read_b128 v[244:247], v248 offset:33280
v_cvt_pk_bf16_f32 v128, v160, v161
v_cvt_pk_bf16_f32 v129, v162, v163
v_add_f32 v166, v166, v151
v_mfma_f32_16x16x32_bf16 v[216:219], v[228:231], v[84:87], v[216:219]
v_add_f32 v167, v167, v151
v_exp_f32 v164, v164
v_mfma_f32_16x16x32_bf16 v[220:223], v[224:227], v[112:115], v[220:223]
v_exp_f32 v165, v165
v_exp_f32 v166, v166
v_mfma_f32_16x16x32_bf16 v[220:223], v[228:231], v[116:119], v[220:223]
s_waitcnt lgkmcnt(2)
v_exp_f32 v167, v167
v_cvt_pk_bf16_f32 v132, v164, v165
v_mfma_f32_16x16x32_bf16 v[208:211], v[232:235], v[24:27], v[208:211]
ds_read_b128 v[224:227], v248 offset:36864
v_cvt_pk_bf16_f32 v133, v166, v167
v_add_f32 v168, v168, v155
v_add_f32 v169, v169, v155
v_mfma_f32_16x16x32_bf16 v[208:211], v[236:239], v[28:31], v[208:211]
v_add_f32 v170, v170, v155
v_add_f32 v171, v171, v155
v_exp_f32 v168, v168
v_mfma_f32_16x16x32_bf16 v[212:215], v[232:235], v[56:59], v[212:215]
v_exp_f32 v169, v169
v_exp_f32 v170, v170
v_mfma_f32_16x16x32_bf16 v[212:215], v[236:239], v[60:63], v[212:215]
v_exp_f32 v171, v171
v_add_f32 v172, v172, v159
v_add_f32 v173, v173, v159
v_mfma_f32_16x16x32_bf16 v[216:219], v[232:235], v[88:91], v[216:219]
ds_read_b128 v[228:231], v248 offset:37376
v_cvt_pk_bf16_f32 v136, v168, v169
v_cvt_pk_bf16_f32 v137, v170, v171
v_add_f32 v174, v174, v159
v_mfma_f32_16x16x32_bf16 v[216:219], v[236:239], v[92:95], v[216:219]
v_add_f32 v175, v175, v159
v_exp_f32 v172, v172
v_mfma_f32_16x16x32_bf16 v[220:223], v[232:235], v[120:123], v[220:223]
v_exp_f32 v173, v173
v_exp_f32 v174, v174
v_mfma_f32_16x16x32_bf16 v[220:223], v[236:239], v[124:127], v[220:223]
s_waitcnt lgkmcnt(2)
v_exp_f32 v175, v175
v_cvt_pk_bf16_f32 v140, v172, v173
v_mfma_f32_16x16x32_bf16 v[192:195], v[240:243], v[0:3], 0
ds_read_b128 v[232:235], v248 offset:40960
v_cvt_pk_bf16_f32 v141, v174, v175
v_add_f32 v176, v176, v147
v_add_f32 v177, v177, v147
v_mfma_f32_16x16x32_bf16 v[192:195], v[244:247], v[4:7], v[192:195]
v_add_f32 v178, v178, v147
v_add_f32 v179, v179, v147
v_exp_f32 v176, v176
v_mfma_f32_16x16x32_bf16 v[196:199], v[240:243], v[32:35], 0
v_exp_f32 v177, v177
v_exp_f32 v178, v178
v_mfma_f32_16x16x32_bf16 v[196:199], v[244:247], v[36:39], v[196:199]
v_exp_f32 v179, v179
v_add_f32 v180, v180, v151
v_add_f32 v181, v181, v151
v_mfma_f32_16x16x32_bf16 v[200:203], v[240:243], v[64:67], 0
ds_read_b128 v[236:239], v248 offset:41472
v_cvt_pk_bf16_f32 v130, v176, v177
v_cvt_pk_bf16_f32 v131, v178, v179
v_add_f32 v182, v182, v151
v_mfma_f32_16x16x32_bf16 v[200:203], v[244:247], v[68:71], v[200:203]
v_add_f32 v183, v183, v151
v_exp_f32 v180, v180
v_mfma_f32_16x16x32_bf16 v[204:207], v[240:243], v[96:99], 0
v_exp_f32 v181, v181
v_exp_f32 v182, v182
v_mfma_f32_16x16x32_bf16 v[204:207], v[244:247], v[100:103], v[204:207]
s_waitcnt lgkmcnt(2)
v_exp_f32 v183, v183
v_cvt_pk_bf16_f32 v134, v180, v181
v_mfma_f32_16x16x32_bf16 v[192:195], v[224:227], v[8:11], v[192:195]
ds_read_b128 v[240:243], v248 offset:45056
v_cvt_pk_bf16_f32 v135, v182, v183
v_add_f32 v184, v184, v155
v_add_f32 v185, v185, v155
v_mfma_f32_16x16x32_bf16 v[192:195], v[228:231], v[12:15], v[192:195]
v_add_f32 v186, v186, v155
v_add_f32 v187, v187, v155
v_exp_f32 v184, v184
v_mfma_f32_16x16x32_bf16 v[196:199], v[224:227], v[40:43], v[196:199]
v_exp_f32 v185, v185
v_exp_f32 v186, v186
v_mfma_f32_16x16x32_bf16 v[196:199], v[228:231], v[44:47], v[196:199]
v_exp_f32 v187, v187
v_add_f32 v188, v188, v159
v_add_f32 v189, v189, v159
v_mfma_f32_16x16x32_bf16 v[200:203], v[224:227], v[72:75], v[200:203]
ds_read_b128 v[244:247], v248 offset:45568
v_cvt_pk_bf16_f32 v138, v184, v185
v_cvt_pk_bf16_f32 v139, v186, v187
v_add_f32 v190, v190, v159
v_mfma_f32_16x16x32_bf16 v[200:203], v[228:231], v[76:79], v[200:203]
v_add_f32 v191, v191, v159
v_exp_f32 v188, v188
v_mfma_f32_16x16x32_bf16 v[204:207], v[224:227], v[104:107], v[204:207]
v_exp_f32 v189, v189
v_exp_f32 v190, v190
v_mfma_f32_16x16x32_bf16 v[204:207], v[228:231], v[108:111], v[204:207]
s_waitcnt lgkmcnt(2)
v_exp_f32 v191, v191
v_cvt_pk_bf16_f32 v142, v188, v189
v_mfma_f32_16x16x32_bf16 v[192:195], v[232:235], v[16:19], v[192:195]
ds_read_b64_tr_b16 v[224:225], v249 offset:0
v_cvt_pk_bf16_f32 v143, v190, v191
v_exp_f32 v208, v208
v_mfma_f32_16x16x32_bf16 v[192:195], v[236:239], v[20:23], v[192:195]
v_exp_f32 v209, v209
v_exp_f32 v210, v210
v_mfma_f32_16x16x32_bf16 v[196:199], v[232:235], v[48:51], v[196:199]
ds_read_b64_tr_b16 v[226:227], v249 offset:2048
v_exp_f32 v211, v211
v_cvt_pk_bf16_f32 v146, v208, v209
v_mfma_f32_16x16x32_bf16 v[196:199], v[236:239], v[52:55], v[196:199]
v_cvt_pk_bf16_f32 v147, v210, v211
v_exp_f32 v212, v212
v_mfma_f32_16x16x32_bf16 v[200:203], v[232:235], v[80:83], v[200:203]
ds_read_b64_tr_b16 v[228:229], v249 offset:16384
v_exp_f32 v213, v213
v_mfma_f32_16x16x32_bf16 v[200:203], v[236:239], v[84:87], v[200:203]
v_exp_f32 v214, v214
v_exp_f32 v215, v215
v_mfma_f32_16x16x32_bf16 v[204:207], v[232:235], v[112:115], v[204:207]
ds_read_b64_tr_b16 v[230:231], v249 offset:18432
v_cvt_pk_bf16_f32 v150, v212, v213
v_cvt_pk_bf16_f32 v151, v214, v215
v_mfma_f32_16x16x32_bf16 v[204:207], v[236:239], v[116:119], v[204:207]
s_waitcnt lgkmcnt(4)
v_exp_f32 v216, v216
v_mfma_f32_16x16x32_bf16 v[192:195], v[240:243], v[24:27], v[192:195]
ds_read_b64_tr_b16 v[232:233], v250 offset:0
v_exp_f32 v217, v217
v_mfma_f32_16x16x32_bf16 v[192:195], v[244:247], v[28:31], v[192:195]
v_exp_f32 v218, v218
v_exp_f32 v219, v219
v_mfma_f32_16x16x32_bf16 v[196:199], v[240:243], v[56:59], v[196:199]
ds_read_b64_tr_b16 v[234:235], v250 offset:2048
v_cvt_pk_bf16_f32 v154, v216, v217
v_cvt_pk_bf16_f32 v155, v218, v219
v_mfma_f32_16x16x32_bf16 v[196:199], v[244:247], v[60:63], v[196:199]
v_exp_f32 v220, v220
v_exp_f32 v221, v221
v_mfma_f32_16x16x32_bf16 v[200:203], v[240:243], v[88:91], v[200:203]
ds_read_b64_tr_b16 v[236:237], v250 offset:16384
v_exp_f32 v222, v222
v_cvt_pk_bf16_f32 v158, v220, v221
v_mfma_f32_16x16x32_bf16 v[200:203], v[244:247], v[92:95], v[200:203]
v_exp_f32 v223, v223
v_mfma_f32_16x16x32_bf16 v[204:207], v[240:243], v[120:123], v[204:207]
ds_read_b64_tr_b16 v[238:239], v250 offset:18432
v_cvt_pk_bf16_f32 v159, v222, v223
v_mfma_f32_16x16x32_bf16 v[204:207], v[244:247], v[124:127], v[204:207]
.p2align 6
L2_loop:
s_waitcnt lgkmcnt(4)
v_mfma_f32_16x16x32_bf16 a[0:3], v[224:227], v[128:131], a[0:3]
ds_read_b64_tr_b16 v[240:241], v249 offset:512
v_mfma_f32_16x16x32_bf16 a[0:3], v[228:231], v[144:147], a[0:3]
v_mfma_f32_16x16x32_bf16 a[4:7], v[224:227], v[132:135], a[4:7]
ds_read_b64_tr_b16 v[242:243], v249 offset:2560
v_mfma_f32_16x16x32_bf16 a[4:7], v[228:231], v[148:151], a[4:7]
v_exp_f32 v192, v192
v_mfma_f32_16x16x32_bf16 a[8:11], v[224:227], v[136:139], a[8:11]
ds_read_b64_tr_b16 v[244:245], v249 offset:16896
v_mfma_f32_16x16x32_bf16 a[8:11], v[228:231], v[152:155], a[8:11]
v_exp_f32 v193, v193
v_mfma_f32_16x16x32_bf16 a[12:15], v[224:227], v[140:143], a[12:15]
ds_read_b64_tr_b16 v[246:247], v249 offset:18944
v_cvt_pk_bf16_f32 v160, v192, v193
v_mfma_f32_16x16x32_bf16 a[12:15], v[228:231], v[156:159], a[12:15]
s_waitcnt lgkmcnt(4)
v_mfma_f32_16x16x32_bf16 a[16:19], v[232:235], v[128:131], a[16:19]
ds_read_b64_tr_b16 v[176:177], v250 offset:512
v_mfma_f32_16x16x32_bf16 a[16:19], v[236:239], v[144:147], a[16:19]
v_exp_f32 v194, v194
v_mfma_f32_16x16x32_bf16 a[20:23], v[232:235], v[132:135], a[20:23]
ds_read_b64_tr_b16 v[178:179], v250 offset:2560
v_mfma_f32_16x16x32_bf16 a[20:23], v[236:239], v[148:151], a[20:23]
v_exp_f32 v195, v195
v_mfma_f32_16x16x32_bf16 a[24:27], v[232:235], v[136:139], a[24:27]
ds_read_b64_tr_b16 v[180:181], v250 offset:16896
v_cvt_pk_bf16_f32 v161, v194, v195
v_mfma_f32_16x16x32_bf16 a[24:27], v[236:239], v[152:155], a[24:27]
v_exp_f32 v196, v196
v_mfma_f32_16x16x32_bf16 a[28:31], v[232:235], v[140:143], a[28:31]
ds_read_b64_tr_b16 v[182:183], v250 offset:18944
v_mfma_f32_16x16x32_bf16 a[28:31], v[236:239], v[156:159], a[28:31]
s_waitcnt lgkmcnt(4)
v_mfma_f32_16x16x32_bf16 a[32:35], v[240:243], v[128:131], a[32:35]
ds_read_b128 v[224:227], v248 offset:34816
v_mfma_f32_16x16x32_bf16 a[32:35], v[244:247], v[144:147], a[32:35]
v_exp_f32 v197, v197
v_mfma_f32_16x16x32_bf16 a[36:39], v[240:243], v[132:135], a[36:39]
v_exp_f32 v198, v198
v_mfma_f32_16x16x32_bf16 a[36:39], v[244:247], v[148:151], a[36:39]
v_exp_f32 v199, v199
v_mfma_f32_16x16x32_bf16 a[40:43], v[240:243], v[136:139], a[40:43]
ds_read_b128 v[228:231], v248 offset:35328
v_cvt_pk_bf16_f32 v164, v196, v197
v_mfma_f32_16x16x32_bf16 a[40:43], v[244:247], v[152:155], a[40:43]
v_cvt_pk_bf16_f32 v165, v198, v199
v_mfma_f32_16x16x32_bf16 a[44:47], v[240:243], v[140:143], a[44:47]
v_exp_f32 v200, v200
v_mfma_f32_16x16x32_bf16 a[44:47], v[244:247], v[156:159], a[44:47]
s_waitcnt lgkmcnt(2)
v_mfma_f32_16x16x32_bf16 a[48:51], v[176:179], v[128:131], a[48:51]
ds_read_b128 v[232:235], v248 offset:38912
v_mfma_f32_16x16x32_bf16 a[48:51], v[180:183], v[144:147], a[48:51]
v_exp_f32 v201, v201
v_mfma_f32_16x16x32_bf16 a[52:55], v[176:179], v[132:135], a[52:55]
v_exp_f32 v202, v202
v_mfma_f32_16x16x32_bf16 a[52:55], v[180:183], v[148:151], a[52:55]
v_exp_f32 v203, v203
v_mfma_f32_16x16x32_bf16 a[56:59], v[176:179], v[136:139], a[56:59]
ds_read_b128 v[236:239], v248 offset:39424
v_cvt_pk_bf16_f32 v168, v200, v201
v_mfma_f32_16x16x32_bf16 a[56:59], v[180:183], v[152:155], a[56:59]
v_cvt_pk_bf16_f32 v169, v202, v203
v_mfma_f32_16x16x32_bf16 a[60:63], v[176:179], v[140:143], a[60:63]
v_exp_f32 v204, v204
v_mfma_f32_16x16x32_bf16 a[60:63], v[180:183], v[156:159], a[60:63]
s_waitcnt lgkmcnt(2)
v_mfma_f32_16x16x32_bf16 v[208:211], v[224:227], v[0:3], 0
ds_read_b128 v[240:243], v248 offset:43008
v_mfma_f32_16x16x32_bf16 v[208:211], v[228:231], v[4:7], v[208:211]
v_exp_f32 v205, v205
v_mfma_f32_16x16x32_bf16 v[212:215], v[224:227], v[32:35], 0
v_exp_f32 v206, v206
v_mfma_f32_16x16x32_bf16 v[212:215], v[228:231], v[36:39], v[212:215]
v_exp_f32 v207, v207
v_mfma_f32_16x16x32_bf16 v[216:219], v[224:227], v[64:67], 0
ds_read_b128 v[244:247], v248 offset:43520
v_cvt_pk_bf16_f32 v172, v204, v205
v_mfma_f32_16x16x32_bf16 v[216:219], v[228:231], v[68:71], v[216:219]
v_cvt_pk_bf16_f32 v173, v206, v207
v_mfma_f32_16x16x32_bf16 v[220:223], v[224:227], v[96:99], 0
v_mfma_f32_16x16x32_bf16 v[220:223], v[228:231], v[100:103], v[220:223]
s_waitcnt lgkmcnt(2)
v_mfma_f32_16x16x32_bf16 v[208:211], v[232:235], v[8:11], v[208:211]
ds_read_b128 v[176:179], v248 offset:47104
v_mfma_f32_16x16x32_bf16 v[208:211], v[236:239], v[12:15], v[208:211]
v_mfma_f32_16x16x32_bf16 v[212:215], v[232:235], v[40:43], v[212:215]
v_mfma_f32_16x16x32_bf16 v[212:215], v[236:239], v[44:47], v[212:215]
v_mfma_f32_16x16x32_bf16 v[216:219], v[232:235], v[72:75], v[216:219]
ds_read_b128 v[180:183], v248 offset:47616
v_mfma_f32_16x16x32_bf16 v[216:219], v[236:239], v[76:79], v[216:219]
v_mfma_f32_16x16x32_bf16 v[220:223], v[232:235], v[104:107], v[220:223]
v_mfma_f32_16x16x32_bf16 v[220:223], v[236:239], v[108:111], v[220:223]
s_waitcnt lgkmcnt(2)
v_mfma_f32_16x16x32_bf16 v[208:211], v[240:243], v[16:19], v[208:211]
ds_read_b64_tr_b16 v[224:225], v249 offset:4096
v_mfma_f32_16x16x32_bf16 v[208:211], v[244:247], v[20:23], v[208:211]
v_mfma_f32_16x16x32_bf16 v[212:215], v[240:243], v[48:51], v[212:215]
ds_read_b64_tr_b16 v[226:227], v249 offset:6144
v_mfma_f32_16x16x32_bf16 v[212:215], v[244:247], v[52:55], v[212:215]
v_mfma_f32_16x16x32_bf16 v[216:219], v[240:243], v[80:83], v[216:219]
ds_read_b64_tr_b16 v[228:229], v249 offset:20480
v_mfma_f32_16x16x32_bf16 v[216:219], v[244:247], v[84:87], v[216:219]
v_mfma_f32_16x16x32_bf16 v[220:223], v[240:243], v[112:115], v[220:223]
ds_read_b64_tr_b16 v[230:231], v249 offset:22528
v_mfma_f32_16x16x32_bf16 v[220:223], v[244:247], v[116:119], v[220:223]
s_waitcnt lgkmcnt(4)
v_mfma_f32_16x16x32_bf16 v[208:211], v[176:179], v[24:27], v[208:211]
ds_read_b64_tr_b16 v[232:233], v250 offset:4096
v_mfma_f32_16x16x32_bf16 v[208:211], v[180:183], v[28:31], v[208:211]
v_mfma_f32_16x16x32_bf16 v[212:215], v[176:179], v[56:59], v[212:215]
ds_read_b64_tr_b16 v[234:235], v250 offset:6144
v_mfma_f32_16x16x32_bf16 v[212:215], v[180:183], v[60:63], v[212:215]
v_mfma_f32_16x16x32_bf16 v[216:219], v[176:179], v[88:91], v[216:219]
ds_read_b64_tr_b16 v[236:237], v250 offset:20480
v_mfma_f32_16x16x32_bf16 v[216:219], v[180:183], v[92:95], v[216:219]
v_mfma_f32_16x16x32_bf16 v[220:223], v[176:179], v[120:123], v[220:223]
ds_read_b64_tr_b16 v[238:239], v250 offset:22528
v_mfma_f32_16x16x32_bf16 v[220:223], v[180:183], v[124:127], v[220:223]
s_waitcnt lgkmcnt(4)
v_mfma_f32_16x16x32_bf16 a[64:67], v[224:227], v[128:131], a[64:67]
ds_read_b64_tr_b16 v[240:241], v249 offset:4608
v_mfma_f32_16x16x32_bf16 a[64:67], v[228:231], v[144:147], a[64:67]
v_mfma_f32_16x16x32_bf16 a[68:71], v[224:227], v[132:135], a[68:71]
ds_read_b64_tr_b16 v[242:243], v249 offset:6656
v_mfma_f32_16x16x32_bf16 a[68:71], v[228:231], v[148:151], a[68:71]
v_exp_f32 v208, v208
v_mfma_f32_16x16x32_bf16 a[72:75], v[224:227], v[136:139], a[72:75]
ds_read_b64_tr_b16 v[244:245], v249 offset:20992
v_mfma_f32_16x16x32_bf16 a[72:75], v[228:231], v[152:155], a[72:75]
v_exp_f32 v209, v209
v_mfma_f32_16x16x32_bf16 a[76:79], v[224:227], v[140:143], a[76:79]
ds_read_b64_tr_b16 v[246:247], v249 offset:23040
v_cvt_pk_bf16_f32 v162, v208, v209
v_mfma_f32_16x16x32_bf16 a[76:79], v[228:231], v[156:159], a[76:79]
s_waitcnt lgkmcnt(4)
s_waitcnt vmcnt(0)
s_barrier
s_add_u32 m0, s30, 0x4000
v_mfma_f32_16x16x32_bf16 a[80:83], v[232:235], v[128:131], a[80:83]
ds_read_b64_tr_b16 v[224:225], v250 offset:4608
v_mfma_f32_16x16x32_bf16 a[80:83], v[236:239], v[144:147], a[80:83]
buffer_load_dwordx4 v251, s[12:15], s28 offen offset:0 lds
v_mfma_f32_16x16x32_bf16 a[84:87], v[232:235], v[132:135], a[84:87]
ds_read_b64_tr_b16 v[226:227], v250 offset:6656
v_mfma_f32_16x16x32_bf16 a[84:87], v[236:239], v[148:151], a[84:87]
v_exp_f32 v210, v210
v_mfma_f32_16x16x32_bf16 a[88:91], v[232:235], v[136:139], a[88:91]
ds_read_b64_tr_b16 v[228:229], v250 offset:20992
v_mfma_f32_16x16x32_bf16 a[88:91], v[236:239], v[152:155], a[88:91]
v_exp_f32 v211, v211
v_mfma_f32_16x16x32_bf16 a[92:95], v[232:235], v[140:143], a[92:95]
ds_read_b64_tr_b16 v[230:231], v250 offset:23040
v_cvt_pk_bf16_f32 v163, v210, v211
v_mfma_f32_16x16x32_bf16 a[92:95], v[236:239], v[156:159], a[92:95]
s_waitcnt lgkmcnt(4)
v_mfma_f32_16x16x32_bf16 a[96:99], v[240:243], v[128:131], a[96:99]
ds_read_b128 v[232:235], v248 offset:49152
v_mfma_f32_16x16x32_bf16 a[96:99], v[244:247], v[144:147], a[96:99]
buffer_load_dwordx4 v251, s[12:15], s28 offen offset:1024 lds
v_mfma_f32_16x16x32_bf16 a[100:103], v[240:243], v[132:135], a[100:103]
v_exp_f32 v212, v212
v_mfma_f32_16x16x32_bf16 a[100:103], v[244:247], v[148:151], a[100:103]
v_exp_f32 v213, v213
v_mfma_f32_16x16x32_bf16 a[104:107], v[240:243], v[136:139], a[104:107]
ds_read_b128 v[236:239], v248 offset:49664
v_cvt_pk_bf16_f32 v166, v212, v213
v_mfma_f32_16x16x32_bf16 a[104:107], v[244:247], v[152:155], a[104:107]
v_exp_f32 v214, v214
v_mfma_f32_16x16x32_bf16 a[108:111], v[240:243], v[140:143], a[108:111]
v_exp_f32 v215, v215
v_mfma_f32_16x16x32_bf16 a[108:111], v[244:247], v[156:159], a[108:111]
s_waitcnt lgkmcnt(2)
v_cvt_pk_bf16_f32 v167, v214, v215
v_mfma_f32_16x16x32_bf16 a[112:115], v[224:227], v[128:131], a[112:115]
ds_read_b128 v[240:243], v248 offset:53248
v_mfma_f32_16x16x32_bf16 a[112:115], v[228:231], v[144:147], a[112:115]
buffer_load_dwordx4 v251, s[12:15], s28 offen offset:2048 lds
v_mfma_f32_16x16x32_bf16 a[116:119], v[224:227], v[132:135], a[116:119]
v_exp_f32 v216, v216
v_mfma_f32_16x16x32_bf16 a[116:119], v[228:231], v[148:151], a[116:119]
v_exp_f32 v217, v217
v_mfma_f32_16x16x32_bf16 a[120:123], v[224:227], v[136:139], a[120:123]
ds_read_b128 v[244:247], v248 offset:53760
v_cvt_pk_bf16_f32 v170, v216, v217
v_mfma_f32_16x16x32_bf16 a[120:123], v[228:231], v[152:155], a[120:123]
v_exp_f32 v218, v218
v_mfma_f32_16x16x32_bf16 a[124:127], v[224:227], v[140:143], a[124:127]
v_exp_f32 v219, v219
v_mfma_f32_16x16x32_bf16 a[124:127], v[228:231], v[156:159], a[124:127]
s_waitcnt lgkmcnt(2)
v_cvt_pk_bf16_f32 v171, v218, v219
v_mfma_f32_16x16x32_bf16 v[192:195], v[232:235], v[0:3], 0
ds_read_b128 v[224:227], v248 offset:57344
v_mfma_f32_16x16x32_bf16 v[192:195], v[236:239], v[4:7], v[192:195]
buffer_load_dwordx4 v251, s[12:15], s28 offen offset:3072 lds
v_mfma_f32_16x16x32_bf16 v[196:199], v[232:235], v[32:35], 0
v_exp_f32 v220, v220
v_mfma_f32_16x16x32_bf16 v[196:199], v[236:239], v[36:39], v[196:199]
s_add_u32 s28, s28, 0x4000
v_mfma_f32_16x16x32_bf16 v[200:203], v[232:235], v[64:67], 0
ds_read_b128 v[228:231], v248 offset:57856
v_mfma_f32_16x16x32_bf16 v[200:203], v[236:239], v[68:71], v[200:203]
v_exp_f32 v221, v221
v_mfma_f32_16x16x32_bf16 v[204:207], v[232:235], v[96:99], 0
v_exp_f32 v222, v222
v_mfma_f32_16x16x32_bf16 v[204:207], v[236:239], v[100:103], v[204:207]
s_waitcnt lgkmcnt(2)
s_add_u32 m0, s30, 0x8000
v_mfma_f32_16x16x32_bf16 v[192:195], v[240:243], v[8:11], v[192:195]
ds_read_b128 v[232:235], v248 offset:61440
v_cvt_pk_bf16_f32 v174, v220, v221
v_mfma_f32_16x16x32_bf16 v[192:195], v[244:247], v[12:15], v[192:195]
buffer_load_dwordx4 v251, s[12:15], s28 offen offset:0 lds
v_mfma_f32_16x16x32_bf16 v[196:199], v[240:243], v[40:43], v[196:199]
v_exp_f32 v223, v223
v_mfma_f32_16x16x32_bf16 v[196:199], v[244:247], v[44:47], v[196:199]
v_mfma_f32_16x16x32_bf16 v[200:203], v[240:243], v[72:75], v[200:203]
ds_read_b128 v[236:239], v248 offset:61952
v_cvt_pk_bf16_f32 v175, v222, v223
v_mfma_f32_16x16x32_bf16 v[200:203], v[244:247], v[76:79], v[200:203]
v_mfma_f32_16x16x32_bf16 v[204:207], v[240:243], v[104:107], v[204:207]
v_mfma_f32_16x16x32_bf16 v[204:207], v[244:247], v[108:111], v[204:207]
s_waitcnt lgkmcnt(2)
v_mfma_f32_16x16x32_bf16 v[192:195], v[224:227], v[16:19], v[192:195]
ds_read_b64_tr_b16 v[240:241], v249 offset:8192
v_mfma_f32_16x16x32_bf16 v[192:195], v[228:231], v[20:23], v[192:195]
buffer_load_dwordx4 v251, s[12:15], s28 offen offset:1024 lds
v_mfma_f32_16x16x32_bf16 v[196:199], v[224:227], v[48:51], v[196:199]
ds_read_b64_tr_b16 v[242:243], v249 offset:10240
v_mfma_f32_16x16x32_bf16 v[196:199], v[228:231], v[52:55], v[196:199]
v_mfma_f32_16x16x32_bf16 v[200:203], v[224:227], v[80:83], v[200:203]
ds_read_b64_tr_b16 v[244:245], v249 offset:24576
v_mfma_f32_16x16x32_bf16 v[200:203], v[228:231], v[84:87], v[200:203]
v_mfma_f32_16x16x32_bf16 v[204:207], v[224:227], v[112:115], v[204:207]
ds_read_b64_tr_b16 v[246:247], v249 offset:26624
v_mfma_f32_16x16x32_bf16 v[204:207], v[228:231], v[116:119], v[204:207]
s_waitcnt lgkmcnt(4)
v_mfma_f32_16x16x32_bf16 v[192:195], v[232:235], v[24:27], v[192:195]
ds_read_b64_tr_b16 v[224:225], v250 offset:8192
v_mfma_f32_16x16x32_bf16 v[192:195], v[236:239], v[28:31], v[192:195]
buffer_load_dwordx4 v251, s[12:15], s28 offen offset:2048 lds
v_mfma_f32_16x16x32_bf16 v[196:199], v[232:235], v[56:59], v[196:199]
ds_read_b64_tr_b16 v[226:227], v250 offset:10240
v_mfma_f32_16x16x32_bf16 v[196:199], v[236:239], v[60:63], v[196:199]
v_mfma_f32_16x16x32_bf16 v[200:203], v[232:235], v[88:91], v[200:203]
ds_read_b64_tr_b16 v[228:229], v250 offset:24576
v_mfma_f32_16x16x32_bf16 v[200:203], v[236:239], v[92:95], v[200:203]
v_mfma_f32_16x16x32_bf16 v[204:207], v[232:235], v[120:123], v[204:207]
ds_read_b64_tr_b16 v[230:231], v250 offset:26624
v_mfma_f32_16x16x32_bf16 v[204:207], v[236:239], v[124:127], v[204:207]
s_waitcnt lgkmcnt(4)
v_mfma_f32_16x16x32_bf16 a[128:131], v[240:243], v[128:131], a[128:131]
ds_read_b64_tr_b16 v[232:233], v249 offset:8704
v_mfma_f32_16x16x32_bf16 a[128:131], v[244:247], v[144:147], a[128:131]
buffer_load_dwordx4 v251, s[12:15], s28 offen offset:3072 lds
v_mfma_f32_16x16x32_bf16 a[132:135], v[240:243], v[132:135], a[132:135]
ds_read_b64_tr_b16 v[234:235], v249 offset:10752
v_mfma_f32_16x16x32_bf16 a[132:135], v[244:247], v[148:151], a[132:135]
s_add_u32 s28, s28, 0x4000
v_mfma_f32_16x16x32_bf16 a[136:139], v[240:243], v[136:139], a[136:139]
ds_read_b64_tr_b16 v[236:237], v249 offset:25088
v_mfma_f32_16x16x32_bf16 a[136:139], v[244:247], v[152:155], a[136:139]
v_exp_f32 v192, v192
v_mfma_f32_16x16x32_bf16 a[140:143], v[240:243], v[140:143], a[140:143]
ds_read_b64_tr_b16 v[238:239], v249 offset:27136
v_mfma_f32_16x16x32_bf16 a[140:143], v[244:247], v[156:159], a[140:143]
s_waitcnt lgkmcnt(4)
v_mfma_f32_16x16x32_bf16 a[144:147], v[224:227], v[128:131], a[144:147]
ds_read_b64_tr_b16 v[240:241], v250 offset:8704
v_mfma_f32_16x16x32_bf16 a[144:147], v[228:231], v[144:147], a[144:147]
v_exp_f32 v193, v193
v_mfma_f32_16x16x32_bf16 a[148:151], v[224:227], v[132:135], a[148:151]
ds_read_b64_tr_b16 v[242:243], v250 offset:10752
v_cvt_pk_bf16_f32 v176, v192, v193
v_mfma_f32_16x16x32_bf16 a[148:151], v[228:231], v[148:151], a[148:151]
v_exp_f32 v194, v194
v_mfma_f32_16x16x32_bf16 a[152:155], v[224:227], v[136:139], a[152:155]
ds_read_b64_tr_b16 v[244:245], v250 offset:25088
v_mfma_f32_16x16x32_bf16 a[152:155], v[228:231], v[152:155], a[152:155]
v_exp_f32 v195, v195
v_mfma_f32_16x16x32_bf16 a[156:159], v[224:227], v[140:143], a[156:159]
ds_read_b64_tr_b16 v[246:247], v250 offset:27136
v_cvt_pk_bf16_f32 v177, v194, v195
v_mfma_f32_16x16x32_bf16 a[156:159], v[228:231], v[156:159], a[156:159]
s_waitcnt lgkmcnt(4)
v_mfma_f32_16x16x32_bf16 a[160:163], v[232:235], v[128:131], a[160:163]
ds_read_b128 v[224:227], v248 offset:51200
v_mfma_f32_16x16x32_bf16 a[160:163], v[236:239], v[144:147], a[160:163]
v_exp_f32 v196, v196
v_mfma_f32_16x16x32_bf16 a[164:167], v[232:235], v[132:135], a[164:167]
v_exp_f32 v197, v197
v_mfma_f32_16x16x32_bf16 a[164:167], v[236:239], v[148:151], a[164:167]
v_exp_f32 v198, v198
v_mfma_f32_16x16x32_bf16 a[168:171], v[232:235], v[136:139], a[168:171]
ds_read_b128 v[228:231], v248 offset:51712
v_cvt_pk_bf16_f32 v180, v196, v197
v_mfma_f32_16x16x32_bf16 a[168:171], v[236:239], v[152:155], a[168:171]
v_exp_f32 v199, v199
v_mfma_f32_16x16x32_bf16 a[172:175], v[232:235], v[140:143], a[172:175]
v_exp_f32 v200, v200
v_mfma_f32_16x16x32_bf16 a[172:175], v[236:239], v[156:159], a[172:175]
s_waitcnt lgkmcnt(2)
v_cvt_pk_bf16_f32 v181, v198, v199
v_mfma_f32_16x16x32_bf16 a[176:179], v[240:243], v[128:131], a[176:179]
ds_read_b128 v[232:235], v248 offset:55296
v_mfma_f32_16x16x32_bf16 a[176:179], v[244:247], v[144:147], a[176:179]
v_exp_f32 v201, v201
v_mfma_f32_16x16x32_bf16 a[180:183], v[240:243], v[132:135], a[180:183]
v_exp_f32 v202, v202
v_mfma_f32_16x16x32_bf16 a[180:183], v[244:247], v[148:151], a[180:183]
v_exp_f32 v203, v203
v_mfma_f32_16x16x32_bf16 a[184:187], v[240:243], v[136:139], a[184:187]
ds_read_b128 v[236:239], v248 offset:55808
v_cvt_pk_bf16_f32 v184, v200, v201
v_mfma_f32_16x16x32_bf16 a[184:187], v[244:247], v[152:155], a[184:187]
v_cvt_pk_bf16_f32 v185, v202, v203
v_mfma_f32_16x16x32_bf16 a[188:191], v[240:243], v[140:143], a[188:191]
v_exp_f32 v204, v204
v_mfma_f32_16x16x32_bf16 a[188:191], v[244:247], v[156:159], a[188:191]
s_waitcnt lgkmcnt(2)
v_mfma_f32_16x16x32_bf16 v[208:211], v[224:227], v[0:3], 0
ds_read_b128 v[240:243], v248 offset:59392
v_mfma_f32_16x16x32_bf16 v[208:211], v[228:231], v[4:7], v[208:211]
v_exp_f32 v205, v205
v_mfma_f32_16x16x32_bf16 v[212:215], v[224:227], v[32:35], 0
v_exp_f32 v206, v206
v_mfma_f32_16x16x32_bf16 v[212:215], v[228:231], v[36:39], v[212:215]
v_exp_f32 v207, v207
v_mfma_f32_16x16x32_bf16 v[216:219], v[224:227], v[64:67], 0
ds_read_b128 v[244:247], v248 offset:59904
v_cvt_pk_bf16_f32 v188, v204, v205
v_mfma_f32_16x16x32_bf16 v[216:219], v[228:231], v[68:71], v[216:219]
v_cvt_pk_bf16_f32 v189, v206, v207
v_mfma_f32_16x16x32_bf16 v[220:223], v[224:227], v[96:99], 0
v_mfma_f32_16x16x32_bf16 v[220:223], v[228:231], v[100:103], v[220:223]
s_waitcnt lgkmcnt(2)
v_mfma_f32_16x16x32_bf16 v[208:211], v[232:235], v[8:11], v[208:211]
ds_read_b128 v[224:227], v248 offset:63488
v_mfma_f32_16x16x32_bf16 v[208:211], v[236:239], v[12:15], v[208:211]
v_mfma_f32_16x16x32_bf16 v[212:215], v[232:235], v[40:43], v[212:215]
v_mfma_f32_16x16x32_bf16 v[212:215], v[236:239], v[44:47], v[212:215]
v_mfma_f32_16x16x32_bf16 v[216:219], v[232:235], v[72:75], v[216:219]
ds_read_b128 v[228:231], v248 offset:64000
v_mfma_f32_16x16x32_bf16 v[216:219], v[236:239], v[76:79], v[216:219]
v_mfma_f32_16x16x32_bf16 v[220:223], v[232:235], v[104:107], v[220:223]
v_mfma_f32_16x16x32_bf16 v[220:223], v[236:239], v[108:111], v[220:223]
s_waitcnt lgkmcnt(2)
v_mfma_f32_16x16x32_bf16 v[208:211], v[240:243], v[16:19], v[208:211]
ds_read_b64_tr_b16 v[232:233], v249 offset:12288
v_mfma_f32_16x16x32_bf16 v[208:211], v[244:247], v[20:23], v[208:211]
v_mfma_f32_16x16x32_bf16 v[212:215], v[240:243], v[48:51], v[212:215]
ds_read_b64_tr_b16 v[234:235], v249 offset:14336
v_mfma_f32_16x16x32_bf16 v[212:215], v[244:247], v[52:55], v[212:215]
v_mfma_f32_16x16x32_bf16 v[216:219], v[240:243], v[80:83], v[216:219]
ds_read_b64_tr_b16 v[236:237], v249 offset:28672
v_mfma_f32_16x16x32_bf16 v[216:219], v[244:247], v[84:87], v[216:219]
v_mfma_f32_16x16x32_bf16 v[220:223], v[240:243], v[112:115], v[220:223]
ds_read_b64_tr_b16 v[238:239], v249 offset:30720
v_mfma_f32_16x16x32_bf16 v[220:223], v[244:247], v[116:119], v[220:223]
s_waitcnt lgkmcnt(4)
v_mfma_f32_16x16x32_bf16 v[208:211], v[224:227], v[24:27], v[208:211]
ds_read_b64_tr_b16 v[240:241], v250 offset:12288
v_mfma_f32_16x16x32_bf16 v[208:211], v[228:231], v[28:31], v[208:211]
v_mfma_f32_16x16x32_bf16 v[212:215], v[224:227], v[56:59], v[212:215]
ds_read_b64_tr_b16 v[242:243], v250 offset:14336
v_mfma_f32_16x16x32_bf16 v[212:215], v[228:231], v[60:63], v[212:215]
v_mfma_f32_16x16x32_bf16 v[216:219], v[224:227], v[88:91], v[216:219]
ds_read_b64_tr_b16 v[244:245], v250 offset:28672
v_mfma_f32_16x16x32_bf16 v[216:219], v[228:231], v[92:95], v[216:219]
v_mfma_f32_16x16x32_bf16 v[220:223], v[224:227], v[120:123], v[220:223]
ds_read_b64_tr_b16 v[246:247], v250 offset:30720
v_xor_b32 v248, 0x10000, v248
v_mfma_f32_16x16x32_bf16 v[220:223], v[228:231], v[124:127], v[220:223]
s_waitcnt lgkmcnt(4)
v_mfma_f32_16x16x32_bf16 a[192:195], v[232:235], v[128:131], a[192:195]
ds_read_b64_tr_b16 v[224:225], v249 offset:12800
v_mfma_f32_16x16x32_bf16 a[192:195], v[236:239], v[144:147], a[192:195]
v_mfma_f32_16x16x32_bf16 a[196:199], v[232:235], v[132:135], a[196:199]
ds_read_b64_tr_b16 v[226:227], v249 offset:14848
v_mfma_f32_16x16x32_bf16 a[196:199], v[236:239], v[148:151], a[196:199]
v_exp_f32 v208, v208
v_mfma_f32_16x16x32_bf16 a[200:203], v[232:235], v[136:139], a[200:203]
ds_read_b64_tr_b16 v[228:229], v249 offset:29184
v_mfma_f32_16x16x32_bf16 a[200:203], v[236:239], v[152:155], a[200:203]
v_exp_f32 v209, v209
v_mfma_f32_16x16x32_bf16 a[204:207], v[232:235], v[140:143], a[204:207]
ds_read_b64_tr_b16 v[230:231], v249 offset:31232
v_cvt_pk_bf16_f32 v178, v208, v209
v_mfma_f32_16x16x32_bf16 a[204:207], v[236:239], v[156:159], a[204:207]
s_waitcnt lgkmcnt(4)
v_mfma_f32_16x16x32_bf16 a[208:211], v[240:243], v[128:131], a[208:211]
ds_read_b64_tr_b16 v[232:233], v250 offset:12800
v_mfma_f32_16x16x32_bf16 a[208:211], v[244:247], v[144:147], a[208:211]
v_exp_f32 v210, v210
v_mfma_f32_16x16x32_bf16 a[212:215], v[240:243], v[132:135], a[212:215]
ds_read_b64_tr_b16 v[234:235], v250 offset:14848
v_mfma_f32_16x16x32_bf16 a[212:215], v[244:247], v[148:151], a[212:215]
v_exp_f32 v211, v211
v_mfma_f32_16x16x32_bf16 a[216:219], v[240:243], v[136:139], a[216:219]
ds_read_b64_tr_b16 v[236:237], v250 offset:29184
v_cvt_pk_bf16_f32 v179, v210, v211
v_mfma_f32_16x16x32_bf16 a[216:219], v[244:247], v[152:155], a[216:219]
v_exp_f32 v212, v212
v_mfma_f32_16x16x32_bf16 a[220:223], v[240:243], v[140:143], a[220:223]
ds_read_b64_tr_b16 v[238:239], v250 offset:31232
v_mfma_f32_16x16x32_bf16 a[220:223], v[244:247], v[156:159], a[220:223]
s_waitcnt lgkmcnt(4)
v_mfma_f32_16x16x32_bf16 a[224:227], v[224:227], v[128:131], a[224:227]
ds_read_b128 v[240:243], v248 offset:0
v_mfma_f32_16x16x32_bf16 a[224:227], v[228:231], v[144:147], a[224:227]
v_exp_f32 v213, v213
v_mfma_f32_16x16x32_bf16 a[228:231], v[224:227], v[132:135], a[228:231]
v_exp_f32 v214, v214
v_mfma_f32_16x16x32_bf16 a[228:231], v[228:231], v[148:151], a[228:231]
v_exp_f32 v215, v215
v_mfma_f32_16x16x32_bf16 a[232:235], v[224:227], v[136:139], a[232:235]
ds_read_b128 v[244:247], v248 offset:512
v_cvt_pk_bf16_f32 v182, v212, v213
v_mfma_f32_16x16x32_bf16 a[232:235], v[228:231], v[152:155], a[232:235]
v_cvt_pk_bf16_f32 v183, v214, v215
v_mfma_f32_16x16x32_bf16 a[236:239], v[224:227], v[140:143], a[236:239]
v_exp_f32 v216, v216
v_mfma_f32_16x16x32_bf16 a[236:239], v[228:231], v[156:159], a[236:239]
s_waitcnt lgkmcnt(2)
v_mfma_f32_16x16x32_bf16 a[240:243], v[232:235], v[128:131], a[240:243]
ds_read_b128 v[224:227], v248 offset:4096
v_mfma_f32_16x16x32_bf16 a[240:243], v[236:239], v[144:147], a[240:243]
v_exp_f32 v217, v217
v_mfma_f32_16x16x32_bf16 a[244:247], v[232:235], v[132:135], a[244:247]
v_exp_f32 v218, v218
v_mfma_f32_16x16x32_bf16 a[244:247], v[236:239], v[148:151], a[244:247]
v_exp_f32 v219, v219
v_mfma_f32_16x16x32_bf16 a[248:251], v[232:235], v[136:139], a[248:251]
ds_read_b128 v[228:231], v248 offset:4608
v_cvt_pk_bf16_f32 v186, v216, v217
v_mfma_f32_16x16x32_bf16 a[248:251], v[236:239], v[152:155], a[248:251]
v_cvt_pk_bf16_f32 v187, v218, v219
v_mfma_f32_16x16x32_bf16 a[252:255], v[232:235], v[140:143], a[252:255]
v_exp_f32 v220, v220
v_mfma_f32_16x16x32_bf16 a[252:255], v[236:239], v[156:159], a[252:255]
s_waitcnt lgkmcnt(2)
v_mfma_f32_16x16x32_bf16 v[192:195], v[240:243], v[0:3], 0
ds_read_b128 v[232:235], v248 offset:8192
v_mfma_f32_16x16x32_bf16 v[192:195], v[244:247], v[4:7], v[192:195]
v_exp_f32 v221, v221
v_mfma_f32_16x16x32_bf16 v[196:199], v[240:243], v[32:35], 0
v_exp_f32 v222, v222
v_mfma_f32_16x16x32_bf16 v[196:199], v[244:247], v[36:39], v[196:199]
v_exp_f32 v223, v223
v_mfma_f32_16x16x32_bf16 v[200:203], v[240:243], v[64:67], 0
ds_read_b128 v[236:239], v248 offset:8704
v_cvt_pk_bf16_f32 v190, v220, v221
v_mfma_f32_16x16x32_bf16 v[200:203], v[244:247], v[68:71], v[200:203]
v_cvt_pk_bf16_f32 v191, v222, v223
v_mfma_f32_16x16x32_bf16 v[204:207], v[240:243], v[96:99], 0
v_mfma_f32_16x16x32_bf16 v[204:207], v[244:247], v[100:103], v[204:207]
s_waitcnt lgkmcnt(2)
v_mfma_f32_16x16x32_bf16 v[192:195], v[224:227], v[8:11], v[192:195]
ds_read_b128 v[240:243], v248 offset:12288
v_mfma_f32_16x16x32_bf16 v[192:195], v[228:231], v[12:15], v[192:195]
v_mfma_f32_16x16x32_bf16 v[196:199], v[224:227], v[40:43], v[196:199]
v_mfma_f32_16x16x32_bf16 v[196:199], v[228:231], v[44:47], v[196:199]
v_mfma_f32_16x16x32_bf16 v[200:203], v[224:227], v[72:75], v[200:203]
ds_read_b128 v[244:247], v248 offset:12800
v_mfma_f32_16x16x32_bf16 v[200:203], v[228:231], v[76:79], v[200:203]
v_mfma_f32_16x16x32_bf16 v[204:207], v[224:227], v[104:107], v[204:207]
v_mfma_f32_16x16x32_bf16 v[204:207], v[228:231], v[108:111], v[204:207]
s_waitcnt lgkmcnt(2)
v_mfma_f32_16x16x32_bf16 v[192:195], v[232:235], v[16:19], v[192:195]
ds_read_b64_tr_b16 v[224:225], v249 offset:32768
v_mfma_f32_16x16x32_bf16 v[192:195], v[236:239], v[20:23], v[192:195]
v_mfma_f32_16x16x32_bf16 v[196:199], v[232:235], v[48:51], v[196:199]
ds_read_b64_tr_b16 v[226:227], v249 offset:34816
v_mfma_f32_16x16x32_bf16 v[196:199], v[236:239], v[52:55], v[196:199]
v_mfma_f32_16x16x32_bf16 v[200:203], v[232:235], v[80:83], v[200:203]
ds_read_b64_tr_b16 v[228:229], v249 offset:49152
v_mfma_f32_16x16x32_bf16 v[200:203], v[236:239], v[84:87], v[200:203]
v_mfma_f32_16x16x32_bf16 v[204:207], v[232:235], v[112:115], v[204:207]
ds_read_b64_tr_b16 v[230:231], v249 offset:51200
v_mfma_f32_16x16x32_bf16 v[204:207], v[236:239], v[116:119], v[204:207]
s_waitcnt lgkmcnt(4)
v_mfma_f32_16x16x32_bf16 v[192:195], v[240:243], v[24:27], v[192:195]
ds_read_b64_tr_b16 v[232:233], v250 offset:32768
v_mfma_f32_16x16x32_bf16 v[192:195], v[244:247], v[28:31], v[192:195]
v_mfma_f32_16x16x32_bf16 v[196:199], v[240:243], v[56:59], v[196:199]
ds_read_b64_tr_b16 v[234:235], v250 offset:34816
v_mfma_f32_16x16x32_bf16 v[196:199], v[244:247], v[60:63], v[196:199]
v_mfma_f32_16x16x32_bf16 v[200:203], v[240:243], v[88:91], v[200:203]
ds_read_b64_tr_b16 v[236:237], v250 offset:49152
v_mfma_f32_16x16x32_bf16 v[200:203], v[244:247], v[92:95], v[200:203]
s_sub_u32 s31, s31, 1
v_mfma_f32_16x16x32_bf16 v[204:207], v[240:243], v[120:123], v[204:207]
ds_read_b64_tr_b16 v[238:239], v250 offset:51200
v_mfma_f32_16x16x32_bf16 v[204:207], v[244:247], v[124:127], v[204:207]
s_cbranch_scc1 L2_tail_1
s_waitcnt lgkmcnt(4)
v_mfma_f32_16x16x32_bf16 a[0:3], v[224:227], v[160:163], a[0:3]
ds_read_b64_tr_b16 v[240:241], v249 offset:33280
v_mfma_f32_16x16x32_bf16 a[0:3], v[228:231], v[176:179], a[0:3]
v_mfma_f32_16x16x32_bf16 a[4:7], v[224:227], v[164:167], a[4:7]
ds_read_b64_tr_b16 v[242:243], v249 offset:35328
v_mfma_f32_16x16x32_bf16 a[4:7], v[228:231], v[180:183], a[4:7]
v_exp_f32 v192, v192
v_mfma_f32_16x16x32_bf16 a[8:11], v[224:227], v[168:171], a[8:11]
ds_read_b64_tr_b16 v[244:245], v249 offset:49664
v_mfma_f32_16x16x32_bf16 a[8:11], v[228:231], v[184:187], a[8:11]
v_exp_f32 v193, v193
v_mfma_f32_16x16x32_bf16 a[12:15], v[224:227], v[172:175], a[12:15]
ds_read_b64_tr_b16 v[246:247], v249 offset:51712
v_cvt_pk_bf16_f32 v128, v192, v193
v_mfma_f32_16x16x32_bf16 a[12:15], v[228:231], v[188:191], a[12:15]
s_waitcnt lgkmcnt(4)
v_mfma_f32_16x16x32_bf16 a[16:19], v[232:235], v[160:163], a[16:19]
ds_read_b64_tr_b16 v[144:145], v250 offset:33280
v_mfma_f32_16x16x32_bf16 a[16:19], v[236:239], v[176:179], a[16:19]
v_exp_f32 v194, v194
v_mfma_f32_16x16x32_bf16 a[20:23], v[232:235], v[164:167], a[20:23]
ds_read_b64_tr_b16 v[146:147], v250 offset:35328
v_mfma_f32_16x16x32_bf16 a[20:23], v[236:239], v[180:183], a[20:23]
v_exp_f32 v195, v195
v_mfma_f32_16x16x32_bf16 a[24:27], v[232:235], v[168:171], a[24:27]
ds_read_b64_tr_b16 v[148:149], v250 offset:49664
v_cvt_pk_bf16_f32 v129, v194, v195
v_mfma_f32_16x16x32_bf16 a[24:27], v[236:239], v[184:187], a[24:27]
v_exp_f32 v196, v196
v_mfma_f32_16x16x32_bf16 a[28:31], v[232:235], v[172:175], a[28:31]
ds_read_b64_tr_b16 v[150:151], v250 offset:51712
v_mfma_f32_16x16x32_bf16 a[28:31], v[236:239], v[188:191], a[28:31]
s_waitcnt lgkmcnt(4)
v_mfma_f32_16x16x32_bf16 a[32:35], v[240:243], v[160:163], a[32:35]
ds_read_b128 v[224:227], v248 offset:2048
v_mfma_f32_16x16x32_bf16 a[32:35], v[244:247], v[176:179], a[32:35]
v_exp_f32 v197, v197
v_mfma_f32_16x16x32_bf16 a[36:39], v[240:243], v[164:167], a[36:39]
v_exp_f32 v198, v198
v_mfma_f32_16x16x32_bf16 a[36:39], v[244:247], v[180:183], a[36:39]
v_exp_f32 v199, v199
v_mfma_f32_16x16x32_bf16 a[40:43], v[240:243], v[168:171], a[40:43]
ds_read_b128 v[228:231], v248 offset:2560
v_cvt_pk_bf16_f32 v132, v196, v197
v_mfma_f32_16x16x32_bf16 a[40:43], v[244:247], v[184:187], a[40:43]
v_cvt_pk_bf16_f32 v133, v198, v199
v_mfma_f32_16x16x32_bf16 a[44:47], v[240:243], v[172:175], a[44:47]
v_exp_f32 v200, v200
v_mfma_f32_16x16x32_bf16 a[44:47], v[244:247], v[188:191], a[44:47]
s_waitcnt lgkmcnt(2)
v_mfma_f32_16x16x32_bf16 a[48:51], v[144:147], v[160:163], a[48:51]
ds_read_b128 v[232:235], v248 offset:6144
v_mfma_f32_16x16x32_bf16 a[48:51], v[148:151], v[176:179], a[48:51]
v_exp_f32 v201, v201
v_mfma_f32_16x16x32_bf16 a[52:55], v[144:147], v[164:167], a[52:55]
v_exp_f32 v202, v202
v_mfma_f32_16x16x32_bf16 a[52:55], v[148:151], v[180:183], a[52:55]
v_exp_f32 v203, v203
v_mfma_f32_16x16x32_bf16 a[56:59], v[144:147], v[168:171], a[56:59]
ds_read_b128 v[236:239], v248 offset:6656
v_cvt_pk_bf16_f32 v136, v200, v201
v_mfma_f32_16x16x32_bf16 a[56:59], v[148:151], v[184:187], a[56:59]
v_cvt_pk_bf16_f32 v137, v202, v203
v_mfma_f32_16x16x32_bf16 a[60:63], v[144:147], v[172:175], a[60:63]
v_exp_f32 v204, v204
v_mfma_f32_16x16x32_bf16 a[60:63], v[148:151], v[188:191], a[60:63]
s_waitcnt lgkmcnt(2)
v_mfma_f32_16x16x32_bf16 v[208:211], v[224:227], v[0:3], 0
ds_read_b128 v[240:243], v248 offset:10240
v_mfma_f32_16x16x32_bf16 v[208:211], v[228:231], v[4:7], v[208:211]
v_exp_f32 v205, v205
v_mfma_f32_16x16x32_bf16 v[212:215], v[224:227], v[32:35], 0
v_exp_f32 v206, v206
v_mfma_f32_16x16x32_bf16 v[212:215], v[228:231], v[36:39], v[212:215]
v_exp_f32 v207, v207
v_mfma_f32_16x16x32_bf16 v[216:219], v[224:227], v[64:67], 0
ds_read_b128 v[244:247], v248 offset:10752
v_cvt_pk_bf16_f32 v140, v204, v205
v_mfma_f32_16x16x32_bf16 v[216:219], v[228:231], v[68:71], v[216:219]
v_cvt_pk_bf16_f32 v141, v206, v207
v_mfma_f32_16x16x32_bf16 v[220:223], v[224:227], v[96:99], 0
v_mfma_f32_16x16x32_bf16 v[220:223], v[228:231], v[100:103], v[220:223]
s_waitcnt lgkmcnt(2)
v_mfma_f32_16x16x32_bf16 v[208:211], v[232:235], v[8:11], v[208:211]
ds_read_b128 v[144:147], v248 offset:14336
v_mfma_f32_16x16x32_bf16 v[208:211], v[236:239], v[12:15], v[208:211]
v_mfma_f32_16x16x32_bf16 v[212:215], v[232:235], v[40:43], v[212:215]
v_mfma_f32_16x16x32_bf16 v[212:215], v[236:239], v[44:47], v[212:215]
v_mfma_f32_16x16x32_bf16 v[216:219], v[232:235], v[72:75], v[216:219]
ds_read_b128 v[148:151], v248 offset:14848
v_mfma_f32_16x16x32_bf16 v[216:219], v[236:239], v[76:79], v[216:219]
v_mfma_f32_16x16x32_bf16 v[220:223], v[232:235], v[104:107], v[220:223]
v_mfma_f32_16x16x32_bf16 v[220:223], v[236:239], v[108:111], v[220:223]
s_waitcnt lgkmcnt(2)
v_mfma_f32_16x16x32_bf16 v[208:211], v[240:243], v[16:19], v[208:211]
ds_read_b64_tr_b16 v[224:225], v249 offset:36864
v_mfma_f32_16x16x32_bf16 v[208:211], v[244:247], v[20:23], v[208:211]
v_mfma_f32_16x16x32_bf16 v[212:215], v[240:243], v[48:51], v[212:215]
ds_read_b64_tr_b16 v[226:227], v249 offset:38912
v_mfma_f32_16x16x32_bf16 v[212:215], v[244:247], v[52:55], v[212:215]
v_mfma_f32_16x16x32_bf16 v[216:219], v[240:243], v[80:83], v[216:219]
ds_read_b64_tr_b16 v[228:229], v249 offset:53248
v_mfma_f32_16x16x32_bf16 v[216:219], v[244:247], v[84:87], v[216:219]
v_mfma_f32_16x16x32_bf16 v[220:223], v[240:243], v[112:115], v[220:223]
ds_read_b64_tr_b16 v[230:231], v249 offset:55296
v_mfma_f32_16x16x32_bf16 v[220:223], v[244:247], v[116:119], v[220:223]
s_waitcnt lgkmcnt(4)
v_mfma_f32_16x16x32_bf16 v[208:211], v[144:147], v[24:27], v[208:211]
ds_read_b64_tr_b16 v[232:233], v250 offset:36864
v_mfma_f32_16x16x32_bf16 v[208:211], v[148:151], v[28:31], v[208:211]
v_mfma_f32_16x16x32_bf16 v[212:215], v[144:147], v[56:59], v[212:215]
ds_read_b64_tr_b16 v[234:235], v250 offset:38912
v_mfma_f32_16x16x32_bf16 v[212:215], v[148:151], v[60:63], v[212:215]
v_mfma_f32_16x16x32_bf16 v[216:219], v[144:147], v[88:91], v[216:219]
ds_read_b64_tr_b16 v[236:237], v250 offset:53248
v_mfma_f32_16x16x32_bf16 v[216:219], v[148:151], v[92:95], v[216:219]
v_mfma_f32_16x16x32_bf16 v[220:223], v[144:147], v[120:123], v[220:223]
ds_read_b64_tr_b16 v[238:239], v250 offset:55296
v_mfma_f32_16x16x32_bf16 v[220:223], v[148:151], v[124:127], v[220:223]
s_waitcnt lgkmcnt(4)
v_mfma_f32_16x16x32_bf16 a[64:67], v[224:227], v[160:163], a[64:67]
ds_read_b64_tr_b16 v[240:241], v249 offset:37376
v_mfma_f32_16x16x32_bf16 a[64:67], v[228:231], v[176:179], a[64:67]
v_mfma_f32_16x16x32_bf16 a[68:71], v[224:227], v[164:167], a[68:71]
ds_read_b64_tr_b16 v[242:243], v249 offset:39424
v_mfma_f32_16x16x32_bf16 a[68:71], v[228:231], v[180:183], a[68:71]
v_exp_f32 v208, v208
v_mfma_f32_16x16x32_bf16 a[72:75], v[224:227], v[168:171], a[72:75]
ds_read_b64_tr_b16 v[244:245], v249 offset:53760
v_mfma_f32_16x16x32_bf16 a[72:75], v[228:231], v[184:187], a[72:75]
v_exp_f32 v209, v209
v_mfma_f32_16x16x32_bf16 a[76:79], v[224:227], v[172:175], a[76:79]
ds_read_b64_tr_b16 v[246:247], v249 offset:55808
v_cvt_pk_bf16_f32 v130, v208, v209
v_mfma_f32_16x16x32_bf16 a[76:79], v[228:231], v[188:191], a[76:79]
s_waitcnt lgkmcnt(4)
s_waitcnt vmcnt(0)
s_barrier
s_add_u32 m0, s30, 0xc000
v_mfma_f32_16x16x32_bf16 a[80:83], v[232:235], v[160:163], a[80:83]
ds_read_b64_tr_b16 v[224:225], v250 offset:37376
v_mfma_f32_16x16x32_bf16 a[80:83], v[236:239], v[176:179], a[80:83]
buffer_load_dwordx4 v251, s[12:15], s28 offen offset:0 lds
v_mfma_f32_16x16x32_bf16 a[84:87], v[232:235], v[164:167], a[84:87]
ds_read_b64_tr_b16 v[226:227], v250 offset:39424
v_mfma_f32_16x16x32_bf16 a[84:87], v[236:239], v[180:183], a[84:87]
v_exp_f32 v210, v210
v_mfma_f32_16x16x32_bf16 a[88:91], v[232:235], v[168:171], a[88:91]
ds_read_b64_tr_b16 v[228:229], v250 offset:53760
v_mfma_f32_16x16x32_bf16 a[88:91], v[236:239], v[184:187], a[88:91]
v_exp_f32 v211, v211
v_mfma_f32_16x16x32_bf16 a[92:95], v[232:235], v[172:175], a[92:95]
ds_read_b64_tr_b16 v[230:231], v250 offset:55808
v_cvt_pk_bf16_f32 v131, v210, v211
v_mfma_f32_16x16x32_bf16 a[92:95], v[236:239], v[188:191], a[92:95]
s_waitcnt lgkmcnt(4)
v_mfma_f32_16x16x32_bf16 a[96:99], v[240:243], v[160:163], a[96:99]
ds_read_b128 v[232:235], v248 offset:16384
v_mfma_f32_16x16x32_bf16 a[96:99], v[244:247], v[176:179], a[96:99]
buffer_load_dwordx4 v251, s[12:15], s28 offen offset:1024 lds
v_mfma_f32_16x16x32_bf16 a[100:103], v[240:243], v[164:167], a[100:103]
v_exp_f32 v212, v212
v_mfma_f32_16x16x32_bf16 a[100:103], v[244:247], v[180:183], a[100:103]
v_exp_f32 v213, v213
v_mfma_f32_16x16x32_bf16 a[104:107], v[240:243], v[168:171], a[104:107]
ds_read_b128 v[236:239], v248 offset:16896
v_cvt_pk_bf16_f32 v134, v212, v213
v_mfma_f32_16x16x32_bf16 a[104:107], v[244:247], v[184:187], a[104:107]
v_exp_f32 v214, v214
v_mfma_f32_16x16x32_bf16 a[108:111], v[240:243], v[172:175], a[108:111]
v_exp_f32 v215, v215
v_mfma_f32_16x16x32_bf16 a[108:111], v[244:247], v[188:191], a[108:111]
s_waitcnt lgkmcnt(2)
v_cvt_pk_bf16_f32 v135, v214, v215
v_mfma_f32_16x16x32_bf16 a[112:115], v[224:227], v[160:163], a[112:115]
ds_read_b128 v[240:243], v248 offset:20480
v_mfma_f32_16x16x32_bf16 a[112:115], v[228:231], v[176:179], a[112:115]
buffer_load_dwordx4 v251, s[12:15], s28 offen offset:2048 lds
v_mfma_f32_16x16x32_bf16 a[116:119], v[224:227], v[164:167], a[116:119]
v_exp_f32 v216, v216
v_mfma_f32_16x16x32_bf16 a[116:119], v[228:231], v[180:183], a[116:119]
v_exp_f32 v217, v217
v_mfma_f32_16x16x32_bf16 a[120:123], v[224:227], v[168:171], a[120:123]
ds_read_b128 v[244:247], v248 offset:20992
v_cvt_pk_bf16_f32 v138, v216, v217
v_mfma_f32_16x16x32_bf16 a[120:123], v[228:231], v[184:187], a[120:123]
v_exp_f32 v218, v218
v_mfma_f32_16x16x32_bf16 a[124:127], v[224:227], v[172:175], a[124:127]
v_exp_f32 v219, v219
v_mfma_f32_16x16x32_bf16 a[124:127], v[228:231], v[188:191], a[124:127]
s_waitcnt lgkmcnt(2)
v_cvt_pk_bf16_f32 v139, v218, v219
v_mfma_f32_16x16x32_bf16 v[192:195], v[232:235], v[0:3], 0
ds_read_b128 v[224:227], v248 offset:24576
v_mfma_f32_16x16x32_bf16 v[192:195], v[236:239], v[4:7], v[192:195]
buffer_load_dwordx4 v251, s[12:15], s28 offen offset:3072 lds
v_mfma_f32_16x16x32_bf16 v[196:199], v[232:235], v[32:35], 0
s_xor_b32 s30, s30, 0x10000
v_mfma_f32_16x16x32_bf16 v[196:199], v[236:239], v[36:39], v[196:199]
s_add_u32 s28, s28, 0x4000
v_mfma_f32_16x16x32_bf16 v[200:203], v[232:235], v[64:67], 0
ds_read_b128 v[228:231], v248 offset:25088
v_mfma_f32_16x16x32_bf16 v[200:203], v[236:239], v[68:71], v[200:203]
v_exp_f32 v220, v220
v_mfma_f32_16x16x32_bf16 v[204:207], v[232:235], v[96:99], 0
v_exp_f32 v221, v221
v_mfma_f32_16x16x32_bf16 v[204:207], v[236:239], v[100:103], v[204:207]
s_waitcnt lgkmcnt(2)
s_add_u32 m0, s30, 0x0
v_mfma_f32_16x16x32_bf16 v[192:195], v[240:243], v[8:11], v[192:195]
ds_read_b128 v[232:235], v248 offset:28672
v_cvt_pk_bf16_f32 v142, v220, v221
v_mfma_f32_16x16x32_bf16 v[192:195], v[244:247], v[12:15], v[192:195]
buffer_load_dwordx4 v251, s[12:15], s28 offen offset:0 lds
v_mfma_f32_16x16x32_bf16 v[196:199], v[240:243], v[40:43], v[196:199]
v_exp_f32 v222, v222
v_mfma_f32_16x16x32_bf16 v[196:199], v[244:247], v[44:47], v[196:199]
v_exp_f32 v223, v223
v_mfma_f32_16x16x32_bf16 v[200:203], v[240:243], v[72:75], v[200:203]
ds_read_b128 v[236:239], v248 offset:29184
v_cvt_pk_bf16_f32 v143, v222, v223
v_mfma_f32_16x16x32_bf16 v[200:203], v[244:247], v[76:79], v[200:203]
v_mfma_f32_16x16x32_bf16 v[204:207], v[240:243], v[104:107], v[204:207]
v_mfma_f32_16x16x32_bf16 v[204:207], v[244:247], v[108:111], v[204:207]
s_waitcnt lgkmcnt(2)
v_mfma_f32_16x16x32_bf16 v[192:195], v[224:227], v[16:19], v[192:195]
ds_read_b64_tr_b16 v[240:241], v249 offset:40960
v_mfma_f32_16x16x32_bf16 v[192:195], v[228:231], v[20:23], v[192:195]
buffer_load_dwordx4 v251, s[12:15], s28 offen offset:1024 lds
v_mfma_f32_16x16x32_bf16 v[196:199], v[224:227], v[48:51], v[196:199]
ds_read_b64_tr_b16 v[242:243], v249 offset:43008
v_mfma_f32_16x16x32_bf16 v[196:199], v[228:231], v[52:55], v[196:199]
v_mfma_f32_16x16x32_bf16 v[200:203], v[224:227], v[80:83], v[200:203]
ds_read_b64_tr_b16 v[244:245], v249 offset:57344
v_mfma_f32_16x16x32_bf16 v[200:203], v[228:231], v[84:87], v[200:203]
v_mfma_f32_16x16x32_bf16 v[204:207], v[224:227], v[112:115], v[204:207]
ds_read_b64_tr_b16 v[246:247], v249 offset:59392
v_mfma_f32_16x16x32_bf16 v[204:207], v[228:231], v[116:119], v[204:207]
s_waitcnt lgkmcnt(4)
v_mfma_f32_16x16x32_bf16 v[192:195], v[232:235], v[24:27], v[192:195]
ds_read_b64_tr_b16 v[224:225], v250 offset:40960
v_mfma_f32_16x16x32_bf16 v[192:195], v[236:239], v[28:31], v[192:195]
buffer_load_dwordx4 v251, s[12:15], s28 offen offset:2048 lds
v_mfma_f32_16x16x32_bf16 v[196:199], v[232:235], v[56:59], v[196:199]
ds_read_b64_tr_b16 v[226:227], v250 offset:43008
v_mfma_f32_16x16x32_bf16 v[196:199], v[236:239], v[60:63], v[196:199]
v_mfma_f32_16x16x32_bf16 v[200:203], v[232:235], v[88:91], v[200:203]
ds_read_b64_tr_b16 v[228:229], v250 offset:57344
v_mfma_f32_16x16x32_bf16 v[200:203], v[236:239], v[92:95], v[200:203]
v_mfma_f32_16x16x32_bf16 v[204:207], v[232:235], v[120:123], v[204:207]
ds_read_b64_tr_b16 v[230:231], v250 offset:59392
v_mfma_f32_16x16x32_bf16 v[204:207], v[236:239], v[124:127], v[204:207]
s_waitcnt lgkmcnt(4)
v_mfma_f32_16x16x32_bf16 a[128:131], v[240:243], v[160:163], a[128:131]
ds_read_b64_tr_b16 v[232:233], v249 offset:41472
v_mfma_f32_16x16x32_bf16 a[128:131], v[244:247], v[176:179], a[128:131]
buffer_load_dwordx4 v251, s[12:15], s28 offen offset:3072 lds
v_mfma_f32_16x16x32_bf16 a[132:135], v[240:243], v[164:167], a[132:135]
ds_read_b64_tr_b16 v[234:235], v249 offset:43520
v_mfma_f32_16x16x32_bf16 a[132:135], v[244:247], v[180:183], a[132:135]
s_add_u32 s28, s28, 0x4000
v_mfma_f32_16x16x32_bf16 a[136:139], v[240:243], v[168:171], a[136:139]
ds_read_b64_tr_b16 v[236:237], v249 offset:57856
v_mfma_f32_16x16x32_bf16 a[136:139], v[244:247], v[184:187], a[136:139]
v_exp_f32 v192, v192
v_mfma_f32_16x16x32_bf16 a[140:143], v[240:243], v[172:175], a[140:143]
ds_read_b64_tr_b16 v[238:239], v249 offset:59904
v_mfma_f32_16x16x32_bf16 a[140:143], v[244:247], v[188:191], a[140:143]
s_waitcnt lgkmcnt(4)
v_mfma_f32_16x16x32_bf16 a[144:147], v[224:227], v[160:163], a[144:147]
ds_read_b64_tr_b16 v[240:241], v250 offset:41472
v_mfma_f32_16x16x32_bf16 a[144:147], v[228:231], v[176:179], a[144:147]
v_exp_f32 v193, v193
v_mfma_f32_16x16x32_bf16 a[148:151], v[224:227], v[164:167], a[148:151]
ds_read_b64_tr_b16 v[242:243], v250 offset:43520
v_cvt_pk_bf16_f32 v144, v192, v193
v_mfma_f32_16x16x32_bf16 a[148:151], v[228:231], v[180:183], a[148:151]
v_exp_f32 v194, v194
v_mfma_f32_16x16x32_bf16 a[152:155], v[224:227], v[168:171], a[152:155]
ds_read_b64_tr_b16 v[244:245], v250 offset:57856
v_mfma_f32_16x16x32_bf16 a[152:155], v[228:231], v[184:187], a[152:155]
v_exp_f32 v195, v195
v_mfma_f32_16x16x32_bf16 a[156:159], v[224:227], v[172:175], a[156:159]
ds_read_b64_tr_b16 v[246:247], v250 offset:59904
v_cvt_pk_bf16_f32 v145, v194, v195
v_mfma_f32_16x16x32_bf16 a[156:159], v[228:231], v[188:191], a[156:159]
s_waitcnt lgkmcnt(4)
v_mfma_f32_16x16x32_bf16 a[160:163], v[232:235], v[160:163], a[160:163]
ds_read_b128 v[224:227], v248 offset:18432
v_mfma_f32_16x16x32_bf16 a[160:163], v[236:239], v[176:179], a[160:163]
v_exp_f32 v196, v196
v_mfma_f32_16x16x32_bf16 a[164:167], v[232:235], v[164:167], a[164:167]
v_exp_f32 v197, v197
v_mfma_f32_16x16x32_bf16 a[164:167], v[236:239], v[180:183], a[164:167]
v_exp_f32 v198, v198
v_mfma_f32_16x16x32_bf16 a[168:171], v[232:235], v[168:171], a[168:171]
ds_read_b128 v[228:231], v248 offset:18944
v_cvt_pk_bf16_f32 v148, v196, v197
v_mfma_f32_16x16x32_bf16 a[168:171], v[236:239], v[184:187], a[168:171]
v_exp_f32 v199, v199
v_mfma_f32_16x16x32_bf16 a[172:175], v[232:235], v[172:175], a[172:175]
v_exp_f32 v200, v200
v_mfma_f32_16x16x32_bf16 a[172:175], v[236:239], v[188:191], a[172:175]
s_waitcnt lgkmcnt(2)
v_cvt_pk_bf16_f32 v149, v198, v199
v_mfma_f32_16x16x32_bf16 a[176:179], v[240:243], v[160:163], a[176:179]
ds_read_b128 v[232:235], v248 offset:22528
v_mfma_f32_16x16x32_bf16 a[176:179], v[244:247], v[176:179], a[176:179]
v_exp_f32 v201, v201
v_mfma_f32_16x16x32_bf16 a[180:183], v[240:243], v[164:167], a[180:183]
v_exp_f32 v202, v202
v_mfma_f32_16x16x32_bf16 a[180:183], v[244:247], v[180:183], a[180:183]
v_exp_f32 v203, v203
v_mfma_f32_16x16x32_bf16 a[184:187], v[240:243], v[168:171], a[184:187]
ds_read_b128 v[236:239], v248 offset:23040
v_cvt_pk_bf16_f32 v152, v200, v201
v_mfma_f32_16x16x32_bf16 a[184:187], v[244:247], v[184:187], a[184:187]
v_cvt_pk_bf16_f32 v153, v202, v203
v_mfma_f32_16x16x32_bf16 a[188:191], v[240:243], v[172:175], a[188:191]
v_exp_f32 v204, v204
v_mfma_f32_16x16x32_bf16 a[188:191], v[244:247], v[188:191], a[188:191]
s_waitcnt lgkmcnt(2)
v_mfma_f32_16x16x32_bf16 v[208:211], v[224:227], v[0:3], 0
ds_read_b128 v[240:243], v248 offset:26624
v_mfma_f32_16x16x32_bf16 v[208:211], v[228:231], v[4:7], v[208:211]
v_exp_f32 v205, v205
v_mfma_f32_16x16x32_bf16 v[212:215], v[224:227], v[32:35], 0
v_exp_f32 v206, v206
v_mfma_f32_16x16x32_bf16 v[212:215], v[228:231], v[36:39], v[212:215]
v_exp_f32 v207, v207
v_mfma_f32_16x16x32_bf16 v[216:219], v[224:227], v[64:67], 0
ds_read_b128 v[244:247], v248 offset:27136
v_cvt_pk_bf16_f32 v156, v204, v205
v_mfma_f32_16x16x32_bf16 v[216:219], v[228:231], v[68:71], v[216:219]
v_cvt_pk_bf16_f32 v157, v206, v207
v_mfma_f32_16x16x32_bf16 v[220:223], v[224:227], v[96:99], 0
v_mfma_f32_16x16x32_bf16 v[220:223], v[228:231], v[100:103], v[220:223]
s_waitcnt lgkmcnt(2)
v_mfma_f32_16x16x32_bf16 v[208:211], v[232:235], v[8:11], v[208:211]
ds_read_b128 v[224:227], v248 offset:30720
v_mfma_f32_16x16x32_bf16 v[208:211], v[236:239], v[12:15], v[208:211]
v_mfma_f32_16x16x32_bf16 v[212:215], v[232:235], v[40:43], v[212:215]
v_mfma_f32_16x16x32_bf16 v[212:215], v[236:239], v[44:47], v[212:215]
v_mfma_f32_16x16x32_bf16 v[216:219], v[232:235], v[72:75], v[216:219]
ds_read_b128 v[228:231], v248 offset:31232
v_mfma_f32_16x16x32_bf16 v[216:219], v[236:239], v[76:79], v[216:219]
v_mfma_f32_16x16x32_bf16 v[220:223], v[232:235], v[104:107], v[220:223]
v_mfma_f32_16x16x32_bf16 v[220:223], v[236:239], v[108:111], v[220:223]
s_waitcnt lgkmcnt(2)
v_mfma_f32_16x16x32_bf16 v[208:211], v[240:243], v[16:19], v[208:211]
ds_read_b64_tr_b16 v[232:233], v249 offset:45056
v_mfma_f32_16x16x32_bf16 v[208:211], v[244:247], v[20:23], v[208:211]
v_mfma_f32_16x16x32_bf16 v[212:215], v[240:243], v[48:51], v[212:215]
ds_read_b64_tr_b16 v[234:235], v249 offset:47104
v_mfma_f32_16x16x32_bf16 v[212:215], v[244:247], v[52:55], v[212:215]
v_mfma_f32_16x16x32_bf16 v[216:219], v[240:243], v[80:83], v[216:219]
ds_read_b64_tr_b16 v[236:237], v249 offset:61440
v_mfma_f32_16x16x32_bf16 v[216:219], v[244:247], v[84:87], v[216:219]
v_mfma_f32_16x16x32_bf16 v[220:223], v[240:243], v[112:115], v[220:223]
ds_read_b64_tr_b16 v[238:239], v249 offset:63488
v_mfma_f32_16x16x32_bf16 v[220:223], v[244:247], v[116:119], v[220:223]
s_waitcnt lgkmcnt(4)
v_mfma_f32_16x16x32_bf16 v[208:211], v[224:227], v[24:27], v[208:211]
ds_read_b64_tr_b16 v[240:241], v250 offset:45056
v_mfma_f32_16x16x32_bf16 v[208:211], v[228:231], v[28:31], v[208:211]
v_mfma_f32_16x16x32_bf16 v[212:215], v[224:227], v[56:59], v[212:215]
ds_read_b64_tr_b16 v[242:243], v250 offset:47104
v_mfma_f32_16x16x32_bf16 v[212:215], v[228:231], v[60:63], v[212:215]
v_mfma_f32_16x16x32_bf16 v[216:219], v[224:227], v[88:91], v[216:219]
ds_read_b64_tr_b16 v[244:245], v250 offset:61440
v_mfma_f32_16x16x32_bf16 v[216:219], v[228:231], v[92:95], v[216:219]
v_mfma_f32_16x16x32_bf16 v[220:223], v[224:227], v[120:123], v[220:223]
ds_read_b64_tr_b16 v[246:247], v250 offset:63488
v_mfma_f32_16x16x32_bf16 v[220:223], v[228:231], v[124:127], v[220:223]
s_waitcnt lgkmcnt(4)
v_mfma_f32_16x16x32_bf16 a[192:195], v[232:235], v[160:163], a[192:195]
ds_read_b64_tr_b16 v[224:225], v249 offset:45568
v_mfma_f32_16x16x32_bf16 a[192:195], v[236:239], v[176:179], a[192:195]
v_mfma_f32_16x16x32_bf16 a[196:199], v[232:235], v[164:167], a[196:199]
ds_read_b64_tr_b16 v[226:227], v249 offset:47616
v_mfma_f32_16x16x32_bf16 a[196:199], v[236:239], v[180:183], a[196:199]
v_exp_f32 v208, v208
v_mfma_f32_16x16x32_bf16 a[200:203], v[232:235], v[168:171], a[200:203]
ds_read_b64_tr_b16 v[228:229], v249 offset:61952
v_mfma_f32_16x16x32_bf16 a[200:203], v[236:239], v[184:187], a[200:203]
v_exp_f32 v209, v209
v_mfma_f32_16x16x32_bf16 a[204:207], v[232:235], v[172:175], a[204:207]
ds_read_b64_tr_b16 v[230:231], v249 offset:64000
v_cvt_pk_bf16_f32 v146, v208, v209
v_mfma_f32_16x16x32_bf16 a[204:207], v[236:239], v[188:191], a[204:207]
s_waitcnt lgkmcnt(4)
v_mfma_f32_16x16x32_bf16 a[208:211], v[240:243], v[160:163], a[208:211]
ds_read_b64_tr_b16 v[232:233], v250 offset:45568
v_mfma_f32_16x16x32_bf16 a[208:211], v[244:247], v[176:179], a[208:211]
v_exp_f32 v210, v210
v_mfma_f32_16x16x32_bf16 a[212:215], v[240:243], v[164:167], a[212:215]
ds_read_b64_tr_b16 v[234:235], v250 offset:47616
v_mfma_f32_16x16x32_bf16 a[212:215], v[244:247], v[180:183], a[212:215]
v_exp_f32 v211, v211
v_mfma_f32_16x16x32_bf16 a[216:219], v[240:243], v[168:171], a[216:219]
ds_read_b64_tr_b16 v[236:237], v250 offset:61952
v_cvt_pk_bf16_f32 v147, v210, v211
v_mfma_f32_16x16x32_bf16 a[216:219], v[244:247], v[184:187], a[216:219]
v_exp_f32 v212, v212
v_mfma_f32_16x16x32_bf16 a[220:223], v[240:243], v[172:175], a[220:223]
ds_read_b64_tr_b16 v[238:239], v250 offset:64000
v_mfma_f32_16x16x32_bf16 a[220:223], v[244:247], v[188:191], a[220:223]
s_waitcnt lgkmcnt(4)
v_mfma_f32_16x16x32_bf16 a[224:227], v[224:227], v[160:163], a[224:227]
ds_read_b128 v[240:243], v248 offset:32768
v_mfma_f32_16x16x32_bf16 a[224:227], v[228:231], v[176:179], a[224:227]
v_exp_f32 v213, v213
v_mfma_f32_16x16x32_bf16 a[228:231], v[224:227], v[164:167], a[228:231]
v_exp_f32 v214, v214
v_mfma_f32_16x16x32_bf16 a[228:231], v[228:231], v[180:183], a[228:231]
v_exp_f32 v215, v215
v_mfma_f32_16x16x32_bf16 a[232:235], v[224:227], v[168:171], a[232:235]
ds_read_b128 v[244:247], v248 offset:33280
v_cvt_pk_bf16_f32 v150, v212, v213
v_mfma_f32_16x16x32_bf16 a[232:235], v[228:231], v[184:187], a[232:235]
v_cvt_pk_bf16_f32 v151, v214, v215
v_mfma_f32_16x16x32_bf16 a[236:239], v[224:227], v[172:175], a[236:239]
v_exp_f32 v216, v216
v_mfma_f32_16x16x32_bf16 a[236:239], v[228:231], v[188:191], a[236:239]
s_waitcnt lgkmcnt(2)
v_mfma_f32_16x16x32_bf16 a[240:243], v[232:235], v[160:163], a[240:243]
ds_read_b128 v[224:227], v248 offset:36864
v_mfma_f32_16x16x32_bf16 a[240:243], v[236:239], v[176:179], a[240:243]
v_exp_f32 v217, v217
v_mfma_f32_16x16x32_bf16 a[244:247], v[232:235], v[164:167], a[244:247]
v_exp_f32 v218, v218
v_mfma_f32_16x16x32_bf16 a[244:247], v[236:239], v[180:183], a[244:247]
v_exp_f32 v219, v219
v_mfma_f32_16x16x32_bf16 a[248:251], v[232:235], v[168:171], a[248:251]
ds_read_b128 v[228:231], v248 offset:37376
v_cvt_pk_bf16_f32 v154, v216, v217
v_mfma_f32_16x16x32_bf16 a[248:251], v[236:239], v[184:187], a[248:251]
v_cvt_pk_bf16_f32 v155, v218, v219
v_mfma_f32_16x16x32_bf16 a[252:255], v[232:235], v[172:175], a[252:255]
v_exp_f32 v220, v220
v_mfma_f32_16x16x32_bf16 a[252:255], v[236:239], v[188:191], a[252:255]
s_waitcnt lgkmcnt(2)
v_mfma_f32_16x16x32_bf16 v[192:195], v[240:243], v[0:3], 0
ds_read_b128 v[232:235], v248 offset:40960
v_mfma_f32_16x16x32_bf16 v[192:195], v[244:247], v[4:7], v[192:195]
v_xor_b32 v249, 0x10000, v249
v_mfma_f32_16x16x32_bf16 v[196:199], v[240:243], v[32:35], 0
v_exp_f32 v221, v221
v_mfma_f32_16x16x32_bf16 v[196:199], v[244:247], v[36:39], v[196:199]
v_xor_b32 v250, 0x10000, v250
v_cvt_pk_bf16_f32 v158, v220, v221
v_mfma_f32_16x16x32_bf16 v[200:203], v[240:243], v[64:67], 0
ds_read_b128 v[236:239], v248 offset:41472
v_mfma_f32_16x16x32_bf16 v[200:203], v[244:247], v[68:71], v[200:203]
v_exp_f32 v222, v222
v_mfma_f32_16x16x32_bf16 v[204:207], v[240:243], v[96:99], 0
v_exp_f32 v223, v223
v_mfma_f32_16x16x32_bf16 v[204:207], v[244:247], v[100:103], v[204:207]
s_waitcnt lgkmcnt(2)
v_cvt_pk_bf16_f32 v159, v222, v223
v_mfma_f32_16x16x32_bf16 v[192:195], v[224:227], v[8:11], v[192:195]
ds_read_b128 v[240:243], v248 offset:45056
v_mfma_f32_16x16x32_bf16 v[192:195], v[228:231], v[12:15], v[192:195]
v_mfma_f32_16x16x32_bf16 v[196:199], v[224:227], v[40:43], v[196:199]
v_mfma_f32_16x16x32_bf16 v[196:199], v[228:231], v[44:47], v[196:199]
v_mfma_f32_16x16x32_bf16 v[200:203], v[224:227], v[72:75], v[200:203]
ds_read_b128 v[244:247], v248 offset:45568
v_mfma_f32_16x16x32_bf16 v[200:203], v[228:231], v[76:79], v[200:203]
v_mfma_f32_16x16x32_bf16 v[204:207], v[224:227], v[104:107], v[204:207]
v_mfma_f32_16x16x32_bf16 v[204:207], v[228:231], v[108:111], v[204:207]
s_waitcnt lgkmcnt(2)
v_mfma_f32_16x16x32_bf16 v[192:195], v[232:235], v[16:19], v[192:195]
ds_read_b64_tr_b16 v[224:225], v249 offset:0
v_mfma_f32_16x16x32_bf16 v[192:195], v[236:239], v[20:23], v[192:195]
v_mfma_f32_16x16x32_bf16 v[196:199], v[232:235], v[48:51], v[196:199]
ds_read_b64_tr_b16 v[226:227], v249 offset:2048
v_mfma_f32_16x16x32_bf16 v[196:199], v[236:239], v[52:55], v[196:199]
v_mfma_f32_16x16x32_bf16 v[200:203], v[232:235], v[80:83], v[200:203]
ds_read_b64_tr_b16 v[228:229], v249 offset:16384
v_mfma_f32_16x16x32_bf16 v[200:203], v[236:239], v[84:87], v[200:203]
v_mfma_f32_16x16x32_bf16 v[204:207], v[232:235], v[112:115], v[204:207]
ds_read_b64_tr_b16 v[230:231], v249 offset:18432
v_mfma_f32_16x16x32_bf16 v[204:207], v[236:239], v[116:119], v[204:207]
s_waitcnt lgkmcnt(4)
v_mfma_f32_16x16x32_bf16 v[192:195], v[240:243], v[24:27], v[192:195]
ds_read_b64_tr_b16 v[232:233], v250 offset:0
v_mfma_f32_16x16x32_bf16 v[192:195], v[244:247], v[28:31], v[192:195]
v_mfma_f32_16x16x32_bf16 v[196:199], v[240:243], v[56:59], v[196:199]
ds_read_b64_tr_b16 v[234:235], v250 offset:2048
v_mfma_f32_16x16x32_bf16 v[196:199], v[244:247], v[60:63], v[196:199]
v_mfma_f32_16x16x32_bf16 v[200:203], v[240:243], v[88:91], v[200:203]
ds_read_b64_tr_b16 v[236:237], v250 offset:16384
v_mfma_f32_16x16x32_bf16 v[200:203], v[244:247], v[92:95], v[200:203]
s_sub_u32 s31, s31, 1
v_mfma_f32_16x16x32_bf16 v[204:207], v[240:243], v[120:123], v[204:207]
ds_read_b64_tr_b16 v[238:239], v250 offset:18432
v_mfma_f32_16x16x32_bf16 v[204:207], v[244:247], v[124:127], v[204:207]
s_cbranch_scc0 L2_loop
L2_tails:
L2_tail_1:
s_cmp_eq_u32 s59, 7
s_cbranch_scc1 L2_tail_1_7
L2_tail_1_6:
s_waitcnt lgkmcnt(4)
v_mfma_f32_16x16x32_bf16 a[0:3], v[224:227], v[160:163], a[0:3]
ds_read_b128 v[240:243], v248 offset:2048
v_mfma_f32_16x16x32_bf16 a[0:3], v[228:231], v[176:179], a[0:3]
s_lshl_b32 s36, s34, 13
v_mfma_f32_16x16x32_bf16 a[4:7], v[224:227], v[164:167], a[4:7]
s_add_u32 s56, s4, 0x1000000
s_addc_u32 s57, s5, 0
v_mfma_f32_16x16x32_bf16 a[4:7], v[228:231], v[180:183], a[4:7]
s_add_u32 s36, s36, 0x20000
s_mov_b32 s58, 0x6c02000
v_mfma_f32_16x16x32_bf16 a[8:11], v[224:227], v[168:171], a[8:11]
ds_read_b128 v[244:247], v248 offset:2560
s_mov_b32 s59, 0x00020000
v_mfma_f32_16x16x32_bf16 a[8:11], v[228:231], v[184:187], a[8:11]
v_add_u32 v255, s36, v252
s_lshr_b32 s35, s2, 1
v_mfma_f32_16x16x32_bf16 a[12:15], v[224:227], v[172:175], a[12:15]
s_and_b32 s35, s35, 28
s_add_u32 s35, s35, s34
v_mfma_f32_16x16x32_bf16 a[12:15], v[228:231], v[188:191], a[12:15]
s_waitcnt lgkmcnt(2)
s_lshl_b32 s35, s35, 13
v_mfma_f32_16x16x32_bf16 a[16:19], v[232:235], v[160:163], a[16:19]
ds_read_b128 v[224:227], v248 offset:6144
v_lshlrev_b32 v253, 3, v252
v_mfma_f32_16x16x32_bf16 a[16:19], v[236:239], v[176:179], a[16:19]
buffer_load_dword v253, v253, s[56:59], s35 offen
ds_write_b128 v255, v[160:163] offset:0
v_mfma_f32_16x16x32_bf16 a[20:23], v[232:235], v[164:167], a[20:23]
v_exp_f32 v192, v192
v_mfma_f32_16x16x32_bf16 a[20:23], v[236:239], v[180:183], a[20:23]
v_exp_f32 v193, v193
v_mfma_f32_16x16x32_bf16 a[24:27], v[232:235], v[168:171], a[24:27]
ds_read_b128 v[228:231], v248 offset:6656
v_cvt_pk_bf16_f32 v128, v192, v193
v_mfma_f32_16x16x32_bf16 a[24:27], v[236:239], v[184:187], a[24:27]
v_exp_f32 v194, v194
v_mfma_f32_16x16x32_bf16 a[28:31], v[232:235], v[172:175], a[28:31]
v_exp_f32 v195, v195
v_mfma_f32_16x16x32_bf16 a[28:31], v[236:239], v[188:191], a[28:31]
s_waitcnt lgkmcnt(3)
v_cvt_pk_bf16_f32 v129, v194, v195
v_mfma_f32_16x16x32_bf16 v[208:211], v[240:243], v[0:3], 0
ds_read_b128 v[232:235], v248 offset:10240
ds_write_b128 v255, v[164:167] offset:1024
v_mfma_f32_16x16x32_bf16 v[208:211], v[244:247], v[4:7], v[208:211]
v_exp_f32 v196, v196
v_mfma_f32_16x16x32_bf16 v[212:215], v[240:243], v[32:35], 0
v_exp_f32 v197, v197
v_mfma_f32_16x16x32_bf16 v[212:215], v[244:247], v[36:39], v[212:215]
v_exp_f32 v198, v198
v_mfma_f32_16x16x32_bf16 v[216:219], v[240:243], v[64:67], 0
ds_read_b128 v[236:239], v248 offset:10752
v_cvt_pk_bf16_f32 v132, v196, v197
v_mfma_f32_16x16x32_bf16 v[216:219], v[244:247], v[68:71], v[216:219]
v_exp_f32 v199, v199
v_mfma_f32_16x16x32_bf16 v[220:223], v[240:243], v[96:99], 0
v_exp_f32 v200, v200
v_mfma_f32_16x16x32_bf16 v[220:223], v[244:247], v[100:103], v[220:223]
s_waitcnt lgkmcnt(3)
v_cvt_pk_bf16_f32 v133, v198, v199
v_mfma_f32_16x16x32_bf16 v[208:211], v[224:227], v[8:11], v[208:211]
ds_read_b128 v[240:243], v248 offset:14336
ds_write_b128 v255, v[168:171] offset:2048
v_mfma_f32_16x16x32_bf16 v[208:211], v[228:231], v[12:15], v[208:211]
v_exp_f32 v201, v201
v_mfma_f32_16x16x32_bf16 v[212:215], v[224:227], v[40:43], v[212:215]
v_exp_f32 v202, v202
v_mfma_f32_16x16x32_bf16 v[212:215], v[228:231], v[44:47], v[212:215]
v_exp_f32 v203, v203
v_mfma_f32_16x16x32_bf16 v[216:219], v[224:227], v[72:75], v[216:219]
ds_read_b128 v[244:247], v248 offset:14848
v_cvt_pk_bf16_f32 v136, v200, v201
v_mfma_f32_16x16x32_bf16 v[216:219], v[228:231], v[76:79], v[216:219]
v_cvt_pk_bf16_f32 v137, v202, v203
ds_write_b128 v255, v[172:175] offset:3072
v_mfma_f32_16x16x32_bf16 v[220:223], v[224:227], v[104:107], v[220:223]
v_exp_f32 v204, v204
v_mfma_f32_16x16x32_bf16 v[220:223], v[228:231], v[108:111], v[220:223]
s_waitcnt lgkmcnt(4)
s_waitcnt vmcnt(1)
s_barrier
v_mfma_f32_16x16x32_bf16 v[208:211], v[232:235], v[16:19], v[208:211]
ds_read_b128 v[224:227], v248 offset:16384
s_add_u32 m0, s30, 0xc000
v_mfma_f32_16x16x32_bf16 v[208:211], v[236:239], v[20:23], v[208:211]
s_and_b32 s100, s30, 0x10000
buffer_load_dwordx4 v251, s[12:15], s28 offen offset:0 lds
v_mfma_f32_16x16x32_bf16 v[212:215], v[232:235], v[48:51], v[212:215]
s_xor_b32 s100, s100, 0x10000
v_mfma_f32_16x16x32_bf16 v[212:215], v[236:239], v[52:55], v[212:215]
v_exp_f32 v205, v205
v_mfma_f32_16x16x32_bf16 v[216:219], v[232:235], v[80:83], v[216:219]
ds_read_b128 v[228:231], v248 offset:16896
v_cvt_pk_bf16_f32 v140, v204, v205
v_mfma_f32_16x16x32_bf16 v[216:219], v[236:239], v[84:87], v[216:219]
v_exp_f32 v206, v206
v_mfma_f32_16x16x32_bf16 v[220:223], v[232:235], v[112:115], v[220:223]
v_exp_f32 v207, v207
v_mfma_f32_16x16x32_bf16 v[220:223], v[236:239], v[116:119], v[220:223]
s_waitcnt lgkmcnt(3)
v_cvt_pk_bf16_f32 v141, v206, v207
v_mfma_f32_16x16x32_bf16 v[208:211], v[240:243], v[24:27], v[208:211]
ds_read_b128 v[232:235], v248 offset:20480
buffer_load_dwordx4 v251, s[12:15], s28 offen offset:1024 lds
v_mfma_f32_16x16x32_bf16 v[208:211], v[244:247], v[28:31], v[208:211]
v_mfma_f32_16x16x32_bf16 v[212:215], v[240:243], v[56:59], v[212:215]
buffer_load_dwordx4 v251, s[12:15], s28 offen offset:2048 lds
v_mfma_f32_16x16x32_bf16 v[212:215], v[244:247], v[60:63], v[212:215]
v_mfma_f32_16x16x32_bf16 v[216:219], v[240:243], v[88:91], v[216:219]
ds_read_b128 v[236:239], v248 offset:20992
buffer_load_dwordx4 v251, s[12:15], s28 offen offset:3072 lds
v_mfma_f32_16x16x32_bf16 v[216:219], v[244:247], v[92:95], v[216:219]
v_mfma_f32_16x16x32_bf16 v[220:223], v[240:243], v[120:123], v[220:223]
s_add_u32 s28, s28, 0x4000
v_mfma_f32_16x16x32_bf16 v[220:223], v[244:247], v[124:127], v[220:223]
s_waitcnt lgkmcnt(2)
v_mfma_f32_16x16x32_bf16 v[192:195], v[224:227], v[0:3], 0
ds_read_b128 v[240:243], v248 offset:24576
v_mfma_f32_16x16x32_bf16 v[192:195], v[228:231], v[4:7], v[192:195]
v_exp_f32 v208, v208
v_mfma_f32_16x16x32_bf16 v[196:199], v[224:227], v[32:35], 0
v_exp_f32 v209, v209
v_mfma_f32_16x16x32_bf16 v[196:199], v[228:231], v[36:39], v[196:199]
v_exp_f32 v210, v210
v_mfma_f32_16x16x32_bf16 v[200:203], v[224:227], v[64:67], 0
ds_read_b128 v[244:247], v248 offset:25088
v_cvt_pk_bf16_f32 v130, v208, v209
v_mfma_f32_16x16x32_bf16 v[200:203], v[228:231], v[68:71], v[200:203]
v_exp_f32 v211, v211
v_mfma_f32_16x16x32_bf16 v[204:207], v[224:227], v[96:99], 0
v_exp_f32 v212, v212
v_mfma_f32_16x16x32_bf16 v[204:207], v[228:231], v[100:103], v[204:207]
s_waitcnt lgkmcnt(2)
v_cvt_pk_bf16_f32 v131, v210, v211
v_mfma_f32_16x16x32_bf16 v[192:195], v[232:235], v[8:11], v[192:195]
ds_read_b128 v[224:227], v248 offset:28672
v_mfma_f32_16x16x32_bf16 v[192:195], v[236:239], v[12:15], v[192:195]
v_exp_f32 v213, v213
v_mfma_f32_16x16x32_bf16 v[196:199], v[232:235], v[40:43], v[196:199]
v_exp_f32 v214, v214
v_mfma_f32_16x16x32_bf16 v[196:199], v[236:239], v[44:47], v[196:199]
v_exp_f32 v215, v215
v_mfma_f32_16x16x32_bf16 v[200:203], v[232:235], v[72:75], v[200:203]
ds_read_b128 v[228:231], v248 offset:29184
v_cvt_pk_bf16_f32 v134, v212, v213
v_mfma_f32_16x16x32_bf16 v[200:203], v[236:239], v[76:79], v[200:203]
v_cvt_pk_bf16_f32 v135, v214, v215
v_mfma_f32_16x16x32_bf16 v[204:207], v[232:235], v[104:107], v[204:207]
v_exp_f32 v216, v216
v_mfma_f32_16x16x32_bf16 v[204:207], v[236:239], v[108:111], v[204:207]
s_waitcnt lgkmcnt(2)
v_mfma_f32_16x16x32_bf16 v[192:195], v[240:243], v[16:19], v[192:195]
ds_read_b128 v[232:235], v248 offset:18432
v_mfma_f32_16x16x32_bf16 v[192:195], v[244:247], v[20:23], v[192:195]
v_exp_f32 v217, v217
v_mfma_f32_16x16x32_bf16 v[196:199], v[240:243], v[48:51], v[196:199]
v_exp_f32 v218, v218
v_mfma_f32_16x16x32_bf16 v[196:199], v[244:247], v[52:55], v[196:199]
v_exp_f32 v219, v219
v_mfma_f32_16x16x32_bf16 v[200:203], v[240:243], v[80:83], v[200:203]
ds_read_b128 v[236:239], v248 offset:18944
v_cvt_pk_bf16_f32 v138, v216, v217
v_mfma_f32_16x16x32_bf16 v[200:203], v[244:247], v[84:87], v[200:203]
v_cvt_pk_bf16_f32 v139, v218, v219
v_mfma_f32_16x16x32_bf16 v[204:207], v[240:243], v[112:115], v[204:207]
v_exp_f32 v220, v220
v_mfma_f32_16x16x32_bf16 v[204:207], v[244:247], v[116:119], v[204:207]
s_waitcnt lgkmcnt(2)
v_mfma_f32_16x16x32_bf16 v[192:195], v[224:227], v[24:27], v[192:195]
ds_read_b128 v[240:243], v248 offset:22528
v_mfma_f32_16x16x32_bf16 v[192:195], v[228:231], v[28:31], v[192:195]
v_exp_f32 v221, v221
v_mfma_f32_16x16x32_bf16 v[196:199], v[224:227], v[56:59], v[196:199]
v_exp_f32 v222, v222
v_mfma_f32_16x16x32_bf16 v[196:199], v[228:231], v[60:63], v[196:199]
v_exp_f32 v223, v223
v_mfma_f32_16x16x32_bf16 v[200:203], v[224:227], v[88:91], v[200:203]
ds_read_b128 v[244:247], v248 offset:23040
v_cvt_pk_bf16_f32 v142, v220, v221
v_mfma_f32_16x16x32_bf16 v[200:203], v[228:231], v[92:95], v[200:203]
v_cvt_pk_bf16_f32 v143, v222, v223
v_mfma_f32_16x16x32_bf16 v[204:207], v[224:227], v[120:123], v[204:207]
v_mfma_f32_16x16x32_bf16 v[204:207], v[228:231], v[124:127], v[204:207]
s_waitcnt lgkmcnt(2)
v_mfma_f32_16x16x32_bf16 v[208:211], v[232:235], v[0:3], 0
ds_read_b128 v[224:227], v248 offset:26624
v_mfma_f32_16x16x32_bf16 v[208:211], v[236:239], v[4:7], v[208:211]
v_exp_f32 v192, v192
v_mfma_f32_16x16x32_bf16 v[212:215], v[232:235], v[32:35], 0
v_exp_f32 v193, v193
v_mfma_f32_16x16x32_bf16 v[212:215], v[236:239], v[36:39], v[212:215]
v_exp_f32 v194, v194
v_mfma_f32_16x16x32_bf16 v[216:219], v[232:235], v[64:67], 0
ds_read_b128 v[228:231], v248 offset:27136
v_cvt_pk_bf16_f32 v144, v192, v193
v_mfma_f32_16x16x32_bf16 v[216:219], v[236:239], v[68:71], v[216:219]
v_exp_f32 v195, v195
v_mfma_f32_16x16x32_bf16 v[220:223], v[232:235], v[96:99], 0
v_exp_f32 v196, v196
v_mfma_f32_16x16x32_bf16 v[220:223], v[236:239], v[100:103], v[220:223]
s_waitcnt lgkmcnt(2)
v_cvt_pk_bf16_f32 v145, v194, v195
v_mfma_f32_16x16x32_bf16 v[208:211], v[240:243], v[8:11], v[208:211]
ds_read_b128 v[232:235], v248 offset:30720
v_mfma_f32_16x16x32_bf16 v[208:211], v[244:247], v[12:15], v[208:211]
v_exp_f32 v197, v197
v_mfma_f32_16x16x32_bf16 v[212:215], v[240:243], v[40:43], v[212:215]
v_exp_f32 v198, v198
v_mfma_f32_16x16x32_bf16 v[212:215], v[244:247], v[44:47], v[212:215]
v_exp_f32 v199, v199
v_mfma_f32_16x16x32_bf16 v[216:219], v[240:243], v[72:75], v[216:219]
ds_read_b128 v[236:239], v248 offset:31232
v_cvt_pk_bf16_f32 v148, v196, v197
v_mfma_f32_16x16x32_bf16 v[216:219], v[244:247], v[76:79], v[216:219]
v_cvt_pk_bf16_f32 v149, v198, v199
v_mfma_f32_16x16x32_bf16 v[220:223], v[240:243], v[104:107], v[220:223]
v_exp_f32 v200, v200
v_mfma_f32_16x16x32_bf16 v[220:223], v[244:247], v[108:111], v[220:223]
s_waitcnt lgkmcnt(2)
v_mfma_f32_16x16x32_bf16 v[208:211], v[224:227], v[16:19], v[208:211]
ds_read_b128 v[240:243], v248 offset:32768
v_mfma_f32_16x16x32_bf16 v[208:211], v[228:231], v[20:23], v[208:211]
v_exp_f32 v201, v201
v_mfma_f32_16x16x32_bf16 v[212:215], v[224:227], v[48:51], v[212:215]
v_exp_f32 v202, v202
v_mfma_f32_16x16x32_bf16 v[212:215], v[228:231], v[52:55], v[212:215]
v_exp_f32 v203, v203
v_mfma_f32_16x16x32_bf16 v[216:219], v[224:227], v[80:83], v[216:219]
ds_read_b128 v[244:247], v248 offset:33280
v_cvt_pk_bf16_f32 v152, v200, v201
v_mfma_f32_16x16x32_bf16 v[216:219], v[228:231], v[84:87], v[216:219]
v_cvt_pk_bf16_f32 v153, v202, v203
v_mfma_f32_16x16x32_bf16 v[220:223], v[224:227], v[112:115], v[220:223]
v_exp_f32 v204, v204
v_mfma_f32_16x16x32_bf16 v[220:223], v[228:231], v[116:119], v[220:223]
s_waitcnt lgkmcnt(2)
v_mfma_f32_16x16x32_bf16 v[208:211], v[232:235], v[24:27], v[208:211]
ds_read_b128 v[224:227], v248 offset:36864
v_mfma_f32_16x16x32_bf16 v[208:211], v[236:239], v[28:31], v[208:211]
v_exp_f32 v205, v205
v_mfma_f32_16x16x32_bf16 v[212:215], v[232:235], v[56:59], v[212:215]
v_exp_f32 v206, v206
v_mfma_f32_16x16x32_bf16 v[212:215], v[236:239], v[60:63], v[212:215]
v_exp_f32 v207, v207
v_mfma_f32_16x16x32_bf16 v[216:219], v[232:235], v[88:91], v[216:219]
ds_read_b128 v[228:231], v248 offset:37376
v_cvt_pk_bf16_f32 v156, v204, v205
v_mfma_f32_16x16x32_bf16 v[216:219], v[236:239], v[92:95], v[216:219]
v_cvt_pk_bf16_f32 v157, v206, v207
v_mfma_f32_16x16x32_bf16 v[220:223], v[232:235], v[120:123], v[220:223]
v_mfma_f32_16x16x32_bf16 v[220:223], v[236:239], v[124:127], v[220:223]
s_waitcnt lgkmcnt(2)
v_mfma_f32_16x16x32_bf16 v[192:195], v[240:243], v[0:3], 0
ds_read_b128 v[232:235], v248 offset:40960
v_mfma_f32_16x16x32_bf16 v[192:195], v[244:247], v[4:7], v[192:195]
v_exp_f32 v208, v208
v_mfma_f32_16x16x32_bf16 v[196:199], v[240:243], v[32:35], 0
v_exp_f32 v209, v209
v_mfma_f32_16x16x32_bf16 v[196:199], v[244:247], v[36:39], v[196:199]
v_exp_f32 v210, v210
v_mfma_f32_16x16x32_bf16 v[200:203], v[240:243], v[64:67], 0
ds_read_b128 v[236:239], v248 offset:41472
v_cvt_pk_bf16_f32 v146, v208, v209
v_mfma_f32_16x16x32_bf16 v[200:203], v[244:247], v[68:71], v[200:203]
v_exp_f32 v211, v211
v_mfma_f32_16x16x32_bf16 v[204:207], v[240:243], v[96:99], 0
v_exp_f32 v212, v212
v_mfma_f32_16x16x32_bf16 v[204:207], v[244:247], v[100:103], v[204:207]
s_waitcnt lgkmcnt(2)
v_cvt_pk_bf16_f32 v147, v210, v211
v_mfma_f32_16x16x32_bf16 v[192:195], v[224:227], v[8:11], v[192:195]
ds_read_b128 v[240:243], v248 offset:45056
v_mfma_f32_16x16x32_bf16 v[192:195], v[228:231], v[12:15], v[192:195]
v_exp_f32 v213, v213
v_mfma_f32_16x16x32_bf16 v[196:199], v[224:227], v[40:43], v[196:199]
v_exp_f32 v214, v214
v_mfma_f32_16x16x32_bf16 v[196:199], v[228:231], v[44:47], v[196:199]
v_exp_f32 v215, v215
v_mfma_f32_16x16x32_bf16 v[200:203], v[224:227], v[72:75], v[200:203]
ds_read_b128 v[244:247], v248 offset:45568
v_cvt_pk_bf16_f32 v150, v212, v213
v_mfma_f32_16x16x32_bf16 v[200:203], v[228:231], v[76:79], v[200:203]
v_cvt_pk_bf16_f32 v151, v214, v215
v_mfma_f32_16x16x32_bf16 v[204:207], v[224:227], v[104:107], v[204:207]
v_exp_f32 v216, v216
v_mfma_f32_16x16x32_bf16 v[204:207], v[228:231], v[108:111], v[204:207]
s_waitcnt lgkmcnt(2)
v_mfma_f32_16x16x32_bf16 v[192:195], v[232:235], v[16:19], v[192:195]
ds_read_b128 v[224:227], v248 offset:34816
v_mfma_f32_16x16x32_bf16 v[192:195], v[236:239], v[20:23], v[192:195]
v_exp_f32 v217, v217
v_mfma_f32_16x16x32_bf16 v[196:199], v[232:235], v[48:51], v[196:199]
v_exp_f32 v218, v218
v_mfma_f32_16x16x32_bf16 v[196:199], v[236:239], v[52:55], v[196:199]
v_exp_f32 v219, v219
v_mfma_f32_16x16x32_bf16 v[200:203], v[232:235], v[80:83], v[200:203]
ds_read_b128 v[228:231], v248 offset:35328
v_cvt_pk_bf16_f32 v154, v216, v217
v_mfma_f32_16x16x32_bf16 v[200:203], v[236:239], v[84:87], v[200:203]
v_cvt_pk_bf16_f32 v155, v218, v219
v_mfma_f32_16x16x32_bf16 v[204:207], v[232:235], v[112:115], v[204:207]
v_exp_f32 v220, v220
v_mfma_f32_16x16x32_bf16 v[204:207], v[236:239], v[116:119], v[204:207]
s_waitcnt lgkmcnt(2)
v_mfma_f32_16x16x32_bf16 v[192:195], v[240:243], v[24:27], v[192:195]
ds_read_b128 v[232:235], v248 offset:38912
v_mfma_f32_16x16x32_bf16 v[192:195], v[244:247], v[28:31], v[192:195]
v_exp_f32 v221, v221
v_mfma_f32_16x16x32_bf16 v[196:199], v[240:243], v[56:59], v[196:199]
v_exp_f32 v222, v222
v_mfma_f32_16x16x32_bf16 v[196:199], v[244:247], v[60:63], v[196:199]
v_exp_f32 v223, v223
v_mfma_f32_16x16x32_bf16 v[200:203], v[240:243], v[88:91], v[200:203]
ds_read_b128 v[236:239], v248 offset:39424
v_cvt_pk_bf16_f32 v158, v220, v221
v_mfma_f32_16x16x32_bf16 v[200:203], v[244:247], v[92:95], v[200:203]
v_cvt_pk_bf16_f32 v159, v222, v223
v_mfma_f32_16x16x32_bf16 v[204:207], v[240:243], v[120:123], v[204:207]
v_mfma_f32_16x16x32_bf16 v[204:207], v[244:247], v[124:127], v[204:207]
s_waitcnt lgkmcnt(2)
v_mfma_f32_16x16x32_bf16 v[208:211], v[224:227], v[0:3], 0
ds_read_b128 v[240:243], v248 offset:43008
v_mfma_f32_16x16x32_bf16 v[208:211], v[228:231], v[4:7], v[208:211]
v_exp_f32 v192, v192
v_mfma_f32_16x16x32_bf16 v[212:215], v[224:227], v[32:35], 0
v_exp_f32 v193, v193
v_mfma_f32_16x16x32_bf16 v[212:215], v[228:231], v[36:39], v[212:215]
v_exp_f32 v194, v194
v_mfma_f32_16x16x32_bf16 v[216:219], v[224:227], v[64:67], 0
ds_read_b128 v[244:247], v248 offset:43520
v_cvt_pk_bf16_f32 v160, v192, v193
v_mfma_f32_16x16x32_bf16 v[216:219], v[228:231], v[68:71], v[216:219]
v_exp_f32 v195, v195
v_mfma_f32_16x16x32_bf16 v[220:223], v[224:227], v[96:99], 0
v_exp_f32 v196, v196
v_mfma_f32_16x16x32_bf16 v[220:223], v[228:231], v[100:103], v[220:223]
s_waitcnt lgkmcnt(2)
v_cvt_pk_bf16_f32 v161, v194, v195
v_mfma_f32_16x16x32_bf16 v[208:211], v[232:235], v[8:11], v[208:211]
ds_read_b128 v[224:227], v248 offset:47104
v_mfma_f32_16x16x32_bf16 v[208:211], v[236:239], v[12:15], v[208:211]
v_exp_f32 v197, v197
v_mfma_f32_16x16x32_bf16 v[212:215], v[232:235], v[40:43], v[212:215]
v_exp_f32 v198, v198
v_mfma_f32_16x16x32_bf16 v[212:215], v[236:239], v[44:47], v[212:215]
v_exp_f32 v199, v199
v_mfma_f32_16x16x32_bf16 v[216:219], v[232:235], v[72:75], v[216:219]
ds_read_b128 v[228:231], v248 offset:47616
v_cvt_pk_bf16_f32 v164, v196, v197
v_mfma_f32_16x16x32_bf16 v[216:219], v[236:239], v[76:79], v[216:219]
v_cvt_pk_bf16_f32 v165, v198, v199
v_mfma_f32_16x16x32_bf16 v[220:223], v[232:235], v[104:107], v[220:223]
v_exp_f32 v200, v200
v_mfma_f32_16x16x32_bf16 v[220:223], v[236:239], v[108:111], v[220:223]
s_waitcnt lgkmcnt(2)
s_waitcnt vmcnt(0)
s_barrier
v_mfma_f32_16x16x32_bf16 v[208:211], v[240:243], v[16:19], v[208:211]
ds_read_b128 v[232:235], v248 offset:49152
s_add_u32 s8, s6, 0x0
s_addc_u32 s9, s7, 0
v_mfma_f32_16x16x32_bf16 v[208:211], v[244:247], v[20:23], v[208:211]
v_exp_f32 v201, v201
s_mov_b32 s10, 0x4e2000
v_mfma_f32_16x16x32_bf16 v[212:215], v[240:243], v[48:51], v[212:215]
v_exp_f32 v202, v202
s_mov_b32 s11, 0x00020000
v_mfma_f32_16x16x32_bf16 v[212:215], v[244:247], v[52:55], v[212:215]
v_exp_f32 v203, v203
s_mul_i32 s35, s37, 3
v_mfma_f32_16x16x32_bf16 v[216:219], v[240:243], v[80:83], v[216:219]
ds_read_b128 v[236:239], v248 offset:49664
v_cvt_pk_bf16_f32 v168, v200, v201
s_lshl_b32 s36, s38, 4
v_mfma_f32_16x16x32_bf16 v[216:219], v[244:247], v[84:87], v[216:219]
v_cvt_pk_bf16_f32 v169, v202, v203
s_add_u32 s35, s35, s36
s_lshl_b32 s35, s35, 13
v_mfma_f32_16x16x32_bf16 v[220:223], v[240:243], v[112:115], v[220:223]
v_exp_f32 v204, v204
s_lshl_b32 s55, s34, 13
v_mfma_f32_16x16x32_bf16 v[220:223], v[244:247], v[116:119], v[220:223]
s_waitcnt lgkmcnt(2)
s_add_u32 s55, s55, 0x21000
s_lshl_b32 s73, s34, 11
v_mfma_f32_16x16x32_bf16 v[208:211], v[224:227], v[24:27], v[208:211]
ds_read_b128 v[240:243], v248 offset:53248
s_add_u32 s73, s73, s100
s_add_u32 s73, s73, 0x6000
v_mfma_f32_16x16x32_bf16 v[208:211], v[228:231], v[28:31], v[208:211]
v_exp_f32 v205, v205
s_lshl_b32 s36, s34, 7
v_mfma_f32_16x16x32_bf16 v[212:215], v[224:227], v[56:59], v[212:215]
v_exp_f32 v206, v206
v_bfe_u32 v253, v252, 4, 3
v_mfma_f32_16x16x32_bf16 v[212:215], v[228:231], v[60:63], v[212:215]
v_exp_f32 v207, v207
v_lshrrev_b32 v254, 7, v252
v_mfma_f32_16x16x32_bf16 v[216:219], v[224:227], v[88:91], v[216:219]
ds_read_b128 v[244:247], v248 offset:53760
v_cvt_pk_bf16_f32 v172, v204, v205
v_xor_b32 v253, v253, v254
v_mfma_f32_16x16x32_bf16 v[216:219], v[228:231], v[92:95], v[216:219]
v_cvt_pk_bf16_f32 v173, v206, v207
v_lshl_add_u32 v254, v254, 9, s36
v_lshl_add_u32 v253, v253, 4, v254
v_mfma_f32_16x16x32_bf16 v[220:223], v[224:227], v[120:123], v[220:223]
s_add_u32 m0, s55, 0
v_mfma_f32_16x16x32_bf16 v[220:223], v[228:231], v[124:127], v[220:223]
s_waitcnt lgkmcnt(2)
buffer_load_dwordx4 v253, s[8:11], s35 offen lds
s_add_u32 s35, s35, 4096
v_mfma_f32_16x16x32_bf16 v[192:195], v[232:235], v[0:3], 0
ds_read_b128 v[224:227], v248 offset:57344
s_add_u32 m0, s55, 1024
v_mfma_f32_16x16x32_bf16 v[192:195], v[236:239], v[4:7], v[192:195]
v_exp_f32 v208, v208
buffer_load_dwordx4 v253, s[8:11], s35 offen lds
v_mfma_f32_16x16x32_bf16 v[196:199], v[232:235], v[32:35], 0
v_exp_f32 v209, v209
s_add_u32 s35, s35, 4096
v_mfma_f32_16x16x32_bf16 v[196:199], v[236:239], v[36:39], v[196:199]
v_exp_f32 v210, v210
s_add_u32 m0, s55, 2048
v_mfma_f32_16x16x32_bf16 v[200:203], v[232:235], v[64:67], 0
ds_read_b128 v[228:231], v248 offset:57856
v_cvt_pk_bf16_f32 v162, v208, v209
buffer_load_dwordx4 v253, s[8:11], s35 offen lds
v_mfma_f32_16x16x32_bf16 v[200:203], v[236:239], v[68:71], v[200:203]
v_exp_f32 v211, v211
s_add_u32 s35, s35, 4096
v_mfma_f32_16x16x32_bf16 v[204:207], v[232:235], v[96:99], 0
v_exp_f32 v212, v212
s_add_u32 m0, s55, 3072
v_mfma_f32_16x16x32_bf16 v[204:207], v[236:239], v[100:103], v[204:207]
s_waitcnt lgkmcnt(2)
v_cvt_pk_bf16_f32 v163, v210, v211
buffer_load_dwordx4 v253, s[8:11], s35 offen lds
v_mfma_f32_16x16x32_bf16 v[192:195], v[240:243], v[8:11], v[192:195]
ds_read_b128 v[232:235], v248 offset:61440
s_add_u32 s35, s35, 4096
s_add_u32 m0, s73, 0
v_mfma_f32_16x16x32_bf16 v[192:195], v[244:247], v[12:15], v[192:195]
v_exp_f32 v213, v213
buffer_load_dwordx4 v253, s[8:11], s35 offen lds
v_mfma_f32_16x16x32_bf16 v[196:199], v[240:243], v[40:43], v[196:199]
v_exp_f32 v214, v214
s_add_u32 s35, s35, 4096
v_mfma_f32_16x16x32_bf16 v[196:199], v[244:247], v[44:47], v[196:199]
v_exp_f32 v215, v215
s_add_u32 m0, s73, 1024
v_mfma_f32_16x16x32_bf16 v[200:203], v[240:243], v[72:75], v[200:203]
ds_read_b128 v[236:239], v248 offset:61952
v_cvt_pk_bf16_f32 v166, v212, v213
buffer_load_dwordx4 v253, s[8:11], s35 offen lds
v_mfma_f32_16x16x32_bf16 v[200:203], v[244:247], v[76:79], v[200:203]
v_cvt_pk_bf16_f32 v167, v214, v215
v_mfma_f32_16x16x32_bf16 v[204:207], v[240:243], v[104:107], v[204:207]
v_exp_f32 v216, v216
v_mfma_f32_16x16x32_bf16 v[204:207], v[244:247], v[108:111], v[204:207]
s_waitcnt lgkmcnt(2)
v_mfma_f32_16x16x32_bf16 v[192:195], v[224:227], v[16:19], v[192:195]
ds_read_b128 v[240:243], v248 offset:51200
v_mfma_f32_16x16x32_bf16 v[192:195], v[228:231], v[20:23], v[192:195]
v_exp_f32 v217, v217
v_mfma_f32_16x16x32_bf16 v[196:199], v[224:227], v[48:51], v[196:199]
v_exp_f32 v218, v218
v_mfma_f32_16x16x32_bf16 v[196:199], v[228:231], v[52:55], v[196:199]
v_exp_f32 v219, v219
v_mfma_f32_16x16x32_bf16 v[200:203], v[224:227], v[80:83], v[200:203]
ds_read_b128 v[244:247], v248 offset:51712
v_cvt_pk_bf16_f32 v170, v216, v217
v_mfma_f32_16x16x32_bf16 v[200:203], v[228:231], v[84:87], v[200:203]
v_cvt_pk_bf16_f32 v171, v218, v219
v_mfma_f32_16x16x32_bf16 v[204:207], v[224:227], v[112:115], v[204:207]
v_exp_f32 v220, v220
v_mfma_f32_16x16x32_bf16 v[204:207], v[228:231], v[116:119], v[204:207]
s_waitcnt lgkmcnt(2)
v_mfma_f32_16x16x32_bf16 v[192:195], v[232:235], v[24:27], v[192:195]
ds_read_b128 v[224:227], v248 offset:55296
v_mfma_f32_16x16x32_bf16 v[192:195], v[236:239], v[28:31], v[192:195]
v_exp_f32 v221, v221
v_mfma_f32_16x16x32_bf16 v[196:199], v[232:235], v[56:59], v[196:199]
v_exp_f32 v222, v222
v_mfma_f32_16x16x32_bf16 v[196:199], v[236:239], v[60:63], v[196:199]
v_exp_f32 v223, v223
v_mfma_f32_16x16x32_bf16 v[200:203], v[232:235], v[88:91], v[200:203]
ds_read_b128 v[228:231], v248 offset:55808
v_cvt_pk_bf16_f32 v174, v220, v221
v_mfma_f32_16x16x32_bf16 v[200:203], v[236:239], v[92:95], v[200:203]
v_cvt_pk_bf16_f32 v175, v222, v223
v_mfma_f32_16x16x32_bf16 v[204:207], v[232:235], v[120:123], v[204:207]
v_mfma_f32_16x16x32_bf16 v[204:207], v[236:239], v[124:127], v[204:207]
s_waitcnt lgkmcnt(2)
v_mfma_f32_16x16x32_bf16 v[208:211], v[240:243], v[0:3], 0
ds_read_b128 v[232:235], v248 offset:59392
v_mfma_f32_16x16x32_bf16 v[208:211], v[244:247], v[4:7], v[208:211]
v_exp_f32 v192, v192
v_mfma_f32_16x16x32_bf16 v[212:215], v[240:243], v[32:35], 0
v_exp_f32 v193, v193
v_mfma_f32_16x16x32_bf16 v[212:215], v[244:247], v[36:39], v[212:215]
v_exp_f32 v194, v194
v_mfma_f32_16x16x32_bf16 v[216:219], v[240:243], v[64:67], 0
ds_read_b128 v[236:239], v248 offset:59904
v_cvt_pk_bf16_f32 v0, v192, v193
v_mfma_f32_16x16x32_bf16 v[216:219], v[244:247], v[68:71], v[216:219]
v_exp_f32 v195, v195
v_mfma_f32_16x16x32_bf16 v[220:223], v[240:243], v[96:99], 0
v_exp_f32 v196, v196
v_mfma_f32_16x16x32_bf16 v[220:223], v[244:247], v[100:103], v[220:223]
s_waitcnt lgkmcnt(2)
v_cvt_pk_bf16_f32 v1, v194, v195
v_mfma_f32_16x16x32_bf16 v[208:211], v[224:227], v[8:11], v[208:211]
ds_read_b128 v[240:243], v248 offset:63488
v_mfma_f32_16x16x32_bf16 v[208:211], v[228:231], v[12:15], v[208:211]
v_exp_f32 v197, v197
v_mfma_f32_16x16x32_bf16 v[212:215], v[224:227], v[40:43], v[212:215]
ds_read_b128 v[4:7], v255 offset:0
ds_read_b128 v[36:39], v255 offset:1024
v_mfma_f32_16x16x32_bf16 v[212:215], v[228:231], v[44:47], v[212:215]
v_exp_f32 v198, v198
v_mfma_f32_16x16x32_bf16 v[216:219], v[224:227], v[72:75], v[216:219]
ds_read_b128 v[244:247], v248 offset:64000
v_xor_b32 v12, 0x10000, v249
v_mfma_f32_16x16x32_bf16 v[216:219], v[228:231], v[76:79], v[216:219]
v_xor_b32 v13, 0x10000, v250
v_cvt_pk_bf16_f32 v32, v196, v197
v_mfma_f32_16x16x32_bf16 v[220:223], v[224:227], v[104:107], v[220:223]
ds_read_b128 v[68:71], v255 offset:2048
ds_read_b128 v[100:103], v255 offset:3072
v_mfma_f32_16x16x32_bf16 v[220:223], v[228:231], v[108:111], v[220:223]
s_waitcnt lgkmcnt(6)
v_mfma_f32_16x16x32_bf16 v[208:211], v[232:235], v[16:19], v[208:211]
ds_read_b64_tr_b16 v[224:225], v12 offset:0
ds_read_b64_tr_b16 v[226:227], v12 offset:2048
v_mfma_f32_16x16x32_bf16 v[208:211], v[236:239], v[20:23], v[208:211]
v_exp_f32 v199, v199
v_mfma_f32_16x16x32_bf16 v[212:215], v[232:235], v[48:51], v[212:215]
v_cvt_pk_bf16_f32 v33, v198, v199
v_mfma_f32_16x16x32_bf16 v[212:215], v[236:239], v[52:55], v[212:215]
v_exp_f32 v200, v200
v_mfma_f32_16x16x32_bf16 v[216:219], v[232:235], v[80:83], v[216:219]
ds_read_b64_tr_b16 v[228:229], v12 offset:16384
ds_read_b64_tr_b16 v[230:231], v12 offset:18432
v_mfma_f32_16x16x32_bf16 v[216:219], v[236:239], v[84:87], v[216:219]
v_exp_f32 v201, v201
v_mfma_f32_16x16x32_bf16 v[220:223], v[232:235], v[112:115], v[220:223]
v_exp_f32 v202, v202
v_mfma_f32_16x16x32_bf16 v[220:223], v[236:239], v[116:119], v[220:223]
s_waitcnt lgkmcnt(6)
v_cvt_pk_bf16_f32 v64, v200, v201
v_mfma_f32_16x16x32_bf16 v[208:211], v[240:243], v[24:27], v[208:211]
ds_read_b64_tr_b16 v[232:233], v13 offset:0
ds_read_b64_tr_b16 v[234:235], v13 offset:2048
v_mfma_f32_16x16x32_bf16 v[208:211], v[244:247], v[28:31], v[208:211]
v_exp_f32 v203, v203
v_mfma_f32_16x16x32_bf16 v[212:215], v[240:243], v[56:59], v[212:215]
v_cvt_pk_bf16_f32 v65, v202, v203
v_mfma_f32_16x16x32_bf16 v[212:215], v[244:247], v[60:63], v[212:215]
v_exp_f32 v204, v204
v_mfma_f32_16x16x32_bf16 v[216:219], v[240:243], v[88:91], v[216:219]
ds_read_b64_tr_b16 v[236:237], v13 offset:16384
ds_read_b64_tr_b16 v[238:239], v13 offset:18432
v_mfma_f32_16x16x32_bf16 v[216:219], v[244:247], v[92:95], v[216:219]
v_exp_f32 v205, v205
v_mfma_f32_16x16x32_bf16 v[220:223], v[240:243], v[120:123], v[220:223]
v_exp_f32 v206, v206
v_mfma_f32_16x16x32_bf16 v[220:223], v[244:247], v[124:127], v[220:223]
s_waitcnt lgkmcnt(4)
v_mfma_f32_16x16x32_bf16 a[0:3], v[224:227], v[128:131], a[0:3]
ds_read_b64_tr_b16 v[240:241], v249 offset:33280
ds_read_b64_tr_b16 v[242:243], v249 offset:35328
v_mfma_f32_16x16x32_bf16 a[0:3], v[228:231], v[144:147], a[0:3]
v_exp_f32 v207, v207
v_mfma_f32_16x16x32_bf16 a[4:7], v[224:227], v[132:135], a[4:7]
v_cvt_pk_bf16_f32 v96, v204, v205
v_cvt_pk_bf16_f32 v97, v206, v207
v_mfma_f32_16x16x32_bf16 a[4:7], v[228:231], v[148:151], a[4:7]
v_exp_f32 v208, v208
v_mfma_f32_16x16x32_bf16 a[8:11], v[224:227], v[136:139], a[8:11]
ds_read_b64_tr_b16 v[244:245], v249 offset:49664
ds_read_b64_tr_b16 v[246:247], v249 offset:51712
v_mfma_f32_16x16x32_bf16 a[8:11], v[228:231], v[152:155], a[8:11]
v_exp_f32 v209, v209
v_mfma_f32_16x16x32_bf16 a[12:15], v[224:227], v[140:143], a[12:15]
v_exp_f32 v210, v210
v_mfma_f32_16x16x32_bf16 a[12:15], v[228:231], v[156:159], a[12:15]
s_waitcnt lgkmcnt(4)
v_cvt_pk_bf16_f32 v2, v208, v209
v_mfma_f32_16x16x32_bf16 a[16:19], v[232:235], v[128:131], a[16:19]
ds_read_b64_tr_b16 v[224:225], v12 offset:512
ds_read_b64_tr_b16 v[226:227], v12 offset:2560
v_mfma_f32_16x16x32_bf16 a[16:19], v[236:239], v[144:147], a[16:19]
v_exp_f32 v211, v211
v_mfma_f32_16x16x32_bf16 a[20:23], v[232:235], v[132:135], a[20:23]
v_cvt_pk_bf16_f32 v3, v210, v211
v_mfma_f32_16x16x32_bf16 a[20:23], v[236:239], v[148:151], a[20:23]
v_exp_f32 v212, v212
v_mfma_f32_16x16x32_bf16 a[24:27], v[232:235], v[136:139], a[24:27]
ds_read_b64_tr_b16 v[228:229], v12 offset:16896
ds_read_b64_tr_b16 v[230:231], v12 offset:18944
v_mfma_f32_16x16x32_bf16 a[24:27], v[236:239], v[152:155], a[24:27]
v_exp_f32 v213, v213
v_mfma_f32_16x16x32_bf16 a[28:31], v[232:235], v[140:143], a[28:31]
v_exp_f32 v214, v214
v_mfma_f32_16x16x32_bf16 a[28:31], v[236:239], v[156:159], a[28:31]
s_waitcnt lgkmcnt(4)
v_cvt_pk_bf16_f32 v34, v212, v213
v_mfma_f32_16x16x32_bf16 a[32:35], v[240:243], v[4:7], a[32:35]
ds_read_b64_tr_b16 v[232:233], v250 offset:33280
ds_read_b64_tr_b16 v[234:235], v250 offset:35328
v_mfma_f32_16x16x32_bf16 a[32:35], v[244:247], v[176:179], a[32:35]
v_exp_f32 v215, v215
v_mfma_f32_16x16x32_bf16 a[36:39], v[240:243], v[36:39], a[36:39]
v_cvt_pk_bf16_f32 v35, v214, v215
v_mfma_f32_16x16x32_bf16 a[36:39], v[244:247], v[180:183], a[36:39]
v_exp_f32 v216, v216
v_mfma_f32_16x16x32_bf16 a[40:43], v[240:243], v[68:71], a[40:43]
ds_read_b64_tr_b16 v[236:237], v250 offset:49664
ds_read_b64_tr_b16 v[238:239], v250 offset:51712
v_mfma_f32_16x16x32_bf16 a[40:43], v[244:247], v[184:187], a[40:43]
v_exp_f32 v217, v217
v_mfma_f32_16x16x32_bf16 a[44:47], v[240:243], v[100:103], a[44:47]
v_exp_f32 v218, v218
v_mfma_f32_16x16x32_bf16 a[44:47], v[244:247], v[188:191], a[44:47]
s_waitcnt lgkmcnt(4)
v_cvt_pk_bf16_f32 v66, v216, v217
v_mfma_f32_16x16x32_bf16 a[32:35], v[224:227], v[128:131], a[32:35]
ds_read_b64_tr_b16 v[240:241], v12 offset:32768
ds_read_b64_tr_b16 v[242:243], v12 offset:34816
v_mfma_f32_16x16x32_bf16 a[32:35], v[228:231], v[144:147], a[32:35]
v_exp_f32 v219, v219
v_mfma_f32_16x16x32_bf16 a[36:39], v[224:227], v[132:135], a[36:39]
v_cvt_pk_bf16_f32 v67, v218, v219
v_mfma_f32_16x16x32_bf16 a[36:39], v[228:231], v[148:151], a[36:39]
v_exp_f32 v220, v220
v_mfma_f32_16x16x32_bf16 a[40:43], v[224:227], v[136:139], a[40:43]
ds_read_b64_tr_b16 v[244:245], v12 offset:49152
ds_read_b64_tr_b16 v[246:247], v12 offset:51200
v_mfma_f32_16x16x32_bf16 a[40:43], v[228:231], v[152:155], a[40:43]
v_exp_f32 v221, v221
v_mfma_f32_16x16x32_bf16 a[44:47], v[224:227], v[140:143], a[44:47]
v_exp_f32 v222, v222
v_mfma_f32_16x16x32_bf16 a[44:47], v[228:231], v[156:159], a[44:47]
s_waitcnt lgkmcnt(4)
v_cvt_pk_bf16_f32 v98, v220, v221
v_mfma_f32_16x16x32_bf16 a[48:51], v[232:235], v[4:7], a[48:51]
ds_read_b64_tr_b16 v[224:225], v13 offset:32768
ds_read_b64_tr_b16 v[226:227], v13 offset:34816
v_mfma_f32_16x16x32_bf16 a[48:51], v[236:239], v[176:179], a[48:51]
v_exp_f32 v223, v223
v_mfma_f32_16x16x32_bf16 a[52:55], v[232:235], v[36:39], a[52:55]
v_cvt_pk_bf16_f32 v99, v222, v223
v_mfma_f32_16x16x32_bf16 a[52:55], v[236:239], v[180:183], a[52:55]
v_mfma_f32_16x16x32_bf16 a[56:59], v[232:235], v[68:71], a[56:59]
ds_read_b64_tr_b16 v[228:229], v13 offset:49152
ds_read_b64_tr_b16 v[230:231], v13 offset:51200
v_mfma_f32_16x16x32_bf16 a[56:59], v[236:239], v[184:187], a[56:59]
v_mfma_f32_16x16x32_bf16 a[60:63], v[232:235], v[100:103], a[60:63]
v_mfma_f32_16x16x32_bf16 a[60:63], v[236:239], v[188:191], a[60:63]
s_waitcnt lgkmcnt(4)
v_mfma_f32_16x16x32_bf16 a[0:3], v[240:243], v[160:163], a[0:3]
ds_read_b64_tr_b16 v[232:233], v12 offset:33280
ds_read_b64_tr_b16 v[234:235], v12 offset:35328
v_mfma_f32_16x16x32_bf16 a[0:3], v[244:247], v[0:3], a[0:3]
v_mfma_f32_16x16x32_bf16 a[4:7], v[240:243], v[164:167], a[4:7]
v_mfma_f32_16x16x32_bf16 a[4:7], v[244:247], v[32:35], a[4:7]
v_mfma_f32_16x16x32_bf16 a[8:11], v[240:243], v[168:171], a[8:11]
ds_read_b64_tr_b16 v[236:237], v12 offset:49664
ds_read_b64_tr_b16 v[238:239], v12 offset:51712
v_mfma_f32_16x16x32_bf16 a[8:11], v[244:247], v[64:67], a[8:11]
v_mfma_f32_16x16x32_bf16 a[12:15], v[240:243], v[172:175], a[12:15]
v_mfma_f32_16x16x32_bf16 a[12:15], v[244:247], v[96:99], a[12:15]
s_waitcnt lgkmcnt(4)
v_mfma_f32_16x16x32_bf16 a[16:19], v[224:227], v[160:163], a[16:19]
ds_read_b64_tr_b16 v[240:241], v13 offset:512
ds_read_b64_tr_b16 v[242:243], v13 offset:2560
v_mfma_f32_16x16x32_bf16 a[16:19], v[228:231], v[0:3], a[16:19]
v_mfma_f32_16x16x32_bf16 a[20:23], v[224:227], v[164:167], a[20:23]
v_mfma_f32_16x16x32_bf16 a[20:23], v[228:231], v[32:35], a[20:23]
v_mfma_f32_16x16x32_bf16 a[24:27], v[224:227], v[168:171], a[24:27]
ds_read_b64_tr_b16 v[244:245], v13 offset:16896
ds_read_b64_tr_b16 v[246:247], v13 offset:18944
v_accvgpr_read_b32 v192, a0
v_mfma_f32_16x16x32_bf16 a[24:27], v[228:231], v[64:67], a[24:27]
v_accvgpr_read_b32 v193, a4
v_accvgpr_read_b32 v194, a8
v_accvgpr_read_b32 v195, a12
v_mfma_f32_16x16x32_bf16 a[28:31], v[224:227], v[172:175], a[28:31]
v_lshlrev_b32 v253, 2, v252
v_max3_u32 v254, v192, v193, v194
v_min3_u32 v255, v192, v193, v194
v_mfma_f32_16x16x32_bf16 a[28:31], v[228:231], v[96:99], a[28:31]
s_waitcnt lgkmcnt(4)
v_max_u32 v254, v254, v195
v_min_u32 v255, v255, v195
v_mfma_f32_16x16x32_bf16 a[32:35], v[232:235], v[160:163], a[32:35]
ds_read_b64_tr_b16 v[224:225], v13 offset:33280
ds_read_b64_tr_b16 v[226:227], v13 offset:35328
v_mfma_f32_16x16x32_bf16 a[32:35], v[236:239], v[0:3], a[32:35]
s_mov_b64 exec, 0xffff
buffer_store_dword v192, v253, s[24:27], s48 offen offset:4 sc1
buffer_store_dword v193, v253, s[24:27], s48 offen offset:1028 sc1
buffer_store_dword v194, v253, s[24:27], s48 offen offset:2052 sc1
buffer_store_dword v195, v253, s[24:27], s48 offen offset:3076 sc1
v_cmp_lt_u32 s[50:51], s52, v254
v_cmp_gt_u32 vcc, s53, v255
s_mov_b64 exec, -1
v_mfma_f32_16x16x32_bf16 a[36:39], v[232:235], v[164:167], a[36:39]
v_accvgpr_read_b32 v192, a0
v_accvgpr_read_b32 v193, a1
v_mfma_f32_16x16x32_bf16 a[36:39], v[236:239], v[32:35], a[36:39]
v_accvgpr_read_b32 v194, a2
v_accvgpr_read_b32 v195, a3
v_mfma_f32_16x16x32_bf16 a[40:43], v[232:235], v[168:171], a[40:43]
ds_read_b64_tr_b16 v[228:229], v13 offset:49664
ds_read_b64_tr_b16 v[230:231], v13 offset:51712
v_mfma_f32_16x16x32_bf16 a[40:43], v[236:239], v[64:67], a[40:43]
v_cvt_pk_bf16_f32 v16, v192, v193
v_cvt_pk_bf16_f32 v17, v194, v195
v_mfma_f32_16x16x32_bf16 a[44:47], v[232:235], v[172:175], a[44:47]
v_accvgpr_read_b32 v200, a4
v_accvgpr_read_b32 v201, a5
v_mfma_f32_16x16x32_bf16 a[44:47], v[236:239], v[96:99], a[44:47]
s_waitcnt lgkmcnt(4)
v_accvgpr_read_b32 v202, a6
v_mfma_f32_16x16x32_bf16 a[48:51], v[240:243], v[128:131], a[48:51]
ds_read_b64_tr_b16 v[232:233], v249 offset:36864
ds_read_b64_tr_b16 v[234:235], v249 offset:38912
v_mfma_f32_16x16x32_bf16 a[48:51], v[244:247], v[144:147], a[48:51]
v_accvgpr_read_b32 v203, a7
v_cvt_pk_bf16_f32 v48, v200, v201
v_mfma_f32_16x16x32_bf16 a[52:55], v[240:243], v[132:135], a[52:55]
v_cvt_pk_bf16_f32 v49, v202, v203
v_accvgpr_read_b32 v208, a8
v_mfma_f32_16x16x32_bf16 a[52:55], v[244:247], v[148:151], a[52:55]
v_accvgpr_read_b32 v209, a9
v_accvgpr_read_b32 v210, a10
v_mfma_f32_16x16x32_bf16 a[56:59], v[240:243], v[136:139], a[56:59]
ds_read_b64_tr_b16 v[236:237], v249 offset:53248
ds_read_b64_tr_b16 v[238:239], v249 offset:55296
v_mfma_f32_16x16x32_bf16 a[56:59], v[244:247], v[152:155], a[56:59]
v_accvgpr_read_b32 v211, a11
v_cvt_pk_bf16_f32 v80, v208, v209
v_mfma_f32_16x16x32_bf16 a[60:63], v[240:243], v[140:143], a[60:63]
v_cvt_pk_bf16_f32 v81, v210, v211
v_accvgpr_read_b32 v216, a12
v_mfma_f32_16x16x32_bf16 a[60:63], v[244:247], v[156:159], a[60:63]
s_waitcnt lgkmcnt(4)
v_accvgpr_read_b32 v217, a13
v_mfma_f32_16x16x32_bf16 a[48:51], v[224:227], v[160:163], a[48:51]
ds_read_b64_tr_b16 v[240:241], v12 offset:4096
ds_read_b64_tr_b16 v[242:243], v12 offset:6144
v_mfma_f32_16x16x32_bf16 a[48:51], v[228:231], v[0:3], a[48:51]
v_accvgpr_read_b32 v218, a14
v_accvgpr_read_b32 v219, a15
v_mfma_f32_16x16x32_bf16 a[52:55], v[224:227], v[164:167], a[52:55]
v_cvt_pk_bf16_f32 v112, v216, v217
v_cvt_pk_bf16_f32 v113, v218, v219
v_mfma_f32_16x16x32_bf16 a[52:55], v[228:231], v[32:35], a[52:55]
v_accvgpr_read_b32 v196, a16
v_accvgpr_read_b32 v197, a17
v_mfma_f32_16x16x32_bf16 a[56:59], v[224:227], v[168:171], a[56:59]
ds_read_b64_tr_b16 v[244:245], v12 offset:20480
ds_read_b64_tr_b16 v[246:247], v12 offset:22528
v_mfma_f32_16x16x32_bf16 a[56:59], v[228:231], v[64:67], a[56:59]
v_accvgpr_read_b32 v198, a18
v_accvgpr_read_b32 v199, a19
v_mfma_f32_16x16x32_bf16 a[60:63], v[224:227], v[172:175], a[60:63]
v_cvt_pk_bf16_f32 v18, v196, v197
v_cvt_pk_bf16_f32 v19, v198, v199
v_mfma_f32_16x16x32_bf16 a[60:63], v[228:231], v[96:99], a[60:63]
s_waitcnt lgkmcnt(4)
buffer_store_dwordx4 v[16:19], v252, s[20:23], s40 offen offset:0 sc1
v_mfma_f32_16x16x32_bf16 a[64:67], v[232:235], v[4:7], a[64:67]
ds_read_b64_tr_b16 v[224:225], v12 offset:36864
ds_read_b64_tr_b16 v[226:227], v12 offset:38912
v_mfma_f32_16x16x32_bf16 a[64:67], v[236:239], v[176:179], a[64:67]
v_accvgpr_read_b32 v204, a20
v_accvgpr_read_b32 v205, a21
v_mfma_f32_16x16x32_bf16 a[68:71], v[232:235], v[36:39], a[68:71]
v_accvgpr_read_b32 v206, a22
v_accvgpr_read_b32 v207, a23
v_mfma_f32_16x16x32_bf16 a[68:71], v[236:239], v[180:183], a[68:71]
v_cvt_pk_bf16_f32 v50, v204, v205
v_cvt_pk_bf16_f32 v51, v206, v207
v_mfma_f32_16x16x32_bf16 a[72:75], v[232:235], v[68:71], a[72:75]
ds_read_b64_tr_b16 v[228:229], v12 offset:53248
ds_read_b64_tr_b16 v[230:231], v12 offset:55296
v_mfma_f32_16x16x32_bf16 a[72:75], v[236:239], v[184:187], a[72:75]
buffer_store_dwordx4 v[48:51], v252, s[20:23], s41 offen offset:0 sc1
v_accvgpr_read_b32 v212, a24
v_mfma_f32_16x16x32_bf16 a[76:79], v[232:235], v[100:103], a[76:79]
v_accvgpr_read_b32 v213, a25
v_accvgpr_read_b32 v214, a26
v_mfma_f32_16x16x32_bf16 a[76:79], v[236:239], v[188:191], a[76:79]
s_waitcnt lgkmcnt(4)
v_accvgpr_read_b32 v215, a27
v_mfma_f32_16x16x32_bf16 a[64:67], v[240:243], v[128:131], a[64:67]
ds_read_b64_tr_b16 v[232:233], v250 offset:36864
ds_read_b64_tr_b16 v[234:235], v250 offset:38912
v_mfma_f32_16x16x32_bf16 a[64:67], v[244:247], v[144:147], a[64:67]
v_cvt_pk_bf16_f32 v82, v212, v213
v_cvt_pk_bf16_f32 v83, v214, v215
v_mfma_f32_16x16x32_bf16 a[68:71], v[240:243], v[132:135], a[68:71]
buffer_store_dwordx4 v[80:83], v252, s[20:23], s42 offen offset:0 sc1
v_accvgpr_read_b32 v220, a28
v_mfma_f32_16x16x32_bf16 a[68:71], v[244:247], v[148:151], a[68:71]
v_accvgpr_read_b32 v221, a29
v_accvgpr_read_b32 v222, a30
v_mfma_f32_16x16x32_bf16 a[72:75], v[240:243], v[136:139], a[72:75]
ds_read_b64_tr_b16 v[236:237], v250 offset:53248
ds_read_b64_tr_b16 v[238:239], v250 offset:55296
v_mfma_f32_16x16x32_bf16 a[72:75], v[244:247], v[152:155], a[72:75]
v_accvgpr_read_b32 v223, a31
v_cvt_pk_bf16_f32 v114, v220, v221
v_mfma_f32_16x16x32_bf16 a[76:79], v[240:243], v[140:143], a[76:79]
v_cvt_pk_bf16_f32 v115, v222, v223
buffer_store_dwordx4 v[112:115], v252, s[20:23], s43 offen offset:0 sc1
v_mfma_f32_16x16x32_bf16 a[76:79], v[244:247], v[156:159], a[76:79]
s_waitcnt lgkmcnt(4)
v_accvgpr_read_b32 v192, a32
v_mfma_f32_16x16x32_bf16 a[64:67], v[224:227], v[160:163], a[64:67]
ds_read_b64_tr_b16 v[240:241], v13 offset:4096
ds_read_b64_tr_b16 v[242:243], v13 offset:6144
v_mfma_f32_16x16x32_bf16 a[64:67], v[228:231], v[0:3], a[64:67]
v_accvgpr_read_b32 v193, a33
v_accvgpr_read_b32 v194, a34
v_mfma_f32_16x16x32_bf16 a[68:71], v[224:227], v[164:167], a[68:71]
v_accvgpr_read_b32 v195, a35
v_cvt_pk_bf16_f32 v20, v192, v193
v_mfma_f32_16x16x32_bf16 a[68:71], v[228:231], v[32:35], a[68:71]
v_cvt_pk_bf16_f32 v21, v194, v195
v_accvgpr_read_b32 v200, a36
v_mfma_f32_16x16x32_bf16 a[72:75], v[224:227], v[168:171], a[72:75]
ds_read_b64_tr_b16 v[244:245], v13 offset:20480
ds_read_b64_tr_b16 v[246:247], v13 offset:22528
v_mfma_f32_16x16x32_bf16 a[72:75], v[228:231], v[64:67], a[72:75]
v_accvgpr_read_b32 v201, a37
v_accvgpr_read_b32 v202, a38
v_mfma_f32_16x16x32_bf16 a[76:79], v[224:227], v[172:175], a[76:79]
v_accvgpr_read_b32 v203, a39
v_cvt_pk_bf16_f32 v52, v200, v201
v_mfma_f32_16x16x32_bf16 a[76:79], v[228:231], v[96:99], a[76:79]
s_waitcnt lgkmcnt(4)
v_cvt_pk_bf16_f32 v53, v202, v203
v_mfma_f32_16x16x32_bf16 a[80:83], v[232:235], v[4:7], a[80:83]
ds_read_b64_tr_b16 v[224:225], v13 offset:36864
ds_read_b64_tr_b16 v[226:227], v13 offset:38912
v_mfma_f32_16x16x32_bf16 a[80:83], v[236:239], v[176:179], a[80:83]
v_accvgpr_read_b32 v208, a40
v_accvgpr_read_b32 v209, a41
v_mfma_f32_16x16x32_bf16 a[84:87], v[232:235], v[36:39], a[84:87]
v_accvgpr_read_b32 v210, a42
v_accvgpr_read_b32 v211, a43
v_mfma_f32_16x16x32_bf16 a[84:87], v[236:239], v[180:183], a[84:87]
v_cvt_pk_bf16_f32 v84, v208, v209
v_cvt_pk_bf16_f32 v85, v210, v211
v_mfma_f32_16x16x32_bf16 a[88:91], v[232:235], v[68:71], a[88:91]
ds_read_b64_tr_b16 v[228:229], v13 offset:53248
ds_read_b64_tr_b16 v[230:231], v13 offset:55296
v_mfma_f32_16x16x32_bf16 a[88:91], v[236:239], v[184:187], a[88:91]
v_accvgpr_read_b32 v216, a44
v_accvgpr_read_b32 v217, a45
v_mfma_f32_16x16x32_bf16 a[92:95], v[232:235], v[100:103], a[92:95]
v_accvgpr_read_b32 v218, a46
v_accvgpr_read_b32 v219, a47
v_mfma_f32_16x16x32_bf16 a[92:95], v[236:239], v[188:191], a[92:95]
s_waitcnt lgkmcnt(4)
v_cvt_pk_bf16_f32 v116, v216, v217
v_mfma_f32_16x16x32_bf16 a[80:83], v[240:243], v[128:131], a[80:83]
ds_read_b64_tr_b16 v[232:233], v249 offset:37376
ds_read_b64_tr_b16 v[234:235], v249 offset:39424
v_mfma_f32_16x16x32_bf16 a[80:83], v[244:247], v[144:147], a[80:83]
v_cvt_pk_bf16_f32 v117, v218, v219
v_accvgpr_read_b32 v196, a48
v_mfma_f32_16x16x32_bf16 a[84:87], v[240:243], v[132:135], a[84:87]
v_accvgpr_read_b32 v197, a49
v_accvgpr_read_b32 v198, a50
v_mfma_f32_16x16x32_bf16 a[84:87], v[244:247], v[148:151], a[84:87]
v_accvgpr_read_b32 v199, a51
v_cvt_pk_bf16_f32 v22, v196, v197
v_mfma_f32_16x16x32_bf16 a[88:91], v[240:243], v[136:139], a[88:91]
ds_read_b64_tr_b16 v[236:237], v249 offset:53760
ds_read_b64_tr_b16 v[238:239], v249 offset:55808
v_mfma_f32_16x16x32_bf16 a[88:91], v[244:247], v[152:155], a[88:91]
v_cvt_pk_bf16_f32 v23, v198, v199
buffer_store_dwordx4 v[20:23], v252, s[20:23], s40 offen offset:1024 sc1
v_mfma_f32_16x16x32_bf16 a[92:95], v[240:243], v[140:143], a[92:95]
v_accvgpr_read_b32 v204, a52
v_accvgpr_read_b32 v205, a53
v_mfma_f32_16x16x32_bf16 a[92:95], v[244:247], v[156:159], a[92:95]
s_waitcnt lgkmcnt(4)
v_accvgpr_read_b32 v206, a54
v_mfma_f32_16x16x32_bf16 a[80:83], v[224:227], v[160:163], a[80:83]
ds_read_b64_tr_b16 v[240:241], v12 offset:4608
ds_read_b64_tr_b16 v[242:243], v12 offset:6656
v_mfma_f32_16x16x32_bf16 a[80:83], v[228:231], v[0:3], a[80:83]
v_accvgpr_read_b32 v207, a55
v_cvt_pk_bf16_f32 v54, v204, v205
v_mfma_f32_16x16x32_bf16 a[84:87], v[224:227], v[164:167], a[84:87]
v_cvt_pk_bf16_f32 v55, v206, v207
buffer_store_dwordx4 v[52:55], v252, s[20:23], s41 offen offset:1024 sc1
v_mfma_f32_16x16x32_bf16 a[84:87], v[228:231], v[32:35], a[84:87]
v_accvgpr_read_b32 v212, a56
v_accvgpr_read_b32 v213, a57
v_mfma_f32_16x16x32_bf16 a[88:91], v[224:227], v[168:171], a[88:91]
ds_read_b64_tr_b16 v[244:245], v12 offset:20992
ds_read_b64_tr_b16 v[246:247], v12 offset:23040
v_mfma_f32_16x16x32_bf16 a[88:91], v[228:231], v[64:67], a[88:91]
v_accvgpr_read_b32 v214, a58
v_accvgpr_read_b32 v215, a59
v_mfma_f32_16x16x32_bf16 a[92:95], v[224:227], v[172:175], a[92:95]
v_cvt_pk_bf16_f32 v86, v212, v213
v_cvt_pk_bf16_f32 v87, v214, v215
v_mfma_f32_16x16x32_bf16 a[92:95], v[228:231], v[96:99], a[92:95]
s_waitcnt lgkmcnt(4)
buffer_store_dwordx4 v[84:87], v252, s[20:23], s42 offen offset:1024 sc1
v_mfma_f32_16x16x32_bf16 a[96:99], v[232:235], v[4:7], a[96:99]
ds_read_b64_tr_b16 v[224:225], v12 offset:37376
ds_read_b64_tr_b16 v[226:227], v12 offset:39424
v_mfma_f32_16x16x32_bf16 a[96:99], v[236:239], v[176:179], a[96:99]
v_accvgpr_read_b32 v220, a60
v_accvgpr_read_b32 v221, a61
v_mfma_f32_16x16x32_bf16 a[100:103], v[232:235], v[36:39], a[100:103]
v_accvgpr_read_b32 v222, a62
v_accvgpr_read_b32 v223, a63
v_mfma_f32_16x16x32_bf16 a[100:103], v[236:239], v[180:183], a[100:103]
v_cvt_pk_bf16_f32 v118, v220, v221
v_cvt_pk_bf16_f32 v119, v222, v223
v_mfma_f32_16x16x32_bf16 a[104:107], v[232:235], v[68:71], a[104:107]
ds_read_b64_tr_b16 v[228:229], v12 offset:53760
ds_read_b64_tr_b16 v[230:231], v12 offset:55808
v_mfma_f32_16x16x32_bf16 a[104:107], v[236:239], v[184:187], a[104:107]
buffer_store_dwordx4 v[116:119], v252, s[20:23], s43 offen offset:1024 sc1
v_accvgpr_read_b32 v192, a64
v_mfma_f32_16x16x32_bf16 a[108:111], v[232:235], v[100:103], a[108:111]
v_accvgpr_read_b32 v193, a65
v_accvgpr_read_b32 v194, a66
v_mfma_f32_16x16x32_bf16 a[108:111], v[236:239], v[188:191], a[108:111]
s_waitcnt lgkmcnt(4)
v_accvgpr_read_b32 v195, a67
v_mfma_f32_16x16x32_bf16 a[96:99], v[240:243], v[128:131], a[96:99]
ds_read_b64_tr_b16 v[232:233], v250 offset:37376
ds_read_b64_tr_b16 v[234:235], v250 offset:39424
v_mfma_f32_16x16x32_bf16 a[96:99], v[244:247], v[144:147], a[96:99]
v_cvt_pk_bf16_f32 v24, v192, v193
v_cvt_pk_bf16_f32 v25, v194, v195
v_mfma_f32_16x16x32_bf16 a[100:103], v[240:243], v[132:135], a[100:103]
v_accvgpr_read_b32 v200, a68
v_accvgpr_read_b32 v201, a69
v_mfma_f32_16x16x32_bf16 a[100:103], v[244:247], v[148:151], a[100:103]
v_accvgpr_read_b32 v202, a70
v_accvgpr_read_b32 v203, a71
v_mfma_f32_16x16x32_bf16 a[104:107], v[240:243], v[136:139], a[104:107]
ds_read_b64_tr_b16 v[236:237], v250 offset:53760
ds_read_b64_tr_b16 v[238:239], v250 offset:55808
v_mfma_f32_16x16x32_bf16 a[104:107], v[244:247], v[152:155], a[104:107]
v_cvt_pk_bf16_f32 v56, v200, v201
v_cvt_pk_bf16_f32 v57, v202, v203
v_mfma_f32_16x16x32_bf16 a[108:111], v[240:243], v[140:143], a[108:111]
v_accvgpr_read_b32 v208, a72
v_accvgpr_read_b32 v209, a73
v_mfma_f32_16x16x32_bf16 a[108:111], v[244:247], v[156:159], a[108:111]
s_waitcnt lgkmcnt(4)
v_accvgpr_read_b32 v210, a74
v_mfma_f32_16x16x32_bf16 a[96:99], v[224:227], v[160:163], a[96:99]
ds_read_b64_tr_b16 v[240:241], v13 offset:4608
ds_read_b64_tr_b16 v[242:243], v13 offset:6656
v_mfma_f32_16x16x32_bf16 a[96:99], v[228:231], v[0:3], a[96:99]
v_accvgpr_read_b32 v211, a75
v_cvt_pk_bf16_f32 v88, v208, v209
v_mfma_f32_16x16x32_bf16 a[100:103], v[224:227], v[164:167], a[100:103]
v_cvt_pk_bf16_f32 v89, v210, v211
v_accvgpr_read_b32 v216, a76
v_mfma_f32_16x16x32_bf16 a[100:103], v[228:231], v[32:35], a[100:103]
v_accvgpr_read_b32 v217, a77
v_accvgpr_read_b32 v218, a78
v_mfma_f32_16x16x32_bf16 a[104:107], v[224:227], v[168:171], a[104:107]
ds_read_b64_tr_b16 v[244:245], v13 offset:20992
ds_read_b64_tr_b16 v[246:247], v13 offset:23040
v_mfma_f32_16x16x32_bf16 a[104:107], v[228:231], v[64:67], a[104:107]
v_accvgpr_read_b32 v219, a79
v_cvt_pk_bf16_f32 v120, v216, v217
v_mfma_f32_16x16x32_bf16 a[108:111], v[224:227], v[172:175], a[108:111]
v_cvt_pk_bf16_f32 v121, v218, v219
v_accvgpr_read_b32 v196, a80
v_mfma_f32_16x16x32_bf16 a[108:111], v[228:231], v[96:99], a[108:111]
s_waitcnt lgkmcnt(4)
v_accvgpr_read_b32 v197, a81
v_mfma_f32_16x16x32_bf16 a[112:115], v[232:235], v[4:7], a[112:115]
ds_read_b64_tr_b16 v[224:225], v13 offset:37376
ds_read_b64_tr_b16 v[226:227], v13 offset:39424
v_mfma_f32_16x16x32_bf16 a[112:115], v[236:239], v[176:179], a[112:115]
v_accvgpr_read_b32 v198, a82
v_accvgpr_read_b32 v199, a83
v_mfma_f32_16x16x32_bf16 a[116:119], v[232:235], v[36:39], a[116:119]
v_cvt_pk_bf16_f32 v26, v196, v197
v_cvt_pk_bf16_f32 v27, v198, v199
v_mfma_f32_16x16x32_bf16 a[116:119], v[236:239], v[180:183], a[116:119]
buffer_store_dwordx4 v[24:27], v252, s[20:23], s40 offen offset:2048 sc1
v_accvgpr_read_b32 v204, a84
v_mfma_f32_16x16x32_bf16 a[120:123], v[232:235], v[68:71], a[120:123]
ds_read_b64_tr_b16 v[228:229], v13 offset:53760
ds_read_b64_tr_b16 v[230:231], v13 offset:55808
v_mfma_f32_16x16x32_bf16 a[120:123], v[236:239], v[184:187], a[120:123]
v_accvgpr_read_b32 v205, a85
v_accvgpr_read_b32 v206, a86
v_mfma_f32_16x16x32_bf16 a[124:127], v[232:235], v[100:103], a[124:127]
v_accvgpr_read_b32 v207, a87
v_cvt_pk_bf16_f32 v58, v204, v205
v_mfma_f32_16x16x32_bf16 a[124:127], v[236:239], v[188:191], a[124:127]
s_waitcnt lgkmcnt(4)
v_cvt_pk_bf16_f32 v59, v206, v207
v_mfma_f32_16x16x32_bf16 a[112:115], v[240:243], v[128:131], a[112:115]
ds_read_b64_tr_b16 v[232:233], v249 offset:40960
ds_read_b64_tr_b16 v[234:235], v249 offset:43008
v_mfma_f32_16x16x32_bf16 a[112:115], v[244:247], v[144:147], a[112:115]
buffer_store_dwordx4 v[56:59], v252, s[20:23], s41 offen offset:2048 sc1
v_accvgpr_read_b32 v212, a88
v_mfma_f32_16x16x32_bf16 a[116:119], v[240:243], v[132:135], a[116:119]
v_accvgpr_read_b32 v213, a89
v_accvgpr_read_b32 v214, a90
v_mfma_f32_16x16x32_bf16 a[116:119], v[244:247], v[148:151], a[116:119]
v_accvgpr_read_b32 v215, a91
v_cvt_pk_bf16_f32 v90, v212, v213
v_mfma_f32_16x16x32_bf16 a[120:123], v[240:243], v[136:139], a[120:123]
ds_read_b64_tr_b16 v[236:237], v249 offset:57344
ds_read_b64_tr_b16 v[238:239], v249 offset:59392
v_mfma_f32_16x16x32_bf16 a[120:123], v[244:247], v[152:155], a[120:123]
v_cvt_pk_bf16_f32 v91, v214, v215
buffer_store_dwordx4 v[88:91], v252, s[20:23], s42 offen offset:2048 sc1
v_mfma_f32_16x16x32_bf16 a[124:127], v[240:243], v[140:143], a[124:127]
v_accvgpr_read_b32 v220, a92
v_accvgpr_read_b32 v221, a93
v_mfma_f32_16x16x32_bf16 a[124:127], v[244:247], v[156:159], a[124:127]
s_waitcnt lgkmcnt(4)
v_accvgpr_read_b32 v222, a94
v_mfma_f32_16x16x32_bf16 a[112:115], v[224:227], v[160:163], a[112:115]
ds_read_b64_tr_b16 v[240:241], v12 offset:8192
ds_read_b64_tr_b16 v[242:243], v12 offset:10240
v_mfma_f32_16x16x32_bf16 a[112:115], v[228:231], v[0:3], a[112:115]
v_accvgpr_read_b32 v223, a95
v_cvt_pk_bf16_f32 v122, v220, v221
v_mfma_f32_16x16x32_bf16 a[116:119], v[224:227], v[164:167], a[116:119]
v_cvt_pk_bf16_f32 v123, v222, v223
buffer_store_dwordx4 v[120:123], v252, s[20:23], s43 offen offset:2048 sc1
v_mfma_f32_16x16x32_bf16 a[116:119], v[228:231], v[32:35], a[116:119]
v_accvgpr_read_b32 v192, a96
v_accvgpr_read_b32 v193, a97
v_mfma_f32_16x16x32_bf16 a[120:123], v[224:227], v[168:171], a[120:123]
ds_read_b64_tr_b16 v[244:245], v12 offset:24576
ds_read_b64_tr_b16 v[246:247], v12 offset:26624
v_mfma_f32_16x16x32_bf16 a[120:123], v[228:231], v[64:67], a[120:123]
v_accvgpr_read_b32 v194, a98
v_accvgpr_read_b32 v195, a99
v_mfma_f32_16x16x32_bf16 a[124:127], v[224:227], v[172:175], a[124:127]
v_cvt_pk_bf16_f32 v28, v192, v193
v_cvt_pk_bf16_f32 v29, v194, v195
v_mfma_f32_16x16x32_bf16 a[124:127], v[228:231], v[96:99], a[124:127]
s_waitcnt lgkmcnt(4)
v_accvgpr_read_b32 v200, a100
v_mfma_f32_16x16x32_bf16 a[128:131], v[232:235], v[4:7], a[128:131]
ds_read_b64_tr_b16 v[224:225], v12 offset:40960
ds_read_b64_tr_b16 v[226:227], v12 offset:43008
v_mfma_f32_16x16x32_bf16 a[128:131], v[236:239], v[176:179], a[128:131]
v_accvgpr_read_b32 v201, a101
v_accvgpr_read_b32 v202, a102
v_mfma_f32_16x16x32_bf16 a[132:135], v[232:235], v[36:39], a[132:135]
v_accvgpr_read_b32 v203, a103
v_cvt_pk_bf16_f32 v60, v200, v201
v_mfma_f32_16x16x32_bf16 a[132:135], v[236:239], v[180:183], a[132:135]
v_cvt_pk_bf16_f32 v61, v202, v203
v_accvgpr_read_b32 v208, a104
v_mfma_f32_16x16x32_bf16 a[136:139], v[232:235], v[68:71], a[136:139]
ds_read_b64_tr_b16 v[228:229], v12 offset:57344
ds_read_b64_tr_b16 v[230:231], v12 offset:59392
v_mfma_f32_16x16x32_bf16 a[136:139], v[236:239], v[184:187], a[136:139]
v_accvgpr_read_b32 v209, a105
v_accvgpr_read_b32 v210, a106
v_mfma_f32_16x16x32_bf16 a[140:143], v[232:235], v[100:103], a[140:143]
v_accvgpr_read_b32 v211, a107
v_cvt_pk_bf16_f32 v92, v208, v209
v_mfma_f32_16x16x32_bf16 a[140:143], v[236:239], v[188:191], a[140:143]
s_waitcnt lgkmcnt(4)
v_cvt_pk_bf16_f32 v93, v210, v211
v_mfma_f32_16x16x32_bf16 a[128:131], v[240:243], v[128:131], a[128:131]
ds_read_b64_tr_b16 v[232:233], v250 offset:40960
ds_read_b64_tr_b16 v[234:235], v250 offset:43008
v_mfma_f32_16x16x32_bf16 a[128:131], v[244:247], v[144:147], a[128:131]
v_accvgpr_read_b32 v216, a108
v_accvgpr_read_b32 v217, a109
v_mfma_f32_16x16x32_bf16 a[132:135], v[240:243], v[132:135], a[132:135]
v_accvgpr_read_b32 v218, a110
v_accvgpr_read_b32 v219, a111
v_mfma_f32_16x16x32_bf16 a[132:135], v[244:247], v[148:151], a[132:135]
v_cvt_pk_bf16_f32 v124, v216, v217
v_cvt_pk_bf16_f32 v125, v218, v219
v_mfma_f32_16x16x32_bf16 a[136:139], v[240:243], v[136:139], a[136:139]
ds_read_b64_tr_b16 v[236:237], v250 offset:57344
ds_read_b64_tr_b16 v[238:239], v250 offset:59392
v_mfma_f32_16x16x32_bf16 a[136:139], v[244:247], v[152:155], a[136:139]
v_accvgpr_read_b32 v196, a112
v_accvgpr_read_b32 v197, a113
v_mfma_f32_16x16x32_bf16 a[140:143], v[240:243], v[140:143], a[140:143]
v_accvgpr_read_b32 v198, a114
v_accvgpr_read_b32 v199, a115
v_mfma_f32_16x16x32_bf16 a[140:143], v[244:247], v[156:159], a[140:143]
s_waitcnt lgkmcnt(4)
v_cvt_pk_bf16_f32 v30, v196, v197
v_mfma_f32_16x16x32_bf16 a[128:131], v[224:227], v[160:163], a[128:131]
ds_read_b64_tr_b16 v[240:241], v13 offset:8192
ds_read_b64_tr_b16 v[242:243], v13 offset:10240
v_mfma_f32_16x16x32_bf16 a[128:131], v[228:231], v[0:3], a[128:131]
v_cvt_pk_bf16_f32 v31, v198, v199
buffer_store_dwordx4 v[28:31], v252, s[20:23], s40 offen offset:3072 sc1
v_mfma_f32_16x16x32_bf16 a[132:135], v[224:227], v[164:167], a[132:135]
v_accvgpr_read_b32 v204, a116
v_accvgpr_read_b32 v205, a117
v_mfma_f32_16x16x32_bf16 a[132:135], v[228:231], v[32:35], a[132:135]
v_accvgpr_read_b32 v206, a118
v_accvgpr_read_b32 v207, a119
v_mfma_f32_16x16x32_bf16 a[136:139], v[224:227], v[168:171], a[136:139]
ds_read_b64_tr_b16 v[244:245], v13 offset:24576
ds_read_b64_tr_b16 v[246:247], v13 offset:26624
v_mfma_f32_16x16x32_bf16 a[136:139], v[228:231], v[64:67], a[136:139]
v_cvt_pk_bf16_f32 v62, v204, v205
v_cvt_pk_bf16_f32 v63, v206, v207
v_mfma_f32_16x16x32_bf16 a[140:143], v[224:227], v[172:175], a[140:143]
buffer_store_dwordx4 v[60:63], v252, s[20:23], s41 offen offset:3072 sc1
v_accvgpr_read_b32 v212, a120
v_mfma_f32_16x16x32_bf16 a[140:143], v[228:231], v[96:99], a[140:143]
s_waitcnt lgkmcnt(4)
v_accvgpr_read_b32 v213, a121
v_mfma_f32_16x16x32_bf16 a[144:147], v[232:235], v[4:7], a[144:147]
ds_read_b64_tr_b16 v[224:225], v13 offset:40960
ds_read_b64_tr_b16 v[226:227], v13 offset:43008
v_mfma_f32_16x16x32_bf16 a[144:147], v[236:239], v[176:179], a[144:147]
v_accvgpr_read_b32 v214, a122
v_accvgpr_read_b32 v215, a123
v_mfma_f32_16x16x32_bf16 a[148:151], v[232:235], v[36:39], a[148:151]
v_cvt_pk_bf16_f32 v94, v212, v213
v_cvt_pk_bf16_f32 v95, v214, v215
v_mfma_f32_16x16x32_bf16 a[148:151], v[236:239], v[180:183], a[148:151]
buffer_store_dwordx4 v[92:95], v252, s[20:23], s42 offen offset:3072 sc1
v_accvgpr_read_b32 v220, a124
v_mfma_f32_16x16x32_bf16 a[152:155], v[232:235], v[68:71], a[152:155]
ds_read_b64_tr_b16 v[228:229], v13 offset:57344
ds_read_b64_tr_b16 v[230:231], v13 offset:59392
v_mfma_f32_16x16x32_bf16 a[152:155], v[236:239], v[184:187], a[152:155]
v_accvgpr_read_b32 v221, a125
v_accvgpr_read_b32 v222, a126
v_mfma_f32_16x16x32_bf16 a[156:159], v[232:235], v[100:103], a[156:159]
v_accvgpr_read_b32 v223, a127
v_cvt_pk_bf16_f32 v126, v220, v221
v_mfma_f32_16x16x32_bf16 a[156:159], v[236:239], v[188:191], a[156:159]
s_waitcnt lgkmcnt(4)
v_cvt_pk_bf16_f32 v127, v222, v223
v_mfma_f32_16x16x32_bf16 a[144:147], v[240:243], v[128:131], a[144:147]
ds_read_b64_tr_b16 v[232:233], v249 offset:41472
ds_read_b64_tr_b16 v[234:235], v249 offset:43520
v_mfma_f32_16x16x32_bf16 a[144:147], v[244:247], v[144:147], a[144:147]
buffer_store_dwordx4 v[124:127], v252, s[20:23], s43 offen offset:3072 sc1
v_accvgpr_read_b32 v192, a128
v_mfma_f32_16x16x32_bf16 a[148:151], v[240:243], v[132:135], a[148:151]
v_accvgpr_read_b32 v193, a129
v_accvgpr_read_b32 v194, a130
v_mfma_f32_16x16x32_bf16 a[148:151], v[244:247], v[148:151], a[148:151]
v_accvgpr_read_b32 v195, a131
v_cvt_pk_bf16_f32 v16, v192, v193
v_mfma_f32_16x16x32_bf16 a[152:155], v[240:243], v[136:139], a[152:155]
ds_read_b64_tr_b16 v[236:237], v249 offset:57856
ds_read_b64_tr_b16 v[238:239], v249 offset:59904
v_mfma_f32_16x16x32_bf16 a[152:155], v[244:247], v[152:155], a[152:155]
v_cvt_pk_bf16_f32 v17, v194, v195
v_accvgpr_read_b32 v200, a132
v_mfma_f32_16x16x32_bf16 a[156:159], v[240:243], v[140:143], a[156:159]
v_accvgpr_read_b32 v201, a133
v_accvgpr_read_b32 v202, a134
v_mfma_f32_16x16x32_bf16 a[156:159], v[244:247], v[156:159], a[156:159]
s_waitcnt lgkmcnt(4)
v_accvgpr_read_b32 v203, a135
v_mfma_f32_16x16x32_bf16 a[144:147], v[224:227], v[160:163], a[144:147]
ds_read_b64_tr_b16 v[240:241], v12 offset:8704
ds_read_b64_tr_b16 v[242:243], v12 offset:10752
v_mfma_f32_16x16x32_bf16 a[144:147], v[228:231], v[0:3], a[144:147]
v_cvt_pk_bf16_f32 v48, v200, v201
v_cvt_pk_bf16_f32 v49, v202, v203
v_mfma_f32_16x16x32_bf16 a[148:151], v[224:227], v[164:167], a[148:151]
v_accvgpr_read_b32 v208, a136
v_accvgpr_read_b32 v209, a137
v_mfma_f32_16x16x32_bf16 a[148:151], v[228:231], v[32:35], a[148:151]
v_accvgpr_read_b32 v210, a138
v_accvgpr_read_b32 v211, a139
v_mfma_f32_16x16x32_bf16 a[152:155], v[224:227], v[168:171], a[152:155]
ds_read_b64_tr_b16 v[244:245], v12 offset:25088
ds_read_b64_tr_b16 v[246:247], v12 offset:27136
v_mfma_f32_16x16x32_bf16 a[152:155], v[228:231], v[64:67], a[152:155]
v_cvt_pk_bf16_f32 v80, v208, v209
v_cvt_pk_bf16_f32 v81, v210, v211
v_mfma_f32_16x16x32_bf16 a[156:159], v[224:227], v[172:175], a[156:159]
v_accvgpr_read_b32 v216, a140
v_accvgpr_read_b32 v217, a141
v_mfma_f32_16x16x32_bf16 a[156:159], v[228:231], v[96:99], a[156:159]
s_waitcnt lgkmcnt(4)
v_accvgpr_read_b32 v218, a142
v_mfma_f32_16x16x32_bf16 a[160:163], v[232:235], v[4:7], a[160:163]
ds_read_b64_tr_b16 v[224:225], v12 offset:41472
ds_read_b64_tr_b16 v[226:227], v12 offset:43520
v_mfma_f32_16x16x32_bf16 a[160:163], v[236:239], v[176:179], a[160:163]
v_accvgpr_read_b32 v219, a143
v_cvt_pk_bf16_f32 v112, v216, v217
v_mfma_f32_16x16x32_bf16 a[164:167], v[232:235], v[36:39], a[164:167]
v_cvt_pk_bf16_f32 v113, v218, v219
v_accvgpr_read_b32 v196, a144
v_mfma_f32_16x16x32_bf16 a[164:167], v[236:239], v[180:183], a[164:167]
v_accvgpr_read_b32 v197, a145
v_accvgpr_read_b32 v198, a146
v_mfma_f32_16x16x32_bf16 a[168:171], v[232:235], v[68:71], a[168:171]
ds_read_b64_tr_b16 v[228:229], v12 offset:57856
ds_read_b64_tr_b16 v[230:231], v12 offset:59904
v_mfma_f32_16x16x32_bf16 a[168:171], v[236:239], v[184:187], a[168:171]
v_accvgpr_read_b32 v199, a147
v_cvt_pk_bf16_f32 v18, v196, v197
v_mfma_f32_16x16x32_bf16 a[172:175], v[232:235], v[100:103], a[172:175]
v_cvt_pk_bf16_f32 v19, v198, v199
buffer_store_dwordx4 v[16:19], v252, s[20:23], s44 offen offset:0 sc1
v_mfma_f32_16x16x32_bf16 a[172:175], v[236:239], v[188:191], a[172:175]
s_waitcnt lgkmcnt(4)
v_accvgpr_read_b32 v204, a148
v_mfma_f32_16x16x32_bf16 a[160:163], v[240:243], v[128:131], a[160:163]
ds_read_b64_tr_b16 v[232:233], v250 offset:41472
ds_read_b64_tr_b16 v[234:235], v250 offset:43520
v_mfma_f32_16x16x32_bf16 a[160:163], v[244:247], v[144:147], a[160:163]
v_accvgpr_read_b32 v205, a149
v_accvgpr_read_b32 v206, a150
v_mfma_f32_16x16x32_bf16 a[164:167], v[240:243], v[132:135], a[164:167]
v_accvgpr_read_b32 v207, a151
v_cvt_pk_bf16_f32 v50, v204, v205
v_mfma_f32_16x16x32_bf16 a[164:167], v[244:247], v[148:151], a[164:167]
v_cvt_pk_bf16_f32 v51, v206, v207
buffer_store_dwordx4 v[48:51], v252, s[20:23], s45 offen offset:0 sc1
v_mfma_f32_16x16x32_bf16 a[168:171], v[240:243], v[136:139], a[168:171]
ds_read_b64_tr_b16 v[236:237], v250 offset:57856
ds_read_b64_tr_b16 v[238:239], v250 offset:59904
v_mfma_f32_16x16x32_bf16 a[168:171], v[244:247], v[152:155], a[168:171]
v_accvgpr_read_b32 v212, a152
v_accvgpr_read_b32 v213, a153
v_mfma_f32_16x16x32_bf16 a[172:175], v[240:243], v[140:143], a[172:175]
v_accvgpr_read_b32 v214, a154
v_accvgpr_read_b32 v215, a155
v_mfma_f32_16x16x32_bf16 a[172:175], v[244:247], v[156:159], a[172:175]
s_waitcnt lgkmcnt(4)
v_cvt_pk_bf16_f32 v82, v212, v213
v_mfma_f32_16x16x32_bf16 a[160:163], v[224:227], v[160:163], a[160:163]
ds_read_b64_tr_b16 v[240:241], v13 offset:8704
ds_read_b64_tr_b16 v[242:243], v13 offset:10752
v_mfma_f32_16x16x32_bf16 a[160:163], v[228:231], v[0:3], a[160:163]
v_cvt_pk_bf16_f32 v83, v214, v215
buffer_store_dwordx4 v[80:83], v252, s[20:23], s46 offen offset:0 sc1
v_mfma_f32_16x16x32_bf16 a[164:167], v[224:227], v[164:167], a[164:167]
v_accvgpr_read_b32 v220, a156
v_accvgpr_read_b32 v221, a157
v_mfma_f32_16x16x32_bf16 a[164:167], v[228:231], v[32:35], a[164:167]
v_accvgpr_read_b32 v222, a158
v_accvgpr_read_b32 v223, a159
v_mfma_f32_16x16x32_bf16 a[168:171], v[224:227], v[168:171], a[168:171]
ds_read_b64_tr_b16 v[244:245], v13 offset:25088
ds_read_b64_tr_b16 v[246:247], v13 offset:27136
v_mfma_f32_16x16x32_bf16 a[168:171], v[228:231], v[64:67], a[168:171]
v_cvt_pk_bf16_f32 v114, v220, v221
v_cvt_pk_bf16_f32 v115, v222, v223
v_mfma_f32_16x16x32_bf16 a[172:175], v[224:227], v[172:175], a[172:175]
buffer_store_dwordx4 v[112:115], v252, s[20:23], s47 offen offset:0 sc1
v_accvgpr_read_b32 v192, a160
v_mfma_f32_16x16x32_bf16 a[172:175], v[228:231], v[96:99], a[172:175]
s_waitcnt lgkmcnt(4)
v_accvgpr_read_b32 v193, a161
v_mfma_f32_16x16x32_bf16 a[176:179], v[232:235], v[4:7], a[176:179]
ds_read_b64_tr_b16 v[224:225], v13 offset:41472
ds_read_b64_tr_b16 v[226:227], v13 offset:43520
v_mfma_f32_16x16x32_bf16 a[176:179], v[236:239], v[176:179], a[176:179]
v_accvgpr_read_b32 v194, a162
v_accvgpr_read_b32 v195, a163
v_mfma_f32_16x16x32_bf16 a[180:183], v[232:235], v[36:39], a[180:183]
v_cvt_pk_bf16_f32 v20, v192, v193
v_cvt_pk_bf16_f32 v21, v194, v195
v_mfma_f32_16x16x32_bf16 a[180:183], v[236:239], v[180:183], a[180:183]
v_accvgpr_read_b32 v200, a164
v_accvgpr_read_b32 v201, a165
v_mfma_f32_16x16x32_bf16 a[184:187], v[232:235], v[68:71], a[184:187]
ds_read_b64_tr_b16 v[228:229], v13 offset:57856
ds_read_b64_tr_b16 v[230:231], v13 offset:59904
v_mfma_f32_16x16x32_bf16 a[184:187], v[236:239], v[184:187], a[184:187]
v_accvgpr_read_b32 v202, a166
v_accvgpr_read_b32 v203, a167
v_mfma_f32_16x16x32_bf16 a[188:191], v[232:235], v[100:103], a[188:191]
v_cvt_pk_bf16_f32 v52, v200, v201
v_cvt_pk_bf16_f32 v53, v202, v203
v_mfma_f32_16x16x32_bf16 a[188:191], v[236:239], v[188:191], a[188:191]
s_waitcnt lgkmcnt(4)
v_accvgpr_read_b32 v208, a168
v_mfma_f32_16x16x32_bf16 a[176:179], v[240:243], v[128:131], a[176:179]
ds_read_b64_tr_b16 v[232:233], v249 offset:45056
ds_read_b64_tr_b16 v[234:235], v249 offset:47104
v_mfma_f32_16x16x32_bf16 a[176:179], v[244:247], v[144:147], a[176:179]
v_accvgpr_read_b32 v209, a169
v_accvgpr_read_b32 v210, a170
v_mfma_f32_16x16x32_bf16 a[180:183], v[240:243], v[132:135], a[180:183]
v_accvgpr_read_b32 v211, a171
v_cvt_pk_bf16_f32 v84, v208, v209
v_mfma_f32_16x16x32_bf16 a[180:183], v[244:247], v[148:151], a[180:183]
v_cvt_pk_bf16_f32 v85, v210, v211
v_accvgpr_read_b32 v216, a172
v_mfma_f32_16x16x32_bf16 a[184:187], v[240:243], v[136:139], a[184:187]
ds_read_b64_tr_b16 v[236:237], v249 offset:61440
ds_read_b64_tr_b16 v[238:239], v249 offset:63488
v_mfma_f32_16x16x32_bf16 a[184:187], v[244:247], v[152:155], a[184:187]
v_accvgpr_read_b32 v217, a173
v_accvgpr_read_b32 v218, a174
v_mfma_f32_16x16x32_bf16 a[188:191], v[240:243], v[140:143], a[188:191]
v_accvgpr_read_b32 v219, a175
v_cvt_pk_bf16_f32 v116, v216, v217
v_mfma_f32_16x16x32_bf16 a[188:191], v[244:247], v[156:159], a[188:191]
s_waitcnt lgkmcnt(4)
v_cvt_pk_bf16_f32 v117, v218, v219
v_mfma_f32_16x16x32_bf16 a[176:179], v[224:227], v[160:163], a[176:179]
ds_read_b64_tr_b16 v[240:241], v12 offset:12288
ds_read_b64_tr_b16 v[242:243], v12 offset:14336
v_mfma_f32_16x16x32_bf16 a[176:179], v[228:231], v[0:3], a[176:179]
s_add_u32 s8, s16, 0x0
s_addc_u32 s9, s17, 0
s_mov_b32 s10, 0x4e20
v_mfma_f32_16x16x32_bf16 a[180:183], v[224:227], v[164:167], a[180:183]
s_mov_b32 s11, 0x00020000
s_mul_i32 s35, s37, 3
s_lshl_b32 s36, s38, 4
v_mfma_f32_16x16x32_bf16 a[180:183], v[228:231], v[32:35], a[180:183]
s_add_u32 s35, s35, s36
s_lshl_b32 s35, s35, 5
v_lshrrev_b32 v253, 3, v252
v_mfma_f32_16x16x32_bf16 a[184:187], v[224:227], v[168:171], a[184:187]
ds_read_b64_tr_b16 v[244:245], v12 offset:28672
ds_read_b64_tr_b16 v[246:247], v12 offset:30720
buffer_load_ushort v255, v253, s[8:11], s35 offen
v_mfma_f32_16x16x32_bf16 a[184:187], v[228:231], v[64:67], a[184:187]
s_mov_b32 s33, 0x6c01400
buffer_load_dword v254, off, s[56:59], s33 sc1
v_mfma_f32_16x16x32_bf16 a[188:191], v[224:227], v[172:175], a[188:191]
v_accvgpr_read_b32 v196, a176
v_accvgpr_read_b32 v197, a177
v_mfma_f32_16x16x32_bf16 a[188:191], v[228:231], v[96:99], a[188:191]
s_waitcnt lgkmcnt(4)
v_accvgpr_read_b32 v198, a178
v_mfma_f32_16x16x32_bf16 a[192:195], v[232:235], v[4:7], a[192:195]
ds_read_b64_tr_b16 v[224:225], v12 offset:45056
ds_read_b64_tr_b16 v[226:227], v12 offset:47104
v_mfma_f32_16x16x32_bf16 a[192:195], v[236:239], v[176:179], a[192:195]
v_accvgpr_read_b32 v199, a179
v_cvt_pk_bf16_f32 v22, v196, v197
v_mfma_f32_16x16x32_bf16 a[196:199], v[232:235], v[36:39], a[196:199]
v_cvt_pk_bf16_f32 v23, v198, v199
buffer_store_dwordx4 v[20:23], v252, s[20:23], s44 offen offset:1024 sc1
v_mfma_f32_16x16x32_bf16 a[196:199], v[236:239], v[180:183], a[196:199]
v_accvgpr_read_b32 v204, a180
v_accvgpr_read_b32 v205, a181
v_mfma_f32_16x16x32_bf16 a[200:203], v[232:235], v[68:71], a[200:203]
ds_read_b64_tr_b16 v[228:229], v12 offset:61440
ds_read_b64_tr_b16 v[230:231], v12 offset:63488
v_mfma_f32_16x16x32_bf16 a[200:203], v[236:239], v[184:187], a[200:203]
v_accvgpr_read_b32 v206, a182
v_accvgpr_read_b32 v207, a183
v_mfma_f32_16x16x32_bf16 a[204:207], v[232:235], v[100:103], a[204:207]
v_cvt_pk_bf16_f32 v54, v204, v205
v_cvt_pk_bf16_f32 v55, v206, v207
v_mfma_f32_16x16x32_bf16 a[204:207], v[236:239], v[188:191], a[204:207]
s_waitcnt lgkmcnt(4)
buffer_store_dwordx4 v[52:55], v252, s[20:23], s45 offen offset:1024 sc1
v_mfma_f32_16x16x32_bf16 a[192:195], v[240:243], v[128:131], a[192:195]
ds_read_b64_tr_b16 v[232:233], v250 offset:45056
ds_read_b64_tr_b16 v[234:235], v250 offset:47104
v_mfma_f32_16x16x32_bf16 a[192:195], v[244:247], v[144:147], a[192:195]
v_accvgpr_read_b32 v212, a184
v_accvgpr_read_b32 v213, a185
v_mfma_f32_16x16x32_bf16 a[196:199], v[240:243], v[132:135], a[196:199]
v_accvgpr_read_b32 v214, a186
v_accvgpr_read_b32 v215, a187
v_mfma_f32_16x16x32_bf16 a[196:199], v[244:247], v[148:151], a[196:199]
v_cvt_pk_bf16_f32 v86, v212, v213
v_cvt_pk_bf16_f32 v87, v214, v215
v_mfma_f32_16x16x32_bf16 a[200:203], v[240:243], v[136:139], a[200:203]
ds_read_b64_tr_b16 v[236:237], v250 offset:61440
ds_read_b64_tr_b16 v[238:239], v250 offset:63488
v_mfma_f32_16x16x32_bf16 a[200:203], v[244:247], v[152:155], a[200:203]
buffer_store_dwordx4 v[84:87], v252, s[20:23], s46 offen offset:1024 sc1
v_accvgpr_read_b32 v220, a188
v_mfma_f32_16x16x32_bf16 a[204:207], v[240:243], v[140:143], a[204:207]
v_accvgpr_read_b32 v221, a189
v_accvgpr_read_b32 v222, a190
v_mfma_f32_16x16x32_bf16 a[204:207], v[244:247], v[156:159], a[204:207]
s_waitcnt lgkmcnt(4)
v_accvgpr_read_b32 v223, a191
v_mfma_f32_16x16x32_bf16 a[192:195], v[224:227], v[160:163], a[192:195]
ds_read_b64_tr_b16 v[240:241], v13 offset:12288
ds_read_b64_tr_b16 v[242:243], v13 offset:14336
v_mfma_f32_16x16x32_bf16 a[192:195], v[228:231], v[0:3], a[192:195]
v_cvt_pk_bf16_f32 v118, v220, v221
v_cvt_pk_bf16_f32 v119, v222, v223
v_mfma_f32_16x16x32_bf16 a[196:199], v[224:227], v[164:167], a[196:199]
buffer_store_dwordx4 v[116:119], v252, s[20:23], s47 offen offset:1024 sc1
v_mfma_f32_16x16x32_bf16 a[196:199], v[228:231], v[32:35], a[196:199]
v_mfma_f32_16x16x32_bf16 a[200:203], v[224:227], v[168:171], a[200:203]
ds_read_b64_tr_b16 v[244:245], v13 offset:28672
ds_read_b64_tr_b16 v[246:247], v13 offset:30720
v_mfma_f32_16x16x32_bf16 a[200:203], v[228:231], v[64:67], a[200:203]
v_mfma_f32_16x16x32_bf16 a[204:207], v[224:227], v[172:175], a[204:207]
v_accvgpr_read_b32 v192, a192
v_accvgpr_read_b32 v193, a193
v_mfma_f32_16x16x32_bf16 a[204:207], v[228:231], v[96:99], a[204:207]
s_waitcnt lgkmcnt(4)
v_accvgpr_read_b32 v194, a194
v_mfma_f32_16x16x32_bf16 a[208:211], v[232:235], v[4:7], a[208:211]
ds_read_b64_tr_b16 v[224:225], v13 offset:45056
ds_read_b64_tr_b16 v[226:227], v13 offset:47104
v_mfma_f32_16x16x32_bf16 a[208:211], v[236:239], v[176:179], a[208:211]
v_accvgpr_read_b32 v195, a195
v_cvt_pk_bf16_f32 v24, v192, v193
v_mfma_f32_16x16x32_bf16 a[212:215], v[232:235], v[36:39], a[212:215]
v_cvt_pk_bf16_f32 v25, v194, v195
v_accvgpr_read_b32 v200, a196
v_mfma_f32_16x16x32_bf16 a[212:215], v[236:239], v[180:183], a[212:215]
v_accvgpr_read_b32 v201, a197
v_accvgpr_read_b32 v202, a198
v_mfma_f32_16x16x32_bf16 a[216:219], v[232:235], v[68:71], a[216:219]
ds_read_b64_tr_b16 v[228:229], v13 offset:61440
ds_read_b64_tr_b16 v[230:231], v13 offset:63488
v_mfma_f32_16x16x32_bf16 a[216:219], v[236:239], v[184:187], a[216:219]
v_accvgpr_read_b32 v203, a199
v_cvt_pk_bf16_f32 v56, v200, v201
v_mfma_f32_16x16x32_bf16 a[220:223], v[232:235], v[100:103], a[220:223]
v_cvt_pk_bf16_f32 v57, v202, v203
v_accvgpr_read_b32 v208, a200
v_mfma_f32_16x16x32_bf16 a[220:223], v[236:239], v[188:191], a[220:223]
s_waitcnt lgkmcnt(4)
v_accvgpr_read_b32 v209, a201
v_mfma_f32_16x16x32_bf16 a[208:211], v[240:243], v[128:131], a[208:211]
ds_read_b64_tr_b16 v[232:233], v249 offset:45568
ds_read_b64_tr_b16 v[234:235], v249 offset:47616
v_mfma_f32_16x16x32_bf16 a[208:211], v[244:247], v[144:147], a[208:211]
v_accvgpr_read_b32 v210, a202
v_accvgpr_read_b32 v211, a203
v_mfma_f32_16x16x32_bf16 a[212:215], v[240:243], v[132:135], a[212:215]
v_cvt_pk_bf16_f32 v88, v208, v209
v_cvt_pk_bf16_f32 v89, v210, v211
v_mfma_f32_16x16x32_bf16 a[212:215], v[244:247], v[148:151], a[212:215]
v_accvgpr_read_b32 v216, a204
v_accvgpr_read_b32 v217, a205
v_mfma_f32_16x16x32_bf16 a[216:219], v[240:243], v[136:139], a[216:219]
ds_read_b64_tr_b16 v[236:237], v249 offset:61952
ds_read_b64_tr_b16 v[238:239], v249 offset:64000
v_mfma_f32_16x16x32_bf16 a[216:219], v[244:247], v[152:155], a[216:219]
v_accvgpr_read_b32 v218, a206
v_accvgpr_read_b32 v219, a207
v_mfma_f32_16x16x32_bf16 a[220:223], v[240:243], v[140:143], a[220:223]
v_cvt_pk_bf16_f32 v120, v216, v217
v_cvt_pk_bf16_f32 v121, v218, v219
v_mfma_f32_16x16x32_bf16 a[220:223], v[244:247], v[156:159], a[220:223]
s_waitcnt lgkmcnt(4)
v_mfma_f32_16x16x32_bf16 a[208:211], v[224:227], v[160:163], a[208:211]
ds_read_b64_tr_b16 v[240:241], v12 offset:12800
ds_read_b64_tr_b16 v[242:243], v12 offset:14848
v_mfma_f32_16x16x32_bf16 a[208:211], v[228:231], v[0:3], a[208:211]
v_mfma_f32_16x16x32_bf16 a[212:215], v[224:227], v[164:167], a[212:215]
v_mfma_f32_16x16x32_bf16 a[212:215], v[228:231], v[32:35], a[212:215]
v_mfma_f32_16x16x32_bf16 a[216:219], v[224:227], v[168:171], a[216:219]
ds_read_b64_tr_b16 v[244:245], v12 offset:29184
ds_read_b64_tr_b16 v[246:247], v12 offset:31232
v_mfma_f32_16x16x32_bf16 a[216:219], v[228:231], v[64:67], a[216:219]
v_mfma_f32_16x16x32_bf16 a[220:223], v[224:227], v[172:175], a[220:223]
s_nop 0
v_accvgpr_read_b32 v196, a208
v_accvgpr_read_b32 v197, a209
v_mfma_f32_16x16x32_bf16 a[220:223], v[228:231], v[96:99], a[220:223]
s_waitcnt lgkmcnt(4)
v_accvgpr_read_b32 v198, a210
v_mfma_f32_16x16x32_bf16 a[224:227], v[232:235], v[4:7], a[224:227]
ds_read_b64_tr_b16 v[224:225], v12 offset:45568
ds_read_b64_tr_b16 v[226:227], v12 offset:47616
v_mfma_f32_16x16x32_bf16 a[224:227], v[236:239], v[176:179], a[224:227]
v_accvgpr_read_b32 v199, a211
v_cvt_pk_bf16_f32 v26, v196, v197
v_mfma_f32_16x16x32_bf16 a[228:231], v[232:235], v[36:39], a[228:231]
v_cvt_pk_bf16_f32 v27, v198, v199
buffer_store_dwordx4 v[24:27], v252, s[20:23], s44 offen offset:2048 sc1
v_mfma_f32_16x16x32_bf16 a[228:231], v[236:239], v[180:183], a[228:231]
v_accvgpr_read_b32 v204, a212
v_accvgpr_read_b32 v205, a213
v_mfma_f32_16x16x32_bf16 a[232:235], v[232:235], v[68:71], a[232:235]
ds_read_b64_tr_b16 v[228:229], v12 offset:61952
ds_read_b64_tr_b16 v[230:231], v12 offset:64000
v_mfma_f32_16x16x32_bf16 a[232:235], v[236:239], v[184:187], a[232:235]
v_accvgpr_read_b32 v206, a214
v_accvgpr_read_b32 v207, a215
v_mfma_f32_16x16x32_bf16 a[236:239], v[232:235], v[100:103], a[236:239]
v_cvt_pk_bf16_f32 v58, v204, v205
v_cvt_pk_bf16_f32 v59, v206, v207
v_mfma_f32_16x16x32_bf16 a[236:239], v[236:239], v[188:191], a[236:239]
s_waitcnt lgkmcnt(4)
buffer_store_dwordx4 v[56:59], v252, s[20:23], s45 offen offset:2048 sc1
v_mfma_f32_16x16x32_bf16 a[224:227], v[240:243], v[128:131], a[224:227]
ds_read_b64_tr_b16 v[232:233], v250 offset:45568
ds_read_b64_tr_b16 v[234:235], v250 offset:47616
v_mfma_f32_16x16x32_bf16 a[224:227], v[244:247], v[144:147], a[224:227]
v_accvgpr_read_b32 v212, a216
v_accvgpr_read_b32 v213, a217
v_mfma_f32_16x16x32_bf16 a[228:231], v[240:243], v[132:135], a[228:231]
v_accvgpr_read_b32 v214, a218
v_accvgpr_read_b32 v215, a219
v_mfma_f32_16x16x32_bf16 a[228:231], v[244:247], v[148:151], a[228:231]
v_cvt_pk_bf16_f32 v90, v212, v213
v_cvt_pk_bf16_f32 v91, v214, v215
v_mfma_f32_16x16x32_bf16 a[232:235], v[240:243], v[136:139], a[232:235]
ds_read_b64_tr_b16 v[236:237], v250 offset:61952
ds_read_b64_tr_b16 v[238:239], v250 offset:64000
v_mfma_f32_16x16x32_bf16 a[232:235], v[244:247], v[152:155], a[232:235]
buffer_store_dwordx4 v[88:91], v252, s[20:23], s46 offen offset:2048 sc1
v_accvgpr_read_b32 v220, a220
v_mfma_f32_16x16x32_bf16 a[236:239], v[240:243], v[140:143], a[236:239]
v_accvgpr_read_b32 v221, a221
v_accvgpr_read_b32 v222, a222
v_mfma_f32_16x16x32_bf16 a[236:239], v[244:247], v[156:159], a[236:239]
s_waitcnt lgkmcnt(4)
v_accvgpr_read_b32 v223, a223
v_mfma_f32_16x16x32_bf16 a[224:227], v[224:227], v[160:163], a[224:227]
ds_read_b64_tr_b16 v[240:241], v13 offset:12800
ds_read_b64_tr_b16 v[242:243], v13 offset:14848
v_mfma_f32_16x16x32_bf16 a[224:227], v[228:231], v[0:3], a[224:227]
v_cvt_pk_bf16_f32 v122, v220, v221
v_cvt_pk_bf16_f32 v123, v222, v223
v_mfma_f32_16x16x32_bf16 a[228:231], v[224:227], v[164:167], a[228:231]
buffer_store_dwordx4 v[120:123], v252, s[20:23], s47 offen offset:2048 sc1
v_mfma_f32_16x16x32_bf16 a[228:231], v[228:231], v[32:35], a[228:231]
v_mfma_f32_16x16x32_bf16 a[232:235], v[224:227], v[168:171], a[232:235]
ds_read_b64_tr_b16 v[244:245], v13 offset:29184
ds_read_b64_tr_b16 v[246:247], v13 offset:31232
v_mfma_f32_16x16x32_bf16 a[232:235], v[228:231], v[64:67], a[232:235]
v_mfma_f32_16x16x32_bf16 a[236:239], v[224:227], v[172:175], a[236:239]
v_accvgpr_read_b32 v192, a224
v_accvgpr_read_b32 v193, a225
v_mfma_f32_16x16x32_bf16 a[236:239], v[228:231], v[96:99], a[236:239]
s_waitcnt lgkmcnt(4)
v_accvgpr_read_b32 v194, a226
v_mfma_f32_16x16x32_bf16 a[240:243], v[232:235], v[4:7], a[240:243]
ds_read_b64_tr_b16 v[224:225], v13 offset:45568
ds_read_b64_tr_b16 v[226:227], v13 offset:47616
v_mfma_f32_16x16x32_bf16 a[240:243], v[236:239], v[176:179], a[240:243]
v_accvgpr_read_b32 v195, a227
v_cvt_pk_bf16_f32 v28, v192, v193
v_mfma_f32_16x16x32_bf16 a[244:247], v[232:235], v[36:39], a[244:247]
v_cvt_pk_bf16_f32 v29, v194, v195
v_accvgpr_read_b32 v200, a228
v_mfma_f32_16x16x32_bf16 a[244:247], v[236:239], v[180:183], a[244:247]
v_accvgpr_read_b32 v201, a229
v_accvgpr_read_b32 v202, a230
v_mfma_f32_16x16x32_bf16 a[248:251], v[232:235], v[68:71], a[248:251]
ds_read_b64_tr_b16 v[228:229], v13 offset:61952
ds_read_b64_tr_b16 v[230:231], v13 offset:64000
v_mfma_f32_16x16x32_bf16 a[248:251], v[236:239], v[184:187], a[248:251]
v_accvgpr_read_b32 v203, a231
v_cvt_pk_bf16_f32 v60, v200, v201
v_mfma_f32_16x16x32_bf16 a[252:255], v[232:235], v[100:103], a[252:255]
v_cvt_pk_bf16_f32 v61, v202, v203
v_accvgpr_read_b32 v208, a232
v_mfma_f32_16x16x32_bf16 a[252:255], v[236:239], v[188:191], a[252:255]
s_waitcnt lgkmcnt(4)
v_accvgpr_read_b32 v209, a233
v_mfma_f32_16x16x32_bf16 a[240:243], v[240:243], v[128:131], a[240:243]
v_accvgpr_read_b32 v210, a234
v_accvgpr_read_b32 v211, a235
v_mfma_f32_16x16x32_bf16 a[240:243], v[244:247], v[144:147], a[240:243]
v_cvt_pk_bf16_f32 v92, v208, v209
v_cvt_pk_bf16_f32 v93, v210, v211
v_mfma_f32_16x16x32_bf16 a[244:247], v[240:243], v[132:135], a[244:247]
v_accvgpr_read_b32 v216, a236
v_accvgpr_read_b32 v217, a237
v_mfma_f32_16x16x32_bf16 a[244:247], v[244:247], v[148:151], a[244:247]
v_accvgpr_read_b32 v218, a238
v_accvgpr_read_b32 v219, a239
v_mfma_f32_16x16x32_bf16 a[248:251], v[240:243], v[136:139], a[248:251]
v_cvt_pk_bf16_f32 v124, v216, v217
v_cvt_pk_bf16_f32 v125, v218, v219
v_mfma_f32_16x16x32_bf16 a[248:251], v[244:247], v[152:155], a[248:251]
v_mfma_f32_16x16x32_bf16 a[252:255], v[240:243], v[140:143], a[252:255]
v_mfma_f32_16x16x32_bf16 a[252:255], v[244:247], v[156:159], a[252:255]
s_waitcnt lgkmcnt(0)
v_mfma_f32_16x16x32_bf16 a[240:243], v[224:227], v[160:163], a[240:243]
v_mfma_f32_16x16x32_bf16 a[240:243], v[228:231], v[0:3], a[240:243]
v_mfma_f32_16x16x32_bf16 a[244:247], v[224:227], v[164:167], a[244:247]
v_mfma_f32_16x16x32_bf16 a[244:247], v[228:231], v[32:35], a[244:247]
v_mfma_f32_16x16x32_bf16 a[248:251], v[224:227], v[168:171], a[248:251]
v_mfma_f32_16x16x32_bf16 a[248:251], v[228:231], v[64:67], a[248:251]
v_mfma_f32_16x16x32_bf16 a[252:255], v[224:227], v[172:175], a[252:255]
s_nop 2
v_accvgpr_read_b32 v196, a240
v_accvgpr_read_b32 v197, a241
v_accvgpr_read_b32 v198, a242
v_accvgpr_read_b32 v199, a243
v_mfma_f32_16x16x32_bf16 a[252:255], v[228:231], v[96:99], a[252:255]
v_cvt_pk_bf16_f32 v30, v196, v197
v_cvt_pk_bf16_f32 v31, v198, v199
buffer_store_dwordx4 v[28:31], v252, s[20:23], s44 offen offset:3072 sc1
v_accvgpr_read_b32 v204, a244
v_accvgpr_read_b32 v205, a245
v_accvgpr_read_b32 v206, a246
v_accvgpr_read_b32 v207, a247
v_cvt_pk_bf16_f32 v62, v204, v205
v_cvt_pk_bf16_f32 v63, v206, v207
buffer_store_dwordx4 v[60:63], v252, s[20:23], s45 offen offset:3072 sc1
v_accvgpr_read_b32 v212, a248
v_accvgpr_read_b32 v213, a249
v_accvgpr_read_b32 v214, a250
v_accvgpr_read_b32 v215, a251
v_cvt_pk_bf16_f32 v94, v212, v213
v_cvt_pk_bf16_f32 v95, v214, v215
buffer_store_dwordx4 v[92:95], v252, s[20:23], s46 offen offset:3072 sc1
v_accvgpr_read_b32 v220, a252
v_accvgpr_read_b32 v221, a253
v_accvgpr_read_b32 v222, a254
v_accvgpr_read_b32 v223, a255
v_cvt_pk_bf16_f32 v126, v220, v221
v_cvt_pk_bf16_f32 v127, v222, v223
buffer_store_dwordx4 v[124:127], v252, s[20:23], s47 offen offset:3072 sc1
s_waitcnt vmcnt(12)
v_readfirstlane_b32 s99, v254
s_branch L2_chk
L2_tail_1_7:
s_waitcnt lgkmcnt(4)
v_mfma_f32_16x16x32_bf16 a[0:3], v[224:227], v[160:163], a[0:3]
ds_read_b128 v[240:243], v248 offset:2048
v_mfma_f32_16x16x32_bf16 a[0:3], v[228:231], v[176:179], a[0:3]
s_lshl_b32 s36, s34, 13
v_mfma_f32_16x16x32_bf16 a[4:7], v[224:227], v[164:167], a[4:7]
s_add_u32 s56, s4, 0x1000000
s_addc_u32 s57, s5, 0
v_mfma_f32_16x16x32_bf16 a[4:7], v[228:231], v[180:183], a[4:7]
s_add_u32 s36, s36, 0x20000
s_mov_b32 s58, 0x6c02000
v_mfma_f32_16x16x32_bf16 a[8:11], v[224:227], v[168:171], a[8:11]
ds_read_b128 v[244:247], v248 offset:2560
s_mov_b32 s59, 0x00020000
v_mfma_f32_16x16x32_bf16 a[8:11], v[228:231], v[184:187], a[8:11]
v_add_u32 v255, s36, v252
s_lshr_b32 s35, s2, 1
v_mfma_f32_16x16x32_bf16 a[12:15], v[224:227], v[172:175], a[12:15]
s_and_b32 s35, s35, 28
s_add_u32 s35, s35, s34
v_mfma_f32_16x16x32_bf16 a[12:15], v[228:231], v[188:191], a[12:15]
s_waitcnt lgkmcnt(2)
s_lshl_b32 s35, s35, 13
v_mfma_f32_16x16x32_bf16 a[16:19], v[232:235], v[160:163], a[16:19]
ds_read_b128 v[224:227], v248 offset:6144
v_lshlrev_b32 v253, 3, v252
v_mfma_f32_16x16x32_bf16 a[16:19], v[236:239], v[176:179], a[16:19]
buffer_load_dword v253, v253, s[56:59], s35 offen
ds_write_b128 v255, v[160:163] offset:0
v_mfma_f32_16x16x32_bf16 a[20:23], v[232:235], v[164:167], a[20:23]
v_exp_f32 v192, v192
v_mfma_f32_16x16x32_bf16 a[20:23], v[236:239], v[180:183], a[20:23]
v_exp_f32 v193, v193
v_mfma_f32_16x16x32_bf16 a[24:27], v[232:235], v[168:171], a[24:27]
ds_read_b128 v[228:231], v248 offset:6656
v_cvt_pk_bf16_f32 v128, v192, v193
v_mfma_f32_16x16x32_bf16 a[24:27], v[236:239], v[184:187], a[24:27]
v_exp_f32 v194, v194
v_mfma_f32_16x16x32_bf16 a[28:31], v[232:235], v[172:175], a[28:31]
v_exp_f32 v195, v195
v_mfma_f32_16x16x32_bf16 a[28:31], v[236:239], v[188:191], a[28:31]
s_waitcnt lgkmcnt(3)
v_cvt_pk_bf16_f32 v129, v194, v195
v_mfma_f32_16x16x32_bf16 v[208:211], v[240:243], v[0:3], 0
ds_read_b128 v[232:235], v248 offset:10240
ds_write_b128 v255, v[164:167] offset:1024
v_mfma_f32_16x16x32_bf16 v[208:211], v[244:247], v[4:7], v[208:211]
v_exp_f32 v196, v196
v_mfma_f32_16x16x32_bf16 v[212:215], v[240:243], v[32:35], 0
v_exp_f32 v197, v197
v_mfma_f32_16x16x32_bf16 v[212:215], v[244:247], v[36:39], v[212:215]
v_exp_f32 v198, v198
v_mfma_f32_16x16x32_bf16 v[216:219], v[240:243], v[64:67], 0
ds_read_b128 v[236:239], v248 offset:10752
v_cvt_pk_bf16_f32 v132, v196, v197
v_mfma_f32_16x16x32_bf16 v[216:219], v[244:247], v[68:71], v[216:219]
v_exp_f32 v199, v199
v_mfma_f32_16x16x32_bf16 v[220:223], v[240:243], v[96:99], 0
v_exp_f32 v200, v200
v_mfma_f32_16x16x32_bf16 v[220:223], v[244:247], v[100:103], v[220:223]
s_waitcnt lgkmcnt(3)
v_cvt_pk_bf16_f32 v133, v198, v199
v_mfma_f32_16x16x32_bf16 v[208:211], v[224:227], v[8:11], v[208:211]
ds_read_b128 v[240:243], v248 offset:14336
ds_write_b128 v255, v[168:171] offset:2048
v_mfma_f32_16x16x32_bf16 v[208:211], v[228:231], v[12:15], v[208:211]
v_exp_f32 v201, v201
v_mfma_f32_16x16x32_bf16 v[212:215], v[224:227], v[40:43], v[212:215]
v_exp_f32 v202, v202
v_mfma_f32_16x16x32_bf16 v[212:215], v[228:231], v[44:47], v[212:215]
v_exp_f32 v203, v203
v_mfma_f32_16x16x32_bf16 v[216:219], v[224:227], v[72:75], v[216:219]
ds_read_b128 v[244:247], v248 offset:14848
v_cvt_pk_bf16_f32 v136, v200, v201
v_mfma_f32_16x16x32_bf16 v[216:219], v[228:231], v[76:79], v[216:219]
v_cvt_pk_bf16_f32 v137, v202, v203
ds_write_b128 v255, v[172:175] offset:3072
v_mfma_f32_16x16x32_bf16 v[220:223], v[224:227], v[104:107], v[220:223]
v_exp_f32 v204, v204
v_mfma_f32_16x16x32_bf16 v[220:223], v[228:231], v[108:111], v[220:223]
s_waitcnt lgkmcnt(4)
s_waitcnt vmcnt(1)
s_barrier
v_mfma_f32_16x16x32_bf16 v[208:211], v[232:235], v[16:19], v[208:211]
ds_read_b128 v[224:227], v248 offset:16384
s_add_u32 m0, s30, 0xc000
v_mfma_f32_16x16x32_bf16 v[208:211], v[236:239], v[20:23], v[208:211]
s_and_b32 s100, s30, 0x10000
buffer_load_dwordx4 v251, s[12:15], s28 offen offset:0 lds
v_mfma_f32_16x16x32_bf16 v[212:215], v[232:235], v[48:51], v[212:215]
s_xor_b32 s100, s100, 0x10000
ds_write_b128 v255, v[176:179] offset:4096
v_mfma_f32_16x16x32_bf16 v[212:215], v[236:239], v[52:55], v[212:215]
s_mov_b32 s99, 0
buffer_load_dwordx4 v251, s[12:15], s28 offen offset:1024 lds
v_mfma_f32_16x16x32_bf16 v[216:219], v[232:235], v[80:83], v[216:219]
ds_read_b128 v[228:231], v248 offset:16896
ds_write_b128 v255, v[180:183] offset:5120
v_mfma_f32_16x16x32_bf16 v[216:219], v[236:239], v[84:87], v[216:219]
v_exp_f32 v205, v205
v_mfma_f32_16x16x32_bf16 v[220:223], v[232:235], v[112:115], v[220:223]
v_exp_f32 v206, v206
v_mfma_f32_16x16x32_bf16 v[220:223], v[236:239], v[116:119], v[220:223]
s_waitcnt lgkmcnt(5)
v_cvt_pk_bf16_f32 v140, v204, v205
v_mfma_f32_16x16x32_bf16 v[208:211], v[240:243], v[24:27], v[208:211]
ds_read_b128 v[232:235], v248 offset:20480
buffer_load_dwordx4 v251, s[12:15], s28 offen offset:2048 lds
v_mfma_f32_16x16x32_bf16 v[208:211], v[244:247], v[28:31], v[208:211]
v_exp_f32 v207, v207
v_mfma_f32_16x16x32_bf16 v[212:215], v[240:243], v[56:59], v[212:215]
buffer_load_dwordx4 v251, s[12:15], s28 offen offset:3072 lds
ds_write_b128 v255, v[184:187] offset:6144
v_mfma_f32_16x16x32_bf16 v[212:215], v[244:247], v[60:63], v[212:215]
ds_write_b128 v255, v[188:191] offset:7168
v_mfma_f32_16x16x32_bf16 v[216:219], v[240:243], v[88:91], v[216:219]
ds_read_b128 v[236:239], v248 offset:20992
v_cvt_pk_bf16_f32 v141, v206, v207
v_mfma_f32_16x16x32_bf16 v[216:219], v[244:247], v[92:95], v[216:219]
s_add_u32 s28, s28, 0x4000
s_xor_b32 s30, s30, 0x10000
v_mfma_f32_16x16x32_bf16 v[220:223], v[240:243], v[120:123], v[220:223]
s_add_u32 m0, s30, 0x0
v_mfma_f32_16x16x32_bf16 v[220:223], v[244:247], v[124:127], v[220:223]
s_waitcnt lgkmcnt(5)
buffer_load_dwordx4 v251, s[12:15], s28 offen offset:0 lds
v_mfma_f32_16x16x32_bf16 v[192:195], v[224:227], v[0:3], 0
ds_read_b128 v[240:243], v248 offset:24576
v_mfma_f32_16x16x32_bf16 v[192:195], v[228:231], v[4:7], v[192:195]
v_exp_f32 v208, v208
v_mfma_f32_16x16x32_bf16 v[196:199], v[224:227], v[32:35], 0
v_exp_f32 v209, v209
v_mfma_f32_16x16x32_bf16 v[196:199], v[228:231], v[36:39], v[196:199]
v_exp_f32 v210, v210
v_mfma_f32_16x16x32_bf16 v[200:203], v[224:227], v[64:67], 0
ds_read_b128 v[244:247], v248 offset:25088
v_cvt_pk_bf16_f32 v130, v208, v209
v_mfma_f32_16x16x32_bf16 v[200:203], v[228:231], v[68:71], v[200:203]
v_exp_f32 v211, v211
v_mfma_f32_16x16x32_bf16 v[204:207], v[224:227], v[96:99], 0
v_exp_f32 v212, v212
v_mfma_f32_16x16x32_bf16 v[204:207], v[228:231], v[100:103], v[204:207]
s_waitcnt lgkmcnt(2)
v_cvt_pk_bf16_f32 v131, v210, v211
v_mfma_f32_16x16x32_bf16 v[192:195], v[232:235], v[8:11], v[192:195]
ds_read_b128 v[224:227], v248 offset:28672
buffer_load_dwordx4 v251, s[12:15], s28 offen offset:1024 lds
v_mfma_f32_16x16x32_bf16 v[192:195], v[236:239], v[12:15], v[192:195]
v_exp_f32 v213, v213
v_mfma_f32_16x16x32_bf16 v[196:199], v[232:235], v[40:43], v[196:199]
v_exp_f32 v214, v214
v_mfma_f32_16x16x32_bf16 v[196:199], v[236:239], v[44:47], v[196:199]
v_exp_f32 v215, v215
v_mfma_f32_16x16x32_bf16 v[200:203], v[232:235], v[72:75], v[200:203]
ds_read_b128 v[228:231], v248 offset:29184
v_cvt_pk_bf16_f32 v134, v212, v213
v_mfma_f32_16x16x32_bf16 v[200:203], v[236:239], v[76:79], v[200:203]
v_cvt_pk_bf16_f32 v135, v214, v215
buffer_load_dwordx4 v251, s[12:15], s28 offen offset:2048 lds
v_mfma_f32_16x16x32_bf16 v[204:207], v[232:235], v[104:107], v[204:207]
v_exp_f32 v216, v216
v_mfma_f32_16x16x32_bf16 v[204:207], v[236:239], v[108:111], v[204:207]
s_waitcnt lgkmcnt(2)
buffer_load_dwordx4 v251, s[12:15], s28 offen offset:3072 lds
v_mfma_f32_16x16x32_bf16 v[192:195], v[240:243], v[16:19], v[192:195]
ds_read_b128 v[232:235], v248 offset:18432
v_mfma_f32_16x16x32_bf16 v[192:195], v[244:247], v[20:23], v[192:195]
v_exp_f32 v217, v217
v_mfma_f32_16x16x32_bf16 v[196:199], v[240:243], v[48:51], v[196:199]
v_exp_f32 v218, v218
v_mfma_f32_16x16x32_bf16 v[196:199], v[244:247], v[52:55], v[196:199]
v_exp_f32 v219, v219
v_mfma_f32_16x16x32_bf16 v[200:203], v[240:243], v[80:83], v[200:203]
ds_read_b128 v[236:239], v248 offset:18944
v_cvt_pk_bf16_f32 v138, v216, v217
v_mfma_f32_16x16x32_bf16 v[200:203], v[244:247], v[84:87], v[200:203]
v_cvt_pk_bf16_f32 v139, v218, v219
s_add_u32 s28, s28, 0x4000
v_mfma_f32_16x16x32_bf16 v[204:207], v[240:243], v[112:115], v[204:207]
v_exp_f32 v220, v220
v_mfma_f32_16x16x32_bf16 v[204:207], v[244:247], v[116:119], v[204:207]
s_waitcnt lgkmcnt(2)
v_mfma_f32_16x16x32_bf16 v[192:195], v[224:227], v[24:27], v[192:195]
ds_read_b128 v[240:243], v248 offset:22528
v_mfma_f32_16x16x32_bf16 v[192:195], v[228:231], v[28:31], v[192:195]
v_exp_f32 v221, v221
v_mfma_f32_16x16x32_bf16 v[196:199], v[224:227], v[56:59], v[196:199]
v_exp_f32 v222, v222
v_mfma_f32_16x16x32_bf16 v[196:199], v[228:231], v[60:63], v[196:199]
v_exp_f32 v223, v223
v_mfma_f32_16x16x32_bf16 v[200:203], v[224:227], v[88:91], v[200:203]
ds_read_b128 v[244:247], v248 offset:23040
v_cvt_pk_bf16_f32 v142, v220, v221
v_mfma_f32_16x16x32_bf16 v[200:203], v[228:231], v[92:95], v[200:203]
v_cvt_pk_bf16_f32 v143, v222, v223
v_mfma_f32_16x16x32_bf16 v[204:207], v[224:227], v[120:123], v[204:207]
v_mfma_f32_16x16x32_bf16 v[204:207], v[228:231], v[124:127], v[204:207]
s_waitcnt lgkmcnt(2)
v_mfma_f32_16x16x32_bf16 v[208:211], v[232:235], v[0:3], 0
ds_read_b128 v[224:227], v248 offset:26624
v_mfma_f32_16x16x32_bf16 v[208:211], v[236:239], v[4:7], v[208:211]
v_exp_f32 v192, v192
v_mfma_f32_16x16x32_bf16 v[212:215], v[232:235], v[32:35], 0
v_exp_f32 v193, v193
v_mfma_f32_16x16x32_bf16 v[212:215], v[236:239], v[36:39], v[212:215]
v_exp_f32 v194, v194
v_mfma_f32_16x16x32_bf16 v[216:219], v[232:235], v[64:67], 0
ds_read_b128 v[228:231], v248 offset:27136
v_cvt_pk_bf16_f32 v144, v192, v193
v_mfma_f32_16x16x32_bf16 v[216:219], v[236:239], v[68:71], v[216:219]
v_exp_f32 v195, v195
v_mfma_f32_16x16x32_bf16 v[220:223], v[232:235], v[96:99], 0
v_exp_f32 v196, v196
v_mfma_f32_16x16x32_bf16 v[220:223], v[236:239], v[100:103], v[220:223]
s_waitcnt lgkmcnt(2)
v_cvt_pk_bf16_f32 v145, v194, v195
v_mfma_f32_16x16x32_bf16 v[208:211], v[240:243], v[8:11], v[208:211]
ds_read_b128 v[232:235], v248 offset:30720
v_mfma_f32_16x16x32_bf16 v[208:211], v[244:247], v[12:15], v[208:211]
v_exp_f32 v197, v197
v_mfma_f32_16x16x32_bf16 v[212:215], v[240:243], v[40:43], v[212:215]
v_exp_f32 v198, v198
v_mfma_f32_16x16x32_bf16 v[212:215], v[244:247], v[44:47], v[212:215]
v_exp_f32 v199, v199
v_mfma_f32_16x16x32_bf16 v[216:219], v[240:243], v[72:75], v[216:219]
ds_read_b128 v[236:239], v248 offset:31232
v_cvt_pk_bf16_f32 v148, v196, v197
v_mfma_f32_16x16x32_bf16 v[216:219], v[244:247], v[76:79], v[216:219]
v_cvt_pk_bf16_f32 v149, v198, v199
v_mfma_f32_16x16x32_bf16 v[220:223], v[240:243], v[104:107], v[220:223]
v_exp_f32 v200, v200
v_mfma_f32_16x16x32_bf16 v[220:223], v[244:247], v[108:111], v[220:223]
s_waitcnt lgkmcnt(2)
v_mfma_f32_16x16x32_bf16 v[208:211], v[224:227], v[16:19], v[208:211]
ds_read_b128 v[240:243], v248 offset:32768
v_mfma_f32_16x16x32_bf16 v[208:211], v[228:231], v[20:23], v[208:211]
v_exp_f32 v201, v201
v_mfma_f32_16x16x32_bf16 v[212:215], v[224:227], v[48:51], v[212:215]
v_exp_f32 v202, v202
v_mfma_f32_16x16x32_bf16 v[212:215], v[228:231], v[52:55], v[212:215]
v_exp_f32 v203, v203
v_mfma_f32_16x16x32_bf16 v[216:219], v[224:227], v[80:83], v[216:219]
ds_read_b128 v[244:247], v248 offset:33280
v_cvt_pk_bf16_f32 v152, v200, v201
v_mfma_f32_16x16x32_bf16 v[216:219], v[228:231], v[84:87], v[216:219]
v_cvt_pk_bf16_f32 v153, v202, v203
v_mfma_f32_16x16x32_bf16 v[220:223], v[224:227], v[112:115], v[220:223]
v_exp_f32 v204, v204
v_mfma_f32_16x16x32_bf16 v[220:223], v[228:231], v[116:119], v[220:223]
s_waitcnt lgkmcnt(2)
v_mfma_f32_16x16x32_bf16 v[208:211], v[232:235], v[24:27], v[208:211]
ds_read_b128 v[224:227], v248 offset:36864
v_mfma_f32_16x16x32_bf16 v[208:211], v[236:239], v[28:31], v[208:211]
v_exp_f32 v205, v205
v_mfma_f32_16x16x32_bf16 v[212:215], v[232:235], v[56:59], v[212:215]
v_exp_f32 v206, v206
v_mfma_f32_16x16x32_bf16 v[212:215], v[236:239], v[60:63], v[212:215]
v_exp_f32 v207, v207
v_mfma_f32_16x16x32_bf16 v[216:219], v[232:235], v[88:91], v[216:219]
ds_read_b128 v[228:231], v248 offset:37376
v_cvt_pk_bf16_f32 v156, v204, v205
v_mfma_f32_16x16x32_bf16 v[216:219], v[236:239], v[92:95], v[216:219]
v_cvt_pk_bf16_f32 v157, v206, v207
v_mfma_f32_16x16x32_bf16 v[220:223], v[232:235], v[120:123], v[220:223]
v_mfma_f32_16x16x32_bf16 v[220:223], v[236:239], v[124:127], v[220:223]
s_waitcnt lgkmcnt(2)
v_mfma_f32_16x16x32_bf16 v[192:195], v[240:243], v[0:3], 0
ds_read_b128 v[232:235], v248 offset:40960
v_mfma_f32_16x16x32_bf16 v[192:195], v[244:247], v[4:7], v[192:195]
v_exp_f32 v208, v208
v_mfma_f32_16x16x32_bf16 v[196:199], v[240:243], v[32:35], 0
v_exp_f32 v209, v209
v_mfma_f32_16x16x32_bf16 v[196:199], v[244:247], v[36:39], v[196:199]
v_exp_f32 v210, v210
v_mfma_f32_16x16x32_bf16 v[200:203], v[240:243], v[64:67], 0
ds_read_b128 v[236:239], v248 offset:41472
v_cvt_pk_bf16_f32 v146, v208, v209
v_mfma_f32_16x16x32_bf16 v[200:203], v[244:247], v[68:71], v[200:203]
v_exp_f32 v211, v211
v_mfma_f32_16x16x32_bf16 v[204:207], v[240:243], v[96:99], 0
v_exp_f32 v212, v212
v_mfma_f32_16x16x32_bf16 v[204:207], v[244:247], v[100:103], v[204:207]
s_waitcnt lgkmcnt(2)
v_cvt_pk_bf16_f32 v147, v210, v211
v_mfma_f32_16x16x32_bf16 v[192:195], v[224:227], v[8:11], v[192:195]
ds_read_b128 v[240:243], v248 offset:45056
v_mfma_f32_16x16x32_bf16 v[192:195], v[228:231], v[12:15], v[192:195]
v_exp_f32 v213, v213
v_mfma_f32_16x16x32_bf16 v[196:199], v[224:227], v[40:43], v[196:199]
v_exp_f32 v214, v214
v_mfma_f32_16x16x32_bf16 v[196:199], v[228:231], v[44:47], v[196:199]
v_exp_f32 v215, v215
v_mfma_f32_16x16x32_bf16 v[200:203], v[224:227], v[72:75], v[200:203]
ds_read_b128 v[244:247], v248 offset:45568
v_cvt_pk_bf16_f32 v150, v212, v213
v_mfma_f32_16x16x32_bf16 v[200:203], v[228:231], v[76:79], v[200:203]
v_cvt_pk_bf16_f32 v151, v214, v215
v_mfma_f32_16x16x32_bf16 v[204:207], v[224:227], v[104:107], v[204:207]
v_exp_f32 v216, v216
v_mfma_f32_16x16x32_bf16 v[204:207], v[228:231], v[108:111], v[204:207]
s_waitcnt lgkmcnt(2)
v_mfma_f32_16x16x32_bf16 v[192:195], v[232:235], v[16:19], v[192:195]
ds_read_b128 v[224:227], v248 offset:34816
v_mfma_f32_16x16x32_bf16 v[192:195], v[236:239], v[20:23], v[192:195]
v_exp_f32 v217, v217
v_mfma_f32_16x16x32_bf16 v[196:199], v[232:235], v[48:51], v[196:199]
v_exp_f32 v218, v218
v_mfma_f32_16x16x32_bf16 v[196:199], v[236:239], v[52:55], v[196:199]
v_exp_f32 v219, v219
v_mfma_f32_16x16x32_bf16 v[200:203], v[232:235], v[80:83], v[200:203]
ds_read_b128 v[228:231], v248 offset:35328
v_cvt_pk_bf16_f32 v154, v216, v217
v_mfma_f32_16x16x32_bf16 v[200:203], v[236:239], v[84:87], v[200:203]
v_cvt_pk_bf16_f32 v155, v218, v219
v_mfma_f32_16x16x32_bf16 v[204:207], v[232:235], v[112:115], v[204:207]
v_exp_f32 v220, v220
v_mfma_f32_16x16x32_bf16 v[204:207], v[236:239], v[116:119], v[204:207]
s_waitcnt lgkmcnt(2)
v_mfma_f32_16x16x32_bf16 v[192:195], v[240:243], v[24:27], v[192:195]
ds_read_b128 v[232:235], v248 offset:38912
v_mfma_f32_16x16x32_bf16 v[192:195], v[244:247], v[28:31], v[192:195]
v_exp_f32 v221, v221
v_mfma_f32_16x16x32_bf16 v[196:199], v[240:243], v[56:59], v[196:199]
v_exp_f32 v222, v222
v_mfma_f32_16x16x32_bf16 v[196:199], v[244:247], v[60:63], v[196:199]
v_exp_f32 v223, v223
v_mfma_f32_16x16x32_bf16 v[200:203], v[240:243], v[88:91], v[200:203]
ds_read_b128 v[236:239], v248 offset:39424
v_cvt_pk_bf16_f32 v158, v220, v221
v_mfma_f32_16x16x32_bf16 v[200:203], v[244:247], v[92:95], v[200:203]
v_cvt_pk_bf16_f32 v159, v222, v223
v_mfma_f32_16x16x32_bf16 v[204:207], v[240:243], v[120:123], v[204:207]
v_mfma_f32_16x16x32_bf16 v[204:207], v[244:247], v[124:127], v[204:207]
s_waitcnt lgkmcnt(2)
v_mfma_f32_16x16x32_bf16 v[208:211], v[224:227], v[0:3], 0
ds_read_b128 v[240:243], v248 offset:43008
v_mfma_f32_16x16x32_bf16 v[208:211], v[228:231], v[4:7], v[208:211]
v_exp_f32 v192, v192
v_mfma_f32_16x16x32_bf16 v[212:215], v[224:227], v[32:35], 0
v_exp_f32 v193, v193
v_mfma_f32_16x16x32_bf16 v[212:215], v[228:231], v[36:39], v[212:215]
v_exp_f32 v194, v194
v_mfma_f32_16x16x32_bf16 v[216:219], v[224:227], v[64:67], 0
ds_read_b128 v[244:247], v248 offset:43520
v_cvt_pk_bf16_f32 v160, v192, v193
v_mfma_f32_16x16x32_bf16 v[216:219], v[228:231], v[68:71], v[216:219]
v_exp_f32 v195, v195
v_mfma_f32_16x16x32_bf16 v[220:223], v[224:227], v[96:99], 0
v_exp_f32 v196, v196
v_mfma_f32_16x16x32_bf16 v[220:223], v[228:231], v[100:103], v[220:223]
s_waitcnt lgkmcnt(2)
v_cvt_pk_bf16_f32 v161, v194, v195
v_mfma_f32_16x16x32_bf16 v[208:211], v[232:235], v[8:11], v[208:211]
ds_read_b128 v[224:227], v248 offset:47104
v_mfma_f32_16x16x32_bf16 v[208:211], v[236:239], v[12:15], v[208:211]
v_exp_f32 v197, v197
v_mfma_f32_16x16x32_bf16 v[212:215], v[232:235], v[40:43], v[212:215]
v_exp_f32 v198, v198
v_mfma_f32_16x16x32_bf16 v[212:215], v[236:239], v[44:47], v[212:215]
v_exp_f32 v199, v199
v_mfma_f32_16x16x32_bf16 v[216:219], v[232:235], v[72:75], v[216:219]
ds_read_b128 v[228:231], v248 offset:47616
v_cvt_pk_bf16_f32 v164, v196, v197
v_mfma_f32_16x16x32_bf16 v[216:219], v[236:239], v[76:79], v[216:219]
v_cvt_pk_bf16_f32 v165, v198, v199
v_mfma_f32_16x16x32_bf16 v[220:223], v[232:235], v[104:107], v[220:223]
v_exp_f32 v200, v200
v_mfma_f32_16x16x32_bf16 v[220:223], v[236:239], v[108:111], v[220:223]
s_waitcnt lgkmcnt(2)
s_waitcnt vmcnt(0)
s_barrier
v_mfma_f32_16x16x32_bf16 v[208:211], v[240:243], v[16:19], v[208:211]
ds_read_b128 v[232:235], v248 offset:49152
v_mfma_f32_16x16x32_bf16 v[208:211], v[244:247], v[20:23], v[208:211]
v_exp_f32 v201, v201
v_mfma_f32_16x16x32_bf16 v[212:215], v[240:243], v[48:51], v[212:215]
v_exp_f32 v202, v202
v_mfma_f32_16x16x32_bf16 v[212:215], v[244:247], v[52:55], v[212:215]
v_exp_f32 v203, v203
v_mfma_f32_16x16x32_bf16 v[216:219], v[240:243], v[80:83], v[216:219]
ds_read_b128 v[236:239], v248 offset:49664
v_cvt_pk_bf16_f32 v168, v200, v201
v_mfma_f32_16x16x32_bf16 v[216:219], v[244:247], v[84:87], v[216:219]
v_cvt_pk_bf16_f32 v169, v202, v203
v_mfma_f32_16x16x32_bf16 v[220:223], v[240:243], v[112:115], v[220:223]
v_exp_f32 v204, v204
v_mfma_f32_16x16x32_bf16 v[220:223], v[244:247], v[116:119], v[220:223]
s_waitcnt lgkmcnt(2)
v_mfma_f32_16x16x32_bf16 v[208:211], v[224:227], v[24:27], v[208:211]
ds_read_b128 v[240:243], v248 offset:53248
v_mfma_f32_16x16x32_bf16 v[208:211], v[228:231], v[28:31], v[208:211]
v_exp_f32 v205, v205
v_mfma_f32_16x16x32_bf16 v[212:215], v[224:227], v[56:59], v[212:215]
v_exp_f32 v206, v206
v_mfma_f32_16x16x32_bf16 v[212:215], v[228:231], v[60:63], v[212:215]
v_exp_f32 v207, v207
v_mfma_f32_16x16x32_bf16 v[216:219], v[224:227], v[88:91], v[216:219]
ds_read_b128 v[244:247], v248 offset:53760
v_cvt_pk_bf16_f32 v172, v204, v205
v_mfma_f32_16x16x32_bf16 v[216:219], v[228:231], v[92:95], v[216:219]
v_cvt_pk_bf16_f32 v173, v206, v207
v_mfma_f32_16x16x32_bf16 v[220:223], v[224:227], v[120:123], v[220:223]
v_mfma_f32_16x16x32_bf16 v[220:223], v[228:231], v[124:127], v[220:223]
s_waitcnt lgkmcnt(2)
v_mfma_f32_16x16x32_bf16 v[192:195], v[232:235], v[0:3], 0
ds_read_b128 v[224:227], v248 offset:57344
v_mfma_f32_16x16x32_bf16 v[192:195], v[236:239], v[4:7], v[192:195]
v_exp_f32 v208, v208
v_mfma_f32_16x16x32_bf16 v[196:199], v[232:235], v[32:35], 0
v_exp_f32 v209, v209
v_mfma_f32_16x16x32_bf16 v[196:199], v[236:239], v[36:39], v[196:199]
v_exp_f32 v210, v210
v_mfma_f32_16x16x32_bf16 v[200:203], v[232:235], v[64:67], 0
ds_read_b128 v[228:231], v248 offset:57856
v_cvt_pk_bf16_f32 v162, v208, v209
v_mfma_f32_16x16x32_bf16 v[200:203], v[236:239], v[68:71], v[200:203]
v_exp_f32 v211, v211
v_mfma_f32_16x16x32_bf16 v[204:207], v[232:235], v[96:99], 0
v_exp_f32 v212, v212
v_mfma_f32_16x16x32_bf16 v[204:207], v[236:239], v[100:103], v[204:207]
s_waitcnt lgkmcnt(2)
v_cvt_pk_bf16_f32 v163, v210, v211
v_mfma_f32_16x16x32_bf16 v[192:195], v[240:243], v[8:11], v[192:195]
ds_read_b128 v[232:235], v248 offset:61440
v_mfma_f32_16x16x32_bf16 v[192:195], v[244:247], v[12:15], v[192:195]
v_exp_f32 v213, v213
v_mfma_f32_16x16x32_bf16 v[196:199], v[240:243], v[40:43], v[196:199]
v_exp_f32 v214, v214
v_mfma_f32_16x16x32_bf16 v[196:199], v[244:247], v[44:47], v[196:199]
v_exp_f32 v215, v215
v_mfma_f32_16x16x32_bf16 v[200:203], v[240:243], v[72:75], v[200:203]
ds_read_b128 v[236:239], v248 offset:61952
v_cvt_pk_bf16_f32 v166, v212, v213
v_mfma_f32_16x16x32_bf16 v[200:203], v[244:247], v[76:79], v[200:203]
v_cvt_pk_bf16_f32 v167, v214, v215
v_mfma_f32_16x16x32_bf16 v[204:207], v[240:243], v[104:107], v[204:207]
v_exp_f32 v216, v216
v_mfma_f32_16x16x32_bf16 v[204:207], v[244:247], v[108:111], v[204:207]
s_waitcnt lgkmcnt(2)
v_mfma_f32_16x16x32_bf16 v[192:195], v[224:227], v[16:19], v[192:195]
ds_read_b128 v[240:243], v248 offset:51200
v_mfma_f32_16x16x32_bf16 v[192:195], v[228:231], v[20:23], v[192:195]
v_exp_f32 v217, v217
v_mfma_f32_16x16x32_bf16 v[196:199], v[224:227], v[48:51], v[196:199]
v_exp_f32 v218, v218
v_mfma_f32_16x16x32_bf16 v[196:199], v[228:231], v[52:55], v[196:199]
v_exp_f32 v219, v219
v_mfma_f32_16x16x32_bf16 v[200:203], v[224:227], v[80:83], v[200:203]
ds_read_b128 v[244:247], v248 offset:51712
v_cvt_pk_bf16_f32 v170, v216, v217
v_mfma_f32_16x16x32_bf16 v[200:203], v[228:231], v[84:87], v[200:203]
v_cvt_pk_bf16_f32 v171, v218, v219
v_mfma_f32_16x16x32_bf16 v[204:207], v[224:227], v[112:115], v[204:207]
v_exp_f32 v220, v220
v_mfma_f32_16x16x32_bf16 v[204:207], v[228:231], v[116:119], v[204:207]
s_waitcnt lgkmcnt(2)
v_mfma_f32_16x16x32_bf16 v[192:195], v[232:235], v[24:27], v[192:195]
ds_read_b128 v[224:227], v248 offset:55296
v_mfma_f32_16x16x32_bf16 v[192:195], v[236:239], v[28:31], v[192:195]
v_exp_f32 v221, v221
v_mfma_f32_16x16x32_bf16 v[196:199], v[232:235], v[56:59], v[196:199]
v_exp_f32 v222, v222
v_mfma_f32_16x16x32_bf16 v[196:199], v[236:239], v[60:63], v[196:199]
v_exp_f32 v223, v223
v_mfma_f32_16x16x32_bf16 v[200:203], v[232:235], v[88:91], v[200:203]
ds_read_b128 v[228:231], v248 offset:55808
v_cvt_pk_bf16_f32 v174, v220, v221
v_mfma_f32_16x16x32_bf16 v[200:203], v[236:239], v[92:95], v[200:203]
v_cvt_pk_bf16_f32 v175, v222, v223
v_mfma_f32_16x16x32_bf16 v[204:207], v[232:235], v[120:123], v[204:207]
v_mfma_f32_16x16x32_bf16 v[204:207], v[236:239], v[124:127], v[204:207]
s_waitcnt lgkmcnt(2)
v_mfma_f32_16x16x32_bf16 v[208:211], v[240:243], v[0:3], 0
ds_read_b128 v[232:235], v248 offset:59392
v_mfma_f32_16x16x32_bf16 v[208:211], v[244:247], v[4:7], v[208:211]
v_exp_f32 v192, v192
v_mfma_f32_16x16x32_bf16 v[212:215], v[240:243], v[32:35], 0
v_exp_f32 v193, v193
v_mfma_f32_16x16x32_bf16 v[212:215], v[244:247], v[36:39], v[212:215]
v_exp_f32 v194, v194
v_mfma_f32_16x16x32_bf16 v[216:219], v[240:243], v[64:67], 0
ds_read_b128 v[236:239], v248 offset:59904
v_cvt_pk_bf16_f32 v176, v192, v193
v_mfma_f32_16x16x32_bf16 v[216:219], v[244:247], v[68:71], v[216:219]
v_exp_f32 v195, v195
v_mfma_f32_16x16x32_bf16 v[220:223], v[240:243], v[96:99], 0
v_exp_f32 v196, v196
v_mfma_f32_16x16x32_bf16 v[220:223], v[244:247], v[100:103], v[220:223]
s_waitcnt lgkmcnt(2)
v_cvt_pk_bf16_f32 v177, v194, v195
v_mfma_f32_16x16x32_bf16 v[208:211], v[224:227], v[8:11], v[208:211]
ds_read_b128 v[240:243], v248 offset:63488
v_mfma_f32_16x16x32_bf16 v[208:211], v[228:231], v[12:15], v[208:211]
v_exp_f32 v197, v197
v_mfma_f32_16x16x32_bf16 v[212:215], v[224:227], v[40:43], v[212:215]
v_exp_f32 v198, v198
v_mfma_f32_16x16x32_bf16 v[212:215], v[228:231], v[44:47], v[212:215]
v_exp_f32 v199, v199
v_mfma_f32_16x16x32_bf16 v[216:219], v[224:227], v[72:75], v[216:219]
ds_read_b128 v[244:247], v248 offset:64000
v_cvt_pk_bf16_f32 v180, v196, v197
v_mfma_f32_16x16x32_bf16 v[216:219], v[228:231], v[76:79], v[216:219]
v_cvt_pk_bf16_f32 v181, v198, v199
v_mfma_f32_16x16x32_bf16 v[220:223], v[224:227], v[104:107], v[220:223]
v_exp_f32 v200, v200
v_mfma_f32_16x16x32_bf16 v[220:223], v[228:231], v[108:111], v[220:223]
s_waitcnt lgkmcnt(2)
v_xor_b32 v248, 0x10000, v248
v_mfma_f32_16x16x32_bf16 v[208:211], v[232:235], v[16:19], v[208:211]
ds_read_b128 v[224:227], v248 offset:0
v_mfma_f32_16x16x32_bf16 v[208:211], v[236:239], v[20:23], v[208:211]
v_exp_f32 v201, v201
v_mfma_f32_16x16x32_bf16 v[212:215], v[232:235], v[48:51], v[212:215]
v_exp_f32 v202, v202
v_mfma_f32_16x16x32_bf16 v[212:215], v[236:239], v[52:55], v[212:215]
v_exp_f32 v203, v203
v_mfma_f32_16x16x32_bf16 v[216:219], v[232:235], v[80:83], v[216:219]
ds_read_b128 v[228:231], v248 offset:512
v_cvt_pk_bf16_f32 v184, v200, v201
v_mfma_f32_16x16x32_bf16 v[216:219], v[236:239], v[84:87], v[216:219]
v_cvt_pk_bf16_f32 v185, v202, v203
v_mfma_f32_16x16x32_bf16 v[220:223], v[232:235], v[112:115], v[220:223]
v_exp_f32 v204, v204
v_mfma_f32_16x16x32_bf16 v[220:223], v[236:239], v[116:119], v[220:223]
s_waitcnt lgkmcnt(2)
v_mfma_f32_16x16x32_bf16 v[208:211], v[240:243], v[24:27], v[208:211]
ds_read_b128 v[232:235], v248 offset:4096
v_mfma_f32_16x16x32_bf16 v[208:211], v[244:247], v[28:31], v[208:211]
v_exp_f32 v205, v205
v_mfma_f32_16x16x32_bf16 v[212:215], v[240:243], v[56:59], v[212:215]
v_exp_f32 v206, v206
v_mfma_f32_16x16x32_bf16 v[212:215], v[244:247], v[60:63], v[212:215]
v_exp_f32 v207, v207
v_mfma_f32_16x16x32_bf16 v[216:219], v[240:243], v[88:91], v[216:219]
ds_read_b128 v[236:239], v248 offset:4608
v_cvt_pk_bf16_f32 v188, v204, v205
v_mfma_f32_16x16x32_bf16 v[216:219], v[244:247], v[92:95], v[216:219]
v_cvt_pk_bf16_f32 v189, v206, v207
v_mfma_f32_16x16x32_bf16 v[220:223], v[240:243], v[120:123], v[220:223]
v_mfma_f32_16x16x32_bf16 v[220:223], v[244:247], v[124:127], v[220:223]
s_waitcnt lgkmcnt(2)
v_mfma_f32_16x16x32_bf16 v[192:195], v[224:227], v[0:3], 0
ds_read_b128 v[240:243], v248 offset:8192
v_mfma_f32_16x16x32_bf16 v[192:195], v[228:231], v[4:7], v[192:195]
v_exp_f32 v208, v208
v_mfma_f32_16x16x32_bf16 v[196:199], v[224:227], v[32:35], 0
v_exp_f32 v209, v209
v_mfma_f32_16x16x32_bf16 v[196:199], v[228:231], v[36:39], v[196:199]
v_exp_f32 v210, v210
v_mfma_f32_16x16x32_bf16 v[200:203], v[224:227], v[64:67], 0
ds_read_b128 v[244:247], v248 offset:8704
v_cvt_pk_bf16_f32 v178, v208, v209
v_mfma_f32_16x16x32_bf16 v[200:203], v[228:231], v[68:71], v[200:203]
v_exp_f32 v211, v211
v_mfma_f32_16x16x32_bf16 v[204:207], v[224:227], v[96:99], 0
v_exp_f32 v212, v212
v_mfma_f32_16x16x32_bf16 v[204:207], v[228:231], v[100:103], v[204:207]
s_waitcnt lgkmcnt(2)
v_cvt_pk_bf16_f32 v179, v210, v211
v_mfma_f32_16x16x32_bf16 v[192:195], v[232:235], v[8:11], v[192:195]
ds_read_b128 v[224:227], v248 offset:12288
v_mfma_f32_16x16x32_bf16 v[192:195], v[236:239], v[12:15], v[192:195]
v_exp_f32 v213, v213
v_mfma_f32_16x16x32_bf16 v[196:199], v[232:235], v[40:43], v[196:199]
v_exp_f32 v214, v214
v_mfma_f32_16x16x32_bf16 v[196:199], v[236:239], v[44:47], v[196:199]
v_exp_f32 v215, v215
v_mfma_f32_16x16x32_bf16 v[200:203], v[232:235], v[72:75], v[200:203]
ds_read_b128 v[228:231], v248 offset:12800
v_cvt_pk_bf16_f32 v182, v212, v213
v_mfma_f32_16x16x32_bf16 v[200:203], v[236:239], v[76:79], v[200:203]
v_cvt_pk_bf16_f32 v183, v214, v215
v_mfma_f32_16x16x32_bf16 v[204:207], v[232:235], v[104:107], v[204:207]
v_exp_f32 v216, v216
v_mfma_f32_16x16x32_bf16 v[204:207], v[236:239], v[108:111], v[204:207]
s_waitcnt lgkmcnt(2)
v_mfma_f32_16x16x32_bf16 v[192:195], v[240:243], v[16:19], v[192:195]
ds_read_b128 v[232:235], v248 offset:2048
v_mfma_f32_16x16x32_bf16 v[192:195], v[244:247], v[20:23], v[192:195]
v_exp_f32 v217, v217
v_mfma_f32_16x16x32_bf16 v[196:199], v[240:243], v[48:51], v[196:199]
v_exp_f32 v218, v218
v_mfma_f32_16x16x32_bf16 v[196:199], v[244:247], v[52:55], v[196:199]
v_exp_f32 v219, v219
v_mfma_f32_16x16x32_bf16 v[200:203], v[240:243], v[80:83], v[200:203]
ds_read_b128 v[236:239], v248 offset:2560
v_cvt_pk_bf16_f32 v186, v216, v217
v_mfma_f32_16x16x32_bf16 v[200:203], v[244:247], v[84:87], v[200:203]
v_cvt_pk_bf16_f32 v187, v218, v219
v_mfma_f32_16x16x32_bf16 v[204:207], v[240:243], v[112:115], v[204:207]
v_exp_f32 v220, v220
v_mfma_f32_16x16x32_bf16 v[204:207], v[244:247], v[116:119], v[204:207]
s_waitcnt lgkmcnt(2)
v_mfma_f32_16x16x32_bf16 v[192:195], v[224:227], v[24:27], v[192:195]
ds_read_b128 v[240:243], v248 offset:6144
v_mfma_f32_16x16x32_bf16 v[192:195], v[228:231], v[28:31], v[192:195]
v_exp_f32 v221, v221
v_mfma_f32_16x16x32_bf16 v[196:199], v[224:227], v[56:59], v[196:199]
v_exp_f32 v222, v222
v_mfma_f32_16x16x32_bf16 v[196:199], v[228:231], v[60:63], v[196:199]
v_exp_f32 v223, v223
v_mfma_f32_16x16x32_bf16 v[200:203], v[224:227], v[88:91], v[200:203]
ds_read_b128 v[244:247], v248 offset:6656
v_cvt_pk_bf16_f32 v190, v220, v221
v_mfma_f32_16x16x32_bf16 v[200:203], v[228:231], v[92:95], v[200:203]
v_cvt_pk_bf16_f32 v191, v222, v223
v_mfma_f32_16x16x32_bf16 v[204:207], v[224:227], v[120:123], v[204:207]
v_mfma_f32_16x16x32_bf16 v[204:207], v[228:231], v[124:127], v[204:207]
s_waitcnt lgkmcnt(2)
v_mfma_f32_16x16x32_bf16 v[208:211], v[232:235], v[0:3], 0
ds_read_b128 v[224:227], v248 offset:10240
v_mfma_f32_16x16x32_bf16 v[208:211], v[236:239], v[4:7], v[208:211]
v_exp_f32 v192, v192
v_mfma_f32_16x16x32_bf16 v[212:215], v[232:235], v[32:35], 0
v_exp_f32 v193, v193
v_mfma_f32_16x16x32_bf16 v[212:215], v[236:239], v[36:39], v[212:215]
v_exp_f32 v194, v194
v_mfma_f32_16x16x32_bf16 v[216:219], v[232:235], v[64:67], 0
ds_read_b128 v[228:231], v248 offset:10752
v_cvt_pk_bf16_f32 v0, v192, v193
v_mfma_f32_16x16x32_bf16 v[216:219], v[236:239], v[68:71], v[216:219]
v_exp_f32 v195, v195
v_mfma_f32_16x16x32_bf16 v[220:223], v[232:235], v[96:99], 0
v_exp_f32 v196, v196
v_mfma_f32_16x16x32_bf16 v[220:223], v[236:239], v[100:103], v[220:223]
s_waitcnt lgkmcnt(2)
v_cvt_pk_bf16_f32 v1, v194, v195
v_mfma_f32_16x16x32_bf16 v[208:211], v[240:243], v[8:11], v[208:211]
ds_read_b128 v[232:235], v248 offset:14336
v_mfma_f32_16x16x32_bf16 v[208:211], v[244:247], v[12:15], v[208:211]
v_exp_f32 v197, v197
v_mfma_f32_16x16x32_bf16 v[212:215], v[240:243], v[40:43], v[212:215]
ds_read_b128 v[4:7], v255 offset:0
ds_read_b128 v[36:39], v255 offset:1024
v_mfma_f32_16x16x32_bf16 v[212:215], v[244:247], v[44:47], v[212:215]
v_exp_f32 v198, v198
v_mfma_f32_16x16x32_bf16 v[216:219], v[240:243], v[72:75], v[216:219]
ds_read_b128 v[236:239], v248 offset:14848
v_xor_b32 v12, 0x10000, v249
v_mfma_f32_16x16x32_bf16 v[216:219], v[244:247], v[76:79], v[216:219]
v_xor_b32 v13, 0x10000, v250
v_cvt_pk_bf16_f32 v32, v196, v197
v_mfma_f32_16x16x32_bf16 v[220:223], v[240:243], v[104:107], v[220:223]
ds_read_b128 v[68:71], v255 offset:2048
ds_read_b128 v[100:103], v255 offset:3072
v_mfma_f32_16x16x32_bf16 v[220:223], v[244:247], v[108:111], v[220:223]
s_waitcnt lgkmcnt(6)
v_mfma_f32_16x16x32_bf16 v[208:211], v[224:227], v[16:19], v[208:211]
ds_read_b64_tr_b16 v[240:241], v12 offset:0
ds_read_b64_tr_b16 v[242:243], v12 offset:2048
v_mfma_f32_16x16x32_bf16 v[208:211], v[228:231], v[20:23], v[208:211]
v_exp_f32 v199, v199
v_mfma_f32_16x16x32_bf16 v[212:215], v[224:227], v[48:51], v[212:215]
ds_read_b128 v[8:11], v255 offset:4096
ds_read_b128 v[40:43], v255 offset:5120
v_mfma_f32_16x16x32_bf16 v[212:215], v[228:231], v[52:55], v[212:215]
v_cvt_pk_bf16_f32 v33, v198, v199
v_mfma_f32_16x16x32_bf16 v[216:219], v[224:227], v[80:83], v[216:219]
ds_read_b64_tr_b16 v[244:245], v12 offset:16384
ds_read_b64_tr_b16 v[246:247], v12 offset:18432
v_mfma_f32_16x16x32_bf16 v[216:219], v[228:231], v[84:87], v[216:219]
v_exp_f32 v200, v200
v_mfma_f32_16x16x32_bf16 v[220:223], v[224:227], v[112:115], v[220:223]
ds_read_b128 v[72:75], v255 offset:6144
ds_read_b128 v[104:107], v255 offset:7168
v_mfma_f32_16x16x32_bf16 v[220:223], v[228:231], v[116:119], v[220:223]
s_waitcnt lgkmcnt(10)
v_mfma_f32_16x16x32_bf16 v[208:211], v[232:235], v[24:27], v[208:211]
ds_read_b64_tr_b16 v[224:225], v12 offset:32768
ds_read_b64_tr_b16 v[226:227], v12 offset:34816
v_mfma_f32_16x16x32_bf16 v[208:211], v[236:239], v[28:31], v[208:211]
v_exp_f32 v201, v201
v_mfma_f32_16x16x32_bf16 v[212:215], v[232:235], v[56:59], v[212:215]
v_exp_f32 v202, v202
v_mfma_f32_16x16x32_bf16 v[212:215], v[236:239], v[60:63], v[212:215]
v_exp_f32 v203, v203
v_mfma_f32_16x16x32_bf16 v[216:219], v[232:235], v[88:91], v[216:219]
ds_read_b64_tr_b16 v[228:229], v12 offset:49152
ds_read_b64_tr_b16 v[230:231], v12 offset:51200
v_mfma_f32_16x16x32_bf16 v[216:219], v[236:239], v[92:95], v[216:219]
v_cvt_pk_bf16_f32 v64, v200, v201
v_cvt_pk_bf16_f32 v65, v202, v203
v_mfma_f32_16x16x32_bf16 v[220:223], v[232:235], v[120:123], v[220:223]
v_exp_f32 v204, v204
v_mfma_f32_16x16x32_bf16 v[220:223], v[236:239], v[124:127], v[220:223]
s_waitcnt lgkmcnt(6)
s_waitcnt lgkmcnt(4)
v_mfma_f32_16x16x32_bf16 a[0:3], v[240:243], v[128:131], a[0:3]
ds_read_b64_tr_b16 v[232:233], v13 offset:0
ds_read_b64_tr_b16 v[234:235], v13 offset:2048
v_mfma_f32_16x16x32_bf16 a[0:3], v[244:247], v[144:147], a[0:3]
v_exp_f32 v205, v205
v_mfma_f32_16x16x32_bf16 a[4:7], v[240:243], v[132:135], a[4:7]
v_exp_f32 v206, v206
v_mfma_f32_16x16x32_bf16 a[4:7], v[244:247], v[148:151], a[4:7]
v_exp_f32 v207, v207
v_mfma_f32_16x16x32_bf16 a[8:11], v[240:243], v[136:139], a[8:11]
ds_read_b64_tr_b16 v[236:237], v13 offset:16384
ds_read_b64_tr_b16 v[238:239], v13 offset:18432
v_mfma_f32_16x16x32_bf16 a[8:11], v[244:247], v[152:155], a[8:11]
v_cvt_pk_bf16_f32 v96, v204, v205
v_cvt_pk_bf16_f32 v97, v206, v207
v_mfma_f32_16x16x32_bf16 a[12:15], v[240:243], v[140:143], a[12:15]
v_exp_f32 v208, v208
v_mfma_f32_16x16x32_bf16 a[12:15], v[244:247], v[156:159], a[12:15]
s_waitcnt lgkmcnt(4)
v_mfma_f32_16x16x32_bf16 a[0:3], v[224:227], v[160:163], a[0:3]
ds_read_b64_tr_b16 v[240:241], v13 offset:32768
ds_read_b64_tr_b16 v[242:243], v13 offset:34816
v_mfma_f32_16x16x32_bf16 a[0:3], v[228:231], v[176:179], a[0:3]
v_exp_f32 v209, v209
v_mfma_f32_16x16x32_bf16 a[4:7], v[224:227], v[164:167], a[4:7]
v_exp_f32 v210, v210
v_mfma_f32_16x16x32_bf16 a[4:7], v[228:231], v[180:183], a[4:7]
v_exp_f32 v211, v211
v_mfma_f32_16x16x32_bf16 a[8:11], v[224:227], v[168:171], a[8:11]
ds_read_b64_tr_b16 v[244:245], v13 offset:49152
ds_read_b64_tr_b16 v[246:247], v13 offset:51200
v_mfma_f32_16x16x32_bf16 a[8:11], v[228:231], v[184:187], a[8:11]
v_cvt_pk_bf16_f32 v2, v208, v209
v_cvt_pk_bf16_f32 v3, v210, v211
v_mfma_f32_16x16x32_bf16 a[12:15], v[224:227], v[172:175], a[12:15]
v_exp_f32 v212, v212
v_mfma_f32_16x16x32_bf16 a[12:15], v[228:231], v[188:191], a[12:15]
s_waitcnt lgkmcnt(4)
v_mfma_f32_16x16x32_bf16 a[16:19], v[232:235], v[128:131], a[16:19]
ds_read_b64_tr_b16 v[224:225], v249 offset:33280
ds_read_b64_tr_b16 v[226:227], v249 offset:35328
v_mfma_f32_16x16x32_bf16 a[16:19], v[236:239], v[144:147], a[16:19]
v_exp_f32 v213, v213
v_mfma_f32_16x16x32_bf16 a[20:23], v[232:235], v[132:135], a[20:23]
v_exp_f32 v214, v214
v_mfma_f32_16x16x32_bf16 a[20:23], v[236:239], v[148:151], a[20:23]
v_exp_f32 v215, v215
v_mfma_f32_16x16x32_bf16 a[24:27], v[232:235], v[136:139], a[24:27]
ds_read_b64_tr_b16 v[228:229], v249 offset:49664
ds_read_b64_tr_b16 v[230:231], v249 offset:51712
v_mfma_f32_16x16x32_bf16 a[24:27], v[236:239], v[152:155], a[24:27]
v_cvt_pk_bf16_f32 v34, v212, v213
v_cvt_pk_bf16_f32 v35, v214, v215
v_mfma_f32_16x16x32_bf16 a[28:31], v[232:235], v[140:143], a[28:31]
v_exp_f32 v216, v216
v_mfma_f32_16x16x32_bf16 a[28:31], v[236:239], v[156:159], a[28:31]
s_waitcnt lgkmcnt(4)
v_mfma_f32_16x16x32_bf16 a[16:19], v[240:243], v[160:163], a[16:19]
ds_read_b64_tr_b16 v[232:233], v249 offset:0
ds_read_b64_tr_b16 v[234:235], v249 offset:2048
v_mfma_f32_16x16x32_bf16 a[16:19], v[244:247], v[176:179], a[16:19]
v_exp_f32 v217, v217
v_mfma_f32_16x16x32_bf16 a[20:23], v[240:243], v[164:167], a[20:23]
v_exp_f32 v218, v218
v_mfma_f32_16x16x32_bf16 a[20:23], v[244:247], v[180:183], a[20:23]
v_exp_f32 v219, v219
v_mfma_f32_16x16x32_bf16 a[24:27], v[240:243], v[168:171], a[24:27]
ds_read_b64_tr_b16 v[236:237], v250 offset:0
ds_read_b64_tr_b16 v[238:239], v250 offset:2048
v_mfma_f32_16x16x32_bf16 a[24:27], v[244:247], v[184:187], a[24:27]
v_cvt_pk_bf16_f32 v66, v216, v217
v_cvt_pk_bf16_f32 v67, v218, v219
v_mfma_f32_16x16x32_bf16 a[28:31], v[240:243], v[172:175], a[28:31]
v_exp_f32 v220, v220
v_mfma_f32_16x16x32_bf16 a[28:31], v[244:247], v[188:191], a[28:31]
s_waitcnt lgkmcnt(4)
v_mfma_f32_16x16x32_bf16 a[32:35], v[224:227], v[4:7], a[32:35]
ds_read_b64_tr_b16 v[240:241], v12 offset:512
ds_read_b64_tr_b16 v[242:243], v12 offset:2560
v_mfma_f32_16x16x32_bf16 a[32:35], v[228:231], v[8:11], a[32:35]
v_exp_f32 v221, v221
v_mfma_f32_16x16x32_bf16 a[36:39], v[224:227], v[36:39], a[36:39]
v_exp_f32 v222, v222
v_mfma_f32_16x16x32_bf16 a[36:39], v[228:231], v[40:43], a[36:39]
v_exp_f32 v223, v223
v_mfma_f32_16x16x32_bf16 a[40:43], v[224:227], v[68:71], a[40:43]
ds_read_b64_tr_b16 v[244:245], v12 offset:16896
ds_read_b64_tr_b16 v[246:247], v12 offset:18944
v_mfma_f32_16x16x32_bf16 a[40:43], v[228:231], v[72:75], a[40:43]
v_cvt_pk_bf16_f32 v98, v220, v221
v_cvt_pk_bf16_f32 v99, v222, v223
v_mfma_f32_16x16x32_bf16 a[44:47], v[224:227], v[100:103], a[44:47]
v_mfma_f32_16x16x32_bf16 a[44:47], v[228:231], v[104:107], a[44:47]
s_waitcnt lgkmcnt(4)
v_mfma_f32_16x16x32_bf16 a[0:3], v[232:235], v[0:3], a[0:3]
ds_read_b64_tr_b16 v[224:225], v12 offset:33280
ds_read_b64_tr_b16 v[226:227], v12 offset:35328
v_mfma_f32_16x16x32_bf16 a[4:7], v[232:235], v[32:35], a[4:7]
v_mfma_f32_16x16x32_bf16 a[8:11], v[232:235], v[64:67], a[8:11]
v_mfma_f32_16x16x32_bf16 a[12:15], v[232:235], v[96:99], a[12:15]
v_mfma_f32_16x16x32_bf16 a[16:19], v[236:239], v[0:3], a[16:19]
ds_read_b64_tr_b16 v[228:229], v12 offset:49664
ds_read_b64_tr_b16 v[230:231], v12 offset:51712
v_mfma_f32_16x16x32_bf16 a[20:23], v[236:239], v[32:35], a[20:23]
v_mfma_f32_16x16x32_bf16 a[24:27], v[236:239], v[64:67], a[24:27]
v_mfma_f32_16x16x32_bf16 a[28:31], v[236:239], v[96:99], a[28:31]
s_waitcnt lgkmcnt(4)
v_mfma_f32_16x16x32_bf16 a[32:35], v[240:243], v[128:131], a[32:35]
ds_read_b64_tr_b16 v[232:233], v249 offset:512
ds_read_b64_tr_b16 v[234:235], v249 offset:2560
v_mfma_f32_16x16x32_bf16 a[32:35], v[244:247], v[144:147], a[32:35]
v_mfma_f32_16x16x32_bf16 a[36:39], v[240:243], v[132:135], a[36:39]
v_mfma_f32_16x16x32_bf16 a[36:39], v[244:247], v[148:151], a[36:39]
v_mfma_f32_16x16x32_bf16 a[40:43], v[240:243], v[136:139], a[40:43]
ds_read_b64_tr_b16 v[236:237], v250 offset:512
ds_read_b64_tr_b16 v[238:239], v250 offset:2560
v_accvgpr_read_b32 v192, a0
v_mfma_f32_16x16x32_bf16 a[40:43], v[244:247], v[152:155], a[40:43]
v_accvgpr_read_b32 v193, a4
v_accvgpr_read_b32 v194, a8
v_accvgpr_read_b32 v195, a12
v_mfma_f32_16x16x32_bf16 a[44:47], v[240:243], v[140:143], a[44:47]
v_lshlrev_b32 v253, 2, v252
v_max3_u32 v254, v192, v193, v194
v_min3_u32 v255, v192, v193, v194
v_mfma_f32_16x16x32_bf16 a[44:47], v[244:247], v[156:159], a[44:47]
s_waitcnt lgkmcnt(4)
v_max_u32 v254, v254, v195
v_min_u32 v255, v255, v195
v_mfma_f32_16x16x32_bf16 a[32:35], v[224:227], v[160:163], a[32:35]
ds_read_b64_tr_b16 v[240:241], v250 offset:33280
ds_read_b64_tr_b16 v[242:243], v250 offset:35328
v_mfma_f32_16x16x32_bf16 a[32:35], v[228:231], v[176:179], a[32:35]
s_mov_b64 exec, 0xffff
buffer_store_dword v192, v253, s[24:27], s48 offen offset:4 sc1
buffer_store_dword v193, v253, s[24:27], s48 offen offset:1028 sc1
buffer_store_dword v194, v253, s[24:27], s48 offen offset:2052 sc1
buffer_store_dword v195, v253, s[24:27], s48 offen offset:3076 sc1
v_cmp_lt_u32 s[50:51], s52, v254
v_cmp_gt_u32 vcc, s53, v255
s_mov_b64 exec, -1
v_mfma_f32_16x16x32_bf16 a[36:39], v[224:227], v[164:167], a[36:39]
v_accvgpr_read_b32 v192, a0
v_accvgpr_read_b32 v193, a1
v_mfma_f32_16x16x32_bf16 a[36:39], v[228:231], v[180:183], a[36:39]
v_accvgpr_read_b32 v194, a2
v_accvgpr_read_b32 v195, a3
v_mfma_f32_16x16x32_bf16 a[40:43], v[224:227], v[168:171], a[40:43]
ds_read_b64_tr_b16 v[244:245], v250 offset:49664
ds_read_b64_tr_b16 v[246:247], v250 offset:51712
v_mfma_f32_16x16x32_bf16 a[40:43], v[228:231], v[184:187], a[40:43]
v_cvt_pk_bf16_f32 v16, v192, v193
v_cvt_pk_bf16_f32 v17, v194, v195
v_mfma_f32_16x16x32_bf16 a[44:47], v[224:227], v[172:175], a[44:47]
v_accvgpr_read_b32 v200, a4
v_accvgpr_read_b32 v201, a5
v_mfma_f32_16x16x32_bf16 a[44:47], v[228:231], v[188:191], a[44:47]
s_waitcnt lgkmcnt(4)
v_accvgpr_read_b32 v202, a6
v_mfma_f32_16x16x32_bf16 a[32:35], v[232:235], v[0:3], a[32:35]
ds_read_b64_tr_b16 v[224:225], v13 offset:512
ds_read_b64_tr_b16 v[226:227], v13 offset:2560
v_mfma_f32_16x16x32_bf16 a[36:39], v[232:235], v[32:35], a[36:39]
v_accvgpr_read_b32 v203, a7
v_cvt_pk_bf16_f32 v48, v200, v201
v_mfma_f32_16x16x32_bf16 a[40:43], v[232:235], v[64:67], a[40:43]
v_cvt_pk_bf16_f32 v49, v202, v203
v_accvgpr_read_b32 v208, a8
v_mfma_f32_16x16x32_bf16 a[44:47], v[232:235], v[96:99], a[44:47]
v_accvgpr_read_b32 v209, a9
v_accvgpr_read_b32 v210, a10
v_mfma_f32_16x16x32_bf16 a[48:51], v[236:239], v[0:3], a[48:51]
ds_read_b64_tr_b16 v[228:229], v13 offset:16896
ds_read_b64_tr_b16 v[230:231], v13 offset:18944
v_mfma_f32_16x16x32_bf16 a[52:55], v[236:239], v[32:35], a[52:55]
v_accvgpr_read_b32 v211, a11
v_cvt_pk_bf16_f32 v80, v208, v209
v_mfma_f32_16x16x32_bf16 a[56:59], v[236:239], v[64:67], a[56:59]
v_cvt_pk_bf16_f32 v81, v210, v211
v_accvgpr_read_b32 v216, a12
v_mfma_f32_16x16x32_bf16 a[60:63], v[236:239], v[96:99], a[60:63]
s_waitcnt lgkmcnt(4)
v_accvgpr_read_b32 v217, a13
v_mfma_f32_16x16x32_bf16 a[48:51], v[240:243], v[4:7], a[48:51]
ds_read_b64_tr_b16 v[232:233], v13 offset:33280
ds_read_b64_tr_b16 v[234:235], v13 offset:35328
v_mfma_f32_16x16x32_bf16 a[48:51], v[244:247], v[8:11], a[48:51]
v_accvgpr_read_b32 v218, a14
v_accvgpr_read_b32 v219, a15
v_mfma_f32_16x16x32_bf16 a[52:55], v[240:243], v[36:39], a[52:55]
v_cvt_pk_bf16_f32 v112, v216, v217
v_cvt_pk_bf16_f32 v113, v218, v219
v_mfma_f32_16x16x32_bf16 a[52:55], v[244:247], v[40:43], a[52:55]
v_accvgpr_read_b32 v196, a16
v_accvgpr_read_b32 v197, a17
v_mfma_f32_16x16x32_bf16 a[56:59], v[240:243], v[68:71], a[56:59]
ds_read_b64_tr_b16 v[236:237], v13 offset:49664
ds_read_b64_tr_b16 v[238:239], v13 offset:51712
v_mfma_f32_16x16x32_bf16 a[56:59], v[244:247], v[72:75], a[56:59]
v_accvgpr_read_b32 v198, a18
v_accvgpr_read_b32 v199, a19
v_mfma_f32_16x16x32_bf16 a[60:63], v[240:243], v[100:103], a[60:63]
v_cvt_pk_bf16_f32 v18, v196, v197
v_cvt_pk_bf16_f32 v19, v198, v199
v_mfma_f32_16x16x32_bf16 a[60:63], v[244:247], v[104:107], a[60:63]
s_waitcnt lgkmcnt(4)
buffer_store_dwordx4 v[16:19], v252, s[20:23], s40 offen offset:0 sc1
v_mfma_f32_16x16x32_bf16 a[48:51], v[224:227], v[128:131], a[48:51]
ds_read_b64_tr_b16 v[240:241], v249 offset:36864
ds_read_b64_tr_b16 v[242:243], v249 offset:38912
v_mfma_f32_16x16x32_bf16 a[48:51], v[228:231], v[144:147], a[48:51]
v_accvgpr_read_b32 v204, a20
v_accvgpr_read_b32 v205, a21
v_mfma_f32_16x16x32_bf16 a[52:55], v[224:227], v[132:135], a[52:55]
v_accvgpr_read_b32 v206, a22
v_accvgpr_read_b32 v207, a23
v_mfma_f32_16x16x32_bf16 a[52:55], v[228:231], v[148:151], a[52:55]
v_cvt_pk_bf16_f32 v50, v204, v205
v_cvt_pk_bf16_f32 v51, v206, v207
v_mfma_f32_16x16x32_bf16 a[56:59], v[224:227], v[136:139], a[56:59]
ds_read_b64_tr_b16 v[244:245], v249 offset:53248
ds_read_b64_tr_b16 v[246:247], v249 offset:55296
v_mfma_f32_16x16x32_bf16 a[56:59], v[228:231], v[152:155], a[56:59]
buffer_store_dwordx4 v[48:51], v252, s[20:23], s41 offen offset:0 sc1
v_accvgpr_read_b32 v212, a24
v_mfma_f32_16x16x32_bf16 a[60:63], v[224:227], v[140:143], a[60:63]
v_accvgpr_read_b32 v213, a25
v_accvgpr_read_b32 v214, a26
v_mfma_f32_16x16x32_bf16 a[60:63], v[228:231], v[156:159], a[60:63]
s_waitcnt lgkmcnt(4)
v_accvgpr_read_b32 v215, a27
v_mfma_f32_16x16x32_bf16 a[48:51], v[232:235], v[160:163], a[48:51]
ds_read_b64_tr_b16 v[224:225], v12 offset:4096
ds_read_b64_tr_b16 v[226:227], v12 offset:6144
v_mfma_f32_16x16x32_bf16 a[48:51], v[236:239], v[176:179], a[48:51]
v_cvt_pk_bf16_f32 v82, v212, v213
v_cvt_pk_bf16_f32 v83, v214, v215
v_mfma_f32_16x16x32_bf16 a[52:55], v[232:235], v[164:167], a[52:55]
buffer_store_dwordx4 v[80:83], v252, s[20:23], s42 offen offset:0 sc1
v_accvgpr_read_b32 v220, a28
v_mfma_f32_16x16x32_bf16 a[52:55], v[236:239], v[180:183], a[52:55]
v_accvgpr_read_b32 v221, a29
v_accvgpr_read_b32 v222, a30
v_mfma_f32_16x16x32_bf16 a[56:59], v[232:235], v[168:171], a[56:59]
ds_read_b64_tr_b16 v[228:229], v12 offset:20480
ds_read_b64_tr_b16 v[230:231], v12 offset:22528
v_mfma_f32_16x16x32_bf16 a[56:59], v[236:239], v[184:187], a[56:59]
v_accvgpr_read_b32 v223, a31
v_cvt_pk_bf16_f32 v114, v220, v221
v_mfma_f32_16x16x32_bf16 a[60:63], v[232:235], v[172:175], a[60:63]
v_cvt_pk_bf16_f32 v115, v222, v223
buffer_store_dwordx4 v[112:115], v252, s[20:23], s43 offen offset:0 sc1
v_mfma_f32_16x16x32_bf16 a[60:63], v[236:239], v[188:191], a[60:63]
s_waitcnt lgkmcnt(4)
v_accvgpr_read_b32 v192, a32
v_mfma_f32_16x16x32_bf16 a[64:67], v[240:243], v[4:7], a[64:67]
ds_read_b64_tr_b16 v[232:233], v12 offset:36864
ds_read_b64_tr_b16 v[234:235], v12 offset:38912
v_mfma_f32_16x16x32_bf16 a[64:67], v[244:247], v[8:11], a[64:67]
v_accvgpr_read_b32 v193, a33
v_accvgpr_read_b32 v194, a34
v_mfma_f32_16x16x32_bf16 a[68:71], v[240:243], v[36:39], a[68:71]
v_accvgpr_read_b32 v195, a35
v_cvt_pk_bf16_f32 v20, v192, v193
v_mfma_f32_16x16x32_bf16 a[68:71], v[244:247], v[40:43], a[68:71]
v_cvt_pk_bf16_f32 v21, v194, v195
v_accvgpr_read_b32 v200, a36
v_mfma_f32_16x16x32_bf16 a[72:75], v[240:243], v[68:71], a[72:75]
ds_read_b64_tr_b16 v[236:237], v12 offset:53248
ds_read_b64_tr_b16 v[238:239], v12 offset:55296
v_mfma_f32_16x16x32_bf16 a[72:75], v[244:247], v[72:75], a[72:75]
v_accvgpr_read_b32 v201, a37
v_accvgpr_read_b32 v202, a38
v_mfma_f32_16x16x32_bf16 a[76:79], v[240:243], v[100:103], a[76:79]
v_accvgpr_read_b32 v203, a39
v_cvt_pk_bf16_f32 v52, v200, v201
v_mfma_f32_16x16x32_bf16 a[76:79], v[244:247], v[104:107], a[76:79]
s_waitcnt lgkmcnt(4)
v_cvt_pk_bf16_f32 v53, v202, v203
v_mfma_f32_16x16x32_bf16 a[64:67], v[224:227], v[128:131], a[64:67]
ds_read_b64_tr_b16 v[240:241], v249 offset:4096
ds_read_b64_tr_b16 v[242:243], v249 offset:6144
v_mfma_f32_16x16x32_bf16 a[64:67], v[228:231], v[144:147], a[64:67]
v_accvgpr_read_b32 v208, a40
v_accvgpr_read_b32 v209, a41
v_mfma_f32_16x16x32_bf16 a[68:71], v[224:227], v[132:135], a[68:71]
v_accvgpr_read_b32 v210, a42
v_accvgpr_read_b32 v211, a43
v_mfma_f32_16x16x32_bf16 a[68:71], v[228:231], v[148:151], a[68:71]
v_cvt_pk_bf16_f32 v84, v208, v209
v_cvt_pk_bf16_f32 v85, v210, v211
v_mfma_f32_16x16x32_bf16 a[72:75], v[224:227], v[136:139], a[72:75]
ds_read_b64_tr_b16 v[244:245], v250 offset:4096
ds_read_b64_tr_b16 v[246:247], v250 offset:6144
v_mfma_f32_16x16x32_bf16 a[72:75], v[228:231], v[152:155], a[72:75]
v_accvgpr_read_b32 v216, a44
v_accvgpr_read_b32 v217, a45
v_mfma_f32_16x16x32_bf16 a[76:79], v[224:227], v[140:143], a[76:79]
v_accvgpr_read_b32 v218, a46
v_accvgpr_read_b32 v219, a47
v_mfma_f32_16x16x32_bf16 a[76:79], v[228:231], v[156:159], a[76:79]
s_waitcnt lgkmcnt(4)
v_cvt_pk_bf16_f32 v116, v216, v217
v_mfma_f32_16x16x32_bf16 a[64:67], v[232:235], v[160:163], a[64:67]
ds_read_b64_tr_b16 v[224:225], v250 offset:36864
ds_read_b64_tr_b16 v[226:227], v250 offset:38912
v_mfma_f32_16x16x32_bf16 a[64:67], v[236:239], v[176:179], a[64:67]
v_cvt_pk_bf16_f32 v117, v218, v219
v_accvgpr_read_b32 v196, a48
v_mfma_f32_16x16x32_bf16 a[68:71], v[232:235], v[164:167], a[68:71]
v_accvgpr_read_b32 v197, a49
v_accvgpr_read_b32 v198, a50
v_mfma_f32_16x16x32_bf16 a[68:71], v[236:239], v[180:183], a[68:71]
v_accvgpr_read_b32 v199, a51
v_cvt_pk_bf16_f32 v22, v196, v197
v_mfma_f32_16x16x32_bf16 a[72:75], v[232:235], v[168:171], a[72:75]
ds_read_b64_tr_b16 v[228:229], v250 offset:53248
ds_read_b64_tr_b16 v[230:231], v250 offset:55296
v_mfma_f32_16x16x32_bf16 a[72:75], v[236:239], v[184:187], a[72:75]
v_cvt_pk_bf16_f32 v23, v198, v199
buffer_store_dwordx4 v[20:23], v252, s[20:23], s40 offen offset:1024 sc1
v_mfma_f32_16x16x32_bf16 a[76:79], v[232:235], v[172:175], a[76:79]
v_accvgpr_read_b32 v204, a52
v_accvgpr_read_b32 v205, a53
v_mfma_f32_16x16x32_bf16 a[76:79], v[236:239], v[188:191], a[76:79]
s_waitcnt lgkmcnt(4)
v_accvgpr_read_b32 v206, a54
v_mfma_f32_16x16x32_bf16 a[64:67], v[240:243], v[0:3], a[64:67]
ds_read_b64_tr_b16 v[232:233], v13 offset:4096
ds_read_b64_tr_b16 v[234:235], v13 offset:6144
v_mfma_f32_16x16x32_bf16 a[68:71], v[240:243], v[32:35], a[68:71]
v_accvgpr_read_b32 v207, a55
v_cvt_pk_bf16_f32 v54, v204, v205
v_mfma_f32_16x16x32_bf16 a[72:75], v[240:243], v[64:67], a[72:75]
v_cvt_pk_bf16_f32 v55, v206, v207
buffer_store_dwordx4 v[52:55], v252, s[20:23], s41 offen offset:1024 sc1
v_mfma_f32_16x16x32_bf16 a[76:79], v[240:243], v[96:99], a[76:79]
v_accvgpr_read_b32 v212, a56
v_accvgpr_read_b32 v213, a57
v_mfma_f32_16x16x32_bf16 a[80:83], v[244:247], v[0:3], a[80:83]
ds_read_b64_tr_b16 v[236:237], v13 offset:20480
ds_read_b64_tr_b16 v[238:239], v13 offset:22528
v_mfma_f32_16x16x32_bf16 a[84:87], v[244:247], v[32:35], a[84:87]
v_accvgpr_read_b32 v214, a58
v_accvgpr_read_b32 v215, a59
v_mfma_f32_16x16x32_bf16 a[88:91], v[244:247], v[64:67], a[88:91]
v_cvt_pk_bf16_f32 v86, v212, v213
v_cvt_pk_bf16_f32 v87, v214, v215
v_mfma_f32_16x16x32_bf16 a[92:95], v[244:247], v[96:99], a[92:95]
s_waitcnt lgkmcnt(4)
buffer_store_dwordx4 v[84:87], v252, s[20:23], s42 offen offset:1024 sc1
v_mfma_f32_16x16x32_bf16 a[80:83], v[224:227], v[4:7], a[80:83]
ds_read_b64_tr_b16 v[240:241], v13 offset:36864
ds_read_b64_tr_b16 v[242:243], v13 offset:38912
v_mfma_f32_16x16x32_bf16 a[80:83], v[228:231], v[8:11], a[80:83]
v_accvgpr_read_b32 v220, a60
v_accvgpr_read_b32 v221, a61
v_mfma_f32_16x16x32_bf16 a[84:87], v[224:227], v[36:39], a[84:87]
v_accvgpr_read_b32 v222, a62
v_accvgpr_read_b32 v223, a63
v_mfma_f32_16x16x32_bf16 a[84:87], v[228:231], v[40:43], a[84:87]
v_cvt_pk_bf16_f32 v118, v220, v221
v_cvt_pk_bf16_f32 v119, v222, v223
v_mfma_f32_16x16x32_bf16 a[88:91], v[224:227], v[68:71], a[88:91]
ds_read_b64_tr_b16 v[244:245], v13 offset:53248
ds_read_b64_tr_b16 v[246:247], v13 offset:55296
v_mfma_f32_16x16x32_bf16 a[88:91], v[228:231], v[72:75], a[88:91]
buffer_store_dwordx4 v[116:119], v252, s[20:23], s43 offen offset:1024 sc1
v_accvgpr_read_b32 v192, a64
v_mfma_f32_16x16x32_bf16 a[92:95], v[224:227], v[100:103], a[92:95]
v_accvgpr_read_b32 v193, a65
v_accvgpr_read_b32 v194, a66
v_mfma_f32_16x16x32_bf16 a[92:95], v[228:231], v[104:107], a[92:95]
s_waitcnt lgkmcnt(4)
v_accvgpr_read_b32 v195, a67
v_mfma_f32_16x16x32_bf16 a[80:83], v[232:235], v[128:131], a[80:83]
ds_read_b64_tr_b16 v[224:225], v249 offset:37376
ds_read_b64_tr_b16 v[226:227], v249 offset:39424
v_mfma_f32_16x16x32_bf16 a[80:83], v[236:239], v[144:147], a[80:83]
v_cvt_pk_bf16_f32 v24, v192, v193
v_cvt_pk_bf16_f32 v25, v194, v195
v_mfma_f32_16x16x32_bf16 a[84:87], v[232:235], v[132:135], a[84:87]
v_accvgpr_read_b32 v200, a68
v_accvgpr_read_b32 v201, a69
v_mfma_f32_16x16x32_bf16 a[84:87], v[236:239], v[148:151], a[84:87]
v_accvgpr_read_b32 v202, a70
v_accvgpr_read_b32 v203, a71
v_mfma_f32_16x16x32_bf16 a[88:91], v[232:235], v[136:139], a[88:91]
ds_read_b64_tr_b16 v[228:229], v249 offset:53760
ds_read_b64_tr_b16 v[230:231], v249 offset:55808
v_mfma_f32_16x16x32_bf16 a[88:91], v[236:239], v[152:155], a[88:91]
v_cvt_pk_bf16_f32 v56, v200, v201
v_cvt_pk_bf16_f32 v57, v202, v203
v_mfma_f32_16x16x32_bf16 a[92:95], v[232:235], v[140:143], a[92:95]
v_accvgpr_read_b32 v208, a72
v_accvgpr_read_b32 v209, a73
v_mfma_f32_16x16x32_bf16 a[92:95], v[236:239], v[156:159], a[92:95]
s_waitcnt lgkmcnt(4)
v_accvgpr_read_b32 v210, a74
v_mfma_f32_16x16x32_bf16 a[80:83], v[240:243], v[160:163], a[80:83]
ds_read_b64_tr_b16 v[232:233], v12 offset:4608
ds_read_b64_tr_b16 v[234:235], v12 offset:6656
v_mfma_f32_16x16x32_bf16 a[80:83], v[244:247], v[176:179], a[80:83]
v_accvgpr_read_b32 v211, a75
v_cvt_pk_bf16_f32 v88, v208, v209
v_mfma_f32_16x16x32_bf16 a[84:87], v[240:243], v[164:167], a[84:87]
v_cvt_pk_bf16_f32 v89, v210, v211
v_accvgpr_read_b32 v216, a76
v_mfma_f32_16x16x32_bf16 a[84:87], v[244:247], v[180:183], a[84:87]
v_accvgpr_read_b32 v217, a77
v_accvgpr_read_b32 v218, a78
v_mfma_f32_16x16x32_bf16 a[88:91], v[240:243], v[168:171], a[88:91]
ds_read_b64_tr_b16 v[236:237], v12 offset:20992
ds_read_b64_tr_b16 v[238:239], v12 offset:23040
v_mfma_f32_16x16x32_bf16 a[88:91], v[244:247], v[184:187], a[88:91]
v_accvgpr_read_b32 v219, a79
v_cvt_pk_bf16_f32 v120, v216, v217
v_mfma_f32_16x16x32_bf16 a[92:95], v[240:243], v[172:175], a[92:95]
v_cvt_pk_bf16_f32 v121, v218, v219
v_accvgpr_read_b32 v196, a80
v_mfma_f32_16x16x32_bf16 a[92:95], v[244:247], v[188:191], a[92:95]
s_waitcnt lgkmcnt(4)
v_accvgpr_read_b32 v197, a81
v_mfma_f32_16x16x32_bf16 a[96:99], v[224:227], v[4:7], a[96:99]
ds_read_b64_tr_b16 v[240:241], v12 offset:37376
ds_read_b64_tr_b16 v[242:243], v12 offset:39424
v_mfma_f32_16x16x32_bf16 a[96:99], v[228:231], v[8:11], a[96:99]
v_accvgpr_read_b32 v198, a82
v_accvgpr_read_b32 v199, a83
v_mfma_f32_16x16x32_bf16 a[100:103], v[224:227], v[36:39], a[100:103]
v_cvt_pk_bf16_f32 v26, v196, v197
v_cvt_pk_bf16_f32 v27, v198, v199
v_mfma_f32_16x16x32_bf16 a[100:103], v[228:231], v[40:43], a[100:103]
buffer_store_dwordx4 v[24:27], v252, s[20:23], s40 offen offset:2048 sc1
v_accvgpr_read_b32 v204, a84
v_mfma_f32_16x16x32_bf16 a[104:107], v[224:227], v[68:71], a[104:107]
ds_read_b64_tr_b16 v[244:245], v12 offset:53760
ds_read_b64_tr_b16 v[246:247], v12 offset:55808
v_mfma_f32_16x16x32_bf16 a[104:107], v[228:231], v[72:75], a[104:107]
v_accvgpr_read_b32 v205, a85
v_accvgpr_read_b32 v206, a86
v_mfma_f32_16x16x32_bf16 a[108:111], v[224:227], v[100:103], a[108:111]
v_accvgpr_read_b32 v207, a87
v_cvt_pk_bf16_f32 v58, v204, v205
v_mfma_f32_16x16x32_bf16 a[108:111], v[228:231], v[104:107], a[108:111]
s_waitcnt lgkmcnt(4)
v_cvt_pk_bf16_f32 v59, v206, v207
v_mfma_f32_16x16x32_bf16 a[96:99], v[232:235], v[128:131], a[96:99]
ds_read_b64_tr_b16 v[224:225], v249 offset:4608
ds_read_b64_tr_b16 v[226:227], v249 offset:6656
v_mfma_f32_16x16x32_bf16 a[96:99], v[236:239], v[144:147], a[96:99]
buffer_store_dwordx4 v[56:59], v252, s[20:23], s41 offen offset:2048 sc1
v_accvgpr_read_b32 v212, a88
v_mfma_f32_16x16x32_bf16 a[100:103], v[232:235], v[132:135], a[100:103]
v_accvgpr_read_b32 v213, a89
v_accvgpr_read_b32 v214, a90
v_mfma_f32_16x16x32_bf16 a[100:103], v[236:239], v[148:151], a[100:103]
v_accvgpr_read_b32 v215, a91
v_cvt_pk_bf16_f32 v90, v212, v213
v_mfma_f32_16x16x32_bf16 a[104:107], v[232:235], v[136:139], a[104:107]
ds_read_b64_tr_b16 v[228:229], v250 offset:4608
ds_read_b64_tr_b16 v[230:231], v250 offset:6656
v_mfma_f32_16x16x32_bf16 a[104:107], v[236:239], v[152:155], a[104:107]
v_cvt_pk_bf16_f32 v91, v214, v215
buffer_store_dwordx4 v[88:91], v252, s[20:23], s42 offen offset:2048 sc1
v_mfma_f32_16x16x32_bf16 a[108:111], v[232:235], v[140:143], a[108:111]
v_accvgpr_read_b32 v220, a92
v_accvgpr_read_b32 v221, a93
v_mfma_f32_16x16x32_bf16 a[108:111], v[236:239], v[156:159], a[108:111]
s_waitcnt lgkmcnt(4)
v_accvgpr_read_b32 v222, a94
v_mfma_f32_16x16x32_bf16 a[96:99], v[240:243], v[160:163], a[96:99]
ds_read_b64_tr_b16 v[232:233], v250 offset:37376
ds_read_b64_tr_b16 v[234:235], v250 offset:39424
v_mfma_f32_16x16x32_bf16 a[96:99], v[244:247], v[176:179], a[96:99]
v_accvgpr_read_b32 v223, a95
v_cvt_pk_bf16_f32 v122, v220, v221
v_mfma_f32_16x16x32_bf16 a[100:103], v[240:243], v[164:167], a[100:103]
v_cvt_pk_bf16_f32 v123, v222, v223
buffer_store_dwordx4 v[120:123], v252, s[20:23], s43 offen offset:2048 sc1
v_mfma_f32_16x16x32_bf16 a[100:103], v[244:247], v[180:183], a[100:103]
v_mfma_f32_16x16x32_bf16 a[104:107], v[240:243], v[168:171], a[104:107]
ds_read_b64_tr_b16 v[236:237], v250 offset:53760
ds_read_b64_tr_b16 v[238:239], v250 offset:55808
v_mfma_f32_16x16x32_bf16 a[104:107], v[244:247], v[184:187], a[104:107]
v_mfma_f32_16x16x32_bf16 a[108:111], v[240:243], v[172:175], a[108:111]
v_mfma_f32_16x16x32_bf16 a[108:111], v[244:247], v[188:191], a[108:111]
s_waitcnt lgkmcnt(4)
v_mfma_f32_16x16x32_bf16 a[96:99], v[224:227], v[0:3], a[96:99]
ds_read_b64_tr_b16 v[240:241], v13 offset:4608
ds_read_b64_tr_b16 v[242:243], v13 offset:6656
v_mfma_f32_16x16x32_bf16 a[100:103], v[224:227], v[32:35], a[100:103]
v_mfma_f32_16x16x32_bf16 a[104:107], v[224:227], v[64:67], a[104:107]
v_mfma_f32_16x16x32_bf16 a[108:111], v[224:227], v[96:99], a[108:111]
v_mfma_f32_16x16x32_bf16 a[112:115], v[228:231], v[0:3], a[112:115]
ds_read_b64_tr_b16 v[244:245], v13 offset:20992
ds_read_b64_tr_b16 v[246:247], v13 offset:23040
v_mfma_f32_16x16x32_bf16 a[116:119], v[228:231], v[32:35], a[116:119]
v_accvgpr_read_b32 v192, a96
v_accvgpr_read_b32 v193, a97
v_mfma_f32_16x16x32_bf16 a[120:123], v[228:231], v[64:67], a[120:123]
v_accvgpr_read_b32 v194, a98
v_accvgpr_read_b32 v195, a99
v_mfma_f32_16x16x32_bf16 a[124:127], v[228:231], v[96:99], a[124:127]
s_waitcnt lgkmcnt(4)
v_cvt_pk_bf16_f32 v28, v192, v193
v_mfma_f32_16x16x32_bf16 a[112:115], v[232:235], v[4:7], a[112:115]
ds_read_b64_tr_b16 v[224:225], v13 offset:37376
ds_read_b64_tr_b16 v[226:227], v13 offset:39424
v_mfma_f32_16x16x32_bf16 a[112:115], v[236:239], v[8:11], a[112:115]
v_cvt_pk_bf16_f32 v29, v194, v195
v_accvgpr_read_b32 v200, a100
v_mfma_f32_16x16x32_bf16 a[116:119], v[232:235], v[36:39], a[116:119]
v_accvgpr_read_b32 v201, a101
v_accvgpr_read_b32 v202, a102
v_mfma_f32_16x16x32_bf16 a[116:119], v[236:239], v[40:43], a[116:119]
v_accvgpr_read_b32 v203, a103
v_cvt_pk_bf16_f32 v60, v200, v201
v_mfma_f32_16x16x32_bf16 a[120:123], v[232:235], v[68:71], a[120:123]
ds_read_b64_tr_b16 v[228:229], v13 offset:53760
ds_read_b64_tr_b16 v[230:231], v13 offset:55808
v_mfma_f32_16x16x32_bf16 a[120:123], v[236:239], v[72:75], a[120:123]
v_cvt_pk_bf16_f32 v61, v202, v203
v_accvgpr_read_b32 v208, a104
v_mfma_f32_16x16x32_bf16 a[124:127], v[232:235], v[100:103], a[124:127]
v_accvgpr_read_b32 v209, a105
v_accvgpr_read_b32 v210, a106
v_mfma_f32_16x16x32_bf16 a[124:127], v[236:239], v[104:107], a[124:127]
s_waitcnt lgkmcnt(4)
v_accvgpr_read_b32 v211, a107
v_mfma_f32_16x16x32_bf16 a[112:115], v[240:243], v[128:131], a[112:115]
ds_read_b64_tr_b16 v[232:233], v249 offset:40960
ds_read_b64_tr_b16 v[234:235], v249 offset:43008
v_mfma_f32_16x16x32_bf16 a[112:115], v[244:247], v[144:147], a[112:115]
v_cvt_pk_bf16_f32 v92, v208, v209
v_cvt_pk_bf16_f32 v93, v210, v211
v_mfma_f32_16x16x32_bf16 a[116:119], v[240:243], v[132:135], a[116:119]
v_accvgpr_read_b32 v216, a108
v_accvgpr_read_b32 v217, a109
v_mfma_f32_16x16x32_bf16 a[116:119], v[244:247], v[148:151], a[116:119]
v_accvgpr_read_b32 v218, a110
v_accvgpr_read_b32 v219, a111
v_mfma_f32_16x16x32_bf16 a[120:123], v[240:243], v[136:139], a[120:123]
ds_read_b64_tr_b16 v[236:237], v249 offset:57344
ds_read_b64_tr_b16 v[238:239], v249 offset:59392
v_mfma_f32_16x16x32_bf16 a[120:123], v[244:247], v[152:155], a[120:123]
v_cvt_pk_bf16_f32 v124, v216, v217
v_cvt_pk_bf16_f32 v125, v218, v219
v_mfma_f32_16x16x32_bf16 a[124:127], v[240:243], v[140:143], a[124:127]
v_mfma_f32_16x16x32_bf16 a[124:127], v[244:247], v[156:159], a[124:127]
s_waitcnt lgkmcnt(4)
v_mfma_f32_16x16x32_bf16 a[112:115], v[224:227], v[160:163], a[112:115]
ds_read_b64_tr_b16 v[240:241], v12 offset:8192
ds_read_b64_tr_b16 v[242:243], v12 offset:10240
v_mfma_f32_16x16x32_bf16 a[112:115], v[228:231], v[176:179], a[112:115]
v_mfma_f32_16x16x32_bf16 a[116:119], v[224:227], v[164:167], a[116:119]
v_mfma_f32_16x16x32_bf16 a[116:119], v[228:231], v[180:183], a[116:119]
v_mfma_f32_16x16x32_bf16 a[120:123], v[224:227], v[168:171], a[120:123]
ds_read_b64_tr_b16 v[244:245], v12 offset:24576
ds_read_b64_tr_b16 v[246:247], v12 offset:26624
v_mfma_f32_16x16x32_bf16 a[120:123], v[228:231], v[184:187], a[120:123]
v_mfma_f32_16x16x32_bf16 a[124:127], v[224:227], v[172:175], a[124:127]
s_nop 0
v_accvgpr_read_b32 v196, a112
v_accvgpr_read_b32 v197, a113
v_mfma_f32_16x16x32_bf16 a[124:127], v[228:231], v[188:191], a[124:127]
s_waitcnt lgkmcnt(4)
v_accvgpr_read_b32 v198, a114
v_mfma_f32_16x16x32_bf16 a[128:131], v[232:235], v[4:7], a[128:131]
ds_read_b64_tr_b16 v[224:225], v12 offset:40960
ds_read_b64_tr_b16 v[226:227], v12 offset:43008
v_mfma_f32_16x16x32_bf16 a[128:131], v[236:239], v[8:11], a[128:131]
v_accvgpr_read_b32 v199, a115
v_cvt_pk_bf16_f32 v30, v196, v197
v_mfma_f32_16x16x32_bf16 a[132:135], v[232:235], v[36:39], a[132:135]
v_cvt_pk_bf16_f32 v31, v198, v199
buffer_store_dwordx4 v[28:31], v252, s[20:23], s40 offen offset:3072 sc1
v_mfma_f32_16x16x32_bf16 a[132:135], v[236:239], v[40:43], a[132:135]
v_accvgpr_read_b32 v204, a116
v_accvgpr_read_b32 v205, a117
v_mfma_f32_16x16x32_bf16 a[136:139], v[232:235], v[68:71], a[136:139]
ds_read_b64_tr_b16 v[228:229], v12 offset:57344
ds_read_b64_tr_b16 v[230:231], v12 offset:59392
v_mfma_f32_16x16x32_bf16 a[136:139], v[236:239], v[72:75], a[136:139]
v_accvgpr_read_b32 v206, a118
v_accvgpr_read_b32 v207, a119
v_mfma_f32_16x16x32_bf16 a[140:143], v[232:235], v[100:103], a[140:143]
v_cvt_pk_bf16_f32 v62, v204, v205
v_cvt_pk_bf16_f32 v63, v206, v207
v_mfma_f32_16x16x32_bf16 a[140:143], v[236:239], v[104:107], a[140:143]
s_waitcnt lgkmcnt(4)
buffer_store_dwordx4 v[60:63], v252, s[20:23], s41 offen offset:3072 sc1
v_mfma_f32_16x16x32_bf16 a[128:131], v[240:243], v[128:131], a[128:131]
ds_read_b64_tr_b16 v[232:233], v249 offset:8192
ds_read_b64_tr_b16 v[234:235], v249 offset:10240
v_mfma_f32_16x16x32_bf16 a[128:131], v[244:247], v[144:147], a[128:131]
v_accvgpr_read_b32 v212, a120
v_accvgpr_read_b32 v213, a121
v_mfma_f32_16x16x32_bf16 a[132:135], v[240:243], v[132:135], a[132:135]
v_accvgpr_read_b32 v214, a122
v_accvgpr_read_b32 v215, a123
v_mfma_f32_16x16x32_bf16 a[132:135], v[244:247], v[148:151], a[132:135]
v_cvt_pk_bf16_f32 v94, v212, v213
v_cvt_pk_bf16_f32 v95, v214, v215
v_mfma_f32_16x16x32_bf16 a[136:139], v[240:243], v[136:139], a[136:139]
ds_read_b64_tr_b16 v[236:237], v250 offset:8192
ds_read_b64_tr_b16 v[238:239], v250 offset:10240
v_mfma_f32_16x16x32_bf16 a[136:139], v[244:247], v[152:155], a[136:139]
buffer_store_dwordx4 v[92:95], v252, s[20:23], s42 offen offset:3072 sc1
v_accvgpr_read_b32 v220, a124
v_mfma_f32_16x16x32_bf16 a[140:143], v[240:243], v[140:143], a[140:143]
v_accvgpr_read_b32 v221, a125
v_accvgpr_read_b32 v222, a126
v_mfma_f32_16x16x32_bf16 a[140:143], v[244:247], v[156:159], a[140:143]
s_waitcnt lgkmcnt(4)
v_accvgpr_read_b32 v223, a127
v_mfma_f32_16x16x32_bf16 a[128:131], v[224:227], v[160:163], a[128:131]
ds_read_b64_tr_b16 v[240:241], v250 offset:40960
ds_read_b64_tr_b16 v[242:243], v250 offset:43008
v_mfma_f32_16x16x32_bf16 a[128:131], v[228:231], v[176:179], a[128:131]
v_cvt_pk_bf16_f32 v126, v220, v221
v_cvt_pk_bf16_f32 v127, v222, v223
v_mfma_f32_16x16x32_bf16 a[132:135], v[224:227], v[164:167], a[132:135]
buffer_store_dwordx4 v[124:127], v252, s[20:23], s43 offen offset:3072 sc1
v_mfma_f32_16x16x32_bf16 a[132:135], v[228:231], v[180:183], a[132:135]
v_mfma_f32_16x16x32_bf16 a[136:139], v[224:227], v[168:171], a[136:139]
ds_read_b64_tr_b16 v[244:245], v250 offset:57344
ds_read_b64_tr_b16 v[246:247], v250 offset:59392
v_mfma_f32_16x16x32_bf16 a[136:139], v[228:231], v[184:187], a[136:139]
v_mfma_f32_16x16x32_bf16 a[140:143], v[224:227], v[172:175], a[140:143]
v_mfma_f32_16x16x32_bf16 a[140:143], v[228:231], v[188:191], a[140:143]
s_waitcnt lgkmcnt(4)
v_mfma_f32_16x16x32_bf16 a[128:131], v[232:235], v[0:3], a[128:131]
ds_read_b64_tr_b16 v[224:225], v13 offset:8192
ds_read_b64_tr_b16 v[226:227], v13 offset:10240
v_mfma_f32_16x16x32_bf16 a[132:135], v[232:235], v[32:35], a[132:135]
v_mfma_f32_16x16x32_bf16 a[136:139], v[232:235], v[64:67], a[136:139]
v_mfma_f32_16x16x32_bf16 a[140:143], v[232:235], v[96:99], a[140:143]
v_mfma_f32_16x16x32_bf16 a[144:147], v[236:239], v[0:3], a[144:147]
ds_read_b64_tr_b16 v[228:229], v13 offset:24576
ds_read_b64_tr_b16 v[230:231], v13 offset:26624
v_mfma_f32_16x16x32_bf16 a[148:151], v[236:239], v[32:35], a[148:151]
v_accvgpr_read_b32 v192, a128
v_accvgpr_read_b32 v193, a129
v_mfma_f32_16x16x32_bf16 a[152:155], v[236:239], v[64:67], a[152:155]
v_accvgpr_read_b32 v194, a130
v_accvgpr_read_b32 v195, a131
v_mfma_f32_16x16x32_bf16 a[156:159], v[236:239], v[96:99], a[156:159]
s_waitcnt lgkmcnt(4)
v_cvt_pk_bf16_f32 v16, v192, v193
v_mfma_f32_16x16x32_bf16 a[144:147], v[240:243], v[4:7], a[144:147]
ds_read_b64_tr_b16 v[232:233], v13 offset:40960
ds_read_b64_tr_b16 v[234:235], v13 offset:43008
v_mfma_f32_16x16x32_bf16 a[144:147], v[244:247], v[8:11], a[144:147]
v_cvt_pk_bf16_f32 v17, v194, v195
v_accvgpr_read_b32 v200, a132
v_mfma_f32_16x16x32_bf16 a[148:151], v[240:243], v[36:39], a[148:151]
v_accvgpr_read_b32 v201, a133
v_accvgpr_read_b32 v202, a134
v_mfma_f32_16x16x32_bf16 a[148:151], v[244:247], v[40:43], a[148:151]
v_accvgpr_read_b32 v203, a135
v_cvt_pk_bf16_f32 v48, v200, v201
v_mfma_f32_16x16x32_bf16 a[152:155], v[240:243], v[68:71], a[152:155]
ds_read_b64_tr_b16 v[236:237], v13 offset:57344
ds_read_b64_tr_b16 v[238:239], v13 offset:59392
v_mfma_f32_16x16x32_bf16 a[152:155], v[244:247], v[72:75], a[152:155]
v_cvt_pk_bf16_f32 v49, v202, v203
v_accvgpr_read_b32 v208, a136
v_mfma_f32_16x16x32_bf16 a[156:159], v[240:243], v[100:103], a[156:159]
v_accvgpr_read_b32 v209, a137
v_accvgpr_read_b32 v210, a138
v_mfma_f32_16x16x32_bf16 a[156:159], v[244:247], v[104:107], a[156:159]
s_waitcnt lgkmcnt(4)
v_accvgpr_read_b32 v211, a139
v_mfma_f32_16x16x32_bf16 a[144:147], v[224:227], v[128:131], a[144:147]
ds_read_b64_tr_b16 v[240:241], v249 offset:41472
ds_read_b64_tr_b16 v[242:243], v249 offset:43520
v_mfma_f32_16x16x32_bf16 a[144:147], v[228:231], v[144:147], a[144:147]
v_cvt_pk_bf16_f32 v80, v208, v209
v_cvt_pk_bf16_f32 v81, v210, v211
v_mfma_f32_16x16x32_bf16 a[148:151], v[224:227], v[132:135], a[148:151]
v_accvgpr_read_b32 v216, a140
v_accvgpr_read_b32 v217, a141
v_mfma_f32_16x16x32_bf16 a[148:151], v[228:231], v[148:151], a[148:151]
v_accvgpr_read_b32 v218, a142
v_accvgpr_read_b32 v219, a143
v_mfma_f32_16x16x32_bf16 a[152:155], v[224:227], v[136:139], a[152:155]
ds_read_b64_tr_b16 v[244:245], v249 offset:57856
ds_read_b64_tr_b16 v[246:247], v249 offset:59904
v_mfma_f32_16x16x32_bf16 a[152:155], v[228:231], v[152:155], a[152:155]
v_cvt_pk_bf16_f32 v112, v216, v217
v_cvt_pk_bf16_f32 v113, v218, v219
v_mfma_f32_16x16x32_bf16 a[156:159], v[224:227], v[140:143], a[156:159]
v_mfma_f32_16x16x32_bf16 a[156:159], v[228:231], v[156:159], a[156:159]
s_waitcnt lgkmcnt(4)
v_mfma_f32_16x16x32_bf16 a[144:147], v[232:235], v[160:163], a[144:147]
ds_read_b64_tr_b16 v[224:225], v12 offset:8704
ds_read_b64_tr_b16 v[226:227], v12 offset:10752
v_mfma_f32_16x16x32_bf16 a[144:147], v[236:239], v[176:179], a[144:147]
v_mfma_f32_16x16x32_bf16 a[148:151], v[232:235], v[164:167], a[148:151]
v_mfma_f32_16x16x32_bf16 a[148:151], v[236:239], v[180:183], a[148:151]
v_mfma_f32_16x16x32_bf16 a[152:155], v[232:235], v[168:171], a[152:155]
ds_read_b64_tr_b16 v[228:229], v12 offset:25088
ds_read_b64_tr_b16 v[230:231], v12 offset:27136
v_mfma_f32_16x16x32_bf16 a[152:155], v[236:239], v[184:187], a[152:155]
v_mfma_f32_16x16x32_bf16 a[156:159], v[232:235], v[172:175], a[156:159]
s_nop 0
v_accvgpr_read_b32 v196, a144
v_accvgpr_read_b32 v197, a145
v_mfma_f32_16x16x32_bf16 a[156:159], v[236:239], v[188:191], a[156:159]
s_waitcnt lgkmcnt(4)
v_accvgpr_read_b32 v198, a146
v_mfma_f32_16x16x32_bf16 a[160:163], v[240:243], v[4:7], a[160:163]
ds_read_b64_tr_b16 v[232:233], v12 offset:41472
ds_read_b64_tr_b16 v[234:235], v12 offset:43520
v_mfma_f32_16x16x32_bf16 a[160:163], v[244:247], v[8:11], a[160:163]
v_accvgpr_read_b32 v199, a147
v_cvt_pk_bf16_f32 v18, v196, v197
v_mfma_f32_16x16x32_bf16 a[164:167], v[240:243], v[36:39], a[164:167]
v_cvt_pk_bf16_f32 v19, v198, v199
buffer_store_dwordx4 v[16:19], v252, s[20:23], s44 offen offset:0 sc1
v_mfma_f32_16x16x32_bf16 a[164:167], v[244:247], v[40:43], a[164:167]
v_accvgpr_read_b32 v204, a148
v_accvgpr_read_b32 v205, a149
v_mfma_f32_16x16x32_bf16 a[168:171], v[240:243], v[68:71], a[168:171]
ds_read_b64_tr_b16 v[236:237], v12 offset:57856
ds_read_b64_tr_b16 v[238:239], v12 offset:59904
v_mfma_f32_16x16x32_bf16 a[168:171], v[244:247], v[72:75], a[168:171]
v_accvgpr_read_b32 v206, a150
v_accvgpr_read_b32 v207, a151
v_mfma_f32_16x16x32_bf16 a[172:175], v[240:243], v[100:103], a[172:175]
v_cvt_pk_bf16_f32 v50, v204, v205
v_cvt_pk_bf16_f32 v51, v206, v207
v_mfma_f32_16x16x32_bf16 a[172:175], v[244:247], v[104:107], a[172:175]
s_waitcnt lgkmcnt(4)
buffer_store_dwordx4 v[48:51], v252, s[20:23], s45 offen offset:0 sc1
v_mfma_f32_16x16x32_bf16 a[160:163], v[224:227], v[128:131], a[160:163]
ds_read_b64_tr_b16 v[240:241], v249 offset:8704
ds_read_b64_tr_b16 v[242:243], v249 offset:10752
v_mfma_f32_16x16x32_bf16 a[160:163], v[228:231], v[144:147], a[160:163]
v_accvgpr_read_b32 v212, a152
v_accvgpr_read_b32 v213, a153
v_mfma_f32_16x16x32_bf16 a[164:167], v[224:227], v[132:135], a[164:167]
v_accvgpr_read_b32 v214, a154
v_accvgpr_read_b32 v215, a155
v_mfma_f32_16x16x32_bf16 a[164:167], v[228:231], v[148:151], a[164:167]
v_cvt_pk_bf16_f32 v82, v212, v213
v_cvt_pk_bf16_f32 v83, v214, v215
v_mfma_f32_16x16x32_bf16 a[168:171], v[224:227], v[136:139], a[168:171]
ds_read_b64_tr_b16 v[244:245], v250 offset:8704
ds_read_b64_tr_b16 v[246:247], v250 offset:10752
v_mfma_f32_16x16x32_bf16 a[168:171], v[228:231], v[152:155], a[168:171]
buffer_store_dwordx4 v[80:83], v252, s[20:23], s46 offen offset:0 sc1
v_accvgpr_read_b32 v220, a156
v_mfma_f32_16x16x32_bf16 a[172:175], v[224:227], v[140:143], a[172:175]
v_accvgpr_read_b32 v221, a157
v_accvgpr_read_b32 v222, a158
v_mfma_f32_16x16x32_bf16 a[172:175], v[228:231], v[156:159], a[172:175]
s_waitcnt lgkmcnt(4)
v_accvgpr_read_b32 v223, a159
v_mfma_f32_16x16x32_bf16 a[160:163], v[232:235], v[160:163], a[160:163]
ds_read_b64_tr_b16 v[224:225], v250 offset:41472
ds_read_b64_tr_b16 v[226:227], v250 offset:43520
v_mfma_f32_16x16x32_bf16 a[160:163], v[236:239], v[176:179], a[160:163]
v_cvt_pk_bf16_f32 v114, v220, v221
v_cvt_pk_bf16_f32 v115, v222, v223
v_mfma_f32_16x16x32_bf16 a[164:167], v[232:235], v[164:167], a[164:167]
buffer_store_dwordx4 v[112:115], v252, s[20:23], s47 offen offset:0 sc1
v_mfma_f32_16x16x32_bf16 a[164:167], v[236:239], v[180:183], a[164:167]
v_mfma_f32_16x16x32_bf16 a[168:171], v[232:235], v[168:171], a[168:171]
ds_read_b64_tr_b16 v[228:229], v250 offset:57856
ds_read_b64_tr_b16 v[230:231], v250 offset:59904
v_mfma_f32_16x16x32_bf16 a[168:171], v[236:239], v[184:187], a[168:171]
v_mfma_f32_16x16x32_bf16 a[172:175], v[232:235], v[172:175], a[172:175]
v_mfma_f32_16x16x32_bf16 a[172:175], v[236:239], v[188:191], a[172:175]
s_waitcnt lgkmcnt(4)
v_mfma_f32_16x16x32_bf16 a[160:163], v[240:243], v[0:3], a[160:163]
ds_read_b64_tr_b16 v[232:233], v13 offset:8704
ds_read_b64_tr_b16 v[234:235], v13 offset:10752
v_mfma_f32_16x16x32_bf16 a[164:167], v[240:243], v[32:35], a[164:167]
v_mfma_f32_16x16x32_bf16 a[168:171], v[240:243], v[64:67], a[168:171]
v_mfma_f32_16x16x32_bf16 a[172:175], v[240:243], v[96:99], a[172:175]
v_mfma_f32_16x16x32_bf16 a[176:179], v[244:247], v[0:3], a[176:179]
ds_read_b64_tr_b16 v[236:237], v13 offset:25088
ds_read_b64_tr_b16 v[238:239], v13 offset:27136
v_mfma_f32_16x16x32_bf16 a[180:183], v[244:247], v[32:35], a[180:183]
v_accvgpr_read_b32 v192, a160
v_accvgpr_read_b32 v193, a161
v_mfma_f32_16x16x32_bf16 a[184:187], v[244:247], v[64:67], a[184:187]
v_accvgpr_read_b32 v194, a162
v_accvgpr_read_b32 v195, a163
v_mfma_f32_16x16x32_bf16 a[188:191], v[244:247], v[96:99], a[188:191]
s_waitcnt lgkmcnt(4)
v_cvt_pk_bf16_f32 v20, v192, v193
v_mfma_f32_16x16x32_bf16 a[176:179], v[224:227], v[4:7], a[176:179]
ds_read_b64_tr_b16 v[240:241], v13 offset:41472
ds_read_b64_tr_b16 v[242:243], v13 offset:43520
v_mfma_f32_16x16x32_bf16 a[176:179], v[228:231], v[8:11], a[176:179]
v_cvt_pk_bf16_f32 v21, v194, v195
v_accvgpr_read_b32 v200, a164
v_mfma_f32_16x16x32_bf16 a[180:183], v[224:227], v[36:39], a[180:183]
v_accvgpr_read_b32 v201, a165
v_accvgpr_read_b32 v202, a166
v_mfma_f32_16x16x32_bf16 a[180:183], v[228:231], v[40:43], a[180:183]
v_accvgpr_read_b32 v203, a167
v_cvt_pk_bf16_f32 v52, v200, v201
v_mfma_f32_16x16x32_bf16 a[184:187], v[224:227], v[68:71], a[184:187]
ds_read_b64_tr_b16 v[244:245], v13 offset:57856
ds_read_b64_tr_b16 v[246:247], v13 offset:59904
v_mfma_f32_16x16x32_bf16 a[184:187], v[228:231], v[72:75], a[184:187]
v_cvt_pk_bf16_f32 v53, v202, v203
v_accvgpr_read_b32 v208, a168
v_mfma_f32_16x16x32_bf16 a[188:191], v[224:227], v[100:103], a[188:191]
v_accvgpr_read_b32 v209, a169
v_accvgpr_read_b32 v210, a170
v_mfma_f32_16x16x32_bf16 a[188:191], v[228:231], v[104:107], a[188:191]
s_waitcnt lgkmcnt(4)
v_accvgpr_read_b32 v211, a171
v_mfma_f32_16x16x32_bf16 a[176:179], v[232:235], v[128:131], a[176:179]
ds_read_b64_tr_b16 v[224:225], v249 offset:45056
ds_read_b64_tr_b16 v[226:227], v249 offset:47104
v_mfma_f32_16x16x32_bf16 a[176:179], v[236:239], v[144:147], a[176:179]
v_cvt_pk_bf16_f32 v84, v208, v209
v_cvt_pk_bf16_f32 v85, v210, v211
v_mfma_f32_16x16x32_bf16 a[180:183], v[232:235], v[132:135], a[180:183]
v_accvgpr_read_b32 v216, a172
v_accvgpr_read_b32 v217, a173
v_mfma_f32_16x16x32_bf16 a[180:183], v[236:239], v[148:151], a[180:183]
v_accvgpr_read_b32 v218, a174
v_accvgpr_read_b32 v219, a175
v_mfma_f32_16x16x32_bf16 a[184:187], v[232:235], v[136:139], a[184:187]
ds_read_b64_tr_b16 v[228:229], v249 offset:61440
ds_read_b64_tr_b16 v[230:231], v249 offset:63488
v_mfma_f32_16x16x32_bf16 a[184:187], v[236:239], v[152:155], a[184:187]
v_cvt_pk_bf16_f32 v116, v216, v217
v_cvt_pk_bf16_f32 v117, v218, v219
v_mfma_f32_16x16x32_bf16 a[188:191], v[232:235], v[140:143], a[188:191]
v_mfma_f32_16x16x32_bf16 a[188:191], v[236:239], v[156:159], a[188:191]
s_waitcnt lgkmcnt(4)
v_mfma_f32_16x16x32_bf16 a[176:179], v[240:243], v[160:163], a[176:179]
ds_read_b64_tr_b16 v[232:233], v12 offset:12288
ds_read_b64_tr_b16 v[234:235], v12 offset:14336
v_mfma_f32_16x16x32_bf16 a[176:179], v[244:247], v[176:179], a[176:179]
v_mfma_f32_16x16x32_bf16 a[180:183], v[240:243], v[164:167], a[180:183]
v_mfma_f32_16x16x32_bf16 a[180:183], v[244:247], v[180:183], a[180:183]
v_mfma_f32_16x16x32_bf16 a[184:187], v[240:243], v[168:171], a[184:187]
ds_read_b64_tr_b16 v[236:237], v12 offset:28672
ds_read_b64_tr_b16 v[238:239], v12 offset:30720
v_mfma_f32_16x16x32_bf16 a[184:187], v[244:247], v[184:187], a[184:187]
v_mfma_f32_16x16x32_bf16 a[188:191], v[240:243], v[172:175], a[188:191]
s_nop 0
v_accvgpr_read_b32 v196, a176
v_accvgpr_read_b32 v197, a177
v_mfma_f32_16x16x32_bf16 a[188:191], v[244:247], v[188:191], a[188:191]
s_waitcnt lgkmcnt(4)
v_accvgpr_read_b32 v198, a178
v_mfma_f32_16x16x32_bf16 a[192:195], v[224:227], v[4:7], a[192:195]
ds_read_b64_tr_b16 v[240:241], v12 offset:45056
ds_read_b64_tr_b16 v[242:243], v12 offset:47104
v_mfma_f32_16x16x32_bf16 a[192:195], v[228:231], v[8:11], a[192:195]
v_accvgpr_read_b32 v199, a179
v_cvt_pk_bf16_f32 v22, v196, v197
v_mfma_f32_16x16x32_bf16 a[196:199], v[224:227], v[36:39], a[196:199]
v_cvt_pk_bf16_f32 v23, v198, v199
buffer_store_dwordx4 v[20:23], v252, s[20:23], s44 offen offset:1024 sc1
v_mfma_f32_16x16x32_bf16 a[196:199], v[228:231], v[40:43], a[196:199]
v_accvgpr_read_b32 v204, a180
v_accvgpr_read_b32 v205, a181
v_mfma_f32_16x16x32_bf16 a[200:203], v[224:227], v[68:71], a[200:203]
ds_read_b64_tr_b16 v[244:245], v12 offset:61440
ds_read_b64_tr_b16 v[246:247], v12 offset:63488
v_mfma_f32_16x16x32_bf16 a[200:203], v[228:231], v[72:75], a[200:203]
v_accvgpr_read_b32 v206, a182
v_accvgpr_read_b32 v207, a183
v_mfma_f32_16x16x32_bf16 a[204:207], v[224:227], v[100:103], a[204:207]
v_cvt_pk_bf16_f32 v54, v204, v205
v_cvt_pk_bf16_f32 v55, v206, v207
v_mfma_f32_16x16x32_bf16 a[204:207], v[228:231], v[104:107], a[204:207]
s_waitcnt lgkmcnt(4)
buffer_store_dwordx4 v[52:55], v252, s[20:23], s45 offen offset:1024 sc1
v_mfma_f32_16x16x32_bf16 a[192:195], v[232:235], v[128:131], a[192:195]
ds_read_b64_tr_b16 v[224:225], v249 offset:12288
ds_read_b64_tr_b16 v[226:227], v249 offset:14336
v_mfma_f32_16x16x32_bf16 a[192:195], v[236:239], v[144:147], a[192:195]
v_accvgpr_read_b32 v212, a184
v_accvgpr_read_b32 v213, a185
v_mfma_f32_16x16x32_bf16 a[196:199], v[232:235], v[132:135], a[196:199]
v_accvgpr_read_b32 v214, a186
v_accvgpr_read_b32 v215, a187
v_mfma_f32_16x16x32_bf16 a[196:199], v[236:239], v[148:151], a[196:199]
v_cvt_pk_bf16_f32 v86, v212, v213
v_cvt_pk_bf16_f32 v87, v214, v215
v_mfma_f32_16x16x32_bf16 a[200:203], v[232:235], v[136:139], a[200:203]
ds_read_b64_tr_b16 v[228:229], v250 offset:12288
ds_read_b64_tr_b16 v[230:231], v250 offset:14336
v_mfma_f32_16x16x32_bf16 a[200:203], v[236:239], v[152:155], a[200:203]
buffer_store_dwordx4 v[84:87], v252, s[20:23], s46 offen offset:1024 sc1
v_accvgpr_read_b32 v220, a188
v_mfma_f32_16x16x32_bf16 a[204:207], v[232:235], v[140:143], a[204:207]
v_accvgpr_read_b32 v221, a189
v_accvgpr_read_b32 v222, a190
v_mfma_f32_16x16x32_bf16 a[204:207], v[236:239], v[156:159], a[204:207]
s_waitcnt lgkmcnt(4)
v_accvgpr_read_b32 v223, a191
v_mfma_f32_16x16x32_bf16 a[192:195], v[240:243], v[160:163], a[192:195]
ds_read_b64_tr_b16 v[232:233], v250 offset:45056
ds_read_b64_tr_b16 v[234:235], v250 offset:47104
v_mfma_f32_16x16x32_bf16 a[192:195], v[244:247], v[176:179], a[192:195]
v_cvt_pk_bf16_f32 v118, v220, v221
v_cvt_pk_bf16_f32 v119, v222, v223
v_mfma_f32_16x16x32_bf16 a[196:199], v[240:243], v[164:167], a[196:199]
buffer_store_dwordx4 v[116:119], v252, s[20:23], s47 offen offset:1024 sc1
v_mfma_f32_16x16x32_bf16 a[196:199], v[244:247], v[180:183], a[196:199]
v_mfma_f32_16x16x32_bf16 a[200:203], v[240:243], v[168:171], a[200:203]
ds_read_b64_tr_b16 v[236:237], v250 offset:61440
ds_read_b64_tr_b16 v[238:239], v250 offset:63488
v_mfma_f32_16x16x32_bf16 a[200:203], v[244:247], v[184:187], a[200:203]
v_mfma_f32_16x16x32_bf16 a[204:207], v[240:243], v[172:175], a[204:207]
v_mfma_f32_16x16x32_bf16 a[204:207], v[244:247], v[188:191], a[204:207]
s_waitcnt lgkmcnt(4)
v_mfma_f32_16x16x32_bf16 a[192:195], v[224:227], v[0:3], a[192:195]
ds_read_b64_tr_b16 v[240:241], v13 offset:12288
ds_read_b64_tr_b16 v[242:243], v13 offset:14336
v_mfma_f32_16x16x32_bf16 a[196:199], v[224:227], v[32:35], a[196:199]
v_mfma_f32_16x16x32_bf16 a[200:203], v[224:227], v[64:67], a[200:203]
v_mfma_f32_16x16x32_bf16 a[204:207], v[224:227], v[96:99], a[204:207]
v_mfma_f32_16x16x32_bf16 a[208:211], v[228:231], v[0:3], a[208:211]
ds_read_b64_tr_b16 v[244:245], v13 offset:28672
ds_read_b64_tr_b16 v[246:247], v13 offset:30720
v_mfma_f32_16x16x32_bf16 a[212:215], v[228:231], v[32:35], a[212:215]
v_accvgpr_read_b32 v192, a192
v_accvgpr_read_b32 v193, a193
v_mfma_f32_16x16x32_bf16 a[216:219], v[228:231], v[64:67], a[216:219]
v_accvgpr_read_b32 v194, a194
v_accvgpr_read_b32 v195, a195
v_mfma_f32_16x16x32_bf16 a[220:223], v[228:231], v[96:99], a[220:223]
s_waitcnt lgkmcnt(4)
v_cvt_pk_bf16_f32 v24, v192, v193
v_mfma_f32_16x16x32_bf16 a[208:211], v[232:235], v[4:7], a[208:211]
ds_read_b64_tr_b16 v[224:225], v13 offset:45056
ds_read_b64_tr_b16 v[226:227], v13 offset:47104
v_mfma_f32_16x16x32_bf16 a[208:211], v[236:239], v[8:11], a[208:211]
v_cvt_pk_bf16_f32 v25, v194, v195
v_accvgpr_read_b32 v200, a196
v_mfma_f32_16x16x32_bf16 a[212:215], v[232:235], v[36:39], a[212:215]
v_accvgpr_read_b32 v201, a197
v_accvgpr_read_b32 v202, a198
v_mfma_f32_16x16x32_bf16 a[212:215], v[236:239], v[40:43], a[212:215]
v_accvgpr_read_b32 v203, a199
v_cvt_pk_bf16_f32 v56, v200, v201
v_mfma_f32_16x16x32_bf16 a[216:219], v[232:235], v[68:71], a[216:219]
ds_read_b64_tr_b16 v[228:229], v13 offset:61440
ds_read_b64_tr_b16 v[230:231], v13 offset:63488
v_mfma_f32_16x16x32_bf16 a[216:219], v[236:239], v[72:75], a[216:219]
v_cvt_pk_bf16_f32 v57, v202, v203
v_accvgpr_read_b32 v208, a200
v_mfma_f32_16x16x32_bf16 a[220:223], v[232:235], v[100:103], a[220:223]
v_accvgpr_read_b32 v209, a201
v_accvgpr_read_b32 v210, a202
v_mfma_f32_16x16x32_bf16 a[220:223], v[236:239], v[104:107], a[220:223]
s_waitcnt lgkmcnt(4)
v_accvgpr_read_b32 v211, a203
v_mfma_f32_16x16x32_bf16 a[208:211], v[240:243], v[128:131], a[208:211]
ds_read_b64_tr_b16 v[232:233], v249 offset:45568
ds_read_b64_tr_b16 v[234:235], v249 offset:47616
v_mfma_f32_16x16x32_bf16 a[208:211], v[244:247], v[144:147], a[208:211]
v_cvt_pk_bf16_f32 v88, v208, v209
v_cvt_pk_bf16_f32 v89, v210, v211
v_mfma_f32_16x16x32_bf16 a[212:215], v[240:243], v[132:135], a[212:215]
v_accvgpr_read_b32 v216, a204
v_accvgpr_read_b32 v217, a205
v_mfma_f32_16x16x32_bf16 a[212:215], v[244:247], v[148:151], a[212:215]
v_accvgpr_read_b32 v218, a206
v_accvgpr_read_b32 v219, a207
v_mfma_f32_16x16x32_bf16 a[216:219], v[240:243], v[136:139], a[216:219]
ds_read_b64_tr_b16 v[236:237], v249 offset:61952
ds_read_b64_tr_b16 v[238:239], v249 offset:64000
v_mfma_f32_16x16x32_bf16 a[216:219], v[244:247], v[152:155], a[216:219]
v_cvt_pk_bf16_f32 v120, v216, v217
v_cvt_pk_bf16_f32 v121, v218, v219
v_mfma_f32_16x16x32_bf16 a[220:223], v[240:243], v[140:143], a[220:223]
v_mfma_f32_16x16x32_bf16 a[220:223], v[244:247], v[156:159], a[220:223]
s_waitcnt lgkmcnt(4)
v_mfma_f32_16x16x32_bf16 a[208:211], v[224:227], v[160:163], a[208:211]
ds_read_b64_tr_b16 v[240:241], v12 offset:12800
ds_read_b64_tr_b16 v[242:243], v12 offset:14848
v_mfma_f32_16x16x32_bf16 a[208:211], v[228:231], v[176:179], a[208:211]
v_mfma_f32_16x16x32_bf16 a[212:215], v[224:227], v[164:167], a[212:215]
v_mfma_f32_16x16x32_bf16 a[212:215], v[228:231], v[180:183], a[212:215]
v_mfma_f32_16x16x32_bf16 a[216:219], v[224:227], v[168:171], a[216:219]
ds_read_b64_tr_b16 v[244:245], v12 offset:29184
ds_read_b64_tr_b16 v[246:247], v12 offset:31232
v_mfma_f32_16x16x32_bf16 a[216:219], v[228:231], v[184:187], a[216:219]
v_mfma_f32_16x16x32_bf16 a[220:223], v[224:227], v[172:175], a[220:223]
s_nop 0
v_accvgpr_read_b32 v196, a208
v_accvgpr_read_b32 v197, a209
v_mfma_f32_16x16x32_bf16 a[220:223], v[228:231], v[188:191], a[220:223]
s_waitcnt lgkmcnt(4)
v_accvgpr_read_b32 v198, a210
v_mfma_f32_16x16x32_bf16 a[224:227], v[232:235], v[4:7], a[224:227]
ds_read_b64_tr_b16 v[224:225], v12 offset:45568
ds_read_b64_tr_b16 v[226:227], v12 offset:47616
v_mfma_f32_16x16x32_bf16 a[224:227], v[236:239], v[8:11], a[224:227]
v_accvgpr_read_b32 v199, a211
v_cvt_pk_bf16_f32 v26, v196, v197
v_mfma_f32_16x16x32_bf16 a[228:231], v[232:235], v[36:39], a[228:231]
v_cvt_pk_bf16_f32 v27, v198, v199
buffer_store_dwordx4 v[24:27], v252, s[20:23], s44 offen offset:2048 sc1
v_mfma_f32_16x16x32_bf16 a[228:231], v[236:239], v[40:43], a[228:231]
v_accvgpr_read_b32 v204, a212
v_accvgpr_read_b32 v205, a213
v_mfma_f32_16x16x32_bf16 a[232:235], v[232:235], v[68:71], a[232:235]
ds_read_b64_tr_b16 v[228:229], v12 offset:61952
ds_read_b64_tr_b16 v[230:231], v12 offset:64000
v_mfma_f32_16x16x32_bf16 a[232:235], v[236:239], v[72:75], a[232:235]
v_accvgpr_read_b32 v206, a214
v_accvgpr_read_b32 v207, a215
v_mfma_f32_16x16x32_bf16 a[236:239], v[232:235], v[100:103], a[236:239]
v_cvt_pk_bf16_f32 v58, v204, v205
v_cvt_pk_bf16_f32 v59, v206, v207
v_mfma_f32_16x16x32_bf16 a[236:239], v[236:239], v[104:107], a[236:239]
s_waitcnt lgkmcnt(4)
buffer_store_dwordx4 v[56:59], v252, s[20:23], s45 offen offset:2048 sc1
v_mfma_f32_16x16x32_bf16 a[224:227], v[240:243], v[128:131], a[224:227]
ds_read_b64_tr_b16 v[232:233], v249 offset:12800
ds_read_b64_tr_b16 v[234:235], v249 offset:14848
v_mfma_f32_16x16x32_bf16 a[224:227], v[244:247], v[144:147], a[224:227]
v_accvgpr_read_b32 v212, a216
v_accvgpr_read_b32 v213, a217
v_mfma_f32_16x16x32_bf16 a[228:231], v[240:243], v[132:135], a[228:231]
v_accvgpr_read_b32 v214, a218
v_accvgpr_read_b32 v215, a219
v_mfma_f32_16x16x32_bf16 a[228:231], v[244:247], v[148:151], a[228:231]
v_cvt_pk_bf16_f32 v90, v212, v213
v_cvt_pk_bf16_f32 v91, v214, v215
v_mfma_f32_16x16x32_bf16 a[232:235], v[240:243], v[136:139], a[232:235]
ds_read_b64_tr_b16 v[236:237], v250 offset:12800
ds_read_b64_tr_b16 v[238:239], v250 offset:14848
v_mfma_f32_16x16x32_bf16 a[232:235], v[244:247], v[152:155], a[232:235]
buffer_store_dwordx4 v[88:91], v252, s[20:23], s46 offen offset:2048 sc1
v_accvgpr_read_b32 v220, a220
v_mfma_f32_16x16x32_bf16 a[236:239], v[240:243], v[140:143], a[236:239]
v_accvgpr_read_b32 v221, a221
v_accvgpr_read_b32 v222, a222
v_mfma_f32_16x16x32_bf16 a[236:239], v[244:247], v[156:159], a[236:239]
s_waitcnt lgkmcnt(4)
v_accvgpr_read_b32 v223, a223
v_mfma_f32_16x16x32_bf16 a[224:227], v[224:227], v[160:163], a[224:227]
ds_read_b64_tr_b16 v[240:241], v250 offset:45568
ds_read_b64_tr_b16 v[242:243], v250 offset:47616
v_mfma_f32_16x16x32_bf16 a[224:227], v[228:231], v[176:179], a[224:227]
v_cvt_pk_bf16_f32 v122, v220, v221
v_cvt_pk_bf16_f32 v123, v222, v223
v_mfma_f32_16x16x32_bf16 a[228:231], v[224:227], v[164:167], a[228:231]
buffer_store_dwordx4 v[120:123], v252, s[20:23], s47 offen offset:2048 sc1
v_mfma_f32_16x16x32_bf16 a[228:231], v[228:231], v[180:183], a[228:231]
v_mfma_f32_16x16x32_bf16 a[232:235], v[224:227], v[168:171], a[232:235]
ds_read_b64_tr_b16 v[244:245], v250 offset:61952
ds_read_b64_tr_b16 v[246:247], v250 offset:64000
v_mfma_f32_16x16x32_bf16 a[232:235], v[228:231], v[184:187], a[232:235]
v_mfma_f32_16x16x32_bf16 a[236:239], v[224:227], v[172:175], a[236:239]
v_mfma_f32_16x16x32_bf16 a[236:239], v[228:231], v[188:191], a[236:239]
s_waitcnt lgkmcnt(4)
v_mfma_f32_16x16x32_bf16 a[224:227], v[232:235], v[0:3], a[224:227]
ds_read_b64_tr_b16 v[224:225], v13 offset:12800
ds_read_b64_tr_b16 v[226:227], v13 offset:14848
v_mfma_f32_16x16x32_bf16 a[228:231], v[232:235], v[32:35], a[228:231]
v_mfma_f32_16x16x32_bf16 a[232:235], v[232:235], v[64:67], a[232:235]
v_mfma_f32_16x16x32_bf16 a[236:239], v[232:235], v[96:99], a[236:239]
v_mfma_f32_16x16x32_bf16 a[240:243], v[236:239], v[0:3], a[240:243]
ds_read_b64_tr_b16 v[228:229], v13 offset:29184
ds_read_b64_tr_b16 v[230:231], v13 offset:31232
v_mfma_f32_16x16x32_bf16 a[244:247], v[236:239], v[32:35], a[244:247]
v_accvgpr_read_b32 v192, a224
v_accvgpr_read_b32 v193, a225
v_mfma_f32_16x16x32_bf16 a[248:251], v[236:239], v[64:67], a[248:251]
v_accvgpr_read_b32 v194, a226
v_accvgpr_read_b32 v195, a227
v_mfma_f32_16x16x32_bf16 a[252:255], v[236:239], v[96:99], a[252:255]
s_waitcnt lgkmcnt(4)
v_cvt_pk_bf16_f32 v28, v192, v193
v_mfma_f32_16x16x32_bf16 a[240:243], v[240:243], v[4:7], a[240:243]
ds_read_b64_tr_b16 v[232:233], v13 offset:45568
ds_read_b64_tr_b16 v[234:235], v13 offset:47616
v_mfma_f32_16x16x32_bf16 a[240:243], v[244:247], v[8:11], a[240:243]
v_cvt_pk_bf16_f32 v29, v194, v195
v_accvgpr_read_b32 v200, a228
v_mfma_f32_16x16x32_bf16 a[244:247], v[240:243], v[36:39], a[244:247]
v_accvgpr_read_b32 v201, a229
v_accvgpr_read_b32 v202, a230
v_mfma_f32_16x16x32_bf16 a[244:247], v[244:247], v[40:43], a[244:247]
v_accvgpr_read_b32 v203, a231
v_cvt_pk_bf16_f32 v60, v200, v201
v_mfma_f32_16x16x32_bf16 a[248:251], v[240:243], v[68:71], a[248:251]
ds_read_b64_tr_b16 v[236:237], v13 offset:61952
ds_read_b64_tr_b16 v[238:239], v13 offset:64000
v_mfma_f32_16x16x32_bf16 a[248:251], v[244:247], v[72:75], a[248:251]
v_cvt_pk_bf16_f32 v61, v202, v203
v_accvgpr_read_b32 v208, a232
v_mfma_f32_16x16x32_bf16 a[252:255], v[240:243], v[100:103], a[252:255]
v_accvgpr_read_b32 v209, a233
v_accvgpr_read_b32 v210, a234
v_mfma_f32_16x16x32_bf16 a[252:255], v[244:247], v[104:107], a[252:255]
s_waitcnt lgkmcnt(4)
v_accvgpr_read_b32 v211, a235
v_mfma_f32_16x16x32_bf16 a[240:243], v[224:227], v[128:131], a[240:243]
v_cvt_pk_bf16_f32 v92, v208, v209
v_cvt_pk_bf16_f32 v93, v210, v211
v_mfma_f32_16x16x32_bf16 a[240:243], v[228:231], v[144:147], a[240:243]
v_accvgpr_read_b32 v216, a236
v_accvgpr_read_b32 v217, a237
v_mfma_f32_16x16x32_bf16 a[244:247], v[224:227], v[132:135], a[244:247]
v_accvgpr_read_b32 v218, a238
v_accvgpr_read_b32 v219, a239
v_mfma_f32_16x16x32_bf16 a[244:247], v[228:231], v[148:151], a[244:247]
v_cvt_pk_bf16_f32 v124, v216, v217
v_cvt_pk_bf16_f32 v125, v218, v219
v_mfma_f32_16x16x32_bf16 a[248:251], v[224:227], v[136:139], a[248:251]
v_mfma_f32_16x16x32_bf16 a[248:251], v[228:231], v[152:155], a[248:251]
v_mfma_f32_16x16x32_bf16 a[252:255], v[224:227], v[140:143], a[252:255]
v_mfma_f32_16x16x32_bf16 a[252:255], v[228:231], v[156:159], a[252:255]
s_waitcnt lgkmcnt(0)
v_mfma_f32_16x16x32_bf16 a[240:243], v[232:235], v[160:163], a[240:243]
v_mfma_f32_16x16x32_bf16 a[240:243], v[236:239], v[176:179], a[240:243]
v_mfma_f32_16x16x32_bf16 a[244:247], v[232:235], v[164:167], a[244:247]
v_mfma_f32_16x16x32_bf16 a[244:247], v[236:239], v[180:183], a[244:247]
v_mfma_f32_16x16x32_bf16 a[248:251], v[232:235], v[168:171], a[248:251]
v_mfma_f32_16x16x32_bf16 a[248:251], v[236:239], v[184:187], a[248:251]
v_mfma_f32_16x16x32_bf16 a[252:255], v[232:235], v[172:175], a[252:255]
s_nop 2
v_accvgpr_read_b32 v196, a240
v_accvgpr_read_b32 v197, a241
v_accvgpr_read_b32 v198, a242
v_accvgpr_read_b32 v199, a243
v_mfma_f32_16x16x32_bf16 a[252:255], v[236:239], v[188:191], a[252:255]
v_cvt_pk_bf16_f32 v30, v196, v197
v_cvt_pk_bf16_f32 v31, v198, v199
buffer_store_dwordx4 v[28:31], v252, s[20:23], s44 offen offset:3072 sc1
v_accvgpr_read_b32 v204, a244
v_accvgpr_read_b32 v205, a245
v_accvgpr_read_b32 v206, a246
v_accvgpr_read_b32 v207, a247
v_cvt_pk_bf16_f32 v62, v204, v205
v_cvt_pk_bf16_f32 v63, v206, v207
buffer_store_dwordx4 v[60:63], v252, s[20:23], s45 offen offset:3072 sc1
v_accvgpr_read_b32 v212, a248
v_accvgpr_read_b32 v213, a249
v_accvgpr_read_b32 v214, a250
v_accvgpr_read_b32 v215, a251
v_cvt_pk_bf16_f32 v94, v212, v213
v_cvt_pk_bf16_f32 v95, v214, v215
buffer_store_dwordx4 v[92:95], v252, s[20:23], s46 offen offset:3072 sc1
v_accvgpr_read_b32 v220, a252
v_accvgpr_read_b32 v221, a253
v_accvgpr_read_b32 v222, a254
v_accvgpr_read_b32 v223, a255
v_cvt_pk_bf16_f32 v126, v220, v221
v_cvt_pk_bf16_f32 v127, v222, v223
buffer_store_dwordx4 v[124:127], v252, s[20:23], s47 offen offset:3072 sc1
s_branch L2_chk
L2_chk:
s_or_b64 vcc, vcc, s[50:51]
LC_start:
s_mul_i32 s32, s37, 3
s_lshl_b32 s33, s38, 4
s_add_u32 s32, s32, s33
s_lshl_b32 s52, s32, 13
s_add_u32 s53, s52, 8192
s_add_u32 s54, s52, 16384
s_lshl_b32 s48, s38, 7
s_lshl_b32 s49, s38, 7
s_lshl_b32 s50, s38, 7
s_cmp_eq_u32 s37, 5
s_cselect_b32 s14, 1, 0
s_cselect_b32 s52, 0x7fff0000, s52
s_cselect_b32 s53, 0x7fff0000, s53
s_cselect_b32 s54, 0x7fff0000, s54
s_cmp_eq_u32 s34, 0
s_cselect_b32 s15, 0x6c00000, s52
s_cselect_b32 s15, s15, 0x7fff0000
LC_common:
s_nop 0
s_bfe_u32 s3, s2, 0x30003
s_and_b32 s3, s3, 7
s_lshl_b32 s13, s34, 4
s_or_b32 s13, s13, s3
s_lshl_b32 s13, s13, 11
s_lshr_b32 s101, s3, 1
s_xor_b32 s101, s101, s34
s_lshl_b32 s101, s101, 10
s_add_u32 s101, s101, s100
s_cmp_eq_u32 s14, 1
s_cselect_b32 s13, 0x7fff0000, s13
s_cmp_lg_u64 vcc, 0
s_cselect_b32 s98, 1, 0
s_add_u32 s28, s4, 0x7000000
s_addc_u32 s29, s5, 0
s_mov_b32 s30, 0x4e2000
s_mov_b32 s31, 0x00020000
s_lshl_b32 s33, s34, 7
v_bfe_u32 v5, v252, 4, 3
v_lshrrev_b32 v6, 8, v252
v_xor_b32 v5, v5, v6
v_lshrrev_b32 v6, 7, v252
v_lshl_add_u32 v6, v6, 9, s33
v_lshl_add_u32 v5, v5, 4, v6
v_xor_b32 v6, 64, v5
v_add_u32 v6, 0x1000, v6
s_cmp_ge_u32 s99, 60
s_cbranch_scc0 LC_side
LC_sideok:
s_add_u32 m0, s101, 0
s_nop 0
buffer_load_dwordx4 v5, s[28:31], s52 offen sc1 lds
s_add_u32 m0, s101, 4096
s_nop 0
buffer_load_dwordx4 v6, s[28:31], s52 offen sc1 lds
s_add_u32 m0, s101, 8192
s_nop 0
buffer_load_dwordx4 v5, s[28:31], s53 offen sc1 lds
s_add_u32 m0, s101, 12288
s_nop 0
buffer_load_dwordx4 v6, s[28:31], s53 offen sc1 lds
s_add_u32 m0, s101, 16384
s_nop 0
buffer_load_dwordx4 v5, s[28:31], s54 offen sc1 lds
s_add_u32 m0, s101, 20480
s_nop 0
buffer_load_dwordx4 v6, s[28:31], s54 offen sc1 lds
s_xor_b32 s33, s13, 0x0
buffer_load_dwordx4 a[0:3], v252, s[56:59], s33 offen offset:0
buffer_load_dwordx4 a[4:7], v252, s[56:59], s33 offen offset:1024
s_xor_b32 s35, s13, 0x4000
buffer_load_dwordx4 a[64:67], v252, s[56:59], s35 offen offset:0
buffer_load_dwordx4 a[68:71], v252, s[56:59], s35 offen offset:1024
s_xor_b32 s39, s13, 0x800
buffer_load_dwordx4 a[8:11], v252, s[56:59], s39 offen offset:0
buffer_load_dwordx4 a[12:15], v252, s[56:59], s39 offen offset:1024
s_xor_b32 s32, s13, 0x4800
buffer_load_dwordx4 a[72:75], v252, s[56:59], s32 offen offset:0
buffer_load_dwordx4 a[76:79], v252, s[56:59], s32 offen offset:1024
s_lshl_b32 s32, s34, 13
s_add_u32 s32, s32, 0x20000
v_mov_b32 v24, s32
v_mov_b32 v25, s98
ds_write_b32 v24, v25
v_lshrrev_b32 v0, 4, v252
v_and_b32 v2, 15, v0
v_lshrrev_b32 v3, 4, v0
s_lshl_b32 s55, s34, 13
s_add_u32 s55, s55, 0x21000
s_lshl_b32 s73, s34, 11
s_add_u32 s73, s73, s100
s_add_u32 s73, s73, 0x6000
s_lshl_b32 s33, s34, 7
v_bfe_u32 v9, v252, 4, 3
v_lshrrev_b32 v1, 7, v252
v_xor_b32 v9, v9, v1
v_lshl_add_u32 v1, v1, 9, s33
v_lshl_add_u32 v9, v9, 4, v1
v_mov_b32 v4, 0x7fff0000
v_cmp_eq_u32 vcc, 0, v3
v_mov_b32 v1, s52
s_nop 0
v_cndmask_b32 v4, v4, v1, vcc
v_cmp_eq_u32 vcc, 1, v3
v_mov_b32 v1, s53
s_nop 0
v_cndmask_b32 v4, v4, v1, vcc
v_cmp_eq_u32 vcc, 2, v3
v_mov_b32 v1, s54
s_nop 0
v_cndmask_b32 v4, v4, v1, vcc
v_lshl_add_u32 v4, v2, 9, v4
v_lshrrev_b32 v7, 3, v4
v_lshrrev_b32 v8, 8, v4
s_add_u32 s20, s4, 0x2000000
s_addc_u32 s21, s5, 0
s_mov_b32 s22, 0x22e4000
s_mov_b32 s23, 0x00020000
s_add_u32 s40, s18, 0x0
s_addc_u32 s41, s19, 0
s_mov_b32 s42, 0x4e2000
s_mov_b32 s43, 0x00020000
s_add_u32 s60, s4, 0x7c00000
s_addc_u32 s61, s5, 0
s_mov_b32 s12, 0xffff0000
v_mov_b32 v22, s48
v_writelane_b32 v22, s49, 1
v_writelane_b32 v22, s50, 2
s_lshl_b32 s33, s34, 11
v_add_u32 v10, s33, v252
s_lshl_b32 s32, s3, 10
v_xor_b32 v18, s32, v10
v_add_u32 v18, 0x8000, v18
v_xor_b32 v26, 0x400, v18
v_lshrrev_b32 v1, 1, v2
v_xor_b32 v1, v1, v3
v_lshrrev_b32 v11, 3, v2
v_lshlrev_b32 v11, 12, v11
v_lshl_add_u32 v11, v1, 4, v11
v_and_b32 v1, 7, v2
v_lshl_add_u32 v11, v1, 7, v11
s_and_b32 s32, s3, 1
s_lshl_b32 s32, s32, 6
v_xor_b32 v11, s32, v11
v_add_u32 v11, s100, v11
v_xor_b32 v12, 64, v11
s_add_u32 s33, s33, 57344
v_lshl_add_u32 v13, v0, 5, s33
v_lshl_add_u32 v14, v2, 5, s33
v_xor_b32 v1, v1, v3
v_lshlrev_b32 v1, 4, v1
v_lshl_add_u32 v1, v2, 7, v1
v_add_u32 v15, s55, v1
v_xor_b32 v16, 64, v15
v_add_u32 v244, s73, v1
v_xor_b32 v245, 64, v244
v_add_u32 v17, s55, v252
v_add_u32 v246, s73, v252
v_mov_b32 v23, 1
v_and_b32 v24, 3, v0
v_lshlrev_b32 v24, 13, v24
v_add_u32 v24, 0x20000, v24
s_waitcnt vmcnt(14)
s_waitcnt lgkmcnt(0)
s_barrier
ds_read_b32 v25, v24
s_waitcnt lgkmcnt(0)
v_cmp_ne_u32 vcc, 0, v25
s_cbranch_vccnz LC_slow
s_mov_b64 exec, 1
buffer_atomic_add v23, v22, s[56:59], s15 offen
s_mov_b64 exec, -1
s_cmp_eq_u32 s14, 1
s_cbranch_scc1 L2_fin
v_lshlrev_b32 v1, 16, v255
ds_write_b32 v13, v1 offset:12
ds_read_b32 v19, v14 offset:12
ds_read_b32 v20, v14 offset:524
ds_read_b32 v21, v14 offset:1036
s_xor_b32 s33, s13, 0x1000
buffer_load_dwordx4 a[16:19], v252, s[56:59], s33 offen offset:0
buffer_load_dwordx4 a[20:23], v252, s[56:59], s33 offen offset:1024
s_xor_b32 s35, s13, 0x5000
buffer_load_dwordx4 a[80:83], v252, s[56:59], s35 offen offset:0
buffer_load_dwordx4 a[84:87], v252, s[56:59], s35 offen offset:1024
s_xor_b32 s39, s13, 0x1800
buffer_load_dwordx4 a[24:27], v252, s[56:59], s39 offen offset:0
buffer_load_dwordx4 a[28:31], v252, s[56:59], s39 offen offset:1024
s_xor_b32 s32, s13, 0x5800
buffer_load_dwordx4 a[88:91], v252, s[56:59], s32 offen offset:0
buffer_load_dwordx4 a[92:95], v252, s[56:59], s32 offen offset:1024
s_xor_b32 s33, s13, 0x2000
buffer_load_dwordx4 a[32:35], v252, s[56:59], s33 offen offset:0
buffer_load_dwordx4 a[36:39], v252, s[56:59], s33 offen offset:1024
s_xor_b32 s35, s13, 0x6000
buffer_load_dwordx4 a[96:99], v252, s[56:59], s35 offen offset:0
buffer_load_dwordx4 a[100:103], v252, s[56:59], s35 offen offset:1024
s_waitcnt vmcnt(11)
s_xor_b32 s39, s13, 0x2800
buffer_load_dwordx4 a[40:43], v252, s[56:59], s39 offen offset:0
s_waitcnt vmcnt(11)
buffer_load_dwordx4 a[44:47], v252, s[56:59], s39 offen offset:1024
s_waitcnt vmcnt(11)
s_xor_b32 s32, s13, 0x6800
buffer_load_dwordx4 a[104:107], v252, s[56:59], s32 offen offset:0
s_waitcnt vmcnt(11)
buffer_load_dwordx4 a[108:111], v252, s[56:59], s32 offen offset:1024
s_waitcnt vmcnt(11)
s_xor_b32 s33, s13, 0x3000
buffer_load_dwordx4 a[48:51], v252, s[56:59], s33 offen offset:0
s_waitcnt vmcnt(11)
buffer_load_dwordx4 a[52:55], v252, s[56:59], s33 offen offset:1024
s_waitcnt vmcnt(11)
s_xor_b32 s35, s13, 0x7000
buffer_load_dwordx4 a[112:115], v252, s[56:59], s35 offen offset:0
s_waitcnt vmcnt(11)
buffer_load_dwordx4 a[116:119], v252, s[56:59], s35 offen offset:1024
s_waitcnt vmcnt(11)
s_xor_b32 s39, s13, 0x3800
buffer_load_dwordx4 a[56:59], v252, s[56:59], s39 offen offset:0
s_waitcnt vmcnt(11)
buffer_load_dwordx4 a[60:63], v252, s[56:59], s39 offen offset:1024
s_waitcnt vmcnt(11)
s_xor_b32 s32, s13, 0x7800
buffer_load_dwordx4 a[120:123], v252, s[56:59], s32 offen offset:0
s_waitcnt vmcnt(11)
buffer_load_dwordx4 a[124:127], v252, s[56:59], s32 offen offset:1024
s_waitcnt vmcnt(11)
s_xor_b32 s33, s13, 0x20000
buffer_load_dwordx4 a[128:131], v252, s[56:59], s33 offen offset:0
s_waitcnt vmcnt(11)
buffer_load_dwordx4 a[132:135], v252, s[56:59], s33 offen offset:1024
s_waitcnt vmcnt(11)
s_xor_b32 s35, s13, 0x24000
buffer_load_dwordx4 a[192:195], v252, s[56:59], s35 offen offset:0
s_waitcnt vmcnt(11)
buffer_load_dwordx4 a[196:199], v252, s[56:59], s35 offen offset:1024
s_waitcnt vmcnt(11)
s_xor_b32 s39, s13, 0x20800
buffer_load_dwordx4 a[136:139], v252, s[56:59], s39 offen offset:0
s_waitcnt vmcnt(11)
buffer_load_dwordx4 a[140:143], v252, s[56:59], s39 offen offset:1024
s_waitcnt vmcnt(11)
s_xor_b32 s32, s13, 0x24800
buffer_load_dwordx4 a[200:203], v252, s[56:59], s32 offen offset:0
s_waitcnt vmcnt(11)
buffer_load_dwordx4 a[204:207], v252, s[56:59], s32 offen offset:1024
s_waitcnt vmcnt(11)
s_mov_b32 s70, 0
s_atomic_add s70, s[60:61], s48 glc
s_waitcnt vmcnt(10)
s_xor_b32 s33, s13, 0x21000
buffer_load_dwordx4 a[144:147], v252, s[56:59], s33 offen offset:0
s_waitcnt vmcnt(10)
buffer_load_dwordx4 a[148:151], v252, s[56:59], s33 offen offset:1024
s_waitcnt vmcnt(10)
s_xor_b32 s35, s13, 0x25000
buffer_load_dwordx4 a[208:211], v252, s[56:59], s35 offen offset:0
s_waitcnt vmcnt(10)
buffer_load_dwordx4 a[212:215], v252, s[56:59], s35 offen offset:1024
s_waitcnt vmcnt(10)
s_xor_b32 s39, s13, 0x21800
buffer_load_dwordx4 a[152:155], v252, s[56:59], s39 offen offset:0
s_waitcnt vmcnt(10)
buffer_load_dwordx4 a[156:159], v252, s[56:59], s39 offen offset:1024
s_waitcnt vmcnt(10)
s_xor_b32 s32, s13, 0x25800
buffer_load_dwordx4 a[216:219], v252, s[56:59], s32 offen offset:0
s_waitcnt vmcnt(10)
buffer_load_dwordx4 a[220:223], v252, s[56:59], s32 offen offset:1024
s_waitcnt lgkmcnt(0)
s_cmp_lt_u32 s70, 6
s_cbranch_scc1 LC_poll
s_cmp_ge_u32 s2, 240
s_cbranch_scc1 LC_poll
LC_got:
buffer_load_dwordx4 v[136:139], v7, s[24:27], 0 offen offset:0 sc1
buffer_load_dwordx4 v[140:143], v7, s[24:27], 0 offen offset:16 sc1
buffer_load_dwordx4 v[144:147], v7, s[24:27], 0 offen offset:32 sc1
s_add_u32 s33, s52, 0x0
buffer_load_dwordx4 v[148:151], v10, s[20:23], s33 offen offset:0 sc1
s_add_u32 s35, s52, 0x600000
buffer_load_dwordx4 v[152:155], v10, s[20:23], s35 offen offset:0 sc1
s_add_u32 s39, s52, 0xc00000
buffer_load_dwordx4 v[156:159], v10, s[20:23], s39 offen offset:0 sc1
s_add_u32 s32, s52, 0x1200000
buffer_load_dwordx4 v[160:163], v10, s[20:23], s32 offen offset:0 sc1
s_add_u32 s33, s52, 0x1800000
buffer_load_dwordx4 v[164:167], v10, s[20:23], s33 offen offset:0 sc1
s_add_u32 s35, s52, 0x1e00000
buffer_load_dwordx4 v[168:171], v10, s[20:23], s35 offen offset:0 sc1
s_add_u32 s39, s52, 0x0
buffer_load_dwordx4 v[172:175], v10, s[20:23], s39 offen offset:1024 sc1
s_add_u32 s32, s52, 0x600000
buffer_load_dwordx4 v[176:179], v10, s[20:23], s32 offen offset:1024 sc1
s_add_u32 s33, s52, 0xc00000
buffer_load_dwordx4 v[180:183], v10, s[20:23], s33 offen offset:1024 sc1
s_barrier
ds_read_b128 v[112:115], v11 offset:0
ds_read_b128 v[116:119], v11 offset:8192
ds_read_b128 v[120:123], v11 offset:16384
ds_read_b128 v[124:127], v12 offset:0
ds_read_b128 v[128:131], v12 offset:8192
s_waitcnt vmcnt(22)
s_waitcnt vmcnt(21)
s_waitcnt vmcnt(20)
s_waitcnt vmcnt(19)
s_waitcnt vmcnt(18)
s_waitcnt vmcnt(17)
s_waitcnt vmcnt(16)
s_waitcnt vmcnt(15)
s_waitcnt vmcnt(14)
s_waitcnt vmcnt(13)
s_waitcnt vmcnt(12)
s_waitcnt lgkmcnt(4)
v_mfma_f32_16x16x32_bf16 v[28:31], a[0:3], v[112:115], 0
ds_read_b128 v[132:135], v12 offset:16384
v_mfma_f32_16x16x32_bf16 v[32:35], a[4:7], v[112:115], 0
v_mfma_f32_16x16x32_bf16 v[36:39], a[64:67], v[112:115], 0
v_mfma_f32_16x16x32_bf16 v[40:43], a[68:71], v[112:115], 0
s_waitcnt lgkmcnt(4)
v_mfma_f32_16x16x32_bf16 v[44:47], a[0:3], v[116:119], 0
ds_read_b128 v[112:115], v11 offset:1024
v_mfma_f32_16x16x32_bf16 v[48:51], a[4:7], v[116:119], 0
v_mfma_f32_16x16x32_bf16 v[52:55], a[64:67], v[116:119], 0
v_mfma_f32_16x16x32_bf16 v[56:59], a[68:71], v[116:119], 0
s_waitcnt lgkmcnt(4)
v_mfma_f32_16x16x32_bf16 v[60:63], a[0:3], v[120:123], 0
ds_read_b128 v[116:119], v11 offset:9216
v_mfma_f32_16x16x32_bf16 v[64:67], a[4:7], v[120:123], 0
v_mfma_f32_16x16x32_bf16 v[68:71], a[64:67], v[120:123], 0
v_mfma_f32_16x16x32_bf16 v[72:75], a[68:71], v[120:123], 0
s_waitcnt lgkmcnt(4)
v_mfma_f32_16x16x32_bf16 v[28:31], a[8:11], v[124:127], v[28:31]
ds_read_b128 v[120:123], v11 offset:17408
v_mfma_f32_16x16x32_bf16 v[32:35], a[12:15], v[124:127], v[32:35]
v_mfma_f32_16x16x32_bf16 v[36:39], a[72:75], v[124:127], v[36:39]
v_mfma_f32_16x16x32_bf16 v[40:43], a[76:79], v[124:127], v[40:43]
s_waitcnt lgkmcnt(4)
v_mfma_f32_16x16x32_bf16 v[44:47], a[8:11], v[128:131], v[44:47]
ds_read_b128 v[124:127], v12 offset:1024
v_mfma_f32_16x16x32_bf16 v[48:51], a[12:15], v[128:131], v[48:51]
v_mfma_f32_16x16x32_bf16 v[52:55], a[72:75], v[128:131], v[52:55]
v_mfma_f32_16x16x32_bf16 v[56:59], a[76:79], v[128:131], v[56:59]
s_waitcnt lgkmcnt(4)
v_mfma_f32_16x16x32_bf16 v[60:63], a[8:11], v[132:135], v[60:63]
ds_read_b128 v[128:131], v12 offset:9216
v_mfma_f32_16x16x32_bf16 v[64:67], a[12:15], v[132:135], v[64:67]
v_mfma_f32_16x16x32_bf16 v[68:71], a[72:75], v[132:135], v[68:71]
v_mfma_f32_16x16x32_bf16 v[72:75], a[76:79], v[132:135], v[72:75]
s_waitcnt lgkmcnt(4)
v_mfma_f32_16x16x32_bf16 v[28:31], a[16:19], v[112:115], v[28:31]
ds_read_b128 v[132:135], v12 offset:17408
v_mfma_f32_16x16x32_bf16 v[32:35], a[20:23], v[112:115], v[32:35]
v_mfma_f32_16x16x32_bf16 v[36:39], a[80:83], v[112:115], v[36:39]
v_mfma_f32_16x16x32_bf16 v[40:43], a[84:87], v[112:115], v[40:43]
s_waitcnt lgkmcnt(4)
v_mfma_f32_16x16x32_bf16 v[44:47], a[16:19], v[116:119], v[44:47]
ds_read_b128 v[112:115], v11 offset:2048
v_mfma_f32_16x16x32_bf16 v[48:51], a[20:23], v[116:119], v[48:51]
v_mfma_f32_16x16x32_bf16 v[52:55], a[80:83], v[116:119], v[52:55]
v_mfma_f32_16x16x32_bf16 v[56:59], a[84:87], v[116:119], v[56:59]
s_waitcnt lgkmcnt(4)
v_mfma_f32_16x16x32_bf16 v[60:63], a[16:19], v[120:123], v[60:63]
ds_read_b128 v[116:119], v11 offset:10240
v_mfma_f32_16x16x32_bf16 v[64:67], a[20:23], v[120:123], v[64:67]
v_mfma_f32_16x16x32_bf16 v[68:71], a[80:83], v[120:123], v[68:71]
v_mfma_f32_16x16x32_bf16 v[72:75], a[84:87], v[120:123], v[72:75]
s_waitcnt lgkmcnt(4)
v_mfma_f32_16x16x32_bf16 v[28:31], a[24:27], v[124:127], v[28:31]
ds_read_b128 v[120:123], v11 offset:18432
v_mfma_f32_16x16x32_bf16 v[32:35], a[28:31], v[124:127], v[32:35]
v_mfma_f32_16x16x32_bf16 v[36:39], a[88:91], v[124:127], v[36:39]
v_mfma_f32_16x16x32_bf16 v[40:43], a[92:95], v[124:127], v[40:43]
s_waitcnt lgkmcnt(4)
v_mfma_f32_16x16x32_bf16 v[44:47], a[24:27], v[128:131], v[44:47]
ds_read_b128 v[124:127], v12 offset:2048
v_mfma_f32_16x16x32_bf16 v[48:51], a[28:31], v[128:131], v[48:51]
v_mfma_f32_16x16x32_bf16 v[52:55], a[88:91], v[128:131], v[52:55]
v_mfma_f32_16x16x32_bf16 v[56:59], a[92:95], v[128:131], v[56:59]
s_waitcnt lgkmcnt(4)
v_mfma_f32_16x16x32_bf16 v[60:63], a[24:27], v[132:135], v[60:63]
ds_read_b128 v[128:131], v12 offset:10240
v_mfma_f32_16x16x32_bf16 v[64:67], a[28:31], v[132:135], v[64:67]
v_mfma_f32_16x16x32_bf16 v[68:71], a[88:91], v[132:135], v[68:71]
v_mfma_f32_16x16x32_bf16 v[72:75], a[92:95], v[132:135], v[72:75]
s_waitcnt lgkmcnt(4)
v_mfma_f32_16x16x32_bf16 v[28:31], a[32:35], v[112:115], v[28:31]
ds_read_b128 v[132:135], v12 offset:18432
v_mfma_f32_16x16x32_bf16 v[32:35], a[36:39], v[112:115], v[32:35]
v_mfma_f32_16x16x32_bf16 v[36:39], a[96:99], v[112:115], v[36:39]
v_mfma_f32_16x16x32_bf16 v[40:43], a[100:103], v[112:115], v[40:43]
s_waitcnt lgkmcnt(4)
v_mfma_f32_16x16x32_bf16 v[44:47], a[32:35], v[116:119], v[44:47]
ds_read_b128 v[112:115], v11 offset:3072
v_mfma_f32_16x16x32_bf16 v[48:51], a[36:39], v[116:119], v[48:51]
v_mfma_f32_16x16x32_bf16 v[52:55], a[96:99], v[116:119], v[52:55]
v_mfma_f32_16x16x32_bf16 v[56:59], a[100:103], v[116:119], v[56:59]
s_waitcnt lgkmcnt(4)
v_mfma_f32_16x16x32_bf16 v[60:63], a[32:35], v[120:123], v[60:63]
ds_read_b128 v[116:119], v11 offset:11264
v_mfma_f32_16x16x32_bf16 v[64:67], a[36:39], v[120:123], v[64:67]
v_mfma_f32_16x16x32_bf16 v[68:71], a[96:99], v[120:123], v[68:71]
v_mfma_f32_16x16x32_bf16 v[72:75], a[100:103], v[120:123], v[72:75]
s_waitcnt lgkmcnt(4)
v_mfma_f32_16x16x32_bf16 v[28:31], a[40:43], v[124:127], v[28:31]
ds_read_b128 v[120:123], v11 offset:19456
v_mfma_f32_16x16x32_bf16 v[32:35], a[44:47], v[124:127], v[32:35]
v_mfma_f32_16x16x32_bf16 v[36:39], a[104:107], v[124:127], v[36:39]
v_mfma_f32_16x16x32_bf16 v[40:43], a[108:111], v[124:127], v[40:43]
s_waitcnt lgkmcnt(4)
v_mfma_f32_16x16x32_bf16 v[44:47], a[40:43], v[128:131], v[44:47]
ds_read_b128 v[124:127], v12 offset:3072
v_mfma_f32_16x16x32_bf16 v[48:51], a[44:47], v[128:131], v[48:51]
v_mfma_f32_16x16x32_bf16 v[52:55], a[104:107], v[128:131], v[52:55]
v_mfma_f32_16x16x32_bf16 v[56:59], a[108:111], v[128:131], v[56:59]
s_waitcnt lgkmcnt(4)
v_mfma_f32_16x16x32_bf16 v[60:63], a[40:43], v[132:135], v[60:63]
ds_read_b128 v[128:131], v12 offset:11264
v_mfma_f32_16x16x32_bf16 v[64:67], a[44:47], v[132:135], v[64:67]
v_mfma_f32_16x16x32_bf16 v[68:71], a[104:107], v[132:135], v[68:71]
v_mfma_f32_16x16x32_bf16 v[72:75], a[108:111], v[132:135], v[72:75]
s_waitcnt lgkmcnt(4)
v_mfma_f32_16x16x32_bf16 v[28:31], a[48:51], v[112:115], v[28:31]
ds_read_b128 v[132:135], v12 offset:19456
v_mfma_f32_16x16x32_bf16 v[32:35], a[52:55], v[112:115], v[32:35]
v_mfma_f32_16x16x32_bf16 v[36:39], a[112:115], v[112:115], v[36:39]
v_mfma_f32_16x16x32_bf16 v[40:43], a[116:119], v[112:115], v[40:43]
s_waitcnt lgkmcnt(4)
v_mfma_f32_16x16x32_bf16 v[44:47], a[48:51], v[116:119], v[44:47]
v_mfma_f32_16x16x32_bf16 v[48:51], a[52:55], v[116:119], v[48:51]
v_mfma_f32_16x16x32_bf16 v[52:55], a[112:115], v[116:119], v[52:55]
v_mfma_f32_16x16x32_bf16 v[56:59], a[116:119], v[116:119], v[56:59]
s_waitcnt lgkmcnt(3)
v_mfma_f32_16x16x32_bf16 v[60:63], a[48:51], v[120:123], v[60:63]
v_mfma_f32_16x16x32_bf16 v[64:67], a[52:55], v[120:123], v[64:67]
v_mfma_f32_16x16x32_bf16 v[68:71], a[112:115], v[120:123], v[68:71]
v_mfma_f32_16x16x32_bf16 v[72:75], a[116:119], v[120:123], v[72:75]
s_waitcnt lgkmcnt(2)
v_mfma_f32_16x16x32_bf16 v[28:31], a[56:59], v[124:127], v[28:31]
v_mfma_f32_16x16x32_bf16 v[32:35], a[60:63], v[124:127], v[32:35]
v_mfma_f32_16x16x32_bf16 v[36:39], a[120:123], v[124:127], v[36:39]
v_mfma_f32_16x16x32_bf16 v[40:43], a[124:127], v[124:127], v[40:43]
s_waitcnt lgkmcnt(1)
v_mfma_f32_16x16x32_bf16 v[44:47], a[56:59], v[128:131], v[44:47]
v_mfma_f32_16x16x32_bf16 v[48:51], a[60:63], v[128:131], v[48:51]
v_mfma_f32_16x16x32_bf16 v[52:55], a[120:123], v[128:131], v[52:55]
v_mfma_f32_16x16x32_bf16 v[56:59], a[124:127], v[128:131], v[56:59]
ds_read_b128 v[76:79], v15 offset:0
s_waitcnt lgkmcnt(0)
v_lshlrev_b32 v106, 16, v76
v_and_b32 v107, s12, v76
v_fma_f32 v28, v28, v19, v106
v_fma_f32 v29, v29, v19, v107
v_lshlrev_b32 v108, 16, v77
v_and_b32 v109, s12, v77
v_fma_f32 v30, v30, v19, v108
v_fma_f32 v31, v31, v19, v109
v_lshlrev_b32 v110, 16, v78
v_and_b32 v111, s12, v78
v_fma_f32 v32, v32, v19, v110
v_fma_f32 v33, v33, v19, v111
v_lshlrev_b32 v104, 16, v79
v_and_b32 v105, s12, v79
v_fma_f32 v34, v34, v19, v104
v_fma_f32 v35, v35, v19, v105
ds_read_b128 v[76:79], v16 offset:0
s_waitcnt lgkmcnt(0)
v_lshlrev_b32 v106, 16, v76
v_and_b32 v107, s12, v76
v_fma_f32 v36, v36, v19, v106
v_fma_f32 v37, v37, v19, v107
v_lshlrev_b32 v108, 16, v77
v_and_b32 v109, s12, v77
v_fma_f32 v38, v38, v19, v108
v_fma_f32 v39, v39, v19, v109
v_lshlrev_b32 v110, 16, v78
v_and_b32 v111, s12, v78
v_fma_f32 v40, v40, v19, v110
v_fma_f32 v41, v41, v19, v111
v_lshlrev_b32 v104, 16, v79
v_and_b32 v105, s12, v79
v_fma_f32 v42, v42, v19, v104
v_fma_f32 v43, v43, v19, v105
v_mfma_f32_16x16x32_bf16 v[60:63], a[56:59], v[132:135], v[60:63]
v_mfma_f32_16x16x32_bf16 v[64:67], a[60:63], v[132:135], v[64:67]
v_mfma_f32_16x16x32_bf16 v[68:71], a[120:123], v[132:135], v[68:71]
v_mfma_f32_16x16x32_bf16 v[72:75], a[124:127], v[132:135], v[72:75]
ds_read_b128 v[76:79], v15 offset:2048
s_waitcnt lgkmcnt(0)
v_lshlrev_b32 v106, 16, v76
v_and_b32 v107, s12, v76
v_fma_f32 v44, v44, v20, v106
v_fma_f32 v45, v45, v20, v107
v_lshlrev_b32 v108, 16, v77
v_and_b32 v109, s12, v77
v_fma_f32 v46, v46, v20, v108
v_fma_f32 v47, v47, v20, v109
v_lshlrev_b32 v110, 16, v78
v_and_b32 v111, s12, v78
v_fma_f32 v48, v48, v20, v110
v_fma_f32 v49, v49, v20, v111
v_lshlrev_b32 v104, 16, v79
v_and_b32 v105, s12, v79
v_fma_f32 v50, v50, v20, v104
v_fma_f32 v51, v51, v20, v105
ds_read_b128 v[76:79], v16 offset:2048
s_waitcnt lgkmcnt(0)
v_lshlrev_b32 v106, 16, v76
v_and_b32 v107, s12, v76
v_fma_f32 v52, v52, v20, v106
v_fma_f32 v53, v53, v20, v107
v_lshlrev_b32 v108, 16, v77
v_and_b32 v109, s12, v77
v_fma_f32 v54, v54, v20, v108
v_fma_f32 v55, v55, v20, v109
v_lshlrev_b32 v110, 16, v78
v_and_b32 v111, s12, v78
v_fma_f32 v56, v56, v20, v110
v_fma_f32 v57, v57, v20, v111
v_lshlrev_b32 v104, 16, v79
v_and_b32 v105, s12, v79
v_fma_f32 v58, v58, v20, v104
v_fma_f32 v59, v59, v20, v105
s_waitcnt vmcnt(11)
s_add_u32 s35, s52, 0x1200000
buffer_load_dwordx4 v[184:187], v10, s[20:23], s35 offen offset:1024 sc1
ds_read_b128 v[76:79], v244 offset:0
s_waitcnt lgkmcnt(0)
v_lshlrev_b32 v106, 16, v76
v_and_b32 v107, s12, v76
v_fma_f32 v60, v60, v21, v106
v_fma_f32 v61, v61, v21, v107
v_lshlrev_b32 v108, 16, v77
v_and_b32 v109, s12, v77
v_fma_f32 v62, v62, v21, v108
v_fma_f32 v63, v63, v21, v109
v_lshlrev_b32 v110, 16, v78
v_and_b32 v111, s12, v78
v_fma_f32 v64, v64, v21, v110
v_fma_f32 v65, v65, v21, v111
v_lshlrev_b32 v104, 16, v79
v_and_b32 v105, s12, v79
v_fma_f32 v66, v66, v21, v104
v_fma_f32 v67, v67, v21, v105
ds_read_b128 v[76:79], v245 offset:0
s_waitcnt lgkmcnt(0)
v_lshlrev_b32 v106, 16, v76
v_and_b32 v107, s12, v76
v_fma_f32 v68, v68, v21, v106
v_fma_f32 v69, v69, v21, v107
v_lshlrev_b32 v108, 16, v77
v_and_b32 v109, s12, v77
v_fma_f32 v70, v70, v21, v108
v_fma_f32 v71, v71, v21, v109
v_lshlrev_b32 v110, 16, v78
v_and_b32 v111, s12, v78
v_fma_f32 v72, v72, v21, v110
v_fma_f32 v73, v73, v21, v111
v_lshlrev_b32 v104, 16, v79
v_and_b32 v105, s12, v79
v_fma_f32 v74, v74, v21, v104
v_fma_f32 v75, v75, v21, v105
s_waitcnt vmcnt(11)
s_add_u32 s39, s52, 0x1800000
buffer_load_dwordx4 v[188:191], v10, s[20:23], s39 offen offset:1024 sc1
s_waitcnt vmcnt(11)
s_add_u32 s32, s52, 0x1e00000
buffer_load_dwordx4 v[192:195], v10, s[20:23], s32 offen offset:1024 sc1
v_max3_f32 v1, v136, v138, v140
v_max3_f32 v97, v142, v144, v146
v_max_f32 v1, v1, v97
v_sub_f32 v136, v136, v1
v_sub_f32 v138, v138, v1
v_sub_f32 v140, v140, v1
v_sub_f32 v142, v142, v1
v_sub_f32 v144, v144, v1
v_sub_f32 v146, v146, v1
v_exp_f32 v136, v136
v_exp_f32 v138, v138
v_exp_f32 v140, v140
v_exp_f32 v142, v142
v_exp_f32 v144, v144
v_exp_f32 v146, v146
s_nop 0
v_mul_f32 v1, v136, v137
v_fmac_f32 v1, v138, v139
v_fmac_f32 v1, v140, v141
v_fmac_f32 v1, v142, v143
v_fmac_f32 v1, v144, v145
v_fmac_f32 v1, v146, v147
v_rcp_f32 v1, v1
s_nop 0
v_mul_f32 v88, v136, v1
v_mul_f32 v89, v138, v1
v_mul_f32 v90, v140, v1
v_mul_f32 v92, v142, v1
v_mul_f32 v93, v144, v1
v_mul_f32 v94, v146, v1
ds_write_b128 v13, v[88:91]
ds_write_b128 v13, v[92:95] offset:16
ds_read_b128 v[80:83], v14 offset:0
ds_read_b128 v[84:87], v14 offset:16
s_waitcnt vmcnt(11)
s_add_u32 s33, s53, 0x0
buffer_load_dwordx4 v[196:199], v10, s[20:23], s33 offen offset:0 sc1
s_waitcnt lgkmcnt(0)
v_lshlrev_b32 v98, 16, v148
v_and_b32 v99, s12, v148
v_mul_f32 v88, v98, v80
v_mul_f32 v89, v99, v80
v_lshlrev_b32 v100, 16, v149
v_and_b32 v101, s12, v149
v_mul_f32 v90, v100, v80
v_mul_f32 v91, v101, v80
v_lshlrev_b32 v102, 16, v150
v_and_b32 v103, s12, v150
v_mul_f32 v92, v102, v80
v_mul_f32 v93, v103, v80
v_lshlrev_b32 v96, 16, v151
v_and_b32 v97, s12, v151
v_mul_f32 v94, v96, v80
v_mul_f32 v95, v97, v80
s_waitcnt vmcnt(11)
s_xor_b32 s35, s13, 0x22000
buffer_load_dwordx4 a[160:163], v252, s[56:59], s35 offen offset:0
v_lshlrev_b32 v98, 16, v152
v_and_b32 v99, s12, v152
v_fmac_f32 v88, v98, v81
v_fmac_f32 v89, v99, v81
v_lshlrev_b32 v100, 16, v153
v_and_b32 v101, s12, v153
v_fmac_f32 v90, v100, v81
v_fmac_f32 v91, v101, v81
v_lshlrev_b32 v102, 16, v154
v_and_b32 v103, s12, v154
v_fmac_f32 v92, v102, v81
v_fmac_f32 v93, v103, v81
v_lshlrev_b32 v96, 16, v155
v_and_b32 v97, s12, v155
v_fmac_f32 v94, v96, v81
v_fmac_f32 v95, v97, v81
s_waitcnt vmcnt(11)
buffer_load_dwordx4 a[164:167], v252, s[56:59], s35 offen offset:1024
v_lshlrev_b32 v98, 16, v156
v_and_b32 v99, s12, v156
v_fmac_f32 v88, v98, v82
v_fmac_f32 v89, v99, v82
v_lshlrev_b32 v100, 16, v157
v_and_b32 v101, s12, v157
v_fmac_f32 v90, v100, v82
v_fmac_f32 v91, v101, v82
v_lshlrev_b32 v102, 16, v158
v_and_b32 v103, s12, v158
v_fmac_f32 v92, v102, v82
v_fmac_f32 v93, v103, v82
v_lshlrev_b32 v96, 16, v159
v_and_b32 v97, s12, v159
v_fmac_f32 v94, v96, v82
v_fmac_f32 v95, v97, v82
s_waitcnt vmcnt(11)
s_add_u32 s39, s53, 0x600000
buffer_load_dwordx4 v[200:203], v10, s[20:23], s39 offen offset:0 sc1
v_lshlrev_b32 v98, 16, v160
v_and_b32 v99, s12, v160
v_fmac_f32 v88, v98, v84
v_fmac_f32 v89, v99, v84
v_lshlrev_b32 v100, 16, v161
v_and_b32 v101, s12, v161
v_fmac_f32 v90, v100, v84
v_fmac_f32 v91, v101, v84
v_lshlrev_b32 v102, 16, v162
v_and_b32 v103, s12, v162
v_fmac_f32 v92, v102, v84
v_fmac_f32 v93, v103, v84
v_lshlrev_b32 v96, 16, v163
v_and_b32 v97, s12, v163
v_fmac_f32 v94, v96, v84
v_fmac_f32 v95, v97, v84
s_waitcnt vmcnt(11)
s_xor_b32 s32, s13, 0x26000
buffer_load_dwordx4 a[224:227], v252, s[56:59], s32 offen offset:0
v_lshlrev_b32 v98, 16, v164
v_and_b32 v99, s12, v164
v_fmac_f32 v88, v98, v85
v_fmac_f32 v89, v99, v85
v_lshlrev_b32 v100, 16, v165
v_and_b32 v101, s12, v165
v_fmac_f32 v90, v100, v85
v_fmac_f32 v91, v101, v85
v_lshlrev_b32 v102, 16, v166
v_and_b32 v103, s12, v166
v_fmac_f32 v92, v102, v85
v_fmac_f32 v93, v103, v85
v_lshlrev_b32 v96, 16, v167
v_and_b32 v97, s12, v167
v_fmac_f32 v94, v96, v85
v_fmac_f32 v95, v97, v85
s_waitcnt vmcnt(11)
buffer_load_dwordx4 a[228:231], v252, s[56:59], s32 offen offset:1024
v_lshlrev_b32 v98, 16, v168
v_and_b32 v99, s12, v168
v_fmac_f32 v88, v98, v86
v_fmac_f32 v89, v99, v86
v_lshlrev_b32 v100, 16, v169
v_and_b32 v101, s12, v169
v_fmac_f32 v90, v100, v86
v_fmac_f32 v91, v101, v86
v_lshlrev_b32 v102, 16, v170
v_and_b32 v103, s12, v170
v_fmac_f32 v92, v102, v86
v_fmac_f32 v93, v103, v86
v_lshlrev_b32 v96, 16, v171
v_and_b32 v97, s12, v171
v_fmac_f32 v94, v96, v86
v_fmac_f32 v95, v97, v86
v_cvt_pk_bf16_f32 v96, v88, v89
v_cvt_pk_bf16_f32 v97, v90, v91
v_cvt_pk_bf16_f32 v98, v92, v93
v_cvt_pk_bf16_f32 v99, v94, v95
ds_write_b128 v18, v[96:99] offset:0
s_waitcnt vmcnt(11)
s_add_u32 s33, s53, 0xc00000
buffer_load_dwordx4 v[204:207], v10, s[20:23], s33 offen offset:0 sc1
v_lshlrev_b32 v98, 16, v172
v_and_b32 v99, s12, v172
v_mul_f32 v88, v98, v80
v_mul_f32 v89, v99, v80
v_lshlrev_b32 v100, 16, v173
v_and_b32 v101, s12, v173
v_mul_f32 v90, v100, v80
v_mul_f32 v91, v101, v80
v_lshlrev_b32 v102, 16, v174
v_and_b32 v103, s12, v174
v_mul_f32 v92, v102, v80
v_mul_f32 v93, v103, v80
v_lshlrev_b32 v96, 16, v175
v_and_b32 v97, s12, v175
v_mul_f32 v94, v96, v80
v_mul_f32 v95, v97, v80
s_waitcnt vmcnt(11)
s_xor_b32 s35, s13, 0x22800
buffer_load_dwordx4 a[168:171], v252, s[56:59], s35 offen offset:0
v_lshlrev_b32 v98, 16, v176
v_and_b32 v99, s12, v176
v_fmac_f32 v88, v98, v81
v_fmac_f32 v89, v99, v81
v_lshlrev_b32 v100, 16, v177
v_and_b32 v101, s12, v177
v_fmac_f32 v90, v100, v81
v_fmac_f32 v91, v101, v81
v_lshlrev_b32 v102, 16, v178
v_and_b32 v103, s12, v178
v_fmac_f32 v92, v102, v81
v_fmac_f32 v93, v103, v81
v_lshlrev_b32 v96, 16, v179
v_and_b32 v97, s12, v179
v_fmac_f32 v94, v96, v81
v_fmac_f32 v95, v97, v81
s_waitcnt vmcnt(11)
buffer_load_dwordx4 a[172:175], v252, s[56:59], s35 offen offset:1024
v_lshlrev_b32 v98, 16, v180
v_and_b32 v99, s12, v180
v_fmac_f32 v88, v98, v82
v_fmac_f32 v89, v99, v82
v_lshlrev_b32 v100, 16, v181
v_and_b32 v101, s12, v181
v_fmac_f32 v90, v100, v82
v_fmac_f32 v91, v101, v82
v_lshlrev_b32 v102, 16, v182
v_and_b32 v103, s12, v182
v_fmac_f32 v92, v102, v82
v_fmac_f32 v93, v103, v82
v_lshlrev_b32 v96, 16, v183
v_and_b32 v97, s12, v183
v_fmac_f32 v94, v96, v82
v_fmac_f32 v95, v97, v82
s_waitcnt vmcnt(11)
s_add_u32 s39, s53, 0x1200000
buffer_load_dwordx4 v[208:211], v10, s[20:23], s39 offen offset:0 sc1
v_lshlrev_b32 v98, 16, v184
v_and_b32 v99, s12, v184
v_fmac_f32 v88, v98, v84
v_fmac_f32 v89, v99, v84
v_lshlrev_b32 v100, 16, v185
v_and_b32 v101, s12, v185
v_fmac_f32 v90, v100, v84
v_fmac_f32 v91, v101, v84
v_lshlrev_b32 v102, 16, v186
v_and_b32 v103, s12, v186
v_fmac_f32 v92, v102, v84
v_fmac_f32 v93, v103, v84
v_lshlrev_b32 v96, 16, v187
v_and_b32 v97, s12, v187
v_fmac_f32 v94, v96, v84
v_fmac_f32 v95, v97, v84
s_waitcnt vmcnt(11)
s_xor_b32 s32, s13, 0x26800
buffer_load_dwordx4 a[232:235], v252, s[56:59], s32 offen offset:0
v_lshlrev_b32 v98, 16, v188
v_and_b32 v99, s12, v188
v_fmac_f32 v88, v98, v85
v_fmac_f32 v89, v99, v85
v_lshlrev_b32 v100, 16, v189
v_and_b32 v101, s12, v189
v_fmac_f32 v90, v100, v85
v_fmac_f32 v91, v101, v85
v_lshlrev_b32 v102, 16, v190
v_and_b32 v103, s12, v190
v_fmac_f32 v92, v102, v85
v_fmac_f32 v93, v103, v85
v_lshlrev_b32 v96, 16, v191
v_and_b32 v97, s12, v191
v_fmac_f32 v94, v96, v85
v_fmac_f32 v95, v97, v85
s_waitcnt vmcnt(11)
buffer_load_dwordx4 a[236:239], v252, s[56:59], s32 offen offset:1024
v_lshlrev_b32 v98, 16, v192
v_and_b32 v99, s12, v192
v_fmac_f32 v88, v98, v86
v_fmac_f32 v89, v99, v86
v_lshlrev_b32 v100, 16, v193
v_and_b32 v101, s12, v193
v_fmac_f32 v90, v100, v86
v_fmac_f32 v91, v101, v86
v_lshlrev_b32 v102, 16, v194
v_and_b32 v103, s12, v194
v_fmac_f32 v92, v102, v86
v_fmac_f32 v93, v103, v86
v_lshlrev_b32 v96, 16, v195
v_and_b32 v97, s12, v195
v_fmac_f32 v94, v96, v86
v_fmac_f32 v95, v97, v86
ds_read_b128 v[80:83], v14 offset:512
ds_read_b128 v[84:87], v14 offset:528
v_cvt_pk_bf16_f32 v96, v88, v89
v_cvt_pk_bf16_f32 v97, v90, v91
v_cvt_pk_bf16_f32 v98, v92, v93
v_cvt_pk_bf16_f32 v99, v94, v95
ds_write_b128 v26, v[96:99] offset:0
s_waitcnt lgkmcnt(0)
s_barrier
ds_read_b128 v[112:115], v252 offset:32768
ds_read_b128 v[116:119], v252 offset:33792
ds_read_b128 v[120:123], v252 offset:34816
ds_read_b128 v[124:127], v252 offset:35840
ds_read_b128 v[128:131], v252 offset:36864
s_waitcnt lgkmcnt(4)
v_mfma_f32_16x16x32_bf16 v[28:31], a[128:131], v[112:115], v[28:31]
ds_read_b128 v[132:135], v252 offset:37888
v_mfma_f32_16x16x32_bf16 v[32:35], a[132:135], v[112:115], v[32:35]
v_mfma_f32_16x16x32_bf16 v[36:39], a[192:195], v[112:115], v[36:39]
v_mfma_f32_16x16x32_bf16 v[40:43], a[196:199], v[112:115], v[40:43]
s_waitcnt vmcnt(11)
s_add_u32 s33, s53, 0x1800000
buffer_load_dwordx4 v[212:215], v10, s[20:23], s33 offen offset:0 sc1
s_waitcnt lgkmcnt(4)
v_mfma_f32_16x16x32_bf16 v[28:31], a[136:139], v[116:119], v[28:31]
ds_read_b128 v[112:115], v252 offset:38912
v_lshlrev_b32 v98, 16, v196
v_and_b32 v99, s12, v196
v_mul_f32 v88, v98, v80
v_mfma_f32_16x16x32_bf16 v[32:35], a[140:143], v[116:119], v[32:35]
v_mul_f32 v89, v99, v80
v_lshlrev_b32 v100, 16, v197
v_and_b32 v101, s12, v197
v_mfma_f32_16x16x32_bf16 v[36:39], a[200:203], v[116:119], v[36:39]
v_mul_f32 v90, v100, v80
v_mul_f32 v91, v101, v80
v_lshlrev_b32 v102, 16, v198
v_mfma_f32_16x16x32_bf16 v[40:43], a[204:207], v[116:119], v[40:43]
v_and_b32 v103, s12, v198
v_mul_f32 v92, v102, v80
v_mul_f32 v93, v103, v80
v_lshlrev_b32 v96, 16, v199
v_and_b32 v97, s12, v199
v_mul_f32 v94, v96, v80
v_mul_f32 v95, v97, v80
s_waitcnt vmcnt(11)
s_xor_b32 s35, s13, 0x23000
buffer_load_dwordx4 a[176:179], v252, s[56:59], s35 offen offset:0
s_waitcnt lgkmcnt(4)
v_mfma_f32_16x16x32_bf16 v[28:31], a[144:147], v[120:123], v[28:31]
ds_read_b128 v[116:119], v252 offset:39936
v_mfma_f32_16x16x32_bf16 v[32:35], a[148:151], v[120:123], v[32:35]
v_mfma_f32_16x16x32_bf16 v[36:39], a[208:211], v[120:123], v[36:39]
v_mfma_f32_16x16x32_bf16 v[40:43], a[212:215], v[120:123], v[40:43]
s_waitcnt vmcnt(11)
buffer_load_dwordx4 a[180:183], v252, s[56:59], s35 offen offset:1024
s_waitcnt lgkmcnt(4)
v_mfma_f32_16x16x32_bf16 v[28:31], a[152:155], v[124:127], v[28:31]
v_mfma_f32_16x16x32_bf16 v[32:35], a[156:159], v[124:127], v[32:35]
v_mfma_f32_16x16x32_bf16 v[36:39], a[216:219], v[124:127], v[36:39]
v_mfma_f32_16x16x32_bf16 v[40:43], a[220:223], v[124:127], v[40:43]
s_waitcnt vmcnt(11)
s_add_u32 s39, s53, 0x1e00000
buffer_load_dwordx4 v[216:219], v10, s[20:23], s39 offen offset:0 sc1
v_lshlrev_b32 v98, 16, v200
v_and_b32 v99, s12, v200
v_fmac_f32 v88, v98, v81
v_fmac_f32 v89, v99, v81
v_lshlrev_b32 v100, 16, v201
v_and_b32 v101, s12, v201
v_fmac_f32 v90, v100, v81
v_fmac_f32 v91, v101, v81
v_lshlrev_b32 v102, 16, v202
v_and_b32 v103, s12, v202
v_fmac_f32 v92, v102, v81
v_fmac_f32 v93, v103, v81
v_lshlrev_b32 v96, 16, v203
v_and_b32 v97, s12, v203
v_fmac_f32 v94, v96, v81
v_fmac_f32 v95, v97, v81
s_waitcnt vmcnt(11)
s_xor_b32 s32, s13, 0x27000
buffer_load_dwordx4 a[240:243], v252, s[56:59], s32 offen offset:0
s_waitcnt vmcnt(11)
buffer_load_dwordx4 a[244:247], v252, s[56:59], s32 offen offset:1024
s_waitcnt lgkmcnt(3)
v_mfma_f32_16x16x32_bf16 v[28:31], a[160:163], v[128:131], v[28:31]
v_mfma_f32_16x16x32_bf16 v[32:35], a[164:167], v[128:131], v[32:35]
v_mfma_f32_16x16x32_bf16 v[36:39], a[224:227], v[128:131], v[36:39]
v_mfma_f32_16x16x32_bf16 v[40:43], a[228:231], v[128:131], v[40:43]
s_waitcnt vmcnt(11)
s_add_u32 s33, s53, 0x0
buffer_load_dwordx4 v[220:223], v10, s[20:23], s33 offen offset:1024 sc1
v_lshlrev_b32 v98, 16, v204
v_and_b32 v99, s12, v204
v_fmac_f32 v88, v98, v82
v_fmac_f32 v89, v99, v82
v_lshlrev_b32 v100, 16, v205
v_and_b32 v101, s12, v205
v_fmac_f32 v90, v100, v82
v_fmac_f32 v91, v101, v82
v_lshlrev_b32 v102, 16, v206
v_and_b32 v103, s12, v206
v_fmac_f32 v92, v102, v82
v_fmac_f32 v93, v103, v82
v_lshlrev_b32 v96, 16, v207
v_and_b32 v97, s12, v207
v_fmac_f32 v94, v96, v82
v_fmac_f32 v95, v97, v82
s_waitcnt vmcnt(11)
s_xor_b32 s35, s13, 0x23800
buffer_load_dwordx4 a[184:187], v252, s[56:59], s35 offen offset:0
s_waitcnt vmcnt(11)
buffer_load_dwordx4 a[188:191], v252, s[56:59], s35 offen offset:1024
s_waitcnt vmcnt(11)
s_add_u32 s39, s53, 0x600000
buffer_load_dwordx4 v[224:227], v10, s[20:23], s39 offen offset:1024 sc1
v_lshlrev_b32 v98, 16, v208
v_and_b32 v99, s12, v208
v_fmac_f32 v88, v98, v84
v_fmac_f32 v89, v99, v84
v_lshlrev_b32 v100, 16, v209
v_and_b32 v101, s12, v209
v_fmac_f32 v90, v100, v84
v_fmac_f32 v91, v101, v84
v_lshlrev_b32 v102, 16, v210
v_and_b32 v103, s12, v210
v_fmac_f32 v92, v102, v84
v_fmac_f32 v93, v103, v84
v_lshlrev_b32 v96, 16, v211
v_and_b32 v97, s12, v211
v_fmac_f32 v94, v96, v84
v_fmac_f32 v95, v97, v84
s_waitcnt vmcnt(11)
s_xor_b32 s32, s13, 0x27800
buffer_load_dwordx4 a[248:251], v252, s[56:59], s32 offen offset:0
s_waitcnt vmcnt(11)
buffer_load_dwordx4 a[252:255], v252, s[56:59], s32 offen offset:1024
s_waitcnt lgkmcnt(2)
v_mfma_f32_16x16x32_bf16 v[28:31], a[168:171], v[132:135], v[28:31]
v_mfma_f32_16x16x32_bf16 v[32:35], a[172:175], v[132:135], v[32:35]
v_mfma_f32_16x16x32_bf16 v[36:39], a[232:235], v[132:135], v[36:39]
v_mfma_f32_16x16x32_bf16 v[40:43], a[236:239], v[132:135], v[40:43]
s_waitcnt vmcnt(11)
s_add_u32 s33, s53, 0xc00000
buffer_load_dwordx4 v[228:231], v10, s[20:23], s33 offen offset:1024 sc1
v_lshlrev_b32 v98, 16, v212
v_and_b32 v99, s12, v212
v_fmac_f32 v88, v98, v85
v_fmac_f32 v89, v99, v85
v_lshlrev_b32 v100, 16, v213
v_and_b32 v101, s12, v213
v_fmac_f32 v90, v100, v85
v_fmac_f32 v91, v101, v85
v_lshlrev_b32 v102, 16, v214
v_and_b32 v103, s12, v214
v_fmac_f32 v92, v102, v85
v_fmac_f32 v93, v103, v85
v_lshlrev_b32 v96, 16, v215
v_and_b32 v97, s12, v215
v_fmac_f32 v94, v96, v85
v_fmac_f32 v95, v97, v85
s_waitcnt vmcnt(11)
s_add_u32 s35, s53, 0x1200000
buffer_load_dwordx4 v[232:235], v10, s[20:23], s35 offen offset:1024 sc1
s_waitcnt vmcnt(11)
s_add_u32 s39, s53, 0x1800000
buffer_load_dwordx4 v[236:239], v10, s[20:23], s39 offen offset:1024 sc1
s_waitcnt vmcnt(11)
s_add_u32 s32, s53, 0x1e00000
buffer_load_dwordx4 v[240:243], v10, s[20:23], s32 offen offset:1024 sc1
v_lshlrev_b32 v98, 16, v216
v_and_b32 v99, s12, v216
v_fmac_f32 v88, v98, v86
v_fmac_f32 v89, v99, v86
v_lshlrev_b32 v100, 16, v217
v_and_b32 v101, s12, v217
v_fmac_f32 v90, v100, v86
v_fmac_f32 v91, v101, v86
v_lshlrev_b32 v102, 16, v218
v_and_b32 v103, s12, v218
v_fmac_f32 v92, v102, v86
v_fmac_f32 v93, v103, v86
v_lshlrev_b32 v96, 16, v219
v_and_b32 v97, s12, v219
v_fmac_f32 v94, v96, v86
v_fmac_f32 v95, v97, v86
v_cvt_pk_bf16_f32 v96, v88, v89
v_cvt_pk_bf16_f32 v97, v90, v91
v_cvt_pk_bf16_f32 v98, v92, v93
v_cvt_pk_bf16_f32 v99, v94, v95
ds_write_b128 v18, v[96:99] offset:8192
s_waitcnt vmcnt(11)
s_add_u32 s33, s54, 0x0
buffer_load_dwordx4 v[136:139], v10, s[20:23], s33 offen offset:0 sc1
s_waitcnt vmcnt(11)
s_add_u32 s35, s54, 0x600000
buffer_load_dwordx4 v[140:143], v10, s[20:23], s35 offen offset:0 sc1
s_waitcnt lgkmcnt(2)
v_mfma_f32_16x16x32_bf16 v[28:31], a[176:179], v[112:115], v[28:31]
v_mfma_f32_16x16x32_bf16 v[32:35], a[180:183], v[112:115], v[32:35]
v_mfma_f32_16x16x32_bf16 v[36:39], a[240:243], v[112:115], v[36:39]
v_mfma_f32_16x16x32_bf16 v[40:43], a[244:247], v[112:115], v[40:43]
s_waitcnt vmcnt(11)
s_add_u32 s39, s54, 0xc00000
buffer_load_dwordx4 v[144:147], v10, s[20:23], s39 offen offset:0 sc1
v_lshlrev_b32 v98, 16, v220
v_and_b32 v99, s12, v220
v_mul_f32 v88, v98, v80
v_mul_f32 v89, v99, v80
v_lshlrev_b32 v100, 16, v221
v_and_b32 v101, s12, v221
v_mul_f32 v90, v100, v80
v_mul_f32 v91, v101, v80
v_lshlrev_b32 v102, 16, v222
v_and_b32 v103, s12, v222
v_mul_f32 v92, v102, v80
v_mul_f32 v93, v103, v80
v_lshlrev_b32 v96, 16, v223
v_and_b32 v97, s12, v223
v_mul_f32 v94, v96, v80
v_mul_f32 v95, v97, v80
s_waitcnt vmcnt(11)
s_add_u32 s32, s54, 0x1200000
buffer_load_dwordx4 v[148:151], v10, s[20:23], s32 offen offset:0 sc1
s_waitcnt vmcnt(11)
s_add_u32 s33, s54, 0x1800000
buffer_load_dwordx4 v[152:155], v10, s[20:23], s33 offen offset:0 sc1
s_waitcnt vmcnt(11)
s_add_u32 s35, s54, 0x1e00000
buffer_load_dwordx4 v[156:159], v10, s[20:23], s35 offen offset:0 sc1
v_lshlrev_b32 v98, 16, v224
v_and_b32 v99, s12, v224
v_fmac_f32 v88, v98, v81
v_fmac_f32 v89, v99, v81
v_lshlrev_b32 v100, 16, v225
v_and_b32 v101, s12, v225
v_fmac_f32 v90, v100, v81
v_fmac_f32 v91, v101, v81
v_lshlrev_b32 v102, 16, v226
v_and_b32 v103, s12, v226
v_fmac_f32 v92, v102, v81
v_fmac_f32 v93, v103, v81
v_lshlrev_b32 v96, 16, v227
v_and_b32 v97, s12, v227
v_fmac_f32 v94, v96, v81
v_fmac_f32 v95, v97, v81
s_waitcnt vmcnt(11)
s_add_u32 s39, s54, 0x0
buffer_load_dwordx4 v[160:163], v10, s[20:23], s39 offen offset:1024 sc1
s_waitcnt vmcnt(11)
s_add_u32 s32, s54, 0x600000
buffer_load_dwordx4 v[164:167], v10, s[20:23], s32 offen offset:1024 sc1
s_waitcnt lgkmcnt(1)
v_mfma_f32_16x16x32_bf16 v[28:31], a[184:187], v[116:119], v[28:31]
v_mfma_f32_16x16x32_bf16 v[32:35], a[188:191], v[116:119], v[32:35]
v_mfma_f32_16x16x32_bf16 v[36:39], a[248:251], v[116:119], v[36:39]
v_mfma_f32_16x16x32_bf16 v[40:43], a[252:255], v[116:119], v[40:43]
s_waitcnt vmcnt(11)
s_add_u32 s33, s54, 0xc00000
buffer_load_dwordx4 v[168:171], v10, s[20:23], s33 offen offset:1024 sc1
s_nop 1
v_cvt_pk_bf16_f32 v28, v28, v29
v_cvt_pk_bf16_f32 v29, v30, v31
v_cvt_pk_bf16_f32 v30, v32, v33
v_cvt_pk_bf16_f32 v31, v34, v35
ds_write_b128 v15, v[28:31] offset:0
v_cvt_pk_bf16_f32 v36, v36, v37
v_cvt_pk_bf16_f32 v37, v38, v39
v_cvt_pk_bf16_f32 v38, v40, v41
v_cvt_pk_bf16_f32 v39, v42, v43
ds_write_b128 v16, v[36:39] offset:0
ds_read_b128 v[32:35], v17 offset:0
ds_read_b128 v[40:43], v17 offset:1024
v_lshlrev_b32 v98, 16, v228
v_and_b32 v99, s12, v228
v_fmac_f32 v88, v98, v82
v_fmac_f32 v89, v99, v82
v_lshlrev_b32 v100, 16, v229
v_and_b32 v101, s12, v229
v_fmac_f32 v90, v100, v82
v_fmac_f32 v91, v101, v82
v_lshlrev_b32 v102, 16, v230
v_and_b32 v103, s12, v230
v_fmac_f32 v92, v102, v82
v_fmac_f32 v93, v103, v82
v_lshlrev_b32 v96, 16, v231
v_and_b32 v97, s12, v231
v_fmac_f32 v94, v96, v82
v_fmac_f32 v95, v97, v82
s_waitcnt vmcnt(11)
s_add_u32 s35, s54, 0x1200000
buffer_load_dwordx4 v[172:175], v10, s[20:23], s35 offen offset:1024 sc1
v_lshlrev_b32 v98, 16, v232
v_and_b32 v99, s12, v232
v_fmac_f32 v88, v98, v84
v_fmac_f32 v89, v99, v84
v_lshlrev_b32 v100, 16, v233
v_and_b32 v101, s12, v233
v_fmac_f32 v90, v100, v84
v_fmac_f32 v91, v101, v84
v_lshlrev_b32 v102, 16, v234
v_and_b32 v103, s12, v234
v_fmac_f32 v92, v102, v84
v_fmac_f32 v93, v103, v84
v_lshlrev_b32 v96, 16, v235
v_and_b32 v97, s12, v235
v_fmac_f32 v94, v96, v84
v_fmac_f32 v95, v97, v84
s_waitcnt vmcnt(11)
s_add_u32 s39, s54, 0x1800000
buffer_load_dwordx4 v[176:179], v10, s[20:23], s39 offen offset:1024 sc1
v_lshlrev_b32 v98, 16, v236
v_and_b32 v99, s12, v236
v_fmac_f32 v88, v98, v85
v_fmac_f32 v89, v99, v85
v_lshlrev_b32 v100, 16, v237
v_and_b32 v101, s12, v237
v_fmac_f32 v90, v100, v85
v_fmac_f32 v91, v101, v85
v_lshlrev_b32 v102, 16, v238
v_and_b32 v103, s12, v238
v_fmac_f32 v92, v102, v85
v_fmac_f32 v93, v103, v85
v_lshlrev_b32 v96, 16, v239
v_and_b32 v97, s12, v239
v_fmac_f32 v94, v96, v85
v_fmac_f32 v95, v97, v85
s_waitcnt vmcnt(11)
s_add_u32 s32, s54, 0x1e00000
buffer_load_dwordx4 v[180:183], v10, s[20:23], s32 offen offset:1024 sc1
v_lshlrev_b32 v98, 16, v240
v_and_b32 v99, s12, v240
v_fmac_f32 v88, v98, v86
v_fmac_f32 v89, v99, v86
v_lshlrev_b32 v100, 16, v241
v_and_b32 v101, s12, v241
v_fmac_f32 v90, v100, v86
v_fmac_f32 v91, v101, v86
v_lshlrev_b32 v102, 16, v242
v_and_b32 v103, s12, v242
v_fmac_f32 v92, v102, v86
v_fmac_f32 v93, v103, v86
v_lshlrev_b32 v96, 16, v243
v_and_b32 v97, s12, v243
v_fmac_f32 v94, v96, v86
v_fmac_f32 v95, v97, v86
ds_read_b128 v[80:83], v14 offset:1024
ds_read_b128 v[84:87], v14 offset:1040
v_cvt_pk_bf16_f32 v96, v88, v89
v_cvt_pk_bf16_f32 v97, v90, v91
v_cvt_pk_bf16_f32 v98, v92, v93
v_cvt_pk_bf16_f32 v99, v94, v95
ds_write_b128 v26, v[96:99] offset:8192
s_waitcnt lgkmcnt(0)
s_barrier
ds_read_b128 v[120:123], v252 offset:40960
ds_read_b128 v[124:127], v252 offset:41984
ds_read_b128 v[128:131], v252 offset:43008
ds_read_b128 v[132:135], v252 offset:44032
ds_read_b128 v[112:115], v252 offset:45056
s_waitcnt lgkmcnt(4)
v_mfma_f32_16x16x32_bf16 v[44:47], a[128:131], v[120:123], v[44:47]
ds_read_b128 v[116:119], v252 offset:46080
v_mfma_f32_16x16x32_bf16 v[48:51], a[132:135], v[120:123], v[48:51]
v_mfma_f32_16x16x32_bf16 v[52:55], a[192:195], v[120:123], v[52:55]
v_mfma_f32_16x16x32_bf16 v[56:59], a[196:199], v[120:123], v[56:59]
s_waitcnt vmcnt(11)
s_add_u32 s33, s52, 0
buffer_store_dwordx4 v[32:35], v9, s[40:43], s33 offen sc1
s_add_u32 s35, s52, 4096
buffer_store_dwordx4 v[40:43], v9, s[40:43], s35 offen sc1
s_waitcnt lgkmcnt(4)
v_mfma_f32_16x16x32_bf16 v[44:47], a[136:139], v[124:127], v[44:47]
ds_read_b128 v[120:123], v252 offset:47104
v_lshlrev_b32 v98, 16, v136
v_and_b32 v99, s12, v136
v_mul_f32 v88, v98, v80
v_mfma_f32_16x16x32_bf16 v[48:51], a[140:143], v[124:127], v[48:51]
v_mul_f32 v89, v99, v80
v_lshlrev_b32 v100, 16, v137
v_and_b32 v101, s12, v137
v_mfma_f32_16x16x32_bf16 v[52:55], a[200:203], v[124:127], v[52:55]
v_mul_f32 v90, v100, v80
v_mul_f32 v91, v101, v80
v_lshlrev_b32 v102, 16, v138
v_mfma_f32_16x16x32_bf16 v[56:59], a[204:207], v[124:127], v[56:59]
v_and_b32 v103, s12, v138
v_mul_f32 v92, v102, v80
v_mul_f32 v93, v103, v80
v_lshlrev_b32 v96, 16, v139
v_and_b32 v97, s12, v139
v_mul_f32 v94, v96, v80
v_mul_f32 v95, v97, v80
s_waitcnt vmcnt(12)
s_waitcnt lgkmcnt(4)
v_mfma_f32_16x16x32_bf16 v[44:47], a[144:147], v[128:131], v[44:47]
ds_read_b128 v[124:127], v252 offset:48128
v_lshlrev_b32 v98, 16, v140
v_and_b32 v99, s12, v140
v_fmac_f32 v88, v98, v81
v_mfma_f32_16x16x32_bf16 v[48:51], a[148:151], v[128:131], v[48:51]
v_fmac_f32 v89, v99, v81
v_lshlrev_b32 v100, 16, v141
v_and_b32 v101, s12, v141
v_mfma_f32_16x16x32_bf16 v[52:55], a[208:211], v[128:131], v[52:55]
v_fmac_f32 v90, v100, v81
v_fmac_f32 v91, v101, v81
v_lshlrev_b32 v102, 16, v142
v_mfma_f32_16x16x32_bf16 v[56:59], a[212:215], v[128:131], v[56:59]
v_and_b32 v103, s12, v142
v_fmac_f32 v92, v102, v81
v_fmac_f32 v93, v103, v81
v_lshlrev_b32 v96, 16, v143
v_and_b32 v97, s12, v143
v_fmac_f32 v94, v96, v81
v_fmac_f32 v95, v97, v81
s_waitcnt vmcnt(11)
s_waitcnt lgkmcnt(4)
v_mfma_f32_16x16x32_bf16 v[44:47], a[152:155], v[132:135], v[44:47]
v_lshlrev_b32 v98, 16, v144
v_and_b32 v99, s12, v144
v_fmac_f32 v88, v98, v82
v_mfma_f32_16x16x32_bf16 v[48:51], a[156:159], v[132:135], v[48:51]
v_fmac_f32 v89, v99, v82
v_lshlrev_b32 v100, 16, v145
v_and_b32 v101, s12, v145
v_mfma_f32_16x16x32_bf16 v[52:55], a[216:219], v[132:135], v[52:55]
v_fmac_f32 v90, v100, v82
v_fmac_f32 v91, v101, v82
v_lshlrev_b32 v102, 16, v146
v_mfma_f32_16x16x32_bf16 v[56:59], a[220:223], v[132:135], v[56:59]
v_and_b32 v103, s12, v146
v_fmac_f32 v92, v102, v82
v_fmac_f32 v93, v103, v82
v_lshlrev_b32 v96, 16, v147
v_and_b32 v97, s12, v147
v_fmac_f32 v94, v96, v82
v_fmac_f32 v95, v97, v82
s_waitcnt vmcnt(10)
s_waitcnt lgkmcnt(3)
v_mfma_f32_16x16x32_bf16 v[44:47], a[160:163], v[112:115], v[44:47]
v_lshlrev_b32 v98, 16, v148
v_and_b32 v99, s12, v148
v_fmac_f32 v88, v98, v84
v_mfma_f32_16x16x32_bf16 v[48:51], a[164:167], v[112:115], v[48:51]
v_fmac_f32 v89, v99, v84
v_lshlrev_b32 v100, 16, v149
v_and_b32 v101, s12, v149
v_mfma_f32_16x16x32_bf16 v[52:55], a[224:227], v[112:115], v[52:55]
v_fmac_f32 v90, v100, v84
v_fmac_f32 v91, v101, v84
v_lshlrev_b32 v102, 16, v150
v_mfma_f32_16x16x32_bf16 v[56:59], a[228:231], v[112:115], v[56:59]
v_and_b32 v103, s12, v150
v_fmac_f32 v92, v102, v84
v_fmac_f32 v93, v103, v84
v_lshlrev_b32 v96, 16, v151
v_and_b32 v97, s12, v151
v_fmac_f32 v94, v96, v84
v_fmac_f32 v95, v97, v84
s_waitcnt vmcnt(9)
s_waitcnt lgkmcnt(2)
v_mfma_f32_16x16x32_bf16 v[44:47], a[168:171], v[116:119], v[44:47]
v_lshlrev_b32 v98, 16, v152
v_and_b32 v99, s12, v152
v_fmac_f32 v88, v98, v85
v_mfma_f32_16x16x32_bf16 v[48:51], a[172:175], v[116:119], v[48:51]
v_fmac_f32 v89, v99, v85
v_lshlrev_b32 v100, 16, v153
v_and_b32 v101, s12, v153
v_mfma_f32_16x16x32_bf16 v[52:55], a[232:235], v[116:119], v[52:55]
v_fmac_f32 v90, v100, v85
v_fmac_f32 v91, v101, v85
v_lshlrev_b32 v102, 16, v154
v_mfma_f32_16x16x32_bf16 v[56:59], a[236:239], v[116:119], v[56:59]
v_and_b32 v103, s12, v154
v_fmac_f32 v92, v102, v85
v_fmac_f32 v93, v103, v85
v_lshlrev_b32 v96, 16, v155
v_and_b32 v97, s12, v155
v_fmac_f32 v94, v96, v85
v_fmac_f32 v95, v97, v85
s_waitcnt vmcnt(8)
s_waitcnt lgkmcnt(1)
v_mfma_f32_16x16x32_bf16 v[44:47], a[176:179], v[120:123], v[44:47]
v_lshlrev_b32 v98, 16, v156
v_and_b32 v99, s12, v156
v_fmac_f32 v88, v98, v86
v_mfma_f32_16x16x32_bf16 v[48:51], a[180:183], v[120:123], v[48:51]
v_fmac_f32 v89, v99, v86
v_lshlrev_b32 v100, 16, v157
v_and_b32 v101, s12, v157
v_mfma_f32_16x16x32_bf16 v[52:55], a[240:243], v[120:123], v[52:55]
v_fmac_f32 v90, v100, v86
v_fmac_f32 v91, v101, v86
v_lshlrev_b32 v102, 16, v158
v_mfma_f32_16x16x32_bf16 v[56:59], a[244:247], v[120:123], v[56:59]
v_and_b32 v103, s12, v158
v_fmac_f32 v92, v102, v86
v_fmac_f32 v93, v103, v86
v_lshlrev_b32 v96, 16, v159
v_and_b32 v97, s12, v159
v_fmac_f32 v94, v96, v86
v_fmac_f32 v95, v97, v86
v_cvt_pk_bf16_f32 v96, v88, v89
v_cvt_pk_bf16_f32 v97, v90, v91
v_cvt_pk_bf16_f32 v98, v92, v93
v_cvt_pk_bf16_f32 v99, v94, v95
ds_write_b128 v18, v[96:99] offset:16384
s_waitcnt vmcnt(7)
s_waitcnt lgkmcnt(1)
v_mfma_f32_16x16x32_bf16 v[44:47], a[184:187], v[124:127], v[44:47]
v_lshlrev_b32 v98, 16, v160
v_and_b32 v99, s12, v160
v_mul_f32 v88, v98, v80
v_mfma_f32_16x16x32_bf16 v[48:51], a[188:191], v[124:127], v[48:51]
v_mul_f32 v89, v99, v80
v_lshlrev_b32 v100, 16, v161
v_and_b32 v101, s12, v161
v_mfma_f32_16x16x32_bf16 v[52:55], a[248:251], v[124:127], v[52:55]
v_mul_f32 v90, v100, v80
v_mul_f32 v91, v101, v80
v_lshlrev_b32 v102, 16, v162
v_mfma_f32_16x16x32_bf16 v[56:59], a[252:255], v[124:127], v[56:59]
v_and_b32 v103, s12, v162
v_mul_f32 v92, v102, v80
v_mul_f32 v93, v103, v80
v_lshlrev_b32 v96, 16, v163
v_and_b32 v97, s12, v163
v_mul_f32 v94, v96, v80
v_mul_f32 v95, v97, v80
s_waitcnt vmcnt(6)
v_cvt_pk_bf16_f32 v44, v44, v45
v_cvt_pk_bf16_f32 v45, v46, v47
v_cvt_pk_bf16_f32 v46, v48, v49
v_cvt_pk_bf16_f32 v47, v50, v51
ds_write_b128 v15, v[44:47] offset:2048
v_cvt_pk_bf16_f32 v52, v52, v53
v_cvt_pk_bf16_f32 v53, v54, v55
v_cvt_pk_bf16_f32 v54, v56, v57
v_cvt_pk_bf16_f32 v55, v58, v59
ds_write_b128 v16, v[52:55] offset:2048
ds_read_b128 v[48:51], v17 offset:2048
ds_read_b128 v[56:59], v17 offset:3072
v_lshlrev_b32 v98, 16, v164
v_and_b32 v99, s12, v164
v_fmac_f32 v88, v98, v81
v_fmac_f32 v89, v99, v81
v_lshlrev_b32 v100, 16, v165
v_and_b32 v101, s12, v165
v_fmac_f32 v90, v100, v81
v_fmac_f32 v91, v101, v81
v_lshlrev_b32 v102, 16, v166
v_and_b32 v103, s12, v166
v_fmac_f32 v92, v102, v81
v_fmac_f32 v93, v103, v81
v_lshlrev_b32 v96, 16, v167
v_and_b32 v97, s12, v167
v_fmac_f32 v94, v96, v81
v_fmac_f32 v95, v97, v81
s_waitcnt vmcnt(5)
s_add_u32 s39, s53, 0
s_waitcnt lgkmcnt(1)
buffer_store_dwordx4 v[48:51], v9, s[40:43], s39 offen sc1
s_add_u32 s32, s53, 4096
s_waitcnt lgkmcnt(0)
buffer_store_dwordx4 v[56:59], v9, s[40:43], s32 offen sc1
v_lshlrev_b32 v98, 16, v168
v_and_b32 v99, s12, v168
v_fmac_f32 v88, v98, v82
v_fmac_f32 v89, v99, v82
v_lshlrev_b32 v100, 16, v169
v_and_b32 v101, s12, v169
v_fmac_f32 v90, v100, v82
v_fmac_f32 v91, v101, v82
v_lshlrev_b32 v102, 16, v170
v_and_b32 v103, s12, v170
v_fmac_f32 v92, v102, v82
v_fmac_f32 v93, v103, v82
v_lshlrev_b32 v96, 16, v171
v_and_b32 v97, s12, v171
v_fmac_f32 v94, v96, v82
v_fmac_f32 v95, v97, v82
s_waitcnt vmcnt(6)
v_lshlrev_b32 v98, 16, v172
v_and_b32 v99, s12, v172
v_fmac_f32 v88, v98, v84
v_fmac_f32 v89, v99, v84
v_lshlrev_b32 v100, 16, v173
v_and_b32 v101, s12, v173
v_fmac_f32 v90, v100, v84
v_fmac_f32 v91, v101, v84
v_lshlrev_b32 v102, 16, v174
v_and_b32 v103, s12, v174
v_fmac_f32 v92, v102, v84
v_fmac_f32 v93, v103, v84
v_lshlrev_b32 v96, 16, v175
v_and_b32 v97, s12, v175
v_fmac_f32 v94, v96, v84
v_fmac_f32 v95, v97, v84
s_waitcnt vmcnt(5)
v_lshlrev_b32 v98, 16, v176
v_and_b32 v99, s12, v176
v_fmac_f32 v88, v98, v85
v_fmac_f32 v89, v99, v85
v_lshlrev_b32 v100, 16, v177
v_and_b32 v101, s12, v177
v_fmac_f32 v90, v100, v85
v_fmac_f32 v91, v101, v85
v_lshlrev_b32 v102, 16, v178
v_and_b32 v103, s12, v178
v_fmac_f32 v92, v102, v85
v_fmac_f32 v93, v103, v85
v_lshlrev_b32 v96, 16, v179
v_and_b32 v97, s12, v179
v_fmac_f32 v94, v96, v85
v_fmac_f32 v95, v97, v85
s_waitcnt vmcnt(4)
v_lshlrev_b32 v98, 16, v180
v_and_b32 v99, s12, v180
v_fmac_f32 v88, v98, v86
v_fmac_f32 v89, v99, v86
v_lshlrev_b32 v100, 16, v181
v_and_b32 v101, s12, v181
v_fmac_f32 v90, v100, v86
v_fmac_f32 v91, v101, v86
v_lshlrev_b32 v102, 16, v182
v_and_b32 v103, s12, v182
v_fmac_f32 v92, v102, v86
v_fmac_f32 v93, v103, v86
v_lshlrev_b32 v96, 16, v183
v_and_b32 v97, s12, v183
v_fmac_f32 v94, v96, v86
v_fmac_f32 v95, v97, v86
v_cvt_pk_bf16_f32 v96, v88, v89
v_cvt_pk_bf16_f32 v97, v90, v91
v_cvt_pk_bf16_f32 v98, v92, v93
v_cvt_pk_bf16_f32 v99, v94, v95
ds_write_b128 v26, v[96:99] offset:16384
s_waitcnt lgkmcnt(0)
s_barrier
ds_read_b128 v[128:131], v252 offset:49152
ds_read_b128 v[132:135], v252 offset:50176
ds_read_b128 v[112:115], v252 offset:51200
ds_read_b128 v[116:119], v252 offset:52224
ds_read_b128 v[120:123], v252 offset:53248
s_waitcnt lgkmcnt(4)
v_mfma_f32_16x16x32_bf16 v[60:63], a[128:131], v[128:131], v[60:63]
ds_read_b128 v[124:127], v252 offset:54272
v_mfma_f32_16x16x32_bf16 v[64:67], a[132:135], v[128:131], v[64:67]
v_mfma_f32_16x16x32_bf16 v[68:71], a[192:195], v[128:131], v[68:71]
v_mfma_f32_16x16x32_bf16 v[72:75], a[196:199], v[128:131], v[72:75]
s_waitcnt lgkmcnt(4)
v_mfma_f32_16x16x32_bf16 v[60:63], a[136:139], v[132:135], v[60:63]
ds_read_b128 v[128:131], v252 offset:55296
v_mfma_f32_16x16x32_bf16 v[64:67], a[140:143], v[132:135], v[64:67]
v_mfma_f32_16x16x32_bf16 v[68:71], a[200:203], v[132:135], v[68:71]
v_mfma_f32_16x16x32_bf16 v[72:75], a[204:207], v[132:135], v[72:75]
s_waitcnt lgkmcnt(4)
v_mfma_f32_16x16x32_bf16 v[60:63], a[144:147], v[112:115], v[60:63]
ds_read_b128 v[132:135], v252 offset:56320
v_mfma_f32_16x16x32_bf16 v[64:67], a[148:151], v[112:115], v[64:67]
v_mfma_f32_16x16x32_bf16 v[68:71], a[208:211], v[112:115], v[68:71]
v_mfma_f32_16x16x32_bf16 v[72:75], a[212:215], v[112:115], v[72:75]
s_waitcnt lgkmcnt(4)
v_mfma_f32_16x16x32_bf16 v[60:63], a[152:155], v[116:119], v[60:63]
v_mfma_f32_16x16x32_bf16 v[64:67], a[156:159], v[116:119], v[64:67]
v_mfma_f32_16x16x32_bf16 v[68:71], a[216:219], v[116:119], v[68:71]
v_mfma_f32_16x16x32_bf16 v[72:75], a[220:223], v[116:119], v[72:75]
s_waitcnt lgkmcnt(3)
v_mfma_f32_16x16x32_bf16 v[60:63], a[160:163], v[120:123], v[60:63]
v_mfma_f32_16x16x32_bf16 v[64:67], a[164:167], v[120:123], v[64:67]
v_mfma_f32_16x16x32_bf16 v[68:71], a[224:227], v[120:123], v[68:71]
v_mfma_f32_16x16x32_bf16 v[72:75], a[228:231], v[120:123], v[72:75]
s_waitcnt lgkmcnt(2)
v_mfma_f32_16x16x32_bf16 v[60:63], a[168:171], v[124:127], v[60:63]
v_mfma_f32_16x16x32_bf16 v[64:67], a[172:175], v[124:127], v[64:67]
v_mfma_f32_16x16x32_bf16 v[68:71], a[232:235], v[124:127], v[68:71]
v_mfma_f32_16x16x32_bf16 v[72:75], a[236:239], v[124:127], v[72:75]
s_waitcnt lgkmcnt(1)
v_mfma_f32_16x16x32_bf16 v[60:63], a[176:179], v[128:131], v[60:63]
v_mfma_f32_16x16x32_bf16 v[64:67], a[180:183], v[128:131], v[64:67]
v_mfma_f32_16x16x32_bf16 v[68:71], a[240:243], v[128:131], v[68:71]
v_mfma_f32_16x16x32_bf16 v[72:75], a[244:247], v[128:131], v[72:75]
s_waitcnt lgkmcnt(0)
v_mfma_f32_16x16x32_bf16 v[60:63], a[184:187], v[132:135], v[60:63]
v_mfma_f32_16x16x32_bf16 v[64:67], a[188:191], v[132:135], v[64:67]
v_mfma_f32_16x16x32_bf16 v[68:71], a[248:251], v[132:135], v[68:71]
v_mfma_f32_16x16x32_bf16 v[72:75], a[252:255], v[132:135], v[72:75]
s_nop 4
v_cvt_pk_bf16_f32 v60, v60, v61
v_cvt_pk_bf16_f32 v61, v62, v63
v_cvt_pk_bf16_f32 v62, v64, v65
v_cvt_pk_bf16_f32 v63, v66, v67
ds_write_b128 v244, v[60:63] offset:0
v_cvt_pk_bf16_f32 v68, v68, v69
v_cvt_pk_bf16_f32 v69, v70, v71
v_cvt_pk_bf16_f32 v70, v72, v73
v_cvt_pk_bf16_f32 v71, v74, v75
ds_write_b128 v245, v[68:71] offset:0
ds_read_b128 v[64:67], v246 offset:0
ds_read_b128 v[72:75], v246 offset:1024
s_add_u32 s33, s54, 0
s_waitcnt lgkmcnt(1)
buffer_store_dwordx4 v[64:67], v9, s[40:43], s33 offen sc1
s_add_u32 s35, s54, 4096
s_waitcnt lgkmcnt(0)
buffer_store_dwordx4 v[72:75], v9, s[40:43], s35 offen sc1
s_branch L2_fin
LC_poll:
s_mov_b32 s36, 0
LC_poll2:
s_mov_b32 s70, 0
s_atomic_add s70, s[60:61], s48 glc
s_cmp_lt_u32 s2, 240
s_cbranch_scc1 LC_poll3
s_mov_b32 s71, 0
s_atomic_add s71, s[60:61], s49 glc
s_mov_b32 s72, 0
s_atomic_add s72, s[60:61], s50 glc
s_waitcnt lgkmcnt(0)
s_min_u32 s70, s70, s71
s_min_u32 s70, s70, s72
LC_poll3:
s_waitcnt lgkmcnt(0)
s_cmp_ge_u32 s70, 6
s_cbranch_scc1 LC_got
s_sleep 2
s_add_u32 s36, s36, 1
s_cmp_gt_u32 s36, 0x40000
s_cbranch_scc0 LC_poll2
s_branch LC_got
LC_side:
s_cmp_eq_u32 s14, 1
s_cbranch_scc1 LC_sideok
s_cmp_lt_u32 s2, 240
s_cbranch_scc1 LC_side1
s_barrier
LC_side1:
s_mov_b32 s36, 0
s_mov_b32 s33, 0x6c01400
LC_side2:
buffer_load_dword v1, off, s[56:59], s33 sc1
s_waitcnt vmcnt(0)
v_readfirstlane_b32 s99, v1
s_add_u32 s36, s36, 1
s_cmp_gt_u32 s36, 0x40000
s_cbranch_scc1 LC_side3
s_cmp_ge_u32 s99, 60
s_cbranch_scc1 LC_side3
s_sleep 8
s_branch LC_side2
LC_side3:
v_lshrrev_b32 v0, 4, v252
v_and_b32 v2, 15, v0
v_lshrrev_b32 v3, 4, v0
s_lshl_b32 s55, s34, 13
s_add_u32 s55, s55, 0x21000
s_lshl_b32 s73, s34, 11
s_add_u32 s73, s73, s100
s_add_u32 s73, s73, 0x6000
s_lshl_b32 s33, s34, 7
v_bfe_u32 v9, v252, 4, 3
v_lshrrev_b32 v1, 7, v252
v_xor_b32 v9, v9, v1
v_lshl_add_u32 v1, v1, 9, s33
v_lshl_add_u32 v9, v9, 4, v1
v_mov_b32 v4, 0x7fff0000
v_cmp_eq_u32 vcc, 0, v3
v_mov_b32 v1, s52
s_nop 0
v_cndmask_b32 v4, v4, v1, vcc
v_cmp_eq_u32 vcc, 1, v3
v_mov_b32 v1, s53
s_nop 0
v_cndmask_b32 v4, v4, v1, vcc
v_cmp_eq_u32 vcc, 2, v3
v_mov_b32 v1, s54
s_nop 0
v_cndmask_b32 v4, v4, v1, vcc
v_lshl_add_u32 v4, v2, 9, v4
v_lshrrev_b32 v7, 3, v4
v_lshrrev_b32 v8, 8, v4
s_add_u32 s8, s6, 0x0
s_addc_u32 s9, s7, 0
s_mov_b32 s10, 0x4e2000
s_mov_b32 s11, 0x00020000
s_add_u32 s44, s16, 0x0
s_addc_u32 s45, s17, 0
s_mov_b32 s46, 0x4e20
s_mov_b32 s47, 0x00020000
s_add_u32 m0, s55, 0
s_add_u32 s39, s52, 0
buffer_load_dwordx4 v9, s[8:11], s39 offen lds
s_add_u32 m0, s55, 1024
s_add_u32 s32, s52, 4096
buffer_load_dwordx4 v9, s[8:11], s32 offen lds
s_add_u32 m0, s55, 2048
s_add_u32 s33, s53, 0
buffer_load_dwordx4 v9, s[8:11], s33 offen lds
s_add_u32 m0, s55, 3072
s_add_u32 s35, s53, 4096
buffer_load_dwordx4 v9, s[8:11], s35 offen lds
s_add_u32 m0, s73, 0
s_add_u32 s39, s54, 0
buffer_load_dwordx4 v9, s[8:11], s39 offen lds
s_add_u32 m0, s73, 1024
s_add_u32 s32, s54, 4096
buffer_load_dwordx4 v9, s[8:11], s32 offen lds
buffer_load_ushort v255, v8, s[44:47], 0 offen
s_waitcnt vmcnt(0)
s_branch LC_sideok
LC_slow:
s_waitcnt vmcnt(0)
s_barrier
s_cmp_eq_u32 s98, 0
s_cbranch_scc1 LC_slowend
s_mov_b32 s50, 0xe1a06800
s_mov_b32 s51, 0x4e608d04
s_mul_i32 s39, s37, 9
s_lshr_b64 s[50:51], s[50:51], s39
s_and_b32 s39, s50, 0x1ff
s_bfe_u32 s49, s50, 0x90009
s_sub_u32 s29, s49, s39
s_lshl_b32 s50, s37, 2
s_lshr_b32 s59, 0x766666, s50
s_and_b32 s59, s59, 15
s_sub_u32 s31, s29, s59
s_lshr_b32 s31, s31, 1
s_sub_u32 s31, s31, 1
s_lshl_b32 s39, s39, 14
s_lshl_b32 s49, s49, 14
s_add_u32 s28, s39, 0x4000
s_cmp_eq_u32 s37, 5
s_cselect_b32 s33, 0xff800000, 0
s_mov_b32 s32, 0xffff
s_add_u32 s12, s4, 0x6800000
s_addc_u32 s13, s5, 0
s_mov_b32 s14, s49
s_mov_b32 s15, 0x00020000
s_add_u32 s8, s4, 0x0
s_addc_u32 s9, s5, 0
s_mov_b32 s10, 0x4e4000
s_mov_b32 s11, 0x00020000
s_mul_i32 s35, s37, 0x600000
s_add_u32 s20, s4, 0x2000000
s_addc_u32 s21, s5, 0
s_add_u32 s20, s20, s35
s_addc_u32 s21, s21, 0
s_mov_b32 s22, 0x4e4000
s_mov_b32 s23, 0x00020000
s_add_u32 s24, s4, 0x6000000
s_addc_u32 s25, s5, 0
s_mov_b32 s26, 0x9c800
s_mov_b32 s27, 0x00020000
s_lshl_b32 s35, s38, 4
s_lshl_b32 s41, s34, 2
s_add_u32 s35, s35, s41
s_lshl_b32 s40, s35, 13
s_lshl_b32 s48, s35, 10
s_lshl_b32 s35, s37, 3
s_add_u32 s48, s48, s35
v_bfe_u32 v248, v252, 4, 3
v_lshlrev_b32 v248, 6, v248
v_bfe_u32 v253, v252, 7, 1
v_lshl_or_b32 v248, v253, 10, v248
v_bfe_u32 v253, v252, 8, 2
v_lshl_or_b32 v248, v253, 4, v248
v_bfe_u32 v253, v252, 6, 1
v_lshlrev_b32 v253, 5, v253
v_xor_b32 v248, v248, v253
v_and_b32 v249, 0x1c0, v252
v_bfe_u32 v253, v252, 9, 1
v_lshl_or_b32 v249, v253, 10, v249
v_bfe_u32 v253, v252, 8, 1
v_lshl_or_b32 v249, v253, 5, v249
v_bfe_u32 v253, v252, 4, 2
v_lshl_or_b32 v249, v253, 3, v249
v_xor_b32 v250, 32, v249
v_and_b32 v251, 0xfffffe7f, v251
s_mul_i32 s36, s34, 0xa000
s_mov_b32 s56, s36
s_add_u32 s57, s56, 32768
s_mov_b32 s55, 4
v_bfe_i32 v188, v252, 8, 1
LS_q:
s_add_u32 s44, s40, 4096
buffer_load_dwordx4 v[0:3], v252, s[8:11], s40 offen offset:0
buffer_load_dwordx4 v[4:7], v252, s[8:11], s40 offen offset:1024
buffer_load_dwordx4 v[8:11], v252, s[8:11], s40 offen offset:2048
buffer_load_dwordx4 v[12:15], v252, s[8:11], s40 offen offset:3072
buffer_load_dwordx4 v[16:19], v252, s[8:11], s44 offen offset:0
buffer_load_dwordx4 v[20:23], v252, s[8:11], s44 offen offset:1024
buffer_load_dwordx4 v[24:27], v252, s[8:11], s44 offen offset:2048
buffer_load_dwordx4 v[28:31], v252, s[8:11], s44 offen offset:3072
s_mov_b32 s53, s56
s_mov_b32 s58, s39
s_add_u32 m0, s53, 0
s_add_u32 s54, s58, 0
buffer_load_dwordx4 v251, s[12:15], s54 offen offset:0 lds
buffer_load_dwordx4 v251, s[12:15], s54 offen offset:1024 lds
buffer_load_dwordx4 v251, s[12:15], s54 offen offset:2048 lds
buffer_load_dwordx4 v251, s[12:15], s54 offen offset:3072 lds
s_add_u32 m0, s53, 4096
s_add_u32 s54, s58, 128
buffer_load_dwordx4 v251, s[12:15], s54 offen offset:0 lds
buffer_load_dwordx4 v251, s[12:15], s54 offen offset:1024 lds
buffer_load_dwordx4 v251, s[12:15], s54 offen offset:2048 lds
buffer_load_dwordx4 v251, s[12:15], s54 offen offset:3072 lds
s_add_u32 m0, s53, 8192
s_add_u32 s54, s58, 256
buffer_load_dwordx4 v251, s[12:15], s54 offen offset:0 lds
buffer_load_dwordx4 v251, s[12:15], s54 offen offset:1024 lds
buffer_load_dwordx4 v251, s[12:15], s54 offen offset:2048 lds
buffer_load_dwordx4 v251, s[12:15], s54 offen offset:3072 lds
s_add_u32 m0, s53, 12288
s_add_u32 s54, s58, 384
buffer_load_dwordx4 v251, s[12:15], s54 offen offset:0 lds
buffer_load_dwordx4 v251, s[12:15], s54 offen offset:1024 lds
buffer_load_dwordx4 v251, s[12:15], s54 offen offset:2048 lds
buffer_load_dwordx4 v251, s[12:15], s54 offen offset:3072 lds
s_add_u32 s53, s53, 0x4000
s_cmp_eq_u32 s53, s57
s_cselect_b32 s53, s56, s53
s_add_u32 s58, s58, 0x4000
s_mov_b32 s51, s29
s_mov_b32 s52, s56
v_mov_b32 v172, 0xff800000
v_accvgpr_write_b32 a0, 0
v_accvgpr_write_b32 a1, 0
v_accvgpr_write_b32 a2, 0
v_accvgpr_write_b32 a3, 0
v_accvgpr_write_b32 a4, 0
v_accvgpr_write_b32 a5, 0
v_accvgpr_write_b32 a6, 0
v_accvgpr_write_b32 a7, 0
v_accvgpr_write_b32 a8, 0
v_accvgpr_write_b32 a9, 0
v_accvgpr_write_b32 a10, 0
v_accvgpr_write_b32 a11, 0
v_accvgpr_write_b32 a12, 0
v_accvgpr_write_b32 a13, 0
v_accvgpr_write_b32 a14, 0
v_accvgpr_write_b32 a15, 0
v_accvgpr_write_b32 a16, 0
v_accvgpr_write_b32 a17, 0
v_accvgpr_write_b32 a18, 0
v_accvgpr_write_b32 a19, 0
v_accvgpr_write_b32 a20, 0
v_accvgpr_write_b32 a21, 0
v_accvgpr_write_b32 a22, 0
v_accvgpr_write_b32 a23, 0
v_accvgpr_write_b32 a24, 0
v_accvgpr_write_b32 a25, 0
v_accvgpr_write_b32 a26, 0
v_accvgpr_write_b32 a27, 0
v_accvgpr_write_b32 a28, 0
v_accvgpr_write_b32 a29, 0
v_accvgpr_write_b32 a30, 0
v_accvgpr_write_b32 a31, 0
v_accvgpr_write_b32 a32, 0
v_accvgpr_write_b32 a33, 0
v_accvgpr_write_b32 a34, 0
v_accvgpr_write_b32 a35, 0
v_accvgpr_write_b32 a36, 0
v_accvgpr_write_b32 a37, 0
v_accvgpr_write_b32 a38, 0
v_accvgpr_write_b32 a39, 0
v_accvgpr_write_b32 a40, 0
v_accvgpr_write_b32 a41, 0
v_accvgpr_write_b32 a42, 0
v_accvgpr_write_b32 a43, 0
v_accvgpr_write_b32 a44, 0
v_accvgpr_write_b32 a45, 0
v_accvgpr_write_b32 a46, 0
v_accvgpr_write_b32 a47, 0
v_accvgpr_write_b32 a48, 0
v_accvgpr_write_b32 a49, 0
v_accvgpr_write_b32 a50, 0
v_accvgpr_write_b32 a51, 0
v_accvgpr_write_b32 a52, 0
v_accvgpr_write_b32 a53, 0
v_accvgpr_write_b32 a54, 0
v_accvgpr_write_b32 a55, 0
v_accvgpr_write_b32 a56, 0
v_accvgpr_write_b32 a57, 0
v_accvgpr_write_b32 a58, 0
v_accvgpr_write_b32 a59, 0
v_accvgpr_write_b32 a60, 0
v_accvgpr_write_b32 a61, 0
v_accvgpr_write_b32 a62, 0
v_accvgpr_write_b32 a63, 0
LS_loop:
s_add_u32 m0, s53, 0
s_add_u32 s54, s58, 0
buffer_load_dwordx4 v251, s[12:15], s54 offen offset:0 lds
buffer_load_dwordx4 v251, s[12:15], s54 offen offset:1024 lds
buffer_load_dwordx4 v251, s[12:15], s54 offen offset:2048 lds
buffer_load_dwordx4 v251, s[12:15], s54 offen offset:3072 lds
s_add_u32 m0, s53, 4096
s_add_u32 s54, s58, 128
buffer_load_dwordx4 v251, s[12:15], s54 offen offset:0 lds
buffer_load_dwordx4 v251, s[12:15], s54 offen offset:1024 lds
buffer_load_dwordx4 v251, s[12:15], s54 offen offset:2048 lds
buffer_load_dwordx4 v251, s[12:15], s54 offen offset:3072 lds
s_add_u32 m0, s53, 8192
s_add_u32 s54, s58, 256
buffer_load_dwordx4 v251, s[12:15], s54 offen offset:0 lds
buffer_load_dwordx4 v251, s[12:15], s54 offen offset:1024 lds
buffer_load_dwordx4 v251, s[12:15], s54 offen offset:2048 lds
buffer_load_dwordx4 v251, s[12:15], s54 offen offset:3072 lds
s_add_u32 m0, s53, 12288
s_add_u32 s54, s58, 384
buffer_load_dwordx4 v251, s[12:15], s54 offen offset:0 lds
buffer_load_dwordx4 v251, s[12:15], s54 offen offset:1024 lds
buffer_load_dwordx4 v251, s[12:15], s54 offen offset:2048 lds
buffer_load_dwordx4 v251, s[12:15], s54 offen offset:3072 lds
s_add_u32 s53, s53, 0x4000
s_cmp_eq_u32 s53, s57
s_cselect_b32 s53, s56, s53
s_add_u32 s58, s58, 0x4000
v_add_u32 v177, s52, v248
v_add_u32 v178, s52, v249
v_add_u32 v179, s52, v250
s_add_u32 s52, s52, 0x4000
s_cmp_eq_u32 s52, s57
s_cselect_b32 s52, s56, s52
s_cmp_eq_u32 s51, 1
s_cselect_b32 s54, s33, 0
v_and_b32 v192, s54, v188
v_and_b32 v193, s54, v188
v_and_b32 v194, s54, v188
v_and_b32 v195, s54, v188
s_waitcnt vmcnt(16)
ds_read_b128 v[32:35], v177 offset:0
ds_read_b128 v[64:67], v177 offset:2048
ds_read_b128 v[36:39], v177 offset:512
ds_read_b128 v[68:71], v177 offset:2560
ds_read_b128 v[40:43], v177 offset:4096
ds_read_b128 v[72:75], v177 offset:6144
ds_read_b128 v[44:47], v177 offset:4608
ds_read_b128 v[76:79], v177 offset:6656
ds_read_b128 v[48:51], v177 offset:8192
ds_read_b128 v[80:83], v177 offset:10240
ds_read_b128 v[52:55], v177 offset:8704
ds_read_b128 v[84:87], v177 offset:10752
ds_read_b128 v[56:59], v177 offset:12288
ds_read_b128 v[88:91], v177 offset:14336
ds_read_b128 v[60:63], v177 offset:12800
ds_read_b128 v[92:95], v177 offset:14848
s_waitcnt lgkmcnt(14)
v_mfma_f32_16x16x32_bf16 v[160:163], v[32:35], v[0:3], v[192:195]
v_mfma_f32_16x16x32_bf16 v[164:167], v[64:67], v[0:3], v[192:195]
s_waitcnt lgkmcnt(12)
v_mfma_f32_16x16x32_bf16 v[160:163], v[36:39], v[4:7], v[160:163]
v_mfma_f32_16x16x32_bf16 v[164:167], v[68:71], v[4:7], v[164:167]
s_waitcnt lgkmcnt(10)
v_mfma_f32_16x16x32_bf16 v[160:163], v[40:43], v[8:11], v[160:163]
v_mfma_f32_16x16x32_bf16 v[164:167], v[72:75], v[8:11], v[164:167]
s_waitcnt lgkmcnt(8)
v_mfma_f32_16x16x32_bf16 v[160:163], v[44:47], v[12:15], v[160:163]
v_mfma_f32_16x16x32_bf16 v[164:167], v[76:79], v[12:15], v[164:167]
s_waitcnt lgkmcnt(6)
v_mfma_f32_16x16x32_bf16 v[160:163], v[48:51], v[16:19], v[160:163]
v_mfma_f32_16x16x32_bf16 v[164:167], v[80:83], v[16:19], v[164:167]
s_waitcnt lgkmcnt(4)
v_mfma_f32_16x16x32_bf16 v[160:163], v[52:55], v[20:23], v[160:163]
v_mfma_f32_16x16x32_bf16 v[164:167], v[84:87], v[20:23], v[164:167]
s_waitcnt lgkmcnt(2)
v_mfma_f32_16x16x32_bf16 v[160:163], v[56:59], v[24:27], v[160:163]
v_mfma_f32_16x16x32_bf16 v[164:167], v[88:91], v[24:27], v[164:167]
s_waitcnt lgkmcnt(0)
v_mfma_f32_16x16x32_bf16 v[160:163], v[60:63], v[28:31], v[160:163]
v_mfma_f32_16x16x32_bf16 v[164:167], v[92:95], v[28:31], v[164:167]
ds_read_b64_tr_b16 v[96:97], v178 offset:0
ds_read_b64_tr_b16 v[98:99], v178 offset:2048
ds_read_b64_tr_b16 v[100:101], v179 offset:0
ds_read_b64_tr_b16 v[102:103], v179 offset:2048
ds_read_b64_tr_b16 v[104:105], v178 offset:512
ds_read_b64_tr_b16 v[106:107], v178 offset:2560
ds_read_b64_tr_b16 v[108:109], v179 offset:512
ds_read_b64_tr_b16 v[110:111], v179 offset:2560
ds_read_b64_tr_b16 v[112:113], v178 offset:4096
ds_read_b64_tr_b16 v[114:115], v178 offset:6144
ds_read_b64_tr_b16 v[116:117], v179 offset:4096
ds_read_b64_tr_b16 v[118:119], v179 offset:6144
ds_read_b64_tr_b16 v[120:121], v178 offset:4608
ds_read_b64_tr_b16 v[122:123], v178 offset:6656
ds_read_b64_tr_b16 v[124:125], v179 offset:4608
ds_read_b64_tr_b16 v[126:127], v179 offset:6656
ds_read_b64_tr_b16 v[128:129], v178 offset:8192
ds_read_b64_tr_b16 v[130:131], v178 offset:10240
ds_read_b64_tr_b16 v[132:133], v179 offset:8192
ds_read_b64_tr_b16 v[134:135], v179 offset:10240
ds_read_b64_tr_b16 v[136:137], v178 offset:8704
ds_read_b64_tr_b16 v[138:139], v178 offset:10752
ds_read_b64_tr_b16 v[140:141], v179 offset:8704
ds_read_b64_tr_b16 v[142:143], v179 offset:10752
ds_read_b64_tr_b16 v[144:145], v178 offset:12288
ds_read_b64_tr_b16 v[146:147], v178 offset:14336
ds_read_b64_tr_b16 v[148:149], v179 offset:12288
ds_read_b64_tr_b16 v[150:151], v179 offset:14336
ds_read_b64_tr_b16 v[152:153], v178 offset:12800
ds_read_b64_tr_b16 v[154:155], v178 offset:14848
ds_read_b64_tr_b16 v[156:157], v179 offset:12800
ds_read_b64_tr_b16 v[158:159], v179 offset:14848
s_nop 7
v_max3_f32 v175, v160, v161, v162
v_max3_f32 v175, v175, v163, v164
v_max3_f32 v175, v175, v165, v166
v_max3_f32 v175, v175, v167, v172
v_mov_b32 v176, v175
s_nop 1
v_permlane32_swap_b32 v175, v176
s_nop 1
v_max_f32 v175, v175, v176
v_mov_b32 v176, v175
s_nop 1
v_permlane16_swap_b32 v175, v176
s_nop 1
v_max_f32 v175, v175, v176
v_sub_f32 v174, v172, v175
v_exp_f32 v174, v174
v_mov_b32 v172, v175
v_sub_f32 v160, v160, v172
v_sub_f32 v161, v161, v172
v_sub_f32 v162, v162, v172
v_sub_f32 v163, v163, v172
v_sub_f32 v164, v164, v172
v_sub_f32 v165, v165, v172
v_sub_f32 v166, v166, v172
v_sub_f32 v167, v167, v172
v_exp_f32 v160, v160
v_exp_f32 v161, v161
v_exp_f32 v162, v162
v_exp_f32 v163, v163
v_exp_f32 v164, v164
v_exp_f32 v165, v165
v_exp_f32 v166, v166
v_exp_f32 v167, v167
v_cmp_neq_f32 vcc, 1.0, v174
v_cvt_pk_bf16_f32 v168, v160, v161
v_cvt_pk_bf16_f32 v169, v162, v163
v_cvt_pk_bf16_f32 v170, v164, v165
v_cvt_pk_bf16_f32 v171, v166, v167
s_cbranch_vccz LS_nors
v_accvgpr_read_b32 v180, a0
v_accvgpr_read_b32 v181, a1
v_accvgpr_read_b32 v182, a2
v_accvgpr_read_b32 v183, a3
v_accvgpr_read_b32 v184, a4
v_accvgpr_read_b32 v185, a5
v_accvgpr_read_b32 v186, a6
v_accvgpr_read_b32 v187, a7
v_mul_f32 v180, v180, v174
v_mul_f32 v181, v181, v174
v_mul_f32 v182, v182, v174
v_mul_f32 v183, v183, v174
v_mul_f32 v184, v184, v174
v_mul_f32 v185, v185, v174
v_mul_f32 v186, v186, v174
v_mul_f32 v187, v187, v174
v_accvgpr_write_b32 a0, v180
v_accvgpr_write_b32 a1, v181
v_accvgpr_write_b32 a2, v182
v_accvgpr_write_b32 a3, v183
v_accvgpr_write_b32 a4, v184
v_accvgpr_write_b32 a5, v185
v_accvgpr_write_b32 a6, v186
v_accvgpr_write_b32 a7, v187
v_accvgpr_read_b32 v180, a8
v_accvgpr_read_b32 v181, a9
v_accvgpr_read_b32 v182, a10
v_accvgpr_read_b32 v183, a11
v_accvgpr_read_b32 v184, a12
v_accvgpr_read_b32 v185, a13
v_accvgpr_read_b32 v186, a14
v_accvgpr_read_b32 v187, a15
v_mul_f32 v180, v180, v174
v_mul_f32 v181, v181, v174
v_mul_f32 v182, v182, v174
v_mul_f32 v183, v183, v174
v_mul_f32 v184, v184, v174
v_mul_f32 v185, v185, v174
v_mul_f32 v186, v186, v174
v_mul_f32 v187, v187, v174
v_accvgpr_write_b32 a8, v180
v_accvgpr_write_b32 a9, v181
v_accvgpr_write_b32 a10, v182
v_accvgpr_write_b32 a11, v183
v_accvgpr_write_b32 a12, v184
v_accvgpr_write_b32 a13, v185
v_accvgpr_write_b32 a14, v186
v_accvgpr_write_b32 a15, v187
v_accvgpr_read_b32 v180, a16
v_accvgpr_read_b32 v181, a17
v_accvgpr_read_b32 v182, a18
v_accvgpr_read_b32 v183, a19
v_accvgpr_read_b32 v184, a20
v_accvgpr_read_b32 v185, a21
v_accvgpr_read_b32 v186, a22
v_accvgpr_read_b32 v187, a23
v_mul_f32 v180, v180, v174
v_mul_f32 v181, v181, v174
v_mul_f32 v182, v182, v174
v_mul_f32 v183, v183, v174
v_mul_f32 v184, v184, v174
v_mul_f32 v185, v185, v174
v_mul_f32 v186, v186, v174
v_mul_f32 v187, v187, v174
v_accvgpr_write_b32 a16, v180
v_accvgpr_write_b32 a17, v181
v_accvgpr_write_b32 a18, v182
v_accvgpr_write_b32 a19, v183
v_accvgpr_write_b32 a20, v184
v_accvgpr_write_b32 a21, v185
v_accvgpr_write_b32 a22, v186
v_accvgpr_write_b32 a23, v187
v_accvgpr_read_b32 v180, a24
v_accvgpr_read_b32 v181, a25
v_accvgpr_read_b32 v182, a26
v_accvgpr_read_b32 v183, a27
v_accvgpr_read_b32 v184, a28
v_accvgpr_read_b32 v185, a29
v_accvgpr_read_b32 v186, a30
v_accvgpr_read_b32 v187, a31
v_mul_f32 v180, v180, v174
v_mul_f32 v181, v181, v174
v_mul_f32 v182, v182, v174
v_mul_f32 v183, v183, v174
v_mul_f32 v184, v184, v174
v_mul_f32 v185, v185, v174
v_mul_f32 v186, v186, v174
v_mul_f32 v187, v187, v174
v_accvgpr_write_b32 a24, v180
v_accvgpr_write_b32 a25, v181
v_accvgpr_write_b32 a26, v182
v_accvgpr_write_b32 a27, v183
v_accvgpr_write_b32 a28, v184
v_accvgpr_write_b32 a29, v185
v_accvgpr_write_b32 a30, v186
v_accvgpr_write_b32 a31, v187
v_accvgpr_read_b32 v180, a32
v_accvgpr_read_b32 v181, a33
v_accvgpr_read_b32 v182, a34
v_accvgpr_read_b32 v183, a35
v_accvgpr_read_b32 v184, a36
v_accvgpr_read_b32 v185, a37
v_accvgpr_read_b32 v186, a38
v_accvgpr_read_b32 v187, a39
v_mul_f32 v180, v180, v174
v_mul_f32 v181, v181, v174
v_mul_f32 v182, v182, v174
v_mul_f32 v183, v183, v174
v_mul_f32 v184, v184, v174
v_mul_f32 v185, v185, v174
v_mul_f32 v186, v186, v174
v_mul_f32 v187, v187, v174
v_accvgpr_write_b32 a32, v180
v_accvgpr_write_b32 a33, v181
v_accvgpr_write_b32 a34, v182
v_accvgpr_write_b32 a35, v183
v_accvgpr_write_b32 a36, v184
v_accvgpr_write_b32 a37, v185
v_accvgpr_write_b32 a38, v186
v_accvgpr_write_b32 a39, v187
v_accvgpr_read_b32 v180, a40
v_accvgpr_read_b32 v181, a41
v_accvgpr_read_b32 v182, a42
v_accvgpr_read_b32 v183, a43
v_accvgpr_read_b32 v184, a44
v_accvgpr_read_b32 v185, a45
v_accvgpr_read_b32 v186, a46
v_accvgpr_read_b32 v187, a47
v_mul_f32 v180, v180, v174
v_mul_f32 v181, v181, v174
v_mul_f32 v182, v182, v174
v_mul_f32 v183, v183, v174
v_mul_f32 v184, v184, v174
v_mul_f32 v185, v185, v174
v_mul_f32 v186, v186, v174
v_mul_f32 v187, v187, v174
v_accvgpr_write_b32 a40, v180
v_accvgpr_write_b32 a41, v181
v_accvgpr_write_b32 a42, v182
v_accvgpr_write_b32 a43, v183
v_accvgpr_write_b32 a44, v184
v_accvgpr_write_b32 a45, v185
v_accvgpr_write_b32 a46, v186
v_accvgpr_write_b32 a47, v187
v_accvgpr_read_b32 v180, a48
v_accvgpr_read_b32 v181, a49
v_accvgpr_read_b32 v182, a50
v_accvgpr_read_b32 v183, a51
v_accvgpr_read_b32 v184, a52
v_accvgpr_read_b32 v185, a53
v_accvgpr_read_b32 v186, a54
v_accvgpr_read_b32 v187, a55
v_mul_f32 v180, v180, v174
v_mul_f32 v181, v181, v174
v_mul_f32 v182, v182, v174
v_mul_f32 v183, v183, v174
v_mul_f32 v184, v184, v174
v_mul_f32 v185, v185, v174
v_mul_f32 v186, v186, v174
v_mul_f32 v187, v187, v174
v_accvgpr_write_b32 a48, v180
v_accvgpr_write_b32 a49, v181
v_accvgpr_write_b32 a50, v182
v_accvgpr_write_b32 a51, v183
v_accvgpr_write_b32 a52, v184
v_accvgpr_write_b32 a53, v185
v_accvgpr_write_b32 a54, v186
v_accvgpr_write_b32 a55, v187
v_accvgpr_read_b32 v180, a56
v_accvgpr_read_b32 v181, a57
v_accvgpr_read_b32 v182, a58
v_accvgpr_read_b32 v183, a59
v_accvgpr_read_b32 v184, a60
v_accvgpr_read_b32 v185, a61
v_accvgpr_read_b32 v186, a62
v_accvgpr_read_b32 v187, a63
v_mul_f32 v180, v180, v174
v_mul_f32 v181, v181, v174
v_mul_f32 v182, v182, v174
v_mul_f32 v183, v183, v174
v_mul_f32 v184, v184, v174
v_mul_f32 v185, v185, v174
v_mul_f32 v186, v186, v174
v_mul_f32 v187, v187, v174
v_accvgpr_write_b32 a56, v180
v_accvgpr_write_b32 a57, v181
v_accvgpr_write_b32 a58, v182
v_accvgpr_write_b32 a59, v183
v_accvgpr_write_b32 a60, v184
v_accvgpr_write_b32 a61, v185
v_accvgpr_write_b32 a62, v186
v_accvgpr_write_b32 a63, v187
LS_nors:
s_waitcnt lgkmcnt(0)
s_nop 1
v_mfma_f32_16x16x32_bf16 a[0:3], v[96:99], v[168:171], a[0:3]
v_mfma_f32_16x16x32_bf16 a[4:7], v[100:103], v[168:171], a[4:7]
v_mfma_f32_16x16x32_bf16 a[8:11], v[104:107], v[168:171], a[8:11]
v_mfma_f32_16x16x32_bf16 a[12:15], v[108:111], v[168:171], a[12:15]
v_mfma_f32_16x16x32_bf16 a[16:19], v[112:115], v[168:171], a[16:19]
v_mfma_f32_16x16x32_bf16 a[20:23], v[116:119], v[168:171], a[20:23]
v_mfma_f32_16x16x32_bf16 a[24:27], v[120:123], v[168:171], a[24:27]
v_mfma_f32_16x16x32_bf16 a[28:31], v[124:127], v[168:171], a[28:31]
v_mfma_f32_16x16x32_bf16 a[32:35], v[128:131], v[168:171], a[32:35]
v_mfma_f32_16x16x32_bf16 a[36:39], v[132:135], v[168:171], a[36:39]
v_mfma_f32_16x16x32_bf16 a[40:43], v[136:139], v[168:171], a[40:43]
v_mfma_f32_16x16x32_bf16 a[44:47], v[140:143], v[168:171], a[44:47]
v_mfma_f32_16x16x32_bf16 a[48:51], v[144:147], v[168:171], a[48:51]
v_mfma_f32_16x16x32_bf16 a[52:55], v[148:151], v[168:171], a[52:55]
v_mfma_f32_16x16x32_bf16 a[56:59], v[152:155], v[168:171], a[56:59]
v_mfma_f32_16x16x32_bf16 a[60:63], v[156:159], v[168:171], a[60:63]
s_sub_u32 s51, s51, 1
s_cmp_lg_u32 s51, 0
s_cbranch_scc1 LS_loop
s_nop 15
v_accvgpr_read_b32 v173, a0
v_accvgpr_read_b32 v180, a0
v_accvgpr_read_b32 v181, a1
v_accvgpr_read_b32 v182, a2
v_accvgpr_read_b32 v183, a3
v_accvgpr_read_b32 v184, a4
v_accvgpr_read_b32 v185, a5
v_accvgpr_read_b32 v186, a6
v_accvgpr_read_b32 v187, a7
v_cvt_pk_bf16_f32 v32, v180, v181
v_cvt_pk_bf16_f32 v33, v182, v183
v_cvt_pk_bf16_f32 v34, v184, v185
v_cvt_pk_bf16_f32 v35, v186, v187
buffer_store_dwordx4 v[32:35], v252, s[20:23], s40 offen offset:0 sc1
v_accvgpr_read_b32 v180, a8
v_accvgpr_read_b32 v181, a9
v_accvgpr_read_b32 v182, a10
v_accvgpr_read_b32 v183, a11
v_accvgpr_read_b32 v184, a12
v_accvgpr_read_b32 v185, a13
v_accvgpr_read_b32 v186, a14
v_accvgpr_read_b32 v187, a15
v_cvt_pk_bf16_f32 v36, v180, v181
v_cvt_pk_bf16_f32 v37, v182, v183
v_cvt_pk_bf16_f32 v38, v184, v185
v_cvt_pk_bf16_f32 v39, v186, v187
buffer_store_dwordx4 v[36:39], v252, s[20:23], s40 offen offset:1024 sc1
v_accvgpr_read_b32 v180, a16
v_accvgpr_read_b32 v181, a17
v_accvgpr_read_b32 v182, a18
v_accvgpr_read_b32 v183, a19
v_accvgpr_read_b32 v184, a20
v_accvgpr_read_b32 v185, a21
v_accvgpr_read_b32 v186, a22
v_accvgpr_read_b32 v187, a23
v_cvt_pk_bf16_f32 v40, v180, v181
v_cvt_pk_bf16_f32 v41, v182, v183
v_cvt_pk_bf16_f32 v42, v184, v185
v_cvt_pk_bf16_f32 v43, v186, v187
buffer_store_dwordx4 v[40:43], v252, s[20:23], s40 offen offset:2048 sc1
v_accvgpr_read_b32 v180, a24
v_accvgpr_read_b32 v181, a25
v_accvgpr_read_b32 v182, a26
v_accvgpr_read_b32 v183, a27
v_accvgpr_read_b32 v184, a28
v_accvgpr_read_b32 v185, a29
v_accvgpr_read_b32 v186, a30
v_accvgpr_read_b32 v187, a31
v_cvt_pk_bf16_f32 v44, v180, v181
v_cvt_pk_bf16_f32 v45, v182, v183
v_cvt_pk_bf16_f32 v46, v184, v185
v_cvt_pk_bf16_f32 v47, v186, v187
buffer_store_dwordx4 v[44:47], v252, s[20:23], s40 offen offset:3072 sc1
v_accvgpr_read_b32 v180, a32
v_accvgpr_read_b32 v181, a33
v_accvgpr_read_b32 v182, a34
v_accvgpr_read_b32 v183, a35
v_accvgpr_read_b32 v184, a36
v_accvgpr_read_b32 v185, a37
v_accvgpr_read_b32 v186, a38
v_accvgpr_read_b32 v187, a39
v_cvt_pk_bf16_f32 v48, v180, v181
v_cvt_pk_bf16_f32 v49, v182, v183
v_cvt_pk_bf16_f32 v50, v184, v185
v_cvt_pk_bf16_f32 v51, v186, v187
buffer_store_dwordx4 v[48:51], v252, s[20:23], s44 offen offset:0 sc1
v_accvgpr_read_b32 v180, a40
v_accvgpr_read_b32 v181, a41
v_accvgpr_read_b32 v182, a42
v_accvgpr_read_b32 v183, a43
v_accvgpr_read_b32 v184, a44
v_accvgpr_read_b32 v185, a45
v_accvgpr_read_b32 v186, a46
v_accvgpr_read_b32 v187, a47
v_cvt_pk_bf16_f32 v52, v180, v181
v_cvt_pk_bf16_f32 v53, v182, v183
v_cvt_pk_bf16_f32 v54, v184, v185
v_cvt_pk_bf16_f32 v55, v186, v187
buffer_store_dwordx4 v[52:55], v252, s[20:23], s44 offen offset:1024 sc1
v_accvgpr_read_b32 v180, a48
v_accvgpr_read_b32 v181, a49
v_accvgpr_read_b32 v182, a50
v_accvgpr_read_b32 v183, a51
v_accvgpr_read_b32 v184, a52
v_accvgpr_read_b32 v185, a53
v_accvgpr_read_b32 v186, a54
v_accvgpr_read_b32 v187, a55
v_cvt_pk_bf16_f32 v56, v180, v181
v_cvt_pk_bf16_f32 v57, v182, v183
v_cvt_pk_bf16_f32 v58, v184, v185
v_cvt_pk_bf16_f32 v59, v186, v187
buffer_store_dwordx4 v[56:59], v252, s[20:23], s44 offen offset:2048 sc1
v_accvgpr_read_b32 v180, a56
v_accvgpr_read_b32 v181, a57
v_accvgpr_read_b32 v182, a58
v_accvgpr_read_b32 v183, a59
v_accvgpr_read_b32 v184, a60
v_accvgpr_read_b32 v185, a61
v_accvgpr_read_b32 v186, a62
v_accvgpr_read_b32 v187, a63
v_cvt_pk_bf16_f32 v60, v180, v181
v_cvt_pk_bf16_f32 v61, v182, v183
v_cvt_pk_bf16_f32 v62, v184, v185
v_cvt_pk_bf16_f32 v63, v186, v187
buffer_store_dwordx4 v[60:63], v252, s[20:23], s44 offen offset:3072 sc1
v_lshlrev_b32 v175, 2, v252
s_mov_b64 exec, 0xffff
buffer_store_dwordx2 v[172:173], v175, s[24:27], s48 offen sc1
s_mov_b64 exec, -1
s_waitcnt vmcnt(0)
s_add_u32 s40, s40, 8192
s_add_u32 s48, s48, 1024
s_sub_u32 s55, s55, 1
s_cmp_lg_u32 s55, 0
s_cbranch_scc1 LS_q
LC_slowend:
s_barrier
s_add_u32 s56, s4, 0x1000000
s_addc_u32 s57, s5, 0
s_mov_b32 s58, 0x6c02000
s_mov_b32 s59, 0x00020000
s_mov_b32 s99, 0
s_mov_b64 vcc, 0
s_branch LC_start
LT_disp:
s_cmp_eq_u32 s34, 0
s_cbranch_scc1 LT_start
s_mov_b32 s41, s34
s_mul_i32 s40, s34, 6
s_add_u32 s40, s40, s37
s_add_u32 s40, s40, 42
s_cmp_lt_u32 s40, 60
s_cbranch_scc1 LE_common
s_branch L2_end
LT_start:
s_waitcnt lgkmcnt(0)
s_add_u32 s12, s4, 0x6800000
s_addc_u32 s13, s5, 0
s_mov_b32 s14, s49
s_mov_b32 s15, 0x00020000
s_add_u32 s8, s4, 0x0
s_addc_u32 s9, s5, 0
s_mov_b32 s10, 0x4e4000
s_mov_b32 s11, 0x00020000
s_mul_i32 s35, s37, 0x600000
s_add_u32 s20, s4, 0x2000000
s_addc_u32 s21, s5, 0
s_add_u32 s20, s20, s35
s_addc_u32 s21, s21, 0
s_mov_b32 s22, 0x4e4000
s_mov_b32 s23, 0x00020000
s_add_u32 s24, s4, 0x6000000
s_addc_u32 s25, s5, 0
s_mov_b32 s26, 0x9c800
s_mov_b32 s27, 0x00020000
s_lshl_b32 s35, s38, 4
s_lshl_b32 s41, s34, 2
s_add_u32 s35, s35, s41
s_lshl_b32 s40, s35, 13
s_lshl_b32 s48, s35, 10
s_lshl_b32 s35, s37, 3
s_add_u32 s48, s48, s35
v_bfe_u32 v248, v252, 4, 3
v_lshlrev_b32 v248, 6, v248
v_bfe_u32 v253, v252, 7, 1
v_lshl_or_b32 v248, v253, 10, v248
v_bfe_u32 v253, v252, 8, 2
v_lshl_or_b32 v248, v253, 4, v248
v_bfe_u32 v253, v252, 6, 1
v_lshlrev_b32 v253, 5, v253
v_xor_b32 v248, v248, v253
v_and_b32 v249, 0x1c0, v252
v_bfe_u32 v253, v252, 9, 1
v_lshl_or_b32 v249, v253, 10, v249
v_bfe_u32 v253, v252, 8, 1
v_lshl_or_b32 v249, v253, 5, v249
v_bfe_u32 v253, v252, 4, 2
v_lshl_or_b32 v249, v253, 3, v249
v_xor_b32 v250, 32, v249
s_mov_b32 s56, 90112
s_add_u32 s57, s56, 65536
s_mov_b32 s55, 1
v_bfe_i32 v188, v252, 8, 1
LT_q:
s_add_u32 s44, s40, 4096
buffer_load_dwordx4 v[0:3], v252, s[8:11], s40 offen offset:0
buffer_load_dwordx4 v[4:7], v252, s[8:11], s40 offen offset:1024
buffer_load_dwordx4 v[8:11], v252, s[8:11], s40 offen offset:2048
buffer_load_dwordx4 v[12:15], v252, s[8:11], s40 offen offset:3072
buffer_load_dwordx4 v[16:19], v252, s[8:11], s44 offen offset:0
buffer_load_dwordx4 v[20:23], v252, s[8:11], s44 offen offset:1024
buffer_load_dwordx4 v[24:27], v252, s[8:11], s44 offen offset:2048
buffer_load_dwordx4 v[28:31], v252, s[8:11], s44 offen offset:3072
s_mov_b32 s53, s56
s_mov_b32 s58, s39
s_add_u32 m0, s53, 0
s_add_u32 s54, s58, 0
buffer_load_dwordx4 v251, s[12:15], s54 offen offset:0 lds
buffer_load_dwordx4 v251, s[12:15], s54 offen offset:1024 lds
buffer_load_dwordx4 v251, s[12:15], s54 offen offset:2048 lds
buffer_load_dwordx4 v251, s[12:15], s54 offen offset:3072 lds
s_add_u32 m0, s53, 4096
s_add_u32 s54, s58, 128
buffer_load_dwordx4 v251, s[12:15], s54 offen offset:0 lds
buffer_load_dwordx4 v251, s[12:15], s54 offen offset:1024 lds
buffer_load_dwordx4 v251, s[12:15], s54 offen offset:2048 lds
buffer_load_dwordx4 v251, s[12:15], s54 offen offset:3072 lds
s_add_u32 m0, s53, 8192
s_add_u32 s54, s58, 256
buffer_load_dwordx4 v251, s[12:15], s54 offen offset:0 lds
buffer_load_dwordx4 v251, s[12:15], s54 offen offset:1024 lds
buffer_load_dwordx4 v251, s[12:15], s54 offen offset:2048 lds
buffer_load_dwordx4 v251, s[12:15], s54 offen offset:3072 lds
s_add_u32 m0, s53, 12288
s_add_u32 s54, s58, 384
buffer_load_dwordx4 v251, s[12:15], s54 offen offset:0 lds
buffer_load_dwordx4 v251, s[12:15], s54 offen offset:1024 lds
buffer_load_dwordx4 v251, s[12:15], s54 offen offset:2048 lds
buffer_load_dwordx4 v251, s[12:15], s54 offen offset:3072 lds
s_add_u32 s53, s53, 0x4000
s_cmp_eq_u32 s53, s57
s_cselect_b32 s53, s56, s53
s_add_u32 s58, s58, 0x4000
s_add_u32 m0, s53, 0
s_add_u32 s54, s58, 0
buffer_load_dwordx4 v251, s[12:15], s54 offen offset:0 lds
buffer_load_dwordx4 v251, s[12:15], s54 offen offset:1024 lds
buffer_load_dwordx4 v251, s[12:15], s54 offen offset:2048 lds
buffer_load_dwordx4 v251, s[12:15], s54 offen offset:3072 lds
s_add_u32 m0, s53, 4096
s_add_u32 s54, s58, 128
buffer_load_dwordx4 v251, s[12:15], s54 offen offset:0 lds
buffer_load_dwordx4 v251, s[12:15], s54 offen offset:1024 lds
buffer_load_dwordx4 v251, s[12:15], s54 offen offset:2048 lds
buffer_load_dwordx4 v251, s[12:15], s54 offen offset:3072 lds
s_add_u32 m0, s53, 8192
s_add_u32 s54, s58, 256
buffer_load_dwordx4 v251, s[12:15], s54 offen offset:0 lds
buffer_load_dwordx4 v251, s[12:15], s54 offen offset:1024 lds
buffer_load_dwordx4 v251, s[12:15], s54 offen offset:2048 lds
buffer_load_dwordx4 v251, s[12:15], s54 offen offset:3072 lds
s_add_u32 m0, s53, 12288
s_add_u32 s54, s58, 384
buffer_load_dwordx4 v251, s[12:15], s54 offen offset:0 lds
buffer_load_dwordx4 v251, s[12:15], s54 offen offset:1024 lds
buffer_load_dwordx4 v251, s[12:15], s54 offen offset:2048 lds
buffer_load_dwordx4 v251, s[12:15], s54 offen offset:3072 lds
s_add_u32 s53, s53, 0x4000
s_cmp_eq_u32 s53, s57
s_cselect_b32 s53, s56, s53
s_add_u32 s58, s58, 0x4000
s_add_u32 m0, s53, 0
s_add_u32 s54, s58, 0
buffer_load_dwordx4 v251, s[12:15], s54 offen offset:0 lds
buffer_load_dwordx4 v251, s[12:15], s54 offen offset:1024 lds
buffer_load_dwordx4 v251, s[12:15], s54 offen offset:2048 lds
buffer_load_dwordx4 v251, s[12:15], s54 offen offset:3072 lds
s_add_u32 m0, s53, 4096
s_add_u32 s54, s58, 128
buffer_load_dwordx4 v251, s[12:15], s54 offen offset:0 lds
buffer_load_dwordx4 v251, s[12:15], s54 offen offset:1024 lds
buffer_load_dwordx4 v251, s[12:15], s54 offen offset:2048 lds
buffer_load_dwordx4 v251, s[12:15], s54 offen offset:3072 lds
s_add_u32 m0, s53, 8192
s_add_u32 s54, s58, 256
buffer_load_dwordx4 v251, s[12:15], s54 offen offset:0 lds
buffer_load_dwordx4 v251, s[12:15], s54 offen offset:1024 lds
buffer_load_dwordx4 v251, s[12:15], s54 offen offset:2048 lds
buffer_load_dwordx4 v251, s[12:15], s54 offen offset:3072 lds
s_add_u32 m0, s53, 12288
s_add_u32 s54, s58, 384
buffer_load_dwordx4 v251, s[12:15], s54 offen offset:0 lds
buffer_load_dwordx4 v251, s[12:15], s54 offen offset:1024 lds
buffer_load_dwordx4 v251, s[12:15], s54 offen offset:2048 lds
buffer_load_dwordx4 v251, s[12:15], s54 offen offset:3072 lds
s_add_u32 s53, s53, 0x4000
s_cmp_eq_u32 s53, s57
s_cselect_b32 s53, s56, s53
s_add_u32 s58, s58, 0x4000
s_mov_b32 s51, s29
s_mov_b32 s52, s56
v_mov_b32 v172, 0xff800000
v_accvgpr_write_b32 a0, 0
v_accvgpr_write_b32 a1, 0
v_accvgpr_write_b32 a2, 0
v_accvgpr_write_b32 a3, 0
v_accvgpr_write_b32 a4, 0
v_accvgpr_write_b32 a5, 0
v_accvgpr_write_b32 a6, 0
v_accvgpr_write_b32 a7, 0
v_accvgpr_write_b32 a8, 0
v_accvgpr_write_b32 a9, 0
v_accvgpr_write_b32 a10, 0
v_accvgpr_write_b32 a11, 0
v_accvgpr_write_b32 a12, 0
v_accvgpr_write_b32 a13, 0
v_accvgpr_write_b32 a14, 0
v_accvgpr_write_b32 a15, 0
v_accvgpr_write_b32 a16, 0
v_accvgpr_write_b32 a17, 0
v_accvgpr_write_b32 a18, 0
v_accvgpr_write_b32 a19, 0
v_accvgpr_write_b32 a20, 0
v_accvgpr_write_b32 a21, 0
v_accvgpr_write_b32 a22, 0
v_accvgpr_write_b32 a23, 0
v_accvgpr_write_b32 a24, 0
v_accvgpr_write_b32 a25, 0
v_accvgpr_write_b32 a26, 0
v_accvgpr_write_b32 a27, 0
v_accvgpr_write_b32 a28, 0
v_accvgpr_write_b32 a29, 0
v_accvgpr_write_b32 a30, 0
v_accvgpr_write_b32 a31, 0
v_accvgpr_write_b32 a32, 0
v_accvgpr_write_b32 a33, 0
v_accvgpr_write_b32 a34, 0
v_accvgpr_write_b32 a35, 0
v_accvgpr_write_b32 a36, 0
v_accvgpr_write_b32 a37, 0
v_accvgpr_write_b32 a38, 0
v_accvgpr_write_b32 a39, 0
v_accvgpr_write_b32 a40, 0
v_accvgpr_write_b32 a41, 0
v_accvgpr_write_b32 a42, 0
v_accvgpr_write_b32 a43, 0
v_accvgpr_write_b32 a44, 0
v_accvgpr_write_b32 a45, 0
v_accvgpr_write_b32 a46, 0
v_accvgpr_write_b32 a47, 0
v_accvgpr_write_b32 a48, 0
v_accvgpr_write_b32 a49, 0
v_accvgpr_write_b32 a50, 0
v_accvgpr_write_b32 a51, 0
v_accvgpr_write_b32 a52, 0
v_accvgpr_write_b32 a53, 0
v_accvgpr_write_b32 a54, 0
v_accvgpr_write_b32 a55, 0
v_accvgpr_write_b32 a56, 0
v_accvgpr_write_b32 a57, 0
v_accvgpr_write_b32 a58, 0
v_accvgpr_write_b32 a59, 0
v_accvgpr_write_b32 a60, 0
v_accvgpr_write_b32 a61, 0
v_accvgpr_write_b32 a62, 0
v_accvgpr_write_b32 a63, 0
LT_loop:
s_add_u32 m0, s53, 0
s_add_u32 s54, s58, 0
buffer_load_dwordx4 v251, s[12:15], s54 offen offset:0 lds
buffer_load_dwordx4 v251, s[12:15], s54 offen offset:1024 lds
buffer_load_dwordx4 v251, s[12:15], s54 offen offset:2048 lds
buffer_load_dwordx4 v251, s[12:15], s54 offen offset:3072 lds
s_add_u32 m0, s53, 4096
s_add_u32 s54, s58, 128
buffer_load_dwordx4 v251, s[12:15], s54 offen offset:0 lds
buffer_load_dwordx4 v251, s[12:15], s54 offen offset:1024 lds
buffer_load_dwordx4 v251, s[12:15], s54 offen offset:2048 lds
buffer_load_dwordx4 v251, s[12:15], s54 offen offset:3072 lds
s_add_u32 m0, s53, 8192
s_add_u32 s54, s58, 256
buffer_load_dwordx4 v251, s[12:15], s54 offen offset:0 lds
buffer_load_dwordx4 v251, s[12:15], s54 offen offset:1024 lds
buffer_load_dwordx4 v251, s[12:15], s54 offen offset:2048 lds
buffer_load_dwordx4 v251, s[12:15], s54 offen offset:3072 lds
s_add_u32 m0, s53, 12288
s_add_u32 s54, s58, 384
buffer_load_dwordx4 v251, s[12:15], s54 offen offset:0 lds
buffer_load_dwordx4 v251, s[12:15], s54 offen offset:1024 lds
buffer_load_dwordx4 v251, s[12:15], s54 offen offset:2048 lds
buffer_load_dwordx4 v251, s[12:15], s54 offen offset:3072 lds
s_add_u32 s53, s53, 0x4000
s_cmp_eq_u32 s53, s57
s_cselect_b32 s53, s56, s53
s_add_u32 s58, s58, 0x4000
v_add_u32 v177, s52, v248
v_add_u32 v178, s52, v249
v_add_u32 v179, s52, v250
s_add_u32 s52, s52, 0x4000
s_cmp_eq_u32 s52, s57
s_cselect_b32 s52, s56, s52
s_cmp_eq_u32 s51, 1
s_cselect_b32 s54, s33, 0
v_and_b32 v192, s54, v188
v_and_b32 v193, s54, v188
v_and_b32 v194, s54, v188
v_and_b32 v195, s54, v188
s_waitcnt vmcnt(48)
ds_read_b128 v[32:35], v177 offset:0
ds_read_b128 v[64:67], v177 offset:2048
ds_read_b128 v[36:39], v177 offset:512
ds_read_b128 v[68:71], v177 offset:2560
ds_read_b128 v[40:43], v177 offset:4096
ds_read_b128 v[72:75], v177 offset:6144
ds_read_b128 v[44:47], v177 offset:4608
ds_read_b128 v[76:79], v177 offset:6656
ds_read_b128 v[48:51], v177 offset:8192
ds_read_b128 v[80:83], v177 offset:10240
ds_read_b128 v[52:55], v177 offset:8704
ds_read_b128 v[84:87], v177 offset:10752
ds_read_b128 v[56:59], v177 offset:12288
ds_read_b128 v[88:91], v177 offset:14336
ds_read_b128 v[60:63], v177 offset:12800
ds_read_b128 v[92:95], v177 offset:14848
s_waitcnt lgkmcnt(14)
v_mfma_f32_16x16x32_bf16 v[160:163], v[32:35], v[0:3], v[192:195]
v_mfma_f32_16x16x32_bf16 v[164:167], v[64:67], v[0:3], v[192:195]
s_waitcnt lgkmcnt(12)
v_mfma_f32_16x16x32_bf16 v[160:163], v[36:39], v[4:7], v[160:163]
v_mfma_f32_16x16x32_bf16 v[164:167], v[68:71], v[4:7], v[164:167]
s_waitcnt lgkmcnt(10)
v_mfma_f32_16x16x32_bf16 v[160:163], v[40:43], v[8:11], v[160:163]
v_mfma_f32_16x16x32_bf16 v[164:167], v[72:75], v[8:11], v[164:167]
s_waitcnt lgkmcnt(8)
v_mfma_f32_16x16x32_bf16 v[160:163], v[44:47], v[12:15], v[160:163]
v_mfma_f32_16x16x32_bf16 v[164:167], v[76:79], v[12:15], v[164:167]
s_waitcnt lgkmcnt(6)
v_mfma_f32_16x16x32_bf16 v[160:163], v[48:51], v[16:19], v[160:163]
v_mfma_f32_16x16x32_bf16 v[164:167], v[80:83], v[16:19], v[164:167]
s_waitcnt lgkmcnt(4)
v_mfma_f32_16x16x32_bf16 v[160:163], v[52:55], v[20:23], v[160:163]
v_mfma_f32_16x16x32_bf16 v[164:167], v[84:87], v[20:23], v[164:167]
s_waitcnt lgkmcnt(2)
v_mfma_f32_16x16x32_bf16 v[160:163], v[56:59], v[24:27], v[160:163]
v_mfma_f32_16x16x32_bf16 v[164:167], v[88:91], v[24:27], v[164:167]
s_waitcnt lgkmcnt(0)
v_mfma_f32_16x16x32_bf16 v[160:163], v[60:63], v[28:31], v[160:163]
v_mfma_f32_16x16x32_bf16 v[164:167], v[92:95], v[28:31], v[164:167]
ds_read_b64_tr_b16 v[96:97], v178 offset:0
ds_read_b64_tr_b16 v[98:99], v178 offset:2048
ds_read_b64_tr_b16 v[100:101], v179 offset:0
ds_read_b64_tr_b16 v[102:103], v179 offset:2048
ds_read_b64_tr_b16 v[104:105], v178 offset:512
ds_read_b64_tr_b16 v[106:107], v178 offset:2560
ds_read_b64_tr_b16 v[108:109], v179 offset:512
ds_read_b64_tr_b16 v[110:111], v179 offset:2560
ds_read_b64_tr_b16 v[112:113], v178 offset:4096
ds_read_b64_tr_b16 v[114:115], v178 offset:6144
ds_read_b64_tr_b16 v[116:117], v179 offset:4096
ds_read_b64_tr_b16 v[118:119], v179 offset:6144
ds_read_b64_tr_b16 v[120:121], v178 offset:4608
ds_read_b64_tr_b16 v[122:123], v178 offset:6656
ds_read_b64_tr_b16 v[124:125], v179 offset:4608
ds_read_b64_tr_b16 v[126:127], v179 offset:6656
ds_read_b64_tr_b16 v[128:129], v178 offset:8192
ds_read_b64_tr_b16 v[130:131], v178 offset:10240
ds_read_b64_tr_b16 v[132:133], v179 offset:8192
ds_read_b64_tr_b16 v[134:135], v179 offset:10240
ds_read_b64_tr_b16 v[136:137], v178 offset:8704
ds_read_b64_tr_b16 v[138:139], v178 offset:10752
ds_read_b64_tr_b16 v[140:141], v179 offset:8704
ds_read_b64_tr_b16 v[142:143], v179 offset:10752
ds_read_b64_tr_b16 v[144:145], v178 offset:12288
ds_read_b64_tr_b16 v[146:147], v178 offset:14336
ds_read_b64_tr_b16 v[148:149], v179 offset:12288
ds_read_b64_tr_b16 v[150:151], v179 offset:14336
ds_read_b64_tr_b16 v[152:153], v178 offset:12800
ds_read_b64_tr_b16 v[154:155], v178 offset:14848
ds_read_b64_tr_b16 v[156:157], v179 offset:12800
ds_read_b64_tr_b16 v[158:159], v179 offset:14848
s_nop 7
v_max3_f32 v175, v160, v161, v162
v_max3_f32 v175, v175, v163, v164
v_max3_f32 v175, v175, v165, v166
v_max3_f32 v175, v175, v167, v172
v_mov_b32 v176, v175
s_nop 1
v_permlane32_swap_b32 v175, v176
s_nop 1
v_max_f32 v175, v175, v176
v_mov_b32 v176, v175
s_nop 1
v_permlane16_swap_b32 v175, v176
s_nop 1
v_max_f32 v175, v175, v176
v_sub_f32 v174, v172, v175
v_exp_f32 v174, v174
v_mov_b32 v172, v175
v_sub_f32 v160, v160, v172
v_sub_f32 v161, v161, v172
v_sub_f32 v162, v162, v172
v_sub_f32 v163, v163, v172
v_sub_f32 v164, v164, v172
v_sub_f32 v165, v165, v172
v_sub_f32 v166, v166, v172
v_sub_f32 v167, v167, v172
v_exp_f32 v160, v160
v_exp_f32 v161, v161
v_exp_f32 v162, v162
v_exp_f32 v163, v163
v_exp_f32 v164, v164
v_exp_f32 v165, v165
v_exp_f32 v166, v166
v_exp_f32 v167, v167
v_cmp_neq_f32 vcc, 1.0, v174
v_cvt_pk_bf16_f32 v168, v160, v161
v_cvt_pk_bf16_f32 v169, v162, v163
v_cvt_pk_bf16_f32 v170, v164, v165
v_cvt_pk_bf16_f32 v171, v166, v167
s_cbranch_vccz LT_nors
v_accvgpr_read_b32 v180, a0
v_accvgpr_read_b32 v181, a1
v_accvgpr_read_b32 v182, a2
v_accvgpr_read_b32 v183, a3
v_accvgpr_read_b32 v184, a4
v_accvgpr_read_b32 v185, a5
v_accvgpr_read_b32 v186, a6
v_accvgpr_read_b32 v187, a7
v_mul_f32 v180, v180, v174
v_mul_f32 v181, v181, v174
v_mul_f32 v182, v182, v174
v_mul_f32 v183, v183, v174
v_mul_f32 v184, v184, v174
v_mul_f32 v185, v185, v174
v_mul_f32 v186, v186, v174
v_mul_f32 v187, v187, v174
v_accvgpr_write_b32 a0, v180
v_accvgpr_write_b32 a1, v181
v_accvgpr_write_b32 a2, v182
v_accvgpr_write_b32 a3, v183
v_accvgpr_write_b32 a4, v184
v_accvgpr_write_b32 a5, v185
v_accvgpr_write_b32 a6, v186
v_accvgpr_write_b32 a7, v187
v_accvgpr_read_b32 v180, a8
v_accvgpr_read_b32 v181, a9
v_accvgpr_read_b32 v182, a10
v_accvgpr_read_b32 v183, a11
v_accvgpr_read_b32 v184, a12
v_accvgpr_read_b32 v185, a13
v_accvgpr_read_b32 v186, a14
v_accvgpr_read_b32 v187, a15
v_mul_f32 v180, v180, v174
v_mul_f32 v181, v181, v174
v_mul_f32 v182, v182, v174
v_mul_f32 v183, v183, v174
v_mul_f32 v184, v184, v174
v_mul_f32 v185, v185, v174
v_mul_f32 v186, v186, v174
v_mul_f32 v187, v187, v174
v_accvgpr_write_b32 a8, v180
v_accvgpr_write_b32 a9, v181
v_accvgpr_write_b32 a10, v182
v_accvgpr_write_b32 a11, v183
v_accvgpr_write_b32 a12, v184
v_accvgpr_write_b32 a13, v185
v_accvgpr_write_b32 a14, v186
v_accvgpr_write_b32 a15, v187
v_accvgpr_read_b32 v180, a16
v_accvgpr_read_b32 v181, a17
v_accvgpr_read_b32 v182, a18
v_accvgpr_read_b32 v183, a19
v_accvgpr_read_b32 v184, a20
v_accvgpr_read_b32 v185, a21
v_accvgpr_read_b32 v186, a22
v_accvgpr_read_b32 v187, a23
v_mul_f32 v180, v180, v174
v_mul_f32 v181, v181, v174
v_mul_f32 v182, v182, v174
v_mul_f32 v183, v183, v174
v_mul_f32 v184, v184, v174
v_mul_f32 v185, v185, v174
v_mul_f32 v186, v186, v174
v_mul_f32 v187, v187, v174
v_accvgpr_write_b32 a16, v180
v_accvgpr_write_b32 a17, v181
v_accvgpr_write_b32 a18, v182
v_accvgpr_write_b32 a19, v183
v_accvgpr_write_b32 a20, v184
v_accvgpr_write_b32 a21, v185
v_accvgpr_write_b32 a22, v186
v_accvgpr_write_b32 a23, v187
v_accvgpr_read_b32 v180, a24
v_accvgpr_read_b32 v181, a25
v_accvgpr_read_b32 v182, a26
v_accvgpr_read_b32 v183, a27
v_accvgpr_read_b32 v184, a28
v_accvgpr_read_b32 v185, a29
v_accvgpr_read_b32 v186, a30
v_accvgpr_read_b32 v187, a31
v_mul_f32 v180, v180, v174
v_mul_f32 v181, v181, v174
v_mul_f32 v182, v182, v174
v_mul_f32 v183, v183, v174
v_mul_f32 v184, v184, v174
v_mul_f32 v185, v185, v174
v_mul_f32 v186, v186, v174
v_mul_f32 v187, v187, v174
v_accvgpr_write_b32 a24, v180
v_accvgpr_write_b32 a25, v181
v_accvgpr_write_b32 a26, v182
v_accvgpr_write_b32 a27, v183
v_accvgpr_write_b32 a28, v184
v_accvgpr_write_b32 a29, v185
v_accvgpr_write_b32 a30, v186
v_accvgpr_write_b32 a31, v187
v_accvgpr_read_b32 v180, a32
v_accvgpr_read_b32 v181, a33
v_accvgpr_read_b32 v182, a34
v_accvgpr_read_b32 v183, a35
v_accvgpr_read_b32 v184, a36
v_accvgpr_read_b32 v185, a37
v_accvgpr_read_b32 v186, a38
v_accvgpr_read_b32 v187, a39
v_mul_f32 v180, v180, v174
v_mul_f32 v181, v181, v174
v_mul_f32 v182, v182, v174
v_mul_f32 v183, v183, v174
v_mul_f32 v184, v184, v174
v_mul_f32 v185, v185, v174
v_mul_f32 v186, v186, v174
v_mul_f32 v187, v187, v174
v_accvgpr_write_b32 a32, v180
v_accvgpr_write_b32 a33, v181
v_accvgpr_write_b32 a34, v182
v_accvgpr_write_b32 a35, v183
v_accvgpr_write_b32 a36, v184
v_accvgpr_write_b32 a37, v185
v_accvgpr_write_b32 a38, v186
v_accvgpr_write_b32 a39, v187
v_accvgpr_read_b32 v180, a40
v_accvgpr_read_b32 v181, a41
v_accvgpr_read_b32 v182, a42
v_accvgpr_read_b32 v183, a43
v_accvgpr_read_b32 v184, a44
v_accvgpr_read_b32 v185, a45
v_accvgpr_read_b32 v186, a46
v_accvgpr_read_b32 v187, a47
v_mul_f32 v180, v180, v174
v_mul_f32 v181, v181, v174
v_mul_f32 v182, v182, v174
v_mul_f32 v183, v183, v174
v_mul_f32 v184, v184, v174
v_mul_f32 v185, v185, v174
v_mul_f32 v186, v186, v174
v_mul_f32 v187, v187, v174
v_accvgpr_write_b32 a40, v180
v_accvgpr_write_b32 a41, v181
v_accvgpr_write_b32 a42, v182
v_accvgpr_write_b32 a43, v183
v_accvgpr_write_b32 a44, v184
v_accvgpr_write_b32 a45, v185
v_accvgpr_write_b32 a46, v186
v_accvgpr_write_b32 a47, v187
v_accvgpr_read_b32 v180, a48
v_accvgpr_read_b32 v181, a49
v_accvgpr_read_b32 v182, a50
v_accvgpr_read_b32 v183, a51
v_accvgpr_read_b32 v184, a52
v_accvgpr_read_b32 v185, a53
v_accvgpr_read_b32 v186, a54
v_accvgpr_read_b32 v187, a55
v_mul_f32 v180, v180, v174
v_mul_f32 v181, v181, v174
v_mul_f32 v182, v182, v174
v_mul_f32 v183, v183, v174
v_mul_f32 v184, v184, v174
v_mul_f32 v185, v185, v174
v_mul_f32 v186, v186, v174
v_mul_f32 v187, v187, v174
v_accvgpr_write_b32 a48, v180
v_accvgpr_write_b32 a49, v181
v_accvgpr_write_b32 a50, v182
v_accvgpr_write_b32 a51, v183
v_accvgpr_write_b32 a52, v184
v_accvgpr_write_b32 a53, v185
v_accvgpr_write_b32 a54, v186
v_accvgpr_write_b32 a55, v187
v_accvgpr_read_b32 v180, a56
v_accvgpr_read_b32 v181, a57
v_accvgpr_read_b32 v182, a58
v_accvgpr_read_b32 v183, a59
v_accvgpr_read_b32 v184, a60
v_accvgpr_read_b32 v185, a61
v_accvgpr_read_b32 v186, a62
v_accvgpr_read_b32 v187, a63
v_mul_f32 v180, v180, v174
v_mul_f32 v181, v181, v174
v_mul_f32 v182, v182, v174
v_mul_f32 v183, v183, v174
v_mul_f32 v184, v184, v174
v_mul_f32 v185, v185, v174
v_mul_f32 v186, v186, v174
v_mul_f32 v187, v187, v174
v_accvgpr_write_b32 a56, v180
v_accvgpr_write_b32 a57, v181
v_accvgpr_write_b32 a58, v182
v_accvgpr_write_b32 a59, v183
v_accvgpr_write_b32 a60, v184
v_accvgpr_write_b32 a61, v185
v_accvgpr_write_b32 a62, v186
v_accvgpr_write_b32 a63, v187
LT_nors:
s_waitcnt lgkmcnt(0)
s_nop 1
v_mfma_f32_16x16x32_bf16 a[0:3], v[96:99], v[168:171], a[0:3]
v_mfma_f32_16x16x32_bf16 a[4:7], v[100:103], v[168:171], a[4:7]
v_mfma_f32_16x16x32_bf16 a[8:11], v[104:107], v[168:171], a[8:11]
v_mfma_f32_16x16x32_bf16 a[12:15], v[108:111], v[168:171], a[12:15]
v_mfma_f32_16x16x32_bf16 a[16:19], v[112:115], v[168:171], a[16:19]
v_mfma_f32_16x16x32_bf16 a[20:23], v[116:119], v[168:171], a[20:23]
v_mfma_f32_16x16x32_bf16 a[24:27], v[120:123], v[168:171], a[24:27]
v_mfma_f32_16x16x32_bf16 a[28:31], v[124:127], v[168:171], a[28:31]
v_mfma_f32_16x16x32_bf16 a[32:35], v[128:131], v[168:171], a[32:35]
v_mfma_f32_16x16x32_bf16 a[36:39], v[132:135], v[168:171], a[36:39]
v_mfma_f32_16x16x32_bf16 a[40:43], v[136:139], v[168:171], a[40:43]
v_mfma_f32_16x16x32_bf16 a[44:47], v[140:143], v[168:171], a[44:47]
v_mfma_f32_16x16x32_bf16 a[48:51], v[144:147], v[168:171], a[48:51]
v_mfma_f32_16x16x32_bf16 a[52:55], v[148:151], v[168:171], a[52:55]
v_mfma_f32_16x16x32_bf16 a[56:59], v[152:155], v[168:171], a[56:59]
v_mfma_f32_16x16x32_bf16 a[60:63], v[156:159], v[168:171], a[60:63]
s_sub_u32 s51, s51, 1
s_cmp_lg_u32 s51, 0
s_cbranch_scc1 LT_loop
s_nop 15
v_accvgpr_read_b32 v173, a0
v_accvgpr_read_b32 v180, a0
v_accvgpr_read_b32 v181, a1
v_accvgpr_read_b32 v182, a2
v_accvgpr_read_b32 v183, a3
v_accvgpr_read_b32 v184, a4
v_accvgpr_read_b32 v185, a5
v_accvgpr_read_b32 v186, a6
v_accvgpr_read_b32 v187, a7
v_cvt_pk_bf16_f32 v32, v180, v181
v_cvt_pk_bf16_f32 v33, v182, v183
v_cvt_pk_bf16_f32 v34, v184, v185
v_cvt_pk_bf16_f32 v35, v186, v187
buffer_store_dwordx4 v[32:35], v252, s[20:23], s40 offen offset:0 sc1
v_accvgpr_read_b32 v180, a8
v_accvgpr_read_b32 v181, a9
v_accvgpr_read_b32 v182, a10
v_accvgpr_read_b32 v183, a11
v_accvgpr_read_b32 v184, a12
v_accvgpr_read_b32 v185, a13
v_accvgpr_read_b32 v186, a14
v_accvgpr_read_b32 v187, a15
v_cvt_pk_bf16_f32 v36, v180, v181
v_cvt_pk_bf16_f32 v37, v182, v183
v_cvt_pk_bf16_f32 v38, v184, v185
v_cvt_pk_bf16_f32 v39, v186, v187
buffer_store_dwordx4 v[36:39], v252, s[20:23], s40 offen offset:1024 sc1
v_accvgpr_read_b32 v180, a16
v_accvgpr_read_b32 v181, a17
v_accvgpr_read_b32 v182, a18
v_accvgpr_read_b32 v183, a19
v_accvgpr_read_b32 v184, a20
v_accvgpr_read_b32 v185, a21
v_accvgpr_read_b32 v186, a22
v_accvgpr_read_b32 v187, a23
v_cvt_pk_bf16_f32 v40, v180, v181
v_cvt_pk_bf16_f32 v41, v182, v183
v_cvt_pk_bf16_f32 v42, v184, v185
v_cvt_pk_bf16_f32 v43, v186, v187
buffer_store_dwordx4 v[40:43], v252, s[20:23], s40 offen offset:2048 sc1
v_accvgpr_read_b32 v180, a24
v_accvgpr_read_b32 v181, a25
v_accvgpr_read_b32 v182, a26
v_accvgpr_read_b32 v183, a27
v_accvgpr_read_b32 v184, a28
v_accvgpr_read_b32 v185, a29
v_accvgpr_read_b32 v186, a30
v_accvgpr_read_b32 v187, a31
v_cvt_pk_bf16_f32 v44, v180, v181
v_cvt_pk_bf16_f32 v45, v182, v183
v_cvt_pk_bf16_f32 v46, v184, v185
v_cvt_pk_bf16_f32 v47, v186, v187
buffer_store_dwordx4 v[44:47], v252, s[20:23], s40 offen offset:3072 sc1
v_accvgpr_read_b32 v180, a32
v_accvgpr_read_b32 v181, a33
v_accvgpr_read_b32 v182, a34
v_accvgpr_read_b32 v183, a35
v_accvgpr_read_b32 v184, a36
v_accvgpr_read_b32 v185, a37
v_accvgpr_read_b32 v186, a38
v_accvgpr_read_b32 v187, a39
v_cvt_pk_bf16_f32 v48, v180, v181
v_cvt_pk_bf16_f32 v49, v182, v183
v_cvt_pk_bf16_f32 v50, v184, v185
v_cvt_pk_bf16_f32 v51, v186, v187
buffer_store_dwordx4 v[48:51], v252, s[20:23], s44 offen offset:0 sc1
v_accvgpr_read_b32 v180, a40
v_accvgpr_read_b32 v181, a41
v_accvgpr_read_b32 v182, a42
v_accvgpr_read_b32 v183, a43
v_accvgpr_read_b32 v184, a44
v_accvgpr_read_b32 v185, a45
v_accvgpr_read_b32 v186, a46
v_accvgpr_read_b32 v187, a47
v_cvt_pk_bf16_f32 v52, v180, v181
v_cvt_pk_bf16_f32 v53, v182, v183
v_cvt_pk_bf16_f32 v54, v184, v185
v_cvt_pk_bf16_f32 v55, v186, v187
buffer_store_dwordx4 v[52:55], v252, s[20:23], s44 offen offset:1024 sc1
v_accvgpr_read_b32 v180, a48
v_accvgpr_read_b32 v181, a49
v_accvgpr_read_b32 v182, a50
v_accvgpr_read_b32 v183, a51
v_accvgpr_read_b32 v184, a52
v_accvgpr_read_b32 v185, a53
v_accvgpr_read_b32 v186, a54
v_accvgpr_read_b32 v187, a55
v_cvt_pk_bf16_f32 v56, v180, v181
v_cvt_pk_bf16_f32 v57, v182, v183
v_cvt_pk_bf16_f32 v58, v184, v185
v_cvt_pk_bf16_f32 v59, v186, v187
buffer_store_dwordx4 v[56:59], v252, s[20:23], s44 offen offset:2048 sc1
v_accvgpr_read_b32 v180, a56
v_accvgpr_read_b32 v181, a57
v_accvgpr_read_b32 v182, a58
v_accvgpr_read_b32 v183, a59
v_accvgpr_read_b32 v184, a60
v_accvgpr_read_b32 v185, a61
v_accvgpr_read_b32 v186, a62
v_accvgpr_read_b32 v187, a63
v_cvt_pk_bf16_f32 v60, v180, v181
v_cvt_pk_bf16_f32 v61, v182, v183
v_cvt_pk_bf16_f32 v62, v184, v185
v_cvt_pk_bf16_f32 v63, v186, v187
buffer_store_dwordx4 v[60:63], v252, s[20:23], s44 offen offset:3072 sc1
v_lshlrev_b32 v175, 2, v252
s_mov_b64 exec, 0xffff
buffer_store_dwordx2 v[172:173], v175, s[24:27], s48 offen sc1
s_mov_b64 exec, -1
s_waitcnt vmcnt(0)
s_add_u32 s40, s40, 8192
s_add_u32 s48, s48, 1024
s_sub_u32 s55, s55, 1
s_cmp_lg_u32 s55, 0
s_cbranch_scc1 LT_q
s_add_u32 s52, s4, 0x7c00000
s_addc_u32 s53, s5, 0
s_mov_b32 s54, 0x2000
s_mov_b32 s55, 0x00020000
v_mov_b32 v1, 4992
v_mov_b32 v2, 1
s_mov_b64 exec, 1
s_waitcnt vmcnt(0)
buffer_atomic_add v2, v1, s[52:55], 0 offen
s_mov_b64 exec, -1
s_branch L2_fin
LE_start:
s_cmp_ge_u32 s37, 32
s_cbranch_scc1 L2_end
v_lshrrev_b32 v1, 6, v0
s_sub_u32 s37, s37, 30
s_lshl_b32 s35, s35, 1
v_readfirstlane_b32 s41, v1
s_add_u32 s35, s35, s37
s_mul_i32 s35, s35, 3
s_add_u32 s40, s35, s41
s_cmp_ge_u32 s41, 3
s_cbranch_scc1 LC_help
LE_common:
v_and_b32 v1, 63, v0
s_mov_b32 s42, 0
s_mov_b32 s49, 512
v_lshrrev_b32 v33, 1, v1
v_and_b32 v34, 1, v1
v_mul_u32_u24 v6, 0x5000, v33
v_lshl_add_u32 v6, v34, 4, v6
v_lshlrev_b32 v33, 2, v33
s_mul_i32 s50, s40, 655360
s_mul_i32 s48, s40, 128
s_waitcnt lgkmcnt(0)
s_add_u32 s8, s4, 0x7800000
s_addc_u32 s9, s5, 0
s_mov_b32 s10, 0x2000
s_mov_b32 s11, 0x00020000
s_add_u32 s12, s4, 0x8000000
s_addc_u32 s13, s5, 0
s_mov_b32 s14, 0x2800000
s_mov_b32 s15, 0x00020000
buffer_load_dword v4, v33, s[8:11], s48 offen
buffer_load_dwordx4 v[192:195], v6, s[12:15], s50 offen offset:0
buffer_load_dwordx4 v[196:199], v6, s[12:15], s50 offen offset:32
buffer_load_dwordx4 v[200:203], v6, s[12:15], s50 offen offset:64
buffer_load_dwordx4 v[204:207], v6, s[12:15], s50 offen offset:96
buffer_load_dwordx4 v[208:211], v6, s[12:15], s50 offen offset:128
buffer_load_dwordx4 v[212:215], v6, s[12:15], s50 offen offset:160
buffer_load_dwordx4 v[216:219], v6, s[12:15], s50 offen offset:192
buffer_load_dwordx4 v[220:223], v6, s[12:15], s50 offen offset:224
buffer_load_dwordx4 v[224:227], v6, s[12:15], s50 offen offset:256
buffer_load_dwordx4 v[228:231], v6, s[12:15], s50 offen offset:288
buffer_load_dwordx4 v[232:235], v6, s[12:15], s50 offen offset:320
buffer_load_dwordx4 v[236:239], v6, s[12:15], s50 offen offset:352
buffer_load_dwordx4 v[240:243], v6, s[12:15], s50 offen offset:384
buffer_load_dwordx4 v[244:247], v6, s[12:15], s50 offen offset:416
buffer_load_dwordx4 v[248:251], v6, s[12:15], s50 offen offset:448
buffer_load_dwordx4 v[252:255], v6, s[12:15], s50 offen offset:480
s_add_u32 s16, s4, 0x6800000
s_addc_u32 s17, s5, 0
s_mov_b32 s18, 0x4e2000
s_mov_b32 s19, 0x00020000
s_add_u32 s20, s4, 0x7000000
s_addc_u32 s21, s5, 0
s_mov_b32 s22, 0x4e2000
s_mov_b32 s23, 0x00020000
v_lshlrev_b32 v5, 2, v34
v_and_b32 v2, 15, v1
v_lshrrev_b32 v3, 4, v1
v_mov_b32 v16, 1
v_mov_b32 v17, 4
v_and_b32 v33, 1, v2
v_lshlrev_b32 v33, 4, v33
v_lshlrev_b32 v33, v33, v16
v_mul_u32_u24 v33, 0x3f80, v33
v_lshrrev_b32 v34, 1, v2
v_cmp_eq_u32 vcc, 0, v34
s_nop 1
v_cndmask_b32 v40, 0, v33, vcc
v_cmp_eq_u32 vcc, 1, v34
s_nop 1
v_cndmask_b32 v41, 0, v33, vcc
v_cmp_eq_u32 vcc, 2, v34
s_nop 1
v_cndmask_b32 v42, 0, v33, vcc
v_cmp_eq_u32 vcc, 3, v34
s_nop 1
v_cndmask_b32 v43, 0, v33, vcc
v_cmp_eq_u32 vcc, 4, v34
s_nop 1
v_cndmask_b32 v44, 0, v33, vcc
v_cmp_eq_u32 vcc, 5, v34
s_nop 1
v_cndmask_b32 v45, 0, v33, vcc
v_cmp_eq_u32 vcc, 6, v34
s_nop 1
v_cndmask_b32 v46, 0, v33, vcc
v_cmp_eq_u32 vcc, 7, v34
s_nop 1
v_cndmask_b32 v47, 0, v33, vcc
v_lshlrev_b32 v39, 5, v2
v_lshl_add_u32 v39, v3, 3, v39
v_lshlrev_b32 v2, 4, v2
s_mul_i32 s48, s41, 21504
s_add_u32 s48, s48, 4096
v_mov_b32 v36, s48
v_lshl_add_u32 v38, v3, 2, v36
s_lshl_b32 s36, s41, 10
v_mov_b32 v7, s36
v_lshlrev_b32 v35, 4, v1
v_add_u32 v68, s48, v35
v_add_u32 v35, s36, v35
v_lshlrev_b32 v33, 2, v1
v_mov_b32 v72, 0xffff
v_mov_b32 v73, 0xffff
v_mov_b32 v74, 0xffff
v_mov_b32 v75, 0xffff
v_cmp_gt_u32 vcc, 167, v33
v_mov_b32 v48, 0
s_nop 0
v_cndmask_b32 v18, 0, v16, vcc
v_cmp_gt_u32 vcc, 166, v33
v_mov_b32 v49, 0
s_nop 0
v_cndmask_b32 v19, 0, v16, vcc
v_cmp_gt_u32 vcc, 165, v33
v_mov_b32 v50, 0
s_nop 0
v_cndmask_b32 v20, 0, v16, vcc
v_cmp_gt_u32 vcc, 164, v33
v_mov_b32 v51, 0
s_nop 0
v_cndmask_b32 v21, 0, v16, vcc
LE_pass:
ds_write_b128 v35, v[48:51]
ds_write_b128 v68, v[72:75] offset:0
ds_write_b128 v68, v[72:75] offset:1024
ds_write_b128 v68, v[72:75] offset:2048
ds_write_b128 v68, v[72:75] offset:3072
ds_write_b128 v68, v[72:75] offset:4096
ds_write_b128 v68, v[72:75] offset:5120
ds_write_b128 v68, v[72:75] offset:6144
ds_write_b128 v68, v[72:75] offset:7168
ds_write_b128 v68, v[72:75] offset:8192
ds_write_b128 v68, v[72:75] offset:9216
ds_write_b128 v68, v[72:75] offset:10240
ds_write_b128 v68, v[72:75] offset:11264
ds_write_b128 v68, v[72:75] offset:12288
ds_write_b128 v68, v[72:75] offset:13312
ds_write_b128 v68, v[72:75] offset:14336
ds_write_b128 v68, v[72:75] offset:15360
ds_write_b128 v68, v[72:75] offset:16384
ds_write_b128 v68, v[72:75] offset:17408
ds_write_b128 v68, v[72:75] offset:18432
ds_write_b128 v68, v[72:75] offset:19456
v_lshl_add_u32 v32, v1, 2, v36
ds_write_b32 v32, v48 offset:20480
s_waitcnt vmcnt(16)
v_sub_u32 v32, v4, v5
s_waitcnt vmcnt(15)
v_cmpx_lt_i32 vcc, 0, v32
s_cbranch_execz LE_c
v_mad_u32_u16 v128, v192, 1, v7 op_sel:[1,0,0,0]
ds_add_u32 v128, v16
v_cmpx_lt_i32 vcc, 1, v32
v_mad_u32_u16 v129, v193, 1, v7 op_sel:[1,0,0,0]
ds_add_u32 v129, v16
v_cmpx_lt_i32 vcc, 2, v32
v_mad_u32_u16 v130, v194, 1, v7 op_sel:[1,0,0,0]
ds_add_u32 v130, v16
v_cmpx_lt_i32 vcc, 3, v32
v_mad_u32_u16 v131, v195, 1, v7 op_sel:[1,0,0,0]
ds_add_u32 v131, v16
s_waitcnt vmcnt(14)
v_cmpx_lt_i32 vcc, 8, v32
s_cbranch_execz LE_c
v_mad_u32_u16 v132, v196, 1, v7 op_sel:[1,0,0,0]
ds_add_u32 v132, v16
v_cmpx_lt_i32 vcc, 9, v32
v_mad_u32_u16 v133, v197, 1, v7 op_sel:[1,0,0,0]
ds_add_u32 v133, v16
v_cmpx_lt_i32 vcc, 10, v32
v_mad_u32_u16 v134, v198, 1, v7 op_sel:[1,0,0,0]
ds_add_u32 v134, v16
v_cmpx_lt_i32 vcc, 11, v32
v_mad_u32_u16 v135, v199, 1, v7 op_sel:[1,0,0,0]
ds_add_u32 v135, v16
s_waitcnt vmcnt(13)
v_cmpx_lt_i32 vcc, 16, v32
s_cbranch_execz LE_c
v_mad_u32_u16 v136, v200, 1, v7 op_sel:[1,0,0,0]
ds_add_u32 v136, v16
v_cmpx_lt_i32 vcc, 17, v32
v_mad_u32_u16 v137, v201, 1, v7 op_sel:[1,0,0,0]
ds_add_u32 v137, v16
v_cmpx_lt_i32 vcc, 18, v32
v_mad_u32_u16 v138, v202, 1, v7 op_sel:[1,0,0,0]
ds_add_u32 v138, v16
v_cmpx_lt_i32 vcc, 19, v32
v_mad_u32_u16 v139, v203, 1, v7 op_sel:[1,0,0,0]
ds_add_u32 v139, v16
s_waitcnt vmcnt(12)
v_cmpx_lt_i32 vcc, 24, v32
s_cbranch_execz LE_c
v_mad_u32_u16 v140, v204, 1, v7 op_sel:[1,0,0,0]
ds_add_u32 v140, v16
v_cmpx_lt_i32 vcc, 25, v32
v_mad_u32_u16 v141, v205, 1, v7 op_sel:[1,0,0,0]
ds_add_u32 v141, v16
v_cmpx_lt_i32 vcc, 26, v32
v_mad_u32_u16 v142, v206, 1, v7 op_sel:[1,0,0,0]
ds_add_u32 v142, v16
v_cmpx_lt_i32 vcc, 27, v32
v_mad_u32_u16 v143, v207, 1, v7 op_sel:[1,0,0,0]
ds_add_u32 v143, v16
s_waitcnt vmcnt(11)
v_cmpx_lt_i32 vcc, 32, v32
s_cbranch_execz LE_c
v_mad_u32_u16 v144, v208, 1, v7 op_sel:[1,0,0,0]
ds_add_u32 v144, v16
v_cmpx_lt_i32 vcc, 33, v32
v_mad_u32_u16 v145, v209, 1, v7 op_sel:[1,0,0,0]
ds_add_u32 v145, v16
v_cmpx_lt_i32 vcc, 34, v32
v_mad_u32_u16 v146, v210, 1, v7 op_sel:[1,0,0,0]
ds_add_u32 v146, v16
v_cmpx_lt_i32 vcc, 35, v32
v_mad_u32_u16 v147, v211, 1, v7 op_sel:[1,0,0,0]
ds_add_u32 v147, v16
s_waitcnt vmcnt(10)
v_cmpx_lt_i32 vcc, 40, v32
s_cbranch_execz LE_c
v_mad_u32_u16 v148, v212, 1, v7 op_sel:[1,0,0,0]
ds_add_u32 v148, v16
v_cmpx_lt_i32 vcc, 41, v32
v_mad_u32_u16 v149, v213, 1, v7 op_sel:[1,0,0,0]
ds_add_u32 v149, v16
v_cmpx_lt_i32 vcc, 42, v32
v_mad_u32_u16 v150, v214, 1, v7 op_sel:[1,0,0,0]
ds_add_u32 v150, v16
v_cmpx_lt_i32 vcc, 43, v32
v_mad_u32_u16 v151, v215, 1, v7 op_sel:[1,0,0,0]
ds_add_u32 v151, v16
s_waitcnt vmcnt(9)
v_cmpx_lt_i32 vcc, 48, v32
s_cbranch_execz LE_c
v_mad_u32_u16 v152, v216, 1, v7 op_sel:[1,0,0,0]
ds_add_u32 v152, v16
v_cmpx_lt_i32 vcc, 49, v32
v_mad_u32_u16 v153, v217, 1, v7 op_sel:[1,0,0,0]
ds_add_u32 v153, v16
v_cmpx_lt_i32 vcc, 50, v32
v_mad_u32_u16 v154, v218, 1, v7 op_sel:[1,0,0,0]
ds_add_u32 v154, v16
v_cmpx_lt_i32 vcc, 51, v32
v_mad_u32_u16 v155, v219, 1, v7 op_sel:[1,0,0,0]
ds_add_u32 v155, v16
s_waitcnt vmcnt(8)
v_cmpx_lt_i32 vcc, 56, v32
s_cbranch_execz LE_c
v_mad_u32_u16 v156, v220, 1, v7 op_sel:[1,0,0,0]
ds_add_u32 v156, v16
v_cmpx_lt_i32 vcc, 57, v32
v_mad_u32_u16 v157, v221, 1, v7 op_sel:[1,0,0,0]
ds_add_u32 v157, v16
v_cmpx_lt_i32 vcc, 58, v32
v_mad_u32_u16 v158, v222, 1, v7 op_sel:[1,0,0,0]
ds_add_u32 v158, v16
v_cmpx_lt_i32 vcc, 59, v32
v_mad_u32_u16 v159, v223, 1, v7 op_sel:[1,0,0,0]
ds_add_u32 v159, v16
s_waitcnt vmcnt(7)
v_cmpx_lt_i32 vcc, 64, v32
s_cbranch_execz LE_c
v_mad_u32_u16 v160, v224, 1, v7 op_sel:[1,0,0,0]
ds_add_u32 v160, v16
v_cmpx_lt_i32 vcc, 65, v32
v_mad_u32_u16 v161, v225, 1, v7 op_sel:[1,0,0,0]
ds_add_u32 v161, v16
v_cmpx_lt_i32 vcc, 66, v32
v_mad_u32_u16 v162, v226, 1, v7 op_sel:[1,0,0,0]
ds_add_u32 v162, v16
v_cmpx_lt_i32 vcc, 67, v32
v_mad_u32_u16 v163, v227, 1, v7 op_sel:[1,0,0,0]
ds_add_u32 v163, v16
s_waitcnt vmcnt(6)
v_cmpx_lt_i32 vcc, 72, v32
s_cbranch_execz LE_c
v_mad_u32_u16 v164, v228, 1, v7 op_sel:[1,0,0,0]
ds_add_u32 v164, v16
v_cmpx_lt_i32 vcc, 73, v32
v_mad_u32_u16 v165, v229, 1, v7 op_sel:[1,0,0,0]
ds_add_u32 v165, v16
v_cmpx_lt_i32 vcc, 74, v32
v_mad_u32_u16 v166, v230, 1, v7 op_sel:[1,0,0,0]
ds_add_u32 v166, v16
v_cmpx_lt_i32 vcc, 75, v32
v_mad_u32_u16 v167, v231, 1, v7 op_sel:[1,0,0,0]
ds_add_u32 v167, v16
s_waitcnt vmcnt(5)
v_cmpx_lt_i32 vcc, 80, v32
s_cbranch_execz LE_c
v_mad_u32_u16 v168, v232, 1, v7 op_sel:[1,0,0,0]
ds_add_u32 v168, v16
v_cmpx_lt_i32 vcc, 81, v32
v_mad_u32_u16 v169, v233, 1, v7 op_sel:[1,0,0,0]
ds_add_u32 v169, v16
v_cmpx_lt_i32 vcc, 82, v32
v_mad_u32_u16 v170, v234, 1, v7 op_sel:[1,0,0,0]
ds_add_u32 v170, v16
v_cmpx_lt_i32 vcc, 83, v32
v_mad_u32_u16 v171, v235, 1, v7 op_sel:[1,0,0,0]
ds_add_u32 v171, v16
s_waitcnt vmcnt(4)
v_cmpx_lt_i32 vcc, 88, v32
s_cbranch_execz LE_c
v_mad_u32_u16 v172, v236, 1, v7 op_sel:[1,0,0,0]
ds_add_u32 v172, v16
v_cmpx_lt_i32 vcc, 89, v32
v_mad_u32_u16 v173, v237, 1, v7 op_sel:[1,0,0,0]
ds_add_u32 v173, v16
v_cmpx_lt_i32 vcc, 90, v32
v_mad_u32_u16 v174, v238, 1, v7 op_sel:[1,0,0,0]
ds_add_u32 v174, v16
v_cmpx_lt_i32 vcc, 91, v32
v_mad_u32_u16 v175, v239, 1, v7 op_sel:[1,0,0,0]
ds_add_u32 v175, v16
s_waitcnt vmcnt(3)
v_cmpx_lt_i32 vcc, 96, v32
s_cbranch_execz LE_c
v_mad_u32_u16 v176, v240, 1, v7 op_sel:[1,0,0,0]
ds_add_u32 v176, v16
v_cmpx_lt_i32 vcc, 97, v32
v_mad_u32_u16 v177, v241, 1, v7 op_sel:[1,0,0,0]
ds_add_u32 v177, v16
v_cmpx_lt_i32 vcc, 98, v32
v_mad_u32_u16 v178, v242, 1, v7 op_sel:[1,0,0,0]
ds_add_u32 v178, v16
v_cmpx_lt_i32 vcc, 99, v32
v_mad_u32_u16 v179, v243, 1, v7 op_sel:[1,0,0,0]
ds_add_u32 v179, v16
s_waitcnt vmcnt(2)
v_cmpx_lt_i32 vcc, 104, v32
s_cbranch_execz LE_c
v_mad_u32_u16 v180, v244, 1, v7 op_sel:[1,0,0,0]
ds_add_u32 v180, v16
v_cmpx_lt_i32 vcc, 105, v32
v_mad_u32_u16 v181, v245, 1, v7 op_sel:[1,0,0,0]
ds_add_u32 v181, v16
v_cmpx_lt_i32 vcc, 106, v32
v_mad_u32_u16 v182, v246, 1, v7 op_sel:[1,0,0,0]
ds_add_u32 v182, v16
v_cmpx_lt_i32 vcc, 107, v32
v_mad_u32_u16 v183, v247, 1, v7 op_sel:[1,0,0,0]
ds_add_u32 v183, v16
s_waitcnt vmcnt(1)
v_cmpx_lt_i32 vcc, 112, v32
s_cbranch_execz LE_c
v_mad_u32_u16 v184, v248, 1, v7 op_sel:[1,0,0,0]
ds_add_u32 v184, v16
v_cmpx_lt_i32 vcc, 113, v32
v_mad_u32_u16 v185, v249, 1, v7 op_sel:[1,0,0,0]
ds_add_u32 v185, v16
v_cmpx_lt_i32 vcc, 114, v32
v_mad_u32_u16 v186, v250, 1, v7 op_sel:[1,0,0,0]
ds_add_u32 v186, v16
v_cmpx_lt_i32 vcc, 115, v32
v_mad_u32_u16 v187, v251, 1, v7 op_sel:[1,0,0,0]
ds_add_u32 v187, v16
s_waitcnt vmcnt(0)
v_cmpx_lt_i32 vcc, 120, v32
s_cbranch_execz LE_c
v_mad_u32_u16 v188, v252, 1, v7 op_sel:[1,0,0,0]
ds_add_u32 v188, v16
v_cmpx_lt_i32 vcc, 121, v32
v_mad_u32_u16 v189, v253, 1, v7 op_sel:[1,0,0,0]
ds_add_u32 v189, v16
v_cmpx_lt_i32 vcc, 122, v32
v_mad_u32_u16 v190, v254, 1, v7 op_sel:[1,0,0,0]
ds_add_u32 v190, v16
v_cmpx_lt_i32 vcc, 123, v32
v_mad_u32_u16 v191, v255, 1, v7 op_sel:[1,0,0,0]
ds_add_u32 v191, v16
LE_c:
s_mov_b64 exec, -1
ds_read_b128 v[24:27], v35
s_waitcnt lgkmcnt(0)
v_add_u32 v24, 3, v24
v_lshrrev_b32 v24, 2, v24
v_max_u32 v24, v24, v18
v_add_u32 v25, 3, v25
v_lshrrev_b32 v25, 2, v25
v_max_u32 v25, v25, v19
v_add_u32 v26, 3, v26
v_lshrrev_b32 v26, 2, v26
v_max_u32 v26, v26, v20
v_add_u32 v27, 3, v27
v_lshrrev_b32 v27, 2, v27
v_max_u32 v27, v27, v21
v_add_u32 v33, v24, v25
v_add3_u32 v33, v33, v26, v27
v_mov_b32 v64, v33
s_nop 1
v_add_u32_dpp v64, v64, v64 row_shr:1 row_mask:0xf bank_mask:0xf
s_nop 1
v_add_u32_dpp v64, v64, v64 row_shr:2 row_mask:0xf bank_mask:0xf
s_nop 1
v_add_u32_dpp v64, v64, v64 row_shr:4 row_mask:0xf bank_mask:0xf
s_nop 1
v_add_u32_dpp v64, v64, v64 row_shr:8 row_mask:0xf bank_mask:0xf
s_nop 1
v_add_u32_dpp v64, v64, v64 row_bcast:15 row_mask:0xa bank_mask:0xf
s_nop 1
v_add_u32_dpp v64, v64, v64 row_bcast:31 row_mask:0xc bank_mask:0xf
s_nop 1
v_readlane_b32 s44, v64, 63
v_sub_u32 v28, v64, v33
v_add_u32 v29, v28, v24
v_add_u32 v30, v29, v25
v_add_u32 v31, v30, v26
v_add3_u32 v33, v28, v24, -1
v_lshlrev_b32 v34, v33, v18
v_lshrrev_b32 v33, 5, v33
v_lshl_add_u32 v33, v33, 2, v36
ds_or_b32 v33, v34 offset:20480
v_lshl_add_u32 v28, v28, 4, v36
v_add3_u32 v33, v29, v25, -1
v_lshlrev_b32 v34, v33, v19
v_lshrrev_b32 v33, 5, v33
v_lshl_add_u32 v33, v33, 2, v36
ds_or_b32 v33, v34 offset:20480
v_lshl_add_u32 v29, v29, 4, v36
v_add3_u32 v33, v30, v26, -1
v_lshlrev_b32 v34, v33, v20
v_lshrrev_b32 v33, 5, v33
v_lshl_add_u32 v33, v33, 2, v36
ds_or_b32 v33, v34 offset:20480
v_lshl_add_u32 v30, v30, 4, v36
v_add3_u32 v33, v31, v27, -1
v_lshlrev_b32 v34, v33, v21
v_lshrrev_b32 v33, 5, v33
v_lshl_add_u32 v33, v33, 2, v36
ds_or_b32 v33, v34 offset:20480
v_lshl_add_u32 v31, v31, 4, v36
ds_write_b128 v35, v[28:31]
s_add_u32 s44, s44, 31
s_lshr_b32 s44, s44, 5
v_cmpx_lt_i32 vcc, 0, v32
s_cbranch_execz LE_p
ds_add_rtn_u32 v128, v128, v17
v_cmpx_lt_i32 vcc, 1, v32
ds_add_rtn_u32 v129, v129, v17
v_cmpx_lt_i32 vcc, 2, v32
ds_add_rtn_u32 v130, v130, v17
v_cmpx_lt_i32 vcc, 3, v32
ds_add_rtn_u32 v131, v131, v17
v_cmpx_lt_i32 vcc, 8, v32
s_cbranch_execz LE_p
ds_add_rtn_u32 v132, v132, v17
v_cmpx_lt_i32 vcc, 9, v32
ds_add_rtn_u32 v133, v133, v17
v_cmpx_lt_i32 vcc, 10, v32
ds_add_rtn_u32 v134, v134, v17
v_cmpx_lt_i32 vcc, 11, v32
ds_add_rtn_u32 v135, v135, v17
v_cmpx_lt_i32 vcc, 16, v32
s_cbranch_execz LE_p
ds_add_rtn_u32 v136, v136, v17
v_cmpx_lt_i32 vcc, 17, v32
ds_add_rtn_u32 v137, v137, v17
v_cmpx_lt_i32 vcc, 18, v32
ds_add_rtn_u32 v138, v138, v17
v_cmpx_lt_i32 vcc, 19, v32
ds_add_rtn_u32 v139, v139, v17
v_cmpx_lt_i32 vcc, 24, v32
s_cbranch_execz LE_p
ds_add_rtn_u32 v140, v140, v17
v_cmpx_lt_i32 vcc, 25, v32
ds_add_rtn_u32 v141, v141, v17
v_cmpx_lt_i32 vcc, 26, v32
ds_add_rtn_u32 v142, v142, v17
v_cmpx_lt_i32 vcc, 27, v32
ds_add_rtn_u32 v143, v143, v17
v_cmpx_lt_i32 vcc, 32, v32
s_cbranch_execz LE_p
ds_add_rtn_u32 v144, v144, v17
v_cmpx_lt_i32 vcc, 33, v32
ds_add_rtn_u32 v145, v145, v17
v_cmpx_lt_i32 vcc, 34, v32
ds_add_rtn_u32 v146, v146, v17
v_cmpx_lt_i32 vcc, 35, v32
ds_add_rtn_u32 v147, v147, v17
v_cmpx_lt_i32 vcc, 40, v32
s_cbranch_execz LE_p
ds_add_rtn_u32 v148, v148, v17
v_cmpx_lt_i32 vcc, 41, v32
ds_add_rtn_u32 v149, v149, v17
v_cmpx_lt_i32 vcc, 42, v32
ds_add_rtn_u32 v150, v150, v17
v_cmpx_lt_i32 vcc, 43, v32
ds_add_rtn_u32 v151, v151, v17
v_cmpx_lt_i32 vcc, 48, v32
s_cbranch_execz LE_p
ds_add_rtn_u32 v152, v152, v17
v_cmpx_lt_i32 vcc, 49, v32
ds_add_rtn_u32 v153, v153, v17
v_cmpx_lt_i32 vcc, 50, v32
ds_add_rtn_u32 v154, v154, v17
v_cmpx_lt_i32 vcc, 51, v32
ds_add_rtn_u32 v155, v155, v17
v_cmpx_lt_i32 vcc, 56, v32
s_cbranch_execz LE_p
ds_add_rtn_u32 v156, v156, v17
v_cmpx_lt_i32 vcc, 57, v32
ds_add_rtn_u32 v157, v157, v17
v_cmpx_lt_i32 vcc, 58, v32
ds_add_rtn_u32 v158, v158, v17
v_cmpx_lt_i32 vcc, 59, v32
ds_add_rtn_u32 v159, v159, v17
v_cmpx_lt_i32 vcc, 64, v32
s_cbranch_execz LE_p
ds_add_rtn_u32 v160, v160, v17
v_cmpx_lt_i32 vcc, 65, v32
ds_add_rtn_u32 v161, v161, v17
v_cmpx_lt_i32 vcc, 66, v32
ds_add_rtn_u32 v162, v162, v17
v_cmpx_lt_i32 vcc, 67, v32
ds_add_rtn_u32 v163, v163, v17
v_cmpx_lt_i32 vcc, 72, v32
s_cbranch_execz LE_p
ds_add_rtn_u32 v164, v164, v17
v_cmpx_lt_i32 vcc, 73, v32
ds_add_rtn_u32 v165, v165, v17
v_cmpx_lt_i32 vcc, 74, v32
ds_add_rtn_u32 v166, v166, v17
v_cmpx_lt_i32 vcc, 75, v32
ds_add_rtn_u32 v167, v167, v17
v_cmpx_lt_i32 vcc, 80, v32
s_cbranch_execz LE_p
ds_add_rtn_u32 v168, v168, v17
v_cmpx_lt_i32 vcc, 81, v32
ds_add_rtn_u32 v169, v169, v17
v_cmpx_lt_i32 vcc, 82, v32
ds_add_rtn_u32 v170, v170, v17
v_cmpx_lt_i32 vcc, 83, v32
ds_add_rtn_u32 v171, v171, v17
v_cmpx_lt_i32 vcc, 88, v32
s_cbranch_execz LE_p
ds_add_rtn_u32 v172, v172, v17
v_cmpx_lt_i32 vcc, 89, v32
ds_add_rtn_u32 v173, v173, v17
v_cmpx_lt_i32 vcc, 90, v32
ds_add_rtn_u32 v174, v174, v17
v_cmpx_lt_i32 vcc, 91, v32
ds_add_rtn_u32 v175, v175, v17
v_cmpx_lt_i32 vcc, 96, v32
s_cbranch_execz LE_p
ds_add_rtn_u32 v176, v176, v17
v_cmpx_lt_i32 vcc, 97, v32
ds_add_rtn_u32 v177, v177, v17
v_cmpx_lt_i32 vcc, 98, v32
ds_add_rtn_u32 v178, v178, v17
v_cmpx_lt_i32 vcc, 99, v32
ds_add_rtn_u32 v179, v179, v17
v_cmpx_lt_i32 vcc, 104, v32
s_cbranch_execz LE_p
ds_add_rtn_u32 v180, v180, v17
v_cmpx_lt_i32 vcc, 105, v32
ds_add_rtn_u32 v181, v181, v17
v_cmpx_lt_i32 vcc, 106, v32
ds_add_rtn_u32 v182, v182, v17
v_cmpx_lt_i32 vcc, 107, v32
ds_add_rtn_u32 v183, v183, v17
v_cmpx_lt_i32 vcc, 112, v32
s_cbranch_execz LE_p
ds_add_rtn_u32 v184, v184, v17
v_cmpx_lt_i32 vcc, 113, v32
ds_add_rtn_u32 v185, v185, v17
v_cmpx_lt_i32 vcc, 114, v32
ds_add_rtn_u32 v186, v186, v17
v_cmpx_lt_i32 vcc, 115, v32
ds_add_rtn_u32 v187, v187, v17
v_cmpx_lt_i32 vcc, 120, v32
s_cbranch_execz LE_p
ds_add_rtn_u32 v188, v188, v17
v_cmpx_lt_i32 vcc, 121, v32
ds_add_rtn_u32 v189, v189, v17
v_cmpx_lt_i32 vcc, 122, v32
ds_add_rtn_u32 v190, v190, v17
v_cmpx_lt_i32 vcc, 123, v32
ds_add_rtn_u32 v191, v191, v17
LE_p:
s_mov_b64 exec, -1
v_lshl_add_u32 v33, v1, 2, v36
ds_read_b32 v37, v33 offset:20480
s_waitcnt lgkmcnt(0)
v_cmpx_lt_i32 vcc, 0, v32
s_cbranch_execz LE_w
ds_write_b32 v128, v192
v_cmpx_lt_i32 vcc, 1, v32
ds_write_b32 v129, v193
v_cmpx_lt_i32 vcc, 2, v32
ds_write_b32 v130, v194
v_cmpx_lt_i32 vcc, 3, v32
ds_write_b32 v131, v195
v_cmpx_lt_i32 vcc, 8, v32
s_cbranch_execz LE_w
ds_write_b32 v132, v196
v_cmpx_lt_i32 vcc, 9, v32
ds_write_b32 v133, v197
v_cmpx_lt_i32 vcc, 10, v32
ds_write_b32 v134, v198
v_cmpx_lt_i32 vcc, 11, v32
ds_write_b32 v135, v199
v_cmpx_lt_i32 vcc, 16, v32
s_cbranch_execz LE_w
ds_write_b32 v136, v200
v_cmpx_lt_i32 vcc, 17, v32
ds_write_b32 v137, v201
v_cmpx_lt_i32 vcc, 18, v32
ds_write_b32 v138, v202
v_cmpx_lt_i32 vcc, 19, v32
ds_write_b32 v139, v203
v_cmpx_lt_i32 vcc, 24, v32
s_cbranch_execz LE_w
ds_write_b32 v140, v204
v_cmpx_lt_i32 vcc, 25, v32
ds_write_b32 v141, v205
v_cmpx_lt_i32 vcc, 26, v32
ds_write_b32 v142, v206
v_cmpx_lt_i32 vcc, 27, v32
ds_write_b32 v143, v207
v_cmpx_lt_i32 vcc, 32, v32
s_cbranch_execz LE_w
ds_write_b32 v144, v208
v_cmpx_lt_i32 vcc, 33, v32
ds_write_b32 v145, v209
v_cmpx_lt_i32 vcc, 34, v32
ds_write_b32 v146, v210
v_cmpx_lt_i32 vcc, 35, v32
ds_write_b32 v147, v211
v_cmpx_lt_i32 vcc, 40, v32
s_cbranch_execz LE_w
ds_write_b32 v148, v212
v_cmpx_lt_i32 vcc, 41, v32
ds_write_b32 v149, v213
v_cmpx_lt_i32 vcc, 42, v32
ds_write_b32 v150, v214
v_cmpx_lt_i32 vcc, 43, v32
ds_write_b32 v151, v215
v_cmpx_lt_i32 vcc, 48, v32
s_cbranch_execz LE_w
ds_write_b32 v152, v216
v_cmpx_lt_i32 vcc, 49, v32
ds_write_b32 v153, v217
v_cmpx_lt_i32 vcc, 50, v32
ds_write_b32 v154, v218
v_cmpx_lt_i32 vcc, 51, v32
ds_write_b32 v155, v219
v_cmpx_lt_i32 vcc, 56, v32
s_cbranch_execz LE_w
ds_write_b32 v156, v220
v_cmpx_lt_i32 vcc, 57, v32
ds_write_b32 v157, v221
v_cmpx_lt_i32 vcc, 58, v32
ds_write_b32 v158, v222
v_cmpx_lt_i32 vcc, 59, v32
ds_write_b32 v159, v223
v_cmpx_lt_i32 vcc, 64, v32
s_cbranch_execz LE_w
ds_write_b32 v160, v224
v_cmpx_lt_i32 vcc, 65, v32
ds_write_b32 v161, v225
v_cmpx_lt_i32 vcc, 66, v32
ds_write_b32 v162, v226
v_cmpx_lt_i32 vcc, 67, v32
ds_write_b32 v163, v227
v_cmpx_lt_i32 vcc, 72, v32
s_cbranch_execz LE_w
ds_write_b32 v164, v228
v_cmpx_lt_i32 vcc, 73, v32
ds_write_b32 v165, v229
v_cmpx_lt_i32 vcc, 74, v32
ds_write_b32 v166, v230
v_cmpx_lt_i32 vcc, 75, v32
ds_write_b32 v167, v231
v_cmpx_lt_i32 vcc, 80, v32
s_cbranch_execz LE_w
ds_write_b32 v168, v232
v_cmpx_lt_i32 vcc, 81, v32
ds_write_b32 v169, v233
v_cmpx_lt_i32 vcc, 82, v32
ds_write_b32 v170, v234
v_cmpx_lt_i32 vcc, 83, v32
ds_write_b32 v171, v235
v_cmpx_lt_i32 vcc, 88, v32
s_cbranch_execz LE_w
ds_write_b32 v172, v236
v_cmpx_lt_i32 vcc, 89, v32
ds_write_b32 v173, v237
v_cmpx_lt_i32 vcc, 90, v32
ds_write_b32 v174, v238
v_cmpx_lt_i32 vcc, 91, v32
ds_write_b32 v175, v239
v_cmpx_lt_i32 vcc, 96, v32
s_cbranch_execz LE_w
ds_write_b32 v176, v240
v_cmpx_lt_i32 vcc, 97, v32
ds_write_b32 v177, v241
v_cmpx_lt_i32 vcc, 98, v32
ds_write_b32 v178, v242
v_cmpx_lt_i32 vcc, 99, v32
ds_write_b32 v179, v243
v_cmpx_lt_i32 vcc, 104, v32
s_cbranch_execz LE_w
ds_write_b32 v180, v244
v_cmpx_lt_i32 vcc, 105, v32
ds_write_b32 v181, v245
v_cmpx_lt_i32 vcc, 106, v32
ds_write_b32 v182, v246
v_cmpx_lt_i32 vcc, 107, v32
ds_write_b32 v183, v247
v_cmpx_lt_i32 vcc, 112, v32
s_cbranch_execz LE_w
ds_write_b32 v184, v248
v_cmpx_lt_i32 vcc, 113, v32
ds_write_b32 v185, v249
v_cmpx_lt_i32 vcc, 114, v32
ds_write_b32 v186, v250
v_cmpx_lt_i32 vcc, 115, v32
ds_write_b32 v187, v251
v_cmpx_lt_i32 vcc, 120, v32
s_cbranch_execz LE_w
ds_write_b32 v188, v252
v_cmpx_lt_i32 vcc, 121, v32
ds_write_b32 v189, v253
v_cmpx_lt_i32 vcc, 122, v32
ds_write_b32 v190, v254
v_cmpx_lt_i32 vcc, 123, v32
ds_write_b32 v191, v255
LE_w:
s_mov_b64 exec, -1
v_mov_b32 v34, v38
ds_read2_b32 v[52:53], v34 offset0:0 offset1:4
ds_read2_b32 v[54:55], v34 offset0:8 offset1:12
s_waitcnt lgkmcnt(0)
ds_read2_b32 v[56:57], v34 offset0:16 offset1:20
ds_read2_b32 v[58:59], v34 offset0:24 offset1:28
v_mad_u32_u16 v60, v52, s49, v2
v_mad_u32_u16 v61, v53, s49, v2
v_mad_u32_u16 v62, v54, s49, v2
v_mad_u32_u16 v63, v55, s49, v2
buffer_load_dwordx4 a[0:3], v60, s[16:19], 0 offen
buffer_load_dwordx4 a[4:7], v60, s[16:19], 0 offen offset:256
buffer_load_dwordx4 a[8:11], v61, s[16:19], 0 offen
buffer_load_dwordx4 a[12:15], v61, s[16:19], 0 offen offset:256
buffer_load_dwordx4 a[16:19], v62, s[16:19], 0 offen
buffer_load_dwordx4 a[20:23], v62, s[16:19], 0 offen offset:256
buffer_load_dwordx4 a[24:27], v63, s[16:19], 0 offen
buffer_load_dwordx4 a[28:31], v63, s[16:19], 0 offen offset:256
s_waitcnt lgkmcnt(0)
ds_read2_b32 v[52:53], v34 offset0:32 offset1:36
ds_read2_b32 v[54:55], v34 offset0:40 offset1:44
v_mad_u32_u16 v60, v56, s49, v2
v_mad_u32_u16 v61, v57, s49, v2
v_mad_u32_u16 v62, v58, s49, v2
v_mad_u32_u16 v63, v59, s49, v2
buffer_load_dwordx4 a[32:35], v60, s[16:19], 0 offen
buffer_load_dwordx4 a[36:39], v60, s[16:19], 0 offen offset:256
buffer_load_dwordx4 a[40:43], v61, s[16:19], 0 offen
buffer_load_dwordx4 a[44:47], v61, s[16:19], 0 offen offset:256
buffer_load_dwordx4 a[48:51], v62, s[16:19], 0 offen
buffer_load_dwordx4 a[52:55], v62, s[16:19], 0 offen offset:256
buffer_load_dwordx4 a[56:59], v63, s[16:19], 0 offen
buffer_load_dwordx4 a[60:63], v63, s[16:19], 0 offen offset:256
s_waitcnt lgkmcnt(0)
ds_read2_b32 v[56:57], v34 offset0:48 offset1:52
ds_read2_b32 v[58:59], v34 offset0:56 offset1:60
v_mad_u32_u16 v60, v52, s49, v2
v_mad_u32_u16 v61, v53, s49, v2
v_mad_u32_u16 v62, v54, s49, v2
v_mad_u32_u16 v63, v55, s49, v2
buffer_load_dwordx4 a[64:67], v60, s[16:19], 0 offen
buffer_load_dwordx4 a[68:71], v60, s[16:19], 0 offen offset:256
buffer_load_dwordx4 a[72:75], v61, s[16:19], 0 offen
buffer_load_dwordx4 a[76:79], v61, s[16:19], 0 offen offset:256
buffer_load_dwordx4 a[80:83], v62, s[16:19], 0 offen
buffer_load_dwordx4 a[84:87], v62, s[16:19], 0 offen offset:256
buffer_load_dwordx4 a[88:91], v63, s[16:19], 0 offen
buffer_load_dwordx4 a[92:95], v63, s[16:19], 0 offen offset:256
s_waitcnt lgkmcnt(0)
ds_read2_b32 v[52:53], v34 offset0:64 offset1:68
ds_read2_b32 v[54:55], v34 offset0:72 offset1:76
v_mad_u32_u16 v60, v56, s49, v2
v_mad_u32_u16 v61, v57, s49, v2
v_mad_u32_u16 v62, v58, s49, v2
v_mad_u32_u16 v63, v59, s49, v2
buffer_load_dwordx4 a[96:99], v60, s[16:19], 0 offen
buffer_load_dwordx4 a[100:103], v60, s[16:19], 0 offen offset:256
buffer_load_dwordx4 a[104:107], v61, s[16:19], 0 offen
buffer_load_dwordx4 a[108:111], v61, s[16:19], 0 offen offset:256
buffer_load_dwordx4 a[112:115], v62, s[16:19], 0 offen
buffer_load_dwordx4 a[116:119], v62, s[16:19], 0 offen offset:256
buffer_load_dwordx4 a[120:123], v63, s[16:19], 0 offen
buffer_load_dwordx4 a[124:127], v63, s[16:19], 0 offen offset:256
s_waitcnt lgkmcnt(0)
ds_read2_b32 v[56:57], v34 offset0:80 offset1:84
ds_read2_b32 v[58:59], v34 offset0:88 offset1:92
v_mad_u32_u16 v60, v52, s49, v2
v_mad_u32_u16 v61, v53, s49, v2
v_mad_u32_u16 v62, v54, s49, v2
v_mad_u32_u16 v63, v55, s49, v2
buffer_load_dwordx4 a[128:131], v60, s[16:19], 0 offen
buffer_load_dwordx4 a[132:135], v60, s[16:19], 0 offen offset:256
buffer_load_dwordx4 a[136:139], v61, s[16:19], 0 offen
buffer_load_dwordx4 a[140:143], v61, s[16:19], 0 offen offset:256
buffer_load_dwordx4 a[144:147], v62, s[16:19], 0 offen
buffer_load_dwordx4 a[148:151], v62, s[16:19], 0 offen offset:256
buffer_load_dwordx4 a[152:155], v63, s[16:19], 0 offen
buffer_load_dwordx4 a[156:159], v63, s[16:19], 0 offen offset:256
s_waitcnt lgkmcnt(0)
ds_read2_b32 v[52:53], v34 offset0:96 offset1:100
ds_read2_b32 v[54:55], v34 offset0:104 offset1:108
v_mad_u32_u16 v60, v56, s49, v2
v_mad_u32_u16 v61, v57, s49, v2
v_mad_u32_u16 v62, v58, s49, v2
v_mad_u32_u16 v63, v59, s49, v2
buffer_load_dwordx4 a[160:163], v60, s[16:19], 0 offen
buffer_load_dwordx4 a[164:167], v60, s[16:19], 0 offen offset:256
buffer_load_dwordx4 a[168:171], v61, s[16:19], 0 offen
buffer_load_dwordx4 a[172:175], v61, s[16:19], 0 offen offset:256
buffer_load_dwordx4 a[176:179], v62, s[16:19], 0 offen
buffer_load_dwordx4 a[180:183], v62, s[16:19], 0 offen offset:256
buffer_load_dwordx4 a[184:187], v63, s[16:19], 0 offen
buffer_load_dwordx4 a[188:191], v63, s[16:19], 0 offen offset:256
s_waitcnt lgkmcnt(0)
ds_read2_b32 v[56:57], v34 offset0:112 offset1:116
ds_read2_b32 v[58:59], v34 offset0:120 offset1:124
v_mad_u32_u16 v60, v52, s49, v2
v_mad_u32_u16 v61, v53, s49, v2
v_mad_u32_u16 v62, v54, s49, v2
v_mad_u32_u16 v63, v55, s49, v2
buffer_load_dwordx4 a[192:195], v60, s[16:19], 0 offen
buffer_load_dwordx4 a[196:199], v60, s[16:19], 0 offen offset:256
buffer_load_dwordx4 a[200:203], v61, s[16:19], 0 offen
buffer_load_dwordx4 a[204:207], v61, s[16:19], 0 offen offset:256
buffer_load_dwordx4 a[208:211], v62, s[16:19], 0 offen
buffer_load_dwordx4 a[212:215], v62, s[16:19], 0 offen offset:256
buffer_load_dwordx4 a[216:219], v63, s[16:19], 0 offen
buffer_load_dwordx4 a[220:223], v63, s[16:19], 0 offen offset:256
s_waitcnt lgkmcnt(0)
ds_read2_b32 v[52:53], v34 offset0:128 offset1:132
ds_read2_b32 v[54:55], v34 offset0:136 offset1:140
v_mad_u32_u16 v60, v56, s49, v2
v_mad_u32_u16 v61, v57, s49, v2
v_mad_u32_u16 v62, v58, s49, v2
v_mad_u32_u16 v63, v59, s49, v2
buffer_load_dwordx4 a[224:227], v60, s[16:19], 0 offen
buffer_load_dwordx4 a[228:231], v60, s[16:19], 0 offen offset:256
buffer_load_dwordx4 a[232:235], v61, s[16:19], 0 offen
buffer_load_dwordx4 a[236:239], v61, s[16:19], 0 offen offset:256
buffer_load_dwordx4 a[240:243], v62, s[16:19], 0 offen
buffer_load_dwordx4 a[244:247], v62, s[16:19], 0 offen offset:256
buffer_load_dwordx4 a[248:251], v63, s[16:19], 0 offen
buffer_load_dwordx4 a[252:255], v63, s[16:19], 0 offen offset:256
v_add_u32 v34, 512, v34
s_mov_b32 s45, 0
s_mul_i32 s47, s40, 85504
LE_loop:
v_readlane_b32 s46, v37, s45
s_add_u32 s45, s45, 1
s_waitcnt vmcnt(56)
v_mfma_f32_16x16x32_bf16 v[48:51], a[0:3], v[40:43], v[48:51]
v_mfma_f32_16x16x32_bf16 v[48:51], a[4:7], v[44:47], v[48:51]
s_bitcmp1_b32 s46, 0
s_cbranch_scc0 LE_nf0
s_cmp_eq_u32 s42, 0
s_cbranch_scc1 LE_fl0
buffer_load_dwordx2 v[66:67], v39, s[20:23], s47 offen sc1
s_waitcnt vmcnt(0)
v_lshlrev_b32 v64, 16, v66
v_and_b32 v65, 0xffff0000, v66
v_add_f32 v48, v48, v64
v_add_f32 v49, v49, v65
v_lshlrev_b32 v64, 16, v67
v_and_b32 v65, 0xffff0000, v67
v_add_f32 v50, v50, v64
v_add_f32 v51, v51, v65
LE_fl0:
s_nop 3
v_cvt_pk_bf16_f32 v64, v48, v49
v_cvt_pk_bf16_f32 v65, v50, v51
v_mov_b32 v48, 0
v_mov_b32 v49, 0
v_mov_b32 v50, 0
v_mov_b32 v51, 0
buffer_store_dwordx2 v[64:65], v39, s[20:23], s47 offen sc1
s_add_u32 s47, s47, 512
LE_nf0:
v_mfma_f32_16x16x32_bf16 v[48:51], a[8:11], v[40:43], v[48:51]
v_mfma_f32_16x16x32_bf16 v[48:51], a[12:15], v[44:47], v[48:51]
s_bitcmp1_b32 s46, 1
s_cbranch_scc0 LE_nf1
s_cmp_eq_u32 s42, 0
s_cbranch_scc1 LE_fl1
buffer_load_dwordx2 v[66:67], v39, s[20:23], s47 offen sc1
s_waitcnt vmcnt(0)
v_lshlrev_b32 v64, 16, v66
v_and_b32 v65, 0xffff0000, v66
v_add_f32 v48, v48, v64
v_add_f32 v49, v49, v65
v_lshlrev_b32 v64, 16, v67
v_and_b32 v65, 0xffff0000, v67
v_add_f32 v50, v50, v64
v_add_f32 v51, v51, v65
LE_fl1:
s_nop 3
v_cvt_pk_bf16_f32 v64, v48, v49
v_cvt_pk_bf16_f32 v65, v50, v51
v_mov_b32 v48, 0
v_mov_b32 v49, 0
v_mov_b32 v50, 0
v_mov_b32 v51, 0
buffer_store_dwordx2 v[64:65], v39, s[20:23], s47 offen sc1
s_add_u32 s47, s47, 512
LE_nf1:
v_mfma_f32_16x16x32_bf16 v[48:51], a[16:19], v[40:43], v[48:51]
v_mfma_f32_16x16x32_bf16 v[48:51], a[20:23], v[44:47], v[48:51]
s_bitcmp1_b32 s46, 2
s_cbranch_scc0 LE_nf2
s_cmp_eq_u32 s42, 0
s_cbranch_scc1 LE_fl2
buffer_load_dwordx2 v[66:67], v39, s[20:23], s47 offen sc1
s_waitcnt vmcnt(0)
v_lshlrev_b32 v64, 16, v66
v_and_b32 v65, 0xffff0000, v66
v_add_f32 v48, v48, v64
v_add_f32 v49, v49, v65
v_lshlrev_b32 v64, 16, v67
v_and_b32 v65, 0xffff0000, v67
v_add_f32 v50, v50, v64
v_add_f32 v51, v51, v65
LE_fl2:
s_nop 3
v_cvt_pk_bf16_f32 v64, v48, v49
v_cvt_pk_bf16_f32 v65, v50, v51
v_mov_b32 v48, 0
v_mov_b32 v49, 0
v_mov_b32 v50, 0
v_mov_b32 v51, 0
buffer_store_dwordx2 v[64:65], v39, s[20:23], s47 offen sc1
s_add_u32 s47, s47, 512
LE_nf2:
v_mfma_f32_16x16x32_bf16 v[48:51], a[24:27], v[40:43], v[48:51]
v_mfma_f32_16x16x32_bf16 v[48:51], a[28:31], v[44:47], v[48:51]
s_bitcmp1_b32 s46, 3
s_cbranch_scc0 LE_nf3
s_cmp_eq_u32 s42, 0
s_cbranch_scc1 LE_fl3
buffer_load_dwordx2 v[66:67], v39, s[20:23], s47 offen sc1
s_waitcnt vmcnt(0)
v_lshlrev_b32 v64, 16, v66
v_and_b32 v65, 0xffff0000, v66
v_add_f32 v48, v48, v64
v_add_f32 v49, v49, v65
v_lshlrev_b32 v64, 16, v67
v_and_b32 v65, 0xffff0000, v67
v_add_f32 v50, v50, v64
v_add_f32 v51, v51, v65
LE_fl3:
s_nop 3
v_cvt_pk_bf16_f32 v64, v48, v49
v_cvt_pk_bf16_f32 v65, v50, v51
v_mov_b32 v48, 0
v_mov_b32 v49, 0
v_mov_b32 v50, 0
v_mov_b32 v51, 0
buffer_store_dwordx2 v[64:65], v39, s[20:23], s47 offen sc1
s_add_u32 s47, s47, 512
LE_nf3:
s_waitcnt lgkmcnt(0)
ds_read2_b32 v[56:57], v34 offset0:16 offset1:20
ds_read2_b32 v[58:59], v34 offset0:24 offset1:28
v_mad_u32_u16 v60, v52, s49, v2
v_mad_u32_u16 v61, v53, s49, v2
v_mad_u32_u16 v62, v54, s49, v2
v_mad_u32_u16 v63, v55, s49, v2
buffer_load_dwordx4 a[0:3], v60, s[16:19], 0 offen
buffer_load_dwordx4 a[4:7], v60, s[16:19], 0 offen offset:256
buffer_load_dwordx4 a[8:11], v61, s[16:19], 0 offen
buffer_load_dwordx4 a[12:15], v61, s[16:19], 0 offen offset:256
buffer_load_dwordx4 a[16:19], v62, s[16:19], 0 offen
buffer_load_dwordx4 a[20:23], v62, s[16:19], 0 offen offset:256
buffer_load_dwordx4 a[24:27], v63, s[16:19], 0 offen
buffer_load_dwordx4 a[28:31], v63, s[16:19], 0 offen offset:256
s_waitcnt vmcnt(56)
v_mfma_f32_16x16x32_bf16 v[48:51], a[32:35], v[40:43], v[48:51]
v_mfma_f32_16x16x32_bf16 v[48:51], a[36:39], v[44:47], v[48:51]
s_bitcmp1_b32 s46, 4
s_cbranch_scc0 LE_nf4
s_cmp_eq_u32 s42, 0
s_cbranch_scc1 LE_fl4
buffer_load_dwordx2 v[66:67], v39, s[20:23], s47 offen sc1
s_waitcnt vmcnt(0)
v_lshlrev_b32 v64, 16, v66
v_and_b32 v65, 0xffff0000, v66
v_add_f32 v48, v48, v64
v_add_f32 v49, v49, v65
v_lshlrev_b32 v64, 16, v67
v_and_b32 v65, 0xffff0000, v67
v_add_f32 v50, v50, v64
v_add_f32 v51, v51, v65
LE_fl4:
s_nop 3
v_cvt_pk_bf16_f32 v64, v48, v49
v_cvt_pk_bf16_f32 v65, v50, v51
v_mov_b32 v48, 0
v_mov_b32 v49, 0
v_mov_b32 v50, 0
v_mov_b32 v51, 0
buffer_store_dwordx2 v[64:65], v39, s[20:23], s47 offen sc1
s_add_u32 s47, s47, 512
LE_nf4:
v_mfma_f32_16x16x32_bf16 v[48:51], a[40:43], v[40:43], v[48:51]
v_mfma_f32_16x16x32_bf16 v[48:51], a[44:47], v[44:47], v[48:51]
s_bitcmp1_b32 s46, 5
s_cbranch_scc0 LE_nf5
s_cmp_eq_u32 s42, 0
s_cbranch_scc1 LE_fl5
buffer_load_dwordx2 v[66:67], v39, s[20:23], s47 offen sc1
s_waitcnt vmcnt(0)
v_lshlrev_b32 v64, 16, v66
v_and_b32 v65, 0xffff0000, v66
v_add_f32 v48, v48, v64
v_add_f32 v49, v49, v65
v_lshlrev_b32 v64, 16, v67
v_and_b32 v65, 0xffff0000, v67
v_add_f32 v50, v50, v64
v_add_f32 v51, v51, v65
LE_fl5:
s_nop 3
v_cvt_pk_bf16_f32 v64, v48, v49
v_cvt_pk_bf16_f32 v65, v50, v51
v_mov_b32 v48, 0
v_mov_b32 v49, 0
v_mov_b32 v50, 0
v_mov_b32 v51, 0
buffer_store_dwordx2 v[64:65], v39, s[20:23], s47 offen sc1
s_add_u32 s47, s47, 512
LE_nf5:
v_mfma_f32_16x16x32_bf16 v[48:51], a[48:51], v[40:43], v[48:51]
v_mfma_f32_16x16x32_bf16 v[48:51], a[52:55], v[44:47], v[48:51]
s_bitcmp1_b32 s46, 6
s_cbranch_scc0 LE_nf6
s_cmp_eq_u32 s42, 0
s_cbranch_scc1 LE_fl6
buffer_load_dwordx2 v[66:67], v39, s[20:23], s47 offen sc1
s_waitcnt vmcnt(0)
v_lshlrev_b32 v64, 16, v66
v_and_b32 v65, 0xffff0000, v66
v_add_f32 v48, v48, v64
v_add_f32 v49, v49, v65
v_lshlrev_b32 v64, 16, v67
v_and_b32 v65, 0xffff0000, v67
v_add_f32 v50, v50, v64
v_add_f32 v51, v51, v65
LE_fl6:
s_nop 3
v_cvt_pk_bf16_f32 v64, v48, v49
v_cvt_pk_bf16_f32 v65, v50, v51
v_mov_b32 v48, 0
v_mov_b32 v49, 0
v_mov_b32 v50, 0
v_mov_b32 v51, 0
buffer_store_dwordx2 v[64:65], v39, s[20:23], s47 offen sc1
s_add_u32 s47, s47, 512
LE_nf6:
v_mfma_f32_16x16x32_bf16 v[48:51], a[56:59], v[40:43], v[48:51]
v_mfma_f32_16x16x32_bf16 v[48:51], a[60:63], v[44:47], v[48:51]
s_bitcmp1_b32 s46, 7
s_cbranch_scc0 LE_nf7
s_cmp_eq_u32 s42, 0
s_cbranch_scc1 LE_fl7
buffer_load_dwordx2 v[66:67], v39, s[20:23], s47 offen sc1
s_waitcnt vmcnt(0)
v_lshlrev_b32 v64, 16, v66
v_and_b32 v65, 0xffff0000, v66
v_add_f32 v48, v48, v64
v_add_f32 v49, v49, v65
v_lshlrev_b32 v64, 16, v67
v_and_b32 v65, 0xffff0000, v67
v_add_f32 v50, v50, v64
v_add_f32 v51, v51, v65
LE_fl7:
s_nop 3
v_cvt_pk_bf16_f32 v64, v48, v49
v_cvt_pk_bf16_f32 v65, v50, v51
v_mov_b32 v48, 0
v_mov_b32 v49, 0
v_mov_b32 v50, 0
v_mov_b32 v51, 0
buffer_store_dwordx2 v[64:65], v39, s[20:23], s47 offen sc1
s_add_u32 s47, s47, 512
LE_nf7:
s_waitcnt lgkmcnt(0)
ds_read2_b32 v[52:53], v34 offset0:32 offset1:36
ds_read2_b32 v[54:55], v34 offset0:40 offset1:44
v_mad_u32_u16 v60, v56, s49, v2
v_mad_u32_u16 v61, v57, s49, v2
v_mad_u32_u16 v62, v58, s49, v2
v_mad_u32_u16 v63, v59, s49, v2
buffer_load_dwordx4 a[32:35], v60, s[16:19], 0 offen
buffer_load_dwordx4 a[36:39], v60, s[16:19], 0 offen offset:256
buffer_load_dwordx4 a[40:43], v61, s[16:19], 0 offen
buffer_load_dwordx4 a[44:47], v61, s[16:19], 0 offen offset:256
buffer_load_dwordx4 a[48:51], v62, s[16:19], 0 offen
buffer_load_dwordx4 a[52:55], v62, s[16:19], 0 offen offset:256
buffer_load_dwordx4 a[56:59], v63, s[16:19], 0 offen
buffer_load_dwordx4 a[60:63], v63, s[16:19], 0 offen offset:256
s_waitcnt vmcnt(56)
v_mfma_f32_16x16x32_bf16 v[48:51], a[64:67], v[40:43], v[48:51]
v_mfma_f32_16x16x32_bf16 v[48:51], a[68:71], v[44:47], v[48:51]
s_bitcmp1_b32 s46, 8
s_cbranch_scc0 LE_nf8
s_cmp_eq_u32 s42, 0
s_cbranch_scc1 LE_fl8
buffer_load_dwordx2 v[66:67], v39, s[20:23], s47 offen sc1
s_waitcnt vmcnt(0)
v_lshlrev_b32 v64, 16, v66
v_and_b32 v65, 0xffff0000, v66
v_add_f32 v48, v48, v64
v_add_f32 v49, v49, v65
v_lshlrev_b32 v64, 16, v67
v_and_b32 v65, 0xffff0000, v67
v_add_f32 v50, v50, v64
v_add_f32 v51, v51, v65
LE_fl8:
s_nop 3
v_cvt_pk_bf16_f32 v64, v48, v49
v_cvt_pk_bf16_f32 v65, v50, v51
v_mov_b32 v48, 0
v_mov_b32 v49, 0
v_mov_b32 v50, 0
v_mov_b32 v51, 0
buffer_store_dwordx2 v[64:65], v39, s[20:23], s47 offen sc1
s_add_u32 s47, s47, 512
LE_nf8:
v_mfma_f32_16x16x32_bf16 v[48:51], a[72:75], v[40:43], v[48:51]
v_mfma_f32_16x16x32_bf16 v[48:51], a[76:79], v[44:47], v[48:51]
s_bitcmp1_b32 s46, 9
s_cbranch_scc0 LE_nf9
s_cmp_eq_u32 s42, 0
s_cbranch_scc1 LE_fl9
buffer_load_dwordx2 v[66:67], v39, s[20:23], s47 offen sc1
s_waitcnt vmcnt(0)
v_lshlrev_b32 v64, 16, v66
v_and_b32 v65, 0xffff0000, v66
v_add_f32 v48, v48, v64
v_add_f32 v49, v49, v65
v_lshlrev_b32 v64, 16, v67
v_and_b32 v65, 0xffff0000, v67
v_add_f32 v50, v50, v64
v_add_f32 v51, v51, v65
LE_fl9:
s_nop 3
v_cvt_pk_bf16_f32 v64, v48, v49
v_cvt_pk_bf16_f32 v65, v50, v51
v_mov_b32 v48, 0
v_mov_b32 v49, 0
v_mov_b32 v50, 0
v_mov_b32 v51, 0
buffer_store_dwordx2 v[64:65], v39, s[20:23], s47 offen sc1
s_add_u32 s47, s47, 512
LE_nf9:
v_mfma_f32_16x16x32_bf16 v[48:51], a[80:83], v[40:43], v[48:51]
v_mfma_f32_16x16x32_bf16 v[48:51], a[84:87], v[44:47], v[48:51]
s_bitcmp1_b32 s46, 10
s_cbranch_scc0 LE_nf10
s_cmp_eq_u32 s42, 0
s_cbranch_scc1 LE_fl10
buffer_load_dwordx2 v[66:67], v39, s[20:23], s47 offen sc1
s_waitcnt vmcnt(0)
v_lshlrev_b32 v64, 16, v66
v_and_b32 v65, 0xffff0000, v66
v_add_f32 v48, v48, v64
v_add_f32 v49, v49, v65
v_lshlrev_b32 v64, 16, v67
v_and_b32 v65, 0xffff0000, v67
v_add_f32 v50, v50, v64
v_add_f32 v51, v51, v65
LE_fl10:
s_nop 3
v_cvt_pk_bf16_f32 v64, v48, v49
v_cvt_pk_bf16_f32 v65, v50, v51
v_mov_b32 v48, 0
v_mov_b32 v49, 0
v_mov_b32 v50, 0
v_mov_b32 v51, 0
buffer_store_dwordx2 v[64:65], v39, s[20:23], s47 offen sc1
s_add_u32 s47, s47, 512
LE_nf10:
v_mfma_f32_16x16x32_bf16 v[48:51], a[88:91], v[40:43], v[48:51]
v_mfma_f32_16x16x32_bf16 v[48:51], a[92:95], v[44:47], v[48:51]
s_bitcmp1_b32 s46, 11
s_cbranch_scc0 LE_nf11
s_cmp_eq_u32 s42, 0
s_cbranch_scc1 LE_fl11
buffer_load_dwordx2 v[66:67], v39, s[20:23], s47 offen sc1
s_waitcnt vmcnt(0)
v_lshlrev_b32 v64, 16, v66
v_and_b32 v65, 0xffff0000, v66
v_add_f32 v48, v48, v64
v_add_f32 v49, v49, v65
v_lshlrev_b32 v64, 16, v67
v_and_b32 v65, 0xffff0000, v67
v_add_f32 v50, v50, v64
v_add_f32 v51, v51, v65
LE_fl11:
s_nop 3
v_cvt_pk_bf16_f32 v64, v48, v49
v_cvt_pk_bf16_f32 v65, v50, v51
v_mov_b32 v48, 0
v_mov_b32 v49, 0
v_mov_b32 v50, 0
v_mov_b32 v51, 0
buffer_store_dwordx2 v[64:65], v39, s[20:23], s47 offen sc1
s_add_u32 s47, s47, 512
LE_nf11:
s_waitcnt lgkmcnt(0)
ds_read2_b32 v[56:57], v34 offset0:48 offset1:52
ds_read2_b32 v[58:59], v34 offset0:56 offset1:60
v_mad_u32_u16 v60, v52, s49, v2
v_mad_u32_u16 v61, v53, s49, v2
v_mad_u32_u16 v62, v54, s49, v2
v_mad_u32_u16 v63, v55, s49, v2
buffer_load_dwordx4 a[64:67], v60, s[16:19], 0 offen
buffer_load_dwordx4 a[68:71], v60, s[16:19], 0 offen offset:256
buffer_load_dwordx4 a[72:75], v61, s[16:19], 0 offen
buffer_load_dwordx4 a[76:79], v61, s[16:19], 0 offen offset:256
buffer_load_dwordx4 a[80:83], v62, s[16:19], 0 offen
buffer_load_dwordx4 a[84:87], v62, s[16:19], 0 offen offset:256
buffer_load_dwordx4 a[88:91], v63, s[16:19], 0 offen
buffer_load_dwordx4 a[92:95], v63, s[16:19], 0 offen offset:256
s_waitcnt vmcnt(56)
v_mfma_f32_16x16x32_bf16 v[48:51], a[96:99], v[40:43], v[48:51]
v_mfma_f32_16x16x32_bf16 v[48:51], a[100:103], v[44:47], v[48:51]
s_bitcmp1_b32 s46, 12
s_cbranch_scc0 LE_nf12
s_cmp_eq_u32 s42, 0
s_cbranch_scc1 LE_fl12
buffer_load_dwordx2 v[66:67], v39, s[20:23], s47 offen sc1
s_waitcnt vmcnt(0)
v_lshlrev_b32 v64, 16, v66
v_and_b32 v65, 0xffff0000, v66
v_add_f32 v48, v48, v64
v_add_f32 v49, v49, v65
v_lshlrev_b32 v64, 16, v67
v_and_b32 v65, 0xffff0000, v67
v_add_f32 v50, v50, v64
v_add_f32 v51, v51, v65
LE_fl12:
s_nop 3
v_cvt_pk_bf16_f32 v64, v48, v49
v_cvt_pk_bf16_f32 v65, v50, v51
v_mov_b32 v48, 0
v_mov_b32 v49, 0
v_mov_b32 v50, 0
v_mov_b32 v51, 0
buffer_store_dwordx2 v[64:65], v39, s[20:23], s47 offen sc1
s_add_u32 s47, s47, 512
LE_nf12:
v_mfma_f32_16x16x32_bf16 v[48:51], a[104:107], v[40:43], v[48:51]
v_mfma_f32_16x16x32_bf16 v[48:51], a[108:111], v[44:47], v[48:51]
s_bitcmp1_b32 s46, 13
s_cbranch_scc0 LE_nf13
s_cmp_eq_u32 s42, 0
s_cbranch_scc1 LE_fl13
buffer_load_dwordx2 v[66:67], v39, s[20:23], s47 offen sc1
s_waitcnt vmcnt(0)
v_lshlrev_b32 v64, 16, v66
v_and_b32 v65, 0xffff0000, v66
v_add_f32 v48, v48, v64
v_add_f32 v49, v49, v65
v_lshlrev_b32 v64, 16, v67
v_and_b32 v65, 0xffff0000, v67
v_add_f32 v50, v50, v64
v_add_f32 v51, v51, v65
LE_fl13:
s_nop 3
v_cvt_pk_bf16_f32 v64, v48, v49
v_cvt_pk_bf16_f32 v65, v50, v51
v_mov_b32 v48, 0
v_mov_b32 v49, 0
v_mov_b32 v50, 0
v_mov_b32 v51, 0
buffer_store_dwordx2 v[64:65], v39, s[20:23], s47 offen sc1
s_add_u32 s47, s47, 512
LE_nf13:
v_mfma_f32_16x16x32_bf16 v[48:51], a[112:115], v[40:43], v[48:51]
v_mfma_f32_16x16x32_bf16 v[48:51], a[116:119], v[44:47], v[48:51]
s_bitcmp1_b32 s46, 14
s_cbranch_scc0 LE_nf14
s_cmp_eq_u32 s42, 0
s_cbranch_scc1 LE_fl14
buffer_load_dwordx2 v[66:67], v39, s[20:23], s47 offen sc1
s_waitcnt vmcnt(0)
v_lshlrev_b32 v64, 16, v66
v_and_b32 v65, 0xffff0000, v66
v_add_f32 v48, v48, v64
v_add_f32 v49, v49, v65
v_lshlrev_b32 v64, 16, v67
v_and_b32 v65, 0xffff0000, v67
v_add_f32 v50, v50, v64
v_add_f32 v51, v51, v65
LE_fl14:
s_nop 3
v_cvt_pk_bf16_f32 v64, v48, v49
v_cvt_pk_bf16_f32 v65, v50, v51
v_mov_b32 v48, 0
v_mov_b32 v49, 0
v_mov_b32 v50, 0
v_mov_b32 v51, 0
buffer_store_dwordx2 v[64:65], v39, s[20:23], s47 offen sc1
s_add_u32 s47, s47, 512
LE_nf14:
v_mfma_f32_16x16x32_bf16 v[48:51], a[120:123], v[40:43], v[48:51]
v_mfma_f32_16x16x32_bf16 v[48:51], a[124:127], v[44:47], v[48:51]
s_bitcmp1_b32 s46, 15
s_cbranch_scc0 LE_nf15
s_cmp_eq_u32 s42, 0
s_cbranch_scc1 LE_fl15
buffer_load_dwordx2 v[66:67], v39, s[20:23], s47 offen sc1
s_waitcnt vmcnt(0)
v_lshlrev_b32 v64, 16, v66
v_and_b32 v65, 0xffff0000, v66
v_add_f32 v48, v48, v64
v_add_f32 v49, v49, v65
v_lshlrev_b32 v64, 16, v67
v_and_b32 v65, 0xffff0000, v67
v_add_f32 v50, v50, v64
v_add_f32 v51, v51, v65
LE_fl15:
s_nop 3
v_cvt_pk_bf16_f32 v64, v48, v49
v_cvt_pk_bf16_f32 v65, v50, v51
v_mov_b32 v48, 0
v_mov_b32 v49, 0
v_mov_b32 v50, 0
v_mov_b32 v51, 0
buffer_store_dwordx2 v[64:65], v39, s[20:23], s47 offen sc1
s_add_u32 s47, s47, 512
LE_nf15:
s_waitcnt lgkmcnt(0)
ds_read2_b32 v[52:53], v34 offset0:64 offset1:68
ds_read2_b32 v[54:55], v34 offset0:72 offset1:76
v_mad_u32_u16 v60, v56, s49, v2
v_mad_u32_u16 v61, v57, s49, v2
v_mad_u32_u16 v62, v58, s49, v2
v_mad_u32_u16 v63, v59, s49, v2
buffer_load_dwordx4 a[96:99], v60, s[16:19], 0 offen
buffer_load_dwordx4 a[100:103], v60, s[16:19], 0 offen offset:256
buffer_load_dwordx4 a[104:107], v61, s[16:19], 0 offen
buffer_load_dwordx4 a[108:111], v61, s[16:19], 0 offen offset:256
buffer_load_dwordx4 a[112:115], v62, s[16:19], 0 offen
buffer_load_dwordx4 a[116:119], v62, s[16:19], 0 offen offset:256
buffer_load_dwordx4 a[120:123], v63, s[16:19], 0 offen
buffer_load_dwordx4 a[124:127], v63, s[16:19], 0 offen offset:256
s_waitcnt vmcnt(56)
v_mfma_f32_16x16x32_bf16 v[48:51], a[128:131], v[40:43], v[48:51]
v_mfma_f32_16x16x32_bf16 v[48:51], a[132:135], v[44:47], v[48:51]
s_bitcmp1_b32 s46, 16
s_cbranch_scc0 LE_nf16
s_cmp_eq_u32 s42, 0
s_cbranch_scc1 LE_fl16
buffer_load_dwordx2 v[66:67], v39, s[20:23], s47 offen sc1
s_waitcnt vmcnt(0)
v_lshlrev_b32 v64, 16, v66
v_and_b32 v65, 0xffff0000, v66
v_add_f32 v48, v48, v64
v_add_f32 v49, v49, v65
v_lshlrev_b32 v64, 16, v67
v_and_b32 v65, 0xffff0000, v67
v_add_f32 v50, v50, v64
v_add_f32 v51, v51, v65
LE_fl16:
s_nop 3
v_cvt_pk_bf16_f32 v64, v48, v49
v_cvt_pk_bf16_f32 v65, v50, v51
v_mov_b32 v48, 0
v_mov_b32 v49, 0
v_mov_b32 v50, 0
v_mov_b32 v51, 0
buffer_store_dwordx2 v[64:65], v39, s[20:23], s47 offen sc1
s_add_u32 s47, s47, 512
LE_nf16:
v_mfma_f32_16x16x32_bf16 v[48:51], a[136:139], v[40:43], v[48:51]
v_mfma_f32_16x16x32_bf16 v[48:51], a[140:143], v[44:47], v[48:51]
s_bitcmp1_b32 s46, 17
s_cbranch_scc0 LE_nf17
s_cmp_eq_u32 s42, 0
s_cbranch_scc1 LE_fl17
buffer_load_dwordx2 v[66:67], v39, s[20:23], s47 offen sc1
s_waitcnt vmcnt(0)
v_lshlrev_b32 v64, 16, v66
v_and_b32 v65, 0xffff0000, v66
v_add_f32 v48, v48, v64
v_add_f32 v49, v49, v65
v_lshlrev_b32 v64, 16, v67
v_and_b32 v65, 0xffff0000, v67
v_add_f32 v50, v50, v64
v_add_f32 v51, v51, v65
LE_fl17:
s_nop 3
v_cvt_pk_bf16_f32 v64, v48, v49
v_cvt_pk_bf16_f32 v65, v50, v51
v_mov_b32 v48, 0
v_mov_b32 v49, 0
v_mov_b32 v50, 0
v_mov_b32 v51, 0
buffer_store_dwordx2 v[64:65], v39, s[20:23], s47 offen sc1
s_add_u32 s47, s47, 512
LE_nf17:
v_mfma_f32_16x16x32_bf16 v[48:51], a[144:147], v[40:43], v[48:51]
v_mfma_f32_16x16x32_bf16 v[48:51], a[148:151], v[44:47], v[48:51]
s_bitcmp1_b32 s46, 18
s_cbranch_scc0 LE_nf18
s_cmp_eq_u32 s42, 0
s_cbranch_scc1 LE_fl18
buffer_load_dwordx2 v[66:67], v39, s[20:23], s47 offen sc1
s_waitcnt vmcnt(0)
v_lshlrev_b32 v64, 16, v66
v_and_b32 v65, 0xffff0000, v66
v_add_f32 v48, v48, v64
v_add_f32 v49, v49, v65
v_lshlrev_b32 v64, 16, v67
v_and_b32 v65, 0xffff0000, v67
v_add_f32 v50, v50, v64
v_add_f32 v51, v51, v65
LE_fl18:
s_nop 3
v_cvt_pk_bf16_f32 v64, v48, v49
v_cvt_pk_bf16_f32 v65, v50, v51
v_mov_b32 v48, 0
v_mov_b32 v49, 0
v_mov_b32 v50, 0
v_mov_b32 v51, 0
buffer_store_dwordx2 v[64:65], v39, s[20:23], s47 offen sc1
s_add_u32 s47, s47, 512
LE_nf18:
v_mfma_f32_16x16x32_bf16 v[48:51], a[152:155], v[40:43], v[48:51]
v_mfma_f32_16x16x32_bf16 v[48:51], a[156:159], v[44:47], v[48:51]
s_bitcmp1_b32 s46, 19
s_cbranch_scc0 LE_nf19
s_cmp_eq_u32 s42, 0
s_cbranch_scc1 LE_fl19
buffer_load_dwordx2 v[66:67], v39, s[20:23], s47 offen sc1
s_waitcnt vmcnt(0)
v_lshlrev_b32 v64, 16, v66
v_and_b32 v65, 0xffff0000, v66
v_add_f32 v48, v48, v64
v_add_f32 v49, v49, v65
v_lshlrev_b32 v64, 16, v67
v_and_b32 v65, 0xffff0000, v67
v_add_f32 v50, v50, v64
v_add_f32 v51, v51, v65
LE_fl19:
s_nop 3
v_cvt_pk_bf16_f32 v64, v48, v49
v_cvt_pk_bf16_f32 v65, v50, v51
v_mov_b32 v48, 0
v_mov_b32 v49, 0
v_mov_b32 v50, 0
v_mov_b32 v51, 0
buffer_store_dwordx2 v[64:65], v39, s[20:23], s47 offen sc1
s_add_u32 s47, s47, 512
LE_nf19:
s_waitcnt lgkmcnt(0)
ds_read2_b32 v[56:57], v34 offset0:80 offset1:84
ds_read2_b32 v[58:59], v34 offset0:88 offset1:92
v_mad_u32_u16 v60, v52, s49, v2
v_mad_u32_u16 v61, v53, s49, v2
v_mad_u32_u16 v62, v54, s49, v2
v_mad_u32_u16 v63, v55, s49, v2
buffer_load_dwordx4 a[128:131], v60, s[16:19], 0 offen
buffer_load_dwordx4 a[132:135], v60, s[16:19], 0 offen offset:256
buffer_load_dwordx4 a[136:139], v61, s[16:19], 0 offen
buffer_load_dwordx4 a[140:143], v61, s[16:19], 0 offen offset:256
buffer_load_dwordx4 a[144:147], v62, s[16:19], 0 offen
buffer_load_dwordx4 a[148:151], v62, s[16:19], 0 offen offset:256
buffer_load_dwordx4 a[152:155], v63, s[16:19], 0 offen
buffer_load_dwordx4 a[156:159], v63, s[16:19], 0 offen offset:256
s_waitcnt vmcnt(56)
v_mfma_f32_16x16x32_bf16 v[48:51], a[160:163], v[40:43], v[48:51]
v_mfma_f32_16x16x32_bf16 v[48:51], a[164:167], v[44:47], v[48:51]
s_bitcmp1_b32 s46, 20
s_cbranch_scc0 LE_nf20
s_cmp_eq_u32 s42, 0
s_cbranch_scc1 LE_fl20
buffer_load_dwordx2 v[66:67], v39, s[20:23], s47 offen sc1
s_waitcnt vmcnt(0)
v_lshlrev_b32 v64, 16, v66
v_and_b32 v65, 0xffff0000, v66
v_add_f32 v48, v48, v64
v_add_f32 v49, v49, v65
v_lshlrev_b32 v64, 16, v67
v_and_b32 v65, 0xffff0000, v67
v_add_f32 v50, v50, v64
v_add_f32 v51, v51, v65
LE_fl20:
s_nop 3
v_cvt_pk_bf16_f32 v64, v48, v49
v_cvt_pk_bf16_f32 v65, v50, v51
v_mov_b32 v48, 0
v_mov_b32 v49, 0
v_mov_b32 v50, 0
v_mov_b32 v51, 0
buffer_store_dwordx2 v[64:65], v39, s[20:23], s47 offen sc1
s_add_u32 s47, s47, 512
LE_nf20:
v_mfma_f32_16x16x32_bf16 v[48:51], a[168:171], v[40:43], v[48:51]
v_mfma_f32_16x16x32_bf16 v[48:51], a[172:175], v[44:47], v[48:51]
s_bitcmp1_b32 s46, 21
s_cbranch_scc0 LE_nf21
s_cmp_eq_u32 s42, 0
s_cbranch_scc1 LE_fl21
buffer_load_dwordx2 v[66:67], v39, s[20:23], s47 offen sc1
s_waitcnt vmcnt(0)
v_lshlrev_b32 v64, 16, v66
v_and_b32 v65, 0xffff0000, v66
v_add_f32 v48, v48, v64
v_add_f32 v49, v49, v65
v_lshlrev_b32 v64, 16, v67
v_and_b32 v65, 0xffff0000, v67
v_add_f32 v50, v50, v64
v_add_f32 v51, v51, v65
LE_fl21:
s_nop 3
v_cvt_pk_bf16_f32 v64, v48, v49
v_cvt_pk_bf16_f32 v65, v50, v51
v_mov_b32 v48, 0
v_mov_b32 v49, 0
v_mov_b32 v50, 0
v_mov_b32 v51, 0
buffer_store_dwordx2 v[64:65], v39, s[20:23], s47 offen sc1
s_add_u32 s47, s47, 512
LE_nf21:
v_mfma_f32_16x16x32_bf16 v[48:51], a[176:179], v[40:43], v[48:51]
v_mfma_f32_16x16x32_bf16 v[48:51], a[180:183], v[44:47], v[48:51]
s_bitcmp1_b32 s46, 22
s_cbranch_scc0 LE_nf22
s_cmp_eq_u32 s42, 0
s_cbranch_scc1 LE_fl22
buffer_load_dwordx2 v[66:67], v39, s[20:23], s47 offen sc1
s_waitcnt vmcnt(0)
v_lshlrev_b32 v64, 16, v66
v_and_b32 v65, 0xffff0000, v66
v_add_f32 v48, v48, v64
v_add_f32 v49, v49, v65
v_lshlrev_b32 v64, 16, v67
v_and_b32 v65, 0xffff0000, v67
v_add_f32 v50, v50, v64
v_add_f32 v51, v51, v65
LE_fl22:
s_nop 3
v_cvt_pk_bf16_f32 v64, v48, v49
v_cvt_pk_bf16_f32 v65, v50, v51
v_mov_b32 v48, 0
v_mov_b32 v49, 0
v_mov_b32 v50, 0
v_mov_b32 v51, 0
buffer_store_dwordx2 v[64:65], v39, s[20:23], s47 offen sc1
s_add_u32 s47, s47, 512
LE_nf22:
v_mfma_f32_16x16x32_bf16 v[48:51], a[184:187], v[40:43], v[48:51]
v_mfma_f32_16x16x32_bf16 v[48:51], a[188:191], v[44:47], v[48:51]
s_bitcmp1_b32 s46, 23
s_cbranch_scc0 LE_nf23
s_cmp_eq_u32 s42, 0
s_cbranch_scc1 LE_fl23
buffer_load_dwordx2 v[66:67], v39, s[20:23], s47 offen sc1
s_waitcnt vmcnt(0)
v_lshlrev_b32 v64, 16, v66
v_and_b32 v65, 0xffff0000, v66
v_add_f32 v48, v48, v64
v_add_f32 v49, v49, v65
v_lshlrev_b32 v64, 16, v67
v_and_b32 v65, 0xffff0000, v67
v_add_f32 v50, v50, v64
v_add_f32 v51, v51, v65
LE_fl23:
s_nop 3
v_cvt_pk_bf16_f32 v64, v48, v49
v_cvt_pk_bf16_f32 v65, v50, v51
v_mov_b32 v48, 0
v_mov_b32 v49, 0
v_mov_b32 v50, 0
v_mov_b32 v51, 0
buffer_store_dwordx2 v[64:65], v39, s[20:23], s47 offen sc1
s_add_u32 s47, s47, 512
LE_nf23:
s_waitcnt lgkmcnt(0)
ds_read2_b32 v[52:53], v34 offset0:96 offset1:100
ds_read2_b32 v[54:55], v34 offset0:104 offset1:108
v_mad_u32_u16 v60, v56, s49, v2
v_mad_u32_u16 v61, v57, s49, v2
v_mad_u32_u16 v62, v58, s49, v2
v_mad_u32_u16 v63, v59, s49, v2
buffer_load_dwordx4 a[160:163], v60, s[16:19], 0 offen
buffer_load_dwordx4 a[164:167], v60, s[16:19], 0 offen offset:256
buffer_load_dwordx4 a[168:171], v61, s[16:19], 0 offen
buffer_load_dwordx4 a[172:175], v61, s[16:19], 0 offen offset:256
buffer_load_dwordx4 a[176:179], v62, s[16:19], 0 offen
buffer_load_dwordx4 a[180:183], v62, s[16:19], 0 offen offset:256
buffer_load_dwordx4 a[184:187], v63, s[16:19], 0 offen
buffer_load_dwordx4 a[188:191], v63, s[16:19], 0 offen offset:256
s_waitcnt vmcnt(56)
v_mfma_f32_16x16x32_bf16 v[48:51], a[192:195], v[40:43], v[48:51]
v_mfma_f32_16x16x32_bf16 v[48:51], a[196:199], v[44:47], v[48:51]
s_bitcmp1_b32 s46, 24
s_cbranch_scc0 LE_nf24
s_cmp_eq_u32 s42, 0
s_cbranch_scc1 LE_fl24
buffer_load_dwordx2 v[66:67], v39, s[20:23], s47 offen sc1
s_waitcnt vmcnt(0)
v_lshlrev_b32 v64, 16, v66
v_and_b32 v65, 0xffff0000, v66
v_add_f32 v48, v48, v64
v_add_f32 v49, v49, v65
v_lshlrev_b32 v64, 16, v67
v_and_b32 v65, 0xffff0000, v67
v_add_f32 v50, v50, v64
v_add_f32 v51, v51, v65
LE_fl24:
s_nop 3
v_cvt_pk_bf16_f32 v64, v48, v49
v_cvt_pk_bf16_f32 v65, v50, v51
v_mov_b32 v48, 0
v_mov_b32 v49, 0
v_mov_b32 v50, 0
v_mov_b32 v51, 0
buffer_store_dwordx2 v[64:65], v39, s[20:23], s47 offen sc1
s_add_u32 s47, s47, 512
LE_nf24:
v_mfma_f32_16x16x32_bf16 v[48:51], a[200:203], v[40:43], v[48:51]
v_mfma_f32_16x16x32_bf16 v[48:51], a[204:207], v[44:47], v[48:51]
s_bitcmp1_b32 s46, 25
s_cbranch_scc0 LE_nf25
s_cmp_eq_u32 s42, 0
s_cbranch_scc1 LE_fl25
buffer_load_dwordx2 v[66:67], v39, s[20:23], s47 offen sc1
s_waitcnt vmcnt(0)
v_lshlrev_b32 v64, 16, v66
v_and_b32 v65, 0xffff0000, v66
v_add_f32 v48, v48, v64
v_add_f32 v49, v49, v65
v_lshlrev_b32 v64, 16, v67
v_and_b32 v65, 0xffff0000, v67
v_add_f32 v50, v50, v64
v_add_f32 v51, v51, v65
LE_fl25:
s_nop 3
v_cvt_pk_bf16_f32 v64, v48, v49
v_cvt_pk_bf16_f32 v65, v50, v51
v_mov_b32 v48, 0
v_mov_b32 v49, 0
v_mov_b32 v50, 0
v_mov_b32 v51, 0
buffer_store_dwordx2 v[64:65], v39, s[20:23], s47 offen sc1
s_add_u32 s47, s47, 512
LE_nf25:
v_mfma_f32_16x16x32_bf16 v[48:51], a[208:211], v[40:43], v[48:51]
v_mfma_f32_16x16x32_bf16 v[48:51], a[212:215], v[44:47], v[48:51]
s_bitcmp1_b32 s46, 26
s_cbranch_scc0 LE_nf26
s_cmp_eq_u32 s42, 0
s_cbranch_scc1 LE_fl26
buffer_load_dwordx2 v[66:67], v39, s[20:23], s47 offen sc1
s_waitcnt vmcnt(0)
v_lshlrev_b32 v64, 16, v66
v_and_b32 v65, 0xffff0000, v66
v_add_f32 v48, v48, v64
v_add_f32 v49, v49, v65
v_lshlrev_b32 v64, 16, v67
v_and_b32 v65, 0xffff0000, v67
v_add_f32 v50, v50, v64
v_add_f32 v51, v51, v65
LE_fl26:
s_nop 3
v_cvt_pk_bf16_f32 v64, v48, v49
v_cvt_pk_bf16_f32 v65, v50, v51
v_mov_b32 v48, 0
v_mov_b32 v49, 0
v_mov_b32 v50, 0
v_mov_b32 v51, 0
buffer_store_dwordx2 v[64:65], v39, s[20:23], s47 offen sc1
s_add_u32 s47, s47, 512
LE_nf26:
v_mfma_f32_16x16x32_bf16 v[48:51], a[216:219], v[40:43], v[48:51]
v_mfma_f32_16x16x32_bf16 v[48:51], a[220:223], v[44:47], v[48:51]
s_bitcmp1_b32 s46, 27
s_cbranch_scc0 LE_nf27
s_cmp_eq_u32 s42, 0
s_cbranch_scc1 LE_fl27
buffer_load_dwordx2 v[66:67], v39, s[20:23], s47 offen sc1
s_waitcnt vmcnt(0)
v_lshlrev_b32 v64, 16, v66
v_and_b32 v65, 0xffff0000, v66
v_add_f32 v48, v48, v64
v_add_f32 v49, v49, v65
v_lshlrev_b32 v64, 16, v67
v_and_b32 v65, 0xffff0000, v67
v_add_f32 v50, v50, v64
v_add_f32 v51, v51, v65
LE_fl27:
s_nop 3
v_cvt_pk_bf16_f32 v64, v48, v49
v_cvt_pk_bf16_f32 v65, v50, v51
v_mov_b32 v48, 0
v_mov_b32 v49, 0
v_mov_b32 v50, 0
v_mov_b32 v51, 0
buffer_store_dwordx2 v[64:65], v39, s[20:23], s47 offen sc1
s_add_u32 s47, s47, 512
LE_nf27:
s_waitcnt lgkmcnt(0)
ds_read2_b32 v[56:57], v34 offset0:112 offset1:116
ds_read2_b32 v[58:59], v34 offset0:120 offset1:124
v_mad_u32_u16 v60, v52, s49, v2
v_mad_u32_u16 v61, v53, s49, v2
v_mad_u32_u16 v62, v54, s49, v2
v_mad_u32_u16 v63, v55, s49, v2
buffer_load_dwordx4 a[192:195], v60, s[16:19], 0 offen
buffer_load_dwordx4 a[196:199], v60, s[16:19], 0 offen offset:256
buffer_load_dwordx4 a[200:203], v61, s[16:19], 0 offen
buffer_load_dwordx4 a[204:207], v61, s[16:19], 0 offen offset:256
buffer_load_dwordx4 a[208:211], v62, s[16:19], 0 offen
buffer_load_dwordx4 a[212:215], v62, s[16:19], 0 offen offset:256
buffer_load_dwordx4 a[216:219], v63, s[16:19], 0 offen
buffer_load_dwordx4 a[220:223], v63, s[16:19], 0 offen offset:256
s_waitcnt vmcnt(56)
v_mfma_f32_16x16x32_bf16 v[48:51], a[224:227], v[40:43], v[48:51]
v_mfma_f32_16x16x32_bf16 v[48:51], a[228:231], v[44:47], v[48:51]
s_bitcmp1_b32 s46, 28
s_cbranch_scc0 LE_nf28
s_cmp_eq_u32 s42, 0
s_cbranch_scc1 LE_fl28
buffer_load_dwordx2 v[66:67], v39, s[20:23], s47 offen sc1
s_waitcnt vmcnt(0)
v_lshlrev_b32 v64, 16, v66
v_and_b32 v65, 0xffff0000, v66
v_add_f32 v48, v48, v64
v_add_f32 v49, v49, v65
v_lshlrev_b32 v64, 16, v67
v_and_b32 v65, 0xffff0000, v67
v_add_f32 v50, v50, v64
v_add_f32 v51, v51, v65
LE_fl28:
s_nop 3
v_cvt_pk_bf16_f32 v64, v48, v49
v_cvt_pk_bf16_f32 v65, v50, v51
v_mov_b32 v48, 0
v_mov_b32 v49, 0
v_mov_b32 v50, 0
v_mov_b32 v51, 0
buffer_store_dwordx2 v[64:65], v39, s[20:23], s47 offen sc1
s_add_u32 s47, s47, 512
LE_nf28:
v_mfma_f32_16x16x32_bf16 v[48:51], a[232:235], v[40:43], v[48:51]
v_mfma_f32_16x16x32_bf16 v[48:51], a[236:239], v[44:47], v[48:51]
s_bitcmp1_b32 s46, 29
s_cbranch_scc0 LE_nf29
s_cmp_eq_u32 s42, 0
s_cbranch_scc1 LE_fl29
buffer_load_dwordx2 v[66:67], v39, s[20:23], s47 offen sc1
s_waitcnt vmcnt(0)
v_lshlrev_b32 v64, 16, v66
v_and_b32 v65, 0xffff0000, v66
v_add_f32 v48, v48, v64
v_add_f32 v49, v49, v65
v_lshlrev_b32 v64, 16, v67
v_and_b32 v65, 0xffff0000, v67
v_add_f32 v50, v50, v64
v_add_f32 v51, v51, v65
LE_fl29:
s_nop 3
v_cvt_pk_bf16_f32 v64, v48, v49
v_cvt_pk_bf16_f32 v65, v50, v51
v_mov_b32 v48, 0
v_mov_b32 v49, 0
v_mov_b32 v50, 0
v_mov_b32 v51, 0
buffer_store_dwordx2 v[64:65], v39, s[20:23], s47 offen sc1
s_add_u32 s47, s47, 512
LE_nf29:
v_mfma_f32_16x16x32_bf16 v[48:51], a[240:243], v[40:43], v[48:51]
v_mfma_f32_16x16x32_bf16 v[48:51], a[244:247], v[44:47], v[48:51]
s_bitcmp1_b32 s46, 30
s_cbranch_scc0 LE_nf30
s_cmp_eq_u32 s42, 0
s_cbranch_scc1 LE_fl30
buffer_load_dwordx2 v[66:67], v39, s[20:23], s47 offen sc1
s_waitcnt vmcnt(0)
v_lshlrev_b32 v64, 16, v66
v_and_b32 v65, 0xffff0000, v66
v_add_f32 v48, v48, v64
v_add_f32 v49, v49, v65
v_lshlrev_b32 v64, 16, v67
v_and_b32 v65, 0xffff0000, v67
v_add_f32 v50, v50, v64
v_add_f32 v51, v51, v65
LE_fl30:
s_nop 3
v_cvt_pk_bf16_f32 v64, v48, v49
v_cvt_pk_bf16_f32 v65, v50, v51
v_mov_b32 v48, 0
v_mov_b32 v49, 0
v_mov_b32 v50, 0
v_mov_b32 v51, 0
buffer_store_dwordx2 v[64:65], v39, s[20:23], s47 offen sc1
s_add_u32 s47, s47, 512
LE_nf30:
v_mfma_f32_16x16x32_bf16 v[48:51], a[248:251], v[40:43], v[48:51]
v_mfma_f32_16x16x32_bf16 v[48:51], a[252:255], v[44:47], v[48:51]
s_bitcmp1_b32 s46, 31
s_cbranch_scc0 LE_nf31
s_cmp_eq_u32 s42, 0
s_cbranch_scc1 LE_fl31
buffer_load_dwordx2 v[66:67], v39, s[20:23], s47 offen sc1
s_waitcnt vmcnt(0)
v_lshlrev_b32 v64, 16, v66
v_and_b32 v65, 0xffff0000, v66
v_add_f32 v48, v48, v64
v_add_f32 v49, v49, v65
v_lshlrev_b32 v64, 16, v67
v_and_b32 v65, 0xffff0000, v67
v_add_f32 v50, v50, v64
v_add_f32 v51, v51, v65
LE_fl31:
s_nop 3
v_cvt_pk_bf16_f32 v64, v48, v49
v_cvt_pk_bf16_f32 v65, v50, v51
v_mov_b32 v48, 0
v_mov_b32 v49, 0
v_mov_b32 v50, 0
v_mov_b32 v51, 0
buffer_store_dwordx2 v[64:65], v39, s[20:23], s47 offen sc1
s_add_u32 s47, s47, 512
LE_nf31:
s_waitcnt lgkmcnt(0)
ds_read2_b32 v[52:53], v34 offset0:128 offset1:132
ds_read2_b32 v[54:55], v34 offset0:136 offset1:140
v_mad_u32_u16 v60, v56, s49, v2
v_mad_u32_u16 v61, v57, s49, v2
v_mad_u32_u16 v62, v58, s49, v2
v_mad_u32_u16 v63, v59, s49, v2
buffer_load_dwordx4 a[224:227], v60, s[16:19], 0 offen
buffer_load_dwordx4 a[228:231], v60, s[16:19], 0 offen offset:256
buffer_load_dwordx4 a[232:235], v61, s[16:19], 0 offen
buffer_load_dwordx4 a[236:239], v61, s[16:19], 0 offen offset:256
buffer_load_dwordx4 a[240:243], v62, s[16:19], 0 offen
buffer_load_dwordx4 a[244:247], v62, s[16:19], 0 offen offset:256
buffer_load_dwordx4 a[248:251], v63, s[16:19], 0 offen
buffer_load_dwordx4 a[252:255], v63, s[16:19], 0 offen offset:256
v_add_u32 v34, 512, v34
s_cmp_lt_u32 s45, s44
s_cbranch_scc1 LE_loop
s_add_u32 s42, s42, 1
s_mul_i32 s43, s42, 128
v_cmp_lt_u32 vcc, s43, v4
s_cbranch_vccz LE_done
s_cmp_ge_u32 s42, 40
s_cbranch_scc1 LE_done
s_waitcnt vmcnt(0) lgkmcnt(0)
s_add_u32 s50, s50, 512
v_add_u32 v5, 0x80, v5
buffer_load_dwordx4 v[192:195], v6, s[12:15], s50 offen offset:0
buffer_load_dwordx4 v[196:199], v6, s[12:15], s50 offen offset:32
buffer_load_dwordx4 v[200:203], v6, s[12:15], s50 offen offset:64
buffer_load_dwordx4 v[204:207], v6, s[12:15], s50 offen offset:96
buffer_load_dwordx4 v[208:211], v6, s[12:15], s50 offen offset:128
buffer_load_dwordx4 v[212:215], v6, s[12:15], s50 offen offset:160
buffer_load_dwordx4 v[216:219], v6, s[12:15], s50 offen offset:192
buffer_load_dwordx4 v[220:223], v6, s[12:15], s50 offen offset:224
buffer_load_dwordx4 v[224:227], v6, s[12:15], s50 offen offset:256
buffer_load_dwordx4 v[228:231], v6, s[12:15], s50 offen offset:288
buffer_load_dwordx4 v[232:235], v6, s[12:15], s50 offen offset:320
buffer_load_dwordx4 v[236:239], v6, s[12:15], s50 offen offset:352
buffer_load_dwordx4 v[240:243], v6, s[12:15], s50 offen offset:384
buffer_load_dwordx4 v[244:247], v6, s[12:15], s50 offen offset:416
buffer_load_dwordx4 v[248:251], v6, s[12:15], s50 offen offset:448
buffer_load_dwordx4 v[252:255], v6, s[12:15], s50 offen offset:480
s_branch LE_pass
LE_done:
s_add_u32 s52, s4, 0x7c00000
s_addc_u32 s53, s5, 0
s_mov_b32 s54, 0x2000
s_mov_b32 s55, 0x00020000
v_mov_b32 v20, 5120
v_mov_b32 v21, 1
s_mov_b64 exec, 1
s_waitcnt vmcnt(0)
buffer_atomic_add v21, v20, s[52:55], 0 offen
s_mov_b64 exec, -1
s_getpc_b64 s[52:53]
LE_pc:
s_sub_u32 s52, s52, LE_pc-L2_tails
s_subb_u32 s53, s53, 0
s_mov_b32 s54, LT_disp-L2_tails
s_mov_b32 s55, 0x00020000
s_mov_b64 exec, -1
v_lshlrev_b32 v30, 7, v1
s_mov_b32 s56, 0x0
buffer_load_dword v32, v30, s[52:55], s56 offen
s_mov_b32 s56, 0x2000
buffer_load_dword v33, v30, s[52:55], s56 offen
s_mov_b32 s56, 0x4000
buffer_load_dword v34, v30, s[52:55], s56 offen
s_mov_b32 s56, 0x6000
buffer_load_dword v35, v30, s[52:55], s56 offen
s_mov_b32 s56, 0x8000
buffer_load_dword v36, v30, s[52:55], s56 offen
s_mov_b32 s56, 0xa000
buffer_load_dword v37, v30, s[52:55], s56 offen
s_mov_b32 s56, 0xc000
buffer_load_dword v38, v30, s[52:55], s56 offen
s_cmp_ge_u32 s2, 240
s_cbranch_scc1 LC_help
s_branch L2_end
LC_help:
s_waitcnt vmcnt(0)
s_mov_b32 s100, 0
s_load_dwordx2 s[6:7], s[0:1], 0
s_load_dwordx2 s[16:17], s[0:1], 24
s_load_dwordx2 s[18:19], s[0:1], 72
s_mov_b32 s34, s41
v_mbcnt_lo_u32_b32 v252, -1, 0
v_mbcnt_hi_u32_b32 v252, -1, v252
v_lshlrev_b32 v252, 4, v252
s_and_b32 s32, s2, 7
s_mul_i32 s32, s32, 5
s_bfe_u32 s33, s2, 0x10003
s_mul_i32 s35, s33, 3
s_add_u32 s32, s32, s35
s_add_u32 s35, s32, 0
s_lshl_b32 s48, s35, 7
s_lshl_b32 s52, s35, 17
s_add_u32 s52, s52, 122880
s_add_u32 s35, s32, 1
s_lshl_b32 s49, s35, 7
s_lshl_b32 s53, s35, 17
s_add_u32 s53, s53, 122880
s_add_u32 s35, s32, 2
s_lshl_b32 s50, s35, 7
s_lshl_b32 s54, s35, 17
s_add_u32 s54, s54, 122880
s_cmp_eq_u32 s49, 4992
s_cselect_b32 s53, 5111808, s53
s_cmp_eq_u32 s33, 1
s_cselect_b32 s54, 0x7fff0000, s54
s_cselect_b32 s50, s48, s50
s_mov_b32 s15, 0x7fff0000
s_mov_b32 s14, 0
s_mov_b32 s99, 0
s_mov_b64 vcc, 0
s_waitcnt lgkmcnt(0)
s_add_u32 s24, s4, 0x6000000
s_addc_u32 s25, s5, 0
s_mov_b32 s26, 0x9c800
s_mov_b32 s27, 0x00020000
s_add_u32 s56, s4, 0x1000000
s_addc_u32 s57, s5, 0
s_mov_b32 s58, 0x6c02000
s_mov_b32 s59, 0x00020000
s_branch LC_common
L2_fin:
L2_end:
s_endpgm
.section .rodata,"a"
.p2align 6
.amdhsa_kernel k1_kernel
  .amdhsa_next_free_vgpr 256
  .amdhsa_next_free_sgpr 102
  .amdhsa_accum_offset 256
  .amdhsa_group_segment_fixed_size 0
  .amdhsa_kernarg_size 96
  .amdhsa_user_sgpr_count 2
  .amdhsa_user_sgpr_kernarg_segment_ptr 1
  .amdhsa_system_sgpr_workgroup_id_x 1
.end_amdhsa_kernel
.p2align 6
.amdhsa_kernel k2_kernel
  .amdhsa_next_free_vgpr 512
  .amdhsa_next_free_sgpr 102
  .amdhsa_accum_offset 256
  .amdhsa_group_segment_fixed_size 0
  .amdhsa_kernarg_size 96
  .amdhsa_user_sgpr_count 2
  .amdhsa_user_sgpr_kernarg_segment_ptr 1
  .amdhsa_system_sgpr_workgroup_id_x 1
.end_amdhsa_kernel
```

```asm
; @launch kernel=k1_kernel grid=(249,1,1) block=(512,1,1) lds=163840
; @launch kernel=k2_kernel grid=(256,1,1) block=(256,1,1) lds=163840
.amdgcn_target "amdgcn-amd-amdhsa--gfx950"
.text
.globl k1_kernel
.p2align 8
.type k1_kernel,@function
k1_kernel:
s_getpc_b64 s[56:57]
s_load_dwordx16 s[16:31], s[0:1], 0
s_load_dwordx8 s[32:39], s[0:1], 64
s_cmp_ge_u32 s2, 249
s_cbranch_scc1 L1_end
v_lshrrev_b32 v1, 6, v0
v_and_b32 v2, 63, v0
s_lshr_b32 s3, s2, 3
v_readfirstlane_b32 s60, v1
s_mul_i32 s5, s3, 8
s_add_u32 s5, s5, s60
s_and_b32 s56, s56, 0xffffff00
s_mov_b32 s58, L2_end-k1_kernel
s_mov_b32 s59, 0x00020000
s_and_b32 s6, s5, 15
s_lshl_b32 s6, s6, 13
v_lshlrev_b32 v10, 7, v2
buffer_load_dword v255, v10, s[56:59], s6 offen
v_and_b32 v3, 15, v2
v_lshrrev_b32 v4, 4, v2
s_and_b32 s62, s3, 7
s_sub_u32 s4, s2, 40
s_cmp_lt_u32 s2, 40
s_cbranch_scc1 L1_notq
s_mov_b32 s61, 0
v_lshlrev_b32 v16, 4, v2
s_mul_i32 s63, s60, 6144
s_mul_i32 s6, s4, 24576
s_mul_i32 s7, s60, 3072
s_add_u32 s64, s6, s7
s_add_u32 s65, s64, 4096
s_lshl_b32 s7, s60, 6
v_lshrrev_b32 v5, 2, v2
v_and_b32 v6, 3, v2
v_lshrrev_b32 v7, 5, v2
v_lshlrev_b32 v7, 1, v7
v_xor_b32 v6, v6, v7
v_lshl_add_u32 v5, v5, 9, s7
v_lshl_add_u32 v17, v6, 4, v5
v_add_u32 v18, 0x1c00, v17
s_xor_b32 s6, s62, 0
s_lshl_b32 s66, s6, 14
s_xor_b32 s6, s62, 1
s_lshl_b32 s67, s6, 14
s_xor_b32 s6, s62, 2
s_lshl_b32 s68, s6, 14
s_xor_b32 s6, s62, 3
s_lshl_b32 s69, s6, 14
s_xor_b32 s6, s62, 4
s_lshl_b32 s70, s6, 14
s_xor_b32 s6, s62, 5
s_lshl_b32 s71, s6, 14
s_xor_b32 s6, s62, 6
s_lshl_b32 s72, s6, 14
s_xor_b32 s6, s62, 7
s_lshl_b32 s73, s6, 14
s_waitcnt lgkmcnt(0)
s_add_u32 s40, s16, 0x0
s_addc_u32 s41, s17, 0
s_mov_b32 s42, 0x4e2000
s_mov_b32 s43, 0x00020000
s_add_u32 s44, s26, 0x0
s_addc_u32 s45, s27, 0
s_mov_b32 s46, 0x20000
s_mov_b32 s47, 0x00020000
buffer_load_dwordx4 v[40:43], v16, s[40:43], s64 offen offset:0
buffer_load_dwordx4 v[44:47], v16, s[40:43], s64 offen offset:1024
buffer_load_dwordx4 v[48:51], v16, s[40:43], s64 offen offset:2048
s_add_u32 m0, s63, 0x0
s_nop 0
buffer_load_dwordx4 v17, s[44:47], s66 offen offset:0 lds
buffer_load_dwordx4 v18, s[44:47], s66 offen offset:1024 lds
s_add_u32 m0, s63, 0x800
s_nop 0
buffer_load_dwordx4 v17, s[44:47], s67 offen offset:0 lds
buffer_load_dwordx4 v18, s[44:47], s67 offen offset:1024 lds
v_bfe_u32 v5, v2, 2, 3
v_xor_b32 v5, s62, v5
v_and_b32 v6, 3, v2
v_lshlrev_b32 v7, 10, v5
v_lshl_add_u32 v7, v6, 8, v7
v_add_u32 v7, 0xc000, v7
v_and_b32 v5, 1, v5
v_lshl_or_b32 v6, v5, 2, v6
v_lshrrev_b32 v5, 5, v2
s_mul_i32 s6, s60, 6
v_add3_u32 v8, v5, s6, 0
v_lshrrev_b32 v9, 4, v8
v_lshl_add_u32 v9, v9, 13, v7
v_and_b32 v8, 15, v8
v_xor_b32 v8, v8, v6
v_lshl_add_u32 v36, v8, 4, v9
v_add3_u32 v8, v5, s6, 2
v_lshrrev_b32 v9, 4, v8
v_lshl_add_u32 v9, v9, 13, v7
v_and_b32 v8, 15, v8
v_xor_b32 v8, v8, v6
v_lshl_add_u32 v37, v8, 4, v9
v_add3_u32 v8, v5, s6, 4
v_lshrrev_b32 v9, 4, v8
v_lshl_add_u32 v9, v9, 13, v7
v_and_b32 v8, 15, v8
v_xor_b32 v8, v8, v6
v_lshl_add_u32 v38, v8, 4, v9
v_xor_b32 v5, v3, v4
v_lshlrev_b32 v5, 4, v5
v_lshl_add_u32 v5, v4, 8, v5
v_add_u32 v31, 0xc000, v5
v_xor_b32 v32, 64, v31
v_lshrrev_b32 v5, 2, v3
v_and_b32 v6, 3, v3
v_and_b32 v7, 1, v4
v_lshlrev_b32 v7, 1, v7
v_lshl_add_u32 v8, v4, 3, v5
v_lshlrev_b32 v8, 6, v8
v_add_u32 v8, s63, v8
v_and_b32 v9, 1, v6
v_lshl_add_u32 v8, v9, 3, v8
v_lshrrev_b32 v6, 1, v6
v_xor_b32 v6, v6, v7
v_xor_b32 v9, 0, v6
v_lshl_add_u32 v25, v9, 4, v8
v_xor_b32 v9, 2, v6
v_lshl_add_u32 v26, v9, 4, v8
v_lshrrev_b32 v5, 3, v2
v_and_b32 v6, 7, v2
v_lshrrev_b32 v7, 1, v5
v_xor_b32 v6, v6, v7
v_and_b32 v7, 4, v5
v_add_u32 v5, v5, v7
s_mul_i32 s6, s60, 16384
v_lshl_add_u32 v5, v5, 9, s6
v_lshl_add_u32 v21, v6, 4, v5
v_xor_b32 v6, 4, v6
v_lshl_add_u32 v22, v6, 4, v5
v_add_u32 v22, 0x1c00, v22
s_lshr_b32 s7, s62, 1
s_xor_b32 s6, s7, 0
s_lshl_b32 s74, s6, 7
s_add_u32 s75, s74, 2048
s_xor_b32 s6, s7, 1
s_lshl_b32 s76, s6, 7
s_add_u32 s77, s76, 2048
s_xor_b32 s6, s7, 2
s_lshl_b32 s78, s6, 7
s_add_u32 s79, s78, 2048
s_xor_b32 s6, s7, 3
s_lshl_b32 s80, s6, 7
s_add_u32 s81, s80, 2048
s_and_b32 s6, s62, 1
s_lshl_b32 s6, s6, 2
v_lshrrev_b32 v5, 1, v3
v_xor_b32 v5, v5, v4
v_xor_b32 v5, s6, v5
v_lshl_add_u32 v6, v3, 7, s63
v_lshl_add_u32 v29, v5, 4, v6
v_xor_b32 v30, 64, v29
s_mul_i32 s6, s60, 1
s_xor_b32 s6, s6, s62
s_lshl_b32 s6, s6, 10
s_add_u32 s6, s6, 0x12000
v_lshrrev_b32 v5, 1, v4
v_and_b32 v6, 1, v4
v_lshl_add_u32 v5, v5, 8, s6
v_lshl_add_u32 v5, v6, 3, v5
v_lshl_add_u32 v33, v3, 4, v5
v_xor_b32 v34, 0x400, v33
v_add_u32 v35, 0x12000, v16
s_mul_i32 s6, s4, 24576
s_mul_i32 s7, s60, 1024
s_add_u32 s82, s6, s7
s_add_u32 s83, s82, 8192
s_add_u32 s84, s82, 16384
s_mov_b32 s86, 0x3db8aa3b
s_mov_b32 s87, 0x3db8aa3b
s_mov_b32 s88, 0x3727c5ac
s_mov_b32 s89, 0x3b800000
s_mov_b32 s90, 0xffff0000
s_add_u32 s48, s28, 0x0
s_addc_u32 s49, s29, 0
s_mov_b32 s50, 0x20000
s_mov_b32 s51, 0x00020000
s_add_u32 s52, s38, 0x0
s_addc_u32 s53, s39, 0
s_mov_b32 s54, 0x4e4000
s_mov_b32 s55, 0x00020000
s_add_u32 s56, s38, 0x6800000
s_addc_u32 s57, s39, 0
s_mov_b32 s58, 0x4e4000
s_mov_b32 s59, 0x00020000
v_lshlrev_b32 v5, 4, v4
s_lshr_b32 s6, s66, 8
buffer_load_dwordx4 v[172:175], v5, s[48:51], s6 offen
s_lshr_b32 s6, s67, 8
buffer_load_dwordx4 v[176:179], v5, s[48:51], s6 offen
s_lshr_b32 s6, s68, 8
buffer_load_dwordx4 v[180:183], v5, s[48:51], s6 offen
s_lshr_b32 s6, s69, 8
buffer_load_dwordx4 v[184:187], v5, s[48:51], s6 offen
s_lshr_b32 s6, s70, 8
buffer_load_dwordx4 v[188:191], v5, s[48:51], s6 offen
s_lshr_b32 s6, s71, 8
buffer_load_dwordx4 v[192:195], v5, s[48:51], s6 offen
s_lshr_b32 s6, s72, 8
buffer_load_dwordx4 v[196:199], v5, s[48:51], s6 offen
s_lshr_b32 s6, s73, 8
buffer_load_dwordx4 v[200:203], v5, s[48:51], s6 offen
s_waitcnt vmcnt(14)
v_lshlrev_b32 v76, 16, v40
v_and_b32 v77, s90, v40
v_lshlrev_b32 v78, 16, v41
v_and_b32 v79, s90, v41
v_lshlrev_b32 v80, 16, v42
v_and_b32 v81, s90, v42
v_lshlrev_b32 v82, 16, v43
v_and_b32 v83, s90, v43
v_pk_add_f32 v[100:101], v[76:77], v[78:79]
v_pk_mul_f32 v[102:103], v[76:77], v[76:77]
v_pk_add_f32 v[40:41], v[80:81], v[82:83]
v_pk_fma_f32 v[102:103], v[78:79], v[78:79], v[102:103]
v_pk_add_f32 v[100:101], v[100:101], v[40:41]
v_pk_fma_f32 v[102:103], v[80:81], v[80:81], v[102:103]
v_add_f32 v100, v100, v101
v_pk_fma_f32 v[102:103], v[82:83], v[82:83], v[102:103]
v_add_f32 v102, v102, v103
s_waitcnt vmcnt(13)
v_lshlrev_b32 v84, 16, v44
v_and_b32 v85, s90, v44
v_lshlrev_b32 v86, 16, v45
v_and_b32 v87, s90, v45
v_lshlrev_b32 v88, 16, v46
v_and_b32 v89, s90, v46
v_lshlrev_b32 v90, 16, v47
v_and_b32 v91, s90, v47
v_pk_add_f32 v[104:105], v[84:85], v[86:87]
v_pk_mul_f32 v[106:107], v[84:85], v[84:85]
v_pk_add_f32 v[44:45], v[88:89], v[90:91]
v_pk_fma_f32 v[106:107], v[86:87], v[86:87], v[106:107]
v_pk_add_f32 v[104:105], v[104:105], v[44:45]
v_pk_fma_f32 v[106:107], v[88:89], v[88:89], v[106:107]
v_add_f32 v104, v104, v105
v_pk_fma_f32 v[106:107], v[90:91], v[90:91], v[106:107]
v_add_f32 v106, v106, v107
s_waitcnt vmcnt(12)
v_lshlrev_b32 v92, 16, v48
v_and_b32 v93, s90, v48
v_lshlrev_b32 v94, 16, v49
v_and_b32 v95, s90, v49
v_lshlrev_b32 v96, 16, v50
v_and_b32 v97, s90, v50
v_lshlrev_b32 v98, 16, v51
v_and_b32 v99, s90, v51
v_pk_add_f32 v[108:109], v[92:93], v[94:95]
v_pk_mul_f32 v[110:111], v[92:93], v[92:93]
v_pk_add_f32 v[48:49], v[96:97], v[98:99]
v_pk_fma_f32 v[110:111], v[94:95], v[94:95], v[110:111]
v_pk_add_f32 v[108:109], v[108:109], v[48:49]
v_pk_fma_f32 v[110:111], v[96:97], v[96:97], v[110:111]
v_add_f32 v108, v108, v109
v_pk_fma_f32 v[110:111], v[98:99], v[98:99], v[110:111]
v_add_f32 v110, v110, v111
v_permlane16_swap_b32 v100, v102
v_permlane16_swap_b32 v104, v106
v_permlane16_swap_b32 v108, v110
v_add_f32 v100, v100, v102
v_add_f32 v104, v104, v106
v_add_f32 v108, v108, v110
v_add_f32_dpp v101, v100, v100 row_ror:8 row_mask:0xf bank_mask:0x3
v_add_f32_dpp v101, v104, v104 row_ror:8 row_mask:0xf bank_mask:0xc
v_add_f32_dpp v109, v108, v108 row_ror:8 row_mask:0xf bank_mask:0xf
s_nop 0
v_add_f32_dpp v102, v101, v101 row_half_mirror row_mask:0xf bank_mask:0x5
v_add_f32_dpp v102, v109, v109 row_half_mirror row_mask:0xf bank_mask:0xa
s_nop 1
v_add_f32_dpp v102, v102, v102 quad_perm:[1,0,3,2] row_mask:0xf bank_mask:0xf
s_nop 1
v_add_f32_dpp v102, v102, v102 quad_perm:[2,3,0,1] row_mask:0xf bank_mask:0xf
v_mov_b32 v103, v102
s_nop 1
v_permlane16_swap_b32 v103, v102
v_mul_f32 v103, s89, v103
v_mul_f32 v102, s89, v102
v_fma_f32 v102, -v103, v103, v102
v_max_f32 v102, 0, v102
v_cvt_pk_bf16_f32 v102, v102, v102
v_and_b32 v102, s90, v102
v_add_f32 v102, s88, v102
v_cvt_pk_bf16_f32 v102, v102, v102
v_and_b32 v102, s90, v102
v_sqrt_f32 v102, v102
s_nop 0
v_cvt_pk_bf16_f32 v102, v102, v102
v_and_b32 v102, s90, v102
v_rcp_f32 v102, v102
s_nop 0
v_mul_f32 v103, -v103, v102
s_nop 1
v_mov_b64_dpp v[100:101], v[102:103] row_newbcast:0 row_mask:0xf bank_mask:0xf
v_mov_b64_dpp v[104:105], v[102:103] row_newbcast:8 row_mask:0xf bank_mask:0xf
v_mov_b64_dpp v[108:109], v[102:103] row_newbcast:4 row_mask:0xf bank_mask:0xf
v_fma_f32 v76, v76, v100, v101
v_fma_f32 v77, v77, v100, v101
v_fma_f32 v78, v78, v100, v101
v_fma_f32 v79, v79, v100, v101
v_fma_f32 v80, v80, v100, v101
v_fma_f32 v81, v81, v100, v101
v_fma_f32 v82, v82, v100, v101
v_fma_f32 v83, v83, v100, v101
v_cvt_pk_bf16_f32 v40, v76, v77
v_cvt_pk_bf16_f32 v41, v78, v79
v_cvt_pk_bf16_f32 v42, v80, v81
v_cvt_pk_bf16_f32 v43, v82, v83
ds_write_b128 v36, v[40:43]
v_fma_f32 v84, v84, v104, v105
v_fma_f32 v85, v85, v104, v105
v_fma_f32 v86, v86, v104, v105
v_fma_f32 v87, v87, v104, v105
v_fma_f32 v88, v88, v104, v105
v_fma_f32 v89, v89, v104, v105
v_fma_f32 v90, v90, v104, v105
v_fma_f32 v91, v91, v104, v105
v_cvt_pk_bf16_f32 v44, v84, v85
v_cvt_pk_bf16_f32 v45, v86, v87
v_cvt_pk_bf16_f32 v46, v88, v89
v_cvt_pk_bf16_f32 v47, v90, v91
ds_write_b128 v37, v[44:47]
v_fma_f32 v92, v92, v108, v109
v_fma_f32 v93, v93, v108, v109
v_fma_f32 v94, v94, v108, v109
v_fma_f32 v95, v95, v108, v109
v_fma_f32 v96, v96, v108, v109
v_fma_f32 v97, v97, v108, v109
v_fma_f32 v98, v98, v108, v109
v_fma_f32 v99, v99, v108, v109
v_cvt_pk_bf16_f32 v48, v92, v93
v_cvt_pk_bf16_f32 v49, v94, v95
v_cvt_pk_bf16_f32 v50, v96, v97
v_cvt_pk_bf16_f32 v51, v98, v99
ds_write_b128 v38, v[48:51]
s_add_u32 m0, s63, 0x1000
s_nop 0
buffer_load_dwordx4 v17, s[44:47], s68 offen offset:0 lds
buffer_load_dwordx4 v18, s[44:47], s68 offen offset:1024 lds
s_waitcnt vmcnt(12)
ds_read_b64_tr_b16 v[100:101], v25 offset:0
ds_read_b64_tr_b16 v[102:103], v25 offset:256
ds_read_b64_tr_b16 v[104:105], v26 offset:0
ds_read_b64_tr_b16 v[106:107], v26 offset:256
s_waitcnt lgkmcnt(4)
s_barrier
ds_read_b128 v[124:127], v31 offset:0
ds_read_b128 v[128:131], v31 offset:8192
ds_read_b128 v[132:135], v31 offset:16384
ds_read_b128 v[136:139], v32 offset:1024
s_waitcnt vmcnt(10)
ds_read_b64_tr_b16 v[108:109], v25 offset:2048
ds_read_b64_tr_b16 v[110:111], v25 offset:2304
s_waitcnt lgkmcnt(5)
v_mfma_f32_16x16x32_bf16 v[52:55], v[100:103], v[124:127], 0
ds_read_b128 v[140:143], v32 offset:9216
s_waitcnt lgkmcnt(5)
v_mfma_f32_16x16x32_bf16 v[56:59], v[100:103], v[128:131], 0
ds_read_b128 v[144:147], v32 offset:17408
s_waitcnt lgkmcnt(5)
v_mfma_f32_16x16x32_bf16 v[60:63], v[100:103], v[132:135], 0
ds_read_b64_tr_b16 v[112:113], v26 offset:2048
ds_read_b64_tr_b16 v[114:115], v26 offset:2304
v_mfma_f32_16x16x32_bf16 v[64:67], v[104:107], v[124:127], 0
s_add_u32 m0, s63, 0x0
s_nop 0
buffer_load_dwordx4 v17, s[44:47], s69 offen offset:0 lds
buffer_load_dwordx4 v18, s[44:47], s69 offen offset:1024 lds
v_mfma_f32_16x16x32_bf16 v[68:71], v[104:107], v[128:131], 0
v_and_b32 v5, 31, v2
v_lshrrev_b32 v6, 5, v2
v_mfma_f32_16x16x32_bf16 v[72:75], v[104:107], v[132:135], 0
ds_read_b128 v[148:151], v31 offset:2048
s_waitcnt vmcnt(2)
ds_read_b64_tr_b16 v[116:117], v25 offset:4096
ds_read_b64_tr_b16 v[118:119], v25 offset:4352
s_waitcnt lgkmcnt(7)
v_mfma_f32_16x16x32_bf16 v[52:55], v[108:111], v[136:139], v[52:55]
ds_read_b128 v[152:155], v31 offset:10240
s_lshr_b32 s6, s64, 9
s_waitcnt lgkmcnt(7)
v_mfma_f32_16x16x32_bf16 v[56:59], v[108:111], v[140:143], v[56:59]
ds_read_b128 v[156:159], v31 offset:18432
v_cmp_eq_u32 vcc, 0, v5
s_waitcnt lgkmcnt(7)
v_mfma_f32_16x16x32_bf16 v[60:63], v[108:111], v[144:147], v[60:63]
ds_read_b64_tr_b16 v[120:121], v26 offset:4096
ds_read_b64_tr_b16 v[122:123], v26 offset:4352
s_waitcnt lgkmcnt(7)
v_mfma_f32_16x16x32_bf16 v[64:67], v[112:115], v[136:139], v[64:67]
s_add_u32 m0, s63, 0x800
s_nop 0
buffer_load_dwordx4 v17, s[44:47], s70 offen offset:0 lds
buffer_load_dwordx4 v18, s[44:47], s70 offen offset:1024 lds
v_mfma_f32_16x16x32_bf16 v[68:71], v[112:115], v[140:143], v[68:71]
s_sub_u32 s6, 10000, s6
v_mov_b32 v7, 0x7fffffff
v_mfma_f32_16x16x32_bf16 v[72:75], v[112:115], v[144:147], v[72:75]
ds_read_b128 v[160:163], v32 offset:3072
s_waitcnt vmcnt(2)
ds_read_b64_tr_b16 v[100:101], v25 offset:0
ds_read_b64_tr_b16 v[102:103], v25 offset:256
s_waitcnt lgkmcnt(7)
v_mfma_f32_16x16x32_bf16 v[52:55], v[116:119], v[148:151], v[52:55]
ds_read_b128 v[164:167], v32 offset:11264
v_cndmask_b32 v6, v7, v6, vcc
s_waitcnt lgkmcnt(7)
v_mfma_f32_16x16x32_bf16 v[56:59], v[116:119], v[152:155], v[56:59]
ds_read_b128 v[168:171], v32 offset:19456
v_cmp_gt_i32 vcc, s6, v6
s_waitcnt lgkmcnt(7)
v_mfma_f32_16x16x32_bf16 v[60:63], v[116:119], v[156:159], v[60:63]
ds_read_b64_tr_b16 v[104:105], v26 offset:0
ds_read_b64_tr_b16 v[106:107], v26 offset:256
s_waitcnt lgkmcnt(7)
v_mfma_f32_16x16x32_bf16 v[64:67], v[120:123], v[148:151], v[64:67]
s_add_u32 m0, s63, 0x1000
s_nop 0
buffer_load_dwordx4 v17, s[44:47], s71 offen offset:0 lds
buffer_load_dwordx4 v18, s[44:47], s71 offen offset:1024 lds
v_mfma_f32_16x16x32_bf16 v[68:71], v[120:123], v[152:155], v[68:71]
v_and_b32 v5, s90, v40
v_or_b32 v5, 0x3f80, v5
v_mfma_f32_16x16x32_bf16 v[72:75], v[120:123], v[156:159], v[72:75]
ds_read_b128 v[124:127], v31 offset:4096
s_waitcnt vmcnt(2)
ds_read_b64_tr_b16 v[108:109], v25 offset:2048
ds_read_b64_tr_b16 v[110:111], v25 offset:2304
s_waitcnt lgkmcnt(7)
v_mfma_f32_16x16x32_bf16 v[52:55], v[100:103], v[160:163], v[52:55]
ds_read_b128 v[128:131], v31 offset:12288
s_sub_u32 s6, s6, 2
s_waitcnt lgkmcnt(7)
v_mfma_f32_16x16x32_bf16 v[56:59], v[100:103], v[164:167], v[56:59]
ds_read_b128 v[132:135], v31 offset:20480
v_cndmask_b32 v40, v40, v5, vcc
s_waitcnt lgkmcnt(7)
v_mfma_f32_16x16x32_bf16 v[60:63], v[100:103], v[168:171], v[60:63]
ds_read_b64_tr_b16 v[112:113], v26 offset:2048
ds_read_b64_tr_b16 v[114:115], v26 offset:2304
s_waitcnt lgkmcnt(7)
v_mfma_f32_16x16x32_bf16 v[64:67], v[104:107], v[160:163], v[64:67]
s_add_u32 m0, s63, 0x0
s_nop 0
buffer_load_dwordx4 v17, s[44:47], s72 offen offset:0 lds
buffer_load_dwordx4 v18, s[44:47], s72 offen offset:1024 lds
v_mfma_f32_16x16x32_bf16 v[68:71], v[104:107], v[164:167], v[68:71]
v_cmp_gt_i32 vcc, s6, v6
v_and_b32 v5, s90, v44
v_mfma_f32_16x16x32_bf16 v[72:75], v[104:107], v[168:171], v[72:75]
ds_read_b128 v[136:139], v32 offset:5120
s_waitcnt vmcnt(2)
ds_read_b64_tr_b16 v[116:117], v25 offset:4096
ds_read_b64_tr_b16 v[118:119], v25 offset:4352
s_waitcnt lgkmcnt(7)
v_mfma_f32_16x16x32_bf16 v[52:55], v[108:111], v[124:127], v[52:55]
ds_read_b128 v[140:143], v32 offset:13312
v_or_b32 v5, 0x3f80, v5
s_waitcnt lgkmcnt(7)
v_mfma_f32_16x16x32_bf16 v[56:59], v[108:111], v[128:131], v[56:59]
ds_read_b128 v[144:147], v32 offset:21504
s_sub_u32 s6, s6, 2
s_waitcnt lgkmcnt(7)
v_mfma_f32_16x16x32_bf16 v[60:63], v[108:111], v[132:135], v[60:63]
ds_read_b64_tr_b16 v[120:121], v26 offset:4096
ds_read_b64_tr_b16 v[122:123], v26 offset:4352
s_waitcnt lgkmcnt(7)
v_mfma_f32_16x16x32_bf16 v[64:67], v[112:115], v[124:127], v[64:67]
s_add_u32 m0, s63, 0x800
s_nop 0
buffer_load_dwordx4 v17, s[44:47], s73 offen offset:0 lds
buffer_load_dwordx4 v18, s[44:47], s73 offen offset:1024 lds
v_mfma_f32_16x16x32_bf16 v[68:71], v[112:115], v[128:131], v[68:71]
v_cndmask_b32 v44, v44, v5, vcc
v_cmp_gt_i32 vcc, s6, v6
v_mfma_f32_16x16x32_bf16 v[72:75], v[112:115], v[132:135], v[72:75]
ds_read_b128 v[148:151], v31 offset:6144
s_waitcnt vmcnt(2)
ds_read_b64_tr_b16 v[100:101], v25 offset:0
ds_read_b64_tr_b16 v[102:103], v25 offset:256
s_waitcnt lgkmcnt(7)
v_mfma_f32_16x16x32_bf16 v[52:55], v[116:119], v[136:139], v[52:55]
ds_read_b128 v[152:155], v31 offset:14336
v_and_b32 v5, s90, v48
s_waitcnt lgkmcnt(7)
v_mfma_f32_16x16x32_bf16 v[56:59], v[116:119], v[140:143], v[56:59]
ds_read_b128 v[156:159], v31 offset:22528
v_or_b32 v5, 0x3f80, v5
s_waitcnt lgkmcnt(7)
v_mfma_f32_16x16x32_bf16 v[60:63], v[116:119], v[144:147], v[60:63]
ds_read_b64_tr_b16 v[104:105], v26 offset:0
ds_read_b64_tr_b16 v[106:107], v26 offset:256
s_waitcnt lgkmcnt(7)
v_mfma_f32_16x16x32_bf16 v[64:67], v[120:123], v[136:139], v[64:67]
s_add_u32 m0, s63, 0x1000
s_nop 0
buffer_load_dwordx4 v21, s[48:51], s74 offen offset:0 lds
buffer_load_dwordx4 v22, s[48:51], s74 offen offset:1024 lds
v_mfma_f32_16x16x32_bf16 v[68:71], v[120:123], v[140:143], v[68:71]
s_sub_u32 s6, s6, 2
v_cndmask_b32 v48, v48, v5, vcc
v_mfma_f32_16x16x32_bf16 v[72:75], v[120:123], v[144:147], v[72:75]
ds_read_b128 v[160:163], v32 offset:7168
s_waitcnt vmcnt(2)
ds_read_b64_tr_b16 v[108:109], v25 offset:2048
ds_read_b64_tr_b16 v[110:111], v25 offset:2304
s_waitcnt lgkmcnt(7)
v_mfma_f32_16x16x32_bf16 v[52:55], v[100:103], v[148:151], v[52:55]
ds_read_b128 v[164:167], v32 offset:15360
s_waitcnt lgkmcnt(7)
v_mfma_f32_16x16x32_bf16 v[56:59], v[100:103], v[152:155], v[56:59]
ds_read_b128 v[168:171], v32 offset:23552
s_waitcnt lgkmcnt(7)
v_mfma_f32_16x16x32_bf16 v[60:63], v[100:103], v[156:159], v[60:63]
ds_read_b64_tr_b16 v[112:113], v26 offset:2048
ds_read_b64_tr_b16 v[114:115], v26 offset:2304
s_waitcnt lgkmcnt(7)
v_mfma_f32_16x16x32_bf16 v[64:67], v[104:107], v[148:151], v[64:67]
s_add_u32 m0, s63, 0x0
s_nop 0
buffer_load_dwordx4 v21, s[48:51], s75 offen offset:0 lds
buffer_load_dwordx4 v22, s[48:51], s75 offen offset:1024 lds
v_mfma_f32_16x16x32_bf16 v[68:71], v[104:107], v[152:155], v[68:71]
v_mfma_f32_16x16x32_bf16 v[72:75], v[104:107], v[156:159], v[72:75]
s_waitcnt lgkmcnt(4)
v_mfma_f32_16x16x32_bf16 v[52:55], v[108:111], v[160:163], v[52:55]
s_waitcnt lgkmcnt(3)
v_mfma_f32_16x16x32_bf16 v[56:59], v[108:111], v[164:167], v[56:59]
s_waitcnt lgkmcnt(2)
v_mfma_f32_16x16x32_bf16 v[60:63], v[108:111], v[168:171], v[60:63]
s_waitcnt lgkmcnt(0)
v_mfma_f32_16x16x32_bf16 v[64:67], v[112:115], v[160:163], v[64:67]
s_nop 1
v_cvt_pk_bf16_f32 v52, v52, v53
v_cvt_pk_bf16_f32 v53, v54, v55
ds_write_b64 v33, v[52:53] offset:0
s_add_u32 m0, s63, 0x800
s_nop 0
buffer_load_dwordx4 v21, s[48:51], s76 offen offset:0 lds
buffer_load_dwordx4 v22, s[48:51], s76 offen offset:1024 lds
v_mfma_f32_16x16x32_bf16 v[68:71], v[112:115], v[164:167], v[68:71]
v_cvt_pk_bf16_f32 v56, v56, v57
v_cvt_pk_bf16_f32 v57, v58, v59
ds_write_b64 v33, v[56:57] offset:8192
v_mfma_f32_16x16x32_bf16 v[72:75], v[112:115], v[168:171], v[72:75]
v_cvt_pk_bf16_f32 v60, v60, v61
v_cvt_pk_bf16_f32 v61, v62, v63
ds_write_b64 v33, v[60:61] offset:16384
v_cvt_pk_bf16_f32 v64, v64, v65
v_cvt_pk_bf16_f32 v65, v66, v67
ds_write_b64 v33, v[64:65] offset:512
v_cvt_pk_bf16_f32 v68, v68, v69
v_cvt_pk_bf16_f32 v69, v70, v71
ds_write_b64 v33, v[68:69] offset:8704
v_cvt_pk_bf16_f32 v72, v72, v73
v_cvt_pk_bf16_f32 v73, v74, v75
ds_write_b64 v33, v[72:73] offset:16896
s_waitcnt vmcnt(4)
ds_read_b128 v[116:119], v29 offset:4096
ds_read_b128 v[120:123], v30 offset:4096
s_waitcnt lgkmcnt(2)
s_barrier
ds_read_b128 v[124:127], v35 offset:0
ds_read_b128 v[128:131], v35 offset:8192
ds_read_b128 v[132:135], v35 offset:16384
ds_read_b128 v[136:139], v35 offset:1024
s_waitcnt lgkmcnt(3)
v_mfma_f32_16x16x32_bf16 v[76:79], v[116:119], v[124:127], 0
ds_read_b128 v[140:143], v35 offset:9216
s_waitcnt lgkmcnt(3)
v_mfma_f32_16x16x32_bf16 v[84:87], v[116:119], v[128:131], 0
ds_read_b128 v[144:147], v35 offset:17408
s_waitcnt lgkmcnt(3)
v_mfma_f32_16x16x32_bf16 v[92:95], v[116:119], v[132:135], 0
v_mfma_f32_16x16x32_bf16 v[204:207], v[172:175], v[124:127], 0
v_mfma_f32_16x16x32_bf16 v[208:211], v[172:175], v[128:131], 0
v_mfma_f32_16x16x32_bf16 v[212:215], v[172:175], v[132:135], 0
s_waitcnt vmcnt(2)
ds_read_b128 v[100:103], v29 offset:0
s_waitcnt lgkmcnt(3)
v_mfma_f32_16x16x32_bf16 v[76:79], v[120:123], v[136:139], v[76:79]
s_add_u32 m0, s63, 0x1000
s_nop 0
buffer_load_dwordx4 v21, s[48:51], s77 offen offset:0 lds
buffer_load_dwordx4 v22, s[48:51], s77 offen offset:1024 lds
s_waitcnt lgkmcnt(2)
v_mfma_f32_16x16x32_bf16 v[84:87], v[120:123], v[140:143], v[84:87]
s_waitcnt lgkmcnt(1)
v_mfma_f32_16x16x32_bf16 v[92:95], v[120:123], v[144:147], v[92:95]
ds_read_b128 v[104:107], v30 offset:0
v_mfma_f32_16x16x32_bf16 v[204:207], v[176:179], v[136:139], v[204:207]
v_mfma_f32_16x16x32_bf16 v[208:211], v[176:179], v[140:143], v[208:211]
v_mfma_f32_16x16x32_bf16 v[212:215], v[176:179], v[144:147], v[212:215]
ds_read_b128 v[148:151], v35 offset:2048
s_waitcnt vmcnt(2)
ds_read_b128 v[108:111], v29 offset:2048
s_waitcnt lgkmcnt(3)
v_mfma_f32_16x16x32_bf16 v[80:83], v[100:103], v[124:127], 0
ds_read_b128 v[152:155], v35 offset:10240
v_mfma_f32_16x16x32_bf16 v[88:91], v[100:103], v[128:131], 0
ds_read_b128 v[156:159], v35 offset:18432
v_mfma_f32_16x16x32_bf16 v[96:99], v[100:103], v[132:135], 0
s_waitcnt lgkmcnt(4)
v_mfma_f32_16x16x32_bf16 v[80:83], v[104:107], v[136:139], v[80:83]
s_add_u32 m0, s63, 0x0
s_nop 0
buffer_load_dwordx4 v21, s[48:51], s78 offen offset:0 lds
buffer_load_dwordx4 v22, s[48:51], s78 offen offset:1024 lds
v_mfma_f32_16x16x32_bf16 v[88:91], v[104:107], v[140:143], v[88:91]
v_mfma_f32_16x16x32_bf16 v[96:99], v[104:107], v[144:147], v[96:99]
ds_read_b128 v[160:163], v35 offset:3072
ds_read_b128 v[112:115], v30 offset:2048
s_waitcnt lgkmcnt(4)
v_mfma_f32_16x16x32_bf16 v[76:79], v[108:111], v[148:151], v[76:79]
ds_read_b128 v[164:167], v35 offset:11264
s_waitcnt lgkmcnt(4)
v_mfma_f32_16x16x32_bf16 v[84:87], v[108:111], v[152:155], v[84:87]
ds_read_b128 v[168:171], v35 offset:19456
s_waitcnt lgkmcnt(4)
v_mfma_f32_16x16x32_bf16 v[92:95], v[108:111], v[156:159], v[92:95]
v_mfma_f32_16x16x32_bf16 v[204:207], v[180:183], v[148:151], v[204:207]
v_mfma_f32_16x16x32_bf16 v[208:211], v[180:183], v[152:155], v[208:211]
v_mfma_f32_16x16x32_bf16 v[212:215], v[180:183], v[156:159], v[212:215]
s_waitcnt vmcnt(2)
ds_read_b128 v[116:119], v29 offset:4096
s_waitcnt lgkmcnt(3)
v_mfma_f32_16x16x32_bf16 v[76:79], v[112:115], v[160:163], v[76:79]
s_add_u32 m0, s63, 0x800
s_nop 0
buffer_load_dwordx4 v21, s[48:51], s79 offen offset:0 lds
buffer_load_dwordx4 v22, s[48:51], s79 offen offset:1024 lds
s_waitcnt lgkmcnt(2)
v_mfma_f32_16x16x32_bf16 v[84:87], v[112:115], v[164:167], v[84:87]
s_waitcnt lgkmcnt(1)
v_mfma_f32_16x16x32_bf16 v[92:95], v[112:115], v[168:171], v[92:95]
ds_read_b128 v[120:123], v30 offset:4096
v_mfma_f32_16x16x32_bf16 v[204:207], v[184:187], v[160:163], v[204:207]
v_mfma_f32_16x16x32_bf16 v[208:211], v[184:187], v[164:167], v[208:211]
v_mfma_f32_16x16x32_bf16 v[212:215], v[184:187], v[168:171], v[212:215]
ds_read_b128 v[124:127], v35 offset:4096
s_waitcnt vmcnt(2)
ds_read_b128 v[100:103], v29 offset:0
s_waitcnt lgkmcnt(3)
v_mfma_f32_16x16x32_bf16 v[80:83], v[116:119], v[148:151], v[80:83]
ds_read_b128 v[128:131], v35 offset:12288
v_mfma_f32_16x16x32_bf16 v[88:91], v[116:119], v[152:155], v[88:91]
ds_read_b128 v[132:135], v35 offset:20480
v_mfma_f32_16x16x32_bf16 v[96:99], v[116:119], v[156:159], v[96:99]
s_waitcnt lgkmcnt(4)
v_mfma_f32_16x16x32_bf16 v[80:83], v[120:123], v[160:163], v[80:83]
s_add_u32 m0, s63, 0x1000
s_nop 0
buffer_load_dwordx4 v21, s[48:51], s80 offen offset:0 lds
buffer_load_dwordx4 v22, s[48:51], s80 offen offset:1024 lds
v_mfma_f32_16x16x32_bf16 v[88:91], v[120:123], v[164:167], v[88:91]
v_mfma_f32_16x16x32_bf16 v[96:99], v[120:123], v[168:171], v[96:99]
ds_read_b128 v[136:139], v35 offset:5120
ds_read_b128 v[104:107], v30 offset:0
s_waitcnt lgkmcnt(4)
v_mfma_f32_16x16x32_bf16 v[76:79], v[100:103], v[124:127], v[76:79]
ds_read_b128 v[140:143], v35 offset:13312
s_waitcnt lgkmcnt(4)
v_mfma_f32_16x16x32_bf16 v[84:87], v[100:103], v[128:131], v[84:87]
ds_read_b128 v[144:147], v35 offset:21504
s_waitcnt lgkmcnt(4)
v_mfma_f32_16x16x32_bf16 v[92:95], v[100:103], v[132:135], v[92:95]
v_mfma_f32_16x16x32_bf16 v[204:207], v[188:191], v[124:127], v[204:207]
v_mfma_f32_16x16x32_bf16 v[208:211], v[188:191], v[128:131], v[208:211]
v_mfma_f32_16x16x32_bf16 v[212:215], v[188:191], v[132:135], v[212:215]
s_waitcnt vmcnt(2)
ds_read_b128 v[108:111], v29 offset:2048
s_waitcnt lgkmcnt(3)
v_mfma_f32_16x16x32_bf16 v[76:79], v[104:107], v[136:139], v[76:79]
s_add_u32 m0, s63, 0x0
s_nop 0
buffer_load_dwordx4 v21, s[48:51], s81 offen offset:0 lds
buffer_load_dwordx4 v22, s[48:51], s81 offen offset:1024 lds
s_waitcnt lgkmcnt(2)
v_mfma_f32_16x16x32_bf16 v[84:87], v[104:107], v[140:143], v[84:87]
buffer_store_dwordx4 v[40:43], v16, s[56:59], s64 offen offset:0 sc1
buffer_store_dwordx4 v[44:47], v16, s[56:59], s64 offen offset:1024 sc1
s_waitcnt lgkmcnt(1)
v_mfma_f32_16x16x32_bf16 v[92:95], v[104:107], v[144:147], v[92:95]
ds_read_b128 v[112:115], v30 offset:2048
buffer_store_dwordx4 v[48:51], v16, s[56:59], s64 offen offset:2048 sc1
v_mfma_f32_16x16x32_bf16 v[204:207], v[192:195], v[136:139], v[204:207]
v_mfma_f32_16x16x32_bf16 v[208:211], v[192:195], v[140:143], v[208:211]
v_mfma_f32_16x16x32_bf16 v[212:215], v[192:195], v[144:147], v[212:215]
ds_read_b128 v[148:151], v35 offset:6144
s_waitcnt vmcnt(5)
ds_read_b128 v[116:119], v29 offset:4096
s_waitcnt lgkmcnt(3)
v_mfma_f32_16x16x32_bf16 v[80:83], v[108:111], v[124:127], v[80:83]
ds_read_b128 v[152:155], v35 offset:14336
v_mfma_f32_16x16x32_bf16 v[88:91], v[108:111], v[128:131], v[88:91]
ds_read_b128 v[156:159], v35 offset:22528
v_mfma_f32_16x16x32_bf16 v[96:99], v[108:111], v[132:135], v[96:99]
s_waitcnt lgkmcnt(4)
v_mfma_f32_16x16x32_bf16 v[80:83], v[112:115], v[136:139], v[80:83]
v_mfma_f32_16x16x32_bf16 v[88:91], v[112:115], v[140:143], v[88:91]
v_mfma_f32_16x16x32_bf16 v[96:99], v[112:115], v[144:147], v[96:99]
ds_read_b128 v[160:163], v35 offset:7168
ds_read_b128 v[120:123], v30 offset:4096
s_waitcnt lgkmcnt(4)
v_mfma_f32_16x16x32_bf16 v[76:79], v[116:119], v[148:151], v[76:79]
ds_read_b128 v[164:167], v35 offset:15360
s_waitcnt lgkmcnt(4)
v_mfma_f32_16x16x32_bf16 v[84:87], v[116:119], v[152:155], v[84:87]
ds_read_b128 v[168:171], v35 offset:23552
s_waitcnt lgkmcnt(4)
v_mfma_f32_16x16x32_bf16 v[92:95], v[116:119], v[156:159], v[92:95]
v_mfma_f32_16x16x32_bf16 v[204:207], v[196:199], v[148:151], v[204:207]
v_mfma_f32_16x16x32_bf16 v[208:211], v[196:199], v[152:155], v[208:211]
v_mfma_f32_16x16x32_bf16 v[212:215], v[196:199], v[156:159], v[212:215]
s_waitcnt vmcnt(3)
ds_read_b128 v[100:103], v29 offset:0
s_waitcnt lgkmcnt(3)
v_mfma_f32_16x16x32_bf16 v[76:79], v[120:123], v[160:163], v[76:79]
s_waitcnt lgkmcnt(2)
v_mfma_f32_16x16x32_bf16 v[84:87], v[120:123], v[164:167], v[84:87]
s_waitcnt lgkmcnt(1)
v_mfma_f32_16x16x32_bf16 v[92:95], v[120:123], v[168:171], v[92:95]
ds_read_b128 v[104:107], v30 offset:0
v_mfma_f32_16x16x32_bf16 v[204:207], v[200:203], v[160:163], v[204:207]
v_mfma_f32_16x16x32_bf16 v[208:211], v[200:203], v[164:167], v[208:211]
v_mfma_f32_16x16x32_bf16 v[212:215], v[200:203], v[168:171], v[212:215]
s_waitcnt lgkmcnt(1)
v_mfma_f32_16x16x32_bf16 v[80:83], v[100:103], v[148:151], v[80:83]
s_nop 3
v_mul_f32 v204, -v204, s86
v_mfma_f32_16x16x32_bf16 v[88:91], v[100:103], v[152:155], v[88:91]
v_mul_f32 v208, -v208, s86
v_mfma_f32_16x16x32_bf16 v[96:99], v[100:103], v[156:159], v[96:99]
v_mul_f32 v212, -v212, s86
s_waitcnt lgkmcnt(0)
v_mfma_f32_16x16x32_bf16 v[80:83], v[104:107], v[160:163], v[80:83]
v_mfma_f32_16x16x32_bf16 v[88:91], v[104:107], v[164:167], v[88:91]
v_mfma_f32_16x16x32_bf16 v[96:99], v[104:107], v[168:171], v[96:99]
v_fma_f32 v76, v76, s86, v204
v_fma_f32 v77, v77, s86, v204
v_fma_f32 v78, v78, s86, v204
v_fma_f32 v79, v79, s86, v204
s_nop 1
v_fma_f32 v80, v80, s86, v204
v_fma_f32 v81, v81, s86, v204
v_fma_f32 v82, v82, s86, v204
v_fma_f32 v83, v83, s86, v204
v_cvt_pk_bf16_f32 v76, v76, v77
v_cvt_pk_bf16_f32 v77, v78, v79
v_cvt_pk_bf16_f32 v78, v80, v81
v_cvt_pk_bf16_f32 v79, v82, v83
buffer_store_dwordx4 v[76:79], v16, s[52:55], s82 offen offset:0 sc1
v_fma_f32 v84, v84, s86, v208
v_fma_f32 v85, v85, s86, v208
v_fma_f32 v86, v86, s86, v208
v_fma_f32 v87, v87, s86, v208
v_fma_f32 v88, v88, s86, v208
v_fma_f32 v89, v89, s86, v208
v_fma_f32 v90, v90, s86, v208
v_fma_f32 v91, v91, s86, v208
v_cvt_pk_bf16_f32 v84, v84, v85
v_cvt_pk_bf16_f32 v85, v86, v87
v_cvt_pk_bf16_f32 v86, v88, v89
v_cvt_pk_bf16_f32 v87, v90, v91
buffer_store_dwordx4 v[84:87], v16, s[52:55], s83 offen offset:0 sc1
v_fma_f32 v92, v92, s86, v212
v_fma_f32 v93, v93, s86, v212
v_fma_f32 v94, v94, s86, v212
v_fma_f32 v95, v95, s86, v212
v_fma_f32 v96, v96, s86, v212
v_fma_f32 v97, v97, s86, v212
v_fma_f32 v98, v98, s86, v212
v_fma_f32 v99, v99, s86, v212
v_cvt_pk_bf16_f32 v92, v92, v93
v_cvt_pk_bf16_f32 v93, v94, v95
v_cvt_pk_bf16_f32 v94, v96, v97
v_cvt_pk_bf16_f32 v95, v98, v99
buffer_store_dwordx4 v[92:95], v16, s[52:55], s84 offen offset:0 sc1
s_branch L1_fin
L1_notq:
s_sub_u32 s4, s2, 32
s_cmp_lt_u32 s2, 32
s_cbranch_scc1 L1_edge
s_mov_b32 s61, 1
v_lshlrev_b32 v16, 4, v2
s_mul_i32 s63, s60, 6144
s_and_b32 s6, s4, 3
s_lshl_b32 s6, s6, 6
s_mul_i32 s7, s60, 8
s_add_u32 s6, s6, s7
v_lshrrev_b32 v5, 5, v2
v_and_b32 v6, 31, v2
v_lshlrev_b32 v6, 4, v6
v_mov_b32 v176, v6
s_cmp_ge_u32 s4, 4
s_cselect_b64 vcc, -1, 0
v_add3_u32 v7, v5, s6, 0
v_and_b32 v8, 0x80, v7
v_bfe_u32 v9, v7, 2, 1
v_lshl_or_b32 v8, v9, 6, v8
v_bfe_u32 v9, v7, 4, 1
v_lshl_or_b32 v8, v9, 5, v8
v_and_b32 v9, 3, v7
v_lshl_or_b32 v8, v9, 3, v8
v_bfe_u32 v9, v7, 5, 2
v_lshl_or_b32 v8, v9, 1, v8
v_bfe_u32 v9, v7, 3, 1
v_or_b32 v8, v9, v8
v_cndmask_b32 v8, v8, v7, vcc
v_lshl_add_u32 v40, v8, 9, v6
v_add3_u32 v7, v5, s6, 2
v_and_b32 v8, 0x80, v7
v_bfe_u32 v9, v7, 2, 1
v_lshl_or_b32 v8, v9, 6, v8
v_bfe_u32 v9, v7, 4, 1
v_lshl_or_b32 v8, v9, 5, v8
v_and_b32 v9, 3, v7
v_lshl_or_b32 v8, v9, 3, v8
v_bfe_u32 v9, v7, 5, 2
v_lshl_or_b32 v8, v9, 1, v8
v_bfe_u32 v9, v7, 3, 1
v_or_b32 v8, v9, v8
v_cndmask_b32 v8, v8, v7, vcc
v_lshl_add_u32 v44, v8, 9, v6
v_add3_u32 v7, v5, s6, 4
v_and_b32 v8, 0x80, v7
v_bfe_u32 v9, v7, 2, 1
v_lshl_or_b32 v8, v9, 6, v8
v_bfe_u32 v9, v7, 4, 1
v_lshl_or_b32 v8, v9, 5, v8
v_and_b32 v9, 3, v7
v_lshl_or_b32 v8, v9, 3, v8
v_bfe_u32 v9, v7, 5, 2
v_lshl_or_b32 v8, v9, 1, v8
v_bfe_u32 v9, v7, 3, 1
v_or_b32 v8, v9, v8
v_cndmask_b32 v8, v8, v7, vcc
v_lshl_add_u32 v48, v8, 9, v6
v_add3_u32 v7, v5, s6, 6
v_and_b32 v8, 0x80, v7
v_bfe_u32 v9, v7, 2, 1
v_lshl_or_b32 v8, v9, 6, v8
v_bfe_u32 v9, v7, 4, 1
v_lshl_or_b32 v8, v9, 5, v8
v_and_b32 v9, 3, v7
v_lshl_or_b32 v8, v9, 3, v8
v_bfe_u32 v9, v7, 5, 2
v_lshl_or_b32 v8, v9, 1, v8
v_bfe_u32 v9, v7, 3, 1
v_or_b32 v8, v9, v8
v_cndmask_b32 v8, v8, v7, vcc
v_lshl_add_u32 v52, v8, 9, v6
s_lshl_b32 s7, s60, 6
v_lshrrev_b32 v5, 2, v2
v_and_b32 v6, 3, v2
v_lshrrev_b32 v7, 5, v2
v_lshlrev_b32 v7, 1, v7
v_xor_b32 v6, v6, v7
v_lshl_add_u32 v5, v5, 9, s7
v_lshl_add_u32 v17, v6, 4, v5
v_add_u32 v18, 0x1c00, v17
s_xor_b32 s6, s62, 0
s_lshl_b32 s66, s6, 14
s_xor_b32 s6, s62, 1
s_lshl_b32 s67, s6, 14
s_xor_b32 s6, s62, 2
s_lshl_b32 s68, s6, 14
s_xor_b32 s6, s62, 3
s_lshl_b32 s69, s6, 14
s_xor_b32 s6, s62, 4
s_lshl_b32 s70, s6, 14
s_xor_b32 s6, s62, 5
s_lshl_b32 s71, s6, 14
s_xor_b32 s6, s62, 6
s_lshl_b32 s72, s6, 14
s_xor_b32 s6, s62, 7
s_lshl_b32 s73, s6, 14
s_waitcnt lgkmcnt(0)
s_cmp_ge_u32 s4, 4
s_cselect_b32 s6, s30, s24
s_cselect_b32 s7, s31, s25
s_add_u32 s40, s6, 0x0
s_addc_u32 s41, s7, 0
s_mov_b32 s42, 0x20000
s_mov_b32 s43, 0x00020000
s_add_u32 s44, s32, 0x0
s_addc_u32 s45, s33, 0
s_mov_b32 s46, 0x20000
s_mov_b32 s47, 0x00020000
buffer_load_dwordx4 v[40:43], v40, s[40:43], 0 offen
buffer_load_dwordx4 v[44:47], v44, s[40:43], 0 offen
buffer_load_dwordx4 v[48:51], v48, s[40:43], 0 offen
buffer_load_dwordx4 v[52:55], v52, s[40:43], 0 offen
buffer_load_dwordx4 v[176:179], v176, s[40:43], 0 offen
s_add_u32 m0, s63, 0x0
s_nop 0
buffer_load_dwordx4 v17, s[44:47], s66 offen offset:0 lds
buffer_load_dwordx4 v18, s[44:47], s66 offen offset:1024 lds
s_add_u32 m0, s63, 0x800
s_nop 0
buffer_load_dwordx4 v17, s[44:47], s67 offen offset:0 lds
buffer_load_dwordx4 v18, s[44:47], s67 offen offset:1024 lds
v_bfe_u32 v5, v2, 2, 3
v_xor_b32 v5, s62, v5
v_and_b32 v6, 3, v2
v_lshlrev_b32 v7, 10, v5
v_lshl_add_u32 v7, v6, 8, v7
v_add_u32 v7, 0xc000, v7
v_and_b32 v5, 1, v5
v_lshl_or_b32 v6, v5, 2, v6
v_lshrrev_b32 v5, 5, v2
s_mul_i32 s6, s60, 8
v_add3_u32 v8, v5, s6, 0
v_lshrrev_b32 v9, 4, v8
v_lshl_add_u32 v9, v9, 13, v7
v_and_b32 v8, 15, v8
v_xor_b32 v8, v8, v6
v_lshl_add_u32 v36, v8, 4, v9
v_add3_u32 v8, v5, s6, 2
v_lshrrev_b32 v9, 4, v8
v_lshl_add_u32 v9, v9, 13, v7
v_and_b32 v8, 15, v8
v_xor_b32 v8, v8, v6
v_lshl_add_u32 v37, v8, 4, v9
v_add3_u32 v8, v5, s6, 4
v_lshrrev_b32 v9, 4, v8
v_lshl_add_u32 v9, v9, 13, v7
v_and_b32 v8, 15, v8
v_xor_b32 v8, v8, v6
v_lshl_add_u32 v38, v8, 4, v9
v_add3_u32 v8, v5, s6, 6
v_lshrrev_b32 v9, 4, v8
v_lshl_add_u32 v9, v9, 13, v7
v_and_b32 v8, 15, v8
v_xor_b32 v8, v8, v6
v_lshl_add_u32 v39, v8, 4, v9
v_xor_b32 v5, v3, v4
v_lshlrev_b32 v5, 4, v5
v_lshl_add_u32 v5, v4, 8, v5
v_add_u32 v31, 0xc000, v5
v_xor_b32 v32, 64, v31
v_lshrrev_b32 v5, 2, v3
v_and_b32 v6, 3, v3
v_and_b32 v7, 1, v4
v_lshlrev_b32 v7, 1, v7
v_lshl_add_u32 v8, v4, 3, v5
v_lshlrev_b32 v8, 6, v8
v_add_u32 v8, s63, v8
v_xor_b32 v6, v6, v7
v_xor_b32 v9, 0, v6
v_lshl_add_u32 v25, v9, 4, v8
v_add_u32 v26, 8, v25
s_lshr_b32 s6, s4, 2
s_lshl_b32 s6, s6, 17
s_and_b32 s7, s4, 3
s_lshl_b32 s7, s7, 12
s_add_u32 s6, s6, s7
s_mul_i32 s7, s60, 16384
s_add_u32 s82, s6, s7
s_add_u32 s83, s82, 16384
s_add_u32 s52, s38, 0x1000000
s_addc_u32 s53, s39, 0
s_mov_b32 s54, 0x40000
s_mov_b32 s55, 0x00020000
s_mov_b32 s90, 0xffff0000
s_waitcnt vmcnt(4)
v_lshlrev_b32 v180, 16, v176
v_and_b32 v181, s90, v176
v_lshlrev_b32 v182, 16, v177
v_and_b32 v183, s90, v177
v_lshlrev_b32 v184, 16, v178
v_and_b32 v185, s90, v178
v_lshlrev_b32 v186, 16, v179
v_and_b32 v187, s90, v179
v_lshlrev_b32 v176, 16, v40
v_and_b32 v177, s90, v40
v_sub_f32 v176, v176, v180
v_sub_f32 v177, v177, v181
v_cvt_pk_bf16_f32 v40, v176, v177
v_lshlrev_b32 v176, 16, v41
v_and_b32 v177, s90, v41
v_sub_f32 v176, v176, v182
v_sub_f32 v177, v177, v183
v_cvt_pk_bf16_f32 v41, v176, v177
v_lshlrev_b32 v176, 16, v42
v_and_b32 v177, s90, v42
v_sub_f32 v176, v176, v184
v_sub_f32 v177, v177, v185
v_cvt_pk_bf16_f32 v42, v176, v177
v_lshlrev_b32 v176, 16, v43
v_and_b32 v177, s90, v43
v_sub_f32 v176, v176, v186
v_sub_f32 v177, v177, v187
v_cvt_pk_bf16_f32 v43, v176, v177
v_lshlrev_b32 v176, 16, v44
v_and_b32 v177, s90, v44
v_sub_f32 v176, v176, v180
v_sub_f32 v177, v177, v181
v_cvt_pk_bf16_f32 v44, v176, v177
v_lshlrev_b32 v176, 16, v45
v_and_b32 v177, s90, v45
v_sub_f32 v176, v176, v182
v_sub_f32 v177, v177, v183
v_cvt_pk_bf16_f32 v45, v176, v177
v_lshlrev_b32 v176, 16, v46
v_and_b32 v177, s90, v46
v_sub_f32 v176, v176, v184
v_sub_f32 v177, v177, v185
v_cvt_pk_bf16_f32 v46, v176, v177
v_lshlrev_b32 v176, 16, v47
v_and_b32 v177, s90, v47
v_sub_f32 v176, v176, v186
v_sub_f32 v177, v177, v187
v_cvt_pk_bf16_f32 v47, v176, v177
v_lshlrev_b32 v176, 16, v48
v_and_b32 v177, s90, v48
v_sub_f32 v176, v176, v180
v_sub_f32 v177, v177, v181
v_cvt_pk_bf16_f32 v48, v176, v177
v_lshlrev_b32 v176, 16, v49
v_and_b32 v177, s90, v49
v_sub_f32 v176, v176, v182
v_sub_f32 v177, v177, v183
v_cvt_pk_bf16_f32 v49, v176, v177
v_lshlrev_b32 v176, 16, v50
v_and_b32 v177, s90, v50
v_sub_f32 v176, v176, v184
v_sub_f32 v177, v177, v185
v_cvt_pk_bf16_f32 v50, v176, v177
v_lshlrev_b32 v176, 16, v51
v_and_b32 v177, s90, v51
v_sub_f32 v176, v176, v186
v_sub_f32 v177, v177, v187
v_cvt_pk_bf16_f32 v51, v176, v177
v_lshlrev_b32 v176, 16, v52
v_and_b32 v177, s90, v52
v_sub_f32 v176, v176, v180
v_sub_f32 v177, v177, v181
v_cvt_pk_bf16_f32 v52, v176, v177
v_lshlrev_b32 v176, 16, v53
v_and_b32 v177, s90, v53
v_sub_f32 v176, v176, v182
v_sub_f32 v177, v177, v183
v_cvt_pk_bf16_f32 v53, v176, v177
v_lshlrev_b32 v176, 16, v54
v_and_b32 v177, s90, v54
v_sub_f32 v176, v176, v184
v_sub_f32 v177, v177, v185
v_cvt_pk_bf16_f32 v54, v176, v177
v_lshlrev_b32 v176, 16, v55
v_and_b32 v177, s90, v55
v_sub_f32 v176, v176, v186
v_sub_f32 v177, v177, v187
v_cvt_pk_bf16_f32 v55, v176, v177
ds_write_b128 v36, v[40:43]
ds_write_b128 v37, v[44:47]
ds_write_b128 v38, v[48:51]
ds_write_b128 v39, v[52:55]
s_add_u32 m0, s63, 0x1000
s_nop 0
buffer_load_dwordx4 v17, s[44:47], s68 offen offset:0 lds
buffer_load_dwordx4 v18, s[44:47], s68 offen offset:1024 lds
s_waitcnt vmcnt(4)
ds_read_b64_tr_b16 v[88:89], v25 offset:0
ds_read_b64_tr_b16 v[90:91], v25 offset:256
ds_read_b64_tr_b16 v[92:93], v26 offset:0
ds_read_b64_tr_b16 v[94:95], v26 offset:256
s_waitcnt lgkmcnt(4)
s_barrier
ds_read_b128 v[112:115], v31 offset:0
ds_read_b128 v[116:119], v31 offset:8192
ds_read_b128 v[120:123], v31 offset:16384
ds_read_b128 v[124:127], v31 offset:24576
ds_read_b128 v[128:131], v32 offset:1024
s_waitcnt vmcnt(2)
ds_read_b64_tr_b16 v[96:97], v25 offset:2048
ds_read_b64_tr_b16 v[98:99], v25 offset:2304
s_waitcnt lgkmcnt(6)
v_mfma_f32_16x16x32_bf16 v[56:59], v[112:115], v[88:91], 0
ds_read_b128 v[132:135], v32 offset:9216
s_waitcnt lgkmcnt(6)
v_mfma_f32_16x16x32_bf16 v[60:63], v[116:119], v[88:91], 0
ds_read_b128 v[136:139], v32 offset:17408
s_waitcnt lgkmcnt(6)
v_mfma_f32_16x16x32_bf16 v[64:67], v[120:123], v[88:91], 0
ds_read_b128 v[140:143], v32 offset:25600
s_waitcnt lgkmcnt(6)
v_mfma_f32_16x16x32_bf16 v[68:71], v[124:127], v[88:91], 0
ds_read_b64_tr_b16 v[100:101], v26 offset:2048
ds_read_b64_tr_b16 v[102:103], v26 offset:2304
v_mfma_f32_16x16x32_bf16 v[72:75], v[112:115], v[92:95], 0
s_add_u32 m0, s63, 0x0
s_nop 0
buffer_load_dwordx4 v17, s[44:47], s69 offen offset:0 lds
buffer_load_dwordx4 v18, s[44:47], s69 offen offset:1024 lds
v_mfma_f32_16x16x32_bf16 v[76:79], v[116:119], v[92:95], 0
v_mfma_f32_16x16x32_bf16 v[80:83], v[120:123], v[92:95], 0
v_mfma_f32_16x16x32_bf16 v[84:87], v[124:127], v[92:95], 0
ds_read_b128 v[144:147], v31 offset:2048
s_waitcnt vmcnt(2)
ds_read_b64_tr_b16 v[104:105], v25 offset:4096
ds_read_b64_tr_b16 v[106:107], v25 offset:4352
s_waitcnt lgkmcnt(8)
v_mfma_f32_16x16x32_bf16 v[56:59], v[128:131], v[96:99], v[56:59]
ds_read_b128 v[148:151], v31 offset:10240
s_waitcnt lgkmcnt(8)
v_mfma_f32_16x16x32_bf16 v[60:63], v[132:135], v[96:99], v[60:63]
ds_read_b128 v[152:155], v31 offset:18432
s_waitcnt lgkmcnt(8)
v_mfma_f32_16x16x32_bf16 v[64:67], v[136:139], v[96:99], v[64:67]
ds_read_b128 v[156:159], v31 offset:26624
s_waitcnt lgkmcnt(8)
v_mfma_f32_16x16x32_bf16 v[68:71], v[140:143], v[96:99], v[68:71]
ds_read_b64_tr_b16 v[108:109], v26 offset:4096
ds_read_b64_tr_b16 v[110:111], v26 offset:4352
s_waitcnt lgkmcnt(8)
v_mfma_f32_16x16x32_bf16 v[72:75], v[128:131], v[100:103], v[72:75]
s_add_u32 m0, s63, 0x800
s_nop 0
buffer_load_dwordx4 v17, s[44:47], s70 offen offset:0 lds
buffer_load_dwordx4 v18, s[44:47], s70 offen offset:1024 lds
v_mfma_f32_16x16x32_bf16 v[76:79], v[132:135], v[100:103], v[76:79]
v_mfma_f32_16x16x32_bf16 v[80:83], v[136:139], v[100:103], v[80:83]
v_mfma_f32_16x16x32_bf16 v[84:87], v[140:143], v[100:103], v[84:87]
ds_read_b128 v[160:163], v32 offset:3072
s_waitcnt vmcnt(2)
ds_read_b64_tr_b16 v[88:89], v25 offset:0
ds_read_b64_tr_b16 v[90:91], v25 offset:256
s_waitcnt lgkmcnt(8)
v_mfma_f32_16x16x32_bf16 v[56:59], v[144:147], v[104:107], v[56:59]
ds_read_b128 v[164:167], v32 offset:11264
s_waitcnt lgkmcnt(8)
v_mfma_f32_16x16x32_bf16 v[60:63], v[148:151], v[104:107], v[60:63]
ds_read_b128 v[168:171], v32 offset:19456
s_waitcnt lgkmcnt(8)
v_mfma_f32_16x16x32_bf16 v[64:67], v[152:155], v[104:107], v[64:67]
ds_read_b128 v[172:175], v32 offset:27648
s_waitcnt lgkmcnt(8)
v_mfma_f32_16x16x32_bf16 v[68:71], v[156:159], v[104:107], v[68:71]
ds_read_b64_tr_b16 v[92:93], v26 offset:0
ds_read_b64_tr_b16 v[94:95], v26 offset:256
s_waitcnt lgkmcnt(8)
v_mfma_f32_16x16x32_bf16 v[72:75], v[144:147], v[108:111], v[72:75]
s_add_u32 m0, s63, 0x1000
s_nop 0
buffer_load_dwordx4 v17, s[44:47], s71 offen offset:0 lds
buffer_load_dwordx4 v18, s[44:47], s71 offen offset:1024 lds
v_mfma_f32_16x16x32_bf16 v[76:79], v[148:151], v[108:111], v[76:79]
v_mfma_f32_16x16x32_bf16 v[80:83], v[152:155], v[108:111], v[80:83]
v_mfma_f32_16x16x32_bf16 v[84:87], v[156:159], v[108:111], v[84:87]
ds_read_b128 v[112:115], v31 offset:4096
s_waitcnt vmcnt(2)
ds_read_b64_tr_b16 v[96:97], v25 offset:2048
ds_read_b64_tr_b16 v[98:99], v25 offset:2304
s_waitcnt lgkmcnt(8)
v_mfma_f32_16x16x32_bf16 v[56:59], v[160:163], v[88:91], v[56:59]
ds_read_b128 v[116:119], v31 offset:12288
s_waitcnt lgkmcnt(8)
v_mfma_f32_16x16x32_bf16 v[60:63], v[164:167], v[88:91], v[60:63]
ds_read_b128 v[120:123], v31 offset:20480
s_waitcnt lgkmcnt(8)
v_mfma_f32_16x16x32_bf16 v[64:67], v[168:171], v[88:91], v[64:67]
ds_read_b128 v[124:127], v31 offset:28672
s_waitcnt lgkmcnt(8)
v_mfma_f32_16x16x32_bf16 v[68:71], v[172:175], v[88:91], v[68:71]
ds_read_b64_tr_b16 v[100:101], v26 offset:2048
ds_read_b64_tr_b16 v[102:103], v26 offset:2304
s_waitcnt lgkmcnt(8)
v_mfma_f32_16x16x32_bf16 v[72:75], v[160:163], v[92:95], v[72:75]
s_add_u32 m0, s63, 0x0
s_nop 0
buffer_load_dwordx4 v17, s[44:47], s72 offen offset:0 lds
buffer_load_dwordx4 v18, s[44:47], s72 offen offset:1024 lds
v_mfma_f32_16x16x32_bf16 v[76:79], v[164:167], v[92:95], v[76:79]
v_mfma_f32_16x16x32_bf16 v[80:83], v[168:171], v[92:95], v[80:83]
v_mfma_f32_16x16x32_bf16 v[84:87], v[172:175], v[92:95], v[84:87]
ds_read_b128 v[128:131], v32 offset:5120
s_waitcnt vmcnt(2)
ds_read_b64_tr_b16 v[104:105], v25 offset:4096
ds_read_b64_tr_b16 v[106:107], v25 offset:4352
s_waitcnt lgkmcnt(8)
v_mfma_f32_16x16x32_bf16 v[56:59], v[112:115], v[96:99], v[56:59]
ds_read_b128 v[132:135], v32 offset:13312
s_waitcnt lgkmcnt(8)
v_mfma_f32_16x16x32_bf16 v[60:63], v[116:119], v[96:99], v[60:63]
ds_read_b128 v[136:139], v32 offset:21504
s_waitcnt lgkmcnt(8)
v_mfma_f32_16x16x32_bf16 v[64:67], v[120:123], v[96:99], v[64:67]
ds_read_b128 v[140:143], v32 offset:29696
s_waitcnt lgkmcnt(8)
v_mfma_f32_16x16x32_bf16 v[68:71], v[124:127], v[96:99], v[68:71]
ds_read_b64_tr_b16 v[108:109], v26 offset:4096
ds_read_b64_tr_b16 v[110:111], v26 offset:4352
s_waitcnt lgkmcnt(8)
v_mfma_f32_16x16x32_bf16 v[72:75], v[112:115], v[100:103], v[72:75]
s_add_u32 m0, s63, 0x800
s_nop 0
buffer_load_dwordx4 v17, s[44:47], s73 offen offset:0 lds
buffer_load_dwordx4 v18, s[44:47], s73 offen offset:1024 lds
v_mfma_f32_16x16x32_bf16 v[76:79], v[116:119], v[100:103], v[76:79]
v_mfma_f32_16x16x32_bf16 v[80:83], v[120:123], v[100:103], v[80:83]
v_mfma_f32_16x16x32_bf16 v[84:87], v[124:127], v[100:103], v[84:87]
ds_read_b128 v[144:147], v31 offset:6144
s_waitcnt vmcnt(2)
ds_read_b64_tr_b16 v[88:89], v25 offset:0
ds_read_b64_tr_b16 v[90:91], v25 offset:256
s_waitcnt lgkmcnt(8)
v_mfma_f32_16x16x32_bf16 v[56:59], v[128:131], v[104:107], v[56:59]
ds_read_b128 v[148:151], v31 offset:14336
s_waitcnt lgkmcnt(8)
v_mfma_f32_16x16x32_bf16 v[60:63], v[132:135], v[104:107], v[60:63]
ds_read_b128 v[152:155], v31 offset:22528
s_waitcnt lgkmcnt(8)
v_mfma_f32_16x16x32_bf16 v[64:67], v[136:139], v[104:107], v[64:67]
ds_read_b128 v[156:159], v31 offset:30720
s_waitcnt lgkmcnt(8)
v_mfma_f32_16x16x32_bf16 v[68:71], v[140:143], v[104:107], v[68:71]
ds_read_b64_tr_b16 v[92:93], v26 offset:0
ds_read_b64_tr_b16 v[94:95], v26 offset:256
s_waitcnt lgkmcnt(8)
v_mfma_f32_16x16x32_bf16 v[72:75], v[128:131], v[108:111], v[72:75]
v_mfma_f32_16x16x32_bf16 v[76:79], v[132:135], v[108:111], v[76:79]
v_mfma_f32_16x16x32_bf16 v[80:83], v[136:139], v[108:111], v[80:83]
v_mfma_f32_16x16x32_bf16 v[84:87], v[140:143], v[108:111], v[84:87]
ds_read_b128 v[160:163], v32 offset:7168
s_waitcnt vmcnt(0)
ds_read_b64_tr_b16 v[96:97], v25 offset:2048
ds_read_b64_tr_b16 v[98:99], v25 offset:2304
s_waitcnt lgkmcnt(8)
v_mfma_f32_16x16x32_bf16 v[56:59], v[144:147], v[88:91], v[56:59]
ds_read_b128 v[164:167], v32 offset:15360
s_waitcnt lgkmcnt(8)
v_mfma_f32_16x16x32_bf16 v[60:63], v[148:151], v[88:91], v[60:63]
ds_read_b128 v[168:171], v32 offset:23552
s_waitcnt lgkmcnt(8)
v_mfma_f32_16x16x32_bf16 v[64:67], v[152:155], v[88:91], v[64:67]
ds_read_b128 v[172:175], v32 offset:31744
s_waitcnt lgkmcnt(8)
v_mfma_f32_16x16x32_bf16 v[68:71], v[156:159], v[88:91], v[68:71]
ds_read_b64_tr_b16 v[100:101], v26 offset:2048
ds_read_b64_tr_b16 v[102:103], v26 offset:2304
s_waitcnt lgkmcnt(8)
v_mfma_f32_16x16x32_bf16 v[72:75], v[144:147], v[92:95], v[72:75]
v_mfma_f32_16x16x32_bf16 v[76:79], v[148:151], v[92:95], v[76:79]
v_mfma_f32_16x16x32_bf16 v[80:83], v[152:155], v[92:95], v[80:83]
v_mfma_f32_16x16x32_bf16 v[84:87], v[156:159], v[92:95], v[84:87]
s_waitcnt lgkmcnt(5)
v_mfma_f32_16x16x32_bf16 v[56:59], v[160:163], v[96:99], v[56:59]
s_waitcnt lgkmcnt(4)
v_mfma_f32_16x16x32_bf16 v[60:63], v[164:167], v[96:99], v[60:63]
s_waitcnt lgkmcnt(3)
v_mfma_f32_16x16x32_bf16 v[64:67], v[168:171], v[96:99], v[64:67]
s_waitcnt lgkmcnt(2)
v_mfma_f32_16x16x32_bf16 v[68:71], v[172:175], v[96:99], v[68:71]
s_waitcnt lgkmcnt(0)
v_mfma_f32_16x16x32_bf16 v[72:75], v[160:163], v[100:103], v[72:75]
v_cvt_pk_bf16_f32 v56, v56, v57
v_cvt_pk_bf16_f32 v57, v58, v59
v_cvt_pk_bf16_f32 v58, v60, v61
v_cvt_pk_bf16_f32 v59, v62, v63
buffer_store_dwordx4 v[56:59], v16, s[52:55], s82 offen offset:0 sc1
v_mfma_f32_16x16x32_bf16 v[76:79], v[164:167], v[100:103], v[76:79]
v_mfma_f32_16x16x32_bf16 v[80:83], v[168:171], v[100:103], v[80:83]
v_cvt_pk_bf16_f32 v64, v64, v65
v_cvt_pk_bf16_f32 v65, v66, v67
v_cvt_pk_bf16_f32 v66, v68, v69
v_cvt_pk_bf16_f32 v67, v70, v71
buffer_store_dwordx4 v[64:67], v16, s[52:55], s82 offen offset:2048 sc1
v_mfma_f32_16x16x32_bf16 v[84:87], v[172:175], v[100:103], v[84:87]
v_cvt_pk_bf16_f32 v72, v72, v73
v_cvt_pk_bf16_f32 v73, v74, v75
v_cvt_pk_bf16_f32 v74, v76, v77
v_cvt_pk_bf16_f32 v75, v78, v79
buffer_store_dwordx4 v[72:75], v16, s[52:55], s82 offen offset:1024 sc1
v_cvt_pk_bf16_f32 v80, v80, v81
v_cvt_pk_bf16_f32 v81, v82, v83
s_nop 0
v_cvt_pk_bf16_f32 v82, v84, v85
v_cvt_pk_bf16_f32 v83, v86, v87
buffer_store_dwordx4 v[80:83], v16, s[52:55], s82 offen offset:3072 sc1
s_branch L1_fin
L1_edge:
s_mov_b32 s61, 4
s_mov_b32 s4, s2
s_mul_i32 s6, s4, 20000
v_lshlrev_b32 v5, 4, v0
v_lshlrev_b32 v6, 2, v2
v_add_u32 v6, 0x10000, v6
v_mov_b32 v7, 0
ds_write_b32 v6, v7
s_mov_b32 s66, 0
s_mov_b32 s67, 8192
s_mov_b32 s68, 16384
s_waitcnt lgkmcnt(0)
s_add_u32 s56, s38, 0x7c00000
s_addc_u32 s57, s39, 0
s_mov_b32 s58, 0x2000
s_mov_b32 s59, 0x00020000
s_cmp_eq_u32 s4, 0
s_cselect_b32 s9, 0, 0x7fff0000
v_mov_b32 v8, 0
v_mov_b32 v9, 0
v_mov_b32 v10, 0
v_mov_b32 v11, 0
buffer_store_dwordx4 v[8:11], v5, s[56:59], s9 offen
s_add_u32 s40, s20, 0x0
s_addc_u32 s41, s21, 0
s_add_u32 s40, s40, s6
s_addc_u32 s41, s41, 0
s_mov_b32 s42, 0x4e20
s_mov_b32 s43, 0x00020000
s_add_u32 s44, s18, 0x0
s_addc_u32 s45, s19, 0
s_add_u32 s44, s44, s6
s_addc_u32 s45, s45, 0
s_mov_b32 s46, 0x4e20
s_mov_b32 s47, 0x00020000
buffer_load_dwordx4 v[16:19], v5, s[40:43], s66 offen
buffer_load_dwordx4 v[20:23], v5, s[40:43], s67 offen
buffer_load_dwordx4 v[24:27], v5, s[40:43], s68 offen
buffer_load_dwordx4 v[28:31], v5, s[44:47], s66 offen
buffer_load_dwordx4 v[32:35], v5, s[44:47], s67 offen
buffer_load_dwordx4 v[36:39], v5, s[44:47], s68 offen
s_add_u32 s48, s38, 0x8000000
s_addc_u32 s49, s39, 0
s_mov_b32 s50, 0x2800000
s_mov_b32 s51, 0x00020000
s_add_u32 s52, s38, 0x7800000
s_addc_u32 s53, s39, 0
s_mov_b32 s54, 0x2000
s_mov_b32 s55, 0x00020000
s_mov_b32 s9, 6279
s_mov_b32 s10, 4294967129
s_mov_b32 s11, 0x10000
v_mov_b32 v7, 1
v_cmp_gt_u32 vcc, 0xe2, v0
s_mov_b64 s[12:13], vcc
s_barrier
s_waitcnt vmcnt(5)
v_mul_u32_u24 v40, s9, v16
v_lshrrev_b32 v40, 20, v40
v_lshl_add_u32 v52, v40, 2, s11
ds_add_rtn_u32 v52, v52, v7
v_mad_i32_i24 v16, v40, s10, v16
v_mul_u32_u24 v41, s9, v17
v_lshrrev_b32 v41, 20, v41
v_lshl_add_u32 v53, v41, 2, s11
ds_add_rtn_u32 v53, v53, v7
v_mad_i32_i24 v17, v41, s10, v17
v_mul_u32_u24 v42, s9, v18
v_lshrrev_b32 v42, 20, v42
v_lshl_add_u32 v54, v42, 2, s11
ds_add_rtn_u32 v54, v54, v7
v_mad_i32_i24 v18, v42, s10, v18
v_mul_u32_u24 v43, s9, v19
v_lshrrev_b32 v43, 20, v43
v_lshl_add_u32 v55, v43, 2, s11
ds_add_rtn_u32 v55, v55, v7
v_mad_i32_i24 v19, v43, s10, v19
s_waitcnt vmcnt(4)
v_mul_u32_u24 v44, s9, v20
v_lshrrev_b32 v44, 20, v44
v_lshl_add_u32 v56, v44, 2, s11
ds_add_rtn_u32 v56, v56, v7
v_mad_i32_i24 v20, v44, s10, v20
v_mul_u32_u24 v45, s9, v21
v_lshrrev_b32 v45, 20, v45
v_lshl_add_u32 v57, v45, 2, s11
ds_add_rtn_u32 v57, v57, v7
v_mad_i32_i24 v21, v45, s10, v21
v_mul_u32_u24 v46, s9, v22
v_lshrrev_b32 v46, 20, v46
v_lshl_add_u32 v58, v46, 2, s11
ds_add_rtn_u32 v58, v58, v7
v_mad_i32_i24 v22, v46, s10, v22
v_mul_u32_u24 v47, s9, v23
v_lshrrev_b32 v47, 20, v47
v_lshl_add_u32 v59, v47, 2, s11
ds_add_rtn_u32 v59, v59, v7
v_mad_i32_i24 v23, v47, s10, v23
s_waitcnt vmcnt(3)
s_mov_b64 exec, s[12:13]
v_mul_u32_u24 v48, s9, v24
v_lshrrev_b32 v48, 20, v48
v_lshl_add_u32 v60, v48, 2, s11
ds_add_rtn_u32 v60, v60, v7
v_mad_i32_i24 v24, v48, s10, v24
v_mul_u32_u24 v49, s9, v25
v_lshrrev_b32 v49, 20, v49
v_lshl_add_u32 v61, v49, 2, s11
ds_add_rtn_u32 v61, v61, v7
v_mad_i32_i24 v25, v49, s10, v25
v_mul_u32_u24 v50, s9, v26
v_lshrrev_b32 v50, 20, v50
v_lshl_add_u32 v62, v50, 2, s11
ds_add_rtn_u32 v62, v62, v7
v_mad_i32_i24 v26, v50, s10, v26
v_mul_u32_u24 v51, s9, v27
v_lshrrev_b32 v51, 20, v51
v_lshl_add_u32 v63, v51, 2, s11
ds_add_rtn_u32 v63, v63, v7
v_mad_i32_i24 v27, v51, s10, v27
s_mov_b64 exec, -1
s_waitcnt vmcnt(2) lgkmcnt(4)
v_and_b32 v8, 0x7f, v52
v_lshl_or_b32 v28, v16, 18, v28
v_lshlrev_b32 v8, 2, v8
v_lshl_add_u32 v8, v40, 9, v8
ds_write_b32 v8, v28
v_and_b32 v8, 0x7f, v53
v_lshl_or_b32 v29, v17, 18, v29
v_lshlrev_b32 v8, 2, v8
v_lshl_add_u32 v8, v41, 9, v8
ds_write_b32 v8, v29
v_and_b32 v8, 0x7f, v54
v_lshl_or_b32 v30, v18, 18, v30
v_lshlrev_b32 v8, 2, v8
v_lshl_add_u32 v8, v42, 9, v8
ds_write_b32 v8, v30
v_and_b32 v8, 0x7f, v55
v_lshl_or_b32 v31, v19, 18, v31
v_lshlrev_b32 v8, 2, v8
v_lshl_add_u32 v8, v43, 9, v8
ds_write_b32 v8, v31
s_waitcnt vmcnt(1) lgkmcnt(4)
v_and_b32 v8, 0x7f, v56
v_lshl_or_b32 v32, v20, 18, v32
v_lshlrev_b32 v8, 2, v8
v_lshl_add_u32 v8, v44, 9, v8
ds_write_b32 v8, v32
v_and_b32 v8, 0x7f, v57
v_lshl_or_b32 v33, v21, 18, v33
v_lshlrev_b32 v8, 2, v8
v_lshl_add_u32 v8, v45, 9, v8
ds_write_b32 v8, v33
v_and_b32 v8, 0x7f, v58
v_lshl_or_b32 v34, v22, 18, v34
v_lshlrev_b32 v8, 2, v8
v_lshl_add_u32 v8, v46, 9, v8
ds_write_b32 v8, v34
v_and_b32 v8, 0x7f, v59
v_lshl_or_b32 v35, v23, 18, v35
v_lshlrev_b32 v8, 2, v8
v_lshl_add_u32 v8, v47, 9, v8
ds_write_b32 v8, v35
s_waitcnt vmcnt(0) lgkmcnt(8)
s_mov_b64 exec, s[12:13]
v_and_b32 v8, 0x7f, v60
v_lshl_or_b32 v36, v24, 18, v36
v_lshlrev_b32 v8, 2, v8
v_lshl_add_u32 v8, v48, 9, v8
ds_write_b32 v8, v36
v_and_b32 v8, 0x7f, v61
v_lshl_or_b32 v37, v25, 18, v37
v_lshlrev_b32 v8, 2, v8
v_lshl_add_u32 v8, v49, 9, v8
ds_write_b32 v8, v37
v_and_b32 v8, 0x7f, v62
v_lshl_or_b32 v38, v26, 18, v38
v_lshlrev_b32 v8, 2, v8
v_lshl_add_u32 v8, v50, 9, v8
ds_write_b32 v8, v38
v_and_b32 v8, 0x7f, v63
v_lshl_or_b32 v39, v27, 18, v39
v_lshlrev_b32 v8, 2, v8
v_lshl_add_u32 v8, v51, 9, v8
ds_write_b32 v8, v39
s_mov_b64 exec, -1
s_waitcnt lgkmcnt(0)
s_barrier
ds_read_b32 v8, v6
s_mul_i32 s6, s60, 4096
v_lshlrev_b32 v10, 4, v2
v_add_u32 v9, s6, v10
ds_read_b128 v[64:67], v9 offset:0
ds_read_b128 v[68:71], v9 offset:1024
ds_read_b128 v[72:75], v9 offset:2048
ds_read_b128 v[76:79], v9 offset:3072
v_lshrrev_b32 v11, 5, v2
v_mul_u32_u24 v11, 0x9fe00, v11
v_add_u32 v10, v10, v11
s_mul_i32 s6, s60, 5242880
s_mul_i32 s7, s4, 20480
s_add_u32 s6, s6, s7
v_lshlrev_b32 v9, 7, v2
s_lshl_b32 s8, s4, 2
s_cmp_eq_u32 s60, 0
s_cselect_b32 s8, s8, 0x7fff0000
s_waitcnt lgkmcnt(4)
buffer_store_dword v8, v9, s[52:55], s8 offen sc1
v_cmp_lt_u32 vcc, 0x80, v8
s_cbranch_vccnz L1_eslow
s_waitcnt lgkmcnt(3)
buffer_store_dwordx4 v[64:67], v10, s[48:51], s6 offen sc1
s_add_u32 s6, s6, 1310720
s_waitcnt lgkmcnt(2)
buffer_store_dwordx4 v[68:71], v10, s[48:51], s6 offen sc1
s_add_u32 s6, s6, 1310720
s_waitcnt lgkmcnt(1)
buffer_store_dwordx4 v[72:75], v10, s[48:51], s6 offen sc1
s_add_u32 s6, s6, 1310720
s_waitcnt lgkmcnt(0)
buffer_store_dwordx4 v[76:79], v10, s[48:51], s6 offen sc1
s_add_u32 s6, s6, 1310720
s_branch L1_fin
L1_eslow:
s_mov_b32 s9, 655360
v_mul_u32_u24 v40, s9, v40
v_lshl_add_u32 v40, v52, 2, v40
v_mul_u32_u24 v41, s9, v41
v_lshl_add_u32 v41, v53, 2, v41
v_mul_u32_u24 v42, s9, v42
v_lshl_add_u32 v42, v54, 2, v42
v_mul_u32_u24 v43, s9, v43
v_lshl_add_u32 v43, v55, 2, v43
v_mul_u32_u24 v44, s9, v44
v_lshl_add_u32 v44, v56, 2, v44
v_mul_u32_u24 v45, s9, v45
v_lshl_add_u32 v45, v57, 2, v45
v_mul_u32_u24 v46, s9, v46
v_lshl_add_u32 v46, v58, 2, v46
v_mul_u32_u24 v47, s9, v47
v_lshl_add_u32 v47, v59, 2, v47
v_mul_u32_u24 v48, s9, v48
v_lshl_add_u32 v48, v60, 2, v48
v_mul_u32_u24 v49, s9, v49
v_lshl_add_u32 v49, v61, 2, v49
v_mul_u32_u24 v50, s9, v50
v_lshl_add_u32 v50, v62, 2, v50
v_mul_u32_u24 v51, s9, v51
v_lshl_add_u32 v51, v63, 2, v51
buffer_store_dword v28, v40, s[48:51], s7 offen
buffer_store_dword v29, v41, s[48:51], s7 offen
buffer_store_dword v30, v42, s[48:51], s7 offen
buffer_store_dword v31, v43, s[48:51], s7 offen
buffer_store_dword v32, v44, s[48:51], s7 offen
buffer_store_dword v33, v45, s[48:51], s7 offen
buffer_store_dword v34, v46, s[48:51], s7 offen
buffer_store_dword v35, v47, s[48:51], s7 offen
s_mov_b64 exec, s[12:13]
buffer_store_dword v36, v48, s[48:51], s7 offen
buffer_store_dword v37, v49, s[48:51], s7 offen
buffer_store_dword v38, v50, s[48:51], s7 offen
buffer_store_dword v39, v51, s[48:51], s7 offen
s_mov_b64 exec, -1
L1_fin:
L1_end:
s_endpgm
.globl k2_kernel
.p2align 8
.type k2_kernel,@function
k2_kernel:
s_load_dwordx2 s[4:5], s[0:1], 88
s_load_dwordx2 s[6:7], s[0:1], 0
s_load_dwordx2 s[18:19], s[0:1], 72
s_and_b32 s35, s2, 7
s_lshr_b32 s37, s2, 3
s_cmp_ge_u32 s37, 30
s_cbranch_scc1 LE_start
s_mul_i32 s38, s37, 52
s_lshr_b32 s38, s38, 8
s_mul_i32 s39, s38, 5
s_sub_u32 s39, s37, s39
s_mov_b32 s37, s38
s_mul_i32 s38, s35, 5
s_add_u32 s38, s38, s39
v_lshrrev_b32 v1, 6, v0
v_and_b32 v252, 63, v0
v_lshlrev_b32 v252, 4, v252
v_readfirstlane_b32 s34, v1
s_mov_b32 s50, 0xe1a06800
s_mov_b32 s51, 0x4e608d04
s_mul_i32 s39, s37, 9
s_lshr_b64 s[50:51], s[50:51], s39
s_and_b32 s39, s50, 0x1ff
s_bfe_u32 s49, s50, 0x90009
s_sub_u32 s29, s49, s39
s_lshl_b32 s50, s37, 2
s_lshr_b32 s59, 0x766666, s50
s_and_b32 s59, s59, 15
s_sub_u32 s31, s29, s59
s_lshr_b32 s31, s31, 1
s_sub_u32 s31, s31, 1
s_lshl_b32 s39, s39, 14
s_lshl_b32 s49, s49, 14
s_add_u32 s28, s39, 0x4000
s_cmp_eq_u32 s37, 5
s_cselect_b32 s33, 0xff800000, 0
s_mov_b32 s32, 0xffff
v_and_b32 v2, 63, v0
v_bfe_u32 v3, v2, 3, 2
v_bfe_u32 v4, v2, 2, 1
v_lshlrev_b32 v251, 12, v3
v_lshl_or_b32 v251, v4, 9, v251
v_lshl_or_b32 v251, v1, 7, v251
v_lshrrev_b32 v4, 5, v2
v_lshl_or_b32 v251, v4, 6, v251
v_and_b32 v3, 2, v3
v_and_b32 v4, 3, v2
v_xor_b32 v3, v3, v4
v_lshl_or_b32 v251, v3, 4, v251
s_cmp_eq_u32 s38, 39
s_cbranch_scc1 LT_disp
s_lshl_b32 s30, s34, 12
s_mov_b32 m0, s30
s_waitcnt lgkmcnt(0)
s_add_u32 s12, s4, 0x6800000
s_addc_u32 s13, s5, 0
s_mov_b32 s14, s49
s_mov_b32 s15, 0x00020000
buffer_load_dwordx4 v251, s[12:15], s39 offen offset:0 lds
buffer_load_dwordx4 v251, s[12:15], s39 offen offset:1024 lds
buffer_load_dwordx4 v251, s[12:15], s39 offen offset:2048 lds
buffer_load_dwordx4 v251, s[12:15], s39 offen offset:3072 lds
s_add_u32 m0, s30, 0x4000
s_nop 0
buffer_load_dwordx4 v251, s[12:15], s28 offen offset:0 lds
buffer_load_dwordx4 v251, s[12:15], s28 offen offset:1024 lds
s_add_u32 s8, s4, 0x0
s_addc_u32 s9, s5, 0
s_mov_b32 s10, 0x4e4000
s_mov_b32 s11, 0x00020000
s_mul_i32 s35, s37, 0x600000
s_add_u32 s20, s4, 0x2000000
s_addc_u32 s21, s5, 0
s_add_u32 s20, s20, s35
s_addc_u32 s21, s21, 0
s_mov_b32 s22, 0x4e4000
s_mov_b32 s23, 0x00020000
s_add_u32 s24, s4, 0x6000000
s_addc_u32 s25, s5, 0
s_mov_b32 s26, 0x9c800
s_mov_b32 s27, 0x00020000
s_lshl_b32 s35, s38, 4
s_lshl_b32 s41, s34, 2
s_add_u32 s35, s35, s41
s_mul_i32 s41, s37, 3
s_sub_u32 s42, s34, s41
s_and_b32 s42, s42, 3
s_add_u32 s41, s41, s42
s_lshr_b32 s41, s41, 2
s_cmp_eq_u32 s37, 5
s_cselect_b32 s42, 3, s42
s_cmp_lt_u32 s42, 3
s_cselect_b32 s41, s41, 0
s_cselect_b32 s50, 1, 0
s_add_u32 s35, s35, s41
s_lshl_b32 s40, s35, 13
s_lshl_b32 s48, s35, 10
s_lshl_b32 s35, s37, 3
s_add_u32 s48, s48, s35
s_xor_b32 s41, s40, 8192
s_xor_b32 s42, s40, 16384
s_xor_b32 s43, s40, 24576
s_add_u32 s44, s40, 4096
s_add_u32 s45, s41, 4096
s_add_u32 s46, s42, 4096
s_add_u32 s47, s43, 4096
s_mul_i32 s35, s37, 3
s_and_b32 s36, s35, 3
s_lshl_b32 s36, s36, 2
s_lshr_b32 s52, s35, 2
s_add_u32 s36, s36, s52
s_lshl_b32 s52, s38, 4
s_add_u32 s52, s52, s36
s_lshl_b32 s52, s52, 13
s_add_u32 s35, s35, 1
s_and_b32 s36, s35, 3
s_lshl_b32 s36, s36, 2
s_lshr_b32 s53, s35, 2
s_add_u32 s36, s36, s53
s_lshl_b32 s53, s38, 4
s_add_u32 s53, s53, s36
s_lshl_b32 s53, s53, 13
s_add_u32 s35, s35, 1
s_and_b32 s36, s35, 3
s_lshl_b32 s36, s36, 2
s_lshr_b32 s54, s35, 2
s_add_u32 s36, s36, s54
s_lshl_b32 s54, s38, 4
s_add_u32 s54, s54, s36
s_lshl_b32 s54, s54, 13
v_mov_b32 v208, 0
v_mov_b32 v209, 0
v_mov_b32 v210, 0
v_mov_b32 v211, 0
buffer_load_dwordx4 v[0:3], v252, s[8:11], s40 offen offset:0
buffer_load_dwordx4 v[32:35], v252, s[8:11], s41 offen offset:0
v_mfma_f32_32x32x16_bf16 a[0:15], v[208:211], v[208:211], 0
buffer_load_dwordx4 v[64:67], v252, s[8:11], s42 offen offset:0
v_mfma_f32_32x32x16_bf16 a[16:31], v[208:211], v[208:211], 0
buffer_load_dwordx4 v[96:99], v252, s[8:11], s43 offen offset:0
buffer_load_dwordx4 v[4:7], v252, s[8:11], s40 offen offset:1024
v_mfma_f32_32x32x16_bf16 a[32:47], v[208:211], v[208:211], 0
buffer_load_dwordx4 v[36:39], v252, s[8:11], s41 offen offset:1024
v_mfma_f32_32x32x16_bf16 a[48:63], v[208:211], v[208:211], 0
buffer_load_dwordx4 v[68:71], v252, s[8:11], s42 offen offset:1024
buffer_load_dwordx4 v[100:103], v252, s[8:11], s43 offen offset:1024
v_mfma_f32_32x32x16_bf16 a[64:79], v[208:211], v[208:211], 0
buffer_load_dwordx4 v[8:11], v252, s[8:11], s40 offen offset:2048
v_mfma_f32_32x32x16_bf16 a[80:95], v[208:211], v[208:211], 0
buffer_load_dwordx4 v[40:43], v252, s[8:11], s41 offen offset:2048
buffer_load_dwordx4 v[72:75], v252, s[8:11], s42 offen offset:2048
v_mfma_f32_32x32x16_bf16 a[96:111], v[208:211], v[208:211], 0
buffer_load_dwordx4 v[104:107], v252, s[8:11], s43 offen offset:2048
v_mfma_f32_32x32x16_bf16 a[112:127], v[208:211], v[208:211], 0
buffer_load_dwordx4 v[12:15], v252, s[8:11], s40 offen offset:3072
buffer_load_dwordx4 v[44:47], v252, s[8:11], s41 offen offset:3072
v_mfma_f32_32x32x16_bf16 a[128:143], v[208:211], v[208:211], 0
buffer_load_dwordx4 v[76:79], v252, s[8:11], s42 offen offset:3072
v_mfma_f32_32x32x16_bf16 a[144:159], v[208:211], v[208:211], 0
buffer_load_dwordx4 v[108:111], v252, s[8:11], s43 offen offset:3072
buffer_load_dwordx4 v[16:19], v252, s[8:11], s44 offen offset:0
v_mfma_f32_32x32x16_bf16 a[160:175], v[208:211], v[208:211], 0
buffer_load_dwordx4 v[48:51], v252, s[8:11], s45 offen offset:0
v_mfma_f32_32x32x16_bf16 a[176:191], v[208:211], v[208:211], 0
buffer_load_dwordx4 v[80:83], v252, s[8:11], s46 offen offset:0
buffer_load_dwordx4 v[112:115], v252, s[8:11], s47 offen offset:0
v_mfma_f32_32x32x16_bf16 a[192:207], v[208:211], v[208:211], 0
buffer_load_dwordx4 v[20:23], v252, s[8:11], s44 offen offset:1024
v_mfma_f32_32x32x16_bf16 a[208:223], v[208:211], v[208:211], 0
buffer_load_dwordx4 v[52:55], v252, s[8:11], s45 offen offset:1024
buffer_load_dwordx4 v[84:87], v252, s[8:11], s46 offen offset:1024
v_mfma_f32_32x32x16_bf16 a[224:239], v[208:211], v[208:211], 0
buffer_load_dwordx4 v[116:119], v252, s[8:11], s47 offen offset:1024
v_mfma_f32_32x32x16_bf16 a[240:255], v[208:211], v[208:211], 0
v_bfe_u32 v248, v252, 4, 3
v_lshlrev_b32 v248, 6, v248
v_bfe_u32 v253, v252, 7, 1
v_lshl_or_b32 v248, v253, 10, v248
v_bfe_u32 v253, v252, 8, 2
v_lshl_or_b32 v248, v253, 4, v248
v_bfe_u32 v253, v252, 6, 1
v_lshlrev_b32 v253, 5, v253
v_xor_b32 v248, v248, v253
v_and_b32 v249, 0x1c0, v252
v_bfe_u32 v253, v252, 9, 1
v_lshl_or_b32 v249, v253, 10, v249
v_bfe_u32 v253, v252, 8, 1
v_lshl_or_b32 v249, v253, 5, v249
v_bfe_u32 v253, v252, 4, 2
v_lshl_or_b32 v249, v253, 3, v249
v_xor_b32 v250, 32, v249
s_waitcnt vmcnt(24)
s_barrier
ds_read_b128 v[224:227], v248 offset:0
ds_read_b128 v[228:231], v248 offset:512
ds_read_b128 v[232:235], v248 offset:2048
ds_read_b128 v[236:239], v248 offset:2560
s_waitcnt lgkmcnt(2)
s_waitcnt vmcnt(16)
v_mfma_f32_16x16x32_bf16 v[160:163], v[224:227], v[0:3], 0
ds_read_b128 v[240:243], v248 offset:16384
v_mfma_f32_16x16x32_bf16 v[160:163], v[228:231], v[4:7], v[160:163]
buffer_load_dwordx4 v[24:27], v252, s[8:11], s44 offen offset:2048
v_mfma_f32_16x16x32_bf16 v[164:167], v[224:227], v[32:35], 0
v_mfma_f32_16x16x32_bf16 v[164:167], v[228:231], v[36:39], v[164:167]
buffer_load_dwordx4 v[56:59], v252, s[8:11], s45 offen offset:2048
v_mfma_f32_16x16x32_bf16 v[168:171], v[224:227], v[64:67], 0
ds_read_b128 v[244:247], v248 offset:16896
v_mfma_f32_16x16x32_bf16 v[168:171], v[228:231], v[68:71], v[168:171]
buffer_load_dwordx4 v[88:91], v252, s[8:11], s46 offen offset:2048
v_mfma_f32_16x16x32_bf16 v[172:175], v[224:227], v[96:99], 0
v_mfma_f32_16x16x32_bf16 v[172:175], v[228:231], v[100:103], v[172:175]
s_waitcnt lgkmcnt(2)
buffer_load_dwordx4 v[120:123], v252, s[8:11], s47 offen offset:2048
v_mfma_f32_16x16x32_bf16 v[176:179], v[232:235], v[0:3], 0
ds_read_b128 v[224:227], v248 offset:4096
v_mfma_f32_16x16x32_bf16 v[176:179], v[236:239], v[4:7], v[176:179]
buffer_load_dwordx4 v[28:31], v252, s[8:11], s44 offen offset:3072
v_mfma_f32_16x16x32_bf16 v[180:183], v[232:235], v[32:35], 0
v_mfma_f32_16x16x32_bf16 v[180:183], v[236:239], v[36:39], v[180:183]
buffer_load_dwordx4 v[60:63], v252, s[8:11], s45 offen offset:3072
v_mfma_f32_16x16x32_bf16 v[184:187], v[232:235], v[64:67], 0
ds_read_b128 v[228:231], v248 offset:4608
v_mfma_f32_16x16x32_bf16 v[184:187], v[236:239], v[68:71], v[184:187]
buffer_load_dwordx4 v[92:95], v252, s[8:11], s46 offen offset:3072
v_mfma_f32_16x16x32_bf16 v[188:191], v[232:235], v[96:99], 0
v_mfma_f32_16x16x32_bf16 v[188:191], v[236:239], v[100:103], v[188:191]
s_waitcnt lgkmcnt(2)
buffer_load_dwordx4 v[124:127], v252, s[8:11], s47 offen offset:3072
v_mfma_f32_16x16x32_bf16 v[192:195], v[240:243], v[0:3], 0
ds_read_b128 v[232:235], v248 offset:6144
v_mfma_f32_16x16x32_bf16 v[192:195], v[244:247], v[4:7], v[192:195]
v_mfma_f32_16x16x32_bf16 v[196:199], v[240:243], v[32:35], 0
v_mfma_f32_16x16x32_bf16 v[196:199], v[244:247], v[36:39], v[196:199]
v_mfma_f32_16x16x32_bf16 v[200:203], v[240:243], v[64:67], 0
ds_read_b128 v[236:239], v248 offset:6656
v_mfma_f32_16x16x32_bf16 v[200:203], v[244:247], v[68:71], v[200:203]
v_mfma_f32_16x16x32_bf16 v[204:207], v[240:243], v[96:99], 0
v_mfma_f32_16x16x32_bf16 v[204:207], v[244:247], v[100:103], v[204:207]
s_waitcnt lgkmcnt(2)
s_waitcnt vmcnt(16)
v_mfma_f32_16x16x32_bf16 v[160:163], v[224:227], v[8:11], v[160:163]
ds_read_b128 v[240:243], v248 offset:20480
v_mfma_f32_16x16x32_bf16 v[160:163], v[228:231], v[12:15], v[160:163]
buffer_load_dwordx4 v251, s[12:15], s28 offen offset:2048 lds
v_mfma_f32_16x16x32_bf16 v[164:167], v[224:227], v[40:43], v[164:167]
v_mfma_f32_16x16x32_bf16 v[164:167], v[228:231], v[44:47], v[164:167]
buffer_load_dwordx4 v251, s[12:15], s28 offen offset:3072 lds
v_mfma_f32_16x16x32_bf16 v[168:171], v[224:227], v[72:75], v[168:171]
ds_read_b128 v[244:247], v248 offset:20992
v_mfma_f32_16x16x32_bf16 v[168:171], v[228:231], v[76:79], v[168:171]
s_add_u32 s28, s28, 0x4000
s_add_u32 m0, s30, 0x8000
s_nop 0
v_mfma_f32_16x16x32_bf16 v[172:175], v[224:227], v[104:107], v[172:175]
v_mfma_f32_16x16x32_bf16 v[172:175], v[228:231], v[108:111], v[172:175]
s_waitcnt lgkmcnt(2)
buffer_load_dwordx4 v251, s[12:15], s28 offen offset:0 lds
v_mfma_f32_16x16x32_bf16 v[176:179], v[232:235], v[8:11], v[176:179]
ds_read_b128 v[224:227], v248 offset:8192
v_mfma_f32_16x16x32_bf16 v[176:179], v[236:239], v[12:15], v[176:179]
buffer_load_dwordx4 v251, s[12:15], s28 offen offset:1024 lds
v_mfma_f32_16x16x32_bf16 v[180:183], v[232:235], v[40:43], v[180:183]
v_mfma_f32_16x16x32_bf16 v[180:183], v[236:239], v[44:47], v[180:183]
buffer_load_dwordx4 v251, s[12:15], s28 offen offset:2048 lds
v_mfma_f32_16x16x32_bf16 v[184:187], v[232:235], v[72:75], v[184:187]
ds_read_b128 v[228:231], v248 offset:8704
v_mfma_f32_16x16x32_bf16 v[184:187], v[236:239], v[76:79], v[184:187]
buffer_load_dwordx4 v251, s[12:15], s28 offen offset:3072 lds
v_mfma_f32_16x16x32_bf16 v[188:191], v[232:235], v[104:107], v[188:191]
v_mfma_f32_16x16x32_bf16 v[188:191], v[236:239], v[108:111], v[188:191]
s_waitcnt lgkmcnt(2)
v_mfma_f32_16x16x32_bf16 v[192:195], v[240:243], v[8:11], v[192:195]
ds_read_b128 v[232:235], v248 offset:10240
v_mfma_f32_16x16x32_bf16 v[192:195], v[244:247], v[12:15], v[192:195]
v_mfma_f32_16x16x32_bf16 v[196:199], v[240:243], v[40:43], v[196:199]
v_mfma_f32_16x16x32_bf16 v[196:199], v[244:247], v[44:47], v[196:199]
v_mfma_f32_16x16x32_bf16 v[200:203], v[240:243], v[72:75], v[200:203]
ds_read_b128 v[236:239], v248 offset:10752
v_mfma_f32_16x16x32_bf16 v[200:203], v[244:247], v[76:79], v[200:203]
v_mfma_f32_16x16x32_bf16 v[204:207], v[240:243], v[104:107], v[204:207]
v_mfma_f32_16x16x32_bf16 v[204:207], v[244:247], v[108:111], v[204:207]
s_waitcnt lgkmcnt(2)
s_waitcnt vmcnt(14)
v_mfma_f32_16x16x32_bf16 v[160:163], v[224:227], v[16:19], v[160:163]
ds_read_b128 v[240:243], v248 offset:24576
v_mfma_f32_16x16x32_bf16 v[160:163], v[228:231], v[20:23], v[160:163]
s_add_u32 s28, s28, 0x4000
s_add_u32 m0, s30, 0xc000
s_nop 0
v_mfma_f32_16x16x32_bf16 v[164:167], v[224:227], v[48:51], v[164:167]
v_mfma_f32_16x16x32_bf16 v[164:167], v[228:231], v[52:55], v[164:167]
buffer_load_dwordx4 v251, s[12:15], s28 offen offset:0 lds
v_mfma_f32_16x16x32_bf16 v[168:171], v[224:227], v[80:83], v[168:171]
ds_read_b128 v[244:247], v248 offset:25088
v_mfma_f32_16x16x32_bf16 v[168:171], v[228:231], v[84:87], v[168:171]
buffer_load_dwordx4 v251, s[12:15], s28 offen offset:1024 lds
v_mfma_f32_16x16x32_bf16 v[172:175], v[224:227], v[112:115], v[172:175]
v_mfma_f32_16x16x32_bf16 v[172:175], v[228:231], v[116:119], v[172:175]
s_waitcnt lgkmcnt(2)
buffer_load_dwordx4 v251, s[12:15], s28 offen offset:2048 lds
v_mfma_f32_16x16x32_bf16 v[176:179], v[232:235], v[16:19], v[176:179]
ds_read_b128 v[224:227], v248 offset:12288
v_mfma_f32_16x16x32_bf16 v[176:179], v[236:239], v[20:23], v[176:179]
buffer_load_dwordx4 v251, s[12:15], s28 offen offset:3072 lds
v_mfma_f32_16x16x32_bf16 v[180:183], v[232:235], v[48:51], v[180:183]
v_mfma_f32_16x16x32_bf16 v[180:183], v[236:239], v[52:55], v[180:183]
v_mfma_f32_16x16x32_bf16 v[184:187], v[232:235], v[80:83], v[184:187]
ds_read_b128 v[228:231], v248 offset:12800
v_mfma_f32_16x16x32_bf16 v[184:187], v[236:239], v[84:87], v[184:187]
v_mfma_f32_16x16x32_bf16 v[188:191], v[232:235], v[112:115], v[188:191]
v_mfma_f32_16x16x32_bf16 v[188:191], v[236:239], v[116:119], v[188:191]
s_waitcnt lgkmcnt(2)
v_mfma_f32_16x16x32_bf16 v[192:195], v[240:243], v[16:19], v[192:195]
ds_read_b128 v[232:235], v248 offset:14336
v_mfma_f32_16x16x32_bf16 v[192:195], v[244:247], v[20:23], v[192:195]
v_mfma_f32_16x16x32_bf16 v[196:199], v[240:243], v[48:51], v[196:199]
v_mfma_f32_16x16x32_bf16 v[196:199], v[244:247], v[52:55], v[196:199]
v_mfma_f32_16x16x32_bf16 v[200:203], v[240:243], v[80:83], v[200:203]
ds_read_b128 v[236:239], v248 offset:14848
v_mfma_f32_16x16x32_bf16 v[200:203], v[244:247], v[84:87], v[200:203]
v_mfma_f32_16x16x32_bf16 v[204:207], v[240:243], v[112:115], v[204:207]
v_mfma_f32_16x16x32_bf16 v[204:207], v[244:247], v[116:119], v[204:207]
s_waitcnt lgkmcnt(2)
s_waitcnt vmcnt(10)
v_mfma_f32_16x16x32_bf16 v[160:163], v[224:227], v[24:27], v[160:163]
ds_read_b128 v[240:243], v248 offset:28672
v_mfma_f32_16x16x32_bf16 v[160:163], v[228:231], v[28:31], v[160:163]
s_add_u32 s28, s28, 0x4000
s_add_u32 m0, s30, 0x10000
s_nop 0
v_mfma_f32_16x16x32_bf16 v[164:167], v[224:227], v[56:59], v[164:167]
v_mfma_f32_16x16x32_bf16 v[164:167], v[228:231], v[60:63], v[164:167]
buffer_load_dwordx4 v251, s[12:15], s28 offen offset:0 lds
v_mfma_f32_16x16x32_bf16 v[168:171], v[224:227], v[88:91], v[168:171]
ds_read_b128 v[244:247], v248 offset:29184
v_mfma_f32_16x16x32_bf16 v[168:171], v[228:231], v[92:95], v[168:171]
buffer_load_dwordx4 v251, s[12:15], s28 offen offset:1024 lds
v_mfma_f32_16x16x32_bf16 v[172:175], v[224:227], v[120:123], v[172:175]
v_mfma_f32_16x16x32_bf16 v[172:175], v[228:231], v[124:127], v[172:175]
s_waitcnt lgkmcnt(2)
buffer_load_dwordx4 v251, s[12:15], s28 offen offset:2048 lds
v_mfma_f32_16x16x32_bf16 v[176:179], v[232:235], v[24:27], v[176:179]
v_mfma_f32_16x16x32_bf16 v[176:179], v[236:239], v[28:31], v[176:179]
buffer_load_dwordx4 v251, s[12:15], s28 offen offset:3072 lds
v_mfma_f32_16x16x32_bf16 v[180:183], v[232:235], v[56:59], v[180:183]
v_mfma_f32_16x16x32_bf16 v[180:183], v[236:239], v[60:63], v[180:183]
v_mfma_f32_16x16x32_bf16 v[184:187], v[232:235], v[88:91], v[184:187]
v_mfma_f32_16x16x32_bf16 v[184:187], v[236:239], v[92:95], v[184:187]
v_mfma_f32_16x16x32_bf16 v[188:191], v[232:235], v[120:123], v[188:191]
v_mfma_f32_16x16x32_bf16 v[188:191], v[236:239], v[124:127], v[188:191]
s_waitcnt lgkmcnt(0)
v_mfma_f32_16x16x32_bf16 v[192:195], v[240:243], v[24:27], v[192:195]
v_mfma_f32_16x16x32_bf16 v[192:195], v[244:247], v[28:31], v[192:195]
v_mfma_f32_16x16x32_bf16 v[196:199], v[240:243], v[56:59], v[196:199]
v_mfma_f32_16x16x32_bf16 v[196:199], v[244:247], v[60:63], v[196:199]
v_mfma_f32_16x16x32_bf16 v[200:203], v[240:243], v[88:91], v[200:203]
v_mfma_f32_16x16x32_bf16 v[200:203], v[244:247], v[92:95], v[200:203]
v_mfma_f32_16x16x32_bf16 v[204:207], v[240:243], v[120:123], v[204:207]
v_mfma_f32_16x16x32_bf16 v[204:207], v[244:247], v[124:127], v[204:207]
s_nop 3
v_max3_f32 v224, v160, v161, v162
v_max3_f32 v225, v164, v165, v166
v_max3_f32 v226, v168, v169, v170
v_max3_f32 v227, v172, v173, v174
v_max3_f32 v224, v224, v163, v176
v_max3_f32 v225, v225, v167, v180
v_max3_f32 v226, v226, v171, v184
v_max3_f32 v227, v227, v175, v188
v_max3_f32 v224, v224, v177, v178
v_max3_f32 v225, v225, v181, v182
v_max3_f32 v226, v226, v185, v186
v_max3_f32 v227, v227, v189, v190
v_max_f32 v224, v224, v179
v_max_f32 v225, v225, v183
v_max_f32 v226, v226, v187
v_max_f32 v227, v227, v191
s_add_u32 s28, s28, 0x4000
s_xor_b32 s30, s30, 0x10000
v_mov_b32 v228, v224
v_mov_b32 v229, v225
v_mov_b32 v230, v226
v_mov_b32 v231, v227
v_permlane32_swap_b32 v224, v228
v_permlane32_swap_b32 v225, v229
v_permlane32_swap_b32 v226, v230
v_permlane32_swap_b32 v227, v231
v_max_f32 v224, v224, v228
v_max_f32 v225, v225, v229
v_max_f32 v226, v226, v230
v_max_f32 v227, v227, v231
v_mov_b32 v228, v224
v_mov_b32 v229, v225
v_mov_b32 v230, v226
v_mov_b32 v231, v227
v_permlane16_swap_b32 v224, v228
v_permlane16_swap_b32 v225, v229
v_permlane16_swap_b32 v226, v230
v_permlane16_swap_b32 v227, v231
v_max_f32 v224, v224, v228
v_max_f32 v225, v225, v229
v_max_f32 v226, v226, v230
v_max_f32 v227, v227, v231
s_waitcnt vmcnt(8)
s_barrier
ds_read_b128 v[232:235], v248 offset:18432
ds_read_b128 v[236:239], v248 offset:18944
ds_read_b128 v[240:243], v248 offset:22528
ds_read_b128 v[244:247], v248 offset:23040
v_cvt_pk_bf16_f32 v228, -v224, -v224
v_cvt_pk_bf16_f32 v229, -v225, -v225
v_cvt_pk_bf16_f32 v230, -v226, -v226
v_cvt_pk_bf16_f32 v231, -v227, -v227
v_lshlrev_b32 v253, 2, v252
v_lshlrev_b32 v147, 16, v228
v_lshlrev_b32 v151, 16, v229
v_lshlrev_b32 v155, 16, v230
v_lshlrev_b32 v159, 16, v231
s_mov_b64 exec, 0xffff
v_bfi_b32 v0, s32, v228, v0
v_bfi_b32 v32, s32, v229, v32
v_bfi_b32 v64, s32, v230, v64
v_bfi_b32 v96, s32, v231, v96
v_xor_b32 v224, 0x80000000, v147
v_xor_b32 v225, 0x80000000, v151
v_xor_b32 v226, 0x80000000, v155
v_xor_b32 v227, 0x80000000, v159
s_xor_b32 s35, s48, 0
buffer_store_dword v224, v253, s[24:27], s35 offen offset:0 sc1
s_xor_b32 s35, s48, 1024
buffer_store_dword v225, v253, s[24:27], s35 offen offset:0 sc1
s_xor_b32 s35, s48, 2048
buffer_store_dword v226, v253, s[24:27], s35 offen offset:0 sc1
s_xor_b32 s35, s48, 3072
buffer_store_dword v227, v253, s[24:27], s35 offen offset:0 sc1
s_mov_b64 exec, -1
s_waitcnt lgkmcnt(2)
v_mfma_f32_16x16x32_bf16 v[208:211], v[232:235], v[0:3], 0
ds_read_b128 v[224:227], v248 offset:26624
v_add_f32 v192, v192, v147
v_add_f32 v193, v193, v147
v_add_f32 v194, v194, v147
v_mfma_f32_16x16x32_bf16 v[208:211], v[236:239], v[4:7], v[208:211]
v_add_f32 v195, v195, v147
v_exp_f32 v192, v192
v_mfma_f32_16x16x32_bf16 v[212:215], v[232:235], v[32:35], 0
v_exp_f32 v193, v193
v_exp_f32 v194, v194
v_mfma_f32_16x16x32_bf16 v[212:215], v[236:239], v[36:39], v[212:215]
v_exp_f32 v195, v195
v_add_f32 v196, v196, v151
v_add_f32 v197, v197, v151
v_mfma_f32_16x16x32_bf16 v[216:219], v[232:235], v[64:67], 0
ds_read_b128 v[228:231], v248 offset:27136
v_cvt_pk_bf16_f32 v144, v192, v193
v_cvt_pk_bf16_f32 v145, v194, v195
v_add_f32 v198, v198, v151
v_mfma_f32_16x16x32_bf16 v[216:219], v[236:239], v[68:71], v[216:219]
v_add_f32 v199, v199, v151
v_exp_f32 v196, v196
v_mfma_f32_16x16x32_bf16 v[220:223], v[232:235], v[96:99], 0
v_exp_f32 v197, v197
v_exp_f32 v198, v198
v_mfma_f32_16x16x32_bf16 v[220:223], v[236:239], v[100:103], v[220:223]
s_waitcnt lgkmcnt(2)
v_exp_f32 v199, v199
v_cvt_pk_bf16_f32 v148, v196, v197
v_mfma_f32_16x16x32_bf16 v[208:211], v[240:243], v[8:11], v[208:211]
ds_read_b128 v[232:235], v248 offset:30720
v_cvt_pk_bf16_f32 v149, v198, v199
v_add_f32 v200, v200, v155
v_add_f32 v201, v201, v155
v_mfma_f32_16x16x32_bf16 v[208:211], v[244:247], v[12:15], v[208:211]
v_add_f32 v202, v202, v155
v_add_f32 v203, v203, v155
v_exp_f32 v200, v200
v_mfma_f32_16x16x32_bf16 v[212:215], v[240:243], v[40:43], v[212:215]
v_exp_f32 v201, v201
v_exp_f32 v202, v202
v_mfma_f32_16x16x32_bf16 v[212:215], v[244:247], v[44:47], v[212:215]
v_exp_f32 v203, v203
v_add_f32 v204, v204, v159
v_add_f32 v205, v205, v159
v_mfma_f32_16x16x32_bf16 v[216:219], v[240:243], v[72:75], v[216:219]
ds_read_b128 v[236:239], v248 offset:31232
v_cvt_pk_bf16_f32 v152, v200, v201
v_cvt_pk_bf16_f32 v153, v202, v203
v_add_f32 v206, v206, v159
v_mfma_f32_16x16x32_bf16 v[216:219], v[244:247], v[76:79], v[216:219]
v_add_f32 v207, v207, v159
v_exp_f32 v204, v204
v_mfma_f32_16x16x32_bf16 v[220:223], v[240:243], v[104:107], v[220:223]
v_exp_f32 v205, v205
v_exp_f32 v206, v206
v_mfma_f32_16x16x32_bf16 v[220:223], v[244:247], v[108:111], v[220:223]
s_waitcnt lgkmcnt(2)
v_exp_f32 v207, v207
v_cvt_pk_bf16_f32 v156, v204, v205
v_mfma_f32_16x16x32_bf16 v[208:211], v[224:227], v[16:19], v[208:211]
ds_read_b128 v[240:243], v248 offset:32768
v_cvt_pk_bf16_f32 v157, v206, v207
v_add_f32 v160, v160, v147
v_add_f32 v161, v161, v147
v_mfma_f32_16x16x32_bf16 v[208:211], v[228:231], v[20:23], v[208:211]
v_add_f32 v162, v162, v147
v_add_f32 v163, v163, v147
v_exp_f32 v160, v160
v_mfma_f32_16x16x32_bf16 v[212:215], v[224:227], v[48:51], v[212:215]
v_exp_f32 v161, v161
v_exp_f32 v162, v162
v_mfma_f32_16x16x32_bf16 v[212:215], v[228:231], v[52:55], v[212:215]
v_exp_f32 v163, v163
v_add_f32 v164, v164, v151
v_add_f32 v165, v165, v151
v_mfma_f32_16x16x32_bf16 v[216:219], v[224:227], v[80:83], v[216:219]
ds_read_b128 v[244:247], v248 offset:33280
v_cvt_pk_bf16_f32 v128, v160, v161
v_cvt_pk_bf16_f32 v129, v162, v163
v_add_f32 v166, v166, v151
v_mfma_f32_16x16x32_bf16 v[216:219], v[228:231], v[84:87], v[216:219]
v_add_f32 v167, v167, v151
v_exp_f32 v164, v164
v_mfma_f32_16x16x32_bf16 v[220:223], v[224:227], v[112:115], v[220:223]
v_exp_f32 v165, v165
v_exp_f32 v166, v166
v_mfma_f32_16x16x32_bf16 v[220:223], v[228:231], v[116:119], v[220:223]
s_waitcnt lgkmcnt(2)
v_exp_f32 v167, v167
v_cvt_pk_bf16_f32 v132, v164, v165
v_mfma_f32_16x16x32_bf16 v[208:211], v[232:235], v[24:27], v[208:211]
ds_read_b128 v[224:227], v248 offset:36864
v_cvt_pk_bf16_f32 v133, v166, v167
v_add_f32 v168, v168, v155
v_add_f32 v169, v169, v155
v_mfma_f32_16x16x32_bf16 v[208:211], v[236:239], v[28:31], v[208:211]
v_add_f32 v170, v170, v155
v_add_f32 v171, v171, v155
v_exp_f32 v168, v168
v_mfma_f32_16x16x32_bf16 v[212:215], v[232:235], v[56:59], v[212:215]
v_exp_f32 v169, v169
v_exp_f32 v170, v170
v_mfma_f32_16x16x32_bf16 v[212:215], v[236:239], v[60:63], v[212:215]
v_exp_f32 v171, v171
v_add_f32 v172, v172, v159
v_add_f32 v173, v173, v159
v_mfma_f32_16x16x32_bf16 v[216:219], v[232:235], v[88:91], v[216:219]
ds_read_b128 v[228:231], v248 offset:37376
v_cvt_pk_bf16_f32 v136, v168, v169
v_cvt_pk_bf16_f32 v137, v170, v171
v_add_f32 v174, v174, v159
v_mfma_f32_16x16x32_bf16 v[216:219], v[236:239], v[92:95], v[216:219]
v_add_f32 v175, v175, v159
v_exp_f32 v172, v172
v_mfma_f32_16x16x32_bf16 v[220:223], v[232:235], v[120:123], v[220:223]
v_exp_f32 v173, v173
v_exp_f32 v174, v174
v_mfma_f32_16x16x32_bf16 v[220:223], v[236:239], v[124:127], v[220:223]
s_waitcnt lgkmcnt(2)
v_exp_f32 v175, v175
v_cvt_pk_bf16_f32 v140, v172, v173
v_mfma_f32_16x16x32_bf16 v[192:195], v[240:243], v[0:3], 0
ds_read_b128 v[232:235], v248 offset:40960
v_cvt_pk_bf16_f32 v141, v174, v175
v_add_f32 v176, v176, v147
v_add_f32 v177, v177, v147
v_mfma_f32_16x16x32_bf16 v[192:195], v[244:247], v[4:7], v[192:195]
v_add_f32 v178, v178, v147
v_add_f32 v179, v179, v147
v_exp_f32 v176, v176
v_mfma_f32_16x16x32_bf16 v[196:199], v[240:243], v[32:35], 0
v_exp_f32 v177, v177
v_exp_f32 v178, v178
v_mfma_f32_16x16x32_bf16 v[196:199], v[244:247], v[36:39], v[196:199]
v_exp_f32 v179, v179
v_add_f32 v180, v180, v151
v_add_f32 v181, v181, v151
v_mfma_f32_16x16x32_bf16 v[200:203], v[240:243], v[64:67], 0
ds_read_b128 v[236:239], v248 offset:41472
v_cvt_pk_bf16_f32 v130, v176, v177
v_cvt_pk_bf16_f32 v131, v178, v179
v_add_f32 v182, v182, v151
v_mfma_f32_16x16x32_bf16 v[200:203], v[244:247], v[68:71], v[200:203]
v_add_f32 v183, v183, v151
v_exp_f32 v180, v180
v_mfma_f32_16x16x32_bf16 v[204:207], v[240:243], v[96:99], 0
v_exp_f32 v181, v181
v_exp_f32 v182, v182
v_mfma_f32_16x16x32_bf16 v[204:207], v[244:247], v[100:103], v[204:207]
s_waitcnt lgkmcnt(2)
v_exp_f32 v183, v183
v_cvt_pk_bf16_f32 v134, v180, v181
v_mfma_f32_16x16x32_bf16 v[192:195], v[224:227], v[8:11], v[192:195]
ds_read_b128 v[240:243], v248 offset:45056
v_cvt_pk_bf16_f32 v135, v182, v183
v_add_f32 v184, v184, v155
v_add_f32 v185, v185, v155
v_mfma_f32_16x16x32_bf16 v[192:195], v[228:231], v[12:15], v[192:195]
v_add_f32 v186, v186, v155
v_add_f32 v187, v187, v155
v_exp_f32 v184, v184
v_mfma_f32_16x16x32_bf16 v[196:199], v[224:227], v[40:43], v[196:199]
v_exp_f32 v185, v185
v_exp_f32 v186, v186
v_mfma_f32_16x16x32_bf16 v[196:199], v[228:231], v[44:47], v[196:199]
v_exp_f32 v187, v187
v_add_f32 v188, v188, v159
v_add_f32 v189, v189, v159
v_mfma_f32_16x16x32_bf16 v[200:203], v[224:227], v[72:75], v[200:203]
ds_read_b128 v[244:247], v248 offset:45568
v_cvt_pk_bf16_f32 v138, v184, v185
v_cvt_pk_bf16_f32 v139, v186, v187
v_add_f32 v190, v190, v159
v_mfma_f32_16x16x32_bf16 v[200:203], v[228:231], v[76:79], v[200:203]
v_add_f32 v191, v191, v159
v_exp_f32 v188, v188
v_mfma_f32_16x16x32_bf16 v[204:207], v[224:227], v[104:107], v[204:207]
v_exp_f32 v189, v189
v_exp_f32 v190, v190
v_mfma_f32_16x16x32_bf16 v[204:207], v[228:231], v[108:111], v[204:207]
s_waitcnt lgkmcnt(2)
v_exp_f32 v191, v191
v_cvt_pk_bf16_f32 v142, v188, v189
v_mfma_f32_16x16x32_bf16 v[192:195], v[232:235], v[16:19], v[192:195]
ds_read_b64_tr_b16 v[224:225], v249 offset:0
v_cvt_pk_bf16_f32 v143, v190, v191
v_exp_f32 v208, v208
v_mfma_f32_16x16x32_bf16 v[192:195], v[236:239], v[20:23], v[192:195]
v_exp_f32 v209, v209
v_exp_f32 v210, v210
v_mfma_f32_16x16x32_bf16 v[196:199], v[232:235], v[48:51], v[196:199]
ds_read_b64_tr_b16 v[226:227], v249 offset:2048
v_exp_f32 v211, v211
v_cvt_pk_bf16_f32 v146, v208, v209
v_mfma_f32_16x16x32_bf16 v[196:199], v[236:239], v[52:55], v[196:199]
v_cvt_pk_bf16_f32 v147, v210, v211
v_exp_f32 v212, v212
v_mfma_f32_16x16x32_bf16 v[200:203], v[232:235], v[80:83], v[200:203]
ds_read_b64_tr_b16 v[228:229], v249 offset:16384
v_exp_f32 v213, v213
v_mfma_f32_16x16x32_bf16 v[200:203], v[236:239], v[84:87], v[200:203]
v_exp_f32 v214, v214
v_exp_f32 v215, v215
v_mfma_f32_16x16x32_bf16 v[204:207], v[232:235], v[112:115], v[204:207]
ds_read_b64_tr_b16 v[230:231], v249 offset:18432
v_cvt_pk_bf16_f32 v150, v212, v213
v_cvt_pk_bf16_f32 v151, v214, v215
v_mfma_f32_16x16x32_bf16 v[204:207], v[236:239], v[116:119], v[204:207]
s_waitcnt lgkmcnt(4)
v_exp_f32 v216, v216
v_mfma_f32_16x16x32_bf16 v[192:195], v[240:243], v[24:27], v[192:195]
ds_read_b64_tr_b16 v[232:233], v250 offset:0
v_exp_f32 v217, v217
v_mfma_f32_16x16x32_bf16 v[192:195], v[244:247], v[28:31], v[192:195]
v_exp_f32 v218, v218
v_exp_f32 v219, v219
v_mfma_f32_16x16x32_bf16 v[196:199], v[240:243], v[56:59], v[196:199]
ds_read_b64_tr_b16 v[234:235], v250 offset:2048
v_cvt_pk_bf16_f32 v154, v216, v217
v_cvt_pk_bf16_f32 v155, v218, v219
v_mfma_f32_16x16x32_bf16 v[196:199], v[244:247], v[60:63], v[196:199]
v_exp_f32 v220, v220
v_exp_f32 v221, v221
v_mfma_f32_16x16x32_bf16 v[200:203], v[240:243], v[88:91], v[200:203]
ds_read_b64_tr_b16 v[236:237], v250 offset:16384
v_exp_f32 v222, v222
v_cvt_pk_bf16_f32 v158, v220, v221
v_mfma_f32_16x16x32_bf16 v[200:203], v[244:247], v[92:95], v[200:203]
v_exp_f32 v223, v223
v_mfma_f32_16x16x32_bf16 v[204:207], v[240:243], v[120:123], v[204:207]
ds_read_b64_tr_b16 v[238:239], v250 offset:18432
v_cvt_pk_bf16_f32 v159, v222, v223
v_mfma_f32_16x16x32_bf16 v[204:207], v[244:247], v[124:127], v[204:207]
s_cmp_eq_u32 s50, 1
s_cselect_b32 s40, 0x7fff0000, s40
s_cselect_b32 s44, 0x7fff0000, s44
.p2align 6
L2_loop:
s_waitcnt lgkmcnt(4)
v_mfma_f32_16x16x32_bf16 a[0:3], v[224:227], v[128:131], a[0:3]
ds_read_b64_tr_b16 v[240:241], v249 offset:512
v_mfma_f32_16x16x32_bf16 a[0:3], v[228:231], v[144:147], a[0:3]
v_mfma_f32_16x16x32_bf16 a[4:7], v[224:227], v[132:135], a[4:7]
ds_read_b64_tr_b16 v[242:243], v249 offset:2560
v_mfma_f32_16x16x32_bf16 a[4:7], v[228:231], v[148:151], a[4:7]
v_exp_f32 v192, v192
v_mfma_f32_16x16x32_bf16 a[8:11], v[224:227], v[136:139], a[8:11]
ds_read_b64_tr_b16 v[244:245], v249 offset:16896
v_mfma_f32_16x16x32_bf16 a[8:11], v[228:231], v[152:155], a[8:11]
v_exp_f32 v193, v193
v_mfma_f32_16x16x32_bf16 a[12:15], v[224:227], v[140:143], a[12:15]
ds_read_b64_tr_b16 v[246:247], v249 offset:18944
v_cvt_pk_bf16_f32 v160, v192, v193
v_mfma_f32_16x16x32_bf16 a[12:15], v[228:231], v[156:159], a[12:15]
s_waitcnt lgkmcnt(4)
v_mfma_f32_16x16x32_bf16 a[16:19], v[232:235], v[128:131], a[16:19]
ds_read_b64_tr_b16 v[176:177], v250 offset:512
v_mfma_f32_16x16x32_bf16 a[16:19], v[236:239], v[144:147], a[16:19]
v_exp_f32 v194, v194
v_mfma_f32_16x16x32_bf16 a[20:23], v[232:235], v[132:135], a[20:23]
ds_read_b64_tr_b16 v[178:179], v250 offset:2560
v_mfma_f32_16x16x32_bf16 a[20:23], v[236:239], v[148:151], a[20:23]
v_exp_f32 v195, v195
v_mfma_f32_16x16x32_bf16 a[24:27], v[232:235], v[136:139], a[24:27]
ds_read_b64_tr_b16 v[180:181], v250 offset:16896
v_cvt_pk_bf16_f32 v161, v194, v195
v_mfma_f32_16x16x32_bf16 a[24:27], v[236:239], v[152:155], a[24:27]
v_exp_f32 v196, v196
v_mfma_f32_16x16x32_bf16 a[28:31], v[232:235], v[140:143], a[28:31]
ds_read_b64_tr_b16 v[182:183], v250 offset:18944
v_mfma_f32_16x16x32_bf16 a[28:31], v[236:239], v[156:159], a[28:31]
s_waitcnt lgkmcnt(4)
v_mfma_f32_16x16x32_bf16 a[32:35], v[240:243], v[128:131], a[32:35]
ds_read_b128 v[224:227], v248 offset:34816
v_mfma_f32_16x16x32_bf16 a[32:35], v[244:247], v[144:147], a[32:35]
v_exp_f32 v197, v197
v_mfma_f32_16x16x32_bf16 a[36:39], v[240:243], v[132:135], a[36:39]
v_exp_f32 v198, v198
v_mfma_f32_16x16x32_bf16 a[36:39], v[244:247], v[148:151], a[36:39]
v_exp_f32 v199, v199
v_mfma_f32_16x16x32_bf16 a[40:43], v[240:243], v[136:139], a[40:43]
ds_read_b128 v[228:231], v248 offset:35328
v_cvt_pk_bf16_f32 v164, v196, v197
v_mfma_f32_16x16x32_bf16 a[40:43], v[244:247], v[152:155], a[40:43]
v_cvt_pk_bf16_f32 v165, v198, v199
v_mfma_f32_16x16x32_bf16 a[44:47], v[240:243], v[140:143], a[44:47]
v_exp_f32 v200, v200
v_mfma_f32_16x16x32_bf16 a[44:47], v[244:247], v[156:159], a[44:47]
s_waitcnt lgkmcnt(2)
v_mfma_f32_16x16x32_bf16 a[48:51], v[176:179], v[128:131], a[48:51]
ds_read_b128 v[232:235], v248 offset:38912
v_mfma_f32_16x16x32_bf16 a[48:51], v[180:183], v[144:147], a[48:51]
v_exp_f32 v201, v201
v_mfma_f32_16x16x32_bf16 a[52:55], v[176:179], v[132:135], a[52:55]
v_exp_f32 v202, v202
v_mfma_f32_16x16x32_bf16 a[52:55], v[180:183], v[148:151], a[52:55]
v_exp_f32 v203, v203
v_mfma_f32_16x16x32_bf16 a[56:59], v[176:179], v[136:139], a[56:59]
ds_read_b128 v[236:239], v248 offset:39424
v_cvt_pk_bf16_f32 v168, v200, v201
v_mfma_f32_16x16x32_bf16 a[56:59], v[180:183], v[152:155], a[56:59]
v_cvt_pk_bf16_f32 v169, v202, v203
v_mfma_f32_16x16x32_bf16 a[60:63], v[176:179], v[140:143], a[60:63]
v_exp_f32 v204, v204
v_mfma_f32_16x16x32_bf16 a[60:63], v[180:183], v[156:159], a[60:63]
s_waitcnt lgkmcnt(2)
v_mfma_f32_16x16x32_bf16 v[208:211], v[224:227], v[0:3], 0
ds_read_b128 v[240:243], v248 offset:43008
v_mfma_f32_16x16x32_bf16 v[208:211], v[228:231], v[4:7], v[208:211]
v_exp_f32 v205, v205
v_mfma_f32_16x16x32_bf16 v[212:215], v[224:227], v[32:35], 0
v_exp_f32 v206, v206
v_mfma_f32_16x16x32_bf16 v[212:215], v[228:231], v[36:39], v[212:215]
v_exp_f32 v207, v207
v_mfma_f32_16x16x32_bf16 v[216:219], v[224:227], v[64:67], 0
ds_read_b128 v[244:247], v248 offset:43520
v_cvt_pk_bf16_f32 v172, v204, v205
v_mfma_f32_16x16x32_bf16 v[216:219], v[228:231], v[68:71], v[216:219]
v_cvt_pk_bf16_f32 v173, v206, v207
v_mfma_f32_16x16x32_bf16 v[220:223], v[224:227], v[96:99], 0
v_mfma_f32_16x16x32_bf16 v[220:223], v[228:231], v[100:103], v[220:223]
s_waitcnt lgkmcnt(2)
v_mfma_f32_16x16x32_bf16 v[208:211], v[232:235], v[8:11], v[208:211]
ds_read_b128 v[176:179], v248 offset:47104
v_mfma_f32_16x16x32_bf16 v[208:211], v[236:239], v[12:15], v[208:211]
v_mfma_f32_16x16x32_bf16 v[212:215], v[232:235], v[40:43], v[212:215]
v_mfma_f32_16x16x32_bf16 v[212:215], v[236:239], v[44:47], v[212:215]
v_mfma_f32_16x16x32_bf16 v[216:219], v[232:235], v[72:75], v[216:219]
ds_read_b128 v[180:183], v248 offset:47616
v_mfma_f32_16x16x32_bf16 v[216:219], v[236:239], v[76:79], v[216:219]
v_mfma_f32_16x16x32_bf16 v[220:223], v[232:235], v[104:107], v[220:223]
v_mfma_f32_16x16x32_bf16 v[220:223], v[236:239], v[108:111], v[220:223]
s_waitcnt lgkmcnt(2)
v_mfma_f32_16x16x32_bf16 v[208:211], v[240:243], v[16:19], v[208:211]
ds_read_b64_tr_b16 v[224:225], v249 offset:4096
v_mfma_f32_16x16x32_bf16 v[208:211], v[244:247], v[20:23], v[208:211]
v_mfma_f32_16x16x32_bf16 v[212:215], v[240:243], v[48:51], v[212:215]
ds_read_b64_tr_b16 v[226:227], v249 offset:6144
v_mfma_f32_16x16x32_bf16 v[212:215], v[244:247], v[52:55], v[212:215]
v_mfma_f32_16x16x32_bf16 v[216:219], v[240:243], v[80:83], v[216:219]
ds_read_b64_tr_b16 v[228:229], v249 offset:20480
v_mfma_f32_16x16x32_bf16 v[216:219], v[244:247], v[84:87], v[216:219]
v_mfma_f32_16x16x32_bf16 v[220:223], v[240:243], v[112:115], v[220:223]
ds_read_b64_tr_b16 v[230:231], v249 offset:22528
v_mfma_f32_16x16x32_bf16 v[220:223], v[244:247], v[116:119], v[220:223]
s_waitcnt lgkmcnt(4)
v_mfma_f32_16x16x32_bf16 v[208:211], v[176:179], v[24:27], v[208:211]
ds_read_b64_tr_b16 v[232:233], v250 offset:4096
v_mfma_f32_16x16x32_bf16 v[208:211], v[180:183], v[28:31], v[208:211]
v_mfma_f32_16x16x32_bf16 v[212:215], v[176:179], v[56:59], v[212:215]
ds_read_b64_tr_b16 v[234:235], v250 offset:6144
v_mfma_f32_16x16x32_bf16 v[212:215], v[180:183], v[60:63], v[212:215]
v_mfma_f32_16x16x32_bf16 v[216:219], v[176:179], v[88:91], v[216:219]
ds_read_b64_tr_b16 v[236:237], v250 offset:20480
v_mfma_f32_16x16x32_bf16 v[216:219], v[180:183], v[92:95], v[216:219]
v_mfma_f32_16x16x32_bf16 v[220:223], v[176:179], v[120:123], v[220:223]
ds_read_b64_tr_b16 v[238:239], v250 offset:22528
v_mfma_f32_16x16x32_bf16 v[220:223], v[180:183], v[124:127], v[220:223]
s_waitcnt lgkmcnt(4)
v_mfma_f32_16x16x32_bf16 a[64:67], v[224:227], v[128:131], a[64:67]
ds_read_b64_tr_b16 v[240:241], v249 offset:4608
v_mfma_f32_16x16x32_bf16 a[64:67], v[228:231], v[144:147], a[64:67]
v_mfma_f32_16x16x32_bf16 a[68:71], v[224:227], v[132:135], a[68:71]
ds_read_b64_tr_b16 v[242:243], v249 offset:6656
v_mfma_f32_16x16x32_bf16 a[68:71], v[228:231], v[148:151], a[68:71]
v_exp_f32 v208, v208
v_mfma_f32_16x16x32_bf16 a[72:75], v[224:227], v[136:139], a[72:75]
ds_read_b64_tr_b16 v[244:245], v249 offset:20992
v_mfma_f32_16x16x32_bf16 a[72:75], v[228:231], v[152:155], a[72:75]
v_exp_f32 v209, v209
v_mfma_f32_16x16x32_bf16 a[76:79], v[224:227], v[140:143], a[76:79]
ds_read_b64_tr_b16 v[246:247], v249 offset:23040
v_cvt_pk_bf16_f32 v162, v208, v209
v_mfma_f32_16x16x32_bf16 a[76:79], v[228:231], v[156:159], a[76:79]
s_waitcnt lgkmcnt(4)
s_waitcnt vmcnt(0)
s_barrier
s_add_u32 m0, s30, 0x4000
v_mfma_f32_16x16x32_bf16 a[80:83], v[232:235], v[128:131], a[80:83]
ds_read_b64_tr_b16 v[224:225], v250 offset:4608
v_mfma_f32_16x16x32_bf16 a[80:83], v[236:239], v[144:147], a[80:83]
buffer_load_dwordx4 v251, s[12:15], s28 offen offset:0 lds
v_mfma_f32_16x16x32_bf16 a[84:87], v[232:235], v[132:135], a[84:87]
ds_read_b64_tr_b16 v[226:227], v250 offset:6656
v_mfma_f32_16x16x32_bf16 a[84:87], v[236:239], v[148:151], a[84:87]
v_exp_f32 v210, v210
v_mfma_f32_16x16x32_bf16 a[88:91], v[232:235], v[136:139], a[88:91]
ds_read_b64_tr_b16 v[228:229], v250 offset:20992
v_mfma_f32_16x16x32_bf16 a[88:91], v[236:239], v[152:155], a[88:91]
v_exp_f32 v211, v211
v_mfma_f32_16x16x32_bf16 a[92:95], v[232:235], v[140:143], a[92:95]
ds_read_b64_tr_b16 v[230:231], v250 offset:23040
v_cvt_pk_bf16_f32 v163, v210, v211
v_mfma_f32_16x16x32_bf16 a[92:95], v[236:239], v[156:159], a[92:95]
s_waitcnt lgkmcnt(4)
v_mfma_f32_16x16x32_bf16 a[96:99], v[240:243], v[128:131], a[96:99]
ds_read_b128 v[232:235], v248 offset:49152
v_mfma_f32_16x16x32_bf16 a[96:99], v[244:247], v[144:147], a[96:99]
buffer_load_dwordx4 v251, s[12:15], s28 offen offset:1024 lds
v_mfma_f32_16x16x32_bf16 a[100:103], v[240:243], v[132:135], a[100:103]
v_exp_f32 v212, v212
v_mfma_f32_16x16x32_bf16 a[100:103], v[244:247], v[148:151], a[100:103]
v_exp_f32 v213, v213
v_mfma_f32_16x16x32_bf16 a[104:107], v[240:243], v[136:139], a[104:107]
ds_read_b128 v[236:239], v248 offset:49664
v_cvt_pk_bf16_f32 v166, v212, v213
v_mfma_f32_16x16x32_bf16 a[104:107], v[244:247], v[152:155], a[104:107]
v_exp_f32 v214, v214
v_mfma_f32_16x16x32_bf16 a[108:111], v[240:243], v[140:143], a[108:111]
v_exp_f32 v215, v215
v_mfma_f32_16x16x32_bf16 a[108:111], v[244:247], v[156:159], a[108:111]
s_waitcnt lgkmcnt(2)
v_cvt_pk_bf16_f32 v167, v214, v215
v_mfma_f32_16x16x32_bf16 a[112:115], v[224:227], v[128:131], a[112:115]
ds_read_b128 v[240:243], v248 offset:53248
v_mfma_f32_16x16x32_bf16 a[112:115], v[228:231], v[144:147], a[112:115]
buffer_load_dwordx4 v251, s[12:15], s28 offen offset:2048 lds
v_mfma_f32_16x16x32_bf16 a[116:119], v[224:227], v[132:135], a[116:119]
v_exp_f32 v216, v216
v_mfma_f32_16x16x32_bf16 a[116:119], v[228:231], v[148:151], a[116:119]
v_exp_f32 v217, v217
v_mfma_f32_16x16x32_bf16 a[120:123], v[224:227], v[136:139], a[120:123]
ds_read_b128 v[244:247], v248 offset:53760
v_cvt_pk_bf16_f32 v170, v216, v217
v_mfma_f32_16x16x32_bf16 a[120:123], v[228:231], v[152:155], a[120:123]
v_exp_f32 v218, v218
v_mfma_f32_16x16x32_bf16 a[124:127], v[224:227], v[140:143], a[124:127]
v_exp_f32 v219, v219
v_mfma_f32_16x16x32_bf16 a[124:127], v[228:231], v[156:159], a[124:127]
s_waitcnt lgkmcnt(2)
v_cvt_pk_bf16_f32 v171, v218, v219
v_mfma_f32_16x16x32_bf16 v[192:195], v[232:235], v[0:3], 0
ds_read_b128 v[224:227], v248 offset:57344
v_mfma_f32_16x16x32_bf16 v[192:195], v[236:239], v[4:7], v[192:195]
buffer_load_dwordx4 v251, s[12:15], s28 offen offset:3072 lds
v_mfma_f32_16x16x32_bf16 v[196:199], v[232:235], v[32:35], 0
v_exp_f32 v220, v220
v_mfma_f32_16x16x32_bf16 v[196:199], v[236:239], v[36:39], v[196:199]
s_add_u32 s28, s28, 0x4000
v_mfma_f32_16x16x32_bf16 v[200:203], v[232:235], v[64:67], 0
ds_read_b128 v[228:231], v248 offset:57856
v_mfma_f32_16x16x32_bf16 v[200:203], v[236:239], v[68:71], v[200:203]
v_exp_f32 v221, v221
v_mfma_f32_16x16x32_bf16 v[204:207], v[232:235], v[96:99], 0
v_exp_f32 v222, v222
v_mfma_f32_16x16x32_bf16 v[204:207], v[236:239], v[100:103], v[204:207]
s_waitcnt lgkmcnt(2)
s_add_u32 m0, s30, 0x8000
v_mfma_f32_16x16x32_bf16 v[192:195], v[240:243], v[8:11], v[192:195]
ds_read_b128 v[232:235], v248 offset:61440
v_cvt_pk_bf16_f32 v174, v220, v221
v_mfma_f32_16x16x32_bf16 v[192:195], v[244:247], v[12:15], v[192:195]
buffer_load_dwordx4 v251, s[12:15], s28 offen offset:0 lds
v_mfma_f32_16x16x32_bf16 v[196:199], v[240:243], v[40:43], v[196:199]
v_exp_f32 v223, v223
v_mfma_f32_16x16x32_bf16 v[196:199], v[244:247], v[44:47], v[196:199]
v_mfma_f32_16x16x32_bf16 v[200:203], v[240:243], v[72:75], v[200:203]
ds_read_b128 v[236:239], v248 offset:61952
v_cvt_pk_bf16_f32 v175, v222, v223
v_mfma_f32_16x16x32_bf16 v[200:203], v[244:247], v[76:79], v[200:203]
v_mfma_f32_16x16x32_bf16 v[204:207], v[240:243], v[104:107], v[204:207]
v_mfma_f32_16x16x32_bf16 v[204:207], v[244:247], v[108:111], v[204:207]
s_waitcnt lgkmcnt(2)
v_mfma_f32_16x16x32_bf16 v[192:195], v[224:227], v[16:19], v[192:195]
ds_read_b64_tr_b16 v[240:241], v249 offset:8192
v_mfma_f32_16x16x32_bf16 v[192:195], v[228:231], v[20:23], v[192:195]
buffer_load_dwordx4 v251, s[12:15], s28 offen offset:1024 lds
v_mfma_f32_16x16x32_bf16 v[196:199], v[224:227], v[48:51], v[196:199]
ds_read_b64_tr_b16 v[242:243], v249 offset:10240
v_mfma_f32_16x16x32_bf16 v[196:199], v[228:231], v[52:55], v[196:199]
v_mfma_f32_16x16x32_bf16 v[200:203], v[224:227], v[80:83], v[200:203]
ds_read_b64_tr_b16 v[244:245], v249 offset:24576
v_mfma_f32_16x16x32_bf16 v[200:203], v[228:231], v[84:87], v[200:203]
v_mfma_f32_16x16x32_bf16 v[204:207], v[224:227], v[112:115], v[204:207]
ds_read_b64_tr_b16 v[246:247], v249 offset:26624
v_mfma_f32_16x16x32_bf16 v[204:207], v[228:231], v[116:119], v[204:207]
s_waitcnt lgkmcnt(4)
v_mfma_f32_16x16x32_bf16 v[192:195], v[232:235], v[24:27], v[192:195]
ds_read_b64_tr_b16 v[224:225], v250 offset:8192
v_mfma_f32_16x16x32_bf16 v[192:195], v[236:239], v[28:31], v[192:195]
buffer_load_dwordx4 v251, s[12:15], s28 offen offset:2048 lds
v_mfma_f32_16x16x32_bf16 v[196:199], v[232:235], v[56:59], v[196:199]
ds_read_b64_tr_b16 v[226:227], v250 offset:10240
v_mfma_f32_16x16x32_bf16 v[196:199], v[236:239], v[60:63], v[196:199]
v_mfma_f32_16x16x32_bf16 v[200:203], v[232:235], v[88:91], v[200:203]
ds_read_b64_tr_b16 v[228:229], v250 offset:24576
v_mfma_f32_16x16x32_bf16 v[200:203], v[236:239], v[92:95], v[200:203]
v_mfma_f32_16x16x32_bf16 v[204:207], v[232:235], v[120:123], v[204:207]
ds_read_b64_tr_b16 v[230:231], v250 offset:26624
v_mfma_f32_16x16x32_bf16 v[204:207], v[236:239], v[124:127], v[204:207]
s_waitcnt lgkmcnt(4)
v_mfma_f32_16x16x32_bf16 a[128:131], v[240:243], v[128:131], a[128:131]
ds_read_b64_tr_b16 v[232:233], v249 offset:8704
v_mfma_f32_16x16x32_bf16 a[128:131], v[244:247], v[144:147], a[128:131]
buffer_load_dwordx4 v251, s[12:15], s28 offen offset:3072 lds
v_mfma_f32_16x16x32_bf16 a[132:135], v[240:243], v[132:135], a[132:135]
ds_read_b64_tr_b16 v[234:235], v249 offset:10752
v_mfma_f32_16x16x32_bf16 a[132:135], v[244:247], v[148:151], a[132:135]
s_add_u32 s28, s28, 0x4000
v_mfma_f32_16x16x32_bf16 a[136:139], v[240:243], v[136:139], a[136:139]
ds_read_b64_tr_b16 v[236:237], v249 offset:25088
v_mfma_f32_16x16x32_bf16 a[136:139], v[244:247], v[152:155], a[136:139]
v_exp_f32 v192, v192
v_mfma_f32_16x16x32_bf16 a[140:143], v[240:243], v[140:143], a[140:143]
ds_read_b64_tr_b16 v[238:239], v249 offset:27136
v_mfma_f32_16x16x32_bf16 a[140:143], v[244:247], v[156:159], a[140:143]
s_waitcnt lgkmcnt(4)
v_mfma_f32_16x16x32_bf16 a[144:147], v[224:227], v[128:131], a[144:147]
ds_read_b64_tr_b16 v[240:241], v250 offset:8704
v_mfma_f32_16x16x32_bf16 a[144:147], v[228:231], v[144:147], a[144:147]
v_exp_f32 v193, v193
v_mfma_f32_16x16x32_bf16 a[148:151], v[224:227], v[132:135], a[148:151]
ds_read_b64_tr_b16 v[242:243], v250 offset:10752
v_cvt_pk_bf16_f32 v176, v192, v193
v_mfma_f32_16x16x32_bf16 a[148:151], v[228:231], v[148:151], a[148:151]
v_exp_f32 v194, v194
v_mfma_f32_16x16x32_bf16 a[152:155], v[224:227], v[136:139], a[152:155]
ds_read_b64_tr_b16 v[244:245], v250 offset:25088
v_mfma_f32_16x16x32_bf16 a[152:155], v[228:231], v[152:155], a[152:155]
v_exp_f32 v195, v195
v_mfma_f32_16x16x32_bf16 a[156:159], v[224:227], v[140:143], a[156:159]
ds_read_b64_tr_b16 v[246:247], v250 offset:27136
v_cvt_pk_bf16_f32 v177, v194, v195
v_mfma_f32_16x16x32_bf16 a[156:159], v[228:231], v[156:159], a[156:159]
s_waitcnt lgkmcnt(4)
v_mfma_f32_16x16x32_bf16 a[160:163], v[232:235], v[128:131], a[160:163]
ds_read_b128 v[224:227], v248 offset:51200
v_mfma_f32_16x16x32_bf16 a[160:163], v[236:239], v[144:147], a[160:163]
v_exp_f32 v196, v196
v_mfma_f32_16x16x32_bf16 a[164:167], v[232:235], v[132:135], a[164:167]
v_exp_f32 v197, v197
v_mfma_f32_16x16x32_bf16 a[164:167], v[236:239], v[148:151], a[164:167]
v_exp_f32 v198, v198
v_mfma_f32_16x16x32_bf16 a[168:171], v[232:235], v[136:139], a[168:171]
ds_read_b128 v[228:231], v248 offset:51712
v_cvt_pk_bf16_f32 v180, v196, v197
v_mfma_f32_16x16x32_bf16 a[168:171], v[236:239], v[152:155], a[168:171]
v_exp_f32 v199, v199
v_mfma_f32_16x16x32_bf16 a[172:175], v[232:235], v[140:143], a[172:175]
v_exp_f32 v200, v200
v_mfma_f32_16x16x32_bf16 a[172:175], v[236:239], v[156:159], a[172:175]
s_waitcnt lgkmcnt(2)
v_cvt_pk_bf16_f32 v181, v198, v199
v_mfma_f32_16x16x32_bf16 a[176:179], v[240:243], v[128:131], a[176:179]
ds_read_b128 v[232:235], v248 offset:55296
v_mfma_f32_16x16x32_bf16 a[176:179], v[244:247], v[144:147], a[176:179]
v_exp_f32 v201, v201
v_mfma_f32_16x16x32_bf16 a[180:183], v[240:243], v[132:135], a[180:183]
v_exp_f32 v202, v202
v_mfma_f32_16x16x32_bf16 a[180:183], v[244:247], v[148:151], a[180:183]
v_exp_f32 v203, v203
v_mfma_f32_16x16x32_bf16 a[184:187], v[240:243], v[136:139], a[184:187]
ds_read_b128 v[236:239], v248 offset:55808
v_cvt_pk_bf16_f32 v184, v200, v201
v_mfma_f32_16x16x32_bf16 a[184:187], v[244:247], v[152:155], a[184:187]
v_cvt_pk_bf16_f32 v185, v202, v203
v_mfma_f32_16x16x32_bf16 a[188:191], v[240:243], v[140:143], a[188:191]
v_exp_f32 v204, v204
v_mfma_f32_16x16x32_bf16 a[188:191], v[244:247], v[156:159], a[188:191]
s_waitcnt lgkmcnt(2)
v_mfma_f32_16x16x32_bf16 v[208:211], v[224:227], v[0:3], 0
ds_read_b128 v[240:243], v248 offset:59392
v_mfma_f32_16x16x32_bf16 v[208:211], v[228:231], v[4:7], v[208:211]
v_exp_f32 v205, v205
v_mfma_f32_16x16x32_bf16 v[212:215], v[224:227], v[32:35], 0
v_exp_f32 v206, v206
v_mfma_f32_16x16x32_bf16 v[212:215], v[228:231], v[36:39], v[212:215]
v_exp_f32 v207, v207
v_mfma_f32_16x16x32_bf16 v[216:219], v[224:227], v[64:67], 0
ds_read_b128 v[244:247], v248 offset:59904
v_cvt_pk_bf16_f32 v188, v204, v205
v_mfma_f32_16x16x32_bf16 v[216:219], v[228:231], v[68:71], v[216:219]
v_cvt_pk_bf16_f32 v189, v206, v207
v_mfma_f32_16x16x32_bf16 v[220:223], v[224:227], v[96:99], 0
v_mfma_f32_16x16x32_bf16 v[220:223], v[228:231], v[100:103], v[220:223]
s_waitcnt lgkmcnt(2)
v_mfma_f32_16x16x32_bf16 v[208:211], v[232:235], v[8:11], v[208:211]
ds_read_b128 v[224:227], v248 offset:63488
v_mfma_f32_16x16x32_bf16 v[208:211], v[236:239], v[12:15], v[208:211]
v_mfma_f32_16x16x32_bf16 v[212:215], v[232:235], v[40:43], v[212:215]
v_mfma_f32_16x16x32_bf16 v[212:215], v[236:239], v[44:47], v[212:215]
v_mfma_f32_16x16x32_bf16 v[216:219], v[232:235], v[72:75], v[216:219]
ds_read_b128 v[228:231], v248 offset:64000
v_mfma_f32_16x16x32_bf16 v[216:219], v[236:239], v[76:79], v[216:219]
v_mfma_f32_16x16x32_bf16 v[220:223], v[232:235], v[104:107], v[220:223]
v_mfma_f32_16x16x32_bf16 v[220:223], v[236:239], v[108:111], v[220:223]
s_waitcnt lgkmcnt(2)
v_mfma_f32_16x16x32_bf16 v[208:211], v[240:243], v[16:19], v[208:211]
ds_read_b64_tr_b16 v[232:233], v249 offset:12288
v_mfma_f32_16x16x32_bf16 v[208:211], v[244:247], v[20:23], v[208:211]
v_mfma_f32_16x16x32_bf16 v[212:215], v[240:243], v[48:51], v[212:215]
ds_read_b64_tr_b16 v[234:235], v249 offset:14336
v_mfma_f32_16x16x32_bf16 v[212:215], v[244:247], v[52:55], v[212:215]
v_mfma_f32_16x16x32_bf16 v[216:219], v[240:243], v[80:83], v[216:219]
ds_read_b64_tr_b16 v[236:237], v249 offset:28672
v_mfma_f32_16x16x32_bf16 v[216:219], v[244:247], v[84:87], v[216:219]
v_mfma_f32_16x16x32_bf16 v[220:223], v[240:243], v[112:115], v[220:223]
ds_read_b64_tr_b16 v[238:239], v249 offset:30720
v_mfma_f32_16x16x32_bf16 v[220:223], v[244:247], v[116:119], v[220:223]
s_waitcnt lgkmcnt(4)
v_mfma_f32_16x16x32_bf16 v[208:211], v[224:227], v[24:27], v[208:211]
ds_read_b64_tr_b16 v[240:241], v250 offset:12288
v_mfma_f32_16x16x32_bf16 v[208:211], v[228:231], v[28:31], v[208:211]
v_mfma_f32_16x16x32_bf16 v[212:215], v[224:227], v[56:59], v[212:215]
ds_read_b64_tr_b16 v[242:243], v250 offset:14336
v_mfma_f32_16x16x32_bf16 v[212:215], v[228:231], v[60:63], v[212:215]
v_mfma_f32_16x16x32_bf16 v[216:219], v[224:227], v[88:91], v[216:219]
ds_read_b64_tr_b16 v[244:245], v250 offset:28672
v_mfma_f32_16x16x32_bf16 v[216:219], v[228:231], v[92:95], v[216:219]
v_mfma_f32_16x16x32_bf16 v[220:223], v[224:227], v[120:123], v[220:223]
ds_read_b64_tr_b16 v[246:247], v250 offset:30720
v_xor_b32 v248, 0x10000, v248
v_mfma_f32_16x16x32_bf16 v[220:223], v[228:231], v[124:127], v[220:223]
s_waitcnt lgkmcnt(4)
v_mfma_f32_16x16x32_bf16 a[192:195], v[232:235], v[128:131], a[192:195]
ds_read_b64_tr_b16 v[224:225], v249 offset:12800
v_mfma_f32_16x16x32_bf16 a[192:195], v[236:239], v[144:147], a[192:195]
v_mfma_f32_16x16x32_bf16 a[196:199], v[232:235], v[132:135], a[196:199]
ds_read_b64_tr_b16 v[226:227], v249 offset:14848
v_mfma_f32_16x16x32_bf16 a[196:199], v[236:239], v[148:151], a[196:199]
v_exp_f32 v208, v208
v_mfma_f32_16x16x32_bf16 a[200:203], v[232:235], v[136:139], a[200:203]
ds_read_b64_tr_b16 v[228:229], v249 offset:29184
v_mfma_f32_16x16x32_bf16 a[200:203], v[236:239], v[152:155], a[200:203]
v_exp_f32 v209, v209
v_mfma_f32_16x16x32_bf16 a[204:207], v[232:235], v[140:143], a[204:207]
ds_read_b64_tr_b16 v[230:231], v249 offset:31232
v_cvt_pk_bf16_f32 v178, v208, v209
v_mfma_f32_16x16x32_bf16 a[204:207], v[236:239], v[156:159], a[204:207]
s_waitcnt lgkmcnt(4)
v_mfma_f32_16x16x32_bf16 a[208:211], v[240:243], v[128:131], a[208:211]
ds_read_b64_tr_b16 v[232:233], v250 offset:12800
v_mfma_f32_16x16x32_bf16 a[208:211], v[244:247], v[144:147], a[208:211]
v_exp_f32 v210, v210
v_mfma_f32_16x16x32_bf16 a[212:215], v[240:243], v[132:135], a[212:215]
ds_read_b64_tr_b16 v[234:235], v250 offset:14848
v_mfma_f32_16x16x32_bf16 a[212:215], v[244:247], v[148:151], a[212:215]
v_exp_f32 v211, v211
v_mfma_f32_16x16x32_bf16 a[216:219], v[240:243], v[136:139], a[216:219]
ds_read_b64_tr_b16 v[236:237], v250 offset:29184
v_cvt_pk_bf16_f32 v179, v210, v211
v_mfma_f32_16x16x32_bf16 a[216:219], v[244:247], v[152:155], a[216:219]
v_exp_f32 v212, v212
v_mfma_f32_16x16x32_bf16 a[220:223], v[240:243], v[140:143], a[220:223]
ds_read_b64_tr_b16 v[238:239], v250 offset:31232
v_mfma_f32_16x16x32_bf16 a[220:223], v[244:247], v[156:159], a[220:223]
s_waitcnt lgkmcnt(4)
v_mfma_f32_16x16x32_bf16 a[224:227], v[224:227], v[128:131], a[224:227]
ds_read_b128 v[240:243], v248 offset:0
v_mfma_f32_16x16x32_bf16 a[224:227], v[228:231], v[144:147], a[224:227]
v_exp_f32 v213, v213
v_mfma_f32_16x16x32_bf16 a[228:231], v[224:227], v[132:135], a[228:231]
v_exp_f32 v214, v214
v_mfma_f32_16x16x32_bf16 a[228:231], v[228:231], v[148:151], a[228:231]
v_exp_f32 v215, v215
v_mfma_f32_16x16x32_bf16 a[232:235], v[224:227], v[136:139], a[232:235]
ds_read_b128 v[244:247], v248 offset:512
v_cvt_pk_bf16_f32 v182, v212, v213
v_mfma_f32_16x16x32_bf16 a[232:235], v[228:231], v[152:155], a[232:235]
v_cvt_pk_bf16_f32 v183, v214, v215
v_mfma_f32_16x16x32_bf16 a[236:239], v[224:227], v[140:143], a[236:239]
v_exp_f32 v216, v216
v_mfma_f32_16x16x32_bf16 a[236:239], v[228:231], v[156:159], a[236:239]
s_waitcnt lgkmcnt(2)
v_mfma_f32_16x16x32_bf16 a[240:243], v[232:235], v[128:131], a[240:243]
ds_read_b128 v[224:227], v248 offset:4096
v_mfma_f32_16x16x32_bf16 a[240:243], v[236:239], v[144:147], a[240:243]
v_exp_f32 v217, v217
v_mfma_f32_16x16x32_bf16 a[244:247], v[232:235], v[132:135], a[244:247]
v_exp_f32 v218, v218
v_mfma_f32_16x16x32_bf16 a[244:247], v[236:239], v[148:151], a[244:247]
v_exp_f32 v219, v219
v_mfma_f32_16x16x32_bf16 a[248:251], v[232:235], v[136:139], a[248:251]
ds_read_b128 v[228:231], v248 offset:4608
v_cvt_pk_bf16_f32 v186, v216, v217
v_mfma_f32_16x16x32_bf16 a[248:251], v[236:239], v[152:155], a[248:251]
v_cvt_pk_bf16_f32 v187, v218, v219
v_mfma_f32_16x16x32_bf16 a[252:255], v[232:235], v[140:143], a[252:255]
v_exp_f32 v220, v220
v_mfma_f32_16x16x32_bf16 a[252:255], v[236:239], v[156:159], a[252:255]
s_waitcnt lgkmcnt(2)
v_mfma_f32_16x16x32_bf16 v[192:195], v[240:243], v[0:3], 0
ds_read_b128 v[232:235], v248 offset:8192
v_mfma_f32_16x16x32_bf16 v[192:195], v[244:247], v[4:7], v[192:195]
v_exp_f32 v221, v221
v_mfma_f32_16x16x32_bf16 v[196:199], v[240:243], v[32:35], 0
v_exp_f32 v222, v222
v_mfma_f32_16x16x32_bf16 v[196:199], v[244:247], v[36:39], v[196:199]
v_exp_f32 v223, v223
v_mfma_f32_16x16x32_bf16 v[200:203], v[240:243], v[64:67], 0
ds_read_b128 v[236:239], v248 offset:8704
v_cvt_pk_bf16_f32 v190, v220, v221
v_mfma_f32_16x16x32_bf16 v[200:203], v[244:247], v[68:71], v[200:203]
v_cvt_pk_bf16_f32 v191, v222, v223
v_mfma_f32_16x16x32_bf16 v[204:207], v[240:243], v[96:99], 0
v_mfma_f32_16x16x32_bf16 v[204:207], v[244:247], v[100:103], v[204:207]
s_waitcnt lgkmcnt(2)
v_mfma_f32_16x16x32_bf16 v[192:195], v[224:227], v[8:11], v[192:195]
ds_read_b128 v[240:243], v248 offset:12288
v_mfma_f32_16x16x32_bf16 v[192:195], v[228:231], v[12:15], v[192:195]
v_mfma_f32_16x16x32_bf16 v[196:199], v[224:227], v[40:43], v[196:199]
v_mfma_f32_16x16x32_bf16 v[196:199], v[228:231], v[44:47], v[196:199]
v_mfma_f32_16x16x32_bf16 v[200:203], v[224:227], v[72:75], v[200:203]
ds_read_b128 v[244:247], v248 offset:12800
v_mfma_f32_16x16x32_bf16 v[200:203], v[228:231], v[76:79], v[200:203]
v_mfma_f32_16x16x32_bf16 v[204:207], v[224:227], v[104:107], v[204:207]
v_mfma_f32_16x16x32_bf16 v[204:207], v[228:231], v[108:111], v[204:207]
s_waitcnt lgkmcnt(2)
v_mfma_f32_16x16x32_bf16 v[192:195], v[232:235], v[16:19], v[192:195]
ds_read_b64_tr_b16 v[224:225], v249 offset:32768
v_mfma_f32_16x16x32_bf16 v[192:195], v[236:239], v[20:23], v[192:195]
v_mfma_f32_16x16x32_bf16 v[196:199], v[232:235], v[48:51], v[196:199]
ds_read_b64_tr_b16 v[226:227], v249 offset:34816
v_mfma_f32_16x16x32_bf16 v[196:199], v[236:239], v[52:55], v[196:199]
v_mfma_f32_16x16x32_bf16 v[200:203], v[232:235], v[80:83], v[200:203]
ds_read_b64_tr_b16 v[228:229], v249 offset:49152
v_mfma_f32_16x16x32_bf16 v[200:203], v[236:239], v[84:87], v[200:203]
v_mfma_f32_16x16x32_bf16 v[204:207], v[232:235], v[112:115], v[204:207]
ds_read_b64_tr_b16 v[230:231], v249 offset:51200
v_mfma_f32_16x16x32_bf16 v[204:207], v[236:239], v[116:119], v[204:207]
s_waitcnt lgkmcnt(4)
v_mfma_f32_16x16x32_bf16 v[192:195], v[240:243], v[24:27], v[192:195]
ds_read_b64_tr_b16 v[232:233], v250 offset:32768
v_mfma_f32_16x16x32_bf16 v[192:195], v[244:247], v[28:31], v[192:195]
v_mfma_f32_16x16x32_bf16 v[196:199], v[240:243], v[56:59], v[196:199]
ds_read_b64_tr_b16 v[234:235], v250 offset:34816
v_mfma_f32_16x16x32_bf16 v[196:199], v[244:247], v[60:63], v[196:199]
v_mfma_f32_16x16x32_bf16 v[200:203], v[240:243], v[88:91], v[200:203]
ds_read_b64_tr_b16 v[236:237], v250 offset:49152
v_mfma_f32_16x16x32_bf16 v[200:203], v[244:247], v[92:95], v[200:203]
s_sub_u32 s31, s31, 1
v_mfma_f32_16x16x32_bf16 v[204:207], v[240:243], v[120:123], v[204:207]
ds_read_b64_tr_b16 v[238:239], v250 offset:51200
v_mfma_f32_16x16x32_bf16 v[204:207], v[244:247], v[124:127], v[204:207]
s_cbranch_scc1 L2_tail_1
s_waitcnt lgkmcnt(4)
v_mfma_f32_16x16x32_bf16 a[0:3], v[224:227], v[160:163], a[0:3]
ds_read_b64_tr_b16 v[240:241], v249 offset:33280
v_mfma_f32_16x16x32_bf16 a[0:3], v[228:231], v[176:179], a[0:3]
v_mfma_f32_16x16x32_bf16 a[4:7], v[224:227], v[164:167], a[4:7]
ds_read_b64_tr_b16 v[242:243], v249 offset:35328
v_mfma_f32_16x16x32_bf16 a[4:7], v[228:231], v[180:183], a[4:7]
v_exp_f32 v192, v192
v_mfma_f32_16x16x32_bf16 a[8:11], v[224:227], v[168:171], a[8:11]
ds_read_b64_tr_b16 v[244:245], v249 offset:49664
v_mfma_f32_16x16x32_bf16 a[8:11], v[228:231], v[184:187], a[8:11]
v_exp_f32 v193, v193
v_mfma_f32_16x16x32_bf16 a[12:15], v[224:227], v[172:175], a[12:15]
ds_read_b64_tr_b16 v[246:247], v249 offset:51712
v_cvt_pk_bf16_f32 v128, v192, v193
v_mfma_f32_16x16x32_bf16 a[12:15], v[228:231], v[188:191], a[12:15]
s_waitcnt lgkmcnt(4)
v_mfma_f32_16x16x32_bf16 a[16:19], v[232:235], v[160:163], a[16:19]
ds_read_b64_tr_b16 v[144:145], v250 offset:33280
v_mfma_f32_16x16x32_bf16 a[16:19], v[236:239], v[176:179], a[16:19]
v_exp_f32 v194, v194
v_mfma_f32_16x16x32_bf16 a[20:23], v[232:235], v[164:167], a[20:23]
ds_read_b64_tr_b16 v[146:147], v250 offset:35328
v_mfma_f32_16x16x32_bf16 a[20:23], v[236:239], v[180:183], a[20:23]
v_exp_f32 v195, v195
v_mfma_f32_16x16x32_bf16 a[24:27], v[232:235], v[168:171], a[24:27]
ds_read_b64_tr_b16 v[148:149], v250 offset:49664
v_cvt_pk_bf16_f32 v129, v194, v195
v_mfma_f32_16x16x32_bf16 a[24:27], v[236:239], v[184:187], a[24:27]
v_exp_f32 v196, v196
v_mfma_f32_16x16x32_bf16 a[28:31], v[232:235], v[172:175], a[28:31]
ds_read_b64_tr_b16 v[150:151], v250 offset:51712
v_mfma_f32_16x16x32_bf16 a[28:31], v[236:239], v[188:191], a[28:31]
s_waitcnt lgkmcnt(4)
v_mfma_f32_16x16x32_bf16 a[32:35], v[240:243], v[160:163], a[32:35]
ds_read_b128 v[224:227], v248 offset:2048
v_mfma_f32_16x16x32_bf16 a[32:35], v[244:247], v[176:179], a[32:35]
v_exp_f32 v197, v197
v_mfma_f32_16x16x32_bf16 a[36:39], v[240:243], v[164:167], a[36:39]
v_exp_f32 v198, v198
v_mfma_f32_16x16x32_bf16 a[36:39], v[244:247], v[180:183], a[36:39]
v_exp_f32 v199, v199
v_mfma_f32_16x16x32_bf16 a[40:43], v[240:243], v[168:171], a[40:43]
ds_read_b128 v[228:231], v248 offset:2560
v_cvt_pk_bf16_f32 v132, v196, v197
v_mfma_f32_16x16x32_bf16 a[40:43], v[244:247], v[184:187], a[40:43]
v_cvt_pk_bf16_f32 v133, v198, v199
v_mfma_f32_16x16x32_bf16 a[44:47], v[240:243], v[172:175], a[44:47]
v_exp_f32 v200, v200
v_mfma_f32_16x16x32_bf16 a[44:47], v[244:247], v[188:191], a[44:47]
s_waitcnt lgkmcnt(2)
v_mfma_f32_16x16x32_bf16 a[48:51], v[144:147], v[160:163], a[48:51]
ds_read_b128 v[232:235], v248 offset:6144
v_mfma_f32_16x16x32_bf16 a[48:51], v[148:151], v[176:179], a[48:51]
v_exp_f32 v201, v201
v_mfma_f32_16x16x32_bf16 a[52:55], v[144:147], v[164:167], a[52:55]
v_exp_f32 v202, v202
v_mfma_f32_16x16x32_bf16 a[52:55], v[148:151], v[180:183], a[52:55]
v_exp_f32 v203, v203
v_mfma_f32_16x16x32_bf16 a[56:59], v[144:147], v[168:171], a[56:59]
ds_read_b128 v[236:239], v248 offset:6656
v_cvt_pk_bf16_f32 v136, v200, v201
v_mfma_f32_16x16x32_bf16 a[56:59], v[148:151], v[184:187], a[56:59]
v_cvt_pk_bf16_f32 v137, v202, v203
v_mfma_f32_16x16x32_bf16 a[60:63], v[144:147], v[172:175], a[60:63]
v_exp_f32 v204, v204
v_mfma_f32_16x16x32_bf16 a[60:63], v[148:151], v[188:191], a[60:63]
s_waitcnt lgkmcnt(2)
v_mfma_f32_16x16x32_bf16 v[208:211], v[224:227], v[0:3], 0
ds_read_b128 v[240:243], v248 offset:10240
v_mfma_f32_16x16x32_bf16 v[208:211], v[228:231], v[4:7], v[208:211]
v_exp_f32 v205, v205
v_mfma_f32_16x16x32_bf16 v[212:215], v[224:227], v[32:35], 0
v_exp_f32 v206, v206
v_mfma_f32_16x16x32_bf16 v[212:215], v[228:231], v[36:39], v[212:215]
v_exp_f32 v207, v207
v_mfma_f32_16x16x32_bf16 v[216:219], v[224:227], v[64:67], 0
ds_read_b128 v[244:247], v248 offset:10752
v_cvt_pk_bf16_f32 v140, v204, v205
v_mfma_f32_16x16x32_bf16 v[216:219], v[228:231], v[68:71], v[216:219]
v_cvt_pk_bf16_f32 v141, v206, v207
v_mfma_f32_16x16x32_bf16 v[220:223], v[224:227], v[96:99], 0
v_mfma_f32_16x16x32_bf16 v[220:223], v[228:231], v[100:103], v[220:223]
s_waitcnt lgkmcnt(2)
v_mfma_f32_16x16x32_bf16 v[208:211], v[232:235], v[8:11], v[208:211]
ds_read_b128 v[144:147], v248 offset:14336
v_mfma_f32_16x16x32_bf16 v[208:211], v[236:239], v[12:15], v[208:211]
v_mfma_f32_16x16x32_bf16 v[212:215], v[232:235], v[40:43], v[212:215]
v_mfma_f32_16x16x32_bf16 v[212:215], v[236:239], v[44:47], v[212:215]
v_mfma_f32_16x16x32_bf16 v[216:219], v[232:235], v[72:75], v[216:219]
ds_read_b128 v[148:151], v248 offset:14848
v_mfma_f32_16x16x32_bf16 v[216:219], v[236:239], v[76:79], v[216:219]
v_mfma_f32_16x16x32_bf16 v[220:223], v[232:235], v[104:107], v[220:223]
v_mfma_f32_16x16x32_bf16 v[220:223], v[236:239], v[108:111], v[220:223]
s_waitcnt lgkmcnt(2)
v_mfma_f32_16x16x32_bf16 v[208:211], v[240:243], v[16:19], v[208:211]
ds_read_b64_tr_b16 v[224:225], v249 offset:36864
v_mfma_f32_16x16x32_bf16 v[208:211], v[244:247], v[20:23], v[208:211]
v_mfma_f32_16x16x32_bf16 v[212:215], v[240:243], v[48:51], v[212:215]
ds_read_b64_tr_b16 v[226:227], v249 offset:38912
v_mfma_f32_16x16x32_bf16 v[212:215], v[244:247], v[52:55], v[212:215]
v_mfma_f32_16x16x32_bf16 v[216:219], v[240:243], v[80:83], v[216:219]
ds_read_b64_tr_b16 v[228:229], v249 offset:53248
v_mfma_f32_16x16x32_bf16 v[216:219], v[244:247], v[84:87], v[216:219]
v_mfma_f32_16x16x32_bf16 v[220:223], v[240:243], v[112:115], v[220:223]
ds_read_b64_tr_b16 v[230:231], v249 offset:55296
v_mfma_f32_16x16x32_bf16 v[220:223], v[244:247], v[116:119], v[220:223]
s_waitcnt lgkmcnt(4)
v_mfma_f32_16x16x32_bf16 v[208:211], v[144:147], v[24:27], v[208:211]
ds_read_b64_tr_b16 v[232:233], v250 offset:36864
v_mfma_f32_16x16x32_bf16 v[208:211], v[148:151], v[28:31], v[208:211]
v_mfma_f32_16x16x32_bf16 v[212:215], v[144:147], v[56:59], v[212:215]
ds_read_b64_tr_b16 v[234:235], v250 offset:38912
v_mfma_f32_16x16x32_bf16 v[212:215], v[148:151], v[60:63], v[212:215]
v_mfma_f32_16x16x32_bf16 v[216:219], v[144:147], v[88:91], v[216:219]
ds_read_b64_tr_b16 v[236:237], v250 offset:53248
v_mfma_f32_16x16x32_bf16 v[216:219], v[148:151], v[92:95], v[216:219]
v_mfma_f32_16x16x32_bf16 v[220:223], v[144:147], v[120:123], v[220:223]
ds_read_b64_tr_b16 v[238:239], v250 offset:55296
v_mfma_f32_16x16x32_bf16 v[220:223], v[148:151], v[124:127], v[220:223]
s_waitcnt lgkmcnt(4)
v_mfma_f32_16x16x32_bf16 a[64:67], v[224:227], v[160:163], a[64:67]
ds_read_b64_tr_b16 v[240:241], v249 offset:37376
v_mfma_f32_16x16x32_bf16 a[64:67], v[228:231], v[176:179], a[64:67]
v_mfma_f32_16x16x32_bf16 a[68:71], v[224:227], v[164:167], a[68:71]
ds_read_b64_tr_b16 v[242:243], v249 offset:39424
v_mfma_f32_16x16x32_bf16 a[68:71], v[228:231], v[180:183], a[68:71]
v_exp_f32 v208, v208
v_mfma_f32_16x16x32_bf16 a[72:75], v[224:227], v[168:171], a[72:75]
ds_read_b64_tr_b16 v[244:245], v249 offset:53760
v_mfma_f32_16x16x32_bf16 a[72:75], v[228:231], v[184:187], a[72:75]
v_exp_f32 v209, v209
v_mfma_f32_16x16x32_bf16 a[76:79], v[224:227], v[172:175], a[76:79]
ds_read_b64_tr_b16 v[246:247], v249 offset:55808
v_cvt_pk_bf16_f32 v130, v208, v209
v_mfma_f32_16x16x32_bf16 a[76:79], v[228:231], v[188:191], a[76:79]
s_waitcnt lgkmcnt(4)
s_waitcnt vmcnt(0)
s_barrier
s_add_u32 m0, s30, 0xc000
v_mfma_f32_16x16x32_bf16 a[80:83], v[232:235], v[160:163], a[80:83]
ds_read_b64_tr_b16 v[224:225], v250 offset:37376
v_mfma_f32_16x16x32_bf16 a[80:83], v[236:239], v[176:179], a[80:83]
buffer_load_dwordx4 v251, s[12:15], s28 offen offset:0 lds
v_mfma_f32_16x16x32_bf16 a[84:87], v[232:235], v[164:167], a[84:87]
ds_read_b64_tr_b16 v[226:227], v250 offset:39424
v_mfma_f32_16x16x32_bf16 a[84:87], v[236:239], v[180:183], a[84:87]
v_exp_f32 v210, v210
v_mfma_f32_16x16x32_bf16 a[88:91], v[232:235], v[168:171], a[88:91]
ds_read_b64_tr_b16 v[228:229], v250 offset:53760
v_mfma_f32_16x16x32_bf16 a[88:91], v[236:239], v[184:187], a[88:91]
v_exp_f32 v211, v211
v_mfma_f32_16x16x32_bf16 a[92:95], v[232:235], v[172:175], a[92:95]
ds_read_b64_tr_b16 v[230:231], v250 offset:55808
v_cvt_pk_bf16_f32 v131, v210, v211
v_mfma_f32_16x16x32_bf16 a[92:95], v[236:239], v[188:191], a[92:95]
s_waitcnt lgkmcnt(4)
v_mfma_f32_16x16x32_bf16 a[96:99], v[240:243], v[160:163], a[96:99]
ds_read_b128 v[232:235], v248 offset:16384
v_mfma_f32_16x16x32_bf16 a[96:99], v[244:247], v[176:179], a[96:99]
buffer_load_dwordx4 v251, s[12:15], s28 offen offset:1024 lds
v_mfma_f32_16x16x32_bf16 a[100:103], v[240:243], v[164:167], a[100:103]
v_exp_f32 v212, v212
v_mfma_f32_16x16x32_bf16 a[100:103], v[244:247], v[180:183], a[100:103]
v_exp_f32 v213, v213
v_mfma_f32_16x16x32_bf16 a[104:107], v[240:243], v[168:171], a[104:107]
ds_read_b128 v[236:239], v248 offset:16896
v_cvt_pk_bf16_f32 v134, v212, v213
v_mfma_f32_16x16x32_bf16 a[104:107], v[244:247], v[184:187], a[104:107]
v_exp_f32 v214, v214
v_mfma_f32_16x16x32_bf16 a[108:111], v[240:243], v[172:175], a[108:111]
v_exp_f32 v215, v215
v_mfma_f32_16x16x32_bf16 a[108:111], v[244:247], v[188:191], a[108:111]
s_waitcnt lgkmcnt(2)
v_cvt_pk_bf16_f32 v135, v214, v215
v_mfma_f32_16x16x32_bf16 a[112:115], v[224:227], v[160:163], a[112:115]
ds_read_b128 v[240:243], v248 offset:20480
v_mfma_f32_16x16x32_bf16 a[112:115], v[228:231], v[176:179], a[112:115]
buffer_load_dwordx4 v251, s[12:15], s28 offen offset:2048 lds
v_mfma_f32_16x16x32_bf16 a[116:119], v[224:227], v[164:167], a[116:119]
v_exp_f32 v216, v216
v_mfma_f32_16x16x32_bf16 a[116:119], v[228:231], v[180:183], a[116:119]
v_exp_f32 v217, v217
v_mfma_f32_16x16x32_bf16 a[120:123], v[224:227], v[168:171], a[120:123]
ds_read_b128 v[244:247], v248 offset:20992
v_cvt_pk_bf16_f32 v138, v216, v217
v_mfma_f32_16x16x32_bf16 a[120:123], v[228:231], v[184:187], a[120:123]
v_exp_f32 v218, v218
v_mfma_f32_16x16x32_bf16 a[124:127], v[224:227], v[172:175], a[124:127]
v_exp_f32 v219, v219
v_mfma_f32_16x16x32_bf16 a[124:127], v[228:231], v[188:191], a[124:127]
s_waitcnt lgkmcnt(2)
v_cvt_pk_bf16_f32 v139, v218, v219
v_mfma_f32_16x16x32_bf16 v[192:195], v[232:235], v[0:3], 0
ds_read_b128 v[224:227], v248 offset:24576
v_mfma_f32_16x16x32_bf16 v[192:195], v[236:239], v[4:7], v[192:195]
buffer_load_dwordx4 v251, s[12:15], s28 offen offset:3072 lds
v_mfma_f32_16x16x32_bf16 v[196:199], v[232:235], v[32:35], 0
s_xor_b32 s30, s30, 0x10000
v_mfma_f32_16x16x32_bf16 v[196:199], v[236:239], v[36:39], v[196:199]
s_add_u32 s28, s28, 0x4000
v_mfma_f32_16x16x32_bf16 v[200:203], v[232:235], v[64:67], 0
ds_read_b128 v[228:231], v248 offset:25088
v_mfma_f32_16x16x32_bf16 v[200:203], v[236:239], v[68:71], v[200:203]
v_exp_f32 v220, v220
v_mfma_f32_16x16x32_bf16 v[204:207], v[232:235], v[96:99], 0
v_exp_f32 v221, v221
v_mfma_f32_16x16x32_bf16 v[204:207], v[236:239], v[100:103], v[204:207]
s_waitcnt lgkmcnt(2)
s_add_u32 m0, s30, 0x0
v_mfma_f32_16x16x32_bf16 v[192:195], v[240:243], v[8:11], v[192:195]
ds_read_b128 v[232:235], v248 offset:28672
v_cvt_pk_bf16_f32 v142, v220, v221
v_mfma_f32_16x16x32_bf16 v[192:195], v[244:247], v[12:15], v[192:195]
buffer_load_dwordx4 v251, s[12:15], s28 offen offset:0 lds
v_mfma_f32_16x16x32_bf16 v[196:199], v[240:243], v[40:43], v[196:199]
v_exp_f32 v222, v222
v_mfma_f32_16x16x32_bf16 v[196:199], v[244:247], v[44:47], v[196:199]
v_exp_f32 v223, v223
v_mfma_f32_16x16x32_bf16 v[200:203], v[240:243], v[72:75], v[200:203]
ds_read_b128 v[236:239], v248 offset:29184
v_cvt_pk_bf16_f32 v143, v222, v223
v_mfma_f32_16x16x32_bf16 v[200:203], v[244:247], v[76:79], v[200:203]
v_mfma_f32_16x16x32_bf16 v[204:207], v[240:243], v[104:107], v[204:207]
v_mfma_f32_16x16x32_bf16 v[204:207], v[244:247], v[108:111], v[204:207]
s_waitcnt lgkmcnt(2)
v_mfma_f32_16x16x32_bf16 v[192:195], v[224:227], v[16:19], v[192:195]
ds_read_b64_tr_b16 v[240:241], v249 offset:40960
v_mfma_f32_16x16x32_bf16 v[192:195], v[228:231], v[20:23], v[192:195]
buffer_load_dwordx4 v251, s[12:15], s28 offen offset:1024 lds
v_mfma_f32_16x16x32_bf16 v[196:199], v[224:227], v[48:51], v[196:199]
ds_read_b64_tr_b16 v[242:243], v249 offset:43008
v_mfma_f32_16x16x32_bf16 v[196:199], v[228:231], v[52:55], v[196:199]
v_mfma_f32_16x16x32_bf16 v[200:203], v[224:227], v[80:83], v[200:203]
ds_read_b64_tr_b16 v[244:245], v249 offset:57344
v_mfma_f32_16x16x32_bf16 v[200:203], v[228:231], v[84:87], v[200:203]
v_mfma_f32_16x16x32_bf16 v[204:207], v[224:227], v[112:115], v[204:207]
ds_read_b64_tr_b16 v[246:247], v249 offset:59392
v_mfma_f32_16x16x32_bf16 v[204:207], v[228:231], v[116:119], v[204:207]
s_waitcnt lgkmcnt(4)
v_mfma_f32_16x16x32_bf16 v[192:195], v[232:235], v[24:27], v[192:195]
ds_read_b64_tr_b16 v[224:225], v250 offset:40960
v_mfma_f32_16x16x32_bf16 v[192:195], v[236:239], v[28:31], v[192:195]
buffer_load_dwordx4 v251, s[12:15], s28 offen offset:2048 lds
v_mfma_f32_16x16x32_bf16 v[196:199], v[232:235], v[56:59], v[196:199]
ds_read_b64_tr_b16 v[226:227], v250 offset:43008
v_mfma_f32_16x16x32_bf16 v[196:199], v[236:239], v[60:63], v[196:199]
v_mfma_f32_16x16x32_bf16 v[200:203], v[232:235], v[88:91], v[200:203]
ds_read_b64_tr_b16 v[228:229], v250 offset:57344
v_mfma_f32_16x16x32_bf16 v[200:203], v[236:239], v[92:95], v[200:203]
v_mfma_f32_16x16x32_bf16 v[204:207], v[232:235], v[120:123], v[204:207]
ds_read_b64_tr_b16 v[230:231], v250 offset:59392
v_mfma_f32_16x16x32_bf16 v[204:207], v[236:239], v[124:127], v[204:207]
s_waitcnt lgkmcnt(4)
v_mfma_f32_16x16x32_bf16 a[128:131], v[240:243], v[160:163], a[128:131]
ds_read_b64_tr_b16 v[232:233], v249 offset:41472
v_mfma_f32_16x16x32_bf16 a[128:131], v[244:247], v[176:179], a[128:131]
buffer_load_dwordx4 v251, s[12:15], s28 offen offset:3072 lds
v_mfma_f32_16x16x32_bf16 a[132:135], v[240:243], v[164:167], a[132:135]
ds_read_b64_tr_b16 v[234:235], v249 offset:43520
v_mfma_f32_16x16x32_bf16 a[132:135], v[244:247], v[180:183], a[132:135]
s_add_u32 s28, s28, 0x4000
v_mfma_f32_16x16x32_bf16 a[136:139], v[240:243], v[168:171], a[136:139]
ds_read_b64_tr_b16 v[236:237], v249 offset:57856
v_mfma_f32_16x16x32_bf16 a[136:139], v[244:247], v[184:187], a[136:139]
v_exp_f32 v192, v192
v_mfma_f32_16x16x32_bf16 a[140:143], v[240:243], v[172:175], a[140:143]
ds_read_b64_tr_b16 v[238:239], v249 offset:59904
v_mfma_f32_16x16x32_bf16 a[140:143], v[244:247], v[188:191], a[140:143]
s_waitcnt lgkmcnt(4)
v_mfma_f32_16x16x32_bf16 a[144:147], v[224:227], v[160:163], a[144:147]
ds_read_b64_tr_b16 v[240:241], v250 offset:41472
v_mfma_f32_16x16x32_bf16 a[144:147], v[228:231], v[176:179], a[144:147]
v_exp_f32 v193, v193
v_mfma_f32_16x16x32_bf16 a[148:151], v[224:227], v[164:167], a[148:151]
ds_read_b64_tr_b16 v[242:243], v250 offset:43520
v_cvt_pk_bf16_f32 v144, v192, v193
v_mfma_f32_16x16x32_bf16 a[148:151], v[228:231], v[180:183], a[148:151]
v_exp_f32 v194, v194
v_mfma_f32_16x16x32_bf16 a[152:155], v[224:227], v[168:171], a[152:155]
ds_read_b64_tr_b16 v[244:245], v250 offset:57856
v_mfma_f32_16x16x32_bf16 a[152:155], v[228:231], v[184:187], a[152:155]
v_exp_f32 v195, v195
v_mfma_f32_16x16x32_bf16 a[156:159], v[224:227], v[172:175], a[156:159]
ds_read_b64_tr_b16 v[246:247], v250 offset:59904
v_cvt_pk_bf16_f32 v145, v194, v195
v_mfma_f32_16x16x32_bf16 a[156:159], v[228:231], v[188:191], a[156:159]
s_waitcnt lgkmcnt(4)
v_mfma_f32_16x16x32_bf16 a[160:163], v[232:235], v[160:163], a[160:163]
ds_read_b128 v[224:227], v248 offset:18432
v_mfma_f32_16x16x32_bf16 a[160:163], v[236:239], v[176:179], a[160:163]
v_exp_f32 v196, v196
v_mfma_f32_16x16x32_bf16 a[164:167], v[232:235], v[164:167], a[164:167]
v_exp_f32 v197, v197
v_mfma_f32_16x16x32_bf16 a[164:167], v[236:239], v[180:183], a[164:167]
v_exp_f32 v198, v198
v_mfma_f32_16x16x32_bf16 a[168:171], v[232:235], v[168:171], a[168:171]
ds_read_b128 v[228:231], v248 offset:18944
v_cvt_pk_bf16_f32 v148, v196, v197
v_mfma_f32_16x16x32_bf16 a[168:171], v[236:239], v[184:187], a[168:171]
v_exp_f32 v199, v199
v_mfma_f32_16x16x32_bf16 a[172:175], v[232:235], v[172:175], a[172:175]
v_exp_f32 v200, v200
v_mfma_f32_16x16x32_bf16 a[172:175], v[236:239], v[188:191], a[172:175]
s_waitcnt lgkmcnt(2)
v_cvt_pk_bf16_f32 v149, v198, v199
v_mfma_f32_16x16x32_bf16 a[176:179], v[240:243], v[160:163], a[176:179]
ds_read_b128 v[232:235], v248 offset:22528
v_mfma_f32_16x16x32_bf16 a[176:179], v[244:247], v[176:179], a[176:179]
v_exp_f32 v201, v201
v_mfma_f32_16x16x32_bf16 a[180:183], v[240:243], v[164:167], a[180:183]
v_exp_f32 v202, v202
v_mfma_f32_16x16x32_bf16 a[180:183], v[244:247], v[180:183], a[180:183]
v_exp_f32 v203, v203
v_mfma_f32_16x16x32_bf16 a[184:187], v[240:243], v[168:171], a[184:187]
ds_read_b128 v[236:239], v248 offset:23040
v_cvt_pk_bf16_f32 v152, v200, v201
v_mfma_f32_16x16x32_bf16 a[184:187], v[244:247], v[184:187], a[184:187]
v_cvt_pk_bf16_f32 v153, v202, v203
v_mfma_f32_16x16x32_bf16 a[188:191], v[240:243], v[172:175], a[188:191]
v_exp_f32 v204, v204
v_mfma_f32_16x16x32_bf16 a[188:191], v[244:247], v[188:191], a[188:191]
s_waitcnt lgkmcnt(2)
v_mfma_f32_16x16x32_bf16 v[208:211], v[224:227], v[0:3], 0
ds_read_b128 v[240:243], v248 offset:26624
v_mfma_f32_16x16x32_bf16 v[208:211], v[228:231], v[4:7], v[208:211]
v_exp_f32 v205, v205
v_mfma_f32_16x16x32_bf16 v[212:215], v[224:227], v[32:35], 0
v_exp_f32 v206, v206
v_mfma_f32_16x16x32_bf16 v[212:215], v[228:231], v[36:39], v[212:215]
v_exp_f32 v207, v207
v_mfma_f32_16x16x32_bf16 v[216:219], v[224:227], v[64:67], 0
ds_read_b128 v[244:247], v248 offset:27136
v_cvt_pk_bf16_f32 v156, v204, v205
v_mfma_f32_16x16x32_bf16 v[216:219], v[228:231], v[68:71], v[216:219]
v_cvt_pk_bf16_f32 v157, v206, v207
v_mfma_f32_16x16x32_bf16 v[220:223], v[224:227], v[96:99], 0
v_mfma_f32_16x16x32_bf16 v[220:223], v[228:231], v[100:103], v[220:223]
s_waitcnt lgkmcnt(2)
v_mfma_f32_16x16x32_bf16 v[208:211], v[232:235], v[8:11], v[208:211]
ds_read_b128 v[224:227], v248 offset:30720
v_mfma_f32_16x16x32_bf16 v[208:211], v[236:239], v[12:15], v[208:211]
v_mfma_f32_16x16x32_bf16 v[212:215], v[232:235], v[40:43], v[212:215]
v_mfma_f32_16x16x32_bf16 v[212:215], v[236:239], v[44:47], v[212:215]
v_mfma_f32_16x16x32_bf16 v[216:219], v[232:235], v[72:75], v[216:219]
ds_read_b128 v[228:231], v248 offset:31232
v_mfma_f32_16x16x32_bf16 v[216:219], v[236:239], v[76:79], v[216:219]
v_mfma_f32_16x16x32_bf16 v[220:223], v[232:235], v[104:107], v[220:223]
v_mfma_f32_16x16x32_bf16 v[220:223], v[236:239], v[108:111], v[220:223]
s_waitcnt lgkmcnt(2)
v_mfma_f32_16x16x32_bf16 v[208:211], v[240:243], v[16:19], v[208:211]
ds_read_b64_tr_b16 v[232:233], v249 offset:45056
v_mfma_f32_16x16x32_bf16 v[208:211], v[244:247], v[20:23], v[208:211]
v_mfma_f32_16x16x32_bf16 v[212:215], v[240:243], v[48:51], v[212:215]
ds_read_b64_tr_b16 v[234:235], v249 offset:47104
v_mfma_f32_16x16x32_bf16 v[212:215], v[244:247], v[52:55], v[212:215]
v_mfma_f32_16x16x32_bf16 v[216:219], v[240:243], v[80:83], v[216:219]
ds_read_b64_tr_b16 v[236:237], v249 offset:61440
v_mfma_f32_16x16x32_bf16 v[216:219], v[244:247], v[84:87], v[216:219]
v_mfma_f32_16x16x32_bf16 v[220:223], v[240:243], v[112:115], v[220:223]
ds_read_b64_tr_b16 v[238:239], v249 offset:63488
v_mfma_f32_16x16x32_bf16 v[220:223], v[244:247], v[116:119], v[220:223]
s_waitcnt lgkmcnt(4)
v_mfma_f32_16x16x32_bf16 v[208:211], v[224:227], v[24:27], v[208:211]
ds_read_b64_tr_b16 v[240:241], v250 offset:45056
v_mfma_f32_16x16x32_bf16 v[208:211], v[228:231], v[28:31], v[208:211]
v_mfma_f32_16x16x32_bf16 v[212:215], v[224:227], v[56:59], v[212:215]
ds_read_b64_tr_b16 v[242:243], v250 offset:47104
v_mfma_f32_16x16x32_bf16 v[212:215], v[228:231], v[60:63], v[212:215]
v_mfma_f32_16x16x32_bf16 v[216:219], v[224:227], v[88:91], v[216:219]
ds_read_b64_tr_b16 v[244:245], v250 offset:61440
v_mfma_f32_16x16x32_bf16 v[216:219], v[228:231], v[92:95], v[216:219]
v_mfma_f32_16x16x32_bf16 v[220:223], v[224:227], v[120:123], v[220:223]
ds_read_b64_tr_b16 v[246:247], v250 offset:63488
v_mfma_f32_16x16x32_bf16 v[220:223], v[228:231], v[124:127], v[220:223]
s_waitcnt lgkmcnt(4)
v_mfma_f32_16x16x32_bf16 a[192:195], v[232:235], v[160:163], a[192:195]
ds_read_b64_tr_b16 v[224:225], v249 offset:45568
v_mfma_f32_16x16x32_bf16 a[192:195], v[236:239], v[176:179], a[192:195]
v_mfma_f32_16x16x32_bf16 a[196:199], v[232:235], v[164:167], a[196:199]
ds_read_b64_tr_b16 v[226:227], v249 offset:47616
v_mfma_f32_16x16x32_bf16 a[196:199], v[236:239], v[180:183], a[196:199]
v_exp_f32 v208, v208
v_mfma_f32_16x16x32_bf16 a[200:203], v[232:235], v[168:171], a[200:203]
ds_read_b64_tr_b16 v[228:229], v249 offset:61952
v_mfma_f32_16x16x32_bf16 a[200:203], v[236:239], v[184:187], a[200:203]
v_exp_f32 v209, v209
v_mfma_f32_16x16x32_bf16 a[204:207], v[232:235], v[172:175], a[204:207]
ds_read_b64_tr_b16 v[230:231], v249 offset:64000
v_cvt_pk_bf16_f32 v146, v208, v209
v_mfma_f32_16x16x32_bf16 a[204:207], v[236:239], v[188:191], a[204:207]
s_waitcnt lgkmcnt(4)
v_mfma_f32_16x16x32_bf16 a[208:211], v[240:243], v[160:163], a[208:211]
ds_read_b64_tr_b16 v[232:233], v250 offset:45568
v_mfma_f32_16x16x32_bf16 a[208:211], v[244:247], v[176:179], a[208:211]
v_exp_f32 v210, v210
v_mfma_f32_16x16x32_bf16 a[212:215], v[240:243], v[164:167], a[212:215]
ds_read_b64_tr_b16 v[234:235], v250 offset:47616
v_mfma_f32_16x16x32_bf16 a[212:215], v[244:247], v[180:183], a[212:215]
v_exp_f32 v211, v211
v_mfma_f32_16x16x32_bf16 a[216:219], v[240:243], v[168:171], a[216:219]
ds_read_b64_tr_b16 v[236:237], v250 offset:61952
v_cvt_pk_bf16_f32 v147, v210, v211
v_mfma_f32_16x16x32_bf16 a[216:219], v[244:247], v[184:187], a[216:219]
v_exp_f32 v212, v212
v_mfma_f32_16x16x32_bf16 a[220:223], v[240:243], v[172:175], a[220:223]
ds_read_b64_tr_b16 v[238:239], v250 offset:64000
v_mfma_f32_16x16x32_bf16 a[220:223], v[244:247], v[188:191], a[220:223]
s_waitcnt lgkmcnt(4)
v_mfma_f32_16x16x32_bf16 a[224:227], v[224:227], v[160:163], a[224:227]
ds_read_b128 v[240:243], v248 offset:32768
v_mfma_f32_16x16x32_bf16 a[224:227], v[228:231], v[176:179], a[224:227]
v_exp_f32 v213, v213
v_mfma_f32_16x16x32_bf16 a[228:231], v[224:227], v[164:167], a[228:231]
v_exp_f32 v214, v214
v_mfma_f32_16x16x32_bf16 a[228:231], v[228:231], v[180:183], a[228:231]
v_exp_f32 v215, v215
v_mfma_f32_16x16x32_bf16 a[232:235], v[224:227], v[168:171], a[232:235]
ds_read_b128 v[244:247], v248 offset:33280
v_cvt_pk_bf16_f32 v150, v212, v213
v_mfma_f32_16x16x32_bf16 a[232:235], v[228:231], v[184:187], a[232:235]
v_cvt_pk_bf16_f32 v151, v214, v215
v_mfma_f32_16x16x32_bf16 a[236:239], v[224:227], v[172:175], a[236:239]
v_exp_f32 v216, v216
v_mfma_f32_16x16x32_bf16 a[236:239], v[228:231], v[188:191], a[236:239]
s_waitcnt lgkmcnt(2)
v_mfma_f32_16x16x32_bf16 a[240:243], v[232:235], v[160:163], a[240:243]
ds_read_b128 v[224:227], v248 offset:36864
v_mfma_f32_16x16x32_bf16 a[240:243], v[236:239], v[176:179], a[240:243]
v_exp_f32 v217, v217
v_mfma_f32_16x16x32_bf16 a[244:247], v[232:235], v[164:167], a[244:247]
v_exp_f32 v218, v218
v_mfma_f32_16x16x32_bf16 a[244:247], v[236:239], v[180:183], a[244:247]
v_exp_f32 v219, v219
v_mfma_f32_16x16x32_bf16 a[248:251], v[232:235], v[168:171], a[248:251]
ds_read_b128 v[228:231], v248 offset:37376
v_cvt_pk_bf16_f32 v154, v216, v217
v_mfma_f32_16x16x32_bf16 a[248:251], v[236:239], v[184:187], a[248:251]
v_cvt_pk_bf16_f32 v155, v218, v219
v_mfma_f32_16x16x32_bf16 a[252:255], v[232:235], v[172:175], a[252:255]
v_exp_f32 v220, v220
v_mfma_f32_16x16x32_bf16 a[252:255], v[236:239], v[188:191], a[252:255]
s_waitcnt lgkmcnt(2)
v_mfma_f32_16x16x32_bf16 v[192:195], v[240:243], v[0:3], 0
ds_read_b128 v[232:235], v248 offset:40960
v_mfma_f32_16x16x32_bf16 v[192:195], v[244:247], v[4:7], v[192:195]
v_xor_b32 v249, 0x10000, v249
v_mfma_f32_16x16x32_bf16 v[196:199], v[240:243], v[32:35], 0
v_exp_f32 v221, v221
v_mfma_f32_16x16x32_bf16 v[196:199], v[244:247], v[36:39], v[196:199]
v_xor_b32 v250, 0x10000, v250
v_cvt_pk_bf16_f32 v158, v220, v221
v_mfma_f32_16x16x32_bf16 v[200:203], v[240:243], v[64:67], 0
ds_read_b128 v[236:239], v248 offset:41472
v_mfma_f32_16x16x32_bf16 v[200:203], v[244:247], v[68:71], v[200:203]
v_exp_f32 v222, v222
v_mfma_f32_16x16x32_bf16 v[204:207], v[240:243], v[96:99], 0
v_exp_f32 v223, v223
v_mfma_f32_16x16x32_bf16 v[204:207], v[244:247], v[100:103], v[204:207]
s_waitcnt lgkmcnt(2)
v_cvt_pk_bf16_f32 v159, v222, v223
v_mfma_f32_16x16x32_bf16 v[192:195], v[224:227], v[8:11], v[192:195]
ds_read_b128 v[240:243], v248 offset:45056
v_mfma_f32_16x16x32_bf16 v[192:195], v[228:231], v[12:15], v[192:195]
v_mfma_f32_16x16x32_bf16 v[196:199], v[224:227], v[40:43], v[196:199]
v_mfma_f32_16x16x32_bf16 v[196:199], v[228:231], v[44:47], v[196:199]
v_mfma_f32_16x16x32_bf16 v[200:203], v[224:227], v[72:75], v[200:203]
ds_read_b128 v[244:247], v248 offset:45568
v_mfma_f32_16x16x32_bf16 v[200:203], v[228:231], v[76:79], v[200:203]
v_mfma_f32_16x16x32_bf16 v[204:207], v[224:227], v[104:107], v[204:207]
v_mfma_f32_16x16x32_bf16 v[204:207], v[228:231], v[108:111], v[204:207]
s_waitcnt lgkmcnt(2)
v_mfma_f32_16x16x32_bf16 v[192:195], v[232:235], v[16:19], v[192:195]
ds_read_b64_tr_b16 v[224:225], v249 offset:0
v_mfma_f32_16x16x32_bf16 v[192:195], v[236:239], v[20:23], v[192:195]
v_mfma_f32_16x16x32_bf16 v[196:199], v[232:235], v[48:51], v[196:199]
ds_read_b64_tr_b16 v[226:227], v249 offset:2048
v_mfma_f32_16x16x32_bf16 v[196:199], v[236:239], v[52:55], v[196:199]
v_mfma_f32_16x16x32_bf16 v[200:203], v[232:235], v[80:83], v[200:203]
ds_read_b64_tr_b16 v[228:229], v249 offset:16384
v_mfma_f32_16x16x32_bf16 v[200:203], v[236:239], v[84:87], v[200:203]
v_mfma_f32_16x16x32_bf16 v[204:207], v[232:235], v[112:115], v[204:207]
ds_read_b64_tr_b16 v[230:231], v249 offset:18432
v_mfma_f32_16x16x32_bf16 v[204:207], v[236:239], v[116:119], v[204:207]
s_waitcnt lgkmcnt(4)
v_mfma_f32_16x16x32_bf16 v[192:195], v[240:243], v[24:27], v[192:195]
ds_read_b64_tr_b16 v[232:233], v250 offset:0
v_mfma_f32_16x16x32_bf16 v[192:195], v[244:247], v[28:31], v[192:195]
v_mfma_f32_16x16x32_bf16 v[196:199], v[240:243], v[56:59], v[196:199]
ds_read_b64_tr_b16 v[234:235], v250 offset:2048
v_mfma_f32_16x16x32_bf16 v[196:199], v[244:247], v[60:63], v[196:199]
v_mfma_f32_16x16x32_bf16 v[200:203], v[240:243], v[88:91], v[200:203]
ds_read_b64_tr_b16 v[236:237], v250 offset:16384
v_mfma_f32_16x16x32_bf16 v[200:203], v[244:247], v[92:95], v[200:203]
s_sub_u32 s31, s31, 1
v_mfma_f32_16x16x32_bf16 v[204:207], v[240:243], v[120:123], v[204:207]
ds_read_b64_tr_b16 v[238:239], v250 offset:18432
v_mfma_f32_16x16x32_bf16 v[204:207], v[244:247], v[124:127], v[204:207]
s_cbranch_scc0 L2_loop
L2_tails:
L2_tail_1:
s_cmp_eq_u32 s59, 7
s_cbranch_scc1 L2_tail_1_7
L2_tail_1_6:
s_waitcnt lgkmcnt(4)
v_mfma_f32_16x16x32_bf16 a[0:3], v[224:227], v[160:163], a[0:3]
ds_read_b128 v[240:243], v248 offset:2048
v_mfma_f32_16x16x32_bf16 a[0:3], v[228:231], v[176:179], a[0:3]
s_lshl_b32 s36, s34, 13
v_mfma_f32_16x16x32_bf16 a[4:7], v[224:227], v[164:167], a[4:7]
s_add_u32 s56, s4, 0x1000000
s_addc_u32 s57, s5, 0
v_mfma_f32_16x16x32_bf16 a[4:7], v[228:231], v[180:183], a[4:7]
s_add_u32 s36, s36, 0x20000
s_mov_b32 s58, 0x6c02000
v_mfma_f32_16x16x32_bf16 a[8:11], v[224:227], v[168:171], a[8:11]
ds_read_b128 v[244:247], v248 offset:2560
s_mov_b32 s59, 0x00020000
v_mfma_f32_16x16x32_bf16 a[8:11], v[228:231], v[184:187], a[8:11]
v_add_u32 v255, s36, v252
s_lshr_b32 s35, s2, 1
v_mfma_f32_16x16x32_bf16 a[12:15], v[224:227], v[172:175], a[12:15]
s_and_b32 s35, s35, 28
s_add_u32 s35, s35, s34
v_mfma_f32_16x16x32_bf16 a[12:15], v[228:231], v[188:191], a[12:15]
s_waitcnt lgkmcnt(2)
s_lshl_b32 s35, s35, 13
v_mfma_f32_16x16x32_bf16 a[16:19], v[232:235], v[160:163], a[16:19]
ds_read_b128 v[224:227], v248 offset:6144
v_lshlrev_b32 v253, 3, v252
v_mfma_f32_16x16x32_bf16 a[16:19], v[236:239], v[176:179], a[16:19]
buffer_load_dword v253, v253, s[56:59], s35 offen
ds_write_b128 v255, v[160:163] offset:0
v_mfma_f32_16x16x32_bf16 a[20:23], v[232:235], v[164:167], a[20:23]
v_exp_f32 v192, v192
v_mfma_f32_16x16x32_bf16 a[20:23], v[236:239], v[180:183], a[20:23]
v_exp_f32 v193, v193
v_mfma_f32_16x16x32_bf16 a[24:27], v[232:235], v[168:171], a[24:27]
ds_read_b128 v[228:231], v248 offset:6656
v_cvt_pk_bf16_f32 v128, v192, v193
v_mfma_f32_16x16x32_bf16 a[24:27], v[236:239], v[184:187], a[24:27]
v_exp_f32 v194, v194
v_mfma_f32_16x16x32_bf16 a[28:31], v[232:235], v[172:175], a[28:31]
v_exp_f32 v195, v195
v_mfma_f32_16x16x32_bf16 a[28:31], v[236:239], v[188:191], a[28:31]
s_waitcnt lgkmcnt(3)
v_cvt_pk_bf16_f32 v129, v194, v195
v_mfma_f32_16x16x32_bf16 v[208:211], v[240:243], v[0:3], 0
ds_read_b128 v[232:235], v248 offset:10240
ds_write_b128 v255, v[164:167] offset:1024
v_mfma_f32_16x16x32_bf16 v[208:211], v[244:247], v[4:7], v[208:211]
v_exp_f32 v196, v196
v_mfma_f32_16x16x32_bf16 v[212:215], v[240:243], v[32:35], 0
v_exp_f32 v197, v197
v_mfma_f32_16x16x32_bf16 v[212:215], v[244:247], v[36:39], v[212:215]
v_exp_f32 v198, v198
v_mfma_f32_16x16x32_bf16 v[216:219], v[240:243], v[64:67], 0
ds_read_b128 v[236:239], v248 offset:10752
v_cvt_pk_bf16_f32 v132, v196, v197
v_mfma_f32_16x16x32_bf16 v[216:219], v[244:247], v[68:71], v[216:219]
v_exp_f32 v199, v199
v_mfma_f32_16x16x32_bf16 v[220:223], v[240:243], v[96:99], 0
v_exp_f32 v200, v200
v_mfma_f32_16x16x32_bf16 v[220:223], v[244:247], v[100:103], v[220:223]
s_waitcnt lgkmcnt(3)
v_cvt_pk_bf16_f32 v133, v198, v199
v_mfma_f32_16x16x32_bf16 v[208:211], v[224:227], v[8:11], v[208:211]
ds_read_b128 v[240:243], v248 offset:14336
ds_write_b128 v255, v[168:171] offset:2048
v_mfma_f32_16x16x32_bf16 v[208:211], v[228:231], v[12:15], v[208:211]
v_exp_f32 v201, v201
v_mfma_f32_16x16x32_bf16 v[212:215], v[224:227], v[40:43], v[212:215]
v_exp_f32 v202, v202
v_mfma_f32_16x16x32_bf16 v[212:215], v[228:231], v[44:47], v[212:215]
v_exp_f32 v203, v203
v_mfma_f32_16x16x32_bf16 v[216:219], v[224:227], v[72:75], v[216:219]
ds_read_b128 v[244:247], v248 offset:14848
v_cvt_pk_bf16_f32 v136, v200, v201
v_mfma_f32_16x16x32_bf16 v[216:219], v[228:231], v[76:79], v[216:219]
v_cvt_pk_bf16_f32 v137, v202, v203
ds_write_b128 v255, v[172:175] offset:3072
v_mfma_f32_16x16x32_bf16 v[220:223], v[224:227], v[104:107], v[220:223]
v_exp_f32 v204, v204
v_mfma_f32_16x16x32_bf16 v[220:223], v[228:231], v[108:111], v[220:223]
s_waitcnt lgkmcnt(4)
s_waitcnt vmcnt(1)
s_barrier
v_mfma_f32_16x16x32_bf16 v[208:211], v[232:235], v[16:19], v[208:211]
ds_read_b128 v[224:227], v248 offset:16384
s_add_u32 m0, s30, 0xc000
v_mfma_f32_16x16x32_bf16 v[208:211], v[236:239], v[20:23], v[208:211]
s_and_b32 s100, s30, 0x10000
buffer_load_dwordx4 v251, s[12:15], s28 offen offset:0 lds
v_mfma_f32_16x16x32_bf16 v[212:215], v[232:235], v[48:51], v[212:215]
s_xor_b32 s100, s100, 0x10000
v_mfma_f32_16x16x32_bf16 v[212:215], v[236:239], v[52:55], v[212:215]
v_exp_f32 v205, v205
v_mfma_f32_16x16x32_bf16 v[216:219], v[232:235], v[80:83], v[216:219]
ds_read_b128 v[228:231], v248 offset:16896
v_cvt_pk_bf16_f32 v140, v204, v205
v_mfma_f32_16x16x32_bf16 v[216:219], v[236:239], v[84:87], v[216:219]
v_exp_f32 v206, v206
v_mfma_f32_16x16x32_bf16 v[220:223], v[232:235], v[112:115], v[220:223]
v_exp_f32 v207, v207
v_mfma_f32_16x16x32_bf16 v[220:223], v[236:239], v[116:119], v[220:223]
s_waitcnt lgkmcnt(3)
v_cvt_pk_bf16_f32 v141, v206, v207
v_mfma_f32_16x16x32_bf16 v[208:211], v[240:243], v[24:27], v[208:211]
ds_read_b128 v[232:235], v248 offset:20480
buffer_load_dwordx4 v251, s[12:15], s28 offen offset:1024 lds
v_mfma_f32_16x16x32_bf16 v[208:211], v[244:247], v[28:31], v[208:211]
v_mfma_f32_16x16x32_bf16 v[212:215], v[240:243], v[56:59], v[212:215]
buffer_load_dwordx4 v251, s[12:15], s28 offen offset:2048 lds
v_mfma_f32_16x16x32_bf16 v[212:215], v[244:247], v[60:63], v[212:215]
v_mfma_f32_16x16x32_bf16 v[216:219], v[240:243], v[88:91], v[216:219]
ds_read_b128 v[236:239], v248 offset:20992
buffer_load_dwordx4 v251, s[12:15], s28 offen offset:3072 lds
v_mfma_f32_16x16x32_bf16 v[216:219], v[244:247], v[92:95], v[216:219]
v_mfma_f32_16x16x32_bf16 v[220:223], v[240:243], v[120:123], v[220:223]
s_add_u32 s28, s28, 0x4000
v_mfma_f32_16x16x32_bf16 v[220:223], v[244:247], v[124:127], v[220:223]
s_waitcnt lgkmcnt(2)
v_mfma_f32_16x16x32_bf16 v[192:195], v[224:227], v[0:3], 0
ds_read_b128 v[240:243], v248 offset:24576
v_mfma_f32_16x16x32_bf16 v[192:195], v[228:231], v[4:7], v[192:195]
v_exp_f32 v208, v208
v_mfma_f32_16x16x32_bf16 v[196:199], v[224:227], v[32:35], 0
v_exp_f32 v209, v209
v_mfma_f32_16x16x32_bf16 v[196:199], v[228:231], v[36:39], v[196:199]
v_exp_f32 v210, v210
v_mfma_f32_16x16x32_bf16 v[200:203], v[224:227], v[64:67], 0
ds_read_b128 v[244:247], v248 offset:25088
v_cvt_pk_bf16_f32 v130, v208, v209
v_mfma_f32_16x16x32_bf16 v[200:203], v[228:231], v[68:71], v[200:203]
v_exp_f32 v211, v211
v_mfma_f32_16x16x32_bf16 v[204:207], v[224:227], v[96:99], 0
v_exp_f32 v212, v212
v_mfma_f32_16x16x32_bf16 v[204:207], v[228:231], v[100:103], v[204:207]
s_waitcnt lgkmcnt(2)
v_cvt_pk_bf16_f32 v131, v210, v211
v_mfma_f32_16x16x32_bf16 v[192:195], v[232:235], v[8:11], v[192:195]
ds_read_b128 v[224:227], v248 offset:28672
v_mfma_f32_16x16x32_bf16 v[192:195], v[236:239], v[12:15], v[192:195]
v_exp_f32 v213, v213
v_mfma_f32_16x16x32_bf16 v[196:199], v[232:235], v[40:43], v[196:199]
v_exp_f32 v214, v214
v_mfma_f32_16x16x32_bf16 v[196:199], v[236:239], v[44:47], v[196:199]
v_exp_f32 v215, v215
v_mfma_f32_16x16x32_bf16 v[200:203], v[232:235], v[72:75], v[200:203]
ds_read_b128 v[228:231], v248 offset:29184
v_cvt_pk_bf16_f32 v134, v212, v213
v_mfma_f32_16x16x32_bf16 v[200:203], v[236:239], v[76:79], v[200:203]
v_cvt_pk_bf16_f32 v135, v214, v215
v_mfma_f32_16x16x32_bf16 v[204:207], v[232:235], v[104:107], v[204:207]
v_exp_f32 v216, v216
v_mfma_f32_16x16x32_bf16 v[204:207], v[236:239], v[108:111], v[204:207]
s_waitcnt lgkmcnt(2)
v_mfma_f32_16x16x32_bf16 v[192:195], v[240:243], v[16:19], v[192:195]
ds_read_b128 v[232:235], v248 offset:18432
v_mfma_f32_16x16x32_bf16 v[192:195], v[244:247], v[20:23], v[192:195]
v_exp_f32 v217, v217
v_mfma_f32_16x16x32_bf16 v[196:199], v[240:243], v[48:51], v[196:199]
v_exp_f32 v218, v218
v_mfma_f32_16x16x32_bf16 v[196:199], v[244:247], v[52:55], v[196:199]
v_exp_f32 v219, v219
v_mfma_f32_16x16x32_bf16 v[200:203], v[240:243], v[80:83], v[200:203]
ds_read_b128 v[236:239], v248 offset:18944
v_cvt_pk_bf16_f32 v138, v216, v217
v_mfma_f32_16x16x32_bf16 v[200:203], v[244:247], v[84:87], v[200:203]
v_cvt_pk_bf16_f32 v139, v218, v219
v_mfma_f32_16x16x32_bf16 v[204:207], v[240:243], v[112:115], v[204:207]
v_exp_f32 v220, v220
v_mfma_f32_16x16x32_bf16 v[204:207], v[244:247], v[116:119], v[204:207]
s_waitcnt lgkmcnt(2)
v_mfma_f32_16x16x32_bf16 v[192:195], v[224:227], v[24:27], v[192:195]
ds_read_b128 v[240:243], v248 offset:22528
v_mfma_f32_16x16x32_bf16 v[192:195], v[228:231], v[28:31], v[192:195]
v_exp_f32 v221, v221
v_mfma_f32_16x16x32_bf16 v[196:199], v[224:227], v[56:59], v[196:199]
v_exp_f32 v222, v222
v_mfma_f32_16x16x32_bf16 v[196:199], v[228:231], v[60:63], v[196:199]
v_exp_f32 v223, v223
v_mfma_f32_16x16x32_bf16 v[200:203], v[224:227], v[88:91], v[200:203]
ds_read_b128 v[244:247], v248 offset:23040
v_cvt_pk_bf16_f32 v142, v220, v221
v_mfma_f32_16x16x32_bf16 v[200:203], v[228:231], v[92:95], v[200:203]
v_cvt_pk_bf16_f32 v143, v222, v223
v_mfma_f32_16x16x32_bf16 v[204:207], v[224:227], v[120:123], v[204:207]
v_mfma_f32_16x16x32_bf16 v[204:207], v[228:231], v[124:127], v[204:207]
s_waitcnt lgkmcnt(2)
v_mfma_f32_16x16x32_bf16 v[208:211], v[232:235], v[0:3], 0
ds_read_b128 v[224:227], v248 offset:26624
v_mfma_f32_16x16x32_bf16 v[208:211], v[236:239], v[4:7], v[208:211]
v_exp_f32 v192, v192
v_mfma_f32_16x16x32_bf16 v[212:215], v[232:235], v[32:35], 0
v_exp_f32 v193, v193
v_mfma_f32_16x16x32_bf16 v[212:215], v[236:239], v[36:39], v[212:215]
v_exp_f32 v194, v194
v_mfma_f32_16x16x32_bf16 v[216:219], v[232:235], v[64:67], 0
ds_read_b128 v[228:231], v248 offset:27136
v_cvt_pk_bf16_f32 v144, v192, v193
v_mfma_f32_16x16x32_bf16 v[216:219], v[236:239], v[68:71], v[216:219]
v_exp_f32 v195, v195
v_mfma_f32_16x16x32_bf16 v[220:223], v[232:235], v[96:99], 0
v_exp_f32 v196, v196
v_mfma_f32_16x16x32_bf16 v[220:223], v[236:239], v[100:103], v[220:223]
s_waitcnt lgkmcnt(2)
v_cvt_pk_bf16_f32 v145, v194, v195
v_mfma_f32_16x16x32_bf16 v[208:211], v[240:243], v[8:11], v[208:211]
ds_read_b128 v[232:235], v248 offset:30720
v_mfma_f32_16x16x32_bf16 v[208:211], v[244:247], v[12:15], v[208:211]
v_exp_f32 v197, v197
v_mfma_f32_16x16x32_bf16 v[212:215], v[240:243], v[40:43], v[212:215]
v_exp_f32 v198, v198
v_mfma_f32_16x16x32_bf16 v[212:215], v[244:247], v[44:47], v[212:215]
v_exp_f32 v199, v199
v_mfma_f32_16x16x32_bf16 v[216:219], v[240:243], v[72:75], v[216:219]
ds_read_b128 v[236:239], v248 offset:31232
v_cvt_pk_bf16_f32 v148, v196, v197
v_mfma_f32_16x16x32_bf16 v[216:219], v[244:247], v[76:79], v[216:219]
v_cvt_pk_bf16_f32 v149, v198, v199
v_mfma_f32_16x16x32_bf16 v[220:223], v[240:243], v[104:107], v[220:223]
v_exp_f32 v200, v200
v_mfma_f32_16x16x32_bf16 v[220:223], v[244:247], v[108:111], v[220:223]
s_waitcnt lgkmcnt(2)
v_mfma_f32_16x16x32_bf16 v[208:211], v[224:227], v[16:19], v[208:211]
ds_read_b128 v[240:243], v248 offset:32768
v_mfma_f32_16x16x32_bf16 v[208:211], v[228:231], v[20:23], v[208:211]
v_exp_f32 v201, v201
v_mfma_f32_16x16x32_bf16 v[212:215], v[224:227], v[48:51], v[212:215]
v_exp_f32 v202, v202
v_mfma_f32_16x16x32_bf16 v[212:215], v[228:231], v[52:55], v[212:215]
v_exp_f32 v203, v203
v_mfma_f32_16x16x32_bf16 v[216:219], v[224:227], v[80:83], v[216:219]
ds_read_b128 v[244:247], v248 offset:33280
v_cvt_pk_bf16_f32 v152, v200, v201
v_mfma_f32_16x16x32_bf16 v[216:219], v[228:231], v[84:87], v[216:219]
v_cvt_pk_bf16_f32 v153, v202, v203
v_mfma_f32_16x16x32_bf16 v[220:223], v[224:227], v[112:115], v[220:223]
v_exp_f32 v204, v204
v_mfma_f32_16x16x32_bf16 v[220:223], v[228:231], v[116:119], v[220:223]
s_waitcnt lgkmcnt(2)
v_mfma_f32_16x16x32_bf16 v[208:211], v[232:235], v[24:27], v[208:211]
ds_read_b128 v[224:227], v248 offset:36864
v_mfma_f32_16x16x32_bf16 v[208:211], v[236:239], v[28:31], v[208:211]
v_exp_f32 v205, v205
v_mfma_f32_16x16x32_bf16 v[212:215], v[232:235], v[56:59], v[212:215]
v_exp_f32 v206, v206
v_mfma_f32_16x16x32_bf16 v[212:215], v[236:239], v[60:63], v[212:215]
v_exp_f32 v207, v207
v_mfma_f32_16x16x32_bf16 v[216:219], v[232:235], v[88:91], v[216:219]
ds_read_b128 v[228:231], v248 offset:37376
v_cvt_pk_bf16_f32 v156, v204, v205
v_mfma_f32_16x16x32_bf16 v[216:219], v[236:239], v[92:95], v[216:219]
v_cvt_pk_bf16_f32 v157, v206, v207
v_mfma_f32_16x16x32_bf16 v[220:223], v[232:235], v[120:123], v[220:223]
v_mfma_f32_16x16x32_bf16 v[220:223], v[236:239], v[124:127], v[220:223]
s_waitcnt lgkmcnt(2)
v_mfma_f32_16x16x32_bf16 v[192:195], v[240:243], v[0:3], 0
ds_read_b128 v[232:235], v248 offset:40960
v_mfma_f32_16x16x32_bf16 v[192:195], v[244:247], v[4:7], v[192:195]
v_exp_f32 v208, v208
v_mfma_f32_16x16x32_bf16 v[196:199], v[240:243], v[32:35], 0
v_exp_f32 v209, v209
v_mfma_f32_16x16x32_bf16 v[196:199], v[244:247], v[36:39], v[196:199]
v_exp_f32 v210, v210
v_mfma_f32_16x16x32_bf16 v[200:203], v[240:243], v[64:67], 0
ds_read_b128 v[236:239], v248 offset:41472
v_cvt_pk_bf16_f32 v146, v208, v209
v_mfma_f32_16x16x32_bf16 v[200:203], v[244:247], v[68:71], v[200:203]
v_exp_f32 v211, v211
v_mfma_f32_16x16x32_bf16 v[204:207], v[240:243], v[96:99], 0
v_exp_f32 v212, v212
v_mfma_f32_16x16x32_bf16 v[204:207], v[244:247], v[100:103], v[204:207]
s_waitcnt lgkmcnt(2)
v_cvt_pk_bf16_f32 v147, v210, v211
v_mfma_f32_16x16x32_bf16 v[192:195], v[224:227], v[8:11], v[192:195]
ds_read_b128 v[240:243], v248 offset:45056
v_mfma_f32_16x16x32_bf16 v[192:195], v[228:231], v[12:15], v[192:195]
v_exp_f32 v213, v213
v_mfma_f32_16x16x32_bf16 v[196:199], v[224:227], v[40:43], v[196:199]
v_exp_f32 v214, v214
v_mfma_f32_16x16x32_bf16 v[196:199], v[228:231], v[44:47], v[196:199]
v_exp_f32 v215, v215
v_mfma_f32_16x16x32_bf16 v[200:203], v[224:227], v[72:75], v[200:203]
ds_read_b128 v[244:247], v248 offset:45568
v_cvt_pk_bf16_f32 v150, v212, v213
v_mfma_f32_16x16x32_bf16 v[200:203], v[228:231], v[76:79], v[200:203]
v_cvt_pk_bf16_f32 v151, v214, v215
v_mfma_f32_16x16x32_bf16 v[204:207], v[224:227], v[104:107], v[204:207]
v_exp_f32 v216, v216
v_mfma_f32_16x16x32_bf16 v[204:207], v[228:231], v[108:111], v[204:207]
s_waitcnt lgkmcnt(2)
v_mfma_f32_16x16x32_bf16 v[192:195], v[232:235], v[16:19], v[192:195]
ds_read_b128 v[224:227], v248 offset:34816
v_mfma_f32_16x16x32_bf16 v[192:195], v[236:239], v[20:23], v[192:195]
v_exp_f32 v217, v217
v_mfma_f32_16x16x32_bf16 v[196:199], v[232:235], v[48:51], v[196:199]
v_exp_f32 v218, v218
v_mfma_f32_16x16x32_bf16 v[196:199], v[236:239], v[52:55], v[196:199]
v_exp_f32 v219, v219
v_mfma_f32_16x16x32_bf16 v[200:203], v[232:235], v[80:83], v[200:203]
ds_read_b128 v[228:231], v248 offset:35328
v_cvt_pk_bf16_f32 v154, v216, v217
v_mfma_f32_16x16x32_bf16 v[200:203], v[236:239], v[84:87], v[200:203]
v_cvt_pk_bf16_f32 v155, v218, v219
v_mfma_f32_16x16x32_bf16 v[204:207], v[232:235], v[112:115], v[204:207]
v_exp_f32 v220, v220
v_mfma_f32_16x16x32_bf16 v[204:207], v[236:239], v[116:119], v[204:207]
s_waitcnt lgkmcnt(2)
v_mfma_f32_16x16x32_bf16 v[192:195], v[240:243], v[24:27], v[192:195]
ds_read_b128 v[232:235], v248 offset:38912
v_mfma_f32_16x16x32_bf16 v[192:195], v[244:247], v[28:31], v[192:195]
v_exp_f32 v221, v221
v_mfma_f32_16x16x32_bf16 v[196:199], v[240:243], v[56:59], v[196:199]
v_exp_f32 v222, v222
v_mfma_f32_16x16x32_bf16 v[196:199], v[244:247], v[60:63], v[196:199]
v_exp_f32 v223, v223
v_mfma_f32_16x16x32_bf16 v[200:203], v[240:243], v[88:91], v[200:203]
ds_read_b128 v[236:239], v248 offset:39424
v_cvt_pk_bf16_f32 v158, v220, v221
v_mfma_f32_16x16x32_bf16 v[200:203], v[244:247], v[92:95], v[200:203]
v_cvt_pk_bf16_f32 v159, v222, v223
v_mfma_f32_16x16x32_bf16 v[204:207], v[240:243], v[120:123], v[204:207]
v_mfma_f32_16x16x32_bf16 v[204:207], v[244:247], v[124:127], v[204:207]
s_waitcnt lgkmcnt(2)
v_mfma_f32_16x16x32_bf16 v[208:211], v[224:227], v[0:3], 0
ds_read_b128 v[240:243], v248 offset:43008
v_mfma_f32_16x16x32_bf16 v[208:211], v[228:231], v[4:7], v[208:211]
v_exp_f32 v192, v192
v_mfma_f32_16x16x32_bf16 v[212:215], v[224:227], v[32:35], 0
v_exp_f32 v193, v193
v_mfma_f32_16x16x32_bf16 v[212:215], v[228:231], v[36:39], v[212:215]
v_exp_f32 v194, v194
v_mfma_f32_16x16x32_bf16 v[216:219], v[224:227], v[64:67], 0
ds_read_b128 v[244:247], v248 offset:43520
v_cvt_pk_bf16_f32 v160, v192, v193
v_mfma_f32_16x16x32_bf16 v[216:219], v[228:231], v[68:71], v[216:219]
v_exp_f32 v195, v195
v_mfma_f32_16x16x32_bf16 v[220:223], v[224:227], v[96:99], 0
v_exp_f32 v196, v196
v_mfma_f32_16x16x32_bf16 v[220:223], v[228:231], v[100:103], v[220:223]
s_waitcnt lgkmcnt(2)
v_cvt_pk_bf16_f32 v161, v194, v195
v_mfma_f32_16x16x32_bf16 v[208:211], v[232:235], v[8:11], v[208:211]
ds_read_b128 v[224:227], v248 offset:47104
v_mfma_f32_16x16x32_bf16 v[208:211], v[236:239], v[12:15], v[208:211]
v_exp_f32 v197, v197
v_mfma_f32_16x16x32_bf16 v[212:215], v[232:235], v[40:43], v[212:215]
v_exp_f32 v198, v198
v_mfma_f32_16x16x32_bf16 v[212:215], v[236:239], v[44:47], v[212:215]
v_exp_f32 v199, v199
v_mfma_f32_16x16x32_bf16 v[216:219], v[232:235], v[72:75], v[216:219]
ds_read_b128 v[228:231], v248 offset:47616
v_cvt_pk_bf16_f32 v164, v196, v197
v_mfma_f32_16x16x32_bf16 v[216:219], v[236:239], v[76:79], v[216:219]
v_cvt_pk_bf16_f32 v165, v198, v199
v_mfma_f32_16x16x32_bf16 v[220:223], v[232:235], v[104:107], v[220:223]
v_exp_f32 v200, v200
v_mfma_f32_16x16x32_bf16 v[220:223], v[236:239], v[108:111], v[220:223]
s_waitcnt lgkmcnt(2)
s_waitcnt vmcnt(0)
s_barrier
v_mfma_f32_16x16x32_bf16 v[208:211], v[240:243], v[16:19], v[208:211]
ds_read_b128 v[232:235], v248 offset:49152
s_add_u32 s8, s6, 0x0
s_addc_u32 s9, s7, 0
v_mfma_f32_16x16x32_bf16 v[208:211], v[244:247], v[20:23], v[208:211]
v_exp_f32 v201, v201
s_mov_b32 s10, 0x4e2000
v_mfma_f32_16x16x32_bf16 v[212:215], v[240:243], v[48:51], v[212:215]
v_exp_f32 v202, v202
s_mov_b32 s11, 0x00020000
v_mfma_f32_16x16x32_bf16 v[212:215], v[244:247], v[52:55], v[212:215]
v_exp_f32 v203, v203
s_lshl_b32 s55, s34, 13
v_mfma_f32_16x16x32_bf16 v[216:219], v[240:243], v[80:83], v[216:219]
ds_read_b128 v[236:239], v248 offset:49664
v_cvt_pk_bf16_f32 v168, v200, v201
s_add_u32 s55, s55, 0x21000
v_mfma_f32_16x16x32_bf16 v[216:219], v[244:247], v[84:87], v[216:219]
v_cvt_pk_bf16_f32 v169, v202, v203
s_lshl_b32 s36, s34, 7
v_bfe_u32 v253, v252, 4, 3
v_mfma_f32_16x16x32_bf16 v[220:223], v[240:243], v[112:115], v[220:223]
v_exp_f32 v204, v204
v_lshrrev_b32 v254, 7, v252
v_mfma_f32_16x16x32_bf16 v[220:223], v[244:247], v[116:119], v[220:223]
s_waitcnt lgkmcnt(2)
v_xor_b32 v253, v253, v254
v_lshl_add_u32 v254, v254, 9, s36
v_mfma_f32_16x16x32_bf16 v[208:211], v[224:227], v[24:27], v[208:211]
ds_read_b128 v[240:243], v248 offset:53248
v_lshl_add_u32 v253, v253, 4, v254
s_add_u32 m0, s55, 0
v_mfma_f32_16x16x32_bf16 v[208:211], v[228:231], v[28:31], v[208:211]
v_exp_f32 v205, v205
s_add_u32 s35, s52, 0
v_mfma_f32_16x16x32_bf16 v[212:215], v[224:227], v[56:59], v[212:215]
v_exp_f32 v206, v206
buffer_load_dwordx4 v253, s[8:11], s35 offen lds
v_mfma_f32_16x16x32_bf16 v[212:215], v[228:231], v[60:63], v[212:215]
v_exp_f32 v207, v207
s_add_u32 m0, s55, 1024
v_mfma_f32_16x16x32_bf16 v[216:219], v[224:227], v[88:91], v[216:219]
ds_read_b128 v[244:247], v248 offset:53760
v_cvt_pk_bf16_f32 v172, v204, v205
s_add_u32 s35, s52, 4096
v_mfma_f32_16x16x32_bf16 v[216:219], v[228:231], v[92:95], v[216:219]
v_cvt_pk_bf16_f32 v173, v206, v207
buffer_load_dwordx4 v253, s[8:11], s35 offen lds
s_add_u32 m0, s55, 2048
v_mfma_f32_16x16x32_bf16 v[220:223], v[224:227], v[120:123], v[220:223]
s_add_u32 s35, s53, 0
buffer_load_dwordx4 v253, s[8:11], s35 offen lds
s_add_u32 m0, s55, 3072
v_mfma_f32_16x16x32_bf16 v[220:223], v[228:231], v[124:127], v[220:223]
s_waitcnt lgkmcnt(2)
s_add_u32 s35, s53, 4096
buffer_load_dwordx4 v253, s[8:11], s35 offen lds
v_mfma_f32_16x16x32_bf16 v[192:195], v[232:235], v[0:3], 0
ds_read_b128 v[224:227], v248 offset:57344
v_mfma_f32_16x16x32_bf16 v[192:195], v[236:239], v[4:7], v[192:195]
v_exp_f32 v208, v208
v_mfma_f32_16x16x32_bf16 v[196:199], v[232:235], v[32:35], 0
v_exp_f32 v209, v209
v_mfma_f32_16x16x32_bf16 v[196:199], v[236:239], v[36:39], v[196:199]
v_exp_f32 v210, v210
v_mfma_f32_16x16x32_bf16 v[200:203], v[232:235], v[64:67], 0
ds_read_b128 v[228:231], v248 offset:57856
v_cvt_pk_bf16_f32 v162, v208, v209
v_mfma_f32_16x16x32_bf16 v[200:203], v[236:239], v[68:71], v[200:203]
v_exp_f32 v211, v211
v_mfma_f32_16x16x32_bf16 v[204:207], v[232:235], v[96:99], 0
v_exp_f32 v212, v212
v_mfma_f32_16x16x32_bf16 v[204:207], v[236:239], v[100:103], v[204:207]
s_waitcnt lgkmcnt(2)
v_cvt_pk_bf16_f32 v163, v210, v211
v_mfma_f32_16x16x32_bf16 v[192:195], v[240:243], v[8:11], v[192:195]
ds_read_b128 v[232:235], v248 offset:61440
v_mfma_f32_16x16x32_bf16 v[192:195], v[244:247], v[12:15], v[192:195]
v_exp_f32 v213, v213
v_mfma_f32_16x16x32_bf16 v[196:199], v[240:243], v[40:43], v[196:199]
v_exp_f32 v214, v214
v_mfma_f32_16x16x32_bf16 v[196:199], v[244:247], v[44:47], v[196:199]
v_exp_f32 v215, v215
v_mfma_f32_16x16x32_bf16 v[200:203], v[240:243], v[72:75], v[200:203]
ds_read_b128 v[236:239], v248 offset:61952
v_cvt_pk_bf16_f32 v166, v212, v213
v_mfma_f32_16x16x32_bf16 v[200:203], v[244:247], v[76:79], v[200:203]
v_cvt_pk_bf16_f32 v167, v214, v215
v_mfma_f32_16x16x32_bf16 v[204:207], v[240:243], v[104:107], v[204:207]
v_exp_f32 v216, v216
v_mfma_f32_16x16x32_bf16 v[204:207], v[244:247], v[108:111], v[204:207]
s_waitcnt lgkmcnt(2)
v_mfma_f32_16x16x32_bf16 v[192:195], v[224:227], v[16:19], v[192:195]
ds_read_b128 v[240:243], v248 offset:51200
v_mfma_f32_16x16x32_bf16 v[192:195], v[228:231], v[20:23], v[192:195]
v_exp_f32 v217, v217
v_mfma_f32_16x16x32_bf16 v[196:199], v[224:227], v[48:51], v[196:199]
v_exp_f32 v218, v218
v_mfma_f32_16x16x32_bf16 v[196:199], v[228:231], v[52:55], v[196:199]
v_exp_f32 v219, v219
v_mfma_f32_16x16x32_bf16 v[200:203], v[224:227], v[80:83], v[200:203]
ds_read_b128 v[244:247], v248 offset:51712
v_cvt_pk_bf16_f32 v170, v216, v217
v_mfma_f32_16x16x32_bf16 v[200:203], v[228:231], v[84:87], v[200:203]
v_cvt_pk_bf16_f32 v171, v218, v219
v_mfma_f32_16x16x32_bf16 v[204:207], v[224:227], v[112:115], v[204:207]
v_exp_f32 v220, v220
v_mfma_f32_16x16x32_bf16 v[204:207], v[228:231], v[116:119], v[204:207]
s_waitcnt lgkmcnt(2)
v_mfma_f32_16x16x32_bf16 v[192:195], v[232:235], v[24:27], v[192:195]
ds_read_b128 v[224:227], v248 offset:55296
v_mfma_f32_16x16x32_bf16 v[192:195], v[236:239], v[28:31], v[192:195]
v_exp_f32 v221, v221
v_mfma_f32_16x16x32_bf16 v[196:199], v[232:235], v[56:59], v[196:199]
v_exp_f32 v222, v222
v_mfma_f32_16x16x32_bf16 v[196:199], v[236:239], v[60:63], v[196:199]
v_exp_f32 v223, v223
v_mfma_f32_16x16x32_bf16 v[200:203], v[232:235], v[88:91], v[200:203]
ds_read_b128 v[228:231], v248 offset:55808
v_cvt_pk_bf16_f32 v174, v220, v221
v_mfma_f32_16x16x32_bf16 v[200:203], v[236:239], v[92:95], v[200:203]
v_cvt_pk_bf16_f32 v175, v222, v223
v_mfma_f32_16x16x32_bf16 v[204:207], v[232:235], v[120:123], v[204:207]
v_mfma_f32_16x16x32_bf16 v[204:207], v[236:239], v[124:127], v[204:207]
s_waitcnt lgkmcnt(2)
v_mfma_f32_16x16x32_bf16 v[208:211], v[240:243], v[0:3], 0
ds_read_b128 v[232:235], v248 offset:59392
v_mfma_f32_16x16x32_bf16 v[208:211], v[244:247], v[4:7], v[208:211]
v_exp_f32 v192, v192
v_mfma_f32_16x16x32_bf16 v[212:215], v[240:243], v[32:35], 0
v_exp_f32 v193, v193
v_mfma_f32_16x16x32_bf16 v[212:215], v[244:247], v[36:39], v[212:215]
v_exp_f32 v194, v194
v_mfma_f32_16x16x32_bf16 v[216:219], v[240:243], v[64:67], 0
ds_read_b128 v[236:239], v248 offset:59904
v_cvt_pk_bf16_f32 v0, v192, v193
v_mfma_f32_16x16x32_bf16 v[216:219], v[244:247], v[68:71], v[216:219]
v_exp_f32 v195, v195
v_mfma_f32_16x16x32_bf16 v[220:223], v[240:243], v[96:99], 0
v_exp_f32 v196, v196
v_mfma_f32_16x16x32_bf16 v[220:223], v[244:247], v[100:103], v[220:223]
s_waitcnt lgkmcnt(2)
v_cvt_pk_bf16_f32 v1, v194, v195
v_mfma_f32_16x16x32_bf16 v[208:211], v[224:227], v[8:11], v[208:211]
ds_read_b128 v[240:243], v248 offset:63488
v_mfma_f32_16x16x32_bf16 v[208:211], v[228:231], v[12:15], v[208:211]
v_exp_f32 v197, v197
v_mfma_f32_16x16x32_bf16 v[212:215], v[224:227], v[40:43], v[212:215]
ds_read_b128 v[4:7], v255 offset:0
ds_read_b128 v[36:39], v255 offset:1024
v_mfma_f32_16x16x32_bf16 v[212:215], v[228:231], v[44:47], v[212:215]
v_exp_f32 v198, v198
v_mfma_f32_16x16x32_bf16 v[216:219], v[224:227], v[72:75], v[216:219]
ds_read_b128 v[244:247], v248 offset:64000
v_xor_b32 v12, 0x10000, v249
v_mfma_f32_16x16x32_bf16 v[216:219], v[228:231], v[76:79], v[216:219]
v_xor_b32 v13, 0x10000, v250
v_cvt_pk_bf16_f32 v32, v196, v197
v_mfma_f32_16x16x32_bf16 v[220:223], v[224:227], v[104:107], v[220:223]
ds_read_b128 v[68:71], v255 offset:2048
ds_read_b128 v[100:103], v255 offset:3072
v_mfma_f32_16x16x32_bf16 v[220:223], v[228:231], v[108:111], v[220:223]
s_waitcnt lgkmcnt(6)
v_mfma_f32_16x16x32_bf16 v[208:211], v[232:235], v[16:19], v[208:211]
ds_read_b64_tr_b16 v[224:225], v12 offset:0
ds_read_b64_tr_b16 v[226:227], v12 offset:2048
v_mfma_f32_16x16x32_bf16 v[208:211], v[236:239], v[20:23], v[208:211]
v_exp_f32 v199, v199
v_mfma_f32_16x16x32_bf16 v[212:215], v[232:235], v[48:51], v[212:215]
v_cvt_pk_bf16_f32 v33, v198, v199
v_mfma_f32_16x16x32_bf16 v[212:215], v[236:239], v[52:55], v[212:215]
v_exp_f32 v200, v200
v_mfma_f32_16x16x32_bf16 v[216:219], v[232:235], v[80:83], v[216:219]
ds_read_b64_tr_b16 v[228:229], v12 offset:16384
ds_read_b64_tr_b16 v[230:231], v12 offset:18432
v_mfma_f32_16x16x32_bf16 v[216:219], v[236:239], v[84:87], v[216:219]
v_exp_f32 v201, v201
v_mfma_f32_16x16x32_bf16 v[220:223], v[232:235], v[112:115], v[220:223]
v_exp_f32 v202, v202
v_mfma_f32_16x16x32_bf16 v[220:223], v[236:239], v[116:119], v[220:223]
s_waitcnt lgkmcnt(6)
v_cvt_pk_bf16_f32 v64, v200, v201
v_mfma_f32_16x16x32_bf16 v[208:211], v[240:243], v[24:27], v[208:211]
ds_read_b64_tr_b16 v[232:233], v13 offset:0
ds_read_b64_tr_b16 v[234:235], v13 offset:2048
v_mfma_f32_16x16x32_bf16 v[208:211], v[244:247], v[28:31], v[208:211]
v_exp_f32 v203, v203
v_mfma_f32_16x16x32_bf16 v[212:215], v[240:243], v[56:59], v[212:215]
v_cvt_pk_bf16_f32 v65, v202, v203
v_mfma_f32_16x16x32_bf16 v[212:215], v[244:247], v[60:63], v[212:215]
v_exp_f32 v204, v204
v_mfma_f32_16x16x32_bf16 v[216:219], v[240:243], v[88:91], v[216:219]
ds_read_b64_tr_b16 v[236:237], v13 offset:16384
ds_read_b64_tr_b16 v[238:239], v13 offset:18432
v_mfma_f32_16x16x32_bf16 v[216:219], v[244:247], v[92:95], v[216:219]
v_exp_f32 v205, v205
v_mfma_f32_16x16x32_bf16 v[220:223], v[240:243], v[120:123], v[220:223]
v_exp_f32 v206, v206
v_mfma_f32_16x16x32_bf16 v[220:223], v[244:247], v[124:127], v[220:223]
s_waitcnt lgkmcnt(4)
v_mfma_f32_16x16x32_bf16 a[0:3], v[224:227], v[128:131], a[0:3]
ds_read_b64_tr_b16 v[240:241], v249 offset:33280
ds_read_b64_tr_b16 v[242:243], v249 offset:35328
v_mfma_f32_16x16x32_bf16 a[0:3], v[228:231], v[144:147], a[0:3]
v_exp_f32 v207, v207
v_mfma_f32_16x16x32_bf16 a[4:7], v[224:227], v[132:135], a[4:7]
v_cvt_pk_bf16_f32 v96, v204, v205
v_cvt_pk_bf16_f32 v97, v206, v207
v_mfma_f32_16x16x32_bf16 a[4:7], v[228:231], v[148:151], a[4:7]
v_exp_f32 v208, v208
v_mfma_f32_16x16x32_bf16 a[8:11], v[224:227], v[136:139], a[8:11]
ds_read_b64_tr_b16 v[244:245], v249 offset:49664
ds_read_b64_tr_b16 v[246:247], v249 offset:51712
v_mfma_f32_16x16x32_bf16 a[8:11], v[228:231], v[152:155], a[8:11]
v_exp_f32 v209, v209
v_mfma_f32_16x16x32_bf16 a[12:15], v[224:227], v[140:143], a[12:15]
v_exp_f32 v210, v210
v_mfma_f32_16x16x32_bf16 a[12:15], v[228:231], v[156:159], a[12:15]
s_waitcnt lgkmcnt(4)
v_cvt_pk_bf16_f32 v2, v208, v209
v_mfma_f32_16x16x32_bf16 a[16:19], v[232:235], v[128:131], a[16:19]
ds_read_b64_tr_b16 v[224:225], v12 offset:512
ds_read_b64_tr_b16 v[226:227], v12 offset:2560
v_mfma_f32_16x16x32_bf16 a[16:19], v[236:239], v[144:147], a[16:19]
v_exp_f32 v211, v211
v_mfma_f32_16x16x32_bf16 a[20:23], v[232:235], v[132:135], a[20:23]
v_cvt_pk_bf16_f32 v3, v210, v211
v_mfma_f32_16x16x32_bf16 a[20:23], v[236:239], v[148:151], a[20:23]
v_exp_f32 v212, v212
v_mfma_f32_16x16x32_bf16 a[24:27], v[232:235], v[136:139], a[24:27]
ds_read_b64_tr_b16 v[228:229], v12 offset:16896
ds_read_b64_tr_b16 v[230:231], v12 offset:18944
v_mfma_f32_16x16x32_bf16 a[24:27], v[236:239], v[152:155], a[24:27]
v_exp_f32 v213, v213
v_mfma_f32_16x16x32_bf16 a[28:31], v[232:235], v[140:143], a[28:31]
v_exp_f32 v214, v214
v_mfma_f32_16x16x32_bf16 a[28:31], v[236:239], v[156:159], a[28:31]
s_waitcnt lgkmcnt(4)
v_cvt_pk_bf16_f32 v34, v212, v213
v_mfma_f32_16x16x32_bf16 a[32:35], v[240:243], v[4:7], a[32:35]
ds_read_b64_tr_b16 v[232:233], v250 offset:33280
ds_read_b64_tr_b16 v[234:235], v250 offset:35328
v_mfma_f32_16x16x32_bf16 a[32:35], v[244:247], v[176:179], a[32:35]
v_exp_f32 v215, v215
v_mfma_f32_16x16x32_bf16 a[36:39], v[240:243], v[36:39], a[36:39]
v_cvt_pk_bf16_f32 v35, v214, v215
v_mfma_f32_16x16x32_bf16 a[36:39], v[244:247], v[180:183], a[36:39]
v_exp_f32 v216, v216
v_mfma_f32_16x16x32_bf16 a[40:43], v[240:243], v[68:71], a[40:43]
ds_read_b64_tr_b16 v[236:237], v250 offset:49664
ds_read_b64_tr_b16 v[238:239], v250 offset:51712
v_mfma_f32_16x16x32_bf16 a[40:43], v[244:247], v[184:187], a[40:43]
v_exp_f32 v217, v217
v_mfma_f32_16x16x32_bf16 a[44:47], v[240:243], v[100:103], a[44:47]
v_exp_f32 v218, v218
v_mfma_f32_16x16x32_bf16 a[44:47], v[244:247], v[188:191], a[44:47]
s_waitcnt lgkmcnt(4)
v_cvt_pk_bf16_f32 v66, v216, v217
v_mfma_f32_16x16x32_bf16 a[32:35], v[224:227], v[128:131], a[32:35]
ds_read_b64_tr_b16 v[240:241], v12 offset:32768
ds_read_b64_tr_b16 v[242:243], v12 offset:34816
v_mfma_f32_16x16x32_bf16 a[32:35], v[228:231], v[144:147], a[32:35]
v_exp_f32 v219, v219
v_mfma_f32_16x16x32_bf16 a[36:39], v[224:227], v[132:135], a[36:39]
v_cvt_pk_bf16_f32 v67, v218, v219
v_mfma_f32_16x16x32_bf16 a[36:39], v[228:231], v[148:151], a[36:39]
v_exp_f32 v220, v220
v_mfma_f32_16x16x32_bf16 a[40:43], v[224:227], v[136:139], a[40:43]
ds_read_b64_tr_b16 v[244:245], v12 offset:49152
ds_read_b64_tr_b16 v[246:247], v12 offset:51200
v_mfma_f32_16x16x32_bf16 a[40:43], v[228:231], v[152:155], a[40:43]
v_exp_f32 v221, v221
v_mfma_f32_16x16x32_bf16 a[44:47], v[224:227], v[140:143], a[44:47]
v_exp_f32 v222, v222
v_mfma_f32_16x16x32_bf16 a[44:47], v[228:231], v[156:159], a[44:47]
s_waitcnt lgkmcnt(4)
v_cvt_pk_bf16_f32 v98, v220, v221
v_mfma_f32_16x16x32_bf16 a[48:51], v[232:235], v[4:7], a[48:51]
ds_read_b64_tr_b16 v[224:225], v13 offset:32768
ds_read_b64_tr_b16 v[226:227], v13 offset:34816
v_mfma_f32_16x16x32_bf16 a[48:51], v[236:239], v[176:179], a[48:51]
v_exp_f32 v223, v223
v_mfma_f32_16x16x32_bf16 a[52:55], v[232:235], v[36:39], a[52:55]
v_cvt_pk_bf16_f32 v99, v222, v223
v_mfma_f32_16x16x32_bf16 a[52:55], v[236:239], v[180:183], a[52:55]
v_mfma_f32_16x16x32_bf16 a[56:59], v[232:235], v[68:71], a[56:59]
ds_read_b64_tr_b16 v[228:229], v13 offset:49152
ds_read_b64_tr_b16 v[230:231], v13 offset:51200
v_mfma_f32_16x16x32_bf16 a[56:59], v[236:239], v[184:187], a[56:59]
v_mfma_f32_16x16x32_bf16 a[60:63], v[232:235], v[100:103], a[60:63]
v_mfma_f32_16x16x32_bf16 a[60:63], v[236:239], v[188:191], a[60:63]
s_waitcnt lgkmcnt(4)
v_mfma_f32_16x16x32_bf16 a[0:3], v[240:243], v[160:163], a[0:3]
ds_read_b64_tr_b16 v[232:233], v12 offset:33280
ds_read_b64_tr_b16 v[234:235], v12 offset:35328
v_mfma_f32_16x16x32_bf16 a[0:3], v[244:247], v[0:3], a[0:3]
v_mfma_f32_16x16x32_bf16 a[4:7], v[240:243], v[164:167], a[4:7]
v_mfma_f32_16x16x32_bf16 a[4:7], v[244:247], v[32:35], a[4:7]
v_mfma_f32_16x16x32_bf16 a[8:11], v[240:243], v[168:171], a[8:11]
ds_read_b64_tr_b16 v[236:237], v12 offset:49664
ds_read_b64_tr_b16 v[238:239], v12 offset:51712
v_mfma_f32_16x16x32_bf16 a[8:11], v[244:247], v[64:67], a[8:11]
v_mfma_f32_16x16x32_bf16 a[12:15], v[240:243], v[172:175], a[12:15]
v_mfma_f32_16x16x32_bf16 a[12:15], v[244:247], v[96:99], a[12:15]
s_waitcnt lgkmcnt(4)
v_mfma_f32_16x16x32_bf16 a[16:19], v[224:227], v[160:163], a[16:19]
ds_read_b64_tr_b16 v[240:241], v13 offset:512
ds_read_b64_tr_b16 v[242:243], v13 offset:2560
v_mfma_f32_16x16x32_bf16 a[16:19], v[228:231], v[0:3], a[16:19]
v_mfma_f32_16x16x32_bf16 a[20:23], v[224:227], v[164:167], a[20:23]
v_mfma_f32_16x16x32_bf16 a[20:23], v[228:231], v[32:35], a[20:23]
v_mfma_f32_16x16x32_bf16 a[24:27], v[224:227], v[168:171], a[24:27]
ds_read_b64_tr_b16 v[244:245], v13 offset:16896
ds_read_b64_tr_b16 v[246:247], v13 offset:18944
v_accvgpr_read_b32 v192, a0
v_mfma_f32_16x16x32_bf16 a[24:27], v[228:231], v[64:67], a[24:27]
v_accvgpr_read_b32 v193, a4
v_accvgpr_read_b32 v194, a8
v_accvgpr_read_b32 v195, a12
v_mfma_f32_16x16x32_bf16 a[28:31], v[224:227], v[172:175], a[28:31]
v_lshlrev_b32 v253, 2, v252
v_subrev_u32 v196, 0x0d800000, v192
v_subrev_u32 v197, 0x0d800000, v193
v_mfma_f32_16x16x32_bf16 a[28:31], v[228:231], v[96:99], a[28:31]
s_waitcnt lgkmcnt(4)
v_subrev_u32 v198, 0x0d800000, v194
v_subrev_u32 v199, 0x0d800000, v195
v_mfma_f32_16x16x32_bf16 a[32:35], v[232:235], v[160:163], a[32:35]
ds_read_b64_tr_b16 v[224:225], v13 offset:33280
ds_read_b64_tr_b16 v[226:227], v13 offset:35328
v_max3_u32 v254, v196, v197, v198
v_mfma_f32_16x16x32_bf16 a[32:35], v[236:239], v[0:3], a[32:35]
v_max_u32 v254, v254, v199
v_mfma_f32_16x16x32_bf16 a[36:39], v[232:235], v[164:167], a[36:39]
s_mov_b64 exec, 0xffff
s_xor_b32 s35, s48, 0
buffer_store_dword v192, v253, s[24:27], s35 offen offset:4 sc1
s_xor_b32 s35, s48, 1024
buffer_store_dword v193, v253, s[24:27], s35 offen offset:4 sc1
s_xor_b32 s35, s48, 2048
buffer_store_dword v194, v253, s[24:27], s35 offen offset:4 sc1
s_xor_b32 s35, s48, 3072
buffer_store_dword v195, v253, s[24:27], s35 offen offset:4 sc1
v_cmp_le_u32 vcc, 0x64000000, v254
s_mov_b64 exec, -1
v_mfma_f32_16x16x32_bf16 a[36:39], v[236:239], v[32:35], a[36:39]
v_accvgpr_read_b32 v192, a0
v_accvgpr_read_b32 v193, a1
v_mfma_f32_16x16x32_bf16 a[40:43], v[232:235], v[168:171], a[40:43]
ds_read_b64_tr_b16 v[228:229], v13 offset:49664
ds_read_b64_tr_b16 v[230:231], v13 offset:51712
v_mfma_f32_16x16x32_bf16 a[40:43], v[236:239], v[64:67], a[40:43]
v_accvgpr_read_b32 v194, a2
v_accvgpr_read_b32 v195, a3
v_mfma_f32_16x16x32_bf16 a[44:47], v[232:235], v[172:175], a[44:47]
v_cvt_pk_bf16_f32 v16, v192, v193
v_cvt_pk_bf16_f32 v17, v194, v195
v_mfma_f32_16x16x32_bf16 a[44:47], v[236:239], v[96:99], a[44:47]
s_waitcnt lgkmcnt(4)
v_accvgpr_read_b32 v200, a4
v_mfma_f32_16x16x32_bf16 a[48:51], v[240:243], v[128:131], a[48:51]
ds_read_b64_tr_b16 v[232:233], v249 offset:36864
ds_read_b64_tr_b16 v[234:235], v249 offset:38912
v_mfma_f32_16x16x32_bf16 a[48:51], v[244:247], v[144:147], a[48:51]
v_accvgpr_read_b32 v201, a5
v_accvgpr_read_b32 v202, a6
v_mfma_f32_16x16x32_bf16 a[52:55], v[240:243], v[132:135], a[52:55]
v_accvgpr_read_b32 v203, a7
v_cvt_pk_bf16_f32 v48, v200, v201
v_mfma_f32_16x16x32_bf16 a[52:55], v[244:247], v[148:151], a[52:55]
v_cvt_pk_bf16_f32 v49, v202, v203
v_accvgpr_read_b32 v208, a8
v_mfma_f32_16x16x32_bf16 a[56:59], v[240:243], v[136:139], a[56:59]
ds_read_b64_tr_b16 v[236:237], v249 offset:53248
ds_read_b64_tr_b16 v[238:239], v249 offset:55296
v_mfma_f32_16x16x32_bf16 a[56:59], v[244:247], v[152:155], a[56:59]
v_accvgpr_read_b32 v209, a9
v_accvgpr_read_b32 v210, a10
v_mfma_f32_16x16x32_bf16 a[60:63], v[240:243], v[140:143], a[60:63]
v_accvgpr_read_b32 v211, a11
v_cvt_pk_bf16_f32 v80, v208, v209
v_mfma_f32_16x16x32_bf16 a[60:63], v[244:247], v[156:159], a[60:63]
s_waitcnt lgkmcnt(4)
v_cvt_pk_bf16_f32 v81, v210, v211
v_mfma_f32_16x16x32_bf16 a[48:51], v[224:227], v[160:163], a[48:51]
ds_read_b64_tr_b16 v[240:241], v12 offset:4096
ds_read_b64_tr_b16 v[242:243], v12 offset:6144
v_mfma_f32_16x16x32_bf16 a[48:51], v[228:231], v[0:3], a[48:51]
v_accvgpr_read_b32 v216, a12
v_accvgpr_read_b32 v217, a13
v_mfma_f32_16x16x32_bf16 a[52:55], v[224:227], v[164:167], a[52:55]
v_accvgpr_read_b32 v218, a14
v_accvgpr_read_b32 v219, a15
v_mfma_f32_16x16x32_bf16 a[52:55], v[228:231], v[32:35], a[52:55]
v_cvt_pk_bf16_f32 v112, v216, v217
v_cvt_pk_bf16_f32 v113, v218, v219
v_mfma_f32_16x16x32_bf16 a[56:59], v[224:227], v[168:171], a[56:59]
ds_read_b64_tr_b16 v[244:245], v12 offset:20480
ds_read_b64_tr_b16 v[246:247], v12 offset:22528
v_mfma_f32_16x16x32_bf16 a[56:59], v[228:231], v[64:67], a[56:59]
v_accvgpr_read_b32 v196, a16
v_accvgpr_read_b32 v197, a17
v_mfma_f32_16x16x32_bf16 a[60:63], v[224:227], v[172:175], a[60:63]
v_accvgpr_read_b32 v198, a18
v_accvgpr_read_b32 v199, a19
v_mfma_f32_16x16x32_bf16 a[60:63], v[228:231], v[96:99], a[60:63]
s_waitcnt lgkmcnt(4)
v_cvt_pk_bf16_f32 v18, v196, v197
v_mfma_f32_16x16x32_bf16 a[64:67], v[232:235], v[4:7], a[64:67]
ds_read_b64_tr_b16 v[224:225], v12 offset:36864
ds_read_b64_tr_b16 v[226:227], v12 offset:38912
v_mfma_f32_16x16x32_bf16 a[64:67], v[236:239], v[176:179], a[64:67]
v_cvt_pk_bf16_f32 v19, v198, v199
buffer_store_dwordx4 v[16:19], v252, s[20:23], s40 offen offset:0 sc1
v_mfma_f32_16x16x32_bf16 a[68:71], v[232:235], v[36:39], a[68:71]
ds_write_b128 v255, v[16:19] offset:0
v_accvgpr_read_b32 v204, a20
v_mfma_f32_16x16x32_bf16 a[68:71], v[236:239], v[180:183], a[68:71]
v_accvgpr_read_b32 v205, a21
v_accvgpr_read_b32 v206, a22
v_mfma_f32_16x16x32_bf16 a[72:75], v[232:235], v[68:71], a[72:75]
ds_read_b64_tr_b16 v[228:229], v12 offset:53248
ds_read_b64_tr_b16 v[230:231], v12 offset:55296
v_mfma_f32_16x16x32_bf16 a[72:75], v[236:239], v[184:187], a[72:75]
v_accvgpr_read_b32 v207, a23
v_cvt_pk_bf16_f32 v50, v204, v205
v_mfma_f32_16x16x32_bf16 a[76:79], v[232:235], v[100:103], a[76:79]
v_cvt_pk_bf16_f32 v51, v206, v207
buffer_store_dwordx4 v[48:51], v252, s[20:23], s41 offen offset:0 sc1
v_mfma_f32_16x16x32_bf16 a[76:79], v[236:239], v[188:191], a[76:79]
s_waitcnt lgkmcnt(5)
v_accvgpr_read_b32 v212, a24
v_mfma_f32_16x16x32_bf16 a[64:67], v[240:243], v[128:131], a[64:67]
ds_read_b64_tr_b16 v[232:233], v250 offset:36864
ds_read_b64_tr_b16 v[234:235], v250 offset:38912
v_mfma_f32_16x16x32_bf16 a[64:67], v[244:247], v[144:147], a[64:67]
v_accvgpr_read_b32 v213, a25
v_accvgpr_read_b32 v214, a26
v_mfma_f32_16x16x32_bf16 a[68:71], v[240:243], v[132:135], a[68:71]
v_accvgpr_read_b32 v215, a27
v_cvt_pk_bf16_f32 v82, v212, v213
v_mfma_f32_16x16x32_bf16 a[68:71], v[244:247], v[148:151], a[68:71]
v_cvt_pk_bf16_f32 v83, v214, v215
buffer_store_dwordx4 v[80:83], v252, s[20:23], s42 offen offset:0 sc1
v_mfma_f32_16x16x32_bf16 a[72:75], v[240:243], v[136:139], a[72:75]
ds_read_b64_tr_b16 v[236:237], v250 offset:53248
ds_read_b64_tr_b16 v[238:239], v250 offset:55296
v_mfma_f32_16x16x32_bf16 a[72:75], v[244:247], v[152:155], a[72:75]
v_accvgpr_read_b32 v220, a28
v_accvgpr_read_b32 v221, a29
v_mfma_f32_16x16x32_bf16 a[76:79], v[240:243], v[140:143], a[76:79]
v_accvgpr_read_b32 v222, a30
v_accvgpr_read_b32 v223, a31
v_mfma_f32_16x16x32_bf16 a[76:79], v[244:247], v[156:159], a[76:79]
s_waitcnt lgkmcnt(4)
v_cvt_pk_bf16_f32 v114, v220, v221
v_mfma_f32_16x16x32_bf16 a[64:67], v[224:227], v[160:163], a[64:67]
ds_read_b64_tr_b16 v[240:241], v13 offset:4096
ds_read_b64_tr_b16 v[242:243], v13 offset:6144
v_mfma_f32_16x16x32_bf16 a[64:67], v[228:231], v[0:3], a[64:67]
v_cvt_pk_bf16_f32 v115, v222, v223
buffer_store_dwordx4 v[112:115], v252, s[20:23], s43 offen offset:0 sc1
v_mfma_f32_16x16x32_bf16 a[68:71], v[224:227], v[164:167], a[68:71]
v_accvgpr_read_b32 v192, a32
v_accvgpr_read_b32 v193, a33
v_mfma_f32_16x16x32_bf16 a[68:71], v[228:231], v[32:35], a[68:71]
v_accvgpr_read_b32 v194, a34
v_accvgpr_read_b32 v195, a35
v_mfma_f32_16x16x32_bf16 a[72:75], v[224:227], v[168:171], a[72:75]
ds_read_b64_tr_b16 v[244:245], v13 offset:20480
ds_read_b64_tr_b16 v[246:247], v13 offset:22528
v_mfma_f32_16x16x32_bf16 a[72:75], v[228:231], v[64:67], a[72:75]
v_cvt_pk_bf16_f32 v20, v192, v193
v_cvt_pk_bf16_f32 v21, v194, v195
v_mfma_f32_16x16x32_bf16 a[76:79], v[224:227], v[172:175], a[76:79]
v_accvgpr_read_b32 v200, a36
v_accvgpr_read_b32 v201, a37
v_mfma_f32_16x16x32_bf16 a[76:79], v[228:231], v[96:99], a[76:79]
s_waitcnt lgkmcnt(4)
v_accvgpr_read_b32 v202, a38
v_mfma_f32_16x16x32_bf16 a[80:83], v[232:235], v[4:7], a[80:83]
ds_read_b64_tr_b16 v[224:225], v13 offset:36864
ds_read_b64_tr_b16 v[226:227], v13 offset:38912
v_mfma_f32_16x16x32_bf16 a[80:83], v[236:239], v[176:179], a[80:83]
v_accvgpr_read_b32 v203, a39
v_cvt_pk_bf16_f32 v52, v200, v201
v_mfma_f32_16x16x32_bf16 a[84:87], v[232:235], v[36:39], a[84:87]
v_cvt_pk_bf16_f32 v53, v202, v203
v_accvgpr_read_b32 v208, a40
v_mfma_f32_16x16x32_bf16 a[84:87], v[236:239], v[180:183], a[84:87]
v_accvgpr_read_b32 v209, a41
v_accvgpr_read_b32 v210, a42
v_mfma_f32_16x16x32_bf16 a[88:91], v[232:235], v[68:71], a[88:91]
ds_read_b64_tr_b16 v[228:229], v13 offset:53248
ds_read_b64_tr_b16 v[230:231], v13 offset:55296
v_mfma_f32_16x16x32_bf16 a[88:91], v[236:239], v[184:187], a[88:91]
v_accvgpr_read_b32 v211, a43
v_cvt_pk_bf16_f32 v84, v208, v209
v_mfma_f32_16x16x32_bf16 a[92:95], v[232:235], v[100:103], a[92:95]
v_cvt_pk_bf16_f32 v85, v210, v211
v_accvgpr_read_b32 v216, a44
v_mfma_f32_16x16x32_bf16 a[92:95], v[236:239], v[188:191], a[92:95]
s_waitcnt lgkmcnt(4)
v_accvgpr_read_b32 v217, a45
v_mfma_f32_16x16x32_bf16 a[80:83], v[240:243], v[128:131], a[80:83]
ds_read_b64_tr_b16 v[232:233], v249 offset:37376
ds_read_b64_tr_b16 v[234:235], v249 offset:39424
v_mfma_f32_16x16x32_bf16 a[80:83], v[244:247], v[144:147], a[80:83]
v_accvgpr_read_b32 v218, a46
v_accvgpr_read_b32 v219, a47
v_mfma_f32_16x16x32_bf16 a[84:87], v[240:243], v[132:135], a[84:87]
v_cvt_pk_bf16_f32 v116, v216, v217
v_cvt_pk_bf16_f32 v117, v218, v219
v_mfma_f32_16x16x32_bf16 a[84:87], v[244:247], v[148:151], a[84:87]
v_accvgpr_read_b32 v196, a48
v_accvgpr_read_b32 v197, a49
v_mfma_f32_16x16x32_bf16 a[88:91], v[240:243], v[136:139], a[88:91]
ds_read_b64_tr_b16 v[236:237], v249 offset:53760
ds_read_b64_tr_b16 v[238:239], v249 offset:55808
v_mfma_f32_16x16x32_bf16 a[88:91], v[244:247], v[152:155], a[88:91]
v_accvgpr_read_b32 v198, a50
v_accvgpr_read_b32 v199, a51
v_mfma_f32_16x16x32_bf16 a[92:95], v[240:243], v[140:143], a[92:95]
v_cvt_pk_bf16_f32 v22, v196, v197
v_cvt_pk_bf16_f32 v23, v198, v199
v_mfma_f32_16x16x32_bf16 a[92:95], v[244:247], v[156:159], a[92:95]
s_waitcnt lgkmcnt(4)
buffer_store_dwordx4 v[20:23], v252, s[20:23], s40 offen offset:1024 sc1
v_mfma_f32_16x16x32_bf16 a[80:83], v[224:227], v[160:163], a[80:83]
ds_read_b64_tr_b16 v[240:241], v12 offset:4608
ds_read_b64_tr_b16 v[242:243], v12 offset:6656
v_mfma_f32_16x16x32_bf16 a[80:83], v[228:231], v[0:3], a[80:83]
ds_write_b128 v255, v[20:23] offset:1024
v_accvgpr_read_b32 v204, a52
v_mfma_f32_16x16x32_bf16 a[84:87], v[224:227], v[164:167], a[84:87]
v_accvgpr_read_b32 v205, a53
v_accvgpr_read_b32 v206, a54
v_mfma_f32_16x16x32_bf16 a[84:87], v[228:231], v[32:35], a[84:87]
v_accvgpr_read_b32 v207, a55
v_cvt_pk_bf16_f32 v54, v204, v205
v_mfma_f32_16x16x32_bf16 a[88:91], v[224:227], v[168:171], a[88:91]
ds_read_b64_tr_b16 v[244:245], v12 offset:20992
ds_read_b64_tr_b16 v[246:247], v12 offset:23040
v_mfma_f32_16x16x32_bf16 a[88:91], v[228:231], v[64:67], a[88:91]
v_cvt_pk_bf16_f32 v55, v206, v207
buffer_store_dwordx4 v[52:55], v252, s[20:23], s41 offen offset:1024 sc1
v_mfma_f32_16x16x32_bf16 a[92:95], v[224:227], v[172:175], a[92:95]
v_accvgpr_read_b32 v212, a56
v_accvgpr_read_b32 v213, a57
v_mfma_f32_16x16x32_bf16 a[92:95], v[228:231], v[96:99], a[92:95]
s_waitcnt lgkmcnt(5)
v_accvgpr_read_b32 v214, a58
v_mfma_f32_16x16x32_bf16 a[96:99], v[232:235], v[4:7], a[96:99]
ds_read_b64_tr_b16 v[224:225], v12 offset:37376
ds_read_b64_tr_b16 v[226:227], v12 offset:39424
v_mfma_f32_16x16x32_bf16 a[96:99], v[236:239], v[176:179], a[96:99]
v_accvgpr_read_b32 v215, a59
v_cvt_pk_bf16_f32 v86, v212, v213
v_mfma_f32_16x16x32_bf16 a[100:103], v[232:235], v[36:39], a[100:103]
v_cvt_pk_bf16_f32 v87, v214, v215
buffer_store_dwordx4 v[84:87], v252, s[20:23], s42 offen offset:1024 sc1
v_mfma_f32_16x16x32_bf16 a[100:103], v[236:239], v[180:183], a[100:103]
v_accvgpr_read_b32 v220, a60
v_accvgpr_read_b32 v221, a61
v_mfma_f32_16x16x32_bf16 a[104:107], v[232:235], v[68:71], a[104:107]
ds_read_b64_tr_b16 v[228:229], v12 offset:53760
ds_read_b64_tr_b16 v[230:231], v12 offset:55808
v_mfma_f32_16x16x32_bf16 a[104:107], v[236:239], v[184:187], a[104:107]
v_accvgpr_read_b32 v222, a62
v_accvgpr_read_b32 v223, a63
v_mfma_f32_16x16x32_bf16 a[108:111], v[232:235], v[100:103], a[108:111]
v_cvt_pk_bf16_f32 v118, v220, v221
v_cvt_pk_bf16_f32 v119, v222, v223
v_mfma_f32_16x16x32_bf16 a[108:111], v[236:239], v[188:191], a[108:111]
s_waitcnt lgkmcnt(4)
buffer_store_dwordx4 v[116:119], v252, s[20:23], s43 offen offset:1024 sc1
v_mfma_f32_16x16x32_bf16 a[96:99], v[240:243], v[128:131], a[96:99]
ds_read_b64_tr_b16 v[232:233], v250 offset:37376
ds_read_b64_tr_b16 v[234:235], v250 offset:39424
v_mfma_f32_16x16x32_bf16 a[96:99], v[244:247], v[144:147], a[96:99]
v_accvgpr_read_b32 v192, a64
v_accvgpr_read_b32 v193, a65
v_mfma_f32_16x16x32_bf16 a[100:103], v[240:243], v[132:135], a[100:103]
v_accvgpr_read_b32 v194, a66
v_accvgpr_read_b32 v195, a67
v_mfma_f32_16x16x32_bf16 a[100:103], v[244:247], v[148:151], a[100:103]
v_cvt_pk_bf16_f32 v24, v192, v193
v_cvt_pk_bf16_f32 v25, v194, v195
v_mfma_f32_16x16x32_bf16 a[104:107], v[240:243], v[136:139], a[104:107]
ds_read_b64_tr_b16 v[236:237], v250 offset:53760
ds_read_b64_tr_b16 v[238:239], v250 offset:55808
v_mfma_f32_16x16x32_bf16 a[104:107], v[244:247], v[152:155], a[104:107]
v_accvgpr_read_b32 v200, a68
v_accvgpr_read_b32 v201, a69
v_mfma_f32_16x16x32_bf16 a[108:111], v[240:243], v[140:143], a[108:111]
v_accvgpr_read_b32 v202, a70
v_accvgpr_read_b32 v203, a71
v_mfma_f32_16x16x32_bf16 a[108:111], v[244:247], v[156:159], a[108:111]
s_waitcnt lgkmcnt(4)
v_cvt_pk_bf16_f32 v56, v200, v201
v_mfma_f32_16x16x32_bf16 a[96:99], v[224:227], v[160:163], a[96:99]
ds_read_b64_tr_b16 v[240:241], v13 offset:4608
ds_read_b64_tr_b16 v[242:243], v13 offset:6656
v_mfma_f32_16x16x32_bf16 a[96:99], v[228:231], v[0:3], a[96:99]
v_cvt_pk_bf16_f32 v57, v202, v203
v_accvgpr_read_b32 v208, a72
v_mfma_f32_16x16x32_bf16 a[100:103], v[224:227], v[164:167], a[100:103]
v_accvgpr_read_b32 v209, a73
v_accvgpr_read_b32 v210, a74
v_mfma_f32_16x16x32_bf16 a[100:103], v[228:231], v[32:35], a[100:103]
v_accvgpr_read_b32 v211, a75
v_cvt_pk_bf16_f32 v88, v208, v209
v_mfma_f32_16x16x32_bf16 a[104:107], v[224:227], v[168:171], a[104:107]
ds_read_b64_tr_b16 v[244:245], v13 offset:20992
ds_read_b64_tr_b16 v[246:247], v13 offset:23040
v_mfma_f32_16x16x32_bf16 a[104:107], v[228:231], v[64:67], a[104:107]
v_cvt_pk_bf16_f32 v89, v210, v211
v_accvgpr_read_b32 v216, a76
v_mfma_f32_16x16x32_bf16 a[108:111], v[224:227], v[172:175], a[108:111]
v_accvgpr_read_b32 v217, a77
v_accvgpr_read_b32 v218, a78
v_mfma_f32_16x16x32_bf16 a[108:111], v[228:231], v[96:99], a[108:111]
s_waitcnt lgkmcnt(4)
v_accvgpr_read_b32 v219, a79
v_mfma_f32_16x16x32_bf16 a[112:115], v[232:235], v[4:7], a[112:115]
ds_read_b64_tr_b16 v[224:225], v13 offset:37376
ds_read_b64_tr_b16 v[226:227], v13 offset:39424
v_mfma_f32_16x16x32_bf16 a[112:115], v[236:239], v[176:179], a[112:115]
v_cvt_pk_bf16_f32 v120, v216, v217
v_cvt_pk_bf16_f32 v121, v218, v219
v_mfma_f32_16x16x32_bf16 a[116:119], v[232:235], v[36:39], a[116:119]
v_accvgpr_read_b32 v196, a80
v_accvgpr_read_b32 v197, a81
v_mfma_f32_16x16x32_bf16 a[116:119], v[236:239], v[180:183], a[116:119]
v_accvgpr_read_b32 v198, a82
v_accvgpr_read_b32 v199, a83
v_mfma_f32_16x16x32_bf16 a[120:123], v[232:235], v[68:71], a[120:123]
ds_read_b64_tr_b16 v[228:229], v13 offset:53760
ds_read_b64_tr_b16 v[230:231], v13 offset:55808
v_mfma_f32_16x16x32_bf16 a[120:123], v[236:239], v[184:187], a[120:123]
v_cvt_pk_bf16_f32 v26, v196, v197
v_cvt_pk_bf16_f32 v27, v198, v199
v_mfma_f32_16x16x32_bf16 a[124:127], v[232:235], v[100:103], a[124:127]
buffer_store_dwordx4 v[24:27], v252, s[20:23], s40 offen offset:2048 sc1
ds_write_b128 v255, v[24:27] offset:2048
v_mfma_f32_16x16x32_bf16 a[124:127], v[236:239], v[188:191], a[124:127]
s_waitcnt lgkmcnt(5)
v_accvgpr_read_b32 v204, a84
v_mfma_f32_16x16x32_bf16 a[112:115], v[240:243], v[128:131], a[112:115]
ds_read_b64_tr_b16 v[232:233], v249 offset:40960
ds_read_b64_tr_b16 v[234:235], v249 offset:43008
v_mfma_f32_16x16x32_bf16 a[112:115], v[244:247], v[144:147], a[112:115]
v_accvgpr_read_b32 v205, a85
v_accvgpr_read_b32 v206, a86
v_mfma_f32_16x16x32_bf16 a[116:119], v[240:243], v[132:135], a[116:119]
v_accvgpr_read_b32 v207, a87
v_cvt_pk_bf16_f32 v58, v204, v205
v_mfma_f32_16x16x32_bf16 a[116:119], v[244:247], v[148:151], a[116:119]
v_cvt_pk_bf16_f32 v59, v206, v207
buffer_store_dwordx4 v[56:59], v252, s[20:23], s41 offen offset:2048 sc1
v_mfma_f32_16x16x32_bf16 a[120:123], v[240:243], v[136:139], a[120:123]
ds_read_b64_tr_b16 v[236:237], v249 offset:57344
ds_read_b64_tr_b16 v[238:239], v249 offset:59392
v_mfma_f32_16x16x32_bf16 a[120:123], v[244:247], v[152:155], a[120:123]
v_accvgpr_read_b32 v212, a88
v_accvgpr_read_b32 v213, a89
v_mfma_f32_16x16x32_bf16 a[124:127], v[240:243], v[140:143], a[124:127]
v_accvgpr_read_b32 v214, a90
v_accvgpr_read_b32 v215, a91
v_mfma_f32_16x16x32_bf16 a[124:127], v[244:247], v[156:159], a[124:127]
s_waitcnt lgkmcnt(5)
v_cvt_pk_bf16_f32 v90, v212, v213
v_mfma_f32_16x16x32_bf16 a[112:115], v[224:227], v[160:163], a[112:115]
ds_read_b64_tr_b16 v[240:241], v12 offset:8192
ds_read_b64_tr_b16 v[242:243], v12 offset:10240
v_mfma_f32_16x16x32_bf16 a[112:115], v[228:231], v[0:3], a[112:115]
v_cvt_pk_bf16_f32 v91, v214, v215
buffer_store_dwordx4 v[88:91], v252, s[20:23], s42 offen offset:2048 sc1
v_mfma_f32_16x16x32_bf16 a[116:119], v[224:227], v[164:167], a[116:119]
v_accvgpr_read_b32 v220, a92
v_accvgpr_read_b32 v221, a93
v_mfma_f32_16x16x32_bf16 a[116:119], v[228:231], v[32:35], a[116:119]
v_accvgpr_read_b32 v222, a94
v_accvgpr_read_b32 v223, a95
v_mfma_f32_16x16x32_bf16 a[120:123], v[224:227], v[168:171], a[120:123]
ds_read_b64_tr_b16 v[244:245], v12 offset:24576
ds_read_b64_tr_b16 v[246:247], v12 offset:26624
v_mfma_f32_16x16x32_bf16 a[120:123], v[228:231], v[64:67], a[120:123]
v_cvt_pk_bf16_f32 v122, v220, v221
v_cvt_pk_bf16_f32 v123, v222, v223
v_mfma_f32_16x16x32_bf16 a[124:127], v[224:227], v[172:175], a[124:127]
buffer_store_dwordx4 v[120:123], v252, s[20:23], s43 offen offset:2048 sc1
v_accvgpr_read_b32 v192, a96
v_mfma_f32_16x16x32_bf16 a[124:127], v[228:231], v[96:99], a[124:127]
s_waitcnt lgkmcnt(4)
v_accvgpr_read_b32 v193, a97
v_mfma_f32_16x16x32_bf16 a[128:131], v[232:235], v[4:7], a[128:131]
ds_read_b64_tr_b16 v[224:225], v12 offset:40960
ds_read_b64_tr_b16 v[226:227], v12 offset:43008
v_mfma_f32_16x16x32_bf16 a[128:131], v[236:239], v[176:179], a[128:131]
v_accvgpr_read_b32 v194, a98
v_accvgpr_read_b32 v195, a99
v_mfma_f32_16x16x32_bf16 a[132:135], v[232:235], v[36:39], a[132:135]
v_cvt_pk_bf16_f32 v28, v192, v193
v_cvt_pk_bf16_f32 v29, v194, v195
v_mfma_f32_16x16x32_bf16 a[132:135], v[236:239], v[180:183], a[132:135]
v_accvgpr_read_b32 v200, a100
v_accvgpr_read_b32 v201, a101
v_mfma_f32_16x16x32_bf16 a[136:139], v[232:235], v[68:71], a[136:139]
ds_read_b64_tr_b16 v[228:229], v12 offset:57344
ds_read_b64_tr_b16 v[230:231], v12 offset:59392
v_mfma_f32_16x16x32_bf16 a[136:139], v[236:239], v[184:187], a[136:139]
v_accvgpr_read_b32 v202, a102
v_accvgpr_read_b32 v203, a103
v_mfma_f32_16x16x32_bf16 a[140:143], v[232:235], v[100:103], a[140:143]
v_cvt_pk_bf16_f32 v60, v200, v201
v_cvt_pk_bf16_f32 v61, v202, v203
v_mfma_f32_16x16x32_bf16 a[140:143], v[236:239], v[188:191], a[140:143]
s_waitcnt lgkmcnt(4)
v_accvgpr_read_b32 v208, a104
v_mfma_f32_16x16x32_bf16 a[128:131], v[240:243], v[128:131], a[128:131]
ds_read_b64_tr_b16 v[232:233], v250 offset:40960
ds_read_b64_tr_b16 v[234:235], v250 offset:43008
v_mfma_f32_16x16x32_bf16 a[128:131], v[244:247], v[144:147], a[128:131]
v_accvgpr_read_b32 v209, a105
v_accvgpr_read_b32 v210, a106
v_mfma_f32_16x16x32_bf16 a[132:135], v[240:243], v[132:135], a[132:135]
v_accvgpr_read_b32 v211, a107
v_cvt_pk_bf16_f32 v92, v208, v209
v_mfma_f32_16x16x32_bf16 a[132:135], v[244:247], v[148:151], a[132:135]
v_cvt_pk_bf16_f32 v93, v210, v211
v_accvgpr_read_b32 v216, a108
v_mfma_f32_16x16x32_bf16 a[136:139], v[240:243], v[136:139], a[136:139]
ds_read_b64_tr_b16 v[236:237], v250 offset:57344
ds_read_b64_tr_b16 v[238:239], v250 offset:59392
v_mfma_f32_16x16x32_bf16 a[136:139], v[244:247], v[152:155], a[136:139]
v_accvgpr_read_b32 v217, a109
v_accvgpr_read_b32 v218, a110
v_mfma_f32_16x16x32_bf16 a[140:143], v[240:243], v[140:143], a[140:143]
v_accvgpr_read_b32 v219, a111
v_cvt_pk_bf16_f32 v124, v216, v217
v_mfma_f32_16x16x32_bf16 a[140:143], v[244:247], v[156:159], a[140:143]
s_waitcnt lgkmcnt(4)
v_cvt_pk_bf16_f32 v125, v218, v219
v_mfma_f32_16x16x32_bf16 a[128:131], v[224:227], v[160:163], a[128:131]
ds_read_b64_tr_b16 v[240:241], v13 offset:8192
ds_read_b64_tr_b16 v[242:243], v13 offset:10240
v_mfma_f32_16x16x32_bf16 a[128:131], v[228:231], v[0:3], a[128:131]
v_accvgpr_read_b32 v196, a112
v_accvgpr_read_b32 v197, a113
v_mfma_f32_16x16x32_bf16 a[132:135], v[224:227], v[164:167], a[132:135]
v_accvgpr_read_b32 v198, a114
v_accvgpr_read_b32 v199, a115
v_mfma_f32_16x16x32_bf16 a[132:135], v[228:231], v[32:35], a[132:135]
v_cvt_pk_bf16_f32 v30, v196, v197
v_cvt_pk_bf16_f32 v31, v198, v199
v_mfma_f32_16x16x32_bf16 a[136:139], v[224:227], v[168:171], a[136:139]
ds_read_b64_tr_b16 v[244:245], v13 offset:24576
ds_read_b64_tr_b16 v[246:247], v13 offset:26624
v_mfma_f32_16x16x32_bf16 a[136:139], v[228:231], v[64:67], a[136:139]
buffer_store_dwordx4 v[28:31], v252, s[20:23], s40 offen offset:3072 sc1
ds_write_b128 v255, v[28:31] offset:3072
v_mfma_f32_16x16x32_bf16 a[140:143], v[224:227], v[172:175], a[140:143]
v_accvgpr_read_b32 v204, a116
v_accvgpr_read_b32 v205, a117
v_mfma_f32_16x16x32_bf16 a[140:143], v[228:231], v[96:99], a[140:143]
s_waitcnt lgkmcnt(5)
v_accvgpr_read_b32 v206, a118
v_mfma_f32_16x16x32_bf16 a[144:147], v[232:235], v[4:7], a[144:147]
ds_read_b64_tr_b16 v[224:225], v13 offset:40960
ds_read_b64_tr_b16 v[226:227], v13 offset:43008
v_mfma_f32_16x16x32_bf16 a[144:147], v[236:239], v[176:179], a[144:147]
v_accvgpr_read_b32 v207, a119
v_cvt_pk_bf16_f32 v62, v204, v205
v_mfma_f32_16x16x32_bf16 a[148:151], v[232:235], v[36:39], a[148:151]
v_cvt_pk_bf16_f32 v63, v206, v207
buffer_store_dwordx4 v[60:63], v252, s[20:23], s41 offen offset:3072 sc1
v_mfma_f32_16x16x32_bf16 a[148:151], v[236:239], v[180:183], a[148:151]
v_accvgpr_read_b32 v212, a120
v_accvgpr_read_b32 v213, a121
v_mfma_f32_16x16x32_bf16 a[152:155], v[232:235], v[68:71], a[152:155]
ds_read_b64_tr_b16 v[228:229], v13 offset:57344
ds_read_b64_tr_b16 v[230:231], v13 offset:59392
v_mfma_f32_16x16x32_bf16 a[152:155], v[236:239], v[184:187], a[152:155]
v_accvgpr_read_b32 v214, a122
v_accvgpr_read_b32 v215, a123
v_mfma_f32_16x16x32_bf16 a[156:159], v[232:235], v[100:103], a[156:159]
v_cvt_pk_bf16_f32 v94, v212, v213
v_cvt_pk_bf16_f32 v95, v214, v215
v_mfma_f32_16x16x32_bf16 a[156:159], v[236:239], v[188:191], a[156:159]
s_waitcnt lgkmcnt(5)
buffer_store_dwordx4 v[92:95], v252, s[20:23], s42 offen offset:3072 sc1
v_mfma_f32_16x16x32_bf16 a[144:147], v[240:243], v[128:131], a[144:147]
ds_read_b64_tr_b16 v[232:233], v249 offset:41472
ds_read_b64_tr_b16 v[234:235], v249 offset:43520
v_mfma_f32_16x16x32_bf16 a[144:147], v[244:247], v[144:147], a[144:147]
v_accvgpr_read_b32 v220, a124
v_accvgpr_read_b32 v221, a125
v_mfma_f32_16x16x32_bf16 a[148:151], v[240:243], v[132:135], a[148:151]
v_accvgpr_read_b32 v222, a126
v_accvgpr_read_b32 v223, a127
v_mfma_f32_16x16x32_bf16 a[148:151], v[244:247], v[148:151], a[148:151]
v_cvt_pk_bf16_f32 v126, v220, v221
v_cvt_pk_bf16_f32 v127, v222, v223
v_mfma_f32_16x16x32_bf16 a[152:155], v[240:243], v[136:139], a[152:155]
ds_read_b64_tr_b16 v[236:237], v249 offset:57856
ds_read_b64_tr_b16 v[238:239], v249 offset:59904
v_mfma_f32_16x16x32_bf16 a[152:155], v[244:247], v[152:155], a[152:155]
buffer_store_dwordx4 v[124:127], v252, s[20:23], s43 offen offset:3072 sc1
v_accvgpr_read_b32 v192, a128
v_mfma_f32_16x16x32_bf16 a[156:159], v[240:243], v[140:143], a[156:159]
v_accvgpr_read_b32 v193, a129
v_accvgpr_read_b32 v194, a130
v_mfma_f32_16x16x32_bf16 a[156:159], v[244:247], v[156:159], a[156:159]
s_waitcnt lgkmcnt(4)
v_accvgpr_read_b32 v195, a131
v_mfma_f32_16x16x32_bf16 a[144:147], v[224:227], v[160:163], a[144:147]
ds_read_b64_tr_b16 v[240:241], v12 offset:8704
ds_read_b64_tr_b16 v[242:243], v12 offset:10752
v_mfma_f32_16x16x32_bf16 a[144:147], v[228:231], v[0:3], a[144:147]
v_cvt_pk_bf16_f32 v16, v192, v193
v_cvt_pk_bf16_f32 v17, v194, v195
v_mfma_f32_16x16x32_bf16 a[148:151], v[224:227], v[164:167], a[148:151]
v_accvgpr_read_b32 v200, a132
v_accvgpr_read_b32 v201, a133
v_mfma_f32_16x16x32_bf16 a[148:151], v[228:231], v[32:35], a[148:151]
v_accvgpr_read_b32 v202, a134
v_accvgpr_read_b32 v203, a135
v_mfma_f32_16x16x32_bf16 a[152:155], v[224:227], v[168:171], a[152:155]
ds_read_b64_tr_b16 v[244:245], v12 offset:25088
ds_read_b64_tr_b16 v[246:247], v12 offset:27136
v_mfma_f32_16x16x32_bf16 a[152:155], v[228:231], v[64:67], a[152:155]
v_cvt_pk_bf16_f32 v48, v200, v201
v_cvt_pk_bf16_f32 v49, v202, v203
v_mfma_f32_16x16x32_bf16 a[156:159], v[224:227], v[172:175], a[156:159]
v_accvgpr_read_b32 v208, a136
v_accvgpr_read_b32 v209, a137
v_mfma_f32_16x16x32_bf16 a[156:159], v[228:231], v[96:99], a[156:159]
s_waitcnt lgkmcnt(4)
v_accvgpr_read_b32 v210, a138
v_mfma_f32_16x16x32_bf16 a[160:163], v[232:235], v[4:7], a[160:163]
ds_read_b64_tr_b16 v[224:225], v12 offset:41472
ds_read_b64_tr_b16 v[226:227], v12 offset:43520
v_mfma_f32_16x16x32_bf16 a[160:163], v[236:239], v[176:179], a[160:163]
v_accvgpr_read_b32 v211, a139
v_cvt_pk_bf16_f32 v80, v208, v209
v_mfma_f32_16x16x32_bf16 a[164:167], v[232:235], v[36:39], a[164:167]
v_cvt_pk_bf16_f32 v81, v210, v211
v_accvgpr_read_b32 v216, a140
v_mfma_f32_16x16x32_bf16 a[164:167], v[236:239], v[180:183], a[164:167]
v_accvgpr_read_b32 v217, a141
v_accvgpr_read_b32 v218, a142
v_mfma_f32_16x16x32_bf16 a[168:171], v[232:235], v[68:71], a[168:171]
ds_read_b64_tr_b16 v[228:229], v12 offset:57856
ds_read_b64_tr_b16 v[230:231], v12 offset:59904
v_mfma_f32_16x16x32_bf16 a[168:171], v[236:239], v[184:187], a[168:171]
v_accvgpr_read_b32 v219, a143
v_cvt_pk_bf16_f32 v112, v216, v217
v_mfma_f32_16x16x32_bf16 a[172:175], v[232:235], v[100:103], a[172:175]
v_cvt_pk_bf16_f32 v113, v218, v219
v_accvgpr_read_b32 v196, a144
v_mfma_f32_16x16x32_bf16 a[172:175], v[236:239], v[188:191], a[172:175]
s_waitcnt lgkmcnt(4)
v_accvgpr_read_b32 v197, a145
v_mfma_f32_16x16x32_bf16 a[160:163], v[240:243], v[128:131], a[160:163]
ds_read_b64_tr_b16 v[232:233], v250 offset:41472
ds_read_b64_tr_b16 v[234:235], v250 offset:43520
v_mfma_f32_16x16x32_bf16 a[160:163], v[244:247], v[144:147], a[160:163]
v_accvgpr_read_b32 v198, a146
v_accvgpr_read_b32 v199, a147
v_mfma_f32_16x16x32_bf16 a[164:167], v[240:243], v[132:135], a[164:167]
v_cvt_pk_bf16_f32 v18, v196, v197
v_cvt_pk_bf16_f32 v19, v198, v199
v_mfma_f32_16x16x32_bf16 a[164:167], v[244:247], v[148:151], a[164:167]
buffer_store_dwordx4 v[16:19], v252, s[20:23], s44 offen offset:0 sc1
v_accvgpr_read_b32 v204, a148
v_mfma_f32_16x16x32_bf16 a[168:171], v[240:243], v[136:139], a[168:171]
ds_read_b64_tr_b16 v[236:237], v250 offset:57856
ds_read_b64_tr_b16 v[238:239], v250 offset:59904
v_mfma_f32_16x16x32_bf16 a[168:171], v[244:247], v[152:155], a[168:171]
v_accvgpr_read_b32 v205, a149
v_accvgpr_read_b32 v206, a150
v_mfma_f32_16x16x32_bf16 a[172:175], v[240:243], v[140:143], a[172:175]
v_accvgpr_read_b32 v207, a151
v_cvt_pk_bf16_f32 v50, v204, v205
s_mov_b32 s33, 0x6c01400
v_mfma_f32_16x16x32_bf16 a[172:175], v[244:247], v[156:159], a[172:175]
s_waitcnt lgkmcnt(4)
v_cvt_pk_bf16_f32 v51, v206, v207
buffer_load_dword v254, off, s[56:59], s33 sc1
v_mfma_f32_16x16x32_bf16 a[160:163], v[224:227], v[160:163], a[160:163]
ds_read_b64_tr_b16 v[240:241], v13 offset:8704
ds_read_b64_tr_b16 v[242:243], v13 offset:10752
v_mfma_f32_16x16x32_bf16 a[160:163], v[228:231], v[0:3], a[160:163]
buffer_store_dwordx4 v[48:51], v252, s[20:23], s45 offen offset:0 sc1
v_accvgpr_read_b32 v212, a152
v_mfma_f32_16x16x32_bf16 a[164:167], v[224:227], v[164:167], a[164:167]
v_accvgpr_read_b32 v213, a153
v_accvgpr_read_b32 v214, a154
v_mfma_f32_16x16x32_bf16 a[164:167], v[228:231], v[32:35], a[164:167]
v_accvgpr_read_b32 v215, a155
v_cvt_pk_bf16_f32 v82, v212, v213
v_mfma_f32_16x16x32_bf16 a[168:171], v[224:227], v[168:171], a[168:171]
ds_read_b64_tr_b16 v[244:245], v13 offset:25088
ds_read_b64_tr_b16 v[246:247], v13 offset:27136
v_mfma_f32_16x16x32_bf16 a[168:171], v[228:231], v[64:67], a[168:171]
v_cvt_pk_bf16_f32 v83, v214, v215
buffer_store_dwordx4 v[80:83], v252, s[20:23], s46 offen offset:0 sc1
v_mfma_f32_16x16x32_bf16 a[172:175], v[224:227], v[172:175], a[172:175]
v_accvgpr_read_b32 v220, a156
v_accvgpr_read_b32 v221, a157
v_mfma_f32_16x16x32_bf16 a[172:175], v[228:231], v[96:99], a[172:175]
s_waitcnt lgkmcnt(4)
v_accvgpr_read_b32 v222, a158
v_mfma_f32_16x16x32_bf16 a[176:179], v[232:235], v[4:7], a[176:179]
ds_read_b64_tr_b16 v[224:225], v13 offset:41472
ds_read_b64_tr_b16 v[226:227], v13 offset:43520
v_mfma_f32_16x16x32_bf16 a[176:179], v[236:239], v[176:179], a[176:179]
v_accvgpr_read_b32 v223, a159
v_cvt_pk_bf16_f32 v114, v220, v221
v_mfma_f32_16x16x32_bf16 a[180:183], v[232:235], v[36:39], a[180:183]
v_cvt_pk_bf16_f32 v115, v222, v223
buffer_store_dwordx4 v[112:115], v252, s[20:23], s47 offen offset:0 sc1
v_mfma_f32_16x16x32_bf16 a[180:183], v[236:239], v[180:183], a[180:183]
v_accvgpr_read_b32 v192, a160
v_accvgpr_read_b32 v193, a161
v_mfma_f32_16x16x32_bf16 a[184:187], v[232:235], v[68:71], a[184:187]
ds_read_b64_tr_b16 v[228:229], v13 offset:57856
ds_read_b64_tr_b16 v[230:231], v13 offset:59904
v_mfma_f32_16x16x32_bf16 a[184:187], v[236:239], v[184:187], a[184:187]
v_accvgpr_read_b32 v194, a162
v_accvgpr_read_b32 v195, a163
v_mfma_f32_16x16x32_bf16 a[188:191], v[232:235], v[100:103], a[188:191]
v_cvt_pk_bf16_f32 v20, v192, v193
v_cvt_pk_bf16_f32 v21, v194, v195
v_mfma_f32_16x16x32_bf16 a[188:191], v[236:239], v[188:191], a[188:191]
s_waitcnt lgkmcnt(4)
v_accvgpr_read_b32 v200, a164
v_mfma_f32_16x16x32_bf16 a[176:179], v[240:243], v[128:131], a[176:179]
ds_read_b64_tr_b16 v[232:233], v249 offset:45056
ds_read_b64_tr_b16 v[234:235], v249 offset:47104
v_mfma_f32_16x16x32_bf16 a[176:179], v[244:247], v[144:147], a[176:179]
v_accvgpr_read_b32 v201, a165
v_accvgpr_read_b32 v202, a166
v_mfma_f32_16x16x32_bf16 a[180:183], v[240:243], v[132:135], a[180:183]
v_accvgpr_read_b32 v203, a167
v_cvt_pk_bf16_f32 v52, v200, v201
v_mfma_f32_16x16x32_bf16 a[180:183], v[244:247], v[148:151], a[180:183]
v_cvt_pk_bf16_f32 v53, v202, v203
v_accvgpr_read_b32 v208, a168
v_mfma_f32_16x16x32_bf16 a[184:187], v[240:243], v[136:139], a[184:187]
ds_read_b64_tr_b16 v[236:237], v249 offset:61440
ds_read_b64_tr_b16 v[238:239], v249 offset:63488
v_mfma_f32_16x16x32_bf16 a[184:187], v[244:247], v[152:155], a[184:187]
v_accvgpr_read_b32 v209, a169
v_accvgpr_read_b32 v210, a170
v_mfma_f32_16x16x32_bf16 a[188:191], v[240:243], v[140:143], a[188:191]
v_accvgpr_read_b32 v211, a171
v_cvt_pk_bf16_f32 v84, v208, v209
v_mfma_f32_16x16x32_bf16 a[188:191], v[244:247], v[156:159], a[188:191]
s_waitcnt lgkmcnt(4)
v_cvt_pk_bf16_f32 v85, v210, v211
v_mfma_f32_16x16x32_bf16 a[176:179], v[224:227], v[160:163], a[176:179]
ds_read_b64_tr_b16 v[240:241], v12 offset:12288
ds_read_b64_tr_b16 v[242:243], v12 offset:14336
v_mfma_f32_16x16x32_bf16 a[176:179], v[228:231], v[0:3], a[176:179]
v_accvgpr_read_b32 v216, a172
v_accvgpr_read_b32 v217, a173
v_mfma_f32_16x16x32_bf16 a[180:183], v[224:227], v[164:167], a[180:183]
v_accvgpr_read_b32 v218, a174
v_accvgpr_read_b32 v219, a175
v_mfma_f32_16x16x32_bf16 a[180:183], v[228:231], v[32:35], a[180:183]
v_cvt_pk_bf16_f32 v116, v216, v217
v_cvt_pk_bf16_f32 v117, v218, v219
v_mfma_f32_16x16x32_bf16 a[184:187], v[224:227], v[168:171], a[184:187]
ds_read_b64_tr_b16 v[244:245], v12 offset:28672
ds_read_b64_tr_b16 v[246:247], v12 offset:30720
v_mfma_f32_16x16x32_bf16 a[184:187], v[228:231], v[64:67], a[184:187]
v_mfma_f32_16x16x32_bf16 a[188:191], v[224:227], v[172:175], a[188:191]
v_accvgpr_read_b32 v196, a176
v_accvgpr_read_b32 v197, a177
v_mfma_f32_16x16x32_bf16 a[188:191], v[228:231], v[96:99], a[188:191]
s_waitcnt lgkmcnt(4)
v_accvgpr_read_b32 v198, a178
v_mfma_f32_16x16x32_bf16 a[192:195], v[232:235], v[4:7], a[192:195]
ds_read_b64_tr_b16 v[224:225], v12 offset:45056
ds_read_b64_tr_b16 v[226:227], v12 offset:47104
v_mfma_f32_16x16x32_bf16 a[192:195], v[236:239], v[176:179], a[192:195]
v_accvgpr_read_b32 v199, a179
v_cvt_pk_bf16_f32 v22, v196, v197
v_mfma_f32_16x16x32_bf16 a[196:199], v[232:235], v[36:39], a[196:199]
v_cvt_pk_bf16_f32 v23, v198, v199
buffer_store_dwordx4 v[20:23], v252, s[20:23], s44 offen offset:1024 sc1
v_mfma_f32_16x16x32_bf16 a[196:199], v[236:239], v[180:183], a[196:199]
v_accvgpr_read_b32 v204, a180
v_accvgpr_read_b32 v205, a181
v_mfma_f32_16x16x32_bf16 a[200:203], v[232:235], v[68:71], a[200:203]
ds_read_b64_tr_b16 v[228:229], v12 offset:61440
ds_read_b64_tr_b16 v[230:231], v12 offset:63488
v_mfma_f32_16x16x32_bf16 a[200:203], v[236:239], v[184:187], a[200:203]
v_accvgpr_read_b32 v206, a182
v_accvgpr_read_b32 v207, a183
v_mfma_f32_16x16x32_bf16 a[204:207], v[232:235], v[100:103], a[204:207]
v_cvt_pk_bf16_f32 v54, v204, v205
v_cvt_pk_bf16_f32 v55, v206, v207
v_mfma_f32_16x16x32_bf16 a[204:207], v[236:239], v[188:191], a[204:207]
s_waitcnt lgkmcnt(4)
buffer_store_dwordx4 v[52:55], v252, s[20:23], s45 offen offset:1024 sc1
v_mfma_f32_16x16x32_bf16 a[192:195], v[240:243], v[128:131], a[192:195]
ds_read_b64_tr_b16 v[232:233], v250 offset:45056
ds_read_b64_tr_b16 v[234:235], v250 offset:47104
v_mfma_f32_16x16x32_bf16 a[192:195], v[244:247], v[144:147], a[192:195]
v_accvgpr_read_b32 v212, a184
v_accvgpr_read_b32 v213, a185
v_mfma_f32_16x16x32_bf16 a[196:199], v[240:243], v[132:135], a[196:199]
v_accvgpr_read_b32 v214, a186
v_accvgpr_read_b32 v215, a187
v_mfma_f32_16x16x32_bf16 a[196:199], v[244:247], v[148:151], a[196:199]
v_cvt_pk_bf16_f32 v86, v212, v213
v_cvt_pk_bf16_f32 v87, v214, v215
v_mfma_f32_16x16x32_bf16 a[200:203], v[240:243], v[136:139], a[200:203]
ds_read_b64_tr_b16 v[236:237], v250 offset:61440
ds_read_b64_tr_b16 v[238:239], v250 offset:63488
v_mfma_f32_16x16x32_bf16 a[200:203], v[244:247], v[152:155], a[200:203]
buffer_store_dwordx4 v[84:87], v252, s[20:23], s46 offen offset:1024 sc1
v_accvgpr_read_b32 v220, a188
v_mfma_f32_16x16x32_bf16 a[204:207], v[240:243], v[140:143], a[204:207]
v_accvgpr_read_b32 v221, a189
v_accvgpr_read_b32 v222, a190
v_mfma_f32_16x16x32_bf16 a[204:207], v[244:247], v[156:159], a[204:207]
s_waitcnt lgkmcnt(4)
v_accvgpr_read_b32 v223, a191
v_mfma_f32_16x16x32_bf16 a[192:195], v[224:227], v[160:163], a[192:195]
ds_read_b64_tr_b16 v[240:241], v13 offset:12288
ds_read_b64_tr_b16 v[242:243], v13 offset:14336
v_mfma_f32_16x16x32_bf16 a[192:195], v[228:231], v[0:3], a[192:195]
v_cvt_pk_bf16_f32 v118, v220, v221
v_cvt_pk_bf16_f32 v119, v222, v223
v_mfma_f32_16x16x32_bf16 a[196:199], v[224:227], v[164:167], a[196:199]
buffer_store_dwordx4 v[116:119], v252, s[20:23], s47 offen offset:1024 sc1
v_mfma_f32_16x16x32_bf16 a[196:199], v[228:231], v[32:35], a[196:199]
v_mfma_f32_16x16x32_bf16 a[200:203], v[224:227], v[168:171], a[200:203]
ds_read_b64_tr_b16 v[244:245], v13 offset:28672
ds_read_b64_tr_b16 v[246:247], v13 offset:30720
v_mfma_f32_16x16x32_bf16 a[200:203], v[228:231], v[64:67], a[200:203]
v_mfma_f32_16x16x32_bf16 a[204:207], v[224:227], v[172:175], a[204:207]
v_accvgpr_read_b32 v192, a192
v_accvgpr_read_b32 v193, a193
v_mfma_f32_16x16x32_bf16 a[204:207], v[228:231], v[96:99], a[204:207]
s_waitcnt lgkmcnt(4)
v_accvgpr_read_b32 v194, a194
v_mfma_f32_16x16x32_bf16 a[208:211], v[232:235], v[4:7], a[208:211]
ds_read_b64_tr_b16 v[224:225], v13 offset:45056
ds_read_b64_tr_b16 v[226:227], v13 offset:47104
v_mfma_f32_16x16x32_bf16 a[208:211], v[236:239], v[176:179], a[208:211]
v_accvgpr_read_b32 v195, a195
v_cvt_pk_bf16_f32 v24, v192, v193
v_mfma_f32_16x16x32_bf16 a[212:215], v[232:235], v[36:39], a[212:215]
v_cvt_pk_bf16_f32 v25, v194, v195
v_accvgpr_read_b32 v200, a196
v_mfma_f32_16x16x32_bf16 a[212:215], v[236:239], v[180:183], a[212:215]
v_accvgpr_read_b32 v201, a197
v_accvgpr_read_b32 v202, a198
v_mfma_f32_16x16x32_bf16 a[216:219], v[232:235], v[68:71], a[216:219]
ds_read_b64_tr_b16 v[228:229], v13 offset:61440
ds_read_b64_tr_b16 v[230:231], v13 offset:63488
v_mfma_f32_16x16x32_bf16 a[216:219], v[236:239], v[184:187], a[216:219]
v_accvgpr_read_b32 v203, a199
v_cvt_pk_bf16_f32 v56, v200, v201
v_mfma_f32_16x16x32_bf16 a[220:223], v[232:235], v[100:103], a[220:223]
v_cvt_pk_bf16_f32 v57, v202, v203
v_accvgpr_read_b32 v208, a200
v_mfma_f32_16x16x32_bf16 a[220:223], v[236:239], v[188:191], a[220:223]
s_waitcnt lgkmcnt(4)
v_accvgpr_read_b32 v209, a201
v_mfma_f32_16x16x32_bf16 a[208:211], v[240:243], v[128:131], a[208:211]
ds_read_b64_tr_b16 v[232:233], v249 offset:45568
ds_read_b64_tr_b16 v[234:235], v249 offset:47616
v_mfma_f32_16x16x32_bf16 a[208:211], v[244:247], v[144:147], a[208:211]
v_accvgpr_read_b32 v210, a202
v_accvgpr_read_b32 v211, a203
v_mfma_f32_16x16x32_bf16 a[212:215], v[240:243], v[132:135], a[212:215]
v_cvt_pk_bf16_f32 v88, v208, v209
v_cvt_pk_bf16_f32 v89, v210, v211
v_mfma_f32_16x16x32_bf16 a[212:215], v[244:247], v[148:151], a[212:215]
v_accvgpr_read_b32 v216, a204
v_accvgpr_read_b32 v217, a205
v_mfma_f32_16x16x32_bf16 a[216:219], v[240:243], v[136:139], a[216:219]
ds_read_b64_tr_b16 v[236:237], v249 offset:61952
ds_read_b64_tr_b16 v[238:239], v249 offset:64000
v_mfma_f32_16x16x32_bf16 a[216:219], v[244:247], v[152:155], a[216:219]
v_accvgpr_read_b32 v218, a206
v_accvgpr_read_b32 v219, a207
v_mfma_f32_16x16x32_bf16 a[220:223], v[240:243], v[140:143], a[220:223]
v_cvt_pk_bf16_f32 v120, v216, v217
v_cvt_pk_bf16_f32 v121, v218, v219
v_mfma_f32_16x16x32_bf16 a[220:223], v[244:247], v[156:159], a[220:223]
s_waitcnt lgkmcnt(4)
v_mfma_f32_16x16x32_bf16 a[208:211], v[224:227], v[160:163], a[208:211]
ds_read_b64_tr_b16 v[240:241], v12 offset:12800
ds_read_b64_tr_b16 v[242:243], v12 offset:14848
v_mfma_f32_16x16x32_bf16 a[208:211], v[228:231], v[0:3], a[208:211]
v_mfma_f32_16x16x32_bf16 a[212:215], v[224:227], v[164:167], a[212:215]
v_mfma_f32_16x16x32_bf16 a[212:215], v[228:231], v[32:35], a[212:215]
v_mfma_f32_16x16x32_bf16 a[216:219], v[224:227], v[168:171], a[216:219]
ds_read_b64_tr_b16 v[244:245], v12 offset:29184
ds_read_b64_tr_b16 v[246:247], v12 offset:31232
v_mfma_f32_16x16x32_bf16 a[216:219], v[228:231], v[64:67], a[216:219]
v_mfma_f32_16x16x32_bf16 a[220:223], v[224:227], v[172:175], a[220:223]
s_nop 0
v_accvgpr_read_b32 v196, a208
v_accvgpr_read_b32 v197, a209
v_mfma_f32_16x16x32_bf16 a[220:223], v[228:231], v[96:99], a[220:223]
s_waitcnt lgkmcnt(4)
v_accvgpr_read_b32 v198, a210
v_mfma_f32_16x16x32_bf16 a[224:227], v[232:235], v[4:7], a[224:227]
ds_read_b64_tr_b16 v[224:225], v12 offset:45568
ds_read_b64_tr_b16 v[226:227], v12 offset:47616
v_mfma_f32_16x16x32_bf16 a[224:227], v[236:239], v[176:179], a[224:227]
v_accvgpr_read_b32 v199, a211
v_cvt_pk_bf16_f32 v26, v196, v197
v_mfma_f32_16x16x32_bf16 a[228:231], v[232:235], v[36:39], a[228:231]
v_cvt_pk_bf16_f32 v27, v198, v199
buffer_store_dwordx4 v[24:27], v252, s[20:23], s44 offen offset:2048 sc1
v_mfma_f32_16x16x32_bf16 a[228:231], v[236:239], v[180:183], a[228:231]
v_accvgpr_read_b32 v204, a212
v_accvgpr_read_b32 v205, a213
v_mfma_f32_16x16x32_bf16 a[232:235], v[232:235], v[68:71], a[232:235]
ds_read_b64_tr_b16 v[228:229], v12 offset:61952
ds_read_b64_tr_b16 v[230:231], v12 offset:64000
v_mfma_f32_16x16x32_bf16 a[232:235], v[236:239], v[184:187], a[232:235]
v_accvgpr_read_b32 v206, a214
v_accvgpr_read_b32 v207, a215
v_mfma_f32_16x16x32_bf16 a[236:239], v[232:235], v[100:103], a[236:239]
v_cvt_pk_bf16_f32 v58, v204, v205
v_cvt_pk_bf16_f32 v59, v206, v207
v_mfma_f32_16x16x32_bf16 a[236:239], v[236:239], v[188:191], a[236:239]
s_waitcnt lgkmcnt(4)
buffer_store_dwordx4 v[56:59], v252, s[20:23], s45 offen offset:2048 sc1
v_mfma_f32_16x16x32_bf16 a[224:227], v[240:243], v[128:131], a[224:227]
ds_read_b64_tr_b16 v[232:233], v250 offset:45568
ds_read_b64_tr_b16 v[234:235], v250 offset:47616
v_mfma_f32_16x16x32_bf16 a[224:227], v[244:247], v[144:147], a[224:227]
v_accvgpr_read_b32 v212, a216
v_accvgpr_read_b32 v213, a217
v_mfma_f32_16x16x32_bf16 a[228:231], v[240:243], v[132:135], a[228:231]
v_accvgpr_read_b32 v214, a218
v_accvgpr_read_b32 v215, a219
v_mfma_f32_16x16x32_bf16 a[228:231], v[244:247], v[148:151], a[228:231]
v_cvt_pk_bf16_f32 v90, v212, v213
v_cvt_pk_bf16_f32 v91, v214, v215
v_mfma_f32_16x16x32_bf16 a[232:235], v[240:243], v[136:139], a[232:235]
ds_read_b64_tr_b16 v[236:237], v250 offset:61952
ds_read_b64_tr_b16 v[238:239], v250 offset:64000
v_mfma_f32_16x16x32_bf16 a[232:235], v[244:247], v[152:155], a[232:235]
buffer_store_dwordx4 v[88:91], v252, s[20:23], s46 offen offset:2048 sc1
v_accvgpr_read_b32 v220, a220
v_mfma_f32_16x16x32_bf16 a[236:239], v[240:243], v[140:143], a[236:239]
v_accvgpr_read_b32 v221, a221
v_accvgpr_read_b32 v222, a222
v_mfma_f32_16x16x32_bf16 a[236:239], v[244:247], v[156:159], a[236:239]
s_waitcnt lgkmcnt(4)
v_accvgpr_read_b32 v223, a223
v_mfma_f32_16x16x32_bf16 a[224:227], v[224:227], v[160:163], a[224:227]
ds_read_b64_tr_b16 v[240:241], v13 offset:12800
ds_read_b64_tr_b16 v[242:243], v13 offset:14848
v_mfma_f32_16x16x32_bf16 a[224:227], v[228:231], v[0:3], a[224:227]
v_cvt_pk_bf16_f32 v122, v220, v221
v_cvt_pk_bf16_f32 v123, v222, v223
v_mfma_f32_16x16x32_bf16 a[228:231], v[224:227], v[164:167], a[228:231]
buffer_store_dwordx4 v[120:123], v252, s[20:23], s47 offen offset:2048 sc1
v_mfma_f32_16x16x32_bf16 a[228:231], v[228:231], v[32:35], a[228:231]
v_mfma_f32_16x16x32_bf16 a[232:235], v[224:227], v[168:171], a[232:235]
ds_read_b64_tr_b16 v[244:245], v13 offset:29184
ds_read_b64_tr_b16 v[246:247], v13 offset:31232
v_mfma_f32_16x16x32_bf16 a[232:235], v[228:231], v[64:67], a[232:235]
v_mfma_f32_16x16x32_bf16 a[236:239], v[224:227], v[172:175], a[236:239]
v_accvgpr_read_b32 v192, a224
v_accvgpr_read_b32 v193, a225
v_mfma_f32_16x16x32_bf16 a[236:239], v[228:231], v[96:99], a[236:239]
s_waitcnt lgkmcnt(4)
v_accvgpr_read_b32 v194, a226
v_mfma_f32_16x16x32_bf16 a[240:243], v[232:235], v[4:7], a[240:243]
ds_read_b64_tr_b16 v[224:225], v13 offset:45568
ds_read_b64_tr_b16 v[226:227], v13 offset:47616
v_mfma_f32_16x16x32_bf16 a[240:243], v[236:239], v[176:179], a[240:243]
v_accvgpr_read_b32 v195, a227
v_cvt_pk_bf16_f32 v28, v192, v193
v_mfma_f32_16x16x32_bf16 a[244:247], v[232:235], v[36:39], a[244:247]
v_cvt_pk_bf16_f32 v29, v194, v195
v_accvgpr_read_b32 v200, a228
v_mfma_f32_16x16x32_bf16 a[244:247], v[236:239], v[180:183], a[244:247]
v_accvgpr_read_b32 v201, a229
v_accvgpr_read_b32 v202, a230
v_mfma_f32_16x16x32_bf16 a[248:251], v[232:235], v[68:71], a[248:251]
ds_read_b64_tr_b16 v[228:229], v13 offset:61952
ds_read_b64_tr_b16 v[230:231], v13 offset:64000
v_mfma_f32_16x16x32_bf16 a[248:251], v[236:239], v[184:187], a[248:251]
v_accvgpr_read_b32 v203, a231
v_cvt_pk_bf16_f32 v60, v200, v201
v_mfma_f32_16x16x32_bf16 a[252:255], v[232:235], v[100:103], a[252:255]
v_cvt_pk_bf16_f32 v61, v202, v203
v_accvgpr_read_b32 v208, a232
v_mfma_f32_16x16x32_bf16 a[252:255], v[236:239], v[188:191], a[252:255]
s_waitcnt lgkmcnt(4)
v_accvgpr_read_b32 v209, a233
v_mfma_f32_16x16x32_bf16 a[240:243], v[240:243], v[128:131], a[240:243]
v_accvgpr_read_b32 v210, a234
v_accvgpr_read_b32 v211, a235
v_mfma_f32_16x16x32_bf16 a[240:243], v[244:247], v[144:147], a[240:243]
v_cvt_pk_bf16_f32 v92, v208, v209
v_cvt_pk_bf16_f32 v93, v210, v211
v_mfma_f32_16x16x32_bf16 a[244:247], v[240:243], v[132:135], a[244:247]
v_accvgpr_read_b32 v216, a236
v_accvgpr_read_b32 v217, a237
v_mfma_f32_16x16x32_bf16 a[244:247], v[244:247], v[148:151], a[244:247]
v_accvgpr_read_b32 v218, a238
v_accvgpr_read_b32 v219, a239
v_mfma_f32_16x16x32_bf16 a[248:251], v[240:243], v[136:139], a[248:251]
v_cvt_pk_bf16_f32 v124, v216, v217
v_cvt_pk_bf16_f32 v125, v218, v219
v_mfma_f32_16x16x32_bf16 a[248:251], v[244:247], v[152:155], a[248:251]
v_mfma_f32_16x16x32_bf16 a[252:255], v[240:243], v[140:143], a[252:255]
v_mfma_f32_16x16x32_bf16 a[252:255], v[244:247], v[156:159], a[252:255]
s_waitcnt lgkmcnt(0)
v_mfma_f32_16x16x32_bf16 a[240:243], v[224:227], v[160:163], a[240:243]
v_mfma_f32_16x16x32_bf16 a[240:243], v[228:231], v[0:3], a[240:243]
v_mfma_f32_16x16x32_bf16 a[244:247], v[224:227], v[164:167], a[244:247]
v_mfma_f32_16x16x32_bf16 a[244:247], v[228:231], v[32:35], a[244:247]
v_mfma_f32_16x16x32_bf16 a[248:251], v[224:227], v[168:171], a[248:251]
v_mfma_f32_16x16x32_bf16 a[248:251], v[228:231], v[64:67], a[248:251]
v_mfma_f32_16x16x32_bf16 a[252:255], v[224:227], v[172:175], a[252:255]
s_nop 2
v_accvgpr_read_b32 v196, a240
v_accvgpr_read_b32 v197, a241
v_accvgpr_read_b32 v198, a242
v_accvgpr_read_b32 v199, a243
v_mfma_f32_16x16x32_bf16 a[252:255], v[228:231], v[96:99], a[252:255]
v_cvt_pk_bf16_f32 v30, v196, v197
v_cvt_pk_bf16_f32 v31, v198, v199
buffer_store_dwordx4 v[28:31], v252, s[20:23], s44 offen offset:3072 sc1
v_accvgpr_read_b32 v204, a244
v_accvgpr_read_b32 v205, a245
v_accvgpr_read_b32 v206, a246
v_accvgpr_read_b32 v207, a247
v_cvt_pk_bf16_f32 v62, v204, v205
v_cvt_pk_bf16_f32 v63, v206, v207
buffer_store_dwordx4 v[60:63], v252, s[20:23], s45 offen offset:3072 sc1
v_accvgpr_read_b32 v212, a248
v_accvgpr_read_b32 v213, a249
v_accvgpr_read_b32 v214, a250
v_accvgpr_read_b32 v215, a251
v_cvt_pk_bf16_f32 v94, v212, v213
v_cvt_pk_bf16_f32 v95, v214, v215
buffer_store_dwordx4 v[92:95], v252, s[20:23], s46 offen offset:3072 sc1
v_accvgpr_read_b32 v220, a252
v_accvgpr_read_b32 v221, a253
v_accvgpr_read_b32 v222, a254
v_accvgpr_read_b32 v223, a255
v_cvt_pk_bf16_f32 v126, v220, v221
v_cvt_pk_bf16_f32 v127, v222, v223
buffer_store_dwordx4 v[124:127], v252, s[20:23], s47 offen offset:3072 sc1
s_waitcnt vmcnt(15)
v_readfirstlane_b32 s99, v254
s_branch L2_chk
L2_tail_1_7:
s_waitcnt lgkmcnt(4)
v_mfma_f32_16x16x32_bf16 a[0:3], v[224:227], v[160:163], a[0:3]
ds_read_b128 v[240:243], v248 offset:2048
v_mfma_f32_16x16x32_bf16 a[0:3], v[228:231], v[176:179], a[0:3]
s_lshl_b32 s36, s34, 13
v_mfma_f32_16x16x32_bf16 a[4:7], v[224:227], v[164:167], a[4:7]
s_add_u32 s56, s4, 0x1000000
s_addc_u32 s57, s5, 0
v_mfma_f32_16x16x32_bf16 a[4:7], v[228:231], v[180:183], a[4:7]
s_add_u32 s36, s36, 0x20000
s_mov_b32 s58, 0x6c02000
v_mfma_f32_16x16x32_bf16 a[8:11], v[224:227], v[168:171], a[8:11]
ds_read_b128 v[244:247], v248 offset:2560
s_mov_b32 s59, 0x00020000
v_mfma_f32_16x16x32_bf16 a[8:11], v[228:231], v[184:187], a[8:11]
v_add_u32 v255, s36, v252
s_lshr_b32 s35, s2, 1
v_mfma_f32_16x16x32_bf16 a[12:15], v[224:227], v[172:175], a[12:15]
s_and_b32 s35, s35, 28
s_add_u32 s35, s35, s34
v_mfma_f32_16x16x32_bf16 a[12:15], v[228:231], v[188:191], a[12:15]
s_waitcnt lgkmcnt(2)
s_lshl_b32 s35, s35, 13
v_mfma_f32_16x16x32_bf16 a[16:19], v[232:235], v[160:163], a[16:19]
ds_read_b128 v[224:227], v248 offset:6144
v_lshlrev_b32 v253, 3, v252
v_mfma_f32_16x16x32_bf16 a[16:19], v[236:239], v[176:179], a[16:19]
buffer_load_dword v253, v253, s[56:59], s35 offen
ds_write_b128 v255, v[160:163] offset:0
v_mfma_f32_16x16x32_bf16 a[20:23], v[232:235], v[164:167], a[20:23]
v_exp_f32 v192, v192
v_mfma_f32_16x16x32_bf16 a[20:23], v[236:239], v[180:183], a[20:23]
v_exp_f32 v193, v193
v_mfma_f32_16x16x32_bf16 a[24:27], v[232:235], v[168:171], a[24:27]
ds_read_b128 v[228:231], v248 offset:6656
v_cvt_pk_bf16_f32 v128, v192, v193
v_mfma_f32_16x16x32_bf16 a[24:27], v[236:239], v[184:187], a[24:27]
v_exp_f32 v194, v194
v_mfma_f32_16x16x32_bf16 a[28:31], v[232:235], v[172:175], a[28:31]
v_exp_f32 v195, v195
v_mfma_f32_16x16x32_bf16 a[28:31], v[236:239], v[188:191], a[28:31]
s_waitcnt lgkmcnt(3)
v_cvt_pk_bf16_f32 v129, v194, v195
v_mfma_f32_16x16x32_bf16 v[208:211], v[240:243], v[0:3], 0
ds_read_b128 v[232:235], v248 offset:10240
ds_write_b128 v255, v[164:167] offset:1024
v_mfma_f32_16x16x32_bf16 v[208:211], v[244:247], v[4:7], v[208:211]
v_exp_f32 v196, v196
v_mfma_f32_16x16x32_bf16 v[212:215], v[240:243], v[32:35], 0
v_exp_f32 v197, v197
v_mfma_f32_16x16x32_bf16 v[212:215], v[244:247], v[36:39], v[212:215]
v_exp_f32 v198, v198
v_mfma_f32_16x16x32_bf16 v[216:219], v[240:243], v[64:67], 0
ds_read_b128 v[236:239], v248 offset:10752
v_cvt_pk_bf16_f32 v132, v196, v197
v_mfma_f32_16x16x32_bf16 v[216:219], v[244:247], v[68:71], v[216:219]
v_exp_f32 v199, v199
v_mfma_f32_16x16x32_bf16 v[220:223], v[240:243], v[96:99], 0
v_exp_f32 v200, v200
v_mfma_f32_16x16x32_bf16 v[220:223], v[244:247], v[100:103], v[220:223]
s_waitcnt lgkmcnt(3)
v_cvt_pk_bf16_f32 v133, v198, v199
v_mfma_f32_16x16x32_bf16 v[208:211], v[224:227], v[8:11], v[208:211]
ds_read_b128 v[240:243], v248 offset:14336
ds_write_b128 v255, v[168:171] offset:2048
v_mfma_f32_16x16x32_bf16 v[208:211], v[228:231], v[12:15], v[208:211]
v_exp_f32 v201, v201
v_mfma_f32_16x16x32_bf16 v[212:215], v[224:227], v[40:43], v[212:215]
v_exp_f32 v202, v202
v_mfma_f32_16x16x32_bf16 v[212:215], v[228:231], v[44:47], v[212:215]
v_exp_f32 v203, v203
v_mfma_f32_16x16x32_bf16 v[216:219], v[224:227], v[72:75], v[216:219]
ds_read_b128 v[244:247], v248 offset:14848
v_cvt_pk_bf16_f32 v136, v200, v201
v_mfma_f32_16x16x32_bf16 v[216:219], v[228:231], v[76:79], v[216:219]
v_cvt_pk_bf16_f32 v137, v202, v203
ds_write_b128 v255, v[172:175] offset:3072
v_mfma_f32_16x16x32_bf16 v[220:223], v[224:227], v[104:107], v[220:223]
v_exp_f32 v204, v204
v_mfma_f32_16x16x32_bf16 v[220:223], v[228:231], v[108:111], v[220:223]
s_waitcnt lgkmcnt(4)
s_waitcnt vmcnt(1)
s_barrier
v_mfma_f32_16x16x32_bf16 v[208:211], v[232:235], v[16:19], v[208:211]
ds_read_b128 v[224:227], v248 offset:16384
s_add_u32 m0, s30, 0xc000
v_mfma_f32_16x16x32_bf16 v[208:211], v[236:239], v[20:23], v[208:211]
s_and_b32 s100, s30, 0x10000
buffer_load_dwordx4 v251, s[12:15], s28 offen offset:0 lds
v_mfma_f32_16x16x32_bf16 v[212:215], v[232:235], v[48:51], v[212:215]
s_xor_b32 s100, s100, 0x10000
ds_write_b128 v255, v[176:179] offset:4096
v_mfma_f32_16x16x32_bf16 v[212:215], v[236:239], v[52:55], v[212:215]
s_mov_b32 s99, 0
buffer_load_dwordx4 v251, s[12:15], s28 offen offset:1024 lds
v_mfma_f32_16x16x32_bf16 v[216:219], v[232:235], v[80:83], v[216:219]
ds_read_b128 v[228:231], v248 offset:16896
ds_write_b128 v255, v[180:183] offset:5120
v_mfma_f32_16x16x32_bf16 v[216:219], v[236:239], v[84:87], v[216:219]
v_exp_f32 v205, v205
v_mfma_f32_16x16x32_bf16 v[220:223], v[232:235], v[112:115], v[220:223]
v_exp_f32 v206, v206
v_mfma_f32_16x16x32_bf16 v[220:223], v[236:239], v[116:119], v[220:223]
s_waitcnt lgkmcnt(5)
v_cvt_pk_bf16_f32 v140, v204, v205
v_mfma_f32_16x16x32_bf16 v[208:211], v[240:243], v[24:27], v[208:211]
ds_read_b128 v[232:235], v248 offset:20480
buffer_load_dwordx4 v251, s[12:15], s28 offen offset:2048 lds
v_mfma_f32_16x16x32_bf16 v[208:211], v[244:247], v[28:31], v[208:211]
v_exp_f32 v207, v207
v_mfma_f32_16x16x32_bf16 v[212:215], v[240:243], v[56:59], v[212:215]
buffer_load_dwordx4 v251, s[12:15], s28 offen offset:3072 lds
ds_write_b128 v255, v[184:187] offset:6144
v_mfma_f32_16x16x32_bf16 v[212:215], v[244:247], v[60:63], v[212:215]
ds_write_b128 v255, v[188:191] offset:7168
v_mfma_f32_16x16x32_bf16 v[216:219], v[240:243], v[88:91], v[216:219]
ds_read_b128 v[236:239], v248 offset:20992
v_cvt_pk_bf16_f32 v141, v206, v207
v_mfma_f32_16x16x32_bf16 v[216:219], v[244:247], v[92:95], v[216:219]
s_add_u32 s28, s28, 0x4000
s_xor_b32 s30, s30, 0x10000
v_mfma_f32_16x16x32_bf16 v[220:223], v[240:243], v[120:123], v[220:223]
s_add_u32 m0, s30, 0x0
v_mfma_f32_16x16x32_bf16 v[220:223], v[244:247], v[124:127], v[220:223]
s_waitcnt lgkmcnt(5)
buffer_load_dwordx4 v251, s[12:15], s28 offen offset:0 lds
v_mfma_f32_16x16x32_bf16 v[192:195], v[224:227], v[0:3], 0
ds_read_b128 v[240:243], v248 offset:24576
v_mfma_f32_16x16x32_bf16 v[192:195], v[228:231], v[4:7], v[192:195]
v_exp_f32 v208, v208
v_mfma_f32_16x16x32_bf16 v[196:199], v[224:227], v[32:35], 0
v_exp_f32 v209, v209
v_mfma_f32_16x16x32_bf16 v[196:199], v[228:231], v[36:39], v[196:199]
v_exp_f32 v210, v210
v_mfma_f32_16x16x32_bf16 v[200:203], v[224:227], v[64:67], 0
ds_read_b128 v[244:247], v248 offset:25088
v_cvt_pk_bf16_f32 v130, v208, v209
v_mfma_f32_16x16x32_bf16 v[200:203], v[228:231], v[68:71], v[200:203]
v_exp_f32 v211, v211
v_mfma_f32_16x16x32_bf16 v[204:207], v[224:227], v[96:99], 0
v_exp_f32 v212, v212
v_mfma_f32_16x16x32_bf16 v[204:207], v[228:231], v[100:103], v[204:207]
s_waitcnt lgkmcnt(2)
v_cvt_pk_bf16_f32 v131, v210, v211
v_mfma_f32_16x16x32_bf16 v[192:195], v[232:235], v[8:11], v[192:195]
ds_read_b128 v[224:227], v248 offset:28672
buffer_load_dwordx4 v251, s[12:15], s28 offen offset:1024 lds
v_mfma_f32_16x16x32_bf16 v[192:195], v[236:239], v[12:15], v[192:195]
v_exp_f32 v213, v213
v_mfma_f32_16x16x32_bf16 v[196:199], v[232:235], v[40:43], v[196:199]
v_exp_f32 v214, v214
v_mfma_f32_16x16x32_bf16 v[196:199], v[236:239], v[44:47], v[196:199]
v_exp_f32 v215, v215
v_mfma_f32_16x16x32_bf16 v[200:203], v[232:235], v[72:75], v[200:203]
ds_read_b128 v[228:231], v248 offset:29184
v_cvt_pk_bf16_f32 v134, v212, v213
v_mfma_f32_16x16x32_bf16 v[200:203], v[236:239], v[76:79], v[200:203]
v_cvt_pk_bf16_f32 v135, v214, v215
buffer_load_dwordx4 v251, s[12:15], s28 offen offset:2048 lds
v_mfma_f32_16x16x32_bf16 v[204:207], v[232:235], v[104:107], v[204:207]
v_exp_f32 v216, v216
v_mfma_f32_16x16x32_bf16 v[204:207], v[236:239], v[108:111], v[204:207]
s_waitcnt lgkmcnt(2)
buffer_load_dwordx4 v251, s[12:15], s28 offen offset:3072 lds
v_mfma_f32_16x16x32_bf16 v[192:195], v[240:243], v[16:19], v[192:195]
ds_read_b128 v[232:235], v248 offset:18432
v_mfma_f32_16x16x32_bf16 v[192:195], v[244:247], v[20:23], v[192:195]
v_exp_f32 v217, v217
v_mfma_f32_16x16x32_bf16 v[196:199], v[240:243], v[48:51], v[196:199]
v_exp_f32 v218, v218
v_mfma_f32_16x16x32_bf16 v[196:199], v[244:247], v[52:55], v[196:199]
v_exp_f32 v219, v219
v_mfma_f32_16x16x32_bf16 v[200:203], v[240:243], v[80:83], v[200:203]
ds_read_b128 v[236:239], v248 offset:18944
v_cvt_pk_bf16_f32 v138, v216, v217
v_mfma_f32_16x16x32_bf16 v[200:203], v[244:247], v[84:87], v[200:203]
v_cvt_pk_bf16_f32 v139, v218, v219
s_add_u32 s28, s28, 0x4000
v_mfma_f32_16x16x32_bf16 v[204:207], v[240:243], v[112:115], v[204:207]
v_exp_f32 v220, v220
v_mfma_f32_16x16x32_bf16 v[204:207], v[244:247], v[116:119], v[204:207]
s_waitcnt lgkmcnt(2)
v_mfma_f32_16x16x32_bf16 v[192:195], v[224:227], v[24:27], v[192:195]
ds_read_b128 v[240:243], v248 offset:22528
v_mfma_f32_16x16x32_bf16 v[192:195], v[228:231], v[28:31], v[192:195]
v_exp_f32 v221, v221
v_mfma_f32_16x16x32_bf16 v[196:199], v[224:227], v[56:59], v[196:199]
v_exp_f32 v222, v222
v_mfma_f32_16x16x32_bf16 v[196:199], v[228:231], v[60:63], v[196:199]
v_exp_f32 v223, v223
v_mfma_f32_16x16x32_bf16 v[200:203], v[224:227], v[88:91], v[200:203]
ds_read_b128 v[244:247], v248 offset:23040
v_cvt_pk_bf16_f32 v142, v220, v221
v_mfma_f32_16x16x32_bf16 v[200:203], v[228:231], v[92:95], v[200:203]
v_cvt_pk_bf16_f32 v143, v222, v223
v_mfma_f32_16x16x32_bf16 v[204:207], v[224:227], v[120:123], v[204:207]
v_mfma_f32_16x16x32_bf16 v[204:207], v[228:231], v[124:127], v[204:207]
s_waitcnt lgkmcnt(2)
v_mfma_f32_16x16x32_bf16 v[208:211], v[232:235], v[0:3], 0
ds_read_b128 v[224:227], v248 offset:26624
v_mfma_f32_16x16x32_bf16 v[208:211], v[236:239], v[4:7], v[208:211]
v_exp_f32 v192, v192
v_mfma_f32_16x16x32_bf16 v[212:215], v[232:235], v[32:35], 0
v_exp_f32 v193, v193
v_mfma_f32_16x16x32_bf16 v[212:215], v[236:239], v[36:39], v[212:215]
v_exp_f32 v194, v194
v_mfma_f32_16x16x32_bf16 v[216:219], v[232:235], v[64:67], 0
ds_read_b128 v[228:231], v248 offset:27136
v_cvt_pk_bf16_f32 v144, v192, v193
v_mfma_f32_16x16x32_bf16 v[216:219], v[236:239], v[68:71], v[216:219]
v_exp_f32 v195, v195
v_mfma_f32_16x16x32_bf16 v[220:223], v[232:235], v[96:99], 0
v_exp_f32 v196, v196
v_mfma_f32_16x16x32_bf16 v[220:223], v[236:239], v[100:103], v[220:223]
s_waitcnt lgkmcnt(2)
v_cvt_pk_bf16_f32 v145, v194, v195
v_mfma_f32_16x16x32_bf16 v[208:211], v[240:243], v[8:11], v[208:211]
ds_read_b128 v[232:235], v248 offset:30720
v_mfma_f32_16x16x32_bf16 v[208:211], v[244:247], v[12:15], v[208:211]
v_exp_f32 v197, v197
v_mfma_f32_16x16x32_bf16 v[212:215], v[240:243], v[40:43], v[212:215]
v_exp_f32 v198, v198
v_mfma_f32_16x16x32_bf16 v[212:215], v[244:247], v[44:47], v[212:215]
v_exp_f32 v199, v199
v_mfma_f32_16x16x32_bf16 v[216:219], v[240:243], v[72:75], v[216:219]
ds_read_b128 v[236:239], v248 offset:31232
v_cvt_pk_bf16_f32 v148, v196, v197
v_mfma_f32_16x16x32_bf16 v[216:219], v[244:247], v[76:79], v[216:219]
v_cvt_pk_bf16_f32 v149, v198, v199
v_mfma_f32_16x16x32_bf16 v[220:223], v[240:243], v[104:107], v[220:223]
v_exp_f32 v200, v200
v_mfma_f32_16x16x32_bf16 v[220:223], v[244:247], v[108:111], v[220:223]
s_waitcnt lgkmcnt(2)
v_mfma_f32_16x16x32_bf16 v[208:211], v[224:227], v[16:19], v[208:211]
ds_read_b128 v[240:243], v248 offset:32768
v_mfma_f32_16x16x32_bf16 v[208:211], v[228:231], v[20:23], v[208:211]
v_exp_f32 v201, v201
v_mfma_f32_16x16x32_bf16 v[212:215], v[224:227], v[48:51], v[212:215]
v_exp_f32 v202, v202
v_mfma_f32_16x16x32_bf16 v[212:215], v[228:231], v[52:55], v[212:215]
v_exp_f32 v203, v203
v_mfma_f32_16x16x32_bf16 v[216:219], v[224:227], v[80:83], v[216:219]
ds_read_b128 v[244:247], v248 offset:33280
v_cvt_pk_bf16_f32 v152, v200, v201
v_mfma_f32_16x16x32_bf16 v[216:219], v[228:231], v[84:87], v[216:219]
v_cvt_pk_bf16_f32 v153, v202, v203
v_mfma_f32_16x16x32_bf16 v[220:223], v[224:227], v[112:115], v[220:223]
v_exp_f32 v204, v204
v_mfma_f32_16x16x32_bf16 v[220:223], v[228:231], v[116:119], v[220:223]
s_waitcnt lgkmcnt(2)
v_mfma_f32_16x16x32_bf16 v[208:211], v[232:235], v[24:27], v[208:211]
ds_read_b128 v[224:227], v248 offset:36864
v_mfma_f32_16x16x32_bf16 v[208:211], v[236:239], v[28:31], v[208:211]
v_exp_f32 v205, v205
v_mfma_f32_16x16x32_bf16 v[212:215], v[232:235], v[56:59], v[212:215]
v_exp_f32 v206, v206
v_mfma_f32_16x16x32_bf16 v[212:215], v[236:239], v[60:63], v[212:215]
v_exp_f32 v207, v207
v_mfma_f32_16x16x32_bf16 v[216:219], v[232:235], v[88:91], v[216:219]
ds_read_b128 v[228:231], v248 offset:37376
v_cvt_pk_bf16_f32 v156, v204, v205
v_mfma_f32_16x16x32_bf16 v[216:219], v[236:239], v[92:95], v[216:219]
v_cvt_pk_bf16_f32 v157, v206, v207
v_mfma_f32_16x16x32_bf16 v[220:223], v[232:235], v[120:123], v[220:223]
v_mfma_f32_16x16x32_bf16 v[220:223], v[236:239], v[124:127], v[220:223]
s_waitcnt lgkmcnt(2)
v_mfma_f32_16x16x32_bf16 v[192:195], v[240:243], v[0:3], 0
ds_read_b128 v[232:235], v248 offset:40960
v_mfma_f32_16x16x32_bf16 v[192:195], v[244:247], v[4:7], v[192:195]
v_exp_f32 v208, v208
v_mfma_f32_16x16x32_bf16 v[196:199], v[240:243], v[32:35], 0
v_exp_f32 v209, v209
v_mfma_f32_16x16x32_bf16 v[196:199], v[244:247], v[36:39], v[196:199]
v_exp_f32 v210, v210
v_mfma_f32_16x16x32_bf16 v[200:203], v[240:243], v[64:67], 0
ds_read_b128 v[236:239], v248 offset:41472
v_cvt_pk_bf16_f32 v146, v208, v209
v_mfma_f32_16x16x32_bf16 v[200:203], v[244:247], v[68:71], v[200:203]
v_exp_f32 v211, v211
v_mfma_f32_16x16x32_bf16 v[204:207], v[240:243], v[96:99], 0
v_exp_f32 v212, v212
v_mfma_f32_16x16x32_bf16 v[204:207], v[244:247], v[100:103], v[204:207]
s_waitcnt lgkmcnt(2)
v_cvt_pk_bf16_f32 v147, v210, v211
v_mfma_f32_16x16x32_bf16 v[192:195], v[224:227], v[8:11], v[192:195]
ds_read_b128 v[240:243], v248 offset:45056
v_mfma_f32_16x16x32_bf16 v[192:195], v[228:231], v[12:15], v[192:195]
v_exp_f32 v213, v213
v_mfma_f32_16x16x32_bf16 v[196:199], v[224:227], v[40:43], v[196:199]
v_exp_f32 v214, v214
v_mfma_f32_16x16x32_bf16 v[196:199], v[228:231], v[44:47], v[196:199]
v_exp_f32 v215, v215
v_mfma_f32_16x16x32_bf16 v[200:203], v[224:227], v[72:75], v[200:203]
ds_read_b128 v[244:247], v248 offset:45568
v_cvt_pk_bf16_f32 v150, v212, v213
v_mfma_f32_16x16x32_bf16 v[200:203], v[228:231], v[76:79], v[200:203]
v_cvt_pk_bf16_f32 v151, v214, v215
v_mfma_f32_16x16x32_bf16 v[204:207], v[224:227], v[104:107], v[204:207]
v_exp_f32 v216, v216
v_mfma_f32_16x16x32_bf16 v[204:207], v[228:231], v[108:111], v[204:207]
s_waitcnt lgkmcnt(2)
v_mfma_f32_16x16x32_bf16 v[192:195], v[232:235], v[16:19], v[192:195]
ds_read_b128 v[224:227], v248 offset:34816
v_mfma_f32_16x16x32_bf16 v[192:195], v[236:239], v[20:23], v[192:195]
v_exp_f32 v217, v217
v_mfma_f32_16x16x32_bf16 v[196:199], v[232:235], v[48:51], v[196:199]
v_exp_f32 v218, v218
v_mfma_f32_16x16x32_bf16 v[196:199], v[236:239], v[52:55], v[196:199]
v_exp_f32 v219, v219
v_mfma_f32_16x16x32_bf16 v[200:203], v[232:235], v[80:83], v[200:203]
ds_read_b128 v[228:231], v248 offset:35328
v_cvt_pk_bf16_f32 v154, v216, v217
v_mfma_f32_16x16x32_bf16 v[200:203], v[236:239], v[84:87], v[200:203]
v_cvt_pk_bf16_f32 v155, v218, v219
v_mfma_f32_16x16x32_bf16 v[204:207], v[232:235], v[112:115], v[204:207]
v_exp_f32 v220, v220
v_mfma_f32_16x16x32_bf16 v[204:207], v[236:239], v[116:119], v[204:207]
s_waitcnt lgkmcnt(2)
v_mfma_f32_16x16x32_bf16 v[192:195], v[240:243], v[24:27], v[192:195]
ds_read_b128 v[232:235], v248 offset:38912
v_mfma_f32_16x16x32_bf16 v[192:195], v[244:247], v[28:31], v[192:195]
v_exp_f32 v221, v221
v_mfma_f32_16x16x32_bf16 v[196:199], v[240:243], v[56:59], v[196:199]
v_exp_f32 v222, v222
v_mfma_f32_16x16x32_bf16 v[196:199], v[244:247], v[60:63], v[196:199]
v_exp_f32 v223, v223
v_mfma_f32_16x16x32_bf16 v[200:203], v[240:243], v[88:91], v[200:203]
ds_read_b128 v[236:239], v248 offset:39424
v_cvt_pk_bf16_f32 v158, v220, v221
v_mfma_f32_16x16x32_bf16 v[200:203], v[244:247], v[92:95], v[200:203]
v_cvt_pk_bf16_f32 v159, v222, v223
v_mfma_f32_16x16x32_bf16 v[204:207], v[240:243], v[120:123], v[204:207]
v_mfma_f32_16x16x32_bf16 v[204:207], v[244:247], v[124:127], v[204:207]
s_waitcnt lgkmcnt(2)
v_mfma_f32_16x16x32_bf16 v[208:211], v[224:227], v[0:3], 0
ds_read_b128 v[240:243], v248 offset:43008
v_mfma_f32_16x16x32_bf16 v[208:211], v[228:231], v[4:7], v[208:211]
v_exp_f32 v192, v192
v_mfma_f32_16x16x32_bf16 v[212:215], v[224:227], v[32:35], 0
v_exp_f32 v193, v193
v_mfma_f32_16x16x32_bf16 v[212:215], v[228:231], v[36:39], v[212:215]
v_exp_f32 v194, v194
v_mfma_f32_16x16x32_bf16 v[216:219], v[224:227], v[64:67], 0
ds_read_b128 v[244:247], v248 offset:43520
v_cvt_pk_bf16_f32 v160, v192, v193
v_mfma_f32_16x16x32_bf16 v[216:219], v[228:231], v[68:71], v[216:219]
v_exp_f32 v195, v195
v_mfma_f32_16x16x32_bf16 v[220:223], v[224:227], v[96:99], 0
v_exp_f32 v196, v196
v_mfma_f32_16x16x32_bf16 v[220:223], v[228:231], v[100:103], v[220:223]
s_waitcnt lgkmcnt(2)
v_cvt_pk_bf16_f32 v161, v194, v195
v_mfma_f32_16x16x32_bf16 v[208:211], v[232:235], v[8:11], v[208:211]
ds_read_b128 v[224:227], v248 offset:47104
v_mfma_f32_16x16x32_bf16 v[208:211], v[236:239], v[12:15], v[208:211]
v_exp_f32 v197, v197
v_mfma_f32_16x16x32_bf16 v[212:215], v[232:235], v[40:43], v[212:215]
v_exp_f32 v198, v198
v_mfma_f32_16x16x32_bf16 v[212:215], v[236:239], v[44:47], v[212:215]
v_exp_f32 v199, v199
v_mfma_f32_16x16x32_bf16 v[216:219], v[232:235], v[72:75], v[216:219]
ds_read_b128 v[228:231], v248 offset:47616
v_cvt_pk_bf16_f32 v164, v196, v197
v_mfma_f32_16x16x32_bf16 v[216:219], v[236:239], v[76:79], v[216:219]
v_cvt_pk_bf16_f32 v165, v198, v199
v_mfma_f32_16x16x32_bf16 v[220:223], v[232:235], v[104:107], v[220:223]
v_exp_f32 v200, v200
v_mfma_f32_16x16x32_bf16 v[220:223], v[236:239], v[108:111], v[220:223]
s_waitcnt lgkmcnt(2)
s_waitcnt vmcnt(0)
s_barrier
v_mfma_f32_16x16x32_bf16 v[208:211], v[240:243], v[16:19], v[208:211]
ds_read_b128 v[232:235], v248 offset:49152
v_mfma_f32_16x16x32_bf16 v[208:211], v[244:247], v[20:23], v[208:211]
v_exp_f32 v201, v201
v_mfma_f32_16x16x32_bf16 v[212:215], v[240:243], v[48:51], v[212:215]
v_exp_f32 v202, v202
v_mfma_f32_16x16x32_bf16 v[212:215], v[244:247], v[52:55], v[212:215]
v_exp_f32 v203, v203
v_mfma_f32_16x16x32_bf16 v[216:219], v[240:243], v[80:83], v[216:219]
ds_read_b128 v[236:239], v248 offset:49664
v_cvt_pk_bf16_f32 v168, v200, v201
v_mfma_f32_16x16x32_bf16 v[216:219], v[244:247], v[84:87], v[216:219]
v_cvt_pk_bf16_f32 v169, v202, v203
v_mfma_f32_16x16x32_bf16 v[220:223], v[240:243], v[112:115], v[220:223]
v_exp_f32 v204, v204
v_mfma_f32_16x16x32_bf16 v[220:223], v[244:247], v[116:119], v[220:223]
s_waitcnt lgkmcnt(2)
v_mfma_f32_16x16x32_bf16 v[208:211], v[224:227], v[24:27], v[208:211]
ds_read_b128 v[240:243], v248 offset:53248
v_mfma_f32_16x16x32_bf16 v[208:211], v[228:231], v[28:31], v[208:211]
v_exp_f32 v205, v205
v_mfma_f32_16x16x32_bf16 v[212:215], v[224:227], v[56:59], v[212:215]
v_exp_f32 v206, v206
v_mfma_f32_16x16x32_bf16 v[212:215], v[228:231], v[60:63], v[212:215]
v_exp_f32 v207, v207
v_mfma_f32_16x16x32_bf16 v[216:219], v[224:227], v[88:91], v[216:219]
ds_read_b128 v[244:247], v248 offset:53760
v_cvt_pk_bf16_f32 v172, v204, v205
v_mfma_f32_16x16x32_bf16 v[216:219], v[228:231], v[92:95], v[216:219]
v_cvt_pk_bf16_f32 v173, v206, v207
v_mfma_f32_16x16x32_bf16 v[220:223], v[224:227], v[120:123], v[220:223]
v_mfma_f32_16x16x32_bf16 v[220:223], v[228:231], v[124:127], v[220:223]
s_waitcnt lgkmcnt(2)
v_mfma_f32_16x16x32_bf16 v[192:195], v[232:235], v[0:3], 0
ds_read_b128 v[224:227], v248 offset:57344
v_mfma_f32_16x16x32_bf16 v[192:195], v[236:239], v[4:7], v[192:195]
v_exp_f32 v208, v208
v_mfma_f32_16x16x32_bf16 v[196:199], v[232:235], v[32:35], 0
v_exp_f32 v209, v209
v_mfma_f32_16x16x32_bf16 v[196:199], v[236:239], v[36:39], v[196:199]
v_exp_f32 v210, v210
v_mfma_f32_16x16x32_bf16 v[200:203], v[232:235], v[64:67], 0
ds_read_b128 v[228:231], v248 offset:57856
v_cvt_pk_bf16_f32 v162, v208, v209
v_mfma_f32_16x16x32_bf16 v[200:203], v[236:239], v[68:71], v[200:203]
v_exp_f32 v211, v211
v_mfma_f32_16x16x32_bf16 v[204:207], v[232:235], v[96:99], 0
v_exp_f32 v212, v212
v_mfma_f32_16x16x32_bf16 v[204:207], v[236:239], v[100:103], v[204:207]
s_waitcnt lgkmcnt(2)
v_cvt_pk_bf16_f32 v163, v210, v211
v_mfma_f32_16x16x32_bf16 v[192:195], v[240:243], v[8:11], v[192:195]
ds_read_b128 v[232:235], v248 offset:61440
v_mfma_f32_16x16x32_bf16 v[192:195], v[244:247], v[12:15], v[192:195]
v_exp_f32 v213, v213
v_mfma_f32_16x16x32_bf16 v[196:199], v[240:243], v[40:43], v[196:199]
v_exp_f32 v214, v214
v_mfma_f32_16x16x32_bf16 v[196:199], v[244:247], v[44:47], v[196:199]
v_exp_f32 v215, v215
v_mfma_f32_16x16x32_bf16 v[200:203], v[240:243], v[72:75], v[200:203]
ds_read_b128 v[236:239], v248 offset:61952
v_cvt_pk_bf16_f32 v166, v212, v213
v_mfma_f32_16x16x32_bf16 v[200:203], v[244:247], v[76:79], v[200:203]
v_cvt_pk_bf16_f32 v167, v214, v215
v_mfma_f32_16x16x32_bf16 v[204:207], v[240:243], v[104:107], v[204:207]
v_exp_f32 v216, v216
v_mfma_f32_16x16x32_bf16 v[204:207], v[244:247], v[108:111], v[204:207]
s_waitcnt lgkmcnt(2)
v_mfma_f32_16x16x32_bf16 v[192:195], v[224:227], v[16:19], v[192:195]
ds_read_b128 v[240:243], v248 offset:51200
v_mfma_f32_16x16x32_bf16 v[192:195], v[228:231], v[20:23], v[192:195]
v_exp_f32 v217, v217
v_mfma_f32_16x16x32_bf16 v[196:199], v[224:227], v[48:51], v[196:199]
v_exp_f32 v218, v218
v_mfma_f32_16x16x32_bf16 v[196:199], v[228:231], v[52:55], v[196:199]
v_exp_f32 v219, v219
v_mfma_f32_16x16x32_bf16 v[200:203], v[224:227], v[80:83], v[200:203]
ds_read_b128 v[244:247], v248 offset:51712
v_cvt_pk_bf16_f32 v170, v216, v217
v_mfma_f32_16x16x32_bf16 v[200:203], v[228:231], v[84:87], v[200:203]
v_cvt_pk_bf16_f32 v171, v218, v219
v_mfma_f32_16x16x32_bf16 v[204:207], v[224:227], v[112:115], v[204:207]
v_exp_f32 v220, v220
v_mfma_f32_16x16x32_bf16 v[204:207], v[228:231], v[116:119], v[204:207]
s_waitcnt lgkmcnt(2)
v_mfma_f32_16x16x32_bf16 v[192:195], v[232:235], v[24:27], v[192:195]
ds_read_b128 v[224:227], v248 offset:55296
v_mfma_f32_16x16x32_bf16 v[192:195], v[236:239], v[28:31], v[192:195]
v_exp_f32 v221, v221
v_mfma_f32_16x16x32_bf16 v[196:199], v[232:235], v[56:59], v[196:199]
v_exp_f32 v222, v222
v_mfma_f32_16x16x32_bf16 v[196:199], v[236:239], v[60:63], v[196:199]
v_exp_f32 v223, v223
v_mfma_f32_16x16x32_bf16 v[200:203], v[232:235], v[88:91], v[200:203]
ds_read_b128 v[228:231], v248 offset:55808
v_cvt_pk_bf16_f32 v174, v220, v221
v_mfma_f32_16x16x32_bf16 v[200:203], v[236:239], v[92:95], v[200:203]
v_cvt_pk_bf16_f32 v175, v222, v223
v_mfma_f32_16x16x32_bf16 v[204:207], v[232:235], v[120:123], v[204:207]
v_mfma_f32_16x16x32_bf16 v[204:207], v[236:239], v[124:127], v[204:207]
s_waitcnt lgkmcnt(2)
v_mfma_f32_16x16x32_bf16 v[208:211], v[240:243], v[0:3], 0
ds_read_b128 v[232:235], v248 offset:59392
v_mfma_f32_16x16x32_bf16 v[208:211], v[244:247], v[4:7], v[208:211]
v_exp_f32 v192, v192
v_mfma_f32_16x16x32_bf16 v[212:215], v[240:243], v[32:35], 0
v_exp_f32 v193, v193
v_mfma_f32_16x16x32_bf16 v[212:215], v[244:247], v[36:39], v[212:215]
v_exp_f32 v194, v194
v_mfma_f32_16x16x32_bf16 v[216:219], v[240:243], v[64:67], 0
ds_read_b128 v[236:239], v248 offset:59904
v_cvt_pk_bf16_f32 v176, v192, v193
v_mfma_f32_16x16x32_bf16 v[216:219], v[244:247], v[68:71], v[216:219]
v_exp_f32 v195, v195
v_mfma_f32_16x16x32_bf16 v[220:223], v[240:243], v[96:99], 0
v_exp_f32 v196, v196
v_mfma_f32_16x16x32_bf16 v[220:223], v[244:247], v[100:103], v[220:223]
s_waitcnt lgkmcnt(2)
v_cvt_pk_bf16_f32 v177, v194, v195
v_mfma_f32_16x16x32_bf16 v[208:211], v[224:227], v[8:11], v[208:211]
ds_read_b128 v[240:243], v248 offset:63488
v_mfma_f32_16x16x32_bf16 v[208:211], v[228:231], v[12:15], v[208:211]
v_exp_f32 v197, v197
v_mfma_f32_16x16x32_bf16 v[212:215], v[224:227], v[40:43], v[212:215]
v_exp_f32 v198, v198
v_mfma_f32_16x16x32_bf16 v[212:215], v[228:231], v[44:47], v[212:215]
v_exp_f32 v199, v199
v_mfma_f32_16x16x32_bf16 v[216:219], v[224:227], v[72:75], v[216:219]
ds_read_b128 v[244:247], v248 offset:64000
v_cvt_pk_bf16_f32 v180, v196, v197
v_mfma_f32_16x16x32_bf16 v[216:219], v[228:231], v[76:79], v[216:219]
v_cvt_pk_bf16_f32 v181, v198, v199
v_mfma_f32_16x16x32_bf16 v[220:223], v[224:227], v[104:107], v[220:223]
v_exp_f32 v200, v200
v_mfma_f32_16x16x32_bf16 v[220:223], v[228:231], v[108:111], v[220:223]
s_waitcnt lgkmcnt(2)
v_xor_b32 v248, 0x10000, v248
v_mfma_f32_16x16x32_bf16 v[208:211], v[232:235], v[16:19], v[208:211]
ds_read_b128 v[224:227], v248 offset:0
v_mfma_f32_16x16x32_bf16 v[208:211], v[236:239], v[20:23], v[208:211]
v_exp_f32 v201, v201
v_mfma_f32_16x16x32_bf16 v[212:215], v[232:235], v[48:51], v[212:215]
v_exp_f32 v202, v202
v_mfma_f32_16x16x32_bf16 v[212:215], v[236:239], v[52:55], v[212:215]
v_exp_f32 v203, v203
v_mfma_f32_16x16x32_bf16 v[216:219], v[232:235], v[80:83], v[216:219]
ds_read_b128 v[228:231], v248 offset:512
v_cvt_pk_bf16_f32 v184, v200, v201
v_mfma_f32_16x16x32_bf16 v[216:219], v[236:239], v[84:87], v[216:219]
v_cvt_pk_bf16_f32 v185, v202, v203
v_mfma_f32_16x16x32_bf16 v[220:223], v[232:235], v[112:115], v[220:223]
v_exp_f32 v204, v204
v_mfma_f32_16x16x32_bf16 v[220:223], v[236:239], v[116:119], v[220:223]
s_waitcnt lgkmcnt(2)
v_mfma_f32_16x16x32_bf16 v[208:211], v[240:243], v[24:27], v[208:211]
ds_read_b128 v[232:235], v248 offset:4096
v_mfma_f32_16x16x32_bf16 v[208:211], v[244:247], v[28:31], v[208:211]
v_exp_f32 v205, v205
v_mfma_f32_16x16x32_bf16 v[212:215], v[240:243], v[56:59], v[212:215]
v_exp_f32 v206, v206
v_mfma_f32_16x16x32_bf16 v[212:215], v[244:247], v[60:63], v[212:215]
v_exp_f32 v207, v207
v_mfma_f32_16x16x32_bf16 v[216:219], v[240:243], v[88:91], v[216:219]
ds_read_b128 v[236:239], v248 offset:4608
v_cvt_pk_bf16_f32 v188, v204, v205
v_mfma_f32_16x16x32_bf16 v[216:219], v[244:247], v[92:95], v[216:219]
v_cvt_pk_bf16_f32 v189, v206, v207
v_mfma_f32_16x16x32_bf16 v[220:223], v[240:243], v[120:123], v[220:223]
v_mfma_f32_16x16x32_bf16 v[220:223], v[244:247], v[124:127], v[220:223]
s_waitcnt lgkmcnt(2)
v_mfma_f32_16x16x32_bf16 v[192:195], v[224:227], v[0:3], 0
ds_read_b128 v[240:243], v248 offset:8192
v_mfma_f32_16x16x32_bf16 v[192:195], v[228:231], v[4:7], v[192:195]
v_exp_f32 v208, v208
v_mfma_f32_16x16x32_bf16 v[196:199], v[224:227], v[32:35], 0
v_exp_f32 v209, v209
v_mfma_f32_16x16x32_bf16 v[196:199], v[228:231], v[36:39], v[196:199]
v_exp_f32 v210, v210
v_mfma_f32_16x16x32_bf16 v[200:203], v[224:227], v[64:67], 0
ds_read_b128 v[244:247], v248 offset:8704
v_cvt_pk_bf16_f32 v178, v208, v209
v_mfma_f32_16x16x32_bf16 v[200:203], v[228:231], v[68:71], v[200:203]
v_exp_f32 v211, v211
v_mfma_f32_16x16x32_bf16 v[204:207], v[224:227], v[96:99], 0
v_exp_f32 v212, v212
v_mfma_f32_16x16x32_bf16 v[204:207], v[228:231], v[100:103], v[204:207]
s_waitcnt lgkmcnt(2)
v_cvt_pk_bf16_f32 v179, v210, v211
v_mfma_f32_16x16x32_bf16 v[192:195], v[232:235], v[8:11], v[192:195]
ds_read_b128 v[224:227], v248 offset:12288
v_mfma_f32_16x16x32_bf16 v[192:195], v[236:239], v[12:15], v[192:195]
v_exp_f32 v213, v213
v_mfma_f32_16x16x32_bf16 v[196:199], v[232:235], v[40:43], v[196:199]
v_exp_f32 v214, v214
v_mfma_f32_16x16x32_bf16 v[196:199], v[236:239], v[44:47], v[196:199]
v_exp_f32 v215, v215
v_mfma_f32_16x16x32_bf16 v[200:203], v[232:235], v[72:75], v[200:203]
ds_read_b128 v[228:231], v248 offset:12800
v_cvt_pk_bf16_f32 v182, v212, v213
v_mfma_f32_16x16x32_bf16 v[200:203], v[236:239], v[76:79], v[200:203]
v_cvt_pk_bf16_f32 v183, v214, v215
v_mfma_f32_16x16x32_bf16 v[204:207], v[232:235], v[104:107], v[204:207]
v_exp_f32 v216, v216
v_mfma_f32_16x16x32_bf16 v[204:207], v[236:239], v[108:111], v[204:207]
s_waitcnt lgkmcnt(2)
v_mfma_f32_16x16x32_bf16 v[192:195], v[240:243], v[16:19], v[192:195]
ds_read_b128 v[232:235], v248 offset:2048
v_mfma_f32_16x16x32_bf16 v[192:195], v[244:247], v[20:23], v[192:195]
v_exp_f32 v217, v217
v_mfma_f32_16x16x32_bf16 v[196:199], v[240:243], v[48:51], v[196:199]
v_exp_f32 v218, v218
v_mfma_f32_16x16x32_bf16 v[196:199], v[244:247], v[52:55], v[196:199]
v_exp_f32 v219, v219
v_mfma_f32_16x16x32_bf16 v[200:203], v[240:243], v[80:83], v[200:203]
ds_read_b128 v[236:239], v248 offset:2560
v_cvt_pk_bf16_f32 v186, v216, v217
v_mfma_f32_16x16x32_bf16 v[200:203], v[244:247], v[84:87], v[200:203]
v_cvt_pk_bf16_f32 v187, v218, v219
v_mfma_f32_16x16x32_bf16 v[204:207], v[240:243], v[112:115], v[204:207]
v_exp_f32 v220, v220
v_mfma_f32_16x16x32_bf16 v[204:207], v[244:247], v[116:119], v[204:207]
s_waitcnt lgkmcnt(2)
v_mfma_f32_16x16x32_bf16 v[192:195], v[224:227], v[24:27], v[192:195]
ds_read_b128 v[240:243], v248 offset:6144
v_mfma_f32_16x16x32_bf16 v[192:195], v[228:231], v[28:31], v[192:195]
v_exp_f32 v221, v221
v_mfma_f32_16x16x32_bf16 v[196:199], v[224:227], v[56:59], v[196:199]
v_exp_f32 v222, v222
v_mfma_f32_16x16x32_bf16 v[196:199], v[228:231], v[60:63], v[196:199]
v_exp_f32 v223, v223
v_mfma_f32_16x16x32_bf16 v[200:203], v[224:227], v[88:91], v[200:203]
ds_read_b128 v[244:247], v248 offset:6656
v_cvt_pk_bf16_f32 v190, v220, v221
v_mfma_f32_16x16x32_bf16 v[200:203], v[228:231], v[92:95], v[200:203]
v_cvt_pk_bf16_f32 v191, v222, v223
v_mfma_f32_16x16x32_bf16 v[204:207], v[224:227], v[120:123], v[204:207]
v_mfma_f32_16x16x32_bf16 v[204:207], v[228:231], v[124:127], v[204:207]
s_waitcnt lgkmcnt(2)
v_mfma_f32_16x16x32_bf16 v[208:211], v[232:235], v[0:3], 0
ds_read_b128 v[224:227], v248 offset:10240
v_mfma_f32_16x16x32_bf16 v[208:211], v[236:239], v[4:7], v[208:211]
v_exp_f32 v192, v192
v_mfma_f32_16x16x32_bf16 v[212:215], v[232:235], v[32:35], 0
v_exp_f32 v193, v193
v_mfma_f32_16x16x32_bf16 v[212:215], v[236:239], v[36:39], v[212:215]
v_exp_f32 v194, v194
v_mfma_f32_16x16x32_bf16 v[216:219], v[232:235], v[64:67], 0
ds_read_b128 v[228:231], v248 offset:10752
v_cvt_pk_bf16_f32 v0, v192, v193
v_mfma_f32_16x16x32_bf16 v[216:219], v[236:239], v[68:71], v[216:219]
v_exp_f32 v195, v195
v_mfma_f32_16x16x32_bf16 v[220:223], v[232:235], v[96:99], 0
v_exp_f32 v196, v196
v_mfma_f32_16x16x32_bf16 v[220:223], v[236:239], v[100:103], v[220:223]
s_waitcnt lgkmcnt(2)
v_cvt_pk_bf16_f32 v1, v194, v195
v_mfma_f32_16x16x32_bf16 v[208:211], v[240:243], v[8:11], v[208:211]
ds_read_b128 v[232:235], v248 offset:14336
v_mfma_f32_16x16x32_bf16 v[208:211], v[244:247], v[12:15], v[208:211]
v_exp_f32 v197, v197
v_mfma_f32_16x16x32_bf16 v[212:215], v[240:243], v[40:43], v[212:215]
ds_read_b128 v[4:7], v255 offset:0
ds_read_b128 v[36:39], v255 offset:1024
v_mfma_f32_16x16x32_bf16 v[212:215], v[244:247], v[44:47], v[212:215]
v_exp_f32 v198, v198
v_mfma_f32_16x16x32_bf16 v[216:219], v[240:243], v[72:75], v[216:219]
ds_read_b128 v[236:239], v248 offset:14848
v_xor_b32 v12, 0x10000, v249
v_mfma_f32_16x16x32_bf16 v[216:219], v[244:247], v[76:79], v[216:219]
v_xor_b32 v13, 0x10000, v250
v_cvt_pk_bf16_f32 v32, v196, v197
v_mfma_f32_16x16x32_bf16 v[220:223], v[240:243], v[104:107], v[220:223]
ds_read_b128 v[68:71], v255 offset:2048
ds_read_b128 v[100:103], v255 offset:3072
v_mfma_f32_16x16x32_bf16 v[220:223], v[244:247], v[108:111], v[220:223]
s_waitcnt lgkmcnt(6)
v_mfma_f32_16x16x32_bf16 v[208:211], v[224:227], v[16:19], v[208:211]
ds_read_b64_tr_b16 v[240:241], v12 offset:0
ds_read_b64_tr_b16 v[242:243], v12 offset:2048
v_mfma_f32_16x16x32_bf16 v[208:211], v[228:231], v[20:23], v[208:211]
v_exp_f32 v199, v199
v_mfma_f32_16x16x32_bf16 v[212:215], v[224:227], v[48:51], v[212:215]
ds_read_b128 v[8:11], v255 offset:4096
ds_read_b128 v[40:43], v255 offset:5120
v_mfma_f32_16x16x32_bf16 v[212:215], v[228:231], v[52:55], v[212:215]
v_cvt_pk_bf16_f32 v33, v198, v199
v_mfma_f32_16x16x32_bf16 v[216:219], v[224:227], v[80:83], v[216:219]
ds_read_b64_tr_b16 v[244:245], v12 offset:16384
ds_read_b64_tr_b16 v[246:247], v12 offset:18432
v_mfma_f32_16x16x32_bf16 v[216:219], v[228:231], v[84:87], v[216:219]
v_exp_f32 v200, v200
v_mfma_f32_16x16x32_bf16 v[220:223], v[224:227], v[112:115], v[220:223]
ds_read_b128 v[72:75], v255 offset:6144
ds_read_b128 v[104:107], v255 offset:7168
v_mfma_f32_16x16x32_bf16 v[220:223], v[228:231], v[116:119], v[220:223]
s_waitcnt lgkmcnt(10)
v_mfma_f32_16x16x32_bf16 v[208:211], v[232:235], v[24:27], v[208:211]
ds_read_b64_tr_b16 v[224:225], v12 offset:32768
ds_read_b64_tr_b16 v[226:227], v12 offset:34816
v_mfma_f32_16x16x32_bf16 v[208:211], v[236:239], v[28:31], v[208:211]
v_exp_f32 v201, v201
v_mfma_f32_16x16x32_bf16 v[212:215], v[232:235], v[56:59], v[212:215]
v_exp_f32 v202, v202
v_mfma_f32_16x16x32_bf16 v[212:215], v[236:239], v[60:63], v[212:215]
v_exp_f32 v203, v203
v_mfma_f32_16x16x32_bf16 v[216:219], v[232:235], v[88:91], v[216:219]
ds_read_b64_tr_b16 v[228:229], v12 offset:49152
ds_read_b64_tr_b16 v[230:231], v12 offset:51200
v_mfma_f32_16x16x32_bf16 v[216:219], v[236:239], v[92:95], v[216:219]
v_cvt_pk_bf16_f32 v64, v200, v201
v_cvt_pk_bf16_f32 v65, v202, v203
v_mfma_f32_16x16x32_bf16 v[220:223], v[232:235], v[120:123], v[220:223]
v_exp_f32 v204, v204
v_mfma_f32_16x16x32_bf16 v[220:223], v[236:239], v[124:127], v[220:223]
s_waitcnt lgkmcnt(6)
s_waitcnt lgkmcnt(4)
v_mfma_f32_16x16x32_bf16 a[0:3], v[240:243], v[128:131], a[0:3]
ds_read_b64_tr_b16 v[232:233], v13 offset:0
ds_read_b64_tr_b16 v[234:235], v13 offset:2048
v_mfma_f32_16x16x32_bf16 a[0:3], v[244:247], v[144:147], a[0:3]
v_exp_f32 v205, v205
v_mfma_f32_16x16x32_bf16 a[4:7], v[240:243], v[132:135], a[4:7]
v_exp_f32 v206, v206
v_mfma_f32_16x16x32_bf16 a[4:7], v[244:247], v[148:151], a[4:7]
v_exp_f32 v207, v207
v_mfma_f32_16x16x32_bf16 a[8:11], v[240:243], v[136:139], a[8:11]
ds_read_b64_tr_b16 v[236:237], v13 offset:16384
ds_read_b64_tr_b16 v[238:239], v13 offset:18432
v_mfma_f32_16x16x32_bf16 a[8:11], v[244:247], v[152:155], a[8:11]
v_cvt_pk_bf16_f32 v96, v204, v205
v_cvt_pk_bf16_f32 v97, v206, v207
v_mfma_f32_16x16x32_bf16 a[12:15], v[240:243], v[140:143], a[12:15]
v_exp_f32 v208, v208
v_mfma_f32_16x16x32_bf16 a[12:15], v[244:247], v[156:159], a[12:15]
s_waitcnt lgkmcnt(4)
v_mfma_f32_16x16x32_bf16 a[0:3], v[224:227], v[160:163], a[0:3]
ds_read_b64_tr_b16 v[240:241], v13 offset:32768
ds_read_b64_tr_b16 v[242:243], v13 offset:34816
v_mfma_f32_16x16x32_bf16 a[0:3], v[228:231], v[176:179], a[0:3]
v_exp_f32 v209, v209
v_mfma_f32_16x16x32_bf16 a[4:7], v[224:227], v[164:167], a[4:7]
v_exp_f32 v210, v210
v_mfma_f32_16x16x32_bf16 a[4:7], v[228:231], v[180:183], a[4:7]
v_exp_f32 v211, v211
v_mfma_f32_16x16x32_bf16 a[8:11], v[224:227], v[168:171], a[8:11]
ds_read_b64_tr_b16 v[244:245], v13 offset:49152
ds_read_b64_tr_b16 v[246:247], v13 offset:51200
v_mfma_f32_16x16x32_bf16 a[8:11], v[228:231], v[184:187], a[8:11]
v_cvt_pk_bf16_f32 v2, v208, v209
v_cvt_pk_bf16_f32 v3, v210, v211
v_mfma_f32_16x16x32_bf16 a[12:15], v[224:227], v[172:175], a[12:15]
v_exp_f32 v212, v212
v_mfma_f32_16x16x32_bf16 a[12:15], v[228:231], v[188:191], a[12:15]
s_waitcnt lgkmcnt(4)
v_mfma_f32_16x16x32_bf16 a[16:19], v[232:235], v[128:131], a[16:19]
ds_read_b64_tr_b16 v[224:225], v249 offset:33280
ds_read_b64_tr_b16 v[226:227], v249 offset:35328
v_mfma_f32_16x16x32_bf16 a[16:19], v[236:239], v[144:147], a[16:19]
v_exp_f32 v213, v213
v_mfma_f32_16x16x32_bf16 a[20:23], v[232:235], v[132:135], a[20:23]
v_exp_f32 v214, v214
v_mfma_f32_16x16x32_bf16 a[20:23], v[236:239], v[148:151], a[20:23]
v_exp_f32 v215, v215
v_mfma_f32_16x16x32_bf16 a[24:27], v[232:235], v[136:139], a[24:27]
ds_read_b64_tr_b16 v[228:229], v249 offset:49664
ds_read_b64_tr_b16 v[230:231], v249 offset:51712
v_mfma_f32_16x16x32_bf16 a[24:27], v[236:239], v[152:155], a[24:27]
v_cvt_pk_bf16_f32 v34, v212, v213
v_cvt_pk_bf16_f32 v35, v214, v215
v_mfma_f32_16x16x32_bf16 a[28:31], v[232:235], v[140:143], a[28:31]
v_exp_f32 v216, v216
v_mfma_f32_16x16x32_bf16 a[28:31], v[236:239], v[156:159], a[28:31]
s_waitcnt lgkmcnt(4)
v_mfma_f32_16x16x32_bf16 a[16:19], v[240:243], v[160:163], a[16:19]
ds_read_b64_tr_b16 v[232:233], v249 offset:0
ds_read_b64_tr_b16 v[234:235], v249 offset:2048
v_mfma_f32_16x16x32_bf16 a[16:19], v[244:247], v[176:179], a[16:19]
v_exp_f32 v217, v217
v_mfma_f32_16x16x32_bf16 a[20:23], v[240:243], v[164:167], a[20:23]
v_exp_f32 v218, v218
v_mfma_f32_16x16x32_bf16 a[20:23], v[244:247], v[180:183], a[20:23]
v_exp_f32 v219, v219
v_mfma_f32_16x16x32_bf16 a[24:27], v[240:243], v[168:171], a[24:27]
ds_read_b64_tr_b16 v[236:237], v250 offset:0
ds_read_b64_tr_b16 v[238:239], v250 offset:2048
v_mfma_f32_16x16x32_bf16 a[24:27], v[244:247], v[184:187], a[24:27]
v_cvt_pk_bf16_f32 v66, v216, v217
v_cvt_pk_bf16_f32 v67, v218, v219
v_mfma_f32_16x16x32_bf16 a[28:31], v[240:243], v[172:175], a[28:31]
v_exp_f32 v220, v220
v_mfma_f32_16x16x32_bf16 a[28:31], v[244:247], v[188:191], a[28:31]
s_waitcnt lgkmcnt(4)
v_mfma_f32_16x16x32_bf16 a[32:35], v[224:227], v[4:7], a[32:35]
ds_read_b64_tr_b16 v[240:241], v12 offset:512
ds_read_b64_tr_b16 v[242:243], v12 offset:2560
v_mfma_f32_16x16x32_bf16 a[32:35], v[228:231], v[8:11], a[32:35]
v_exp_f32 v221, v221
v_mfma_f32_16x16x32_bf16 a[36:39], v[224:227], v[36:39], a[36:39]
v_exp_f32 v222, v222
v_mfma_f32_16x16x32_bf16 a[36:39], v[228:231], v[40:43], a[36:39]
v_exp_f32 v223, v223
v_mfma_f32_16x16x32_bf16 a[40:43], v[224:227], v[68:71], a[40:43]
ds_read_b64_tr_b16 v[244:245], v12 offset:16896
ds_read_b64_tr_b16 v[246:247], v12 offset:18944
v_mfma_f32_16x16x32_bf16 a[40:43], v[228:231], v[72:75], a[40:43]
v_cvt_pk_bf16_f32 v98, v220, v221
v_cvt_pk_bf16_f32 v99, v222, v223
v_mfma_f32_16x16x32_bf16 a[44:47], v[224:227], v[100:103], a[44:47]
v_mfma_f32_16x16x32_bf16 a[44:47], v[228:231], v[104:107], a[44:47]
s_waitcnt lgkmcnt(4)
v_mfma_f32_16x16x32_bf16 a[0:3], v[232:235], v[0:3], a[0:3]
ds_read_b64_tr_b16 v[224:225], v12 offset:33280
ds_read_b64_tr_b16 v[226:227], v12 offset:35328
v_mfma_f32_16x16x32_bf16 a[4:7], v[232:235], v[32:35], a[4:7]
v_mfma_f32_16x16x32_bf16 a[8:11], v[232:235], v[64:67], a[8:11]
v_mfma_f32_16x16x32_bf16 a[12:15], v[232:235], v[96:99], a[12:15]
v_mfma_f32_16x16x32_bf16 a[16:19], v[236:239], v[0:3], a[16:19]
ds_read_b64_tr_b16 v[228:229], v12 offset:49664
ds_read_b64_tr_b16 v[230:231], v12 offset:51712
v_mfma_f32_16x16x32_bf16 a[20:23], v[236:239], v[32:35], a[20:23]
v_mfma_f32_16x16x32_bf16 a[24:27], v[236:239], v[64:67], a[24:27]
v_mfma_f32_16x16x32_bf16 a[28:31], v[236:239], v[96:99], a[28:31]
s_waitcnt lgkmcnt(4)
v_mfma_f32_16x16x32_bf16 a[32:35], v[240:243], v[128:131], a[32:35]
ds_read_b64_tr_b16 v[232:233], v249 offset:512
ds_read_b64_tr_b16 v[234:235], v249 offset:2560
v_mfma_f32_16x16x32_bf16 a[32:35], v[244:247], v[144:147], a[32:35]
v_mfma_f32_16x16x32_bf16 a[36:39], v[240:243], v[132:135], a[36:39]
v_mfma_f32_16x16x32_bf16 a[36:39], v[244:247], v[148:151], a[36:39]
v_mfma_f32_16x16x32_bf16 a[40:43], v[240:243], v[136:139], a[40:43]
ds_read_b64_tr_b16 v[236:237], v250 offset:512
ds_read_b64_tr_b16 v[238:239], v250 offset:2560
v_accvgpr_read_b32 v192, a0
v_mfma_f32_16x16x32_bf16 a[40:43], v[244:247], v[152:155], a[40:43]
v_accvgpr_read_b32 v193, a4
v_accvgpr_read_b32 v194, a8
v_accvgpr_read_b32 v195, a12
v_mfma_f32_16x16x32_bf16 a[44:47], v[240:243], v[140:143], a[44:47]
v_lshlrev_b32 v253, 2, v252
v_subrev_u32 v196, 0x0d800000, v192
v_subrev_u32 v197, 0x0d800000, v193
v_mfma_f32_16x16x32_bf16 a[44:47], v[244:247], v[156:159], a[44:47]
s_waitcnt lgkmcnt(4)
v_subrev_u32 v198, 0x0d800000, v194
v_subrev_u32 v199, 0x0d800000, v195
v_mfma_f32_16x16x32_bf16 a[32:35], v[224:227], v[160:163], a[32:35]
ds_read_b64_tr_b16 v[240:241], v250 offset:33280
ds_read_b64_tr_b16 v[242:243], v250 offset:35328
v_max3_u32 v254, v196, v197, v198
v_mfma_f32_16x16x32_bf16 a[32:35], v[228:231], v[176:179], a[32:35]
v_max_u32 v254, v254, v199
v_mfma_f32_16x16x32_bf16 a[36:39], v[224:227], v[164:167], a[36:39]
s_mov_b64 exec, 0xffff
s_xor_b32 s35, s48, 0
buffer_store_dword v192, v253, s[24:27], s35 offen offset:4 sc1
s_xor_b32 s35, s48, 1024
buffer_store_dword v193, v253, s[24:27], s35 offen offset:4 sc1
s_xor_b32 s35, s48, 2048
buffer_store_dword v194, v253, s[24:27], s35 offen offset:4 sc1
s_xor_b32 s35, s48, 3072
buffer_store_dword v195, v253, s[24:27], s35 offen offset:4 sc1
v_cmp_le_u32 vcc, 0x64000000, v254
s_mov_b64 exec, -1
v_mfma_f32_16x16x32_bf16 a[36:39], v[228:231], v[180:183], a[36:39]
v_accvgpr_read_b32 v192, a0
v_accvgpr_read_b32 v193, a1
v_mfma_f32_16x16x32_bf16 a[40:43], v[224:227], v[168:171], a[40:43]
ds_read_b64_tr_b16 v[244:245], v250 offset:49664
ds_read_b64_tr_b16 v[246:247], v250 offset:51712
v_mfma_f32_16x16x32_bf16 a[40:43], v[228:231], v[184:187], a[40:43]
v_accvgpr_read_b32 v194, a2
v_accvgpr_read_b32 v195, a3
v_mfma_f32_16x16x32_bf16 a[44:47], v[224:227], v[172:175], a[44:47]
v_cvt_pk_bf16_f32 v16, v192, v193
v_cvt_pk_bf16_f32 v17, v194, v195
v_mfma_f32_16x16x32_bf16 a[44:47], v[228:231], v[188:191], a[44:47]
s_waitcnt lgkmcnt(4)
v_accvgpr_read_b32 v200, a4
v_mfma_f32_16x16x32_bf16 a[32:35], v[232:235], v[0:3], a[32:35]
ds_read_b64_tr_b16 v[224:225], v13 offset:512
ds_read_b64_tr_b16 v[226:227], v13 offset:2560
v_mfma_f32_16x16x32_bf16 a[36:39], v[232:235], v[32:35], a[36:39]
v_accvgpr_read_b32 v201, a5
v_accvgpr_read_b32 v202, a6
v_mfma_f32_16x16x32_bf16 a[40:43], v[232:235], v[64:67], a[40:43]
v_accvgpr_read_b32 v203, a7
v_cvt_pk_bf16_f32 v48, v200, v201
v_mfma_f32_16x16x32_bf16 a[44:47], v[232:235], v[96:99], a[44:47]
v_cvt_pk_bf16_f32 v49, v202, v203
v_accvgpr_read_b32 v208, a8
v_mfma_f32_16x16x32_bf16 a[48:51], v[236:239], v[0:3], a[48:51]
ds_read_b64_tr_b16 v[228:229], v13 offset:16896
ds_read_b64_tr_b16 v[230:231], v13 offset:18944
v_mfma_f32_16x16x32_bf16 a[52:55], v[236:239], v[32:35], a[52:55]
v_accvgpr_read_b32 v209, a9
v_accvgpr_read_b32 v210, a10
v_mfma_f32_16x16x32_bf16 a[56:59], v[236:239], v[64:67], a[56:59]
v_accvgpr_read_b32 v211, a11
v_cvt_pk_bf16_f32 v80, v208, v209
v_mfma_f32_16x16x32_bf16 a[60:63], v[236:239], v[96:99], a[60:63]
s_waitcnt lgkmcnt(4)
v_cvt_pk_bf16_f32 v81, v210, v211
v_mfma_f32_16x16x32_bf16 a[48:51], v[240:243], v[4:7], a[48:51]
ds_read_b64_tr_b16 v[232:233], v13 offset:33280
ds_read_b64_tr_b16 v[234:235], v13 offset:35328
v_mfma_f32_16x16x32_bf16 a[48:51], v[244:247], v[8:11], a[48:51]
v_accvgpr_read_b32 v216, a12
v_accvgpr_read_b32 v217, a13
v_mfma_f32_16x16x32_bf16 a[52:55], v[240:243], v[36:39], a[52:55]
v_accvgpr_read_b32 v218, a14
v_accvgpr_read_b32 v219, a15
v_mfma_f32_16x16x32_bf16 a[52:55], v[244:247], v[40:43], a[52:55]
v_cvt_pk_bf16_f32 v112, v216, v217
v_cvt_pk_bf16_f32 v113, v218, v219
v_mfma_f32_16x16x32_bf16 a[56:59], v[240:243], v[68:71], a[56:59]
ds_read_b64_tr_b16 v[236:237], v13 offset:49664
ds_read_b64_tr_b16 v[238:239], v13 offset:51712
v_mfma_f32_16x16x32_bf16 a[56:59], v[244:247], v[72:75], a[56:59]
v_accvgpr_read_b32 v196, a16
v_accvgpr_read_b32 v197, a17
v_mfma_f32_16x16x32_bf16 a[60:63], v[240:243], v[100:103], a[60:63]
v_accvgpr_read_b32 v198, a18
v_accvgpr_read_b32 v199, a19
v_mfma_f32_16x16x32_bf16 a[60:63], v[244:247], v[104:107], a[60:63]
s_waitcnt lgkmcnt(4)
v_cvt_pk_bf16_f32 v18, v196, v197
v_mfma_f32_16x16x32_bf16 a[48:51], v[224:227], v[128:131], a[48:51]
ds_read_b64_tr_b16 v[240:241], v249 offset:36864
ds_read_b64_tr_b16 v[242:243], v249 offset:38912
v_mfma_f32_16x16x32_bf16 a[48:51], v[228:231], v[144:147], a[48:51]
v_cvt_pk_bf16_f32 v19, v198, v199
buffer_store_dwordx4 v[16:19], v252, s[20:23], s40 offen offset:0 sc1
v_mfma_f32_16x16x32_bf16 a[52:55], v[224:227], v[132:135], a[52:55]
v_accvgpr_read_b32 v204, a20
v_accvgpr_read_b32 v205, a21
v_mfma_f32_16x16x32_bf16 a[52:55], v[228:231], v[148:151], a[52:55]
v_accvgpr_read_b32 v206, a22
v_accvgpr_read_b32 v207, a23
v_mfma_f32_16x16x32_bf16 a[56:59], v[224:227], v[136:139], a[56:59]
ds_read_b64_tr_b16 v[244:245], v249 offset:53248
ds_read_b64_tr_b16 v[246:247], v249 offset:55296
v_mfma_f32_16x16x32_bf16 a[56:59], v[228:231], v[152:155], a[56:59]
v_cvt_pk_bf16_f32 v50, v204, v205
v_cvt_pk_bf16_f32 v51, v206, v207
v_mfma_f32_16x16x32_bf16 a[60:63], v[224:227], v[140:143], a[60:63]
buffer_store_dwordx4 v[48:51], v252, s[20:23], s41 offen offset:0 sc1
v_accvgpr_read_b32 v212, a24
v_mfma_f32_16x16x32_bf16 a[60:63], v[228:231], v[156:159], a[60:63]
s_waitcnt lgkmcnt(4)
v_accvgpr_read_b32 v213, a25
v_mfma_f32_16x16x32_bf16 a[48:51], v[232:235], v[160:163], a[48:51]
ds_read_b64_tr_b16 v[224:225], v12 offset:4096
ds_read_b64_tr_b16 v[226:227], v12 offset:6144
v_mfma_f32_16x16x32_bf16 a[48:51], v[236:239], v[176:179], a[48:51]
v_accvgpr_read_b32 v214, a26
v_accvgpr_read_b32 v215, a27
v_mfma_f32_16x16x32_bf16 a[52:55], v[232:235], v[164:167], a[52:55]
v_cvt_pk_bf16_f32 v82, v212, v213
v_cvt_pk_bf16_f32 v83, v214, v215
v_mfma_f32_16x16x32_bf16 a[52:55], v[236:239], v[180:183], a[52:55]
buffer_store_dwordx4 v[80:83], v252, s[20:23], s42 offen offset:0 sc1
v_accvgpr_read_b32 v220, a28
v_mfma_f32_16x16x32_bf16 a[56:59], v[232:235], v[168:171], a[56:59]
ds_read_b64_tr_b16 v[228:229], v12 offset:20480
ds_read_b64_tr_b16 v[230:231], v12 offset:22528
v_mfma_f32_16x16x32_bf16 a[56:59], v[236:239], v[184:187], a[56:59]
v_accvgpr_read_b32 v221, a29
v_accvgpr_read_b32 v222, a30
v_mfma_f32_16x16x32_bf16 a[60:63], v[232:235], v[172:175], a[60:63]
v_accvgpr_read_b32 v223, a31
v_cvt_pk_bf16_f32 v114, v220, v221
v_mfma_f32_16x16x32_bf16 a[60:63], v[236:239], v[188:191], a[60:63]
s_waitcnt lgkmcnt(4)
v_cvt_pk_bf16_f32 v115, v222, v223
v_mfma_f32_16x16x32_bf16 a[64:67], v[240:243], v[4:7], a[64:67]
ds_read_b64_tr_b16 v[232:233], v12 offset:36864
ds_read_b64_tr_b16 v[234:235], v12 offset:38912
v_mfma_f32_16x16x32_bf16 a[64:67], v[244:247], v[8:11], a[64:67]
buffer_store_dwordx4 v[112:115], v252, s[20:23], s43 offen offset:0 sc1
v_accvgpr_read_b32 v192, a32
v_mfma_f32_16x16x32_bf16 a[68:71], v[240:243], v[36:39], a[68:71]
v_accvgpr_read_b32 v193, a33
v_accvgpr_read_b32 v194, a34
v_mfma_f32_16x16x32_bf16 a[68:71], v[244:247], v[40:43], a[68:71]
v_accvgpr_read_b32 v195, a35
v_cvt_pk_bf16_f32 v20, v192, v193
v_mfma_f32_16x16x32_bf16 a[72:75], v[240:243], v[68:71], a[72:75]
ds_read_b64_tr_b16 v[236:237], v12 offset:53248
ds_read_b64_tr_b16 v[238:239], v12 offset:55296
v_mfma_f32_16x16x32_bf16 a[72:75], v[244:247], v[72:75], a[72:75]
v_cvt_pk_bf16_f32 v21, v194, v195
v_accvgpr_read_b32 v200, a36
v_mfma_f32_16x16x32_bf16 a[76:79], v[240:243], v[100:103], a[76:79]
v_accvgpr_read_b32 v201, a37
v_accvgpr_read_b32 v202, a38
v_mfma_f32_16x16x32_bf16 a[76:79], v[244:247], v[104:107], a[76:79]
s_waitcnt lgkmcnt(4)
v_accvgpr_read_b32 v203, a39
v_mfma_f32_16x16x32_bf16 a[64:67], v[224:227], v[128:131], a[64:67]
ds_read_b64_tr_b16 v[240:241], v249 offset:4096
ds_read_b64_tr_b16 v[242:243], v249 offset:6144
v_mfma_f32_16x16x32_bf16 a[64:67], v[228:231], v[144:147], a[64:67]
v_cvt_pk_bf16_f32 v52, v200, v201
v_cvt_pk_bf16_f32 v53, v202, v203
v_mfma_f32_16x16x32_bf16 a[68:71], v[224:227], v[132:135], a[68:71]
v_accvgpr_read_b32 v208, a40
v_accvgpr_read_b32 v209, a41
v_mfma_f32_16x16x32_bf16 a[68:71], v[228:231], v[148:151], a[68:71]
v_accvgpr_read_b32 v210, a42
v_accvgpr_read_b32 v211, a43
v_mfma_f32_16x16x32_bf16 a[72:75], v[224:227], v[136:139], a[72:75]
ds_read_b64_tr_b16 v[244:245], v250 offset:4096
ds_read_b64_tr_b16 v[246:247], v250 offset:6144
v_mfma_f32_16x16x32_bf16 a[72:75], v[228:231], v[152:155], a[72:75]
v_cvt_pk_bf16_f32 v84, v208, v209
v_cvt_pk_bf16_f32 v85, v210, v211
v_mfma_f32_16x16x32_bf16 a[76:79], v[224:227], v[140:143], a[76:79]
v_accvgpr_read_b32 v216, a44
v_accvgpr_read_b32 v217, a45
v_mfma_f32_16x16x32_bf16 a[76:79], v[228:231], v[156:159], a[76:79]
s_waitcnt lgkmcnt(4)
v_accvgpr_read_b32 v218, a46
v_mfma_f32_16x16x32_bf16 a[64:67], v[232:235], v[160:163], a[64:67]
ds_read_b64_tr_b16 v[224:225], v250 offset:36864
ds_read_b64_tr_b16 v[226:227], v250 offset:38912
v_mfma_f32_16x16x32_bf16 a[64:67], v[236:239], v[176:179], a[64:67]
v_accvgpr_read_b32 v219, a47
v_cvt_pk_bf16_f32 v116, v216, v217
v_mfma_f32_16x16x32_bf16 a[68:71], v[232:235], v[164:167], a[68:71]
v_cvt_pk_bf16_f32 v117, v218, v219
v_accvgpr_read_b32 v196, a48
v_mfma_f32_16x16x32_bf16 a[68:71], v[236:239], v[180:183], a[68:71]
v_accvgpr_read_b32 v197, a49
v_accvgpr_read_b32 v198, a50
v_mfma_f32_16x16x32_bf16 a[72:75], v[232:235], v[168:171], a[72:75]
ds_read_b64_tr_b16 v[228:229], v250 offset:53248
ds_read_b64_tr_b16 v[230:231], v250 offset:55296
v_mfma_f32_16x16x32_bf16 a[72:75], v[236:239], v[184:187], a[72:75]
v_accvgpr_read_b32 v199, a51
v_cvt_pk_bf16_f32 v22, v196, v197
v_mfma_f32_16x16x32_bf16 a[76:79], v[232:235], v[172:175], a[76:79]
v_cvt_pk_bf16_f32 v23, v198, v199
buffer_store_dwordx4 v[20:23], v252, s[20:23], s40 offen offset:1024 sc1
v_mfma_f32_16x16x32_bf16 a[76:79], v[236:239], v[188:191], a[76:79]
s_waitcnt lgkmcnt(4)
v_accvgpr_read_b32 v204, a52
v_mfma_f32_16x16x32_bf16 a[64:67], v[240:243], v[0:3], a[64:67]
ds_read_b64_tr_b16 v[232:233], v13 offset:4096
ds_read_b64_tr_b16 v[234:235], v13 offset:6144
v_mfma_f32_16x16x32_bf16 a[68:71], v[240:243], v[32:35], a[68:71]
v_accvgpr_read_b32 v205, a53
v_accvgpr_read_b32 v206, a54
v_mfma_f32_16x16x32_bf16 a[72:75], v[240:243], v[64:67], a[72:75]
v_accvgpr_read_b32 v207, a55
v_cvt_pk_bf16_f32 v54, v204, v205
v_mfma_f32_16x16x32_bf16 a[76:79], v[240:243], v[96:99], a[76:79]
v_cvt_pk_bf16_f32 v55, v206, v207
buffer_store_dwordx4 v[52:55], v252, s[20:23], s41 offen offset:1024 sc1
v_mfma_f32_16x16x32_bf16 a[80:83], v[244:247], v[0:3], a[80:83]
ds_read_b64_tr_b16 v[236:237], v13 offset:20480
ds_read_b64_tr_b16 v[238:239], v13 offset:22528
v_mfma_f32_16x16x32_bf16 a[84:87], v[244:247], v[32:35], a[84:87]
v_accvgpr_read_b32 v212, a56
v_accvgpr_read_b32 v213, a57
v_mfma_f32_16x16x32_bf16 a[88:91], v[244:247], v[64:67], a[88:91]
v_accvgpr_read_b32 v214, a58
v_accvgpr_read_b32 v215, a59
v_mfma_f32_16x16x32_bf16 a[92:95], v[244:247], v[96:99], a[92:95]
s_waitcnt lgkmcnt(4)
v_cvt_pk_bf16_f32 v86, v212, v213
v_mfma_f32_16x16x32_bf16 a[80:83], v[224:227], v[4:7], a[80:83]
ds_read_b64_tr_b16 v[240:241], v13 offset:36864
ds_read_b64_tr_b16 v[242:243], v13 offset:38912
v_mfma_f32_16x16x32_bf16 a[80:83], v[228:231], v[8:11], a[80:83]
v_cvt_pk_bf16_f32 v87, v214, v215
buffer_store_dwordx4 v[84:87], v252, s[20:23], s42 offen offset:1024 sc1
v_mfma_f32_16x16x32_bf16 a[84:87], v[224:227], v[36:39], a[84:87]
v_accvgpr_read_b32 v220, a60
v_accvgpr_read_b32 v221, a61
v_mfma_f32_16x16x32_bf16 a[84:87], v[228:231], v[40:43], a[84:87]
v_accvgpr_read_b32 v222, a62
v_accvgpr_read_b32 v223, a63
v_mfma_f32_16x16x32_bf16 a[88:91], v[224:227], v[68:71], a[88:91]
ds_read_b64_tr_b16 v[244:245], v13 offset:53248
ds_read_b64_tr_b16 v[246:247], v13 offset:55296
v_mfma_f32_16x16x32_bf16 a[88:91], v[228:231], v[72:75], a[88:91]
v_cvt_pk_bf16_f32 v118, v220, v221
v_cvt_pk_bf16_f32 v119, v222, v223
v_mfma_f32_16x16x32_bf16 a[92:95], v[224:227], v[100:103], a[92:95]
buffer_store_dwordx4 v[116:119], v252, s[20:23], s43 offen offset:1024 sc1
v_accvgpr_read_b32 v192, a64
v_mfma_f32_16x16x32_bf16 a[92:95], v[228:231], v[104:107], a[92:95]
s_waitcnt lgkmcnt(4)
v_accvgpr_read_b32 v193, a65
v_mfma_f32_16x16x32_bf16 a[80:83], v[232:235], v[128:131], a[80:83]
ds_read_b64_tr_b16 v[224:225], v249 offset:37376
ds_read_b64_tr_b16 v[226:227], v249 offset:39424
v_mfma_f32_16x16x32_bf16 a[80:83], v[236:239], v[144:147], a[80:83]
v_accvgpr_read_b32 v194, a66
v_accvgpr_read_b32 v195, a67
v_mfma_f32_16x16x32_bf16 a[84:87], v[232:235], v[132:135], a[84:87]
v_cvt_pk_bf16_f32 v24, v192, v193
v_cvt_pk_bf16_f32 v25, v194, v195
v_mfma_f32_16x16x32_bf16 a[84:87], v[236:239], v[148:151], a[84:87]
v_accvgpr_read_b32 v200, a68
v_accvgpr_read_b32 v201, a69
v_mfma_f32_16x16x32_bf16 a[88:91], v[232:235], v[136:139], a[88:91]
ds_read_b64_tr_b16 v[228:229], v249 offset:53760
ds_read_b64_tr_b16 v[230:231], v249 offset:55808
v_mfma_f32_16x16x32_bf16 a[88:91], v[236:239], v[152:155], a[88:91]
v_accvgpr_read_b32 v202, a70
v_accvgpr_read_b32 v203, a71
v_mfma_f32_16x16x32_bf16 a[92:95], v[232:235], v[140:143], a[92:95]
v_cvt_pk_bf16_f32 v56, v200, v201
v_cvt_pk_bf16_f32 v57, v202, v203
v_mfma_f32_16x16x32_bf16 a[92:95], v[236:239], v[156:159], a[92:95]
s_waitcnt lgkmcnt(4)
v_accvgpr_read_b32 v208, a72
v_mfma_f32_16x16x32_bf16 a[80:83], v[240:243], v[160:163], a[80:83]
ds_read_b64_tr_b16 v[232:233], v12 offset:4608
ds_read_b64_tr_b16 v[234:235], v12 offset:6656
v_mfma_f32_16x16x32_bf16 a[80:83], v[244:247], v[176:179], a[80:83]
v_accvgpr_read_b32 v209, a73
v_accvgpr_read_b32 v210, a74
v_mfma_f32_16x16x32_bf16 a[84:87], v[240:243], v[164:167], a[84:87]
v_accvgpr_read_b32 v211, a75
v_cvt_pk_bf16_f32 v88, v208, v209
v_mfma_f32_16x16x32_bf16 a[84:87], v[244:247], v[180:183], a[84:87]
v_cvt_pk_bf16_f32 v89, v210, v211
v_accvgpr_read_b32 v216, a76
v_mfma_f32_16x16x32_bf16 a[88:91], v[240:243], v[168:171], a[88:91]
ds_read_b64_tr_b16 v[236:237], v12 offset:20992
ds_read_b64_tr_b16 v[238:239], v12 offset:23040
v_mfma_f32_16x16x32_bf16 a[88:91], v[244:247], v[184:187], a[88:91]
v_accvgpr_read_b32 v217, a77
v_accvgpr_read_b32 v218, a78
v_mfma_f32_16x16x32_bf16 a[92:95], v[240:243], v[172:175], a[92:95]
v_accvgpr_read_b32 v219, a79
v_cvt_pk_bf16_f32 v120, v216, v217
v_mfma_f32_16x16x32_bf16 a[92:95], v[244:247], v[188:191], a[92:95]
s_waitcnt lgkmcnt(4)
v_cvt_pk_bf16_f32 v121, v218, v219
v_mfma_f32_16x16x32_bf16 a[96:99], v[224:227], v[4:7], a[96:99]
ds_read_b64_tr_b16 v[240:241], v12 offset:37376
ds_read_b64_tr_b16 v[242:243], v12 offset:39424
v_mfma_f32_16x16x32_bf16 a[96:99], v[228:231], v[8:11], a[96:99]
v_accvgpr_read_b32 v196, a80
v_accvgpr_read_b32 v197, a81
v_mfma_f32_16x16x32_bf16 a[100:103], v[224:227], v[36:39], a[100:103]
v_accvgpr_read_b32 v198, a82
v_accvgpr_read_b32 v199, a83
v_mfma_f32_16x16x32_bf16 a[100:103], v[228:231], v[40:43], a[100:103]
v_cvt_pk_bf16_f32 v26, v196, v197
v_cvt_pk_bf16_f32 v27, v198, v199
v_mfma_f32_16x16x32_bf16 a[104:107], v[224:227], v[68:71], a[104:107]
ds_read_b64_tr_b16 v[244:245], v12 offset:53760
ds_read_b64_tr_b16 v[246:247], v12 offset:55808
v_mfma_f32_16x16x32_bf16 a[104:107], v[228:231], v[72:75], a[104:107]
buffer_store_dwordx4 v[24:27], v252, s[20:23], s40 offen offset:2048 sc1
v_accvgpr_read_b32 v204, a84
v_mfma_f32_16x16x32_bf16 a[108:111], v[224:227], v[100:103], a[108:111]
v_accvgpr_read_b32 v205, a85
v_accvgpr_read_b32 v206, a86
v_mfma_f32_16x16x32_bf16 a[108:111], v[228:231], v[104:107], a[108:111]
s_waitcnt lgkmcnt(4)
v_accvgpr_read_b32 v207, a87
v_mfma_f32_16x16x32_bf16 a[96:99], v[232:235], v[128:131], a[96:99]
ds_read_b64_tr_b16 v[224:225], v249 offset:4608
ds_read_b64_tr_b16 v[226:227], v249 offset:6656
v_mfma_f32_16x16x32_bf16 a[96:99], v[236:239], v[144:147], a[96:99]
v_cvt_pk_bf16_f32 v58, v204, v205
v_cvt_pk_bf16_f32 v59, v206, v207
v_mfma_f32_16x16x32_bf16 a[100:103], v[232:235], v[132:135], a[100:103]
buffer_store_dwordx4 v[56:59], v252, s[20:23], s41 offen offset:2048 sc1
v_accvgpr_read_b32 v212, a88
v_mfma_f32_16x16x32_bf16 a[100:103], v[236:239], v[148:151], a[100:103]
v_accvgpr_read_b32 v213, a89
v_accvgpr_read_b32 v214, a90
v_mfma_f32_16x16x32_bf16 a[104:107], v[232:235], v[136:139], a[104:107]
ds_read_b64_tr_b16 v[228:229], v250 offset:4608
ds_read_b64_tr_b16 v[230:231], v250 offset:6656
v_mfma_f32_16x16x32_bf16 a[104:107], v[236:239], v[152:155], a[104:107]
v_accvgpr_read_b32 v215, a91
v_cvt_pk_bf16_f32 v90, v212, v213
v_mfma_f32_16x16x32_bf16 a[108:111], v[232:235], v[140:143], a[108:111]
v_cvt_pk_bf16_f32 v91, v214, v215
buffer_store_dwordx4 v[88:91], v252, s[20:23], s42 offen offset:2048 sc1
v_mfma_f32_16x16x32_bf16 a[108:111], v[236:239], v[156:159], a[108:111]
s_waitcnt lgkmcnt(4)
v_accvgpr_read_b32 v220, a92
v_mfma_f32_16x16x32_bf16 a[96:99], v[240:243], v[160:163], a[96:99]
ds_read_b64_tr_b16 v[232:233], v250 offset:37376
ds_read_b64_tr_b16 v[234:235], v250 offset:39424
v_mfma_f32_16x16x32_bf16 a[96:99], v[244:247], v[176:179], a[96:99]
v_accvgpr_read_b32 v221, a93
v_accvgpr_read_b32 v222, a94
v_mfma_f32_16x16x32_bf16 a[100:103], v[240:243], v[164:167], a[100:103]
v_accvgpr_read_b32 v223, a95
v_cvt_pk_bf16_f32 v122, v220, v221
v_mfma_f32_16x16x32_bf16 a[100:103], v[244:247], v[180:183], a[100:103]
v_cvt_pk_bf16_f32 v123, v222, v223
buffer_store_dwordx4 v[120:123], v252, s[20:23], s43 offen offset:2048 sc1
v_mfma_f32_16x16x32_bf16 a[104:107], v[240:243], v[168:171], a[104:107]
ds_read_b64_tr_b16 v[236:237], v250 offset:53760
ds_read_b64_tr_b16 v[238:239], v250 offset:55808
v_mfma_f32_16x16x32_bf16 a[104:107], v[244:247], v[184:187], a[104:107]
v_mfma_f32_16x16x32_bf16 a[108:111], v[240:243], v[172:175], a[108:111]
v_mfma_f32_16x16x32_bf16 a[108:111], v[244:247], v[188:191], a[108:111]
s_waitcnt lgkmcnt(4)
v_mfma_f32_16x16x32_bf16 a[96:99], v[224:227], v[0:3], a[96:99]
ds_read_b64_tr_b16 v[240:241], v13 offset:4608
ds_read_b64_tr_b16 v[242:243], v13 offset:6656
v_mfma_f32_16x16x32_bf16 a[100:103], v[224:227], v[32:35], a[100:103]
v_mfma_f32_16x16x32_bf16 a[104:107], v[224:227], v[64:67], a[104:107]
v_mfma_f32_16x16x32_bf16 a[108:111], v[224:227], v[96:99], a[108:111]
v_mfma_f32_16x16x32_bf16 a[112:115], v[228:231], v[0:3], a[112:115]
ds_read_b64_tr_b16 v[244:245], v13 offset:20992
ds_read_b64_tr_b16 v[246:247], v13 offset:23040
v_mfma_f32_16x16x32_bf16 a[116:119], v[228:231], v[32:35], a[116:119]
v_accvgpr_read_b32 v192, a96
v_accvgpr_read_b32 v193, a97
v_mfma_f32_16x16x32_bf16 a[120:123], v[228:231], v[64:67], a[120:123]
v_accvgpr_read_b32 v194, a98
v_accvgpr_read_b32 v195, a99
v_mfma_f32_16x16x32_bf16 a[124:127], v[228:231], v[96:99], a[124:127]
s_waitcnt lgkmcnt(4)
v_cvt_pk_bf16_f32 v28, v192, v193
v_mfma_f32_16x16x32_bf16 a[112:115], v[232:235], v[4:7], a[112:115]
ds_read_b64_tr_b16 v[224:225], v13 offset:37376
ds_read_b64_tr_b16 v[226:227], v13 offset:39424
v_mfma_f32_16x16x32_bf16 a[112:115], v[236:239], v[8:11], a[112:115]
v_cvt_pk_bf16_f32 v29, v194, v195
v_accvgpr_read_b32 v200, a100
v_mfma_f32_16x16x32_bf16 a[116:119], v[232:235], v[36:39], a[116:119]
v_accvgpr_read_b32 v201, a101
v_accvgpr_read_b32 v202, a102
v_mfma_f32_16x16x32_bf16 a[116:119], v[236:239], v[40:43], a[116:119]
v_accvgpr_read_b32 v203, a103
v_cvt_pk_bf16_f32 v60, v200, v201
v_mfma_f32_16x16x32_bf16 a[120:123], v[232:235], v[68:71], a[120:123]
ds_read_b64_tr_b16 v[228:229], v13 offset:53760
ds_read_b64_tr_b16 v[230:231], v13 offset:55808
v_mfma_f32_16x16x32_bf16 a[120:123], v[236:239], v[72:75], a[120:123]
v_cvt_pk_bf16_f32 v61, v202, v203
v_accvgpr_read_b32 v208, a104
v_mfma_f32_16x16x32_bf16 a[124:127], v[232:235], v[100:103], a[124:127]
v_accvgpr_read_b32 v209, a105
v_accvgpr_read_b32 v210, a106
v_mfma_f32_16x16x32_bf16 a[124:127], v[236:239], v[104:107], a[124:127]
s_waitcnt lgkmcnt(4)
v_accvgpr_read_b32 v211, a107
v_mfma_f32_16x16x32_bf16 a[112:115], v[240:243], v[128:131], a[112:115]
ds_read_b64_tr_b16 v[232:233], v249 offset:40960
ds_read_b64_tr_b16 v[234:235], v249 offset:43008
v_mfma_f32_16x16x32_bf16 a[112:115], v[244:247], v[144:147], a[112:115]
v_cvt_pk_bf16_f32 v92, v208, v209
v_cvt_pk_bf16_f32 v93, v210, v211
v_mfma_f32_16x16x32_bf16 a[116:119], v[240:243], v[132:135], a[116:119]
v_accvgpr_read_b32 v216, a108
v_accvgpr_read_b32 v217, a109
v_mfma_f32_16x16x32_bf16 a[116:119], v[244:247], v[148:151], a[116:119]
v_accvgpr_read_b32 v218, a110
v_accvgpr_read_b32 v219, a111
v_mfma_f32_16x16x32_bf16 a[120:123], v[240:243], v[136:139], a[120:123]
ds_read_b64_tr_b16 v[236:237], v249 offset:57344
ds_read_b64_tr_b16 v[238:239], v249 offset:59392
v_mfma_f32_16x16x32_bf16 a[120:123], v[244:247], v[152:155], a[120:123]
v_cvt_pk_bf16_f32 v124, v216, v217
v_cvt_pk_bf16_f32 v125, v218, v219
v_mfma_f32_16x16x32_bf16 a[124:127], v[240:243], v[140:143], a[124:127]
v_mfma_f32_16x16x32_bf16 a[124:127], v[244:247], v[156:159], a[124:127]
s_waitcnt lgkmcnt(4)
v_mfma_f32_16x16x32_bf16 a[112:115], v[224:227], v[160:163], a[112:115]
ds_read_b64_tr_b16 v[240:241], v12 offset:8192
ds_read_b64_tr_b16 v[242:243], v12 offset:10240
v_mfma_f32_16x16x32_bf16 a[112:115], v[228:231], v[176:179], a[112:115]
v_mfma_f32_16x16x32_bf16 a[116:119], v[224:227], v[164:167], a[116:119]
v_mfma_f32_16x16x32_bf16 a[116:119], v[228:231], v[180:183], a[116:119]
v_mfma_f32_16x16x32_bf16 a[120:123], v[224:227], v[168:171], a[120:123]
ds_read_b64_tr_b16 v[244:245], v12 offset:24576
ds_read_b64_tr_b16 v[246:247], v12 offset:26624
v_mfma_f32_16x16x32_bf16 a[120:123], v[228:231], v[184:187], a[120:123]
v_mfma_f32_16x16x32_bf16 a[124:127], v[224:227], v[172:175], a[124:127]
s_nop 0
v_accvgpr_read_b32 v196, a112
v_accvgpr_read_b32 v197, a113
v_mfma_f32_16x16x32_bf16 a[124:127], v[228:231], v[188:191], a[124:127]
s_waitcnt lgkmcnt(4)
v_accvgpr_read_b32 v198, a114
v_mfma_f32_16x16x32_bf16 a[128:131], v[232:235], v[4:7], a[128:131]
ds_read_b64_tr_b16 v[224:225], v12 offset:40960
ds_read_b64_tr_b16 v[226:227], v12 offset:43008
v_mfma_f32_16x16x32_bf16 a[128:131], v[236:239], v[8:11], a[128:131]
v_accvgpr_read_b32 v199, a115
v_cvt_pk_bf16_f32 v30, v196, v197
v_mfma_f32_16x16x32_bf16 a[132:135], v[232:235], v[36:39], a[132:135]
v_cvt_pk_bf16_f32 v31, v198, v199
buffer_store_dwordx4 v[28:31], v252, s[20:23], s40 offen offset:3072 sc1
v_mfma_f32_16x16x32_bf16 a[132:135], v[236:239], v[40:43], a[132:135]
v_accvgpr_read_b32 v204, a116
v_accvgpr_read_b32 v205, a117
v_mfma_f32_16x16x32_bf16 a[136:139], v[232:235], v[68:71], a[136:139]
ds_read_b64_tr_b16 v[228:229], v12 offset:57344
ds_read_b64_tr_b16 v[230:231], v12 offset:59392
v_mfma_f32_16x16x32_bf16 a[136:139], v[236:239], v[72:75], a[136:139]
v_accvgpr_read_b32 v206, a118
v_accvgpr_read_b32 v207, a119
v_mfma_f32_16x16x32_bf16 a[140:143], v[232:235], v[100:103], a[140:143]
v_cvt_pk_bf16_f32 v62, v204, v205
v_cvt_pk_bf16_f32 v63, v206, v207
v_mfma_f32_16x16x32_bf16 a[140:143], v[236:239], v[104:107], a[140:143]
s_waitcnt lgkmcnt(4)
buffer_store_dwordx4 v[60:63], v252, s[20:23], s41 offen offset:3072 sc1
v_mfma_f32_16x16x32_bf16 a[128:131], v[240:243], v[128:131], a[128:131]
ds_read_b64_tr_b16 v[232:233], v249 offset:8192
ds_read_b64_tr_b16 v[234:235], v249 offset:10240
v_mfma_f32_16x16x32_bf16 a[128:131], v[244:247], v[144:147], a[128:131]
v_accvgpr_read_b32 v212, a120
v_accvgpr_read_b32 v213, a121
v_mfma_f32_16x16x32_bf16 a[132:135], v[240:243], v[132:135], a[132:135]
v_accvgpr_read_b32 v214, a122
v_accvgpr_read_b32 v215, a123
v_mfma_f32_16x16x32_bf16 a[132:135], v[244:247], v[148:151], a[132:135]
v_cvt_pk_bf16_f32 v94, v212, v213
v_cvt_pk_bf16_f32 v95, v214, v215
v_mfma_f32_16x16x32_bf16 a[136:139], v[240:243], v[136:139], a[136:139]
ds_read_b64_tr_b16 v[236:237], v250 offset:8192
ds_read_b64_tr_b16 v[238:239], v250 offset:10240
v_mfma_f32_16x16x32_bf16 a[136:139], v[244:247], v[152:155], a[136:139]
buffer_store_dwordx4 v[92:95], v252, s[20:23], s42 offen offset:3072 sc1
v_accvgpr_read_b32 v220, a124
v_mfma_f32_16x16x32_bf16 a[140:143], v[240:243], v[140:143], a[140:143]
v_accvgpr_read_b32 v221, a125
v_accvgpr_read_b32 v222, a126
v_mfma_f32_16x16x32_bf16 a[140:143], v[244:247], v[156:159], a[140:143]
s_waitcnt lgkmcnt(4)
v_accvgpr_read_b32 v223, a127
v_mfma_f32_16x16x32_bf16 a[128:131], v[224:227], v[160:163], a[128:131]
ds_read_b64_tr_b16 v[240:241], v250 offset:40960
ds_read_b64_tr_b16 v[242:243], v250 offset:43008
v_mfma_f32_16x16x32_bf16 a[128:131], v[228:231], v[176:179], a[128:131]
v_cvt_pk_bf16_f32 v126, v220, v221
v_cvt_pk_bf16_f32 v127, v222, v223
v_mfma_f32_16x16x32_bf16 a[132:135], v[224:227], v[164:167], a[132:135]
buffer_store_dwordx4 v[124:127], v252, s[20:23], s43 offen offset:3072 sc1
v_mfma_f32_16x16x32_bf16 a[132:135], v[228:231], v[180:183], a[132:135]
v_mfma_f32_16x16x32_bf16 a[136:139], v[224:227], v[168:171], a[136:139]
ds_read_b64_tr_b16 v[244:245], v250 offset:57344
ds_read_b64_tr_b16 v[246:247], v250 offset:59392
v_mfma_f32_16x16x32_bf16 a[136:139], v[228:231], v[184:187], a[136:139]
v_mfma_f32_16x16x32_bf16 a[140:143], v[224:227], v[172:175], a[140:143]
v_mfma_f32_16x16x32_bf16 a[140:143], v[228:231], v[188:191], a[140:143]
s_waitcnt lgkmcnt(4)
v_mfma_f32_16x16x32_bf16 a[128:131], v[232:235], v[0:3], a[128:131]
ds_read_b64_tr_b16 v[224:225], v13 offset:8192
ds_read_b64_tr_b16 v[226:227], v13 offset:10240
v_mfma_f32_16x16x32_bf16 a[132:135], v[232:235], v[32:35], a[132:135]
v_mfma_f32_16x16x32_bf16 a[136:139], v[232:235], v[64:67], a[136:139]
v_mfma_f32_16x16x32_bf16 a[140:143], v[232:235], v[96:99], a[140:143]
v_mfma_f32_16x16x32_bf16 a[144:147], v[236:239], v[0:3], a[144:147]
ds_read_b64_tr_b16 v[228:229], v13 offset:24576
ds_read_b64_tr_b16 v[230:231], v13 offset:26624
v_mfma_f32_16x16x32_bf16 a[148:151], v[236:239], v[32:35], a[148:151]
v_accvgpr_read_b32 v192, a128
v_accvgpr_read_b32 v193, a129
v_mfma_f32_16x16x32_bf16 a[152:155], v[236:239], v[64:67], a[152:155]
v_accvgpr_read_b32 v194, a130
v_accvgpr_read_b32 v195, a131
v_mfma_f32_16x16x32_bf16 a[156:159], v[236:239], v[96:99], a[156:159]
s_waitcnt lgkmcnt(4)
v_cvt_pk_bf16_f32 v16, v192, v193
v_mfma_f32_16x16x32_bf16 a[144:147], v[240:243], v[4:7], a[144:147]
ds_read_b64_tr_b16 v[232:233], v13 offset:40960
ds_read_b64_tr_b16 v[234:235], v13 offset:43008
v_mfma_f32_16x16x32_bf16 a[144:147], v[244:247], v[8:11], a[144:147]
v_cvt_pk_bf16_f32 v17, v194, v195
v_accvgpr_read_b32 v200, a132
v_mfma_f32_16x16x32_bf16 a[148:151], v[240:243], v[36:39], a[148:151]
v_accvgpr_read_b32 v201, a133
v_accvgpr_read_b32 v202, a134
v_mfma_f32_16x16x32_bf16 a[148:151], v[244:247], v[40:43], a[148:151]
v_accvgpr_read_b32 v203, a135
v_cvt_pk_bf16_f32 v48, v200, v201
v_mfma_f32_16x16x32_bf16 a[152:155], v[240:243], v[68:71], a[152:155]
ds_read_b64_tr_b16 v[236:237], v13 offset:57344
ds_read_b64_tr_b16 v[238:239], v13 offset:59392
v_mfma_f32_16x16x32_bf16 a[152:155], v[244:247], v[72:75], a[152:155]
v_cvt_pk_bf16_f32 v49, v202, v203
v_accvgpr_read_b32 v208, a136
v_mfma_f32_16x16x32_bf16 a[156:159], v[240:243], v[100:103], a[156:159]
v_accvgpr_read_b32 v209, a137
v_accvgpr_read_b32 v210, a138
v_mfma_f32_16x16x32_bf16 a[156:159], v[244:247], v[104:107], a[156:159]
s_waitcnt lgkmcnt(4)
v_accvgpr_read_b32 v211, a139
v_mfma_f32_16x16x32_bf16 a[144:147], v[224:227], v[128:131], a[144:147]
ds_read_b64_tr_b16 v[240:241], v249 offset:41472
ds_read_b64_tr_b16 v[242:243], v249 offset:43520
v_mfma_f32_16x16x32_bf16 a[144:147], v[228:231], v[144:147], a[144:147]
v_cvt_pk_bf16_f32 v80, v208, v209
v_cvt_pk_bf16_f32 v81, v210, v211
v_mfma_f32_16x16x32_bf16 a[148:151], v[224:227], v[132:135], a[148:151]
v_accvgpr_read_b32 v216, a140
v_accvgpr_read_b32 v217, a141
v_mfma_f32_16x16x32_bf16 a[148:151], v[228:231], v[148:151], a[148:151]
v_accvgpr_read_b32 v218, a142
v_accvgpr_read_b32 v219, a143
v_mfma_f32_16x16x32_bf16 a[152:155], v[224:227], v[136:139], a[152:155]
ds_read_b64_tr_b16 v[244:245], v249 offset:57856
ds_read_b64_tr_b16 v[246:247], v249 offset:59904
v_mfma_f32_16x16x32_bf16 a[152:155], v[228:231], v[152:155], a[152:155]
v_cvt_pk_bf16_f32 v112, v216, v217
v_cvt_pk_bf16_f32 v113, v218, v219
v_mfma_f32_16x16x32_bf16 a[156:159], v[224:227], v[140:143], a[156:159]
v_mfma_f32_16x16x32_bf16 a[156:159], v[228:231], v[156:159], a[156:159]
s_waitcnt lgkmcnt(4)
v_mfma_f32_16x16x32_bf16 a[144:147], v[232:235], v[160:163], a[144:147]
ds_read_b64_tr_b16 v[224:225], v12 offset:8704
ds_read_b64_tr_b16 v[226:227], v12 offset:10752
v_mfma_f32_16x16x32_bf16 a[144:147], v[236:239], v[176:179], a[144:147]
v_mfma_f32_16x16x32_bf16 a[148:151], v[232:235], v[164:167], a[148:151]
v_mfma_f32_16x16x32_bf16 a[148:151], v[236:239], v[180:183], a[148:151]
v_mfma_f32_16x16x32_bf16 a[152:155], v[232:235], v[168:171], a[152:155]
ds_read_b64_tr_b16 v[228:229], v12 offset:25088
ds_read_b64_tr_b16 v[230:231], v12 offset:27136
v_mfma_f32_16x16x32_bf16 a[152:155], v[236:239], v[184:187], a[152:155]
v_mfma_f32_16x16x32_bf16 a[156:159], v[232:235], v[172:175], a[156:159]
s_nop 0
v_accvgpr_read_b32 v196, a144
v_accvgpr_read_b32 v197, a145
v_mfma_f32_16x16x32_bf16 a[156:159], v[236:239], v[188:191], a[156:159]
s_waitcnt lgkmcnt(4)
v_accvgpr_read_b32 v198, a146
v_mfma_f32_16x16x32_bf16 a[160:163], v[240:243], v[4:7], a[160:163]
ds_read_b64_tr_b16 v[232:233], v12 offset:41472
ds_read_b64_tr_b16 v[234:235], v12 offset:43520
v_mfma_f32_16x16x32_bf16 a[160:163], v[244:247], v[8:11], a[160:163]
v_accvgpr_read_b32 v199, a147
v_cvt_pk_bf16_f32 v18, v196, v197
v_mfma_f32_16x16x32_bf16 a[164:167], v[240:243], v[36:39], a[164:167]
v_cvt_pk_bf16_f32 v19, v198, v199
buffer_store_dwordx4 v[16:19], v252, s[20:23], s44 offen offset:0 sc1
v_mfma_f32_16x16x32_bf16 a[164:167], v[244:247], v[40:43], a[164:167]
v_accvgpr_read_b32 v204, a148
v_accvgpr_read_b32 v205, a149
v_mfma_f32_16x16x32_bf16 a[168:171], v[240:243], v[68:71], a[168:171]
ds_read_b64_tr_b16 v[236:237], v12 offset:57856
ds_read_b64_tr_b16 v[238:239], v12 offset:59904
v_mfma_f32_16x16x32_bf16 a[168:171], v[244:247], v[72:75], a[168:171]
v_accvgpr_read_b32 v206, a150
v_accvgpr_read_b32 v207, a151
v_mfma_f32_16x16x32_bf16 a[172:175], v[240:243], v[100:103], a[172:175]
v_cvt_pk_bf16_f32 v50, v204, v205
v_cvt_pk_bf16_f32 v51, v206, v207
v_mfma_f32_16x16x32_bf16 a[172:175], v[244:247], v[104:107], a[172:175]
s_waitcnt lgkmcnt(4)
buffer_store_dwordx4 v[48:51], v252, s[20:23], s45 offen offset:0 sc1
v_mfma_f32_16x16x32_bf16 a[160:163], v[224:227], v[128:131], a[160:163]
ds_read_b64_tr_b16 v[240:241], v249 offset:8704
ds_read_b64_tr_b16 v[242:243], v249 offset:10752
v_mfma_f32_16x16x32_bf16 a[160:163], v[228:231], v[144:147], a[160:163]
v_accvgpr_read_b32 v212, a152
v_accvgpr_read_b32 v213, a153
v_mfma_f32_16x16x32_bf16 a[164:167], v[224:227], v[132:135], a[164:167]
v_accvgpr_read_b32 v214, a154
v_accvgpr_read_b32 v215, a155
v_mfma_f32_16x16x32_bf16 a[164:167], v[228:231], v[148:151], a[164:167]
v_cvt_pk_bf16_f32 v82, v212, v213
v_cvt_pk_bf16_f32 v83, v214, v215
v_mfma_f32_16x16x32_bf16 a[168:171], v[224:227], v[136:139], a[168:171]
ds_read_b64_tr_b16 v[244:245], v250 offset:8704
ds_read_b64_tr_b16 v[246:247], v250 offset:10752
v_mfma_f32_16x16x32_bf16 a[168:171], v[228:231], v[152:155], a[168:171]
buffer_store_dwordx4 v[80:83], v252, s[20:23], s46 offen offset:0 sc1
v_accvgpr_read_b32 v220, a156
v_mfma_f32_16x16x32_bf16 a[172:175], v[224:227], v[140:143], a[172:175]
v_accvgpr_read_b32 v221, a157
v_accvgpr_read_b32 v222, a158
v_mfma_f32_16x16x32_bf16 a[172:175], v[228:231], v[156:159], a[172:175]
s_waitcnt lgkmcnt(4)
v_accvgpr_read_b32 v223, a159
v_mfma_f32_16x16x32_bf16 a[160:163], v[232:235], v[160:163], a[160:163]
ds_read_b64_tr_b16 v[224:225], v250 offset:41472
ds_read_b64_tr_b16 v[226:227], v250 offset:43520
v_mfma_f32_16x16x32_bf16 a[160:163], v[236:239], v[176:179], a[160:163]
v_cvt_pk_bf16_f32 v114, v220, v221
v_cvt_pk_bf16_f32 v115, v222, v223
v_mfma_f32_16x16x32_bf16 a[164:167], v[232:235], v[164:167], a[164:167]
buffer_store_dwordx4 v[112:115], v252, s[20:23], s47 offen offset:0 sc1
v_mfma_f32_16x16x32_bf16 a[164:167], v[236:239], v[180:183], a[164:167]
v_mfma_f32_16x16x32_bf16 a[168:171], v[232:235], v[168:171], a[168:171]
ds_read_b64_tr_b16 v[228:229], v250 offset:57856
ds_read_b64_tr_b16 v[230:231], v250 offset:59904
v_mfma_f32_16x16x32_bf16 a[168:171], v[236:239], v[184:187], a[168:171]
v_mfma_f32_16x16x32_bf16 a[172:175], v[232:235], v[172:175], a[172:175]
v_mfma_f32_16x16x32_bf16 a[172:175], v[236:239], v[188:191], a[172:175]
s_waitcnt lgkmcnt(4)
v_mfma_f32_16x16x32_bf16 a[160:163], v[240:243], v[0:3], a[160:163]
ds_read_b64_tr_b16 v[232:233], v13 offset:8704
ds_read_b64_tr_b16 v[234:235], v13 offset:10752
v_mfma_f32_16x16x32_bf16 a[164:167], v[240:243], v[32:35], a[164:167]
v_mfma_f32_16x16x32_bf16 a[168:171], v[240:243], v[64:67], a[168:171]
v_mfma_f32_16x16x32_bf16 a[172:175], v[240:243], v[96:99], a[172:175]
v_mfma_f32_16x16x32_bf16 a[176:179], v[244:247], v[0:3], a[176:179]
ds_read_b64_tr_b16 v[236:237], v13 offset:25088
ds_read_b64_tr_b16 v[238:239], v13 offset:27136
v_mfma_f32_16x16x32_bf16 a[180:183], v[244:247], v[32:35], a[180:183]
v_accvgpr_read_b32 v192, a160
v_accvgpr_read_b32 v193, a161
v_mfma_f32_16x16x32_bf16 a[184:187], v[244:247], v[64:67], a[184:187]
v_accvgpr_read_b32 v194, a162
v_accvgpr_read_b32 v195, a163
v_mfma_f32_16x16x32_bf16 a[188:191], v[244:247], v[96:99], a[188:191]
s_waitcnt lgkmcnt(4)
v_cvt_pk_bf16_f32 v20, v192, v193
v_mfma_f32_16x16x32_bf16 a[176:179], v[224:227], v[4:7], a[176:179]
ds_read_b64_tr_b16 v[240:241], v13 offset:41472
ds_read_b64_tr_b16 v[242:243], v13 offset:43520
v_mfma_f32_16x16x32_bf16 a[176:179], v[228:231], v[8:11], a[176:179]
v_cvt_pk_bf16_f32 v21, v194, v195
v_accvgpr_read_b32 v200, a164
v_mfma_f32_16x16x32_bf16 a[180:183], v[224:227], v[36:39], a[180:183]
v_accvgpr_read_b32 v201, a165
v_accvgpr_read_b32 v202, a166
v_mfma_f32_16x16x32_bf16 a[180:183], v[228:231], v[40:43], a[180:183]
v_accvgpr_read_b32 v203, a167
v_cvt_pk_bf16_f32 v52, v200, v201
v_mfma_f32_16x16x32_bf16 a[184:187], v[224:227], v[68:71], a[184:187]
ds_read_b64_tr_b16 v[244:245], v13 offset:57856
ds_read_b64_tr_b16 v[246:247], v13 offset:59904
v_mfma_f32_16x16x32_bf16 a[184:187], v[228:231], v[72:75], a[184:187]
v_cvt_pk_bf16_f32 v53, v202, v203
v_accvgpr_read_b32 v208, a168
v_mfma_f32_16x16x32_bf16 a[188:191], v[224:227], v[100:103], a[188:191]
v_accvgpr_read_b32 v209, a169
v_accvgpr_read_b32 v210, a170
v_mfma_f32_16x16x32_bf16 a[188:191], v[228:231], v[104:107], a[188:191]
s_waitcnt lgkmcnt(4)
v_accvgpr_read_b32 v211, a171
v_mfma_f32_16x16x32_bf16 a[176:179], v[232:235], v[128:131], a[176:179]
ds_read_b64_tr_b16 v[224:225], v249 offset:45056
ds_read_b64_tr_b16 v[226:227], v249 offset:47104
v_mfma_f32_16x16x32_bf16 a[176:179], v[236:239], v[144:147], a[176:179]
v_cvt_pk_bf16_f32 v84, v208, v209
v_cvt_pk_bf16_f32 v85, v210, v211
v_mfma_f32_16x16x32_bf16 a[180:183], v[232:235], v[132:135], a[180:183]
v_accvgpr_read_b32 v216, a172
v_accvgpr_read_b32 v217, a173
v_mfma_f32_16x16x32_bf16 a[180:183], v[236:239], v[148:151], a[180:183]
v_accvgpr_read_b32 v218, a174
v_accvgpr_read_b32 v219, a175
v_mfma_f32_16x16x32_bf16 a[184:187], v[232:235], v[136:139], a[184:187]
ds_read_b64_tr_b16 v[228:229], v249 offset:61440
ds_read_b64_tr_b16 v[230:231], v249 offset:63488
v_mfma_f32_16x16x32_bf16 a[184:187], v[236:239], v[152:155], a[184:187]
v_cvt_pk_bf16_f32 v116, v216, v217
v_cvt_pk_bf16_f32 v117, v218, v219
v_mfma_f32_16x16x32_bf16 a[188:191], v[232:235], v[140:143], a[188:191]
v_mfma_f32_16x16x32_bf16 a[188:191], v[236:239], v[156:159], a[188:191]
s_waitcnt lgkmcnt(4)
v_mfma_f32_16x16x32_bf16 a[176:179], v[240:243], v[160:163], a[176:179]
ds_read_b64_tr_b16 v[232:233], v12 offset:12288
ds_read_b64_tr_b16 v[234:235], v12 offset:14336
v_mfma_f32_16x16x32_bf16 a[176:179], v[244:247], v[176:179], a[176:179]
v_mfma_f32_16x16x32_bf16 a[180:183], v[240:243], v[164:167], a[180:183]
v_mfma_f32_16x16x32_bf16 a[180:183], v[244:247], v[180:183], a[180:183]
v_mfma_f32_16x16x32_bf16 a[184:187], v[240:243], v[168:171], a[184:187]
ds_read_b64_tr_b16 v[236:237], v12 offset:28672
ds_read_b64_tr_b16 v[238:239], v12 offset:30720
v_mfma_f32_16x16x32_bf16 a[184:187], v[244:247], v[184:187], a[184:187]
v_mfma_f32_16x16x32_bf16 a[188:191], v[240:243], v[172:175], a[188:191]
s_nop 0
v_accvgpr_read_b32 v196, a176
v_accvgpr_read_b32 v197, a177
v_mfma_f32_16x16x32_bf16 a[188:191], v[244:247], v[188:191], a[188:191]
s_waitcnt lgkmcnt(4)
v_accvgpr_read_b32 v198, a178
v_mfma_f32_16x16x32_bf16 a[192:195], v[224:227], v[4:7], a[192:195]
ds_read_b64_tr_b16 v[240:241], v12 offset:45056
ds_read_b64_tr_b16 v[242:243], v12 offset:47104
v_mfma_f32_16x16x32_bf16 a[192:195], v[228:231], v[8:11], a[192:195]
v_accvgpr_read_b32 v199, a179
v_cvt_pk_bf16_f32 v22, v196, v197
v_mfma_f32_16x16x32_bf16 a[196:199], v[224:227], v[36:39], a[196:199]
v_cvt_pk_bf16_f32 v23, v198, v199
buffer_store_dwordx4 v[20:23], v252, s[20:23], s44 offen offset:1024 sc1
v_mfma_f32_16x16x32_bf16 a[196:199], v[228:231], v[40:43], a[196:199]
v_accvgpr_read_b32 v204, a180
v_accvgpr_read_b32 v205, a181
v_mfma_f32_16x16x32_bf16 a[200:203], v[224:227], v[68:71], a[200:203]
ds_read_b64_tr_b16 v[244:245], v12 offset:61440
ds_read_b64_tr_b16 v[246:247], v12 offset:63488
v_mfma_f32_16x16x32_bf16 a[200:203], v[228:231], v[72:75], a[200:203]
v_accvgpr_read_b32 v206, a182
v_accvgpr_read_b32 v207, a183
v_mfma_f32_16x16x32_bf16 a[204:207], v[224:227], v[100:103], a[204:207]
v_cvt_pk_bf16_f32 v54, v204, v205
v_cvt_pk_bf16_f32 v55, v206, v207
v_mfma_f32_16x16x32_bf16 a[204:207], v[228:231], v[104:107], a[204:207]
s_waitcnt lgkmcnt(4)
buffer_store_dwordx4 v[52:55], v252, s[20:23], s45 offen offset:1024 sc1
v_mfma_f32_16x16x32_bf16 a[192:195], v[232:235], v[128:131], a[192:195]
ds_read_b64_tr_b16 v[224:225], v249 offset:12288
ds_read_b64_tr_b16 v[226:227], v249 offset:14336
v_mfma_f32_16x16x32_bf16 a[192:195], v[236:239], v[144:147], a[192:195]
v_accvgpr_read_b32 v212, a184
v_accvgpr_read_b32 v213, a185
v_mfma_f32_16x16x32_bf16 a[196:199], v[232:235], v[132:135], a[196:199]
v_accvgpr_read_b32 v214, a186
v_accvgpr_read_b32 v215, a187
v_mfma_f32_16x16x32_bf16 a[196:199], v[236:239], v[148:151], a[196:199]
v_cvt_pk_bf16_f32 v86, v212, v213
v_cvt_pk_bf16_f32 v87, v214, v215
v_mfma_f32_16x16x32_bf16 a[200:203], v[232:235], v[136:139], a[200:203]
ds_read_b64_tr_b16 v[228:229], v250 offset:12288
ds_read_b64_tr_b16 v[230:231], v250 offset:14336
v_mfma_f32_16x16x32_bf16 a[200:203], v[236:239], v[152:155], a[200:203]
buffer_store_dwordx4 v[84:87], v252, s[20:23], s46 offen offset:1024 sc1
v_accvgpr_read_b32 v220, a188
v_mfma_f32_16x16x32_bf16 a[204:207], v[232:235], v[140:143], a[204:207]
v_accvgpr_read_b32 v221, a189
v_accvgpr_read_b32 v222, a190
v_mfma_f32_16x16x32_bf16 a[204:207], v[236:239], v[156:159], a[204:207]
s_waitcnt lgkmcnt(4)
v_accvgpr_read_b32 v223, a191
v_mfma_f32_16x16x32_bf16 a[192:195], v[240:243], v[160:163], a[192:195]
ds_read_b64_tr_b16 v[232:233], v250 offset:45056
ds_read_b64_tr_b16 v[234:235], v250 offset:47104
v_mfma_f32_16x16x32_bf16 a[192:195], v[244:247], v[176:179], a[192:195]
v_cvt_pk_bf16_f32 v118, v220, v221
v_cvt_pk_bf16_f32 v119, v222, v223
v_mfma_f32_16x16x32_bf16 a[196:199], v[240:243], v[164:167], a[196:199]
buffer_store_dwordx4 v[116:119], v252, s[20:23], s47 offen offset:1024 sc1
v_mfma_f32_16x16x32_bf16 a[196:199], v[244:247], v[180:183], a[196:199]
v_mfma_f32_16x16x32_bf16 a[200:203], v[240:243], v[168:171], a[200:203]
ds_read_b64_tr_b16 v[236:237], v250 offset:61440
ds_read_b64_tr_b16 v[238:239], v250 offset:63488
v_mfma_f32_16x16x32_bf16 a[200:203], v[244:247], v[184:187], a[200:203]
v_mfma_f32_16x16x32_bf16 a[204:207], v[240:243], v[172:175], a[204:207]
v_mfma_f32_16x16x32_bf16 a[204:207], v[244:247], v[188:191], a[204:207]
s_waitcnt lgkmcnt(4)
v_mfma_f32_16x16x32_bf16 a[192:195], v[224:227], v[0:3], a[192:195]
ds_read_b64_tr_b16 v[240:241], v13 offset:12288
ds_read_b64_tr_b16 v[242:243], v13 offset:14336
v_mfma_f32_16x16x32_bf16 a[196:199], v[224:227], v[32:35], a[196:199]
v_mfma_f32_16x16x32_bf16 a[200:203], v[224:227], v[64:67], a[200:203]
v_mfma_f32_16x16x32_bf16 a[204:207], v[224:227], v[96:99], a[204:207]
v_mfma_f32_16x16x32_bf16 a[208:211], v[228:231], v[0:3], a[208:211]
ds_read_b64_tr_b16 v[244:245], v13 offset:28672
ds_read_b64_tr_b16 v[246:247], v13 offset:30720
v_mfma_f32_16x16x32_bf16 a[212:215], v[228:231], v[32:35], a[212:215]
v_accvgpr_read_b32 v192, a192
v_accvgpr_read_b32 v193, a193
v_mfma_f32_16x16x32_bf16 a[216:219], v[228:231], v[64:67], a[216:219]
v_accvgpr_read_b32 v194, a194
v_accvgpr_read_b32 v195, a195
v_mfma_f32_16x16x32_bf16 a[220:223], v[228:231], v[96:99], a[220:223]
s_waitcnt lgkmcnt(4)
v_cvt_pk_bf16_f32 v24, v192, v193
v_mfma_f32_16x16x32_bf16 a[208:211], v[232:235], v[4:7], a[208:211]
ds_read_b64_tr_b16 v[224:225], v13 offset:45056
ds_read_b64_tr_b16 v[226:227], v13 offset:47104
v_mfma_f32_16x16x32_bf16 a[208:211], v[236:239], v[8:11], a[208:211]
v_cvt_pk_bf16_f32 v25, v194, v195
v_accvgpr_read_b32 v200, a196
v_mfma_f32_16x16x32_bf16 a[212:215], v[232:235], v[36:39], a[212:215]
v_accvgpr_read_b32 v201, a197
v_accvgpr_read_b32 v202, a198
v_mfma_f32_16x16x32_bf16 a[212:215], v[236:239], v[40:43], a[212:215]
v_accvgpr_read_b32 v203, a199
v_cvt_pk_bf16_f32 v56, v200, v201
v_mfma_f32_16x16x32_bf16 a[216:219], v[232:235], v[68:71], a[216:219]
ds_read_b64_tr_b16 v[228:229], v13 offset:61440
ds_read_b64_tr_b16 v[230:231], v13 offset:63488
v_mfma_f32_16x16x32_bf16 a[216:219], v[236:239], v[72:75], a[216:219]
v_cvt_pk_bf16_f32 v57, v202, v203
v_accvgpr_read_b32 v208, a200
v_mfma_f32_16x16x32_bf16 a[220:223], v[232:235], v[100:103], a[220:223]
v_accvgpr_read_b32 v209, a201
v_accvgpr_read_b32 v210, a202
v_mfma_f32_16x16x32_bf16 a[220:223], v[236:239], v[104:107], a[220:223]
s_waitcnt lgkmcnt(4)
v_accvgpr_read_b32 v211, a203
v_mfma_f32_16x16x32_bf16 a[208:211], v[240:243], v[128:131], a[208:211]
ds_read_b64_tr_b16 v[232:233], v249 offset:45568
ds_read_b64_tr_b16 v[234:235], v249 offset:47616
v_mfma_f32_16x16x32_bf16 a[208:211], v[244:247], v[144:147], a[208:211]
v_cvt_pk_bf16_f32 v88, v208, v209
v_cvt_pk_bf16_f32 v89, v210, v211
v_mfma_f32_16x16x32_bf16 a[212:215], v[240:243], v[132:135], a[212:215]
v_accvgpr_read_b32 v216, a204
v_accvgpr_read_b32 v217, a205
v_mfma_f32_16x16x32_bf16 a[212:215], v[244:247], v[148:151], a[212:215]
v_accvgpr_read_b32 v218, a206
v_accvgpr_read_b32 v219, a207
v_mfma_f32_16x16x32_bf16 a[216:219], v[240:243], v[136:139], a[216:219]
ds_read_b64_tr_b16 v[236:237], v249 offset:61952
ds_read_b64_tr_b16 v[238:239], v249 offset:64000
v_mfma_f32_16x16x32_bf16 a[216:219], v[244:247], v[152:155], a[216:219]
v_cvt_pk_bf16_f32 v120, v216, v217
v_cvt_pk_bf16_f32 v121, v218, v219
v_mfma_f32_16x16x32_bf16 a[220:223], v[240:243], v[140:143], a[220:223]
v_mfma_f32_16x16x32_bf16 a[220:223], v[244:247], v[156:159], a[220:223]
s_waitcnt lgkmcnt(4)
v_mfma_f32_16x16x32_bf16 a[208:211], v[224:227], v[160:163], a[208:211]
ds_read_b64_tr_b16 v[240:241], v12 offset:12800
ds_read_b64_tr_b16 v[242:243], v12 offset:14848
v_mfma_f32_16x16x32_bf16 a[208:211], v[228:231], v[176:179], a[208:211]
v_mfma_f32_16x16x32_bf16 a[212:215], v[224:227], v[164:167], a[212:215]
v_mfma_f32_16x16x32_bf16 a[212:215], v[228:231], v[180:183], a[212:215]
v_mfma_f32_16x16x32_bf16 a[216:219], v[224:227], v[168:171], a[216:219]
ds_read_b64_tr_b16 v[244:245], v12 offset:29184
ds_read_b64_tr_b16 v[246:247], v12 offset:31232
v_mfma_f32_16x16x32_bf16 a[216:219], v[228:231], v[184:187], a[216:219]
v_mfma_f32_16x16x32_bf16 a[220:223], v[224:227], v[172:175], a[220:223]
s_nop 0
v_accvgpr_read_b32 v196, a208
v_accvgpr_read_b32 v197, a209
v_mfma_f32_16x16x32_bf16 a[220:223], v[228:231], v[188:191], a[220:223]
s_waitcnt lgkmcnt(4)
v_accvgpr_read_b32 v198, a210
v_mfma_f32_16x16x32_bf16 a[224:227], v[232:235], v[4:7], a[224:227]
ds_read_b64_tr_b16 v[224:225], v12 offset:45568
ds_read_b64_tr_b16 v[226:227], v12 offset:47616
v_mfma_f32_16x16x32_bf16 a[224:227], v[236:239], v[8:11], a[224:227]
v_accvgpr_read_b32 v199, a211
v_cvt_pk_bf16_f32 v26, v196, v197
v_mfma_f32_16x16x32_bf16 a[228:231], v[232:235], v[36:39], a[228:231]
v_cvt_pk_bf16_f32 v27, v198, v199
buffer_store_dwordx4 v[24:27], v252, s[20:23], s44 offen offset:2048 sc1
v_mfma_f32_16x16x32_bf16 a[228:231], v[236:239], v[40:43], a[228:231]
v_accvgpr_read_b32 v204, a212
v_accvgpr_read_b32 v205, a213
v_mfma_f32_16x16x32_bf16 a[232:235], v[232:235], v[68:71], a[232:235]
ds_read_b64_tr_b16 v[228:229], v12 offset:61952
ds_read_b64_tr_b16 v[230:231], v12 offset:64000
v_mfma_f32_16x16x32_bf16 a[232:235], v[236:239], v[72:75], a[232:235]
v_accvgpr_read_b32 v206, a214
v_accvgpr_read_b32 v207, a215
v_mfma_f32_16x16x32_bf16 a[236:239], v[232:235], v[100:103], a[236:239]
v_cvt_pk_bf16_f32 v58, v204, v205
v_cvt_pk_bf16_f32 v59, v206, v207
v_mfma_f32_16x16x32_bf16 a[236:239], v[236:239], v[104:107], a[236:239]
s_waitcnt lgkmcnt(4)
buffer_store_dwordx4 v[56:59], v252, s[20:23], s45 offen offset:2048 sc1
v_mfma_f32_16x16x32_bf16 a[224:227], v[240:243], v[128:131], a[224:227]
ds_read_b64_tr_b16 v[232:233], v249 offset:12800
ds_read_b64_tr_b16 v[234:235], v249 offset:14848
v_mfma_f32_16x16x32_bf16 a[224:227], v[244:247], v[144:147], a[224:227]
v_accvgpr_read_b32 v212, a216
v_accvgpr_read_b32 v213, a217
v_mfma_f32_16x16x32_bf16 a[228:231], v[240:243], v[132:135], a[228:231]
v_accvgpr_read_b32 v214, a218
v_accvgpr_read_b32 v215, a219
v_mfma_f32_16x16x32_bf16 a[228:231], v[244:247], v[148:151], a[228:231]
v_cvt_pk_bf16_f32 v90, v212, v213
v_cvt_pk_bf16_f32 v91, v214, v215
v_mfma_f32_16x16x32_bf16 a[232:235], v[240:243], v[136:139], a[232:235]
ds_read_b64_tr_b16 v[236:237], v250 offset:12800
ds_read_b64_tr_b16 v[238:239], v250 offset:14848
v_mfma_f32_16x16x32_bf16 a[232:235], v[244:247], v[152:155], a[232:235]
buffer_store_dwordx4 v[88:91], v252, s[20:23], s46 offen offset:2048 sc1
v_accvgpr_read_b32 v220, a220
v_mfma_f32_16x16x32_bf16 a[236:239], v[240:243], v[140:143], a[236:239]
v_accvgpr_read_b32 v221, a221
v_accvgpr_read_b32 v222, a222
v_mfma_f32_16x16x32_bf16 a[236:239], v[244:247], v[156:159], a[236:239]
s_waitcnt lgkmcnt(4)
v_accvgpr_read_b32 v223, a223
v_mfma_f32_16x16x32_bf16 a[224:227], v[224:227], v[160:163], a[224:227]
ds_read_b64_tr_b16 v[240:241], v250 offset:45568
ds_read_b64_tr_b16 v[242:243], v250 offset:47616
v_mfma_f32_16x16x32_bf16 a[224:227], v[228:231], v[176:179], a[224:227]
v_cvt_pk_bf16_f32 v122, v220, v221
v_cvt_pk_bf16_f32 v123, v222, v223
v_mfma_f32_16x16x32_bf16 a[228:231], v[224:227], v[164:167], a[228:231]
buffer_store_dwordx4 v[120:123], v252, s[20:23], s47 offen offset:2048 sc1
v_mfma_f32_16x16x32_bf16 a[228:231], v[228:231], v[180:183], a[228:231]
v_mfma_f32_16x16x32_bf16 a[232:235], v[224:227], v[168:171], a[232:235]
ds_read_b64_tr_b16 v[244:245], v250 offset:61952
ds_read_b64_tr_b16 v[246:247], v250 offset:64000
v_mfma_f32_16x16x32_bf16 a[232:235], v[228:231], v[184:187], a[232:235]
v_mfma_f32_16x16x32_bf16 a[236:239], v[224:227], v[172:175], a[236:239]
v_mfma_f32_16x16x32_bf16 a[236:239], v[228:231], v[188:191], a[236:239]
s_waitcnt lgkmcnt(4)
v_mfma_f32_16x16x32_bf16 a[224:227], v[232:235], v[0:3], a[224:227]
ds_read_b64_tr_b16 v[224:225], v13 offset:12800
ds_read_b64_tr_b16 v[226:227], v13 offset:14848
v_mfma_f32_16x16x32_bf16 a[228:231], v[232:235], v[32:35], a[228:231]
v_mfma_f32_16x16x32_bf16 a[232:235], v[232:235], v[64:67], a[232:235]
v_mfma_f32_16x16x32_bf16 a[236:239], v[232:235], v[96:99], a[236:239]
v_mfma_f32_16x16x32_bf16 a[240:243], v[236:239], v[0:3], a[240:243]
ds_read_b64_tr_b16 v[228:229], v13 offset:29184
ds_read_b64_tr_b16 v[230:231], v13 offset:31232
v_mfma_f32_16x16x32_bf16 a[244:247], v[236:239], v[32:35], a[244:247]
v_accvgpr_read_b32 v192, a224
v_accvgpr_read_b32 v193, a225
v_mfma_f32_16x16x32_bf16 a[248:251], v[236:239], v[64:67], a[248:251]
v_accvgpr_read_b32 v194, a226
v_accvgpr_read_b32 v195, a227
v_mfma_f32_16x16x32_bf16 a[252:255], v[236:239], v[96:99], a[252:255]
s_waitcnt lgkmcnt(4)
v_cvt_pk_bf16_f32 v28, v192, v193
v_mfma_f32_16x16x32_bf16 a[240:243], v[240:243], v[4:7], a[240:243]
ds_read_b64_tr_b16 v[232:233], v13 offset:45568
ds_read_b64_tr_b16 v[234:235], v13 offset:47616
v_mfma_f32_16x16x32_bf16 a[240:243], v[244:247], v[8:11], a[240:243]
v_cvt_pk_bf16_f32 v29, v194, v195
v_accvgpr_read_b32 v200, a228
v_mfma_f32_16x16x32_bf16 a[244:247], v[240:243], v[36:39], a[244:247]
v_accvgpr_read_b32 v201, a229
v_accvgpr_read_b32 v202, a230
v_mfma_f32_16x16x32_bf16 a[244:247], v[244:247], v[40:43], a[244:247]
v_accvgpr_read_b32 v203, a231
v_cvt_pk_bf16_f32 v60, v200, v201
v_mfma_f32_16x16x32_bf16 a[248:251], v[240:243], v[68:71], a[248:251]
ds_read_b64_tr_b16 v[236:237], v13 offset:61952
ds_read_b64_tr_b16 v[238:239], v13 offset:64000
v_mfma_f32_16x16x32_bf16 a[248:251], v[244:247], v[72:75], a[248:251]
v_cvt_pk_bf16_f32 v61, v202, v203
v_accvgpr_read_b32 v208, a232
v_mfma_f32_16x16x32_bf16 a[252:255], v[240:243], v[100:103], a[252:255]
v_accvgpr_read_b32 v209, a233
v_accvgpr_read_b32 v210, a234
v_mfma_f32_16x16x32_bf16 a[252:255], v[244:247], v[104:107], a[252:255]
s_waitcnt lgkmcnt(4)
v_accvgpr_read_b32 v211, a235
v_mfma_f32_16x16x32_bf16 a[240:243], v[224:227], v[128:131], a[240:243]
v_cvt_pk_bf16_f32 v92, v208, v209
v_cvt_pk_bf16_f32 v93, v210, v211
v_mfma_f32_16x16x32_bf16 a[240:243], v[228:231], v[144:147], a[240:243]
v_accvgpr_read_b32 v216, a236
v_accvgpr_read_b32 v217, a237
v_mfma_f32_16x16x32_bf16 a[244:247], v[224:227], v[132:135], a[244:247]
v_accvgpr_read_b32 v218, a238
v_accvgpr_read_b32 v219, a239
v_mfma_f32_16x16x32_bf16 a[244:247], v[228:231], v[148:151], a[244:247]
v_cvt_pk_bf16_f32 v124, v216, v217
v_cvt_pk_bf16_f32 v125, v218, v219
v_mfma_f32_16x16x32_bf16 a[248:251], v[224:227], v[136:139], a[248:251]
v_mfma_f32_16x16x32_bf16 a[248:251], v[228:231], v[152:155], a[248:251]
v_mfma_f32_16x16x32_bf16 a[252:255], v[224:227], v[140:143], a[252:255]
v_mfma_f32_16x16x32_bf16 a[252:255], v[228:231], v[156:159], a[252:255]
s_waitcnt lgkmcnt(0)
v_mfma_f32_16x16x32_bf16 a[240:243], v[232:235], v[160:163], a[240:243]
v_mfma_f32_16x16x32_bf16 a[240:243], v[236:239], v[176:179], a[240:243]
v_mfma_f32_16x16x32_bf16 a[244:247], v[232:235], v[164:167], a[244:247]
v_mfma_f32_16x16x32_bf16 a[244:247], v[236:239], v[180:183], a[244:247]
v_mfma_f32_16x16x32_bf16 a[248:251], v[232:235], v[168:171], a[248:251]
v_mfma_f32_16x16x32_bf16 a[248:251], v[236:239], v[184:187], a[248:251]
v_mfma_f32_16x16x32_bf16 a[252:255], v[232:235], v[172:175], a[252:255]
s_nop 2
v_accvgpr_read_b32 v196, a240
v_accvgpr_read_b32 v197, a241
v_accvgpr_read_b32 v198, a242
v_accvgpr_read_b32 v199, a243
v_mfma_f32_16x16x32_bf16 a[252:255], v[236:239], v[188:191], a[252:255]
v_cvt_pk_bf16_f32 v30, v196, v197
v_cvt_pk_bf16_f32 v31, v198, v199
buffer_store_dwordx4 v[28:31], v252, s[20:23], s44 offen offset:3072 sc1
v_accvgpr_read_b32 v204, a244
v_accvgpr_read_b32 v205, a245
v_accvgpr_read_b32 v206, a246
v_accvgpr_read_b32 v207, a247
v_cvt_pk_bf16_f32 v62, v204, v205
v_cvt_pk_bf16_f32 v63, v206, v207
buffer_store_dwordx4 v[60:63], v252, s[20:23], s45 offen offset:3072 sc1
v_accvgpr_read_b32 v212, a248
v_accvgpr_read_b32 v213, a249
v_accvgpr_read_b32 v214, a250
v_accvgpr_read_b32 v215, a251
v_cvt_pk_bf16_f32 v94, v212, v213
v_cvt_pk_bf16_f32 v95, v214, v215
buffer_store_dwordx4 v[92:95], v252, s[20:23], s46 offen offset:3072 sc1
v_accvgpr_read_b32 v220, a252
v_accvgpr_read_b32 v221, a253
v_accvgpr_read_b32 v222, a254
v_accvgpr_read_b32 v223, a255
v_cvt_pk_bf16_f32 v126, v220, v221
v_cvt_pk_bf16_f32 v127, v222, v223
buffer_store_dwordx4 v[124:127], v252, s[20:23], s47 offen offset:3072 sc1
s_branch L2_chk
L2_chk:
LC_start:
s_cmp_lg_u64 vcc, 0
s_cselect_b32 s98, 1, 0
LC_again:
s_lshl_b32 s48, s38, 7
s_lshl_b32 s49, s38, 7
s_lshl_b32 s50, s38, 7
s_mov_b32 s51, s37
s_cmp_eq_u32 s37, 5
s_cselect_b32 s14, 1, 0
s_cselect_b32 s52, 0x7fff0000, s52
s_cselect_b32 s53, 0x7fff0000, s53
s_cselect_b32 s54, 0x7fff0000, s54
s_cmp_eq_u32 s34, 0
s_cselect_b32 s15, 0x6c00000, s52
s_cselect_b32 s15, s15, 0x7fff0000
LC_common:
s_nop 0
s_bfe_u32 s3, s2, 0x30003
s_lshl_b32 s13, s34, 4
s_or_b32 s13, s13, s3
s_lshl_b32 s13, s13, 11
s_lshr_b32 s101, s3, 1
s_xor_b32 s101, s101, s34
s_lshl_b32 s101, s101, 10
s_add_u32 s101, s101, s100
s_cmp_eq_u32 s14, 1
s_cselect_b32 s13, 0x7fff0000, s13
s_add_u32 s28, s4, 0x7000000
s_addc_u32 s29, s5, 0
s_mov_b32 s30, 0x4e2000
s_mov_b32 s31, 0x00020000
s_lshl_b32 s33, s34, 7
v_bfe_u32 v5, v252, 4, 3
v_lshrrev_b32 v6, 8, v252
v_xor_b32 v5, v5, v6
v_lshrrev_b32 v6, 7, v252
v_lshl_add_u32 v6, v6, 9, s33
v_lshl_add_u32 v5, v5, 4, v6
v_xor_b32 v6, 64, v5
v_add_u32 v6, 0x1000, v6
s_cmp_ge_u32 s99, 60
s_cbranch_scc0 LC_side
LC_sideok:
s_add_u32 m0, s101, 0
s_nop 0
buffer_load_dwordx4 v5, s[28:31], s52 offen sc1 lds
s_add_u32 m0, s101, 4096
s_nop 0
buffer_load_dwordx4 v6, s[28:31], s52 offen sc1 lds
s_add_u32 m0, s101, 8192
s_nop 0
buffer_load_dwordx4 v5, s[28:31], s53 offen sc1 lds
s_add_u32 m0, s101, 12288
s_nop 0
buffer_load_dwordx4 v6, s[28:31], s53 offen sc1 lds
s_add_u32 m0, s101, 16384
s_nop 0
buffer_load_dwordx4 v5, s[28:31], s54 offen sc1 lds
s_add_u32 m0, s101, 20480
s_nop 0
buffer_load_dwordx4 v6, s[28:31], s54 offen sc1 lds
s_xor_b32 s33, s13, 0x0
buffer_load_dwordx4 a[0:3], v252, s[56:59], s33 offen offset:0
buffer_load_dwordx4 a[4:7], v252, s[56:59], s33 offen offset:1024
s_xor_b32 s35, s13, 0x4000
buffer_load_dwordx4 a[64:67], v252, s[56:59], s35 offen offset:0
buffer_load_dwordx4 a[68:71], v252, s[56:59], s35 offen offset:1024
s_xor_b32 s39, s13, 0x800
buffer_load_dwordx4 a[8:11], v252, s[56:59], s39 offen offset:0
buffer_load_dwordx4 a[12:15], v252, s[56:59], s39 offen offset:1024
s_xor_b32 s32, s13, 0x4800
buffer_load_dwordx4 a[72:75], v252, s[56:59], s32 offen offset:0
buffer_load_dwordx4 a[76:79], v252, s[56:59], s32 offen offset:1024
s_lshl_b32 s32, s34, 2
s_add_u32 s32, s32, s100
s_and_b32 s33, s98, 1
v_mov_b32 v42, s32
v_mov_b32 v43, s33
ds_write_b32 v42, v43 offset:24576
v_lshrrev_b32 v0, 4, v252
v_and_b32 v2, 15, v0
v_lshrrev_b32 v3, 4, v0
s_add_u32 s8, s6, 0x0
s_addc_u32 s9, s7, 0
s_mov_b32 s10, 0x4e2000
s_mov_b32 s11, 0x00020000
s_lshl_b32 s55, s34, 13
s_add_u32 s55, s55, 0x21000
s_lshl_b32 s33, s34, 7
v_bfe_u32 v9, v252, 4, 3
v_lshrrev_b32 v1, 7, v252
v_xor_b32 v9, v9, v1
v_lshl_add_u32 v1, v1, 9, s33
v_lshl_add_u32 v9, v9, 4, v1
s_lshl_b32 s73, s34, 11
s_add_u32 s73, s73, 0xe000
v_mov_b32 v4, 0x7fff0000
v_cmp_eq_u32 vcc, 0, v3
v_mov_b32 v1, s52
s_nop 0
v_cndmask_b32 v4, v4, v1, vcc
v_cmp_eq_u32 vcc, 1, v3
v_mov_b32 v1, s53
s_nop 0
v_cndmask_b32 v4, v4, v1, vcc
v_cmp_eq_u32 vcc, 2, v3
v_mov_b32 v1, s54
s_nop 0
v_cndmask_b32 v4, v4, v1, vcc
v_lshl_add_u32 v4, v2, 9, v4
v_lshrrev_b32 v7, 3, v4
s_add_u32 s20, s4, 0x2000000
s_addc_u32 s21, s5, 0
s_mov_b32 s22, 0x22e4000
s_mov_b32 s23, 0x00020000
s_add_u32 s40, s18, 0x0
s_addc_u32 s41, s19, 0
s_mov_b32 s42, 0x4e2000
s_mov_b32 s43, 0x00020000
s_add_u32 s60, s4, 0x7c00000
s_addc_u32 s61, s5, 0
s_mov_b32 s12, 0xffff0000
v_mov_b32 v40, s48
s_lshl_b32 s33, s34, 11
v_add_u32 v10, s33, v252
s_lshl_b32 s32, s3, 10
v_xor_b32 v38, s32, v10
v_add_u32 v38, 0x8000, v38
v_xor_b32 v39, 0x400, v38
v_lshrrev_b32 v1, 1, v2
v_xor_b32 v1, v1, v3
v_lshrrev_b32 v11, 3, v2
v_lshlrev_b32 v11, 12, v11
v_lshl_add_u32 v11, v1, 4, v11
v_and_b32 v1, 7, v2
v_lshl_add_u32 v11, v1, 7, v11
s_and_b32 s32, s3, 1
s_lshl_b32 s32, s32, 6
v_xor_b32 v11, s32, v11
v_add_u32 v11, s100, v11
v_xor_b32 v12, 64, v11
s_lshl_b32 s33, s34, 12
s_add_u32 s33, s33, 0x18000
v_lshl_add_u32 v13, v0, 6, s33
s_lshl_b32 s32, s51, 2
s_add_u32 s33, s33, s32
v_lshl_add_u32 v14, v2, 6, s33
v_xor_b32 v1, v1, v3
v_lshlrev_b32 v1, 4, v1
v_lshl_add_u32 v1, v2, 7, v1
v_add_u32 v32, s55, v1
v_xor_b32 v33, 64, v32
v_add_u32 v35, s73, v1
v_xor_b32 v36, 64, v35
v_add_u32 v34, s55, v252
v_add_u32 v37, s73, v252
s_lshl_b32 s32, s34, 11
s_cmp_lt_u32 s34, 2
s_cselect_b32 s33, 0x20000, s32
s_cselect_b32 s33, s33, 0x1b000
s_cselect_b32 s35, 13, 12
s_add_u32 s32, s32, s33
s_mul_i32 s33, s51, 3
s_add_u32 s39, s33, 0
s_and_b32 s39, s39, 3
s_lshl_b32 s39, s39, s35
s_add_u32 s39, s39, s32
v_add_u32 v44, s39, v252
s_add_u32 s39, s33, 1
s_and_b32 s39, s39, 3
s_lshl_b32 s39, s39, s35
s_add_u32 s39, s39, s32
v_add_u32 v45, s39, v252
s_add_u32 s39, s33, 2
s_and_b32 s39, s39, 3
s_lshl_b32 s39, s39, s35
s_add_u32 s39, s39, s32
v_add_u32 v46, s39, v252
s_add_u32 s32, s51, 1
s_sub_u32 s33, s32, 6
s_cselect_b32 s32, s32, s33
s_mul_i32 s44, s32, 0x600000
s_add_u32 s32, s51, 2
s_sub_u32 s33, s32, 6
s_cselect_b32 s32, s32, s33
s_mul_i32 s45, s32, 0x600000
s_add_u32 s32, s51, 3
s_sub_u32 s33, s32, 6
s_cselect_b32 s32, s32, s33
s_mul_i32 s46, s32, 0x600000
s_add_u32 s32, s51, 4
s_sub_u32 s33, s32, 6
s_cselect_b32 s32, s32, s33
s_mul_i32 s47, s32, 0x600000
v_mov_b32 v41, 1
v_and_b32 v42, 3, v0
v_lshl_add_u32 v42, v42, 2, s100
s_lshl_b32 s33, s34, 12
s_cmp_lt_u32 s98, 2
s_cselect_b32 s33, s33, 0x100000
v_add_u32 v1, s33, v252
v_add_u32 v1, 0x1c000, v1
s_waitcnt vmcnt(14)
s_waitcnt lgkmcnt(0)
s_barrier
ds_read_b32 v43, v42 offset:24576
ds_write_b128 v1, v[16:19] offset:0
ds_write_b128 v1, v[20:23] offset:1024
ds_write_b128 v1, v[24:27] offset:2048
ds_write_b128 v1, v[28:31] offset:3072
s_waitcnt lgkmcnt(4)
v_cmp_ne_u32 vcc, 0, v43
s_cbranch_vccnz LC_slow
s_mov_b64 exec, 1
buffer_atomic_add v41, v40, s[56:59], s15 offen
s_mov_b64 exec, -1
s_cmp_eq_u32 s14, 1
s_cbranch_scc1 L2_fin
s_add_u32 s32, s51, 5
s_sub_u32 s33, s32, 6
s_cselect_b32 s32, s32, s33
s_mul_i32 s15, s32, 0x600000
s_add_u32 m0, s73, 0
s_add_u32 s33, s54, 0
buffer_load_dwordx4 v9, s[8:11], s33 offen lds
s_add_u32 m0, s73, 1024
s_add_u32 s35, s54, 4096
buffer_load_dwordx4 v9, s[8:11], s35 offen lds
s_xor_b32 s39, s13, 0x1000
buffer_load_dwordx4 a[16:19], v252, s[56:59], s39 offen offset:0
buffer_load_dwordx4 a[20:23], v252, s[56:59], s39 offen offset:1024
s_xor_b32 s32, s13, 0x5000
buffer_load_dwordx4 a[80:83], v252, s[56:59], s32 offen offset:0
buffer_load_dwordx4 a[84:87], v252, s[56:59], s32 offen offset:1024
s_xor_b32 s33, s13, 0x1800
buffer_load_dwordx4 a[24:27], v252, s[56:59], s33 offen offset:0
buffer_load_dwordx4 a[28:31], v252, s[56:59], s33 offen offset:1024
s_xor_b32 s35, s13, 0x5800
buffer_load_dwordx4 a[88:91], v252, s[56:59], s35 offen offset:0
buffer_load_dwordx4 a[92:95], v252, s[56:59], s35 offen offset:1024
s_xor_b32 s39, s13, 0x2000
buffer_load_dwordx4 a[32:35], v252, s[56:59], s39 offen offset:0
buffer_load_dwordx4 a[36:39], v252, s[56:59], s39 offen offset:1024
ds_read_b128 v[52:55], v32 offset:0
ds_read_b128 v[60:63], v33 offset:0
s_waitcnt lgkmcnt(1)
v_lshlrev_b32 v48, 16, v52
v_and_b32 v49, s12, v52
v_lshlrev_b32 v50, 16, v53
v_and_b32 v51, s12, v53
v_lshlrev_b32 v52, 16, v54
v_and_b32 v53, s12, v54
v_lshlrev_b32 v54, 16, v55
v_and_b32 v55, s12, v55
s_waitcnt lgkmcnt(0)
v_lshlrev_b32 v56, 16, v60
v_and_b32 v57, s12, v60
v_lshlrev_b32 v58, 16, v61
v_and_b32 v59, s12, v61
v_lshlrev_b32 v60, 16, v62
v_and_b32 v61, s12, v62
v_lshlrev_b32 v62, 16, v63
v_and_b32 v63, s12, v63
ds_read_b128 v[68:71], v32 offset:2048
ds_read_b128 v[76:79], v33 offset:2048
s_waitcnt lgkmcnt(1)
v_lshlrev_b32 v64, 16, v68
v_and_b32 v65, s12, v68
v_lshlrev_b32 v66, 16, v69
v_and_b32 v67, s12, v69
v_lshlrev_b32 v68, 16, v70
v_and_b32 v69, s12, v70
v_lshlrev_b32 v70, 16, v71
v_and_b32 v71, s12, v71
s_waitcnt lgkmcnt(0)
v_lshlrev_b32 v72, 16, v76
v_and_b32 v73, s12, v76
v_lshlrev_b32 v74, 16, v77
v_and_b32 v75, s12, v77
v_lshlrev_b32 v76, 16, v78
v_and_b32 v77, s12, v78
v_lshlrev_b32 v78, 16, v79
v_and_b32 v79, s12, v79
s_waitcnt vmcnt(11)
s_xor_b32 s32, s13, 0x6000
buffer_load_dwordx4 a[96:99], v252, s[56:59], s32 offen offset:0
s_waitcnt vmcnt(11)
buffer_load_dwordx4 a[100:103], v252, s[56:59], s32 offen offset:1024
s_waitcnt vmcnt(11)
s_xor_b32 s33, s13, 0x2800
buffer_load_dwordx4 a[40:43], v252, s[56:59], s33 offen offset:0
s_waitcnt vmcnt(11)
buffer_load_dwordx4 a[44:47], v252, s[56:59], s33 offen offset:1024
s_waitcnt vmcnt(11)
s_xor_b32 s35, s13, 0x6800
buffer_load_dwordx4 a[104:107], v252, s[56:59], s35 offen offset:0
s_waitcnt vmcnt(11)
buffer_load_dwordx4 a[108:111], v252, s[56:59], s35 offen offset:1024
s_waitcnt vmcnt(11)
s_mov_b32 s70, 0
s_atomic_add s70, s[60:61], s48 glc
s_waitcnt vmcnt(10)
s_xor_b32 s39, s13, 0x3000
buffer_load_dwordx4 a[48:51], v252, s[56:59], s39 offen offset:0
s_waitcnt vmcnt(10)
buffer_load_dwordx4 a[52:55], v252, s[56:59], s39 offen offset:1024
s_waitcnt vmcnt(10)
s_xor_b32 s32, s13, 0x7000
buffer_load_dwordx4 a[112:115], v252, s[56:59], s32 offen offset:0
s_waitcnt vmcnt(10)
buffer_load_dwordx4 a[116:119], v252, s[56:59], s32 offen offset:1024
s_waitcnt vmcnt(10)
s_xor_b32 s33, s13, 0x3800
buffer_load_dwordx4 a[56:59], v252, s[56:59], s33 offen offset:0
s_waitcnt vmcnt(10)
buffer_load_dwordx4 a[60:63], v252, s[56:59], s33 offen offset:1024
s_waitcnt vmcnt(10)
s_xor_b32 s35, s13, 0x7800
buffer_load_dwordx4 a[120:123], v252, s[56:59], s35 offen offset:0
s_waitcnt vmcnt(10)
buffer_load_dwordx4 a[124:127], v252, s[56:59], s35 offen offset:1024
s_waitcnt lgkmcnt(0)
s_cmp_lt_u32 s70, 6
s_cbranch_scc1 LC_poll
s_cmp_ge_u32 s98, 2
s_cbranch_scc1 LC_poll
LC_got:
buffer_load_dwordx4 v[156:159], v7, s[24:27], 0 offen offset:0 sc1
buffer_load_dwordx4 v[160:163], v7, s[24:27], 0 offen offset:16 sc1
buffer_load_dwordx4 v[164:167], v7, s[24:27], 0 offen offset:32 sc1
s_add_u32 s39, s52, s44
buffer_load_dwordx4 v[168:171], v10, s[20:23], s39 offen offset:0 sc1
s_add_u32 s32, s52, s45
buffer_load_dwordx4 v[172:175], v10, s[20:23], s32 offen offset:0 sc1
s_add_u32 s33, s52, s46
buffer_load_dwordx4 v[176:179], v10, s[20:23], s33 offen offset:0 sc1
s_add_u32 s35, s52, s47
buffer_load_dwordx4 v[180:183], v10, s[20:23], s35 offen offset:0 sc1
s_add_u32 s39, s52, s15
buffer_load_dwordx4 v[184:187], v10, s[20:23], s39 offen offset:0 sc1
s_add_u32 s32, s52, s44
buffer_load_dwordx4 v[188:191], v10, s[20:23], s32 offen offset:1024 sc1
s_add_u32 s33, s52, s45
buffer_load_dwordx4 v[192:195], v10, s[20:23], s33 offen offset:1024 sc1
s_add_u32 s35, s52, s46
buffer_load_dwordx4 v[196:199], v10, s[20:23], s35 offen offset:1024 sc1
s_add_u32 s39, s52, s47
buffer_load_dwordx4 v[200:203], v10, s[20:23], s39 offen offset:1024 sc1
s_add_u32 s32, s52, s15
buffer_load_dwordx4 v[204:207], v10, s[20:23], s32 offen offset:1024 sc1
s_xor_b32 s33, s13, 0x20000
buffer_load_dwordx4 a[128:131], v252, s[56:59], s33 offen offset:0
s_barrier
ds_read_b128 v[132:135], v11 offset:0
ds_read_b128 v[136:139], v11 offset:8192
ds_read_b128 v[140:143], v11 offset:16384
ds_read_b128 v[144:147], v12 offset:0
ds_read_b128 v[148:151], v12 offset:8192
s_waitcnt vmcnt(24)
s_waitcnt vmcnt(23)
s_waitcnt vmcnt(22)
s_waitcnt vmcnt(21)
s_waitcnt vmcnt(20)
s_waitcnt vmcnt(19)
s_waitcnt vmcnt(18)
s_waitcnt vmcnt(17)
s_waitcnt vmcnt(16)
s_waitcnt vmcnt(15)
s_waitcnt vmcnt(14)
s_waitcnt lgkmcnt(4)
v_mfma_f32_16x16x32_bf16 v[48:51], a[0:3], v[132:135], v[48:51]
ds_read_b128 v[152:155], v12 offset:16384
v_mfma_f32_16x16x32_bf16 v[52:55], a[4:7], v[132:135], v[52:55]
v_mfma_f32_16x16x32_bf16 v[56:59], a[64:67], v[132:135], v[56:59]
v_mfma_f32_16x16x32_bf16 v[60:63], a[68:71], v[132:135], v[60:63]
s_waitcnt lgkmcnt(4)
v_mfma_f32_16x16x32_bf16 v[64:67], a[0:3], v[136:139], v[64:67]
ds_read_b128 v[132:135], v11 offset:1024
v_mfma_f32_16x16x32_bf16 v[68:71], a[4:7], v[136:139], v[68:71]
v_mfma_f32_16x16x32_bf16 v[72:75], a[64:67], v[136:139], v[72:75]
v_mfma_f32_16x16x32_bf16 v[76:79], a[68:71], v[136:139], v[76:79]
ds_read_b128 v[84:87], v35 offset:0
ds_read_b128 v[92:95], v36 offset:0
s_waitcnt lgkmcnt(1)
v_lshlrev_b32 v80, 16, v84
v_and_b32 v81, s12, v84
v_lshlrev_b32 v82, 16, v85
v_and_b32 v83, s12, v85
v_lshlrev_b32 v84, 16, v86
v_and_b32 v85, s12, v86
v_lshlrev_b32 v86, 16, v87
v_and_b32 v87, s12, v87
s_waitcnt lgkmcnt(0)
v_lshlrev_b32 v88, 16, v92
v_and_b32 v89, s12, v92
v_lshlrev_b32 v90, 16, v93
v_and_b32 v91, s12, v93
v_lshlrev_b32 v92, 16, v94
v_and_b32 v93, s12, v94
v_lshlrev_b32 v94, 16, v95
v_and_b32 v95, s12, v95
v_mfma_f32_16x16x32_bf16 v[80:83], a[0:3], v[140:143], v[80:83]
ds_read_b128 v[136:139], v11 offset:9216
v_mfma_f32_16x16x32_bf16 v[84:87], a[4:7], v[140:143], v[84:87]
v_mfma_f32_16x16x32_bf16 v[88:91], a[64:67], v[140:143], v[88:91]
v_mfma_f32_16x16x32_bf16 v[92:95], a[68:71], v[140:143], v[92:95]
v_mfma_f32_16x16x32_bf16 v[48:51], a[8:11], v[144:147], v[48:51]
ds_read_b128 v[140:143], v11 offset:17408
v_mfma_f32_16x16x32_bf16 v[52:55], a[12:15], v[144:147], v[52:55]
v_mfma_f32_16x16x32_bf16 v[56:59], a[72:75], v[144:147], v[56:59]
v_mfma_f32_16x16x32_bf16 v[60:63], a[76:79], v[144:147], v[60:63]
v_mfma_f32_16x16x32_bf16 v[64:67], a[8:11], v[148:151], v[64:67]
ds_read_b128 v[144:147], v12 offset:1024
v_mfma_f32_16x16x32_bf16 v[68:71], a[12:15], v[148:151], v[68:71]
v_mfma_f32_16x16x32_bf16 v[72:75], a[72:75], v[148:151], v[72:75]
v_mfma_f32_16x16x32_bf16 v[76:79], a[76:79], v[148:151], v[76:79]
v_mfma_f32_16x16x32_bf16 v[80:83], a[8:11], v[152:155], v[80:83]
ds_read_b128 v[148:151], v12 offset:9216
v_mfma_f32_16x16x32_bf16 v[84:87], a[12:15], v[152:155], v[84:87]
v_mfma_f32_16x16x32_bf16 v[88:91], a[72:75], v[152:155], v[88:91]
v_mfma_f32_16x16x32_bf16 v[92:95], a[76:79], v[152:155], v[92:95]
v_mfma_f32_16x16x32_bf16 v[48:51], a[16:19], v[132:135], v[48:51]
ds_read_b128 v[152:155], v12 offset:17408
v_mfma_f32_16x16x32_bf16 v[52:55], a[20:23], v[132:135], v[52:55]
v_mfma_f32_16x16x32_bf16 v[56:59], a[80:83], v[132:135], v[56:59]
v_mfma_f32_16x16x32_bf16 v[60:63], a[84:87], v[132:135], v[60:63]
s_waitcnt lgkmcnt(4)
v_mfma_f32_16x16x32_bf16 v[64:67], a[16:19], v[136:139], v[64:67]
ds_read_b128 v[132:135], v11 offset:2048
v_mfma_f32_16x16x32_bf16 v[68:71], a[20:23], v[136:139], v[68:71]
v_mfma_f32_16x16x32_bf16 v[72:75], a[80:83], v[136:139], v[72:75]
v_mfma_f32_16x16x32_bf16 v[76:79], a[84:87], v[136:139], v[76:79]
s_waitcnt lgkmcnt(4)
v_mfma_f32_16x16x32_bf16 v[80:83], a[16:19], v[140:143], v[80:83]
ds_read_b128 v[136:139], v11 offset:10240
v_mfma_f32_16x16x32_bf16 v[84:87], a[20:23], v[140:143], v[84:87]
v_mfma_f32_16x16x32_bf16 v[88:91], a[80:83], v[140:143], v[88:91]
v_mfma_f32_16x16x32_bf16 v[92:95], a[84:87], v[140:143], v[92:95]
s_waitcnt lgkmcnt(4)
v_mfma_f32_16x16x32_bf16 v[48:51], a[24:27], v[144:147], v[48:51]
ds_read_b128 v[140:143], v11 offset:18432
v_mfma_f32_16x16x32_bf16 v[52:55], a[28:31], v[144:147], v[52:55]
v_mfma_f32_16x16x32_bf16 v[56:59], a[88:91], v[144:147], v[56:59]
v_mfma_f32_16x16x32_bf16 v[60:63], a[92:95], v[144:147], v[60:63]
s_waitcnt lgkmcnt(4)
v_mfma_f32_16x16x32_bf16 v[64:67], a[24:27], v[148:151], v[64:67]
ds_read_b128 v[144:147], v12 offset:2048
v_mfma_f32_16x16x32_bf16 v[68:71], a[28:31], v[148:151], v[68:71]
v_mfma_f32_16x16x32_bf16 v[72:75], a[88:91], v[148:151], v[72:75]
v_mfma_f32_16x16x32_bf16 v[76:79], a[92:95], v[148:151], v[76:79]
s_waitcnt lgkmcnt(4)
v_mfma_f32_16x16x32_bf16 v[80:83], a[24:27], v[152:155], v[80:83]
ds_read_b128 v[148:151], v12 offset:10240
v_mfma_f32_16x16x32_bf16 v[84:87], a[28:31], v[152:155], v[84:87]
v_mfma_f32_16x16x32_bf16 v[88:91], a[88:91], v[152:155], v[88:91]
v_mfma_f32_16x16x32_bf16 v[92:95], a[92:95], v[152:155], v[92:95]
s_waitcnt lgkmcnt(4)
v_mfma_f32_16x16x32_bf16 v[48:51], a[32:35], v[132:135], v[48:51]
ds_read_b128 v[152:155], v12 offset:18432
v_mfma_f32_16x16x32_bf16 v[52:55], a[36:39], v[132:135], v[52:55]
v_mfma_f32_16x16x32_bf16 v[56:59], a[96:99], v[132:135], v[56:59]
v_mfma_f32_16x16x32_bf16 v[60:63], a[100:103], v[132:135], v[60:63]
s_waitcnt lgkmcnt(4)
v_mfma_f32_16x16x32_bf16 v[64:67], a[32:35], v[136:139], v[64:67]
ds_read_b128 v[132:135], v11 offset:3072
v_mfma_f32_16x16x32_bf16 v[68:71], a[36:39], v[136:139], v[68:71]
v_mfma_f32_16x16x32_bf16 v[72:75], a[96:99], v[136:139], v[72:75]
v_mfma_f32_16x16x32_bf16 v[76:79], a[100:103], v[136:139], v[76:79]
s_waitcnt lgkmcnt(4)
v_mfma_f32_16x16x32_bf16 v[80:83], a[32:35], v[140:143], v[80:83]
ds_read_b128 v[136:139], v11 offset:11264
v_mfma_f32_16x16x32_bf16 v[84:87], a[36:39], v[140:143], v[84:87]
v_mfma_f32_16x16x32_bf16 v[88:91], a[96:99], v[140:143], v[88:91]
v_mfma_f32_16x16x32_bf16 v[92:95], a[100:103], v[140:143], v[92:95]
s_waitcnt lgkmcnt(4)
v_mfma_f32_16x16x32_bf16 v[48:51], a[40:43], v[144:147], v[48:51]
ds_read_b128 v[140:143], v11 offset:19456
v_mfma_f32_16x16x32_bf16 v[52:55], a[44:47], v[144:147], v[52:55]
v_mfma_f32_16x16x32_bf16 v[56:59], a[104:107], v[144:147], v[56:59]
v_mfma_f32_16x16x32_bf16 v[60:63], a[108:111], v[144:147], v[60:63]
s_waitcnt lgkmcnt(4)
v_mfma_f32_16x16x32_bf16 v[64:67], a[40:43], v[148:151], v[64:67]
ds_read_b128 v[144:147], v12 offset:3072
v_mfma_f32_16x16x32_bf16 v[68:71], a[44:47], v[148:151], v[68:71]
v_mfma_f32_16x16x32_bf16 v[72:75], a[104:107], v[148:151], v[72:75]
v_mfma_f32_16x16x32_bf16 v[76:79], a[108:111], v[148:151], v[76:79]
s_waitcnt lgkmcnt(4)
v_mfma_f32_16x16x32_bf16 v[80:83], a[40:43], v[152:155], v[80:83]
ds_read_b128 v[148:151], v12 offset:11264
v_mfma_f32_16x16x32_bf16 v[84:87], a[44:47], v[152:155], v[84:87]
v_mfma_f32_16x16x32_bf16 v[88:91], a[104:107], v[152:155], v[88:91]
v_mfma_f32_16x16x32_bf16 v[92:95], a[108:111], v[152:155], v[92:95]
s_waitcnt lgkmcnt(4)
v_mfma_f32_16x16x32_bf16 v[48:51], a[48:51], v[132:135], v[48:51]
ds_read_b128 v[152:155], v12 offset:19456
v_mfma_f32_16x16x32_bf16 v[52:55], a[52:55], v[132:135], v[52:55]
v_mfma_f32_16x16x32_bf16 v[56:59], a[112:115], v[132:135], v[56:59]
v_mfma_f32_16x16x32_bf16 v[60:63], a[116:119], v[132:135], v[60:63]
s_waitcnt lgkmcnt(4)
v_mfma_f32_16x16x32_bf16 v[64:67], a[48:51], v[136:139], v[64:67]
v_mfma_f32_16x16x32_bf16 v[68:71], a[52:55], v[136:139], v[68:71]
v_mfma_f32_16x16x32_bf16 v[72:75], a[112:115], v[136:139], v[72:75]
v_mfma_f32_16x16x32_bf16 v[76:79], a[116:119], v[136:139], v[76:79]
s_waitcnt lgkmcnt(3)
v_mfma_f32_16x16x32_bf16 v[80:83], a[48:51], v[140:143], v[80:83]
v_mfma_f32_16x16x32_bf16 v[84:87], a[52:55], v[140:143], v[84:87]
v_mfma_f32_16x16x32_bf16 v[88:91], a[112:115], v[140:143], v[88:91]
v_mfma_f32_16x16x32_bf16 v[92:95], a[116:119], v[140:143], v[92:95]
s_waitcnt lgkmcnt(2)
v_mfma_f32_16x16x32_bf16 v[48:51], a[56:59], v[144:147], v[48:51]
v_mfma_f32_16x16x32_bf16 v[52:55], a[60:63], v[144:147], v[52:55]
v_mfma_f32_16x16x32_bf16 v[56:59], a[120:123], v[144:147], v[56:59]
v_mfma_f32_16x16x32_bf16 v[60:63], a[124:127], v[144:147], v[60:63]
s_waitcnt lgkmcnt(1)
v_mfma_f32_16x16x32_bf16 v[64:67], a[56:59], v[148:151], v[64:67]
v_mfma_f32_16x16x32_bf16 v[68:71], a[60:63], v[148:151], v[68:71]
v_mfma_f32_16x16x32_bf16 v[72:75], a[120:123], v[148:151], v[72:75]
v_mfma_f32_16x16x32_bf16 v[76:79], a[124:127], v[148:151], v[76:79]
s_waitcnt lgkmcnt(0)
v_mfma_f32_16x16x32_bf16 v[80:83], a[56:59], v[152:155], v[80:83]
v_mfma_f32_16x16x32_bf16 v[84:87], a[60:63], v[152:155], v[84:87]
v_mfma_f32_16x16x32_bf16 v[88:91], a[120:123], v[152:155], v[88:91]
v_mfma_f32_16x16x32_bf16 v[92:95], a[124:127], v[152:155], v[92:95]
s_waitcnt vmcnt(13)
buffer_load_dwordx4 a[132:135], v252, s[56:59], s33 offen offset:1024
s_waitcnt vmcnt(13)
s_xor_b32 s35, s13, 0x24000
buffer_load_dwordx4 a[192:195], v252, s[56:59], s35 offen offset:0
s_waitcnt vmcnt(13)
buffer_load_dwordx4 a[196:199], v252, s[56:59], s35 offen offset:1024
v_max3_f32 v1, v156, v158, v160
v_max3_f32 v117, v162, v164, v166
v_max_f32 v1, v1, v117
v_sub_f32 v156, v156, v1
v_sub_f32 v158, v158, v1
v_sub_f32 v160, v160, v1
v_sub_f32 v162, v162, v1
v_sub_f32 v164, v164, v1
v_sub_f32 v166, v166, v1
v_exp_f32 v156, v156
v_exp_f32 v158, v158
v_exp_f32 v160, v160
v_exp_f32 v162, v162
v_exp_f32 v164, v164
v_exp_f32 v166, v166
s_nop 0
v_mul_f32 v1, v156, v157
v_fmac_f32 v1, v158, v159
v_fmac_f32 v1, v160, v161
v_fmac_f32 v1, v162, v163
v_fmac_f32 v1, v164, v165
v_fmac_f32 v1, v166, v167
v_rcp_f32 v1, v1
s_nop 0
v_mul_f32 v108, v156, v1
v_mul_f32 v109, v158, v1
v_mul_f32 v110, v160, v1
v_mul_f32 v111, v162, v1
v_mul_f32 v112, v164, v1
v_mul_f32 v113, v166, v1
v_mul_f32 v114, v156, v1
v_mul_f32 v115, v158, v1
ds_write_b128 v13, v[108:111]
ds_write_b128 v13, v[112:115] offset:16
ds_write_b64 v13, v[110:111] offset:32
ds_write_b64 v13, v[112:113] offset:40
ds_read2_b32 v[100:101], v14 offset0:1 offset1:2
ds_read2_b32 v[102:103], v14 offset0:3 offset1:4
ds_read2_b32 v[104:105], v14 offset0:5 offset1:6
v_add_u32 v14, 0x400, v14
s_waitcnt vmcnt(13)
s_xor_b32 s39, s13, 0x20800
buffer_load_dwordx4 a[136:139], v252, s[56:59], s39 offen offset:0
ds_read_b128 v[96:99], v44 offset:0
s_waitcnt lgkmcnt(1)
v_lshlrev_b32 v118, 16, v168
v_and_b32 v119, s12, v168
v_mul_f32 v108, v118, v100
v_mul_f32 v109, v119, v100
v_lshlrev_b32 v120, 16, v169
v_and_b32 v121, s12, v169
v_mul_f32 v110, v120, v100
v_mul_f32 v111, v121, v100
v_lshlrev_b32 v122, 16, v170
v_and_b32 v123, s12, v170
v_mul_f32 v112, v122, v100
v_mul_f32 v113, v123, v100
v_lshlrev_b32 v116, 16, v171
v_and_b32 v117, s12, v171
v_mul_f32 v114, v116, v100
v_mul_f32 v115, v117, v100
s_waitcnt vmcnt(13)
buffer_load_dwordx4 a[140:143], v252, s[56:59], s39 offen offset:1024
v_lshlrev_b32 v118, 16, v172
v_and_b32 v119, s12, v172
v_fmac_f32 v108, v118, v101
v_fmac_f32 v109, v119, v101
v_lshlrev_b32 v120, 16, v173
v_and_b32 v121, s12, v173
v_fmac_f32 v110, v120, v101
v_fmac_f32 v111, v121, v101
v_lshlrev_b32 v122, 16, v174
v_and_b32 v123, s12, v174
v_fmac_f32 v112, v122, v101
v_fmac_f32 v113, v123, v101
v_lshlrev_b32 v116, 16, v175
v_and_b32 v117, s12, v175
v_fmac_f32 v114, v116, v101
v_fmac_f32 v115, v117, v101
s_waitcnt lgkmcnt(0)
v_lshlrev_b32 v118, 16, v96
v_and_b32 v119, s12, v96
v_fmac_f32 v108, v118, v105
v_fmac_f32 v109, v119, v105
v_lshlrev_b32 v120, 16, v97
v_and_b32 v121, s12, v97
v_fmac_f32 v110, v120, v105
v_fmac_f32 v111, v121, v105
v_lshlrev_b32 v122, 16, v98
v_and_b32 v123, s12, v98
v_fmac_f32 v112, v122, v105
v_fmac_f32 v113, v123, v105
v_lshlrev_b32 v116, 16, v99
v_and_b32 v117, s12, v99
v_fmac_f32 v114, v116, v105
v_fmac_f32 v115, v117, v105
s_waitcnt vmcnt(13)
s_xor_b32 s32, s13, 0x24800
buffer_load_dwordx4 a[200:203], v252, s[56:59], s32 offen offset:0
v_lshlrev_b32 v118, 16, v176
v_and_b32 v119, s12, v176
v_fmac_f32 v108, v118, v102
v_fmac_f32 v109, v119, v102
v_lshlrev_b32 v120, 16, v177
v_and_b32 v121, s12, v177
v_fmac_f32 v110, v120, v102
v_fmac_f32 v111, v121, v102
v_lshlrev_b32 v122, 16, v178
v_and_b32 v123, s12, v178
v_fmac_f32 v112, v122, v102
v_fmac_f32 v113, v123, v102
v_lshlrev_b32 v116, 16, v179
v_and_b32 v117, s12, v179
v_fmac_f32 v114, v116, v102
v_fmac_f32 v115, v117, v102
s_waitcnt vmcnt(13)
buffer_load_dwordx4 a[204:207], v252, s[56:59], s32 offen offset:1024
v_lshlrev_b32 v118, 16, v180
v_and_b32 v119, s12, v180
v_fmac_f32 v108, v118, v103
v_fmac_f32 v109, v119, v103
v_lshlrev_b32 v120, 16, v181
v_and_b32 v121, s12, v181
v_fmac_f32 v110, v120, v103
v_fmac_f32 v111, v121, v103
v_lshlrev_b32 v122, 16, v182
v_and_b32 v123, s12, v182
v_fmac_f32 v112, v122, v103
v_fmac_f32 v113, v123, v103
v_lshlrev_b32 v116, 16, v183
v_and_b32 v117, s12, v183
v_fmac_f32 v114, v116, v103
v_fmac_f32 v115, v117, v103
s_waitcnt vmcnt(13)
s_add_u32 s33, s53, s44
buffer_load_dwordx4 v[208:211], v10, s[20:23], s33 offen offset:0 sc1
v_lshlrev_b32 v118, 16, v184
v_and_b32 v119, s12, v184
v_fmac_f32 v108, v118, v104
v_fmac_f32 v109, v119, v104
v_lshlrev_b32 v120, 16, v185
v_and_b32 v121, s12, v185
v_fmac_f32 v110, v120, v104
v_fmac_f32 v111, v121, v104
v_lshlrev_b32 v122, 16, v186
v_and_b32 v123, s12, v186
v_fmac_f32 v112, v122, v104
v_fmac_f32 v113, v123, v104
v_lshlrev_b32 v116, 16, v187
v_and_b32 v117, s12, v187
v_fmac_f32 v114, v116, v104
v_fmac_f32 v115, v117, v104
v_cvt_pk_bf16_f32 v116, v108, v109
v_cvt_pk_bf16_f32 v117, v110, v111
v_cvt_pk_bf16_f32 v118, v112, v113
v_cvt_pk_bf16_f32 v119, v114, v115
ds_write_b128 v38, v[116:119] offset:0
s_waitcnt vmcnt(13)
s_xor_b32 s35, s13, 0x21000
buffer_load_dwordx4 a[144:147], v252, s[56:59], s35 offen offset:0
ds_read_b128 v[96:99], v44 offset:1024
v_lshlrev_b32 v118, 16, v188
v_and_b32 v119, s12, v188
v_mul_f32 v108, v118, v100
v_mul_f32 v109, v119, v100
v_lshlrev_b32 v120, 16, v189
v_and_b32 v121, s12, v189
v_mul_f32 v110, v120, v100
v_mul_f32 v111, v121, v100
v_lshlrev_b32 v122, 16, v190
v_and_b32 v123, s12, v190
v_mul_f32 v112, v122, v100
v_mul_f32 v113, v123, v100
v_lshlrev_b32 v116, 16, v191
v_and_b32 v117, s12, v191
v_mul_f32 v114, v116, v100
v_mul_f32 v115, v117, v100
s_waitcnt vmcnt(13)
buffer_load_dwordx4 a[148:151], v252, s[56:59], s35 offen offset:1024
v_lshlrev_b32 v118, 16, v192
v_and_b32 v119, s12, v192
v_fmac_f32 v108, v118, v101
v_fmac_f32 v109, v119, v101
v_lshlrev_b32 v120, 16, v193
v_and_b32 v121, s12, v193
v_fmac_f32 v110, v120, v101
v_fmac_f32 v111, v121, v101
v_lshlrev_b32 v122, 16, v194
v_and_b32 v123, s12, v194
v_fmac_f32 v112, v122, v101
v_fmac_f32 v113, v123, v101
v_lshlrev_b32 v116, 16, v195
v_and_b32 v117, s12, v195
v_fmac_f32 v114, v116, v101
v_fmac_f32 v115, v117, v101
s_waitcnt lgkmcnt(0)
v_lshlrev_b32 v118, 16, v96
v_and_b32 v119, s12, v96
v_fmac_f32 v108, v118, v105
v_fmac_f32 v109, v119, v105
v_lshlrev_b32 v120, 16, v97
v_and_b32 v121, s12, v97
v_fmac_f32 v110, v120, v105
v_fmac_f32 v111, v121, v105
v_lshlrev_b32 v122, 16, v98
v_and_b32 v123, s12, v98
v_fmac_f32 v112, v122, v105
v_fmac_f32 v113, v123, v105
v_lshlrev_b32 v116, 16, v99
v_and_b32 v117, s12, v99
v_fmac_f32 v114, v116, v105
v_fmac_f32 v115, v117, v105
s_waitcnt vmcnt(13)
s_add_u32 s39, s53, s45
buffer_load_dwordx4 v[212:215], v10, s[20:23], s39 offen offset:0 sc1
v_lshlrev_b32 v118, 16, v196
v_and_b32 v119, s12, v196
v_fmac_f32 v108, v118, v102
v_fmac_f32 v109, v119, v102
v_lshlrev_b32 v120, 16, v197
v_and_b32 v121, s12, v197
v_fmac_f32 v110, v120, v102
v_fmac_f32 v111, v121, v102
v_lshlrev_b32 v122, 16, v198
v_and_b32 v123, s12, v198
v_fmac_f32 v112, v122, v102
v_fmac_f32 v113, v123, v102
v_lshlrev_b32 v116, 16, v199
v_and_b32 v117, s12, v199
v_fmac_f32 v114, v116, v102
v_fmac_f32 v115, v117, v102
s_waitcnt vmcnt(13)
s_xor_b32 s32, s13, 0x25000
buffer_load_dwordx4 a[208:211], v252, s[56:59], s32 offen offset:0
v_lshlrev_b32 v118, 16, v200
v_and_b32 v119, s12, v200
v_fmac_f32 v108, v118, v103
v_fmac_f32 v109, v119, v103
v_lshlrev_b32 v120, 16, v201
v_and_b32 v121, s12, v201
v_fmac_f32 v110, v120, v103
v_fmac_f32 v111, v121, v103
v_lshlrev_b32 v122, 16, v202
v_and_b32 v123, s12, v202
v_fmac_f32 v112, v122, v103
v_fmac_f32 v113, v123, v103
v_lshlrev_b32 v116, 16, v203
v_and_b32 v117, s12, v203
v_fmac_f32 v114, v116, v103
v_fmac_f32 v115, v117, v103
s_waitcnt vmcnt(13)
buffer_load_dwordx4 a[212:215], v252, s[56:59], s32 offen offset:1024
v_lshlrev_b32 v118, 16, v204
v_and_b32 v119, s12, v204
v_fmac_f32 v108, v118, v104
v_fmac_f32 v109, v119, v104
v_lshlrev_b32 v120, 16, v205
v_and_b32 v121, s12, v205
v_fmac_f32 v110, v120, v104
v_fmac_f32 v111, v121, v104
v_lshlrev_b32 v122, 16, v206
v_and_b32 v123, s12, v206
v_fmac_f32 v112, v122, v104
v_fmac_f32 v113, v123, v104
v_lshlrev_b32 v116, 16, v207
v_and_b32 v117, s12, v207
v_fmac_f32 v114, v116, v104
v_fmac_f32 v115, v117, v104
ds_read2_b32 v[100:101], v14 offset0:1 offset1:2
ds_read2_b32 v[102:103], v14 offset0:3 offset1:4
ds_read2_b32 v[104:105], v14 offset0:5 offset1:6
v_add_u32 v14, 0x400, v14
v_cvt_pk_bf16_f32 v116, v108, v109
v_cvt_pk_bf16_f32 v117, v110, v111
v_cvt_pk_bf16_f32 v118, v112, v113
v_cvt_pk_bf16_f32 v119, v114, v115
ds_write_b128 v39, v[116:119] offset:0
s_waitcnt vmcnt(13)
s_add_u32 s33, s53, s46
buffer_load_dwordx4 v[216:219], v10, s[20:23], s33 offen offset:0 sc1
s_waitcnt vmcnt(13)
s_xor_b32 s35, s13, 0x21800
buffer_load_dwordx4 a[152:155], v252, s[56:59], s35 offen offset:0
s_waitcnt vmcnt(13)
buffer_load_dwordx4 a[156:159], v252, s[56:59], s35 offen offset:1024
s_waitcnt vmcnt(13)
s_add_u32 s39, s53, s47
buffer_load_dwordx4 v[220:223], v10, s[20:23], s39 offen offset:0 sc1
s_waitcnt vmcnt(13)
s_xor_b32 s32, s13, 0x25800
buffer_load_dwordx4 a[216:219], v252, s[56:59], s32 offen offset:0
s_waitcnt vmcnt(13)
buffer_load_dwordx4 a[220:223], v252, s[56:59], s32 offen offset:1024
s_waitcnt vmcnt(13)
s_add_u32 s33, s53, s15
buffer_load_dwordx4 v[224:227], v10, s[20:23], s33 offen offset:0 sc1
s_waitcnt vmcnt(13)
s_xor_b32 s35, s13, 0x22000
buffer_load_dwordx4 a[160:163], v252, s[56:59], s35 offen offset:0
s_waitcnt lgkmcnt(0)
s_barrier
ds_read_b128 v[132:135], v252 offset:32768
ds_read_b128 v[136:139], v252 offset:33792
ds_read_b128 v[140:143], v252 offset:34816
ds_read_b128 v[144:147], v252 offset:35840
ds_read_b128 v[148:151], v252 offset:36864
s_waitcnt lgkmcnt(4)
v_mfma_f32_16x16x32_bf16 v[48:51], a[128:131], v[132:135], v[48:51]
ds_read_b128 v[152:155], v252 offset:37888
v_mfma_f32_16x16x32_bf16 v[52:55], a[132:135], v[132:135], v[52:55]
v_mfma_f32_16x16x32_bf16 v[56:59], a[192:195], v[132:135], v[56:59]
v_mfma_f32_16x16x32_bf16 v[60:63], a[196:199], v[132:135], v[60:63]
s_waitcnt vmcnt(13)
buffer_load_dwordx4 a[164:167], v252, s[56:59], s35 offen offset:1024
s_waitcnt lgkmcnt(4)
v_mfma_f32_16x16x32_bf16 v[48:51], a[136:139], v[136:139], v[48:51]
ds_read_b128 v[132:135], v252 offset:38912
ds_read_b128 v[96:99], v45 offset:0
v_lshlrev_b32 v118, 16, v208
v_and_b32 v119, s12, v208
v_mfma_f32_16x16x32_bf16 v[52:55], a[140:143], v[136:139], v[52:55]
v_mul_f32 v108, v118, v100
v_mul_f32 v109, v119, v100
v_lshlrev_b32 v120, 16, v209
v_mfma_f32_16x16x32_bf16 v[56:59], a[200:203], v[136:139], v[56:59]
v_and_b32 v121, s12, v209
v_mul_f32 v110, v120, v100
v_mul_f32 v111, v121, v100
v_mfma_f32_16x16x32_bf16 v[60:63], a[204:207], v[136:139], v[60:63]
v_lshlrev_b32 v122, 16, v210
v_and_b32 v123, s12, v210
v_mul_f32 v112, v122, v100
v_mul_f32 v113, v123, v100
v_lshlrev_b32 v116, 16, v211
v_and_b32 v117, s12, v211
v_mul_f32 v114, v116, v100
v_mul_f32 v115, v117, v100
s_waitcnt vmcnt(13)
s_add_u32 s39, s53, s44
buffer_load_dwordx4 v[228:231], v10, s[20:23], s39 offen offset:1024 sc1
s_waitcnt vmcnt(13)
s_xor_b32 s32, s13, 0x26000
buffer_load_dwordx4 a[224:227], v252, s[56:59], s32 offen offset:0
s_waitcnt vmcnt(13)
buffer_load_dwordx4 a[228:231], v252, s[56:59], s32 offen offset:1024
v_lshlrev_b32 v118, 16, v212
v_and_b32 v119, s12, v212
v_fmac_f32 v108, v118, v101
v_fmac_f32 v109, v119, v101
v_lshlrev_b32 v120, 16, v213
v_and_b32 v121, s12, v213
v_fmac_f32 v110, v120, v101
v_fmac_f32 v111, v121, v101
v_lshlrev_b32 v122, 16, v214
v_and_b32 v123, s12, v214
v_fmac_f32 v112, v122, v101
v_fmac_f32 v113, v123, v101
v_lshlrev_b32 v116, 16, v215
v_and_b32 v117, s12, v215
v_fmac_f32 v114, v116, v101
v_fmac_f32 v115, v117, v101
s_waitcnt lgkmcnt(0)
v_lshlrev_b32 v118, 16, v96
v_and_b32 v119, s12, v96
v_fmac_f32 v108, v118, v105
v_fmac_f32 v109, v119, v105
v_lshlrev_b32 v120, 16, v97
v_and_b32 v121, s12, v97
v_fmac_f32 v110, v120, v105
v_fmac_f32 v111, v121, v105
v_lshlrev_b32 v122, 16, v98
v_and_b32 v123, s12, v98
v_fmac_f32 v112, v122, v105
v_fmac_f32 v113, v123, v105
v_lshlrev_b32 v116, 16, v99
v_and_b32 v117, s12, v99
v_fmac_f32 v114, v116, v105
v_fmac_f32 v115, v117, v105
s_waitcnt vmcnt(13)
s_add_u32 s33, s53, s45
buffer_load_dwordx4 v[232:235], v10, s[20:23], s33 offen offset:1024 sc1
s_waitcnt vmcnt(13)
s_xor_b32 s35, s13, 0x22800
buffer_load_dwordx4 a[168:171], v252, s[56:59], s35 offen offset:0
v_mfma_f32_16x16x32_bf16 v[48:51], a[144:147], v[140:143], v[48:51]
v_mfma_f32_16x16x32_bf16 v[52:55], a[148:151], v[140:143], v[52:55]
v_mfma_f32_16x16x32_bf16 v[56:59], a[208:211], v[140:143], v[56:59]
v_mfma_f32_16x16x32_bf16 v[60:63], a[212:215], v[140:143], v[60:63]
s_waitcnt vmcnt(13)
buffer_load_dwordx4 a[172:175], v252, s[56:59], s35 offen offset:1024
v_lshlrev_b32 v118, 16, v216
v_and_b32 v119, s12, v216
v_fmac_f32 v108, v118, v102
v_fmac_f32 v109, v119, v102
v_lshlrev_b32 v120, 16, v217
v_and_b32 v121, s12, v217
v_fmac_f32 v110, v120, v102
v_fmac_f32 v111, v121, v102
v_lshlrev_b32 v122, 16, v218
v_and_b32 v123, s12, v218
v_fmac_f32 v112, v122, v102
v_fmac_f32 v113, v123, v102
v_lshlrev_b32 v116, 16, v219
v_and_b32 v117, s12, v219
v_fmac_f32 v114, v116, v102
v_fmac_f32 v115, v117, v102
s_waitcnt vmcnt(13)
s_add_u32 s39, s53, s46
buffer_load_dwordx4 v[236:239], v10, s[20:23], s39 offen offset:1024 sc1
s_waitcnt vmcnt(13)
s_xor_b32 s32, s13, 0x26800
buffer_load_dwordx4 a[232:235], v252, s[56:59], s32 offen offset:0
s_waitcnt vmcnt(13)
buffer_load_dwordx4 a[236:239], v252, s[56:59], s32 offen offset:1024
v_lshlrev_b32 v118, 16, v220
v_and_b32 v119, s12, v220
v_fmac_f32 v108, v118, v103
v_fmac_f32 v109, v119, v103
v_lshlrev_b32 v120, 16, v221
v_and_b32 v121, s12, v221
v_fmac_f32 v110, v120, v103
v_fmac_f32 v111, v121, v103
v_lshlrev_b32 v122, 16, v222
v_and_b32 v123, s12, v222
v_fmac_f32 v112, v122, v103
v_fmac_f32 v113, v123, v103
v_lshlrev_b32 v116, 16, v223
v_and_b32 v117, s12, v223
v_fmac_f32 v114, v116, v103
v_fmac_f32 v115, v117, v103
s_waitcnt vmcnt(13)
s_add_u32 s33, s53, s47
buffer_load_dwordx4 v[240:243], v10, s[20:23], s33 offen offset:1024 sc1
s_waitcnt vmcnt(13)
s_xor_b32 s35, s13, 0x23000
buffer_load_dwordx4 a[176:179], v252, s[56:59], s35 offen offset:0
v_mfma_f32_16x16x32_bf16 v[48:51], a[152:155], v[144:147], v[48:51]
v_mfma_f32_16x16x32_bf16 v[52:55], a[156:159], v[144:147], v[52:55]
v_mfma_f32_16x16x32_bf16 v[56:59], a[216:219], v[144:147], v[56:59]
v_mfma_f32_16x16x32_bf16 v[60:63], a[220:223], v[144:147], v[60:63]
s_waitcnt vmcnt(13)
buffer_load_dwordx4 a[180:183], v252, s[56:59], s35 offen offset:1024
v_lshlrev_b32 v118, 16, v224
v_and_b32 v119, s12, v224
v_fmac_f32 v108, v118, v104
v_fmac_f32 v109, v119, v104
v_lshlrev_b32 v120, 16, v225
v_and_b32 v121, s12, v225
v_fmac_f32 v110, v120, v104
v_fmac_f32 v111, v121, v104
v_lshlrev_b32 v122, 16, v226
v_and_b32 v123, s12, v226
v_fmac_f32 v112, v122, v104
v_fmac_f32 v113, v123, v104
v_lshlrev_b32 v116, 16, v227
v_and_b32 v117, s12, v227
v_fmac_f32 v114, v116, v104
v_fmac_f32 v115, v117, v104
v_cvt_pk_bf16_f32 v116, v108, v109
v_cvt_pk_bf16_f32 v117, v110, v111
v_cvt_pk_bf16_f32 v118, v112, v113
v_cvt_pk_bf16_f32 v119, v114, v115
ds_write_b128 v38, v[116:119] offset:8192
s_waitcnt vmcnt(13)
s_add_u32 s39, s53, s15
buffer_load_dwordx4 v[244:247], v10, s[20:23], s39 offen offset:1024 sc1
s_waitcnt vmcnt(13)
s_xor_b32 s32, s13, 0x27000
buffer_load_dwordx4 a[240:243], v252, s[56:59], s32 offen offset:0
s_waitcnt vmcnt(13)
buffer_load_dwordx4 a[244:247], v252, s[56:59], s32 offen offset:1024
ds_read_b128 v[96:99], v45 offset:1024
v_lshlrev_b32 v118, 16, v228
v_and_b32 v119, s12, v228
v_mul_f32 v108, v118, v100
v_mul_f32 v109, v119, v100
v_lshlrev_b32 v120, 16, v229
v_and_b32 v121, s12, v229
v_mul_f32 v110, v120, v100
v_mul_f32 v111, v121, v100
v_lshlrev_b32 v122, 16, v230
v_and_b32 v123, s12, v230
v_mul_f32 v112, v122, v100
v_mul_f32 v113, v123, v100
v_lshlrev_b32 v116, 16, v231
v_and_b32 v117, s12, v231
v_mul_f32 v114, v116, v100
v_mul_f32 v115, v117, v100
s_waitcnt vmcnt(13)
s_xor_b32 s33, s13, 0x23800
buffer_load_dwordx4 a[184:187], v252, s[56:59], s33 offen offset:0
s_waitcnt vmcnt(13)
buffer_load_dwordx4 a[188:191], v252, s[56:59], s33 offen offset:1024
v_mfma_f32_16x16x32_bf16 v[48:51], a[160:163], v[148:151], v[48:51]
v_mfma_f32_16x16x32_bf16 v[52:55], a[164:167], v[148:151], v[52:55]
v_mfma_f32_16x16x32_bf16 v[56:59], a[224:227], v[148:151], v[56:59]
v_mfma_f32_16x16x32_bf16 v[60:63], a[228:231], v[148:151], v[60:63]
s_waitcnt vmcnt(13)
s_xor_b32 s35, s13, 0x27800
buffer_load_dwordx4 a[248:251], v252, s[56:59], s35 offen offset:0
v_lshlrev_b32 v118, 16, v232
v_and_b32 v119, s12, v232
v_fmac_f32 v108, v118, v101
v_fmac_f32 v109, v119, v101
v_lshlrev_b32 v120, 16, v233
v_and_b32 v121, s12, v233
v_fmac_f32 v110, v120, v101
v_fmac_f32 v111, v121, v101
v_lshlrev_b32 v122, 16, v234
v_and_b32 v123, s12, v234
v_fmac_f32 v112, v122, v101
v_fmac_f32 v113, v123, v101
v_lshlrev_b32 v116, 16, v235
v_and_b32 v117, s12, v235
v_fmac_f32 v114, v116, v101
v_fmac_f32 v115, v117, v101
s_waitcnt lgkmcnt(0)
v_lshlrev_b32 v118, 16, v96
v_and_b32 v119, s12, v96
v_fmac_f32 v108, v118, v105
v_fmac_f32 v109, v119, v105
v_lshlrev_b32 v120, 16, v97
v_and_b32 v121, s12, v97
v_fmac_f32 v110, v120, v105
v_fmac_f32 v111, v121, v105
v_lshlrev_b32 v122, 16, v98
v_and_b32 v123, s12, v98
v_fmac_f32 v112, v122, v105
v_fmac_f32 v113, v123, v105
v_lshlrev_b32 v116, 16, v99
v_and_b32 v117, s12, v99
v_fmac_f32 v114, v116, v105
v_fmac_f32 v115, v117, v105
s_waitcnt vmcnt(13)
buffer_load_dwordx4 a[252:255], v252, s[56:59], s35 offen offset:1024
s_waitcnt vmcnt(13)
s_add_u32 s39, s54, s44
buffer_load_dwordx4 v[156:159], v10, s[20:23], s39 offen offset:0 sc1
s_waitcnt vmcnt(13)
s_add_u32 s32, s54, s45
buffer_load_dwordx4 v[160:163], v10, s[20:23], s32 offen offset:0 sc1
v_lshlrev_b32 v118, 16, v236
v_and_b32 v119, s12, v236
v_fmac_f32 v108, v118, v102
v_fmac_f32 v109, v119, v102
v_lshlrev_b32 v120, 16, v237
v_and_b32 v121, s12, v237
v_fmac_f32 v110, v120, v102
v_fmac_f32 v111, v121, v102
v_lshlrev_b32 v122, 16, v238
v_and_b32 v123, s12, v238
v_fmac_f32 v112, v122, v102
v_fmac_f32 v113, v123, v102
v_lshlrev_b32 v116, 16, v239
v_and_b32 v117, s12, v239
v_fmac_f32 v114, v116, v102
v_fmac_f32 v115, v117, v102
s_waitcnt vmcnt(13)
s_add_u32 s33, s54, s46
buffer_load_dwordx4 v[164:167], v10, s[20:23], s33 offen offset:0 sc1
s_waitcnt vmcnt(13)
s_add_u32 s35, s54, s47
buffer_load_dwordx4 v[168:171], v10, s[20:23], s35 offen offset:0 sc1
v_mfma_f32_16x16x32_bf16 v[48:51], a[168:171], v[152:155], v[48:51]
v_mfma_f32_16x16x32_bf16 v[52:55], a[172:175], v[152:155], v[52:55]
v_mfma_f32_16x16x32_bf16 v[56:59], a[232:235], v[152:155], v[56:59]
v_mfma_f32_16x16x32_bf16 v[60:63], a[236:239], v[152:155], v[60:63]
s_waitcnt vmcnt(13)
s_add_u32 s39, s54, s15
buffer_load_dwordx4 v[172:175], v10, s[20:23], s39 offen offset:0 sc1
v_lshlrev_b32 v118, 16, v240
v_and_b32 v119, s12, v240
v_fmac_f32 v108, v118, v103
v_fmac_f32 v109, v119, v103
v_lshlrev_b32 v120, 16, v241
v_and_b32 v121, s12, v241
v_fmac_f32 v110, v120, v103
v_fmac_f32 v111, v121, v103
v_lshlrev_b32 v122, 16, v242
v_and_b32 v123, s12, v242
v_fmac_f32 v112, v122, v103
v_fmac_f32 v113, v123, v103
v_lshlrev_b32 v116, 16, v243
v_and_b32 v117, s12, v243
v_fmac_f32 v114, v116, v103
v_fmac_f32 v115, v117, v103
s_waitcnt vmcnt(13)
s_add_u32 s32, s54, s44
buffer_load_dwordx4 v[176:179], v10, s[20:23], s32 offen offset:1024 sc1
s_waitcnt vmcnt(13)
s_add_u32 s33, s54, s45
buffer_load_dwordx4 v[180:183], v10, s[20:23], s33 offen offset:1024 sc1
s_waitcnt vmcnt(13)
s_add_u32 s35, s54, s46
buffer_load_dwordx4 v[184:187], v10, s[20:23], s35 offen offset:1024 sc1
v_lshlrev_b32 v118, 16, v244
v_and_b32 v119, s12, v244
v_fmac_f32 v108, v118, v104
v_fmac_f32 v109, v119, v104
v_lshlrev_b32 v120, 16, v245
v_and_b32 v121, s12, v245
v_fmac_f32 v110, v120, v104
v_fmac_f32 v111, v121, v104
v_lshlrev_b32 v122, 16, v246
v_and_b32 v123, s12, v246
v_fmac_f32 v112, v122, v104
v_fmac_f32 v113, v123, v104
v_lshlrev_b32 v116, 16, v247
v_and_b32 v117, s12, v247
v_fmac_f32 v114, v116, v104
v_fmac_f32 v115, v117, v104
ds_read2_b32 v[100:101], v14 offset0:1 offset1:2
ds_read2_b32 v[102:103], v14 offset0:3 offset1:4
ds_read2_b32 v[104:105], v14 offset0:5 offset1:6
v_cvt_pk_bf16_f32 v116, v108, v109
v_cvt_pk_bf16_f32 v117, v110, v111
v_cvt_pk_bf16_f32 v118, v112, v113
v_cvt_pk_bf16_f32 v119, v114, v115
ds_write_b128 v39, v[116:119] offset:8192
s_waitcnt vmcnt(13)
s_add_u32 s39, s54, s47
buffer_load_dwordx4 v[188:191], v10, s[20:23], s39 offen offset:1024 sc1
s_waitcnt vmcnt(13)
s_add_u32 s32, s54, s15
buffer_load_dwordx4 v[192:195], v10, s[20:23], s32 offen offset:1024 sc1
v_mfma_f32_16x16x32_bf16 v[48:51], a[176:179], v[132:135], v[48:51]
v_mfma_f32_16x16x32_bf16 v[52:55], a[180:183], v[132:135], v[52:55]
v_mfma_f32_16x16x32_bf16 v[56:59], a[240:243], v[132:135], v[56:59]
v_mfma_f32_16x16x32_bf16 v[60:63], a[244:247], v[132:135], v[60:63]
s_waitcnt vmcnt(13)
s_waitcnt vmcnt(12)
s_waitcnt vmcnt(11)
s_waitcnt vmcnt(10)
s_waitcnt lgkmcnt(0)
s_barrier
ds_read_b128 v[136:139], v252 offset:39936
ds_read_b128 v[140:143], v252 offset:40960
ds_read_b128 v[144:147], v252 offset:41984
ds_read_b128 v[148:151], v252 offset:43008
ds_read_b128 v[152:155], v252 offset:44032
s_waitcnt lgkmcnt(4)
v_mfma_f32_16x16x32_bf16 v[48:51], a[184:187], v[136:139], v[48:51]
ds_read_b128 v[132:135], v252 offset:45056
v_mfma_f32_16x16x32_bf16 v[52:55], a[188:191], v[136:139], v[52:55]
v_mfma_f32_16x16x32_bf16 v[56:59], a[248:251], v[136:139], v[56:59]
v_mfma_f32_16x16x32_bf16 v[60:63], a[252:255], v[136:139], v[60:63]
s_waitcnt lgkmcnt(4)
v_mfma_f32_16x16x32_bf16 v[64:67], a[128:131], v[140:143], v[64:67]
ds_read_b128 v[136:139], v252 offset:46080
v_mfma_f32_16x16x32_bf16 v[68:71], a[132:135], v[140:143], v[68:71]
v_mfma_f32_16x16x32_bf16 v[72:75], a[192:195], v[140:143], v[72:75]
v_mfma_f32_16x16x32_bf16 v[76:79], a[196:199], v[140:143], v[76:79]
v_cvt_pk_bf16_f32 v48, v48, v49
v_cvt_pk_bf16_f32 v49, v50, v51
v_cvt_pk_bf16_f32 v50, v52, v53
v_cvt_pk_bf16_f32 v51, v54, v55
ds_write_b128 v32, v[48:51] offset:0
v_cvt_pk_bf16_f32 v56, v56, v57
v_cvt_pk_bf16_f32 v57, v58, v59
v_cvt_pk_bf16_f32 v58, v60, v61
v_cvt_pk_bf16_f32 v59, v62, v63
ds_write_b128 v33, v[56:59] offset:0
ds_read_b128 v[52:55], v34 offset:0
ds_read_b128 v[60:63], v34 offset:1024
s_waitcnt lgkmcnt(8)
v_mfma_f32_16x16x32_bf16 v[64:67], a[136:139], v[144:147], v[64:67]
ds_read_b128 v[140:143], v252 offset:47104
v_mfma_f32_16x16x32_bf16 v[68:71], a[140:143], v[144:147], v[68:71]
v_mfma_f32_16x16x32_bf16 v[72:75], a[200:203], v[144:147], v[72:75]
v_mfma_f32_16x16x32_bf16 v[76:79], a[204:207], v[144:147], v[76:79]
s_waitcnt lgkmcnt(8)
v_mfma_f32_16x16x32_bf16 v[64:67], a[144:147], v[148:151], v[64:67]
ds_read_b128 v[144:147], v252 offset:48128
v_mfma_f32_16x16x32_bf16 v[68:71], a[148:151], v[148:151], v[68:71]
v_mfma_f32_16x16x32_bf16 v[72:75], a[208:211], v[148:151], v[72:75]
v_mfma_f32_16x16x32_bf16 v[76:79], a[212:215], v[148:151], v[76:79]
s_waitcnt lgkmcnt(8)
v_mfma_f32_16x16x32_bf16 v[64:67], a[152:155], v[152:155], v[64:67]
v_mfma_f32_16x16x32_bf16 v[68:71], a[156:159], v[152:155], v[68:71]
v_mfma_f32_16x16x32_bf16 v[72:75], a[216:219], v[152:155], v[72:75]
v_mfma_f32_16x16x32_bf16 v[76:79], a[220:223], v[152:155], v[76:79]
s_waitcnt lgkmcnt(7)
v_mfma_f32_16x16x32_bf16 v[64:67], a[160:163], v[132:135], v[64:67]
v_mfma_f32_16x16x32_bf16 v[68:71], a[164:167], v[132:135], v[68:71]
v_mfma_f32_16x16x32_bf16 v[72:75], a[224:227], v[132:135], v[72:75]
v_mfma_f32_16x16x32_bf16 v[76:79], a[228:231], v[132:135], v[76:79]
s_waitcnt lgkmcnt(6)
v_mfma_f32_16x16x32_bf16 v[64:67], a[168:171], v[136:139], v[64:67]
v_mfma_f32_16x16x32_bf16 v[68:71], a[172:175], v[136:139], v[68:71]
v_mfma_f32_16x16x32_bf16 v[72:75], a[232:235], v[136:139], v[72:75]
v_mfma_f32_16x16x32_bf16 v[76:79], a[236:239], v[136:139], v[76:79]
s_waitcnt lgkmcnt(1)
v_mfma_f32_16x16x32_bf16 v[64:67], a[176:179], v[140:143], v[64:67]
v_mfma_f32_16x16x32_bf16 v[68:71], a[180:183], v[140:143], v[68:71]
v_mfma_f32_16x16x32_bf16 v[72:75], a[240:243], v[140:143], v[72:75]
v_mfma_f32_16x16x32_bf16 v[76:79], a[244:247], v[140:143], v[76:79]
s_waitcnt lgkmcnt(0)
v_mfma_f32_16x16x32_bf16 v[64:67], a[184:187], v[144:147], v[64:67]
v_mfma_f32_16x16x32_bf16 v[68:71], a[188:191], v[144:147], v[68:71]
v_mfma_f32_16x16x32_bf16 v[72:75], a[248:251], v[144:147], v[72:75]
v_mfma_f32_16x16x32_bf16 v[76:79], a[252:255], v[144:147], v[76:79]
s_waitcnt vmcnt(9)
s_add_u32 s33, s52, 0
buffer_store_dwordx4 v[52:55], v9, s[40:43], s33 offen sc1
s_add_u32 s35, s52, 4096
buffer_store_dwordx4 v[60:63], v9, s[40:43], s35 offen sc1
v_cvt_pk_bf16_f32 v64, v64, v65
v_cvt_pk_bf16_f32 v65, v66, v67
v_cvt_pk_bf16_f32 v66, v68, v69
v_cvt_pk_bf16_f32 v67, v70, v71
ds_write_b128 v32, v[64:67] offset:2048
v_cvt_pk_bf16_f32 v72, v72, v73
v_cvt_pk_bf16_f32 v73, v74, v75
v_cvt_pk_bf16_f32 v74, v76, v77
v_cvt_pk_bf16_f32 v75, v78, v79
ds_write_b128 v33, v[72:75] offset:2048
ds_read_b128 v[68:71], v34 offset:2048
ds_read_b128 v[76:79], v34 offset:3072
ds_read_b128 v[96:99], v46 offset:0
v_lshlrev_b32 v118, 16, v156
v_and_b32 v119, s12, v156
v_mul_f32 v108, v118, v100
v_mul_f32 v109, v119, v100
v_lshlrev_b32 v120, 16, v157
v_and_b32 v121, s12, v157
v_mul_f32 v110, v120, v100
v_mul_f32 v111, v121, v100
v_lshlrev_b32 v122, 16, v158
v_and_b32 v123, s12, v158
v_mul_f32 v112, v122, v100
v_mul_f32 v113, v123, v100
v_lshlrev_b32 v116, 16, v159
v_and_b32 v117, s12, v159
v_mul_f32 v114, v116, v100
v_mul_f32 v115, v117, v100
s_waitcnt vmcnt(10)
s_add_u32 s39, s53, 0
s_waitcnt lgkmcnt(2)
buffer_store_dwordx4 v[68:71], v9, s[40:43], s39 offen sc1
s_add_u32 s32, s53, 4096
s_waitcnt lgkmcnt(1)
buffer_store_dwordx4 v[76:79], v9, s[40:43], s32 offen sc1
v_lshlrev_b32 v118, 16, v160
v_and_b32 v119, s12, v160
v_fmac_f32 v108, v118, v101
v_fmac_f32 v109, v119, v101
v_lshlrev_b32 v120, 16, v161
v_and_b32 v121, s12, v161
v_fmac_f32 v110, v120, v101
v_fmac_f32 v111, v121, v101
v_lshlrev_b32 v122, 16, v162
v_and_b32 v123, s12, v162
v_fmac_f32 v112, v122, v101
v_fmac_f32 v113, v123, v101
v_lshlrev_b32 v116, 16, v163
v_and_b32 v117, s12, v163
v_fmac_f32 v114, v116, v101
v_fmac_f32 v115, v117, v101
s_waitcnt lgkmcnt(0)
v_lshlrev_b32 v118, 16, v96
v_and_b32 v119, s12, v96
v_fmac_f32 v108, v118, v105
v_fmac_f32 v109, v119, v105
v_lshlrev_b32 v120, 16, v97
v_and_b32 v121, s12, v97
v_fmac_f32 v110, v120, v105
v_fmac_f32 v111, v121, v105
v_lshlrev_b32 v122, 16, v98
v_and_b32 v123, s12, v98
v_fmac_f32 v112, v122, v105
v_fmac_f32 v113, v123, v105
v_lshlrev_b32 v116, 16, v99
v_and_b32 v117, s12, v99
v_fmac_f32 v114, v116, v105
v_fmac_f32 v115, v117, v105
s_waitcnt vmcnt(11)
v_lshlrev_b32 v118, 16, v164
v_and_b32 v119, s12, v164
v_fmac_f32 v108, v118, v102
v_fmac_f32 v109, v119, v102
v_lshlrev_b32 v120, 16, v165
v_and_b32 v121, s12, v165
v_fmac_f32 v110, v120, v102
v_fmac_f32 v111, v121, v102
v_lshlrev_b32 v122, 16, v166
v_and_b32 v123, s12, v166
v_fmac_f32 v112, v122, v102
v_fmac_f32 v113, v123, v102
v_lshlrev_b32 v116, 16, v167
v_and_b32 v117, s12, v167
v_fmac_f32 v114, v116, v102
v_fmac_f32 v115, v117, v102
s_waitcnt vmcnt(10)
v_lshlrev_b32 v118, 16, v168
v_and_b32 v119, s12, v168
v_fmac_f32 v108, v118, v103
v_fmac_f32 v109, v119, v103
v_lshlrev_b32 v120, 16, v169
v_and_b32 v121, s12, v169
v_fmac_f32 v110, v120, v103
v_fmac_f32 v111, v121, v103
v_lshlrev_b32 v122, 16, v170
v_and_b32 v123, s12, v170
v_fmac_f32 v112, v122, v103
v_fmac_f32 v113, v123, v103
v_lshlrev_b32 v116, 16, v171
v_and_b32 v117, s12, v171
v_fmac_f32 v114, v116, v103
v_fmac_f32 v115, v117, v103
s_waitcnt vmcnt(9)
v_lshlrev_b32 v118, 16, v172
v_and_b32 v119, s12, v172
v_fmac_f32 v108, v118, v104
v_fmac_f32 v109, v119, v104
v_lshlrev_b32 v120, 16, v173
v_and_b32 v121, s12, v173
v_fmac_f32 v110, v120, v104
v_fmac_f32 v111, v121, v104
v_lshlrev_b32 v122, 16, v174
v_and_b32 v123, s12, v174
v_fmac_f32 v112, v122, v104
v_fmac_f32 v113, v123, v104
v_lshlrev_b32 v116, 16, v175
v_and_b32 v117, s12, v175
v_fmac_f32 v114, v116, v104
v_fmac_f32 v115, v117, v104
v_cvt_pk_bf16_f32 v116, v108, v109
v_cvt_pk_bf16_f32 v117, v110, v111
v_cvt_pk_bf16_f32 v118, v112, v113
v_cvt_pk_bf16_f32 v119, v114, v115
ds_write_b128 v38, v[116:119] offset:16384
s_waitcnt vmcnt(8)
ds_read_b128 v[96:99], v46 offset:1024
v_lshlrev_b32 v118, 16, v176
v_and_b32 v119, s12, v176
v_mul_f32 v108, v118, v100
v_mul_f32 v109, v119, v100
v_lshlrev_b32 v120, 16, v177
v_and_b32 v121, s12, v177
v_mul_f32 v110, v120, v100
v_mul_f32 v111, v121, v100
v_lshlrev_b32 v122, 16, v178
v_and_b32 v123, s12, v178
v_mul_f32 v112, v122, v100
v_mul_f32 v113, v123, v100
v_lshlrev_b32 v116, 16, v179
v_and_b32 v117, s12, v179
v_mul_f32 v114, v116, v100
v_mul_f32 v115, v117, v100
s_waitcnt vmcnt(7)
v_lshlrev_b32 v118, 16, v180
v_and_b32 v119, s12, v180
v_fmac_f32 v108, v118, v101
v_fmac_f32 v109, v119, v101
v_lshlrev_b32 v120, 16, v181
v_and_b32 v121, s12, v181
v_fmac_f32 v110, v120, v101
v_fmac_f32 v111, v121, v101
v_lshlrev_b32 v122, 16, v182
v_and_b32 v123, s12, v182
v_fmac_f32 v112, v122, v101
v_fmac_f32 v113, v123, v101
v_lshlrev_b32 v116, 16, v183
v_and_b32 v117, s12, v183
v_fmac_f32 v114, v116, v101
v_fmac_f32 v115, v117, v101
s_waitcnt lgkmcnt(0)
v_lshlrev_b32 v118, 16, v96
v_and_b32 v119, s12, v96
v_fmac_f32 v108, v118, v105
v_fmac_f32 v109, v119, v105
v_lshlrev_b32 v120, 16, v97
v_and_b32 v121, s12, v97
v_fmac_f32 v110, v120, v105
v_fmac_f32 v111, v121, v105
v_lshlrev_b32 v122, 16, v98
v_and_b32 v123, s12, v98
v_fmac_f32 v112, v122, v105
v_fmac_f32 v113, v123, v105
v_lshlrev_b32 v116, 16, v99
v_and_b32 v117, s12, v99
v_fmac_f32 v114, v116, v105
v_fmac_f32 v115, v117, v105
s_waitcnt vmcnt(6)
v_lshlrev_b32 v118, 16, v184
v_and_b32 v119, s12, v184
v_fmac_f32 v108, v118, v102
v_fmac_f32 v109, v119, v102
v_lshlrev_b32 v120, 16, v185
v_and_b32 v121, s12, v185
v_fmac_f32 v110, v120, v102
v_fmac_f32 v111, v121, v102
v_lshlrev_b32 v122, 16, v186
v_and_b32 v123, s12, v186
v_fmac_f32 v112, v122, v102
v_fmac_f32 v113, v123, v102
v_lshlrev_b32 v116, 16, v187
v_and_b32 v117, s12, v187
v_fmac_f32 v114, v116, v102
v_fmac_f32 v115, v117, v102
s_waitcnt vmcnt(5)
v_lshlrev_b32 v118, 16, v188
v_and_b32 v119, s12, v188
v_fmac_f32 v108, v118, v103
v_fmac_f32 v109, v119, v103
v_lshlrev_b32 v120, 16, v189
v_and_b32 v121, s12, v189
v_fmac_f32 v110, v120, v103
v_fmac_f32 v111, v121, v103
v_lshlrev_b32 v122, 16, v190
v_and_b32 v123, s12, v190
v_fmac_f32 v112, v122, v103
v_fmac_f32 v113, v123, v103
v_lshlrev_b32 v116, 16, v191
v_and_b32 v117, s12, v191
v_fmac_f32 v114, v116, v103
v_fmac_f32 v115, v117, v103
s_waitcnt vmcnt(4)
v_lshlrev_b32 v118, 16, v192
v_and_b32 v119, s12, v192
v_fmac_f32 v108, v118, v104
v_fmac_f32 v109, v119, v104
v_lshlrev_b32 v120, 16, v193
v_and_b32 v121, s12, v193
v_fmac_f32 v110, v120, v104
v_fmac_f32 v111, v121, v104
v_lshlrev_b32 v122, 16, v194
v_and_b32 v123, s12, v194
v_fmac_f32 v112, v122, v104
v_fmac_f32 v113, v123, v104
v_lshlrev_b32 v116, 16, v195
v_and_b32 v117, s12, v195
v_fmac_f32 v114, v116, v104
v_fmac_f32 v115, v117, v104
v_cvt_pk_bf16_f32 v116, v108, v109
v_cvt_pk_bf16_f32 v117, v110, v111
v_cvt_pk_bf16_f32 v118, v112, v113
v_cvt_pk_bf16_f32 v119, v114, v115
ds_write_b128 v39, v[116:119] offset:16384
s_waitcnt lgkmcnt(0)
s_barrier
ds_read_b128 v[148:151], v252 offset:49152
ds_read_b128 v[152:155], v252 offset:50176
ds_read_b128 v[132:135], v252 offset:51200
ds_read_b128 v[136:139], v252 offset:52224
ds_read_b128 v[140:143], v252 offset:53248
s_waitcnt lgkmcnt(4)
v_mfma_f32_16x16x32_bf16 v[80:83], a[128:131], v[148:151], v[80:83]
ds_read_b128 v[144:147], v252 offset:54272
v_mfma_f32_16x16x32_bf16 v[84:87], a[132:135], v[148:151], v[84:87]
v_mfma_f32_16x16x32_bf16 v[88:91], a[192:195], v[148:151], v[88:91]
v_mfma_f32_16x16x32_bf16 v[92:95], a[196:199], v[148:151], v[92:95]
s_waitcnt lgkmcnt(4)
v_mfma_f32_16x16x32_bf16 v[80:83], a[136:139], v[152:155], v[80:83]
ds_read_b128 v[148:151], v252 offset:55296
v_mfma_f32_16x16x32_bf16 v[84:87], a[140:143], v[152:155], v[84:87]
v_mfma_f32_16x16x32_bf16 v[88:91], a[200:203], v[152:155], v[88:91]
v_mfma_f32_16x16x32_bf16 v[92:95], a[204:207], v[152:155], v[92:95]
s_waitcnt lgkmcnt(4)
v_mfma_f32_16x16x32_bf16 v[80:83], a[144:147], v[132:135], v[80:83]
ds_read_b128 v[152:155], v252 offset:56320
v_mfma_f32_16x16x32_bf16 v[84:87], a[148:151], v[132:135], v[84:87]
v_mfma_f32_16x16x32_bf16 v[88:91], a[208:211], v[132:135], v[88:91]
v_mfma_f32_16x16x32_bf16 v[92:95], a[212:215], v[132:135], v[92:95]
s_waitcnt lgkmcnt(4)
v_mfma_f32_16x16x32_bf16 v[80:83], a[152:155], v[136:139], v[80:83]
v_mfma_f32_16x16x32_bf16 v[84:87], a[156:159], v[136:139], v[84:87]
v_mfma_f32_16x16x32_bf16 v[88:91], a[216:219], v[136:139], v[88:91]
v_mfma_f32_16x16x32_bf16 v[92:95], a[220:223], v[136:139], v[92:95]
s_waitcnt lgkmcnt(3)
v_mfma_f32_16x16x32_bf16 v[80:83], a[160:163], v[140:143], v[80:83]
v_mfma_f32_16x16x32_bf16 v[84:87], a[164:167], v[140:143], v[84:87]
v_mfma_f32_16x16x32_bf16 v[88:91], a[224:227], v[140:143], v[88:91]
v_mfma_f32_16x16x32_bf16 v[92:95], a[228:231], v[140:143], v[92:95]
s_waitcnt lgkmcnt(2)
v_mfma_f32_16x16x32_bf16 v[80:83], a[168:171], v[144:147], v[80:83]
v_mfma_f32_16x16x32_bf16 v[84:87], a[172:175], v[144:147], v[84:87]
v_mfma_f32_16x16x32_bf16 v[88:91], a[232:235], v[144:147], v[88:91]
v_mfma_f32_16x16x32_bf16 v[92:95], a[236:239], v[144:147], v[92:95]
s_waitcnt lgkmcnt(1)
v_mfma_f32_16x16x32_bf16 v[80:83], a[176:179], v[148:151], v[80:83]
v_mfma_f32_16x16x32_bf16 v[84:87], a[180:183], v[148:151], v[84:87]
v_mfma_f32_16x16x32_bf16 v[88:91], a[240:243], v[148:151], v[88:91]
v_mfma_f32_16x16x32_bf16 v[92:95], a[244:247], v[148:151], v[92:95]
s_waitcnt lgkmcnt(0)
v_mfma_f32_16x16x32_bf16 v[80:83], a[184:187], v[152:155], v[80:83]
v_mfma_f32_16x16x32_bf16 v[84:87], a[188:191], v[152:155], v[84:87]
v_mfma_f32_16x16x32_bf16 v[88:91], a[248:251], v[152:155], v[88:91]
v_mfma_f32_16x16x32_bf16 v[92:95], a[252:255], v[152:155], v[92:95]
s_nop 4
v_cvt_pk_bf16_f32 v80, v80, v81
v_cvt_pk_bf16_f32 v81, v82, v83
v_cvt_pk_bf16_f32 v82, v84, v85
v_cvt_pk_bf16_f32 v83, v86, v87
ds_write_b128 v35, v[80:83] offset:0
v_cvt_pk_bf16_f32 v88, v88, v89
v_cvt_pk_bf16_f32 v89, v90, v91
v_cvt_pk_bf16_f32 v90, v92, v93
v_cvt_pk_bf16_f32 v91, v94, v95
ds_write_b128 v36, v[88:91] offset:0
ds_read_b128 v[84:87], v37 offset:0
ds_read_b128 v[92:95], v37 offset:1024
s_add_u32 s33, s54, 0
s_waitcnt lgkmcnt(1)
buffer_store_dwordx4 v[84:87], v9, s[40:43], s33 offen sc1
s_add_u32 s35, s54, 4096
s_waitcnt lgkmcnt(0)
buffer_store_dwordx4 v[92:95], v9, s[40:43], s35 offen sc1
s_branch L2_fin
LC_poll:
s_mov_b32 s36, 0
LC_poll2:
s_mov_b32 s70, 0
s_atomic_add s70, s[60:61], s48 glc
s_cmp_lt_u32 s2, 240
s_cbranch_scc1 LC_poll3
s_mov_b32 s71, 0
s_atomic_add s71, s[60:61], s49 glc
s_mov_b32 s72, 0
s_atomic_add s72, s[60:61], s50 glc
s_waitcnt lgkmcnt(0)
s_min_u32 s70, s70, s71
s_min_u32 s70, s70, s72
LC_poll3:
s_waitcnt lgkmcnt(0)
s_cmp_ge_u32 s70, 6
s_cbranch_scc1 LC_poll4
s_sleep 2
s_add_u32 s36, s36, 1
s_cmp_gt_u32 s36, 0x40000
s_cbranch_scc0 LC_poll2
LC_poll4:
s_cmp_lt_u32 s98, 2
s_cbranch_scc1 LC_got
s_mul_i32 s33, s51, 0x600000
v_readfirstlane_b32 s32, v44
s_add_u32 s35, s33, s52
s_mov_b32 m0, s32
s_nop 0
buffer_load_dwordx4 v10, s[20:23], s35 offen offset:0 sc1 lds
buffer_load_dwordx4 v10, s[20:23], s35 offen offset:1024 sc1 lds
v_readfirstlane_b32 s32, v45
s_add_u32 s35, s33, s53
s_mov_b32 m0, s32
s_nop 0
buffer_load_dwordx4 v10, s[20:23], s35 offen offset:0 sc1 lds
buffer_load_dwordx4 v10, s[20:23], s35 offen offset:1024 sc1 lds
v_readfirstlane_b32 s32, v46
s_add_u32 s35, s33, s54
s_mov_b32 m0, s32
s_nop 0
buffer_load_dwordx4 v10, s[20:23], s35 offen offset:0 sc1 lds
buffer_load_dwordx4 v10, s[20:23], s35 offen offset:1024 sc1 lds
s_waitcnt vmcnt(0)
s_branch LC_got
LC_side:
s_cmp_eq_u32 s14, 1
s_cbranch_scc1 LC_sideok
s_cmp_lt_u32 s2, 240
s_cbranch_scc1 LC_side1
s_barrier
LC_side1:
s_mov_b32 s36, 0
s_mov_b32 s33, 0x6c01400
LC_side2:
buffer_load_dword v1, off, s[56:59], s33 sc1
s_waitcnt vmcnt(0)
v_readfirstlane_b32 s99, v1
s_add_u32 s36, s36, 1
s_cmp_gt_u32 s36, 0x40000
s_cbranch_scc1 LC_side3
s_cmp_ge_u32 s99, 60
s_cbranch_scc1 LC_side3
s_sleep 8
s_branch LC_side2
LC_side3:
s_cmp_lt_u32 s98, 2
s_cbranch_scc1 LC_sideok
s_add_u32 s8, s6, 0x0
s_addc_u32 s9, s7, 0
s_mov_b32 s10, 0x4e2000
s_mov_b32 s11, 0x00020000
s_lshl_b32 s55, s34, 13
s_add_u32 s55, s55, 0x21000
s_lshl_b32 s33, s34, 7
v_bfe_u32 v9, v252, 4, 3
v_lshrrev_b32 v1, 7, v252
v_xor_b32 v9, v9, v1
v_lshl_add_u32 v1, v1, 9, s33
v_lshl_add_u32 v9, v9, 4, v1
s_add_u32 m0, s55, 0
s_add_u32 s39, s52, 0
buffer_load_dwordx4 v9, s[8:11], s39 offen lds
s_add_u32 m0, s55, 1024
s_add_u32 s32, s52, 4096
buffer_load_dwordx4 v9, s[8:11], s32 offen lds
s_add_u32 m0, s55, 2048
s_add_u32 s33, s53, 0
buffer_load_dwordx4 v9, s[8:11], s33 offen lds
s_add_u32 m0, s55, 3072
s_add_u32 s35, s53, 4096
buffer_load_dwordx4 v9, s[8:11], s35 offen lds
s_waitcnt vmcnt(0)
s_branch LC_sideok
LC_slow:
s_waitcnt vmcnt(0) lgkmcnt(0)
s_barrier
s_mov_b32 s50, 0xe1a06800
s_mov_b32 s51, 0x4e608d04
s_mul_i32 s39, s37, 9
s_lshr_b64 s[50:51], s[50:51], s39
s_and_b32 s39, s50, 0x1ff
s_bfe_u32 s49, s50, 0x90009
s_sub_u32 s29, s49, s39
s_lshl_b32 s50, s37, 2
s_lshr_b32 s59, 0x766666, s50
s_and_b32 s59, s59, 15
s_sub_u32 s31, s29, s59
s_lshr_b32 s31, s31, 1
s_sub_u32 s31, s31, 1
s_lshl_b32 s39, s39, 14
s_lshl_b32 s49, s49, 14
s_add_u32 s28, s39, 0x4000
s_cmp_eq_u32 s37, 5
s_cselect_b32 s33, 0xff800000, 0
s_mov_b32 s32, 0xffff
s_add_u32 s12, s4, 0x6800000
s_addc_u32 s13, s5, 0
s_mov_b32 s14, s49
s_mov_b32 s15, 0x00020000
s_add_u32 s8, s4, 0x0
s_addc_u32 s9, s5, 0
s_mov_b32 s10, 0x4e4000
s_mov_b32 s11, 0x00020000
s_mul_i32 s35, s37, 0x600000
s_add_u32 s20, s4, 0x2000000
s_addc_u32 s21, s5, 0
s_add_u32 s20, s20, s35
s_addc_u32 s21, s21, 0
s_mov_b32 s22, 0x4e4000
s_mov_b32 s23, 0x00020000
s_add_u32 s24, s4, 0x6000000
s_addc_u32 s25, s5, 0
s_mov_b32 s26, 0x9c800
s_mov_b32 s27, 0x00020000
s_lshl_b32 s35, s38, 4
s_lshl_b32 s41, s34, 2
s_add_u32 s35, s35, s41
s_lshl_b32 s40, s35, 13
s_lshl_b32 s48, s35, 10
s_lshl_b32 s35, s37, 3
s_add_u32 s48, s48, s35
v_bfe_u32 v248, v252, 4, 3
v_lshlrev_b32 v248, 6, v248
v_bfe_u32 v253, v252, 7, 1
v_lshl_or_b32 v248, v253, 10, v248
v_bfe_u32 v253, v252, 8, 2
v_lshl_or_b32 v248, v253, 4, v248
v_bfe_u32 v253, v252, 6, 1
v_lshlrev_b32 v253, 5, v253
v_xor_b32 v248, v248, v253
v_and_b32 v249, 0x1c0, v252
v_bfe_u32 v253, v252, 9, 1
v_lshl_or_b32 v249, v253, 10, v249
v_bfe_u32 v253, v252, 8, 1
v_lshl_or_b32 v249, v253, 5, v249
v_bfe_u32 v253, v252, 4, 2
v_lshl_or_b32 v249, v253, 3, v249
v_xor_b32 v250, 32, v249
v_and_b32 v251, 0xfffffe7f, v251
s_mul_i32 s36, s34, 0xa000
s_mov_b32 s56, s36
s_add_u32 s57, s56, 32768
s_mov_b32 s55, 4
v_bfe_i32 v188, v252, 8, 1
LS_q:
s_add_u32 s44, s40, 4096
buffer_load_dwordx4 v[0:3], v252, s[8:11], s40 offen offset:0
buffer_load_dwordx4 v[4:7], v252, s[8:11], s40 offen offset:1024
buffer_load_dwordx4 v[8:11], v252, s[8:11], s40 offen offset:2048
buffer_load_dwordx4 v[12:15], v252, s[8:11], s40 offen offset:3072
buffer_load_dwordx4 v[16:19], v252, s[8:11], s44 offen offset:0
buffer_load_dwordx4 v[20:23], v252, s[8:11], s44 offen offset:1024
buffer_load_dwordx4 v[24:27], v252, s[8:11], s44 offen offset:2048
buffer_load_dwordx4 v[28:31], v252, s[8:11], s44 offen offset:3072
s_mov_b32 s53, s56
s_mov_b32 s58, s39
s_add_u32 m0, s53, 0
s_add_u32 s54, s58, 0
buffer_load_dwordx4 v251, s[12:15], s54 offen offset:0 lds
buffer_load_dwordx4 v251, s[12:15], s54 offen offset:1024 lds
buffer_load_dwordx4 v251, s[12:15], s54 offen offset:2048 lds
buffer_load_dwordx4 v251, s[12:15], s54 offen offset:3072 lds
s_add_u32 m0, s53, 4096
s_add_u32 s54, s58, 128
buffer_load_dwordx4 v251, s[12:15], s54 offen offset:0 lds
buffer_load_dwordx4 v251, s[12:15], s54 offen offset:1024 lds
buffer_load_dwordx4 v251, s[12:15], s54 offen offset:2048 lds
buffer_load_dwordx4 v251, s[12:15], s54 offen offset:3072 lds
s_add_u32 m0, s53, 8192
s_add_u32 s54, s58, 256
buffer_load_dwordx4 v251, s[12:15], s54 offen offset:0 lds
buffer_load_dwordx4 v251, s[12:15], s54 offen offset:1024 lds
buffer_load_dwordx4 v251, s[12:15], s54 offen offset:2048 lds
buffer_load_dwordx4 v251, s[12:15], s54 offen offset:3072 lds
s_add_u32 m0, s53, 12288
s_add_u32 s54, s58, 384
buffer_load_dwordx4 v251, s[12:15], s54 offen offset:0 lds
buffer_load_dwordx4 v251, s[12:15], s54 offen offset:1024 lds
buffer_load_dwordx4 v251, s[12:15], s54 offen offset:2048 lds
buffer_load_dwordx4 v251, s[12:15], s54 offen offset:3072 lds
s_add_u32 s53, s53, 0x4000
s_cmp_eq_u32 s53, s57
s_cselect_b32 s53, s56, s53
s_add_u32 s58, s58, 0x4000
s_mov_b32 s51, s29
s_mov_b32 s52, s56
v_mov_b32 v172, 0xff800000
v_accvgpr_write_b32 a0, 0
v_accvgpr_write_b32 a1, 0
v_accvgpr_write_b32 a2, 0
v_accvgpr_write_b32 a3, 0
v_accvgpr_write_b32 a4, 0
v_accvgpr_write_b32 a5, 0
v_accvgpr_write_b32 a6, 0
v_accvgpr_write_b32 a7, 0
v_accvgpr_write_b32 a8, 0
v_accvgpr_write_b32 a9, 0
v_accvgpr_write_b32 a10, 0
v_accvgpr_write_b32 a11, 0
v_accvgpr_write_b32 a12, 0
v_accvgpr_write_b32 a13, 0
v_accvgpr_write_b32 a14, 0
v_accvgpr_write_b32 a15, 0
v_accvgpr_write_b32 a16, 0
v_accvgpr_write_b32 a17, 0
v_accvgpr_write_b32 a18, 0
v_accvgpr_write_b32 a19, 0
v_accvgpr_write_b32 a20, 0
v_accvgpr_write_b32 a21, 0
v_accvgpr_write_b32 a22, 0
v_accvgpr_write_b32 a23, 0
v_accvgpr_write_b32 a24, 0
v_accvgpr_write_b32 a25, 0
v_accvgpr_write_b32 a26, 0
v_accvgpr_write_b32 a27, 0
v_accvgpr_write_b32 a28, 0
v_accvgpr_write_b32 a29, 0
v_accvgpr_write_b32 a30, 0
v_accvgpr_write_b32 a31, 0
v_accvgpr_write_b32 a32, 0
v_accvgpr_write_b32 a33, 0
v_accvgpr_write_b32 a34, 0
v_accvgpr_write_b32 a35, 0
v_accvgpr_write_b32 a36, 0
v_accvgpr_write_b32 a37, 0
v_accvgpr_write_b32 a38, 0
v_accvgpr_write_b32 a39, 0
v_accvgpr_write_b32 a40, 0
v_accvgpr_write_b32 a41, 0
v_accvgpr_write_b32 a42, 0
v_accvgpr_write_b32 a43, 0
v_accvgpr_write_b32 a44, 0
v_accvgpr_write_b32 a45, 0
v_accvgpr_write_b32 a46, 0
v_accvgpr_write_b32 a47, 0
v_accvgpr_write_b32 a48, 0
v_accvgpr_write_b32 a49, 0
v_accvgpr_write_b32 a50, 0
v_accvgpr_write_b32 a51, 0
v_accvgpr_write_b32 a52, 0
v_accvgpr_write_b32 a53, 0
v_accvgpr_write_b32 a54, 0
v_accvgpr_write_b32 a55, 0
v_accvgpr_write_b32 a56, 0
v_accvgpr_write_b32 a57, 0
v_accvgpr_write_b32 a58, 0
v_accvgpr_write_b32 a59, 0
v_accvgpr_write_b32 a60, 0
v_accvgpr_write_b32 a61, 0
v_accvgpr_write_b32 a62, 0
v_accvgpr_write_b32 a63, 0
LS_loop:
s_add_u32 m0, s53, 0
s_add_u32 s54, s58, 0
buffer_load_dwordx4 v251, s[12:15], s54 offen offset:0 lds
buffer_load_dwordx4 v251, s[12:15], s54 offen offset:1024 lds
buffer_load_dwordx4 v251, s[12:15], s54 offen offset:2048 lds
buffer_load_dwordx4 v251, s[12:15], s54 offen offset:3072 lds
s_add_u32 m0, s53, 4096
s_add_u32 s54, s58, 128
buffer_load_dwordx4 v251, s[12:15], s54 offen offset:0 lds
buffer_load_dwordx4 v251, s[12:15], s54 offen offset:1024 lds
buffer_load_dwordx4 v251, s[12:15], s54 offen offset:2048 lds
buffer_load_dwordx4 v251, s[12:15], s54 offen offset:3072 lds
s_add_u32 m0, s53, 8192
s_add_u32 s54, s58, 256
buffer_load_dwordx4 v251, s[12:15], s54 offen offset:0 lds
buffer_load_dwordx4 v251, s[12:15], s54 offen offset:1024 lds
buffer_load_dwordx4 v251, s[12:15], s54 offen offset:2048 lds
buffer_load_dwordx4 v251, s[12:15], s54 offen offset:3072 lds
s_add_u32 m0, s53, 12288
s_add_u32 s54, s58, 384
buffer_load_dwordx4 v251, s[12:15], s54 offen offset:0 lds
buffer_load_dwordx4 v251, s[12:15], s54 offen offset:1024 lds
buffer_load_dwordx4 v251, s[12:15], s54 offen offset:2048 lds
buffer_load_dwordx4 v251, s[12:15], s54 offen offset:3072 lds
s_add_u32 s53, s53, 0x4000
s_cmp_eq_u32 s53, s57
s_cselect_b32 s53, s56, s53
s_add_u32 s58, s58, 0x4000
v_add_u32 v177, s52, v248
v_add_u32 v178, s52, v249
v_add_u32 v179, s52, v250
s_add_u32 s52, s52, 0x4000
s_cmp_eq_u32 s52, s57
s_cselect_b32 s52, s56, s52
s_cmp_eq_u32 s51, 1
s_cselect_b32 s54, s33, 0
v_and_b32 v192, s54, v188
v_and_b32 v193, s54, v188
v_and_b32 v194, s54, v188
v_and_b32 v195, s54, v188
s_waitcnt vmcnt(16)
ds_read_b128 v[32:35], v177 offset:0
ds_read_b128 v[64:67], v177 offset:2048
ds_read_b128 v[36:39], v177 offset:512
ds_read_b128 v[68:71], v177 offset:2560
ds_read_b128 v[40:43], v177 offset:4096
ds_read_b128 v[72:75], v177 offset:6144
ds_read_b128 v[44:47], v177 offset:4608
ds_read_b128 v[76:79], v177 offset:6656
ds_read_b128 v[48:51], v177 offset:8192
ds_read_b128 v[80:83], v177 offset:10240
ds_read_b128 v[52:55], v177 offset:8704
ds_read_b128 v[84:87], v177 offset:10752
ds_read_b128 v[56:59], v177 offset:12288
ds_read_b128 v[88:91], v177 offset:14336
ds_read_b128 v[60:63], v177 offset:12800
ds_read_b128 v[92:95], v177 offset:14848
s_waitcnt lgkmcnt(14)
v_mfma_f32_16x16x32_bf16 v[160:163], v[32:35], v[0:3], v[192:195]
v_mfma_f32_16x16x32_bf16 v[164:167], v[64:67], v[0:3], v[192:195]
s_waitcnt lgkmcnt(12)
v_mfma_f32_16x16x32_bf16 v[160:163], v[36:39], v[4:7], v[160:163]
v_mfma_f32_16x16x32_bf16 v[164:167], v[68:71], v[4:7], v[164:167]
s_waitcnt lgkmcnt(10)
v_mfma_f32_16x16x32_bf16 v[160:163], v[40:43], v[8:11], v[160:163]
v_mfma_f32_16x16x32_bf16 v[164:167], v[72:75], v[8:11], v[164:167]
s_waitcnt lgkmcnt(8)
v_mfma_f32_16x16x32_bf16 v[160:163], v[44:47], v[12:15], v[160:163]
v_mfma_f32_16x16x32_bf16 v[164:167], v[76:79], v[12:15], v[164:167]
s_waitcnt lgkmcnt(6)
v_mfma_f32_16x16x32_bf16 v[160:163], v[48:51], v[16:19], v[160:163]
v_mfma_f32_16x16x32_bf16 v[164:167], v[80:83], v[16:19], v[164:167]
s_waitcnt lgkmcnt(4)
v_mfma_f32_16x16x32_bf16 v[160:163], v[52:55], v[20:23], v[160:163]
v_mfma_f32_16x16x32_bf16 v[164:167], v[84:87], v[20:23], v[164:167]
s_waitcnt lgkmcnt(2)
v_mfma_f32_16x16x32_bf16 v[160:163], v[56:59], v[24:27], v[160:163]
v_mfma_f32_16x16x32_bf16 v[164:167], v[88:91], v[24:27], v[164:167]
s_waitcnt lgkmcnt(0)
v_mfma_f32_16x16x32_bf16 v[160:163], v[60:63], v[28:31], v[160:163]
v_mfma_f32_16x16x32_bf16 v[164:167], v[92:95], v[28:31], v[164:167]
ds_read_b64_tr_b16 v[96:97], v178 offset:0
ds_read_b64_tr_b16 v[98:99], v178 offset:2048
ds_read_b64_tr_b16 v[100:101], v179 offset:0
ds_read_b64_tr_b16 v[102:103], v179 offset:2048
ds_read_b64_tr_b16 v[104:105], v178 offset:512
ds_read_b64_tr_b16 v[106:107], v178 offset:2560
ds_read_b64_tr_b16 v[108:109], v179 offset:512
ds_read_b64_tr_b16 v[110:111], v179 offset:2560
ds_read_b64_tr_b16 v[112:113], v178 offset:4096
ds_read_b64_tr_b16 v[114:115], v178 offset:6144
ds_read_b64_tr_b16 v[116:117], v179 offset:4096
ds_read_b64_tr_b16 v[118:119], v179 offset:6144
ds_read_b64_tr_b16 v[120:121], v178 offset:4608
ds_read_b64_tr_b16 v[122:123], v178 offset:6656
ds_read_b64_tr_b16 v[124:125], v179 offset:4608
ds_read_b64_tr_b16 v[126:127], v179 offset:6656
ds_read_b64_tr_b16 v[128:129], v178 offset:8192
ds_read_b64_tr_b16 v[130:131], v178 offset:10240
ds_read_b64_tr_b16 v[132:133], v179 offset:8192
ds_read_b64_tr_b16 v[134:135], v179 offset:10240
ds_read_b64_tr_b16 v[136:137], v178 offset:8704
ds_read_b64_tr_b16 v[138:139], v178 offset:10752
ds_read_b64_tr_b16 v[140:141], v179 offset:8704
ds_read_b64_tr_b16 v[142:143], v179 offset:10752
ds_read_b64_tr_b16 v[144:145], v178 offset:12288
ds_read_b64_tr_b16 v[146:147], v178 offset:14336
ds_read_b64_tr_b16 v[148:149], v179 offset:12288
ds_read_b64_tr_b16 v[150:151], v179 offset:14336
ds_read_b64_tr_b16 v[152:153], v178 offset:12800
ds_read_b64_tr_b16 v[154:155], v178 offset:14848
ds_read_b64_tr_b16 v[156:157], v179 offset:12800
ds_read_b64_tr_b16 v[158:159], v179 offset:14848
s_nop 7
v_max3_f32 v175, v160, v161, v162
v_max3_f32 v175, v175, v163, v164
v_max3_f32 v175, v175, v165, v166
v_max3_f32 v175, v175, v167, v172
v_mov_b32 v176, v175
s_nop 1
v_permlane32_swap_b32 v175, v176
s_nop 1
v_max_f32 v175, v175, v176
v_mov_b32 v176, v175
s_nop 1
v_permlane16_swap_b32 v175, v176
s_nop 1
v_max_f32 v175, v175, v176
v_sub_f32 v174, v172, v175
v_exp_f32 v174, v174
v_mov_b32 v172, v175
v_sub_f32 v160, v160, v172
v_sub_f32 v161, v161, v172
v_sub_f32 v162, v162, v172
v_sub_f32 v163, v163, v172
v_sub_f32 v164, v164, v172
v_sub_f32 v165, v165, v172
v_sub_f32 v166, v166, v172
v_sub_f32 v167, v167, v172
v_exp_f32 v160, v160
v_exp_f32 v161, v161
v_exp_f32 v162, v162
v_exp_f32 v163, v163
v_exp_f32 v164, v164
v_exp_f32 v165, v165
v_exp_f32 v166, v166
v_exp_f32 v167, v167
v_cmp_neq_f32 vcc, 1.0, v174
v_cvt_pk_bf16_f32 v168, v160, v161
v_cvt_pk_bf16_f32 v169, v162, v163
v_cvt_pk_bf16_f32 v170, v164, v165
v_cvt_pk_bf16_f32 v171, v166, v167
s_cbranch_vccz LS_nors
v_accvgpr_read_b32 v180, a0
v_accvgpr_read_b32 v181, a1
v_accvgpr_read_b32 v182, a2
v_accvgpr_read_b32 v183, a3
v_accvgpr_read_b32 v184, a4
v_accvgpr_read_b32 v185, a5
v_accvgpr_read_b32 v186, a6
v_accvgpr_read_b32 v187, a7
v_mul_f32 v180, v180, v174
v_mul_f32 v181, v181, v174
v_mul_f32 v182, v182, v174
v_mul_f32 v183, v183, v174
v_mul_f32 v184, v184, v174
v_mul_f32 v185, v185, v174
v_mul_f32 v186, v186, v174
v_mul_f32 v187, v187, v174
v_accvgpr_write_b32 a0, v180
v_accvgpr_write_b32 a1, v181
v_accvgpr_write_b32 a2, v182
v_accvgpr_write_b32 a3, v183
v_accvgpr_write_b32 a4, v184
v_accvgpr_write_b32 a5, v185
v_accvgpr_write_b32 a6, v186
v_accvgpr_write_b32 a7, v187
v_accvgpr_read_b32 v180, a8
v_accvgpr_read_b32 v181, a9
v_accvgpr_read_b32 v182, a10
v_accvgpr_read_b32 v183, a11
v_accvgpr_read_b32 v184, a12
v_accvgpr_read_b32 v185, a13
v_accvgpr_read_b32 v186, a14
v_accvgpr_read_b32 v187, a15
v_mul_f32 v180, v180, v174
v_mul_f32 v181, v181, v174
v_mul_f32 v182, v182, v174
v_mul_f32 v183, v183, v174
v_mul_f32 v184, v184, v174
v_mul_f32 v185, v185, v174
v_mul_f32 v186, v186, v174
v_mul_f32 v187, v187, v174
v_accvgpr_write_b32 a8, v180
v_accvgpr_write_b32 a9, v181
v_accvgpr_write_b32 a10, v182
v_accvgpr_write_b32 a11, v183
v_accvgpr_write_b32 a12, v184
v_accvgpr_write_b32 a13, v185
v_accvgpr_write_b32 a14, v186
v_accvgpr_write_b32 a15, v187
v_accvgpr_read_b32 v180, a16
v_accvgpr_read_b32 v181, a17
v_accvgpr_read_b32 v182, a18
v_accvgpr_read_b32 v183, a19
v_accvgpr_read_b32 v184, a20
v_accvgpr_read_b32 v185, a21
v_accvgpr_read_b32 v186, a22
v_accvgpr_read_b32 v187, a23
v_mul_f32 v180, v180, v174
v_mul_f32 v181, v181, v174
v_mul_f32 v182, v182, v174
v_mul_f32 v183, v183, v174
v_mul_f32 v184, v184, v174
v_mul_f32 v185, v185, v174
v_mul_f32 v186, v186, v174
v_mul_f32 v187, v187, v174
v_accvgpr_write_b32 a16, v180
v_accvgpr_write_b32 a17, v181
v_accvgpr_write_b32 a18, v182
v_accvgpr_write_b32 a19, v183
v_accvgpr_write_b32 a20, v184
v_accvgpr_write_b32 a21, v185
v_accvgpr_write_b32 a22, v186
v_accvgpr_write_b32 a23, v187
v_accvgpr_read_b32 v180, a24
v_accvgpr_read_b32 v181, a25
v_accvgpr_read_b32 v182, a26
v_accvgpr_read_b32 v183, a27
v_accvgpr_read_b32 v184, a28
v_accvgpr_read_b32 v185, a29
v_accvgpr_read_b32 v186, a30
v_accvgpr_read_b32 v187, a31
v_mul_f32 v180, v180, v174
v_mul_f32 v181, v181, v174
v_mul_f32 v182, v182, v174
v_mul_f32 v183, v183, v174
v_mul_f32 v184, v184, v174
v_mul_f32 v185, v185, v174
v_mul_f32 v186, v186, v174
v_mul_f32 v187, v187, v174
v_accvgpr_write_b32 a24, v180
v_accvgpr_write_b32 a25, v181
v_accvgpr_write_b32 a26, v182
v_accvgpr_write_b32 a27, v183
v_accvgpr_write_b32 a28, v184
v_accvgpr_write_b32 a29, v185
v_accvgpr_write_b32 a30, v186
v_accvgpr_write_b32 a31, v187
v_accvgpr_read_b32 v180, a32
v_accvgpr_read_b32 v181, a33
v_accvgpr_read_b32 v182, a34
v_accvgpr_read_b32 v183, a35
v_accvgpr_read_b32 v184, a36
v_accvgpr_read_b32 v185, a37
v_accvgpr_read_b32 v186, a38
v_accvgpr_read_b32 v187, a39
v_mul_f32 v180, v180, v174
v_mul_f32 v181, v181, v174
v_mul_f32 v182, v182, v174
v_mul_f32 v183, v183, v174
v_mul_f32 v184, v184, v174
v_mul_f32 v185, v185, v174
v_mul_f32 v186, v186, v174
v_mul_f32 v187, v187, v174
v_accvgpr_write_b32 a32, v180
v_accvgpr_write_b32 a33, v181
v_accvgpr_write_b32 a34, v182
v_accvgpr_write_b32 a35, v183
v_accvgpr_write_b32 a36, v184
v_accvgpr_write_b32 a37, v185
v_accvgpr_write_b32 a38, v186
v_accvgpr_write_b32 a39, v187
v_accvgpr_read_b32 v180, a40
v_accvgpr_read_b32 v181, a41
v_accvgpr_read_b32 v182, a42
v_accvgpr_read_b32 v183, a43
v_accvgpr_read_b32 v184, a44
v_accvgpr_read_b32 v185, a45
v_accvgpr_read_b32 v186, a46
v_accvgpr_read_b32 v187, a47
v_mul_f32 v180, v180, v174
v_mul_f32 v181, v181, v174
v_mul_f32 v182, v182, v174
v_mul_f32 v183, v183, v174
v_mul_f32 v184, v184, v174
v_mul_f32 v185, v185, v174
v_mul_f32 v186, v186, v174
v_mul_f32 v187, v187, v174
v_accvgpr_write_b32 a40, v180
v_accvgpr_write_b32 a41, v181
v_accvgpr_write_b32 a42, v182
v_accvgpr_write_b32 a43, v183
v_accvgpr_write_b32 a44, v184
v_accvgpr_write_b32 a45, v185
v_accvgpr_write_b32 a46, v186
v_accvgpr_write_b32 a47, v187
v_accvgpr_read_b32 v180, a48
v_accvgpr_read_b32 v181, a49
v_accvgpr_read_b32 v182, a50
v_accvgpr_read_b32 v183, a51
v_accvgpr_read_b32 v184, a52
v_accvgpr_read_b32 v185, a53
v_accvgpr_read_b32 v186, a54
v_accvgpr_read_b32 v187, a55
v_mul_f32 v180, v180, v174
v_mul_f32 v181, v181, v174
v_mul_f32 v182, v182, v174
v_mul_f32 v183, v183, v174
v_mul_f32 v184, v184, v174
v_mul_f32 v185, v185, v174
v_mul_f32 v186, v186, v174
v_mul_f32 v187, v187, v174
v_accvgpr_write_b32 a48, v180
v_accvgpr_write_b32 a49, v181
v_accvgpr_write_b32 a50, v182
v_accvgpr_write_b32 a51, v183
v_accvgpr_write_b32 a52, v184
v_accvgpr_write_b32 a53, v185
v_accvgpr_write_b32 a54, v186
v_accvgpr_write_b32 a55, v187
v_accvgpr_read_b32 v180, a56
v_accvgpr_read_b32 v181, a57
v_accvgpr_read_b32 v182, a58
v_accvgpr_read_b32 v183, a59
v_accvgpr_read_b32 v184, a60
v_accvgpr_read_b32 v185, a61
v_accvgpr_read_b32 v186, a62
v_accvgpr_read_b32 v187, a63
v_mul_f32 v180, v180, v174
v_mul_f32 v181, v181, v174
v_mul_f32 v182, v182, v174
v_mul_f32 v183, v183, v174
v_mul_f32 v184, v184, v174
v_mul_f32 v185, v185, v174
v_mul_f32 v186, v186, v174
v_mul_f32 v187, v187, v174
v_accvgpr_write_b32 a56, v180
v_accvgpr_write_b32 a57, v181
v_accvgpr_write_b32 a58, v182
v_accvgpr_write_b32 a59, v183
v_accvgpr_write_b32 a60, v184
v_accvgpr_write_b32 a61, v185
v_accvgpr_write_b32 a62, v186
v_accvgpr_write_b32 a63, v187
LS_nors:
s_waitcnt lgkmcnt(0)
s_nop 1
v_mfma_f32_16x16x32_bf16 a[0:3], v[96:99], v[168:171], a[0:3]
v_mfma_f32_16x16x32_bf16 a[4:7], v[100:103], v[168:171], a[4:7]
v_mfma_f32_16x16x32_bf16 a[8:11], v[104:107], v[168:171], a[8:11]
v_mfma_f32_16x16x32_bf16 a[12:15], v[108:111], v[168:171], a[12:15]
v_mfma_f32_16x16x32_bf16 a[16:19], v[112:115], v[168:171], a[16:19]
v_mfma_f32_16x16x32_bf16 a[20:23], v[116:119], v[168:171], a[20:23]
v_mfma_f32_16x16x32_bf16 a[24:27], v[120:123], v[168:171], a[24:27]
v_mfma_f32_16x16x32_bf16 a[28:31], v[124:127], v[168:171], a[28:31]
v_mfma_f32_16x16x32_bf16 a[32:35], v[128:131], v[168:171], a[32:35]
v_mfma_f32_16x16x32_bf16 a[36:39], v[132:135], v[168:171], a[36:39]
v_mfma_f32_16x16x32_bf16 a[40:43], v[136:139], v[168:171], a[40:43]
v_mfma_f32_16x16x32_bf16 a[44:47], v[140:143], v[168:171], a[44:47]
v_mfma_f32_16x16x32_bf16 a[48:51], v[144:147], v[168:171], a[48:51]
v_mfma_f32_16x16x32_bf16 a[52:55], v[148:151], v[168:171], a[52:55]
v_mfma_f32_16x16x32_bf16 a[56:59], v[152:155], v[168:171], a[56:59]
v_mfma_f32_16x16x32_bf16 a[60:63], v[156:159], v[168:171], a[60:63]
s_sub_u32 s51, s51, 1
s_cmp_lg_u32 s51, 0
s_cbranch_scc1 LS_loop
s_nop 15
v_accvgpr_read_b32 v173, a0
v_accvgpr_read_b32 v180, a0
v_accvgpr_read_b32 v181, a1
v_accvgpr_read_b32 v182, a2
v_accvgpr_read_b32 v183, a3
v_accvgpr_read_b32 v184, a4
v_accvgpr_read_b32 v185, a5
v_accvgpr_read_b32 v186, a6
v_accvgpr_read_b32 v187, a7
v_cvt_pk_bf16_f32 v32, v180, v181
v_cvt_pk_bf16_f32 v33, v182, v183
v_cvt_pk_bf16_f32 v34, v184, v185
v_cvt_pk_bf16_f32 v35, v186, v187
buffer_store_dwordx4 v[32:35], v252, s[20:23], s40 offen offset:0 sc1
v_accvgpr_read_b32 v180, a8
v_accvgpr_read_b32 v181, a9
v_accvgpr_read_b32 v182, a10
v_accvgpr_read_b32 v183, a11
v_accvgpr_read_b32 v184, a12
v_accvgpr_read_b32 v185, a13
v_accvgpr_read_b32 v186, a14
v_accvgpr_read_b32 v187, a15
v_cvt_pk_bf16_f32 v36, v180, v181
v_cvt_pk_bf16_f32 v37, v182, v183
v_cvt_pk_bf16_f32 v38, v184, v185
v_cvt_pk_bf16_f32 v39, v186, v187
buffer_store_dwordx4 v[36:39], v252, s[20:23], s40 offen offset:1024 sc1
v_accvgpr_read_b32 v180, a16
v_accvgpr_read_b32 v181, a17
v_accvgpr_read_b32 v182, a18
v_accvgpr_read_b32 v183, a19
v_accvgpr_read_b32 v184, a20
v_accvgpr_read_b32 v185, a21
v_accvgpr_read_b32 v186, a22
v_accvgpr_read_b32 v187, a23
v_cvt_pk_bf16_f32 v40, v180, v181
v_cvt_pk_bf16_f32 v41, v182, v183
v_cvt_pk_bf16_f32 v42, v184, v185
v_cvt_pk_bf16_f32 v43, v186, v187
buffer_store_dwordx4 v[40:43], v252, s[20:23], s40 offen offset:2048 sc1
v_accvgpr_read_b32 v180, a24
v_accvgpr_read_b32 v181, a25
v_accvgpr_read_b32 v182, a26
v_accvgpr_read_b32 v183, a27
v_accvgpr_read_b32 v184, a28
v_accvgpr_read_b32 v185, a29
v_accvgpr_read_b32 v186, a30
v_accvgpr_read_b32 v187, a31
v_cvt_pk_bf16_f32 v44, v180, v181
v_cvt_pk_bf16_f32 v45, v182, v183
v_cvt_pk_bf16_f32 v46, v184, v185
v_cvt_pk_bf16_f32 v47, v186, v187
buffer_store_dwordx4 v[44:47], v252, s[20:23], s40 offen offset:3072 sc1
v_accvgpr_read_b32 v180, a32
v_accvgpr_read_b32 v181, a33
v_accvgpr_read_b32 v182, a34
v_accvgpr_read_b32 v183, a35
v_accvgpr_read_b32 v184, a36
v_accvgpr_read_b32 v185, a37
v_accvgpr_read_b32 v186, a38
v_accvgpr_read_b32 v187, a39
v_cvt_pk_bf16_f32 v48, v180, v181
v_cvt_pk_bf16_f32 v49, v182, v183
v_cvt_pk_bf16_f32 v50, v184, v185
v_cvt_pk_bf16_f32 v51, v186, v187
buffer_store_dwordx4 v[48:51], v252, s[20:23], s44 offen offset:0 sc1
v_accvgpr_read_b32 v180, a40
v_accvgpr_read_b32 v181, a41
v_accvgpr_read_b32 v182, a42
v_accvgpr_read_b32 v183, a43
v_accvgpr_read_b32 v184, a44
v_accvgpr_read_b32 v185, a45
v_accvgpr_read_b32 v186, a46
v_accvgpr_read_b32 v187, a47
v_cvt_pk_bf16_f32 v52, v180, v181
v_cvt_pk_bf16_f32 v53, v182, v183
v_cvt_pk_bf16_f32 v54, v184, v185
v_cvt_pk_bf16_f32 v55, v186, v187
buffer_store_dwordx4 v[52:55], v252, s[20:23], s44 offen offset:1024 sc1
v_accvgpr_read_b32 v180, a48
v_accvgpr_read_b32 v181, a49
v_accvgpr_read_b32 v182, a50
v_accvgpr_read_b32 v183, a51
v_accvgpr_read_b32 v184, a52
v_accvgpr_read_b32 v185, a53
v_accvgpr_read_b32 v186, a54
v_accvgpr_read_b32 v187, a55
v_cvt_pk_bf16_f32 v56, v180, v181
v_cvt_pk_bf16_f32 v57, v182, v183
v_cvt_pk_bf16_f32 v58, v184, v185
v_cvt_pk_bf16_f32 v59, v186, v187
buffer_store_dwordx4 v[56:59], v252, s[20:23], s44 offen offset:2048 sc1
v_accvgpr_read_b32 v180, a56
v_accvgpr_read_b32 v181, a57
v_accvgpr_read_b32 v182, a58
v_accvgpr_read_b32 v183, a59
v_accvgpr_read_b32 v184, a60
v_accvgpr_read_b32 v185, a61
v_accvgpr_read_b32 v186, a62
v_accvgpr_read_b32 v187, a63
v_cvt_pk_bf16_f32 v60, v180, v181
v_cvt_pk_bf16_f32 v61, v182, v183
v_cvt_pk_bf16_f32 v62, v184, v185
v_cvt_pk_bf16_f32 v63, v186, v187
buffer_store_dwordx4 v[60:63], v252, s[20:23], s44 offen offset:3072 sc1
v_lshlrev_b32 v175, 2, v252
s_mov_b64 exec, 0xffff
buffer_store_dwordx2 v[172:173], v175, s[24:27], s48 offen sc1
s_mov_b64 exec, -1
s_waitcnt vmcnt(0)
s_add_u32 s40, s40, 8192
s_add_u32 s48, s48, 1024
s_sub_u32 s55, s55, 1
s_cmp_lg_u32 s55, 0
s_cbranch_scc1 LS_q
s_barrier
s_add_u32 s56, s4, 0x1000000
s_addc_u32 s57, s5, 0
s_mov_b32 s58, 0x6c02000
s_mov_b32 s59, 0x00020000
s_mul_i32 s35, s37, 3
s_and_b32 s36, s35, 3
s_lshl_b32 s36, s36, 2
s_lshr_b32 s52, s35, 2
s_add_u32 s36, s36, s52
s_lshl_b32 s52, s38, 4
s_add_u32 s52, s52, s36
s_lshl_b32 s52, s52, 13
s_add_u32 s35, s35, 1
s_and_b32 s36, s35, 3
s_lshl_b32 s36, s36, 2
s_lshr_b32 s53, s35, 2
s_add_u32 s36, s36, s53
s_lshl_b32 s53, s38, 4
s_add_u32 s53, s53, s36
s_lshl_b32 s53, s53, 13
s_add_u32 s35, s35, 1
s_and_b32 s36, s35, 3
s_lshl_b32 s36, s36, 2
s_lshr_b32 s54, s35, 2
s_add_u32 s36, s36, s54
s_lshl_b32 s54, s38, 4
s_add_u32 s54, s54, s36
s_lshl_b32 s54, s54, 13
s_mov_b32 s99, 0
s_mov_b32 s98, 2
s_branch LC_again
LT_disp:
s_cmp_eq_u32 s34, 0
s_cbranch_scc1 LT_start
s_mov_b32 s41, s34
s_mul_i32 s40, s34, 6
s_add_u32 s40, s40, s37
s_add_u32 s40, s40, 42
s_cmp_lt_u32 s40, 60
s_cbranch_scc1 LE_common
s_branch L2_end
LT_start:
s_waitcnt lgkmcnt(0)
s_add_u32 s12, s4, 0x6800000
s_addc_u32 s13, s5, 0
s_mov_b32 s14, s49
s_mov_b32 s15, 0x00020000
s_add_u32 s8, s4, 0x0
s_addc_u32 s9, s5, 0
s_mov_b32 s10, 0x4e4000
s_mov_b32 s11, 0x00020000
s_mul_i32 s35, s37, 0x600000
s_add_u32 s20, s4, 0x2000000
s_addc_u32 s21, s5, 0
s_add_u32 s20, s20, s35
s_addc_u32 s21, s21, 0
s_mov_b32 s22, 0x4e4000
s_mov_b32 s23, 0x00020000
s_add_u32 s24, s4, 0x6000000
s_addc_u32 s25, s5, 0
s_mov_b32 s26, 0x9c800
s_mov_b32 s27, 0x00020000
s_lshl_b32 s35, s38, 4
s_lshl_b32 s41, s34, 2
s_add_u32 s35, s35, s41
s_lshl_b32 s40, s35, 13
s_lshl_b32 s48, s35, 10
s_lshl_b32 s35, s37, 3
s_add_u32 s48, s48, s35
v_bfe_u32 v248, v252, 4, 3
v_lshlrev_b32 v248, 6, v248
v_bfe_u32 v253, v252, 7, 1
v_lshl_or_b32 v248, v253, 10, v248
v_bfe_u32 v253, v252, 8, 2
v_lshl_or_b32 v248, v253, 4, v248
v_bfe_u32 v253, v252, 6, 1
v_lshlrev_b32 v253, 5, v253
v_xor_b32 v248, v248, v253
v_and_b32 v249, 0x1c0, v252
v_bfe_u32 v253, v252, 9, 1
v_lshl_or_b32 v249, v253, 10, v249
v_bfe_u32 v253, v252, 8, 1
v_lshl_or_b32 v249, v253, 5, v249
v_bfe_u32 v253, v252, 4, 2
v_lshl_or_b32 v249, v253, 3, v249
v_xor_b32 v250, 32, v249
s_mov_b32 s56, 90112
s_add_u32 s57, s56, 65536
s_mov_b32 s55, 1
v_bfe_i32 v188, v252, 8, 1
LT_q:
s_add_u32 s44, s40, 4096
buffer_load_dwordx4 v[0:3], v252, s[8:11], s40 offen offset:0
buffer_load_dwordx4 v[4:7], v252, s[8:11], s40 offen offset:1024
buffer_load_dwordx4 v[8:11], v252, s[8:11], s40 offen offset:2048
buffer_load_dwordx4 v[12:15], v252, s[8:11], s40 offen offset:3072
buffer_load_dwordx4 v[16:19], v252, s[8:11], s44 offen offset:0
buffer_load_dwordx4 v[20:23], v252, s[8:11], s44 offen offset:1024
buffer_load_dwordx4 v[24:27], v252, s[8:11], s44 offen offset:2048
buffer_load_dwordx4 v[28:31], v252, s[8:11], s44 offen offset:3072
s_mov_b32 s53, s56
s_mov_b32 s58, s39
s_add_u32 m0, s53, 0
s_add_u32 s54, s58, 0
buffer_load_dwordx4 v251, s[12:15], s54 offen offset:0 lds
buffer_load_dwordx4 v251, s[12:15], s54 offen offset:1024 lds
buffer_load_dwordx4 v251, s[12:15], s54 offen offset:2048 lds
buffer_load_dwordx4 v251, s[12:15], s54 offen offset:3072 lds
s_add_u32 m0, s53, 4096
s_add_u32 s54, s58, 128
buffer_load_dwordx4 v251, s[12:15], s54 offen offset:0 lds
buffer_load_dwordx4 v251, s[12:15], s54 offen offset:1024 lds
buffer_load_dwordx4 v251, s[12:15], s54 offen offset:2048 lds
buffer_load_dwordx4 v251, s[12:15], s54 offen offset:3072 lds
s_add_u32 m0, s53, 8192
s_add_u32 s54, s58, 256
buffer_load_dwordx4 v251, s[12:15], s54 offen offset:0 lds
buffer_load_dwordx4 v251, s[12:15], s54 offen offset:1024 lds
buffer_load_dwordx4 v251, s[12:15], s54 offen offset:2048 lds
buffer_load_dwordx4 v251, s[12:15], s54 offen offset:3072 lds
s_add_u32 m0, s53, 12288
s_add_u32 s54, s58, 384
buffer_load_dwordx4 v251, s[12:15], s54 offen offset:0 lds
buffer_load_dwordx4 v251, s[12:15], s54 offen offset:1024 lds
buffer_load_dwordx4 v251, s[12:15], s54 offen offset:2048 lds
buffer_load_dwordx4 v251, s[12:15], s54 offen offset:3072 lds
s_add_u32 s53, s53, 0x4000
s_cmp_eq_u32 s53, s57
s_cselect_b32 s53, s56, s53
s_add_u32 s58, s58, 0x4000
s_add_u32 m0, s53, 0
s_add_u32 s54, s58, 0
buffer_load_dwordx4 v251, s[12:15], s54 offen offset:0 lds
buffer_load_dwordx4 v251, s[12:15], s54 offen offset:1024 lds
buffer_load_dwordx4 v251, s[12:15], s54 offen offset:2048 lds
buffer_load_dwordx4 v251, s[12:15], s54 offen offset:3072 lds
s_add_u32 m0, s53, 4096
s_add_u32 s54, s58, 128
buffer_load_dwordx4 v251, s[12:15], s54 offen offset:0 lds
buffer_load_dwordx4 v251, s[12:15], s54 offen offset:1024 lds
buffer_load_dwordx4 v251, s[12:15], s54 offen offset:2048 lds
buffer_load_dwordx4 v251, s[12:15], s54 offen offset:3072 lds
s_add_u32 m0, s53, 8192
s_add_u32 s54, s58, 256
buffer_load_dwordx4 v251, s[12:15], s54 offen offset:0 lds
buffer_load_dwordx4 v251, s[12:15], s54 offen offset:1024 lds
buffer_load_dwordx4 v251, s[12:15], s54 offen offset:2048 lds
buffer_load_dwordx4 v251, s[12:15], s54 offen offset:3072 lds
s_add_u32 m0, s53, 12288
s_add_u32 s54, s58, 384
buffer_load_dwordx4 v251, s[12:15], s54 offen offset:0 lds
buffer_load_dwordx4 v251, s[12:15], s54 offen offset:1024 lds
buffer_load_dwordx4 v251, s[12:15], s54 offen offset:2048 lds
buffer_load_dwordx4 v251, s[12:15], s54 offen offset:3072 lds
s_add_u32 s53, s53, 0x4000
s_cmp_eq_u32 s53, s57
s_cselect_b32 s53, s56, s53
s_add_u32 s58, s58, 0x4000
s_add_u32 m0, s53, 0
s_add_u32 s54, s58, 0
buffer_load_dwordx4 v251, s[12:15], s54 offen offset:0 lds
buffer_load_dwordx4 v251, s[12:15], s54 offen offset:1024 lds
buffer_load_dwordx4 v251, s[12:15], s54 offen offset:2048 lds
buffer_load_dwordx4 v251, s[12:15], s54 offen offset:3072 lds
s_add_u32 m0, s53, 4096
s_add_u32 s54, s58, 128
buffer_load_dwordx4 v251, s[12:15], s54 offen offset:0 lds
buffer_load_dwordx4 v251, s[12:15], s54 offen offset:1024 lds
buffer_load_dwordx4 v251, s[12:15], s54 offen offset:2048 lds
buffer_load_dwordx4 v251, s[12:15], s54 offen offset:3072 lds
s_add_u32 m0, s53, 8192
s_add_u32 s54, s58, 256
buffer_load_dwordx4 v251, s[12:15], s54 offen offset:0 lds
buffer_load_dwordx4 v251, s[12:15], s54 offen offset:1024 lds
buffer_load_dwordx4 v251, s[12:15], s54 offen offset:2048 lds
buffer_load_dwordx4 v251, s[12:15], s54 offen offset:3072 lds
s_add_u32 m0, s53, 12288
s_add_u32 s54, s58, 384
buffer_load_dwordx4 v251, s[12:15], s54 offen offset:0 lds
buffer_load_dwordx4 v251, s[12:15], s54 offen offset:1024 lds
buffer_load_dwordx4 v251, s[12:15], s54 offen offset:2048 lds
buffer_load_dwordx4 v251, s[12:15], s54 offen offset:3072 lds
s_add_u32 s53, s53, 0x4000
s_cmp_eq_u32 s53, s57
s_cselect_b32 s53, s56, s53
s_add_u32 s58, s58, 0x4000
s_mov_b32 s51, s29
s_mov_b32 s52, s56
v_mov_b32 v172, 0xff800000
v_accvgpr_write_b32 a0, 0
v_accvgpr_write_b32 a1, 0
v_accvgpr_write_b32 a2, 0
v_accvgpr_write_b32 a3, 0
v_accvgpr_write_b32 a4, 0
v_accvgpr_write_b32 a5, 0
v_accvgpr_write_b32 a6, 0
v_accvgpr_write_b32 a7, 0
v_accvgpr_write_b32 a8, 0
v_accvgpr_write_b32 a9, 0
v_accvgpr_write_b32 a10, 0
v_accvgpr_write_b32 a11, 0
v_accvgpr_write_b32 a12, 0
v_accvgpr_write_b32 a13, 0
v_accvgpr_write_b32 a14, 0
v_accvgpr_write_b32 a15, 0
v_accvgpr_write_b32 a16, 0
v_accvgpr_write_b32 a17, 0
v_accvgpr_write_b32 a18, 0
v_accvgpr_write_b32 a19, 0
v_accvgpr_write_b32 a20, 0
v_accvgpr_write_b32 a21, 0
v_accvgpr_write_b32 a22, 0
v_accvgpr_write_b32 a23, 0
v_accvgpr_write_b32 a24, 0
v_accvgpr_write_b32 a25, 0
v_accvgpr_write_b32 a26, 0
v_accvgpr_write_b32 a27, 0
v_accvgpr_write_b32 a28, 0
v_accvgpr_write_b32 a29, 0
v_accvgpr_write_b32 a30, 0
v_accvgpr_write_b32 a31, 0
v_accvgpr_write_b32 a32, 0
v_accvgpr_write_b32 a33, 0
v_accvgpr_write_b32 a34, 0
v_accvgpr_write_b32 a35, 0
v_accvgpr_write_b32 a36, 0
v_accvgpr_write_b32 a37, 0
v_accvgpr_write_b32 a38, 0
v_accvgpr_write_b32 a39, 0
v_accvgpr_write_b32 a40, 0
v_accvgpr_write_b32 a41, 0
v_accvgpr_write_b32 a42, 0
v_accvgpr_write_b32 a43, 0
v_accvgpr_write_b32 a44, 0
v_accvgpr_write_b32 a45, 0
v_accvgpr_write_b32 a46, 0
v_accvgpr_write_b32 a47, 0
v_accvgpr_write_b32 a48, 0
v_accvgpr_write_b32 a49, 0
v_accvgpr_write_b32 a50, 0
v_accvgpr_write_b32 a51, 0
v_accvgpr_write_b32 a52, 0
v_accvgpr_write_b32 a53, 0
v_accvgpr_write_b32 a54, 0
v_accvgpr_write_b32 a55, 0
v_accvgpr_write_b32 a56, 0
v_accvgpr_write_b32 a57, 0
v_accvgpr_write_b32 a58, 0
v_accvgpr_write_b32 a59, 0
v_accvgpr_write_b32 a60, 0
v_accvgpr_write_b32 a61, 0
v_accvgpr_write_b32 a62, 0
v_accvgpr_write_b32 a63, 0
LT_loop:
s_add_u32 m0, s53, 0
s_add_u32 s54, s58, 0
buffer_load_dwordx4 v251, s[12:15], s54 offen offset:0 lds
buffer_load_dwordx4 v251, s[12:15], s54 offen offset:1024 lds
buffer_load_dwordx4 v251, s[12:15], s54 offen offset:2048 lds
buffer_load_dwordx4 v251, s[12:15], s54 offen offset:3072 lds
s_add_u32 m0, s53, 4096
s_add_u32 s54, s58, 128
buffer_load_dwordx4 v251, s[12:15], s54 offen offset:0 lds
buffer_load_dwordx4 v251, s[12:15], s54 offen offset:1024 lds
buffer_load_dwordx4 v251, s[12:15], s54 offen offset:2048 lds
buffer_load_dwordx4 v251, s[12:15], s54 offen offset:3072 lds
s_add_u32 m0, s53, 8192
s_add_u32 s54, s58, 256
buffer_load_dwordx4 v251, s[12:15], s54 offen offset:0 lds
buffer_load_dwordx4 v251, s[12:15], s54 offen offset:1024 lds
buffer_load_dwordx4 v251, s[12:15], s54 offen offset:2048 lds
buffer_load_dwordx4 v251, s[12:15], s54 offen offset:3072 lds
s_add_u32 m0, s53, 12288
s_add_u32 s54, s58, 384
buffer_load_dwordx4 v251, s[12:15], s54 offen offset:0 lds
buffer_load_dwordx4 v251, s[12:15], s54 offen offset:1024 lds
buffer_load_dwordx4 v251, s[12:15], s54 offen offset:2048 lds
buffer_load_dwordx4 v251, s[12:15], s54 offen offset:3072 lds
s_add_u32 s53, s53, 0x4000
s_cmp_eq_u32 s53, s57
s_cselect_b32 s53, s56, s53
s_add_u32 s58, s58, 0x4000
v_add_u32 v177, s52, v248
v_add_u32 v178, s52, v249
v_add_u32 v179, s52, v250
s_add_u32 s52, s52, 0x4000
s_cmp_eq_u32 s52, s57
s_cselect_b32 s52, s56, s52
s_cmp_eq_u32 s51, 1
s_cselect_b32 s54, s33, 0
v_and_b32 v192, s54, v188
v_and_b32 v193, s54, v188
v_and_b32 v194, s54, v188
v_and_b32 v195, s54, v188
s_waitcnt vmcnt(48)
ds_read_b128 v[32:35], v177 offset:0
ds_read_b128 v[64:67], v177 offset:2048
ds_read_b128 v[36:39], v177 offset:512
ds_read_b128 v[68:71], v177 offset:2560
ds_read_b128 v[40:43], v177 offset:4096
ds_read_b128 v[72:75], v177 offset:6144
ds_read_b128 v[44:47], v177 offset:4608
ds_read_b128 v[76:79], v177 offset:6656
ds_read_b128 v[48:51], v177 offset:8192
ds_read_b128 v[80:83], v177 offset:10240
ds_read_b128 v[52:55], v177 offset:8704
ds_read_b128 v[84:87], v177 offset:10752
ds_read_b128 v[56:59], v177 offset:12288
ds_read_b128 v[88:91], v177 offset:14336
ds_read_b128 v[60:63], v177 offset:12800
ds_read_b128 v[92:95], v177 offset:14848
s_waitcnt lgkmcnt(14)
v_mfma_f32_16x16x32_bf16 v[160:163], v[32:35], v[0:3], v[192:195]
v_mfma_f32_16x16x32_bf16 v[164:167], v[64:67], v[0:3], v[192:195]
s_waitcnt lgkmcnt(12)
v_mfma_f32_16x16x32_bf16 v[160:163], v[36:39], v[4:7], v[160:163]
v_mfma_f32_16x16x32_bf16 v[164:167], v[68:71], v[4:7], v[164:167]
s_waitcnt lgkmcnt(10)
v_mfma_f32_16x16x32_bf16 v[160:163], v[40:43], v[8:11], v[160:163]
v_mfma_f32_16x16x32_bf16 v[164:167], v[72:75], v[8:11], v[164:167]
s_waitcnt lgkmcnt(8)
v_mfma_f32_16x16x32_bf16 v[160:163], v[44:47], v[12:15], v[160:163]
v_mfma_f32_16x16x32_bf16 v[164:167], v[76:79], v[12:15], v[164:167]
s_waitcnt lgkmcnt(6)
v_mfma_f32_16x16x32_bf16 v[160:163], v[48:51], v[16:19], v[160:163]
v_mfma_f32_16x16x32_bf16 v[164:167], v[80:83], v[16:19], v[164:167]
s_waitcnt lgkmcnt(4)
v_mfma_f32_16x16x32_bf16 v[160:163], v[52:55], v[20:23], v[160:163]
v_mfma_f32_16x16x32_bf16 v[164:167], v[84:87], v[20:23], v[164:167]
s_waitcnt lgkmcnt(2)
v_mfma_f32_16x16x32_bf16 v[160:163], v[56:59], v[24:27], v[160:163]
v_mfma_f32_16x16x32_bf16 v[164:167], v[88:91], v[24:27], v[164:167]
s_waitcnt lgkmcnt(0)
v_mfma_f32_16x16x32_bf16 v[160:163], v[60:63], v[28:31], v[160:163]
v_mfma_f32_16x16x32_bf16 v[164:167], v[92:95], v[28:31], v[164:167]
ds_read_b64_tr_b16 v[96:97], v178 offset:0
ds_read_b64_tr_b16 v[98:99], v178 offset:2048
ds_read_b64_tr_b16 v[100:101], v179 offset:0
ds_read_b64_tr_b16 v[102:103], v179 offset:2048
ds_read_b64_tr_b16 v[104:105], v178 offset:512
ds_read_b64_tr_b16 v[106:107], v178 offset:2560
ds_read_b64_tr_b16 v[108:109], v179 offset:512
ds_read_b64_tr_b16 v[110:111], v179 offset:2560
ds_read_b64_tr_b16 v[112:113], v178 offset:4096
ds_read_b64_tr_b16 v[114:115], v178 offset:6144
ds_read_b64_tr_b16 v[116:117], v179 offset:4096
ds_read_b64_tr_b16 v[118:119], v179 offset:6144
ds_read_b64_tr_b16 v[120:121], v178 offset:4608
ds_read_b64_tr_b16 v[122:123], v178 offset:6656
ds_read_b64_tr_b16 v[124:125], v179 offset:4608
ds_read_b64_tr_b16 v[126:127], v179 offset:6656
ds_read_b64_tr_b16 v[128:129], v178 offset:8192
ds_read_b64_tr_b16 v[130:131], v178 offset:10240
ds_read_b64_tr_b16 v[132:133], v179 offset:8192
ds_read_b64_tr_b16 v[134:135], v179 offset:10240
ds_read_b64_tr_b16 v[136:137], v178 offset:8704
ds_read_b64_tr_b16 v[138:139], v178 offset:10752
ds_read_b64_tr_b16 v[140:141], v179 offset:8704
ds_read_b64_tr_b16 v[142:143], v179 offset:10752
ds_read_b64_tr_b16 v[144:145], v178 offset:12288
ds_read_b64_tr_b16 v[146:147], v178 offset:14336
ds_read_b64_tr_b16 v[148:149], v179 offset:12288
ds_read_b64_tr_b16 v[150:151], v179 offset:14336
ds_read_b64_tr_b16 v[152:153], v178 offset:12800
ds_read_b64_tr_b16 v[154:155], v178 offset:14848
ds_read_b64_tr_b16 v[156:157], v179 offset:12800
ds_read_b64_tr_b16 v[158:159], v179 offset:14848
s_nop 7
v_max3_f32 v175, v160, v161, v162
v_max3_f32 v175, v175, v163, v164
v_max3_f32 v175, v175, v165, v166
v_max3_f32 v175, v175, v167, v172
v_mov_b32 v176, v175
s_nop 1
v_permlane32_swap_b32 v175, v176
s_nop 1
v_max_f32 v175, v175, v176
v_mov_b32 v176, v175
s_nop 1
v_permlane16_swap_b32 v175, v176
s_nop 1
v_max_f32 v175, v175, v176
v_sub_f32 v174, v172, v175
v_exp_f32 v174, v174
v_mov_b32 v172, v175
v_sub_f32 v160, v160, v172
v_sub_f32 v161, v161, v172
v_sub_f32 v162, v162, v172
v_sub_f32 v163, v163, v172
v_sub_f32 v164, v164, v172
v_sub_f32 v165, v165, v172
v_sub_f32 v166, v166, v172
v_sub_f32 v167, v167, v172
v_exp_f32 v160, v160
v_exp_f32 v161, v161
v_exp_f32 v162, v162
v_exp_f32 v163, v163
v_exp_f32 v164, v164
v_exp_f32 v165, v165
v_exp_f32 v166, v166
v_exp_f32 v167, v167
v_cmp_neq_f32 vcc, 1.0, v174
v_cvt_pk_bf16_f32 v168, v160, v161
v_cvt_pk_bf16_f32 v169, v162, v163
v_cvt_pk_bf16_f32 v170, v164, v165
v_cvt_pk_bf16_f32 v171, v166, v167
s_cbranch_vccz LT_nors
v_accvgpr_read_b32 v180, a0
v_accvgpr_read_b32 v181, a1
v_accvgpr_read_b32 v182, a2
v_accvgpr_read_b32 v183, a3
v_accvgpr_read_b32 v184, a4
v_accvgpr_read_b32 v185, a5
v_accvgpr_read_b32 v186, a6
v_accvgpr_read_b32 v187, a7
v_mul_f32 v180, v180, v174
v_mul_f32 v181, v181, v174
v_mul_f32 v182, v182, v174
v_mul_f32 v183, v183, v174
v_mul_f32 v184, v184, v174
v_mul_f32 v185, v185, v174
v_mul_f32 v186, v186, v174
v_mul_f32 v187, v187, v174
v_accvgpr_write_b32 a0, v180
v_accvgpr_write_b32 a1, v181
v_accvgpr_write_b32 a2, v182
v_accvgpr_write_b32 a3, v183
v_accvgpr_write_b32 a4, v184
v_accvgpr_write_b32 a5, v185
v_accvgpr_write_b32 a6, v186
v_accvgpr_write_b32 a7, v187
v_accvgpr_read_b32 v180, a8
v_accvgpr_read_b32 v181, a9
v_accvgpr_read_b32 v182, a10
v_accvgpr_read_b32 v183, a11
v_accvgpr_read_b32 v184, a12
v_accvgpr_read_b32 v185, a13
v_accvgpr_read_b32 v186, a14
v_accvgpr_read_b32 v187, a15
v_mul_f32 v180, v180, v174
v_mul_f32 v181, v181, v174
v_mul_f32 v182, v182, v174
v_mul_f32 v183, v183, v174
v_mul_f32 v184, v184, v174
v_mul_f32 v185, v185, v174
v_mul_f32 v186, v186, v174
v_mul_f32 v187, v187, v174
v_accvgpr_write_b32 a8, v180
v_accvgpr_write_b32 a9, v181
v_accvgpr_write_b32 a10, v182
v_accvgpr_write_b32 a11, v183
v_accvgpr_write_b32 a12, v184
v_accvgpr_write_b32 a13, v185
v_accvgpr_write_b32 a14, v186
v_accvgpr_write_b32 a15, v187
v_accvgpr_read_b32 v180, a16
v_accvgpr_read_b32 v181, a17
v_accvgpr_read_b32 v182, a18
v_accvgpr_read_b32 v183, a19
v_accvgpr_read_b32 v184, a20
v_accvgpr_read_b32 v185, a21
v_accvgpr_read_b32 v186, a22
v_accvgpr_read_b32 v187, a23
v_mul_f32 v180, v180, v174
v_mul_f32 v181, v181, v174
v_mul_f32 v182, v182, v174
v_mul_f32 v183, v183, v174
v_mul_f32 v184, v184, v174
v_mul_f32 v185, v185, v174
v_mul_f32 v186, v186, v174
v_mul_f32 v187, v187, v174
v_accvgpr_write_b32 a16, v180
v_accvgpr_write_b32 a17, v181
v_accvgpr_write_b32 a18, v182
v_accvgpr_write_b32 a19, v183
v_accvgpr_write_b32 a20, v184
v_accvgpr_write_b32 a21, v185
v_accvgpr_write_b32 a22, v186
v_accvgpr_write_b32 a23, v187
v_accvgpr_read_b32 v180, a24
v_accvgpr_read_b32 v181, a25
v_accvgpr_read_b32 v182, a26
v_accvgpr_read_b32 v183, a27
v_accvgpr_read_b32 v184, a28
v_accvgpr_read_b32 v185, a29
v_accvgpr_read_b32 v186, a30
v_accvgpr_read_b32 v187, a31
v_mul_f32 v180, v180, v174
v_mul_f32 v181, v181, v174
v_mul_f32 v182, v182, v174
v_mul_f32 v183, v183, v174
v_mul_f32 v184, v184, v174
v_mul_f32 v185, v185, v174
v_mul_f32 v186, v186, v174
v_mul_f32 v187, v187, v174
v_accvgpr_write_b32 a24, v180
v_accvgpr_write_b32 a25, v181
v_accvgpr_write_b32 a26, v182
v_accvgpr_write_b32 a27, v183
v_accvgpr_write_b32 a28, v184
v_accvgpr_write_b32 a29, v185
v_accvgpr_write_b32 a30, v186
v_accvgpr_write_b32 a31, v187
v_accvgpr_read_b32 v180, a32
v_accvgpr_read_b32 v181, a33
v_accvgpr_read_b32 v182, a34
v_accvgpr_read_b32 v183, a35
v_accvgpr_read_b32 v184, a36
v_accvgpr_read_b32 v185, a37
v_accvgpr_read_b32 v186, a38
v_accvgpr_read_b32 v187, a39
v_mul_f32 v180, v180, v174
v_mul_f32 v181, v181, v174
v_mul_f32 v182, v182, v174
v_mul_f32 v183, v183, v174
v_mul_f32 v184, v184, v174
v_mul_f32 v185, v185, v174
v_mul_f32 v186, v186, v174
v_mul_f32 v187, v187, v174
v_accvgpr_write_b32 a32, v180
v_accvgpr_write_b32 a33, v181
v_accvgpr_write_b32 a34, v182
v_accvgpr_write_b32 a35, v183
v_accvgpr_write_b32 a36, v184
v_accvgpr_write_b32 a37, v185
v_accvgpr_write_b32 a38, v186
v_accvgpr_write_b32 a39, v187
v_accvgpr_read_b32 v180, a40
v_accvgpr_read_b32 v181, a41
v_accvgpr_read_b32 v182, a42
v_accvgpr_read_b32 v183, a43
v_accvgpr_read_b32 v184, a44
v_accvgpr_read_b32 v185, a45
v_accvgpr_read_b32 v186, a46
v_accvgpr_read_b32 v187, a47
v_mul_f32 v180, v180, v174
v_mul_f32 v181, v181, v174
v_mul_f32 v182, v182, v174
v_mul_f32 v183, v183, v174
v_mul_f32 v184, v184, v174
v_mul_f32 v185, v185, v174
v_mul_f32 v186, v186, v174
v_mul_f32 v187, v187, v174
v_accvgpr_write_b32 a40, v180
v_accvgpr_write_b32 a41, v181
v_accvgpr_write_b32 a42, v182
v_accvgpr_write_b32 a43, v183
v_accvgpr_write_b32 a44, v184
v_accvgpr_write_b32 a45, v185
v_accvgpr_write_b32 a46, v186
v_accvgpr_write_b32 a47, v187
v_accvgpr_read_b32 v180, a48
v_accvgpr_read_b32 v181, a49
v_accvgpr_read_b32 v182, a50
v_accvgpr_read_b32 v183, a51
v_accvgpr_read_b32 v184, a52
v_accvgpr_read_b32 v185, a53
v_accvgpr_read_b32 v186, a54
v_accvgpr_read_b32 v187, a55
v_mul_f32 v180, v180, v174
v_mul_f32 v181, v181, v174
v_mul_f32 v182, v182, v174
v_mul_f32 v183, v183, v174
v_mul_f32 v184, v184, v174
v_mul_f32 v185, v185, v174
v_mul_f32 v186, v186, v174
v_mul_f32 v187, v187, v174
v_accvgpr_write_b32 a48, v180
v_accvgpr_write_b32 a49, v181
v_accvgpr_write_b32 a50, v182
v_accvgpr_write_b32 a51, v183
v_accvgpr_write_b32 a52, v184
v_accvgpr_write_b32 a53, v185
v_accvgpr_write_b32 a54, v186
v_accvgpr_write_b32 a55, v187
v_accvgpr_read_b32 v180, a56
v_accvgpr_read_b32 v181, a57
v_accvgpr_read_b32 v182, a58
v_accvgpr_read_b32 v183, a59
v_accvgpr_read_b32 v184, a60
v_accvgpr_read_b32 v185, a61
v_accvgpr_read_b32 v186, a62
v_accvgpr_read_b32 v187, a63
v_mul_f32 v180, v180, v174
v_mul_f32 v181, v181, v174
v_mul_f32 v182, v182, v174
v_mul_f32 v183, v183, v174
v_mul_f32 v184, v184, v174
v_mul_f32 v185, v185, v174
v_mul_f32 v186, v186, v174
v_mul_f32 v187, v187, v174
v_accvgpr_write_b32 a56, v180
v_accvgpr_write_b32 a57, v181
v_accvgpr_write_b32 a58, v182
v_accvgpr_write_b32 a59, v183
v_accvgpr_write_b32 a60, v184
v_accvgpr_write_b32 a61, v185
v_accvgpr_write_b32 a62, v186
v_accvgpr_write_b32 a63, v187
LT_nors:
s_waitcnt lgkmcnt(0)
s_nop 1
v_mfma_f32_16x16x32_bf16 a[0:3], v[96:99], v[168:171], a[0:3]
v_mfma_f32_16x16x32_bf16 a[4:7], v[100:103], v[168:171], a[4:7]
v_mfma_f32_16x16x32_bf16 a[8:11], v[104:107], v[168:171], a[8:11]
v_mfma_f32_16x16x32_bf16 a[12:15], v[108:111], v[168:171], a[12:15]
v_mfma_f32_16x16x32_bf16 a[16:19], v[112:115], v[168:171], a[16:19]
v_mfma_f32_16x16x32_bf16 a[20:23], v[116:119], v[168:171], a[20:23]
v_mfma_f32_16x16x32_bf16 a[24:27], v[120:123], v[168:171], a[24:27]
v_mfma_f32_16x16x32_bf16 a[28:31], v[124:127], v[168:171], a[28:31]
v_mfma_f32_16x16x32_bf16 a[32:35], v[128:131], v[168:171], a[32:35]
v_mfma_f32_16x16x32_bf16 a[36:39], v[132:135], v[168:171], a[36:39]
v_mfma_f32_16x16x32_bf16 a[40:43], v[136:139], v[168:171], a[40:43]
v_mfma_f32_16x16x32_bf16 a[44:47], v[140:143], v[168:171], a[44:47]
v_mfma_f32_16x16x32_bf16 a[48:51], v[144:147], v[168:171], a[48:51]
v_mfma_f32_16x16x32_bf16 a[52:55], v[148:151], v[168:171], a[52:55]
v_mfma_f32_16x16x32_bf16 a[56:59], v[152:155], v[168:171], a[56:59]
v_mfma_f32_16x16x32_bf16 a[60:63], v[156:159], v[168:171], a[60:63]
s_sub_u32 s51, s51, 1
s_cmp_lg_u32 s51, 0
s_cbranch_scc1 LT_loop
s_nop 15
v_accvgpr_read_b32 v173, a0
v_accvgpr_read_b32 v180, a0
v_accvgpr_read_b32 v181, a1
v_accvgpr_read_b32 v182, a2
v_accvgpr_read_b32 v183, a3
v_accvgpr_read_b32 v184, a4
v_accvgpr_read_b32 v185, a5
v_accvgpr_read_b32 v186, a6
v_accvgpr_read_b32 v187, a7
v_cvt_pk_bf16_f32 v32, v180, v181
v_cvt_pk_bf16_f32 v33, v182, v183
v_cvt_pk_bf16_f32 v34, v184, v185
v_cvt_pk_bf16_f32 v35, v186, v187
buffer_store_dwordx4 v[32:35], v252, s[20:23], s40 offen offset:0 sc1
v_accvgpr_read_b32 v180, a8
v_accvgpr_read_b32 v181, a9
v_accvgpr_read_b32 v182, a10
v_accvgpr_read_b32 v183, a11
v_accvgpr_read_b32 v184, a12
v_accvgpr_read_b32 v185, a13
v_accvgpr_read_b32 v186, a14
v_accvgpr_read_b32 v187, a15
v_cvt_pk_bf16_f32 v36, v180, v181
v_cvt_pk_bf16_f32 v37, v182, v183
v_cvt_pk_bf16_f32 v38, v184, v185
v_cvt_pk_bf16_f32 v39, v186, v187
buffer_store_dwordx4 v[36:39], v252, s[20:23], s40 offen offset:1024 sc1
v_accvgpr_read_b32 v180, a16
v_accvgpr_read_b32 v181, a17
v_accvgpr_read_b32 v182, a18
v_accvgpr_read_b32 v183, a19
v_accvgpr_read_b32 v184, a20
v_accvgpr_read_b32 v185, a21
v_accvgpr_read_b32 v186, a22
v_accvgpr_read_b32 v187, a23
v_cvt_pk_bf16_f32 v40, v180, v181
v_cvt_pk_bf16_f32 v41, v182, v183
v_cvt_pk_bf16_f32 v42, v184, v185
v_cvt_pk_bf16_f32 v43, v186, v187
buffer_store_dwordx4 v[40:43], v252, s[20:23], s40 offen offset:2048 sc1
v_accvgpr_read_b32 v180, a24
v_accvgpr_read_b32 v181, a25
v_accvgpr_read_b32 v182, a26
v_accvgpr_read_b32 v183, a27
v_accvgpr_read_b32 v184, a28
v_accvgpr_read_b32 v185, a29
v_accvgpr_read_b32 v186, a30
v_accvgpr_read_b32 v187, a31
v_cvt_pk_bf16_f32 v44, v180, v181
v_cvt_pk_bf16_f32 v45, v182, v183
v_cvt_pk_bf16_f32 v46, v184, v185
v_cvt_pk_bf16_f32 v47, v186, v187
buffer_store_dwordx4 v[44:47], v252, s[20:23], s40 offen offset:3072 sc1
v_accvgpr_read_b32 v180, a32
v_accvgpr_read_b32 v181, a33
v_accvgpr_read_b32 v182, a34
v_accvgpr_read_b32 v183, a35
v_accvgpr_read_b32 v184, a36
v_accvgpr_read_b32 v185, a37
v_accvgpr_read_b32 v186, a38
v_accvgpr_read_b32 v187, a39
v_cvt_pk_bf16_f32 v48, v180, v181
v_cvt_pk_bf16_f32 v49, v182, v183
v_cvt_pk_bf16_f32 v50, v184, v185
v_cvt_pk_bf16_f32 v51, v186, v187
buffer_store_dwordx4 v[48:51], v252, s[20:23], s44 offen offset:0 sc1
v_accvgpr_read_b32 v180, a40
v_accvgpr_read_b32 v181, a41
v_accvgpr_read_b32 v182, a42
v_accvgpr_read_b32 v183, a43
v_accvgpr_read_b32 v184, a44
v_accvgpr_read_b32 v185, a45
v_accvgpr_read_b32 v186, a46
v_accvgpr_read_b32 v187, a47
v_cvt_pk_bf16_f32 v52, v180, v181
v_cvt_pk_bf16_f32 v53, v182, v183
v_cvt_pk_bf16_f32 v54, v184, v185
v_cvt_pk_bf16_f32 v55, v186, v187
buffer_store_dwordx4 v[52:55], v252, s[20:23], s44 offen offset:1024 sc1
v_accvgpr_read_b32 v180, a48
v_accvgpr_read_b32 v181, a49
v_accvgpr_read_b32 v182, a50
v_accvgpr_read_b32 v183, a51
v_accvgpr_read_b32 v184, a52
v_accvgpr_read_b32 v185, a53
v_accvgpr_read_b32 v186, a54
v_accvgpr_read_b32 v187, a55
v_cvt_pk_bf16_f32 v56, v180, v181
v_cvt_pk_bf16_f32 v57, v182, v183
v_cvt_pk_bf16_f32 v58, v184, v185
v_cvt_pk_bf16_f32 v59, v186, v187
buffer_store_dwordx4 v[56:59], v252, s[20:23], s44 offen offset:2048 sc1
v_accvgpr_read_b32 v180, a56
v_accvgpr_read_b32 v181, a57
v_accvgpr_read_b32 v182, a58
v_accvgpr_read_b32 v183, a59
v_accvgpr_read_b32 v184, a60
v_accvgpr_read_b32 v185, a61
v_accvgpr_read_b32 v186, a62
v_accvgpr_read_b32 v187, a63
v_cvt_pk_bf16_f32 v60, v180, v181
v_cvt_pk_bf16_f32 v61, v182, v183
v_cvt_pk_bf16_f32 v62, v184, v185
v_cvt_pk_bf16_f32 v63, v186, v187
buffer_store_dwordx4 v[60:63], v252, s[20:23], s44 offen offset:3072 sc1
v_lshlrev_b32 v175, 2, v252
s_mov_b64 exec, 0xffff
buffer_store_dwordx2 v[172:173], v175, s[24:27], s48 offen sc1
s_mov_b64 exec, -1
s_waitcnt vmcnt(0)
s_add_u32 s40, s40, 8192
s_add_u32 s48, s48, 1024
s_sub_u32 s55, s55, 1
s_cmp_lg_u32 s55, 0
s_cbranch_scc1 LT_q
s_add_u32 s52, s4, 0x7c00000
s_addc_u32 s53, s5, 0
s_mov_b32 s54, 0x2000
s_mov_b32 s55, 0x00020000
v_mov_b32 v1, 4992
v_mov_b32 v2, 1
s_mov_b64 exec, 1
s_waitcnt vmcnt(0)
buffer_atomic_add v2, v1, s[52:55], 0 offen
s_mov_b64 exec, -1
s_branch L2_fin
LE_start:
s_cmp_ge_u32 s37, 32
s_cbranch_scc1 L2_end
v_lshrrev_b32 v1, 6, v0
s_sub_u32 s37, s37, 30
s_lshl_b32 s35, s35, 1
v_readfirstlane_b32 s41, v1
s_add_u32 s35, s35, s37
s_mul_i32 s35, s35, 3
s_add_u32 s40, s35, s41
s_cmp_ge_u32 s41, 3
s_cbranch_scc1 LC_help
LE_common:
v_and_b32 v1, 63, v0
s_load_dwordx2 s[58:59], s[0:1], 24
s_mov_b32 s42, 0
s_mov_b32 s49, 512
v_lshrrev_b32 v33, 1, v1
v_and_b32 v34, 1, v1
v_mul_u32_u24 v6, 0x5000, v33
v_lshl_add_u32 v6, v34, 4, v6
v_lshlrev_b32 v33, 2, v33
s_mul_i32 s50, s40, 655360
s_mul_i32 s48, s40, 128
s_waitcnt lgkmcnt(0)
s_add_u32 s8, s4, 0x7800000
s_addc_u32 s9, s5, 0
s_mov_b32 s10, 0x2000
s_mov_b32 s11, 0x00020000
s_add_u32 s12, s4, 0x8000000
s_addc_u32 s13, s5, 0
s_mov_b32 s14, 0x2800000
s_mov_b32 s15, 0x00020000
buffer_load_dword v4, v33, s[8:11], s48 offen
buffer_load_dwordx4 v[192:195], v6, s[12:15], s50 offen offset:0
buffer_load_dwordx4 v[196:199], v6, s[12:15], s50 offen offset:32
buffer_load_dwordx4 v[200:203], v6, s[12:15], s50 offen offset:64
buffer_load_dwordx4 v[204:207], v6, s[12:15], s50 offen offset:96
buffer_load_dwordx4 v[208:211], v6, s[12:15], s50 offen offset:128
buffer_load_dwordx4 v[212:215], v6, s[12:15], s50 offen offset:160
buffer_load_dwordx4 v[216:219], v6, s[12:15], s50 offen offset:192
buffer_load_dwordx4 v[220:223], v6, s[12:15], s50 offen offset:224
buffer_load_dwordx4 v[224:227], v6, s[12:15], s50 offen offset:256
buffer_load_dwordx4 v[228:231], v6, s[12:15], s50 offen offset:288
buffer_load_dwordx4 v[232:235], v6, s[12:15], s50 offen offset:320
buffer_load_dwordx4 v[236:239], v6, s[12:15], s50 offen offset:352
buffer_load_dwordx4 v[240:243], v6, s[12:15], s50 offen offset:384
buffer_load_dwordx4 v[244:247], v6, s[12:15], s50 offen offset:416
buffer_load_dwordx4 v[248:251], v6, s[12:15], s50 offen offset:448
buffer_load_dwordx4 v[252:255], v6, s[12:15], s50 offen offset:480
s_add_u32 s16, s58, 0x0
s_addc_u32 s17, s59, 0
s_mov_b32 s18, 0x4e20
s_mov_b32 s19, 0x00020000
v_lshlrev_b32 v35, 1, v1
s_mul_i32 s48, s40, 334
buffer_load_ushort v76, v35, s[16:19], s48 offen offset:0
buffer_load_ushort v77, v35, s[16:19], s48 offen offset:128
buffer_load_ushort v78, v35, s[16:19], s48 offen offset:256
s_add_u32 s16, s4, 0x6800000
s_addc_u32 s17, s5, 0
s_mov_b32 s18, 0x4e2000
s_mov_b32 s19, 0x00020000
s_add_u32 s20, s4, 0x7000000
s_addc_u32 s21, s5, 0
s_mov_b32 s22, 0x4e2000
s_mov_b32 s23, 0x00020000
v_lshlrev_b32 v5, 2, v34
v_and_b32 v2, 15, v1
v_lshrrev_b32 v3, 4, v1
v_mov_b32 v16, 1
v_mov_b32 v17, 4
v_and_b32 v33, 1, v2
v_lshlrev_b32 v33, 4, v33
v_lshlrev_b32 v33, v33, v16
v_mul_u32_u24 v33, 0x3f80, v33
v_lshrrev_b32 v34, 1, v2
v_cmp_eq_u32 vcc, 0, v34
s_nop 1
v_cndmask_b32 v40, 0, v33, vcc
v_cmp_eq_u32 vcc, 1, v34
s_nop 1
v_cndmask_b32 v41, 0, v33, vcc
v_cmp_eq_u32 vcc, 2, v34
s_nop 1
v_cndmask_b32 v42, 0, v33, vcc
v_cmp_eq_u32 vcc, 3, v34
s_nop 1
v_cndmask_b32 v43, 0, v33, vcc
v_cmp_eq_u32 vcc, 4, v34
s_nop 1
v_cndmask_b32 v44, 0, v33, vcc
v_cmp_eq_u32 vcc, 5, v34
s_nop 1
v_cndmask_b32 v45, 0, v33, vcc
v_cmp_eq_u32 vcc, 6, v34
s_nop 1
v_cndmask_b32 v46, 0, v33, vcc
v_cmp_eq_u32 vcc, 7, v34
s_nop 1
v_cndmask_b32 v47, 0, v33, vcc
v_lshlrev_b32 v39, 5, v2
v_lshl_add_u32 v39, v3, 3, v39
v_lshlrev_b32 v2, 4, v2
s_mul_i32 s48, s41, 21504
s_add_u32 s48, s48, 4096
v_mov_b32 v36, s48
v_lshl_add_u32 v38, v3, 2, v36
s_lshl_b32 s36, s41, 10
v_mov_b32 v7, s36
v_lshlrev_b32 v35, 4, v1
v_add_u32 v68, s48, v35
v_add_u32 v35, s36, v35
v_lshlrev_b32 v33, 2, v1
v_mov_b32 v72, 0xffff
v_mov_b32 v73, 0xffff
v_mov_b32 v74, 0xffff
v_mov_b32 v75, 0xffff
v_cmp_gt_u32 vcc, 167, v33
v_mov_b32 v48, 0
s_nop 0
v_cndmask_b32 v18, 0, v16, vcc
v_cmp_gt_u32 vcc, 166, v33
v_mov_b32 v49, 0
s_nop 0
v_cndmask_b32 v19, 0, v16, vcc
v_cmp_gt_u32 vcc, 165, v33
v_mov_b32 v50, 0
s_nop 0
v_cndmask_b32 v20, 0, v16, vcc
v_cmp_gt_u32 vcc, 164, v33
v_mov_b32 v51, 0
s_nop 0
v_cndmask_b32 v21, 0, v16, vcc
LE_pass:
ds_write_b128 v35, v[48:51]
ds_write_b128 v68, v[72:75] offset:0
ds_write_b128 v68, v[72:75] offset:1024
ds_write_b128 v68, v[72:75] offset:2048
ds_write_b128 v68, v[72:75] offset:3072
ds_write_b128 v68, v[72:75] offset:4096
ds_write_b128 v68, v[72:75] offset:5120
ds_write_b128 v68, v[72:75] offset:6144
ds_write_b128 v68, v[72:75] offset:7168
ds_write_b128 v68, v[72:75] offset:8192
ds_write_b128 v68, v[72:75] offset:9216
ds_write_b128 v68, v[72:75] offset:10240
ds_write_b128 v68, v[72:75] offset:11264
ds_write_b128 v68, v[72:75] offset:12288
ds_write_b128 v68, v[72:75] offset:13312
ds_write_b128 v68, v[72:75] offset:14336
ds_write_b128 v68, v[72:75] offset:15360
ds_write_b128 v68, v[72:75] offset:16384
ds_write_b128 v68, v[72:75] offset:17408
ds_write_b128 v68, v[72:75] offset:18432
ds_write_b128 v68, v[72:75] offset:19456
v_lshl_add_u32 v32, v1, 2, v36
ds_write_b32 v32, v48 offset:20480
s_waitcnt vmcnt(19)
v_sub_u32 v32, v4, v5
s_waitcnt vmcnt(15)
v_cmpx_lt_i32 vcc, 0, v32
s_cbranch_execz LE_c
v_mad_u32_u16 v128, v192, 1, v7 op_sel:[1,0,0,0]
ds_add_u32 v128, v16
v_cmpx_lt_i32 vcc, 1, v32
v_mad_u32_u16 v129, v193, 1, v7 op_sel:[1,0,0,0]
ds_add_u32 v129, v16
v_cmpx_lt_i32 vcc, 2, v32
v_mad_u32_u16 v130, v194, 1, v7 op_sel:[1,0,0,0]
ds_add_u32 v130, v16
v_cmpx_lt_i32 vcc, 3, v32
v_mad_u32_u16 v131, v195, 1, v7 op_sel:[1,0,0,0]
ds_add_u32 v131, v16
s_waitcnt vmcnt(14)
v_cmpx_lt_i32 vcc, 8, v32
s_cbranch_execz LE_c
v_mad_u32_u16 v132, v196, 1, v7 op_sel:[1,0,0,0]
ds_add_u32 v132, v16
v_cmpx_lt_i32 vcc, 9, v32
v_mad_u32_u16 v133, v197, 1, v7 op_sel:[1,0,0,0]
ds_add_u32 v133, v16
v_cmpx_lt_i32 vcc, 10, v32
v_mad_u32_u16 v134, v198, 1, v7 op_sel:[1,0,0,0]
ds_add_u32 v134, v16
v_cmpx_lt_i32 vcc, 11, v32
v_mad_u32_u16 v135, v199, 1, v7 op_sel:[1,0,0,0]
ds_add_u32 v135, v16
s_waitcnt vmcnt(13)
v_cmpx_lt_i32 vcc, 16, v32
s_cbranch_execz LE_c
v_mad_u32_u16 v136, v200, 1, v7 op_sel:[1,0,0,0]
ds_add_u32 v136, v16
v_cmpx_lt_i32 vcc, 17, v32
v_mad_u32_u16 v137, v201, 1, v7 op_sel:[1,0,0,0]
ds_add_u32 v137, v16
v_cmpx_lt_i32 vcc, 18, v32
v_mad_u32_u16 v138, v202, 1, v7 op_sel:[1,0,0,0]
ds_add_u32 v138, v16
v_cmpx_lt_i32 vcc, 19, v32
v_mad_u32_u16 v139, v203, 1, v7 op_sel:[1,0,0,0]
ds_add_u32 v139, v16
s_waitcnt vmcnt(12)
v_cmpx_lt_i32 vcc, 24, v32
s_cbranch_execz LE_c
v_mad_u32_u16 v140, v204, 1, v7 op_sel:[1,0,0,0]
ds_add_u32 v140, v16
v_cmpx_lt_i32 vcc, 25, v32
v_mad_u32_u16 v141, v205, 1, v7 op_sel:[1,0,0,0]
ds_add_u32 v141, v16
v_cmpx_lt_i32 vcc, 26, v32
v_mad_u32_u16 v142, v206, 1, v7 op_sel:[1,0,0,0]
ds_add_u32 v142, v16
v_cmpx_lt_i32 vcc, 27, v32
v_mad_u32_u16 v143, v207, 1, v7 op_sel:[1,0,0,0]
ds_add_u32 v143, v16
s_waitcnt vmcnt(11)
v_cmpx_lt_i32 vcc, 32, v32
s_cbranch_execz LE_c
v_mad_u32_u16 v144, v208, 1, v7 op_sel:[1,0,0,0]
ds_add_u32 v144, v16
v_cmpx_lt_i32 vcc, 33, v32
v_mad_u32_u16 v145, v209, 1, v7 op_sel:[1,0,0,0]
ds_add_u32 v145, v16
v_cmpx_lt_i32 vcc, 34, v32
v_mad_u32_u16 v146, v210, 1, v7 op_sel:[1,0,0,0]
ds_add_u32 v146, v16
v_cmpx_lt_i32 vcc, 35, v32
v_mad_u32_u16 v147, v211, 1, v7 op_sel:[1,0,0,0]
ds_add_u32 v147, v16
s_waitcnt vmcnt(10)
v_cmpx_lt_i32 vcc, 40, v32
s_cbranch_execz LE_c
v_mad_u32_u16 v148, v212, 1, v7 op_sel:[1,0,0,0]
ds_add_u32 v148, v16
v_cmpx_lt_i32 vcc, 41, v32
v_mad_u32_u16 v149, v213, 1, v7 op_sel:[1,0,0,0]
ds_add_u32 v149, v16
v_cmpx_lt_i32 vcc, 42, v32
v_mad_u32_u16 v150, v214, 1, v7 op_sel:[1,0,0,0]
ds_add_u32 v150, v16
v_cmpx_lt_i32 vcc, 43, v32
v_mad_u32_u16 v151, v215, 1, v7 op_sel:[1,0,0,0]
ds_add_u32 v151, v16
s_waitcnt vmcnt(9)
v_cmpx_lt_i32 vcc, 48, v32
s_cbranch_execz LE_c
v_mad_u32_u16 v152, v216, 1, v7 op_sel:[1,0,0,0]
ds_add_u32 v152, v16
v_cmpx_lt_i32 vcc, 49, v32
v_mad_u32_u16 v153, v217, 1, v7 op_sel:[1,0,0,0]
ds_add_u32 v153, v16
v_cmpx_lt_i32 vcc, 50, v32
v_mad_u32_u16 v154, v218, 1, v7 op_sel:[1,0,0,0]
ds_add_u32 v154, v16
v_cmpx_lt_i32 vcc, 51, v32
v_mad_u32_u16 v155, v219, 1, v7 op_sel:[1,0,0,0]
ds_add_u32 v155, v16
s_waitcnt vmcnt(8)
v_cmpx_lt_i32 vcc, 56, v32
s_cbranch_execz LE_c
v_mad_u32_u16 v156, v220, 1, v7 op_sel:[1,0,0,0]
ds_add_u32 v156, v16
v_cmpx_lt_i32 vcc, 57, v32
v_mad_u32_u16 v157, v221, 1, v7 op_sel:[1,0,0,0]
ds_add_u32 v157, v16
v_cmpx_lt_i32 vcc, 58, v32
v_mad_u32_u16 v158, v222, 1, v7 op_sel:[1,0,0,0]
ds_add_u32 v158, v16
v_cmpx_lt_i32 vcc, 59, v32
v_mad_u32_u16 v159, v223, 1, v7 op_sel:[1,0,0,0]
ds_add_u32 v159, v16
s_waitcnt vmcnt(7)
v_cmpx_lt_i32 vcc, 64, v32
s_cbranch_execz LE_c
v_mad_u32_u16 v160, v224, 1, v7 op_sel:[1,0,0,0]
ds_add_u32 v160, v16
v_cmpx_lt_i32 vcc, 65, v32
v_mad_u32_u16 v161, v225, 1, v7 op_sel:[1,0,0,0]
ds_add_u32 v161, v16
v_cmpx_lt_i32 vcc, 66, v32
v_mad_u32_u16 v162, v226, 1, v7 op_sel:[1,0,0,0]
ds_add_u32 v162, v16
v_cmpx_lt_i32 vcc, 67, v32
v_mad_u32_u16 v163, v227, 1, v7 op_sel:[1,0,0,0]
ds_add_u32 v163, v16
s_waitcnt vmcnt(6)
v_cmpx_lt_i32 vcc, 72, v32
s_cbranch_execz LE_c
v_mad_u32_u16 v164, v228, 1, v7 op_sel:[1,0,0,0]
ds_add_u32 v164, v16
v_cmpx_lt_i32 vcc, 73, v32
v_mad_u32_u16 v165, v229, 1, v7 op_sel:[1,0,0,0]
ds_add_u32 v165, v16
v_cmpx_lt_i32 vcc, 74, v32
v_mad_u32_u16 v166, v230, 1, v7 op_sel:[1,0,0,0]
ds_add_u32 v166, v16
v_cmpx_lt_i32 vcc, 75, v32
v_mad_u32_u16 v167, v231, 1, v7 op_sel:[1,0,0,0]
ds_add_u32 v167, v16
s_waitcnt vmcnt(5)
v_cmpx_lt_i32 vcc, 80, v32
s_cbranch_execz LE_c
v_mad_u32_u16 v168, v232, 1, v7 op_sel:[1,0,0,0]
ds_add_u32 v168, v16
v_cmpx_lt_i32 vcc, 81, v32
v_mad_u32_u16 v169, v233, 1, v7 op_sel:[1,0,0,0]
ds_add_u32 v169, v16
v_cmpx_lt_i32 vcc, 82, v32
v_mad_u32_u16 v170, v234, 1, v7 op_sel:[1,0,0,0]
ds_add_u32 v170, v16
v_cmpx_lt_i32 vcc, 83, v32
v_mad_u32_u16 v171, v235, 1, v7 op_sel:[1,0,0,0]
ds_add_u32 v171, v16
s_waitcnt vmcnt(4)
v_cmpx_lt_i32 vcc, 88, v32
s_cbranch_execz LE_c
v_mad_u32_u16 v172, v236, 1, v7 op_sel:[1,0,0,0]
ds_add_u32 v172, v16
v_cmpx_lt_i32 vcc, 89, v32
v_mad_u32_u16 v173, v237, 1, v7 op_sel:[1,0,0,0]
ds_add_u32 v173, v16
v_cmpx_lt_i32 vcc, 90, v32
v_mad_u32_u16 v174, v238, 1, v7 op_sel:[1,0,0,0]
ds_add_u32 v174, v16
v_cmpx_lt_i32 vcc, 91, v32
v_mad_u32_u16 v175, v239, 1, v7 op_sel:[1,0,0,0]
ds_add_u32 v175, v16
s_waitcnt vmcnt(3)
v_cmpx_lt_i32 vcc, 96, v32
s_cbranch_execz LE_c
v_mad_u32_u16 v176, v240, 1, v7 op_sel:[1,0,0,0]
ds_add_u32 v176, v16
v_cmpx_lt_i32 vcc, 97, v32
v_mad_u32_u16 v177, v241, 1, v7 op_sel:[1,0,0,0]
ds_add_u32 v177, v16
v_cmpx_lt_i32 vcc, 98, v32
v_mad_u32_u16 v178, v242, 1, v7 op_sel:[1,0,0,0]
ds_add_u32 v178, v16
v_cmpx_lt_i32 vcc, 99, v32
v_mad_u32_u16 v179, v243, 1, v7 op_sel:[1,0,0,0]
ds_add_u32 v179, v16
s_waitcnt vmcnt(2)
v_cmpx_lt_i32 vcc, 104, v32
s_cbranch_execz LE_c
v_mad_u32_u16 v180, v244, 1, v7 op_sel:[1,0,0,0]
ds_add_u32 v180, v16
v_cmpx_lt_i32 vcc, 105, v32
v_mad_u32_u16 v181, v245, 1, v7 op_sel:[1,0,0,0]
ds_add_u32 v181, v16
v_cmpx_lt_i32 vcc, 106, v32
v_mad_u32_u16 v182, v246, 1, v7 op_sel:[1,0,0,0]
ds_add_u32 v182, v16
v_cmpx_lt_i32 vcc, 107, v32
v_mad_u32_u16 v183, v247, 1, v7 op_sel:[1,0,0,0]
ds_add_u32 v183, v16
s_waitcnt vmcnt(1)
v_cmpx_lt_i32 vcc, 112, v32
s_cbranch_execz LE_c
v_mad_u32_u16 v184, v248, 1, v7 op_sel:[1,0,0,0]
ds_add_u32 v184, v16
v_cmpx_lt_i32 vcc, 113, v32
v_mad_u32_u16 v185, v249, 1, v7 op_sel:[1,0,0,0]
ds_add_u32 v185, v16
v_cmpx_lt_i32 vcc, 114, v32
v_mad_u32_u16 v186, v250, 1, v7 op_sel:[1,0,0,0]
ds_add_u32 v186, v16
v_cmpx_lt_i32 vcc, 115, v32
v_mad_u32_u16 v187, v251, 1, v7 op_sel:[1,0,0,0]
ds_add_u32 v187, v16
s_waitcnt vmcnt(0)
v_cmpx_lt_i32 vcc, 120, v32
s_cbranch_execz LE_c
v_mad_u32_u16 v188, v252, 1, v7 op_sel:[1,0,0,0]
ds_add_u32 v188, v16
v_cmpx_lt_i32 vcc, 121, v32
v_mad_u32_u16 v189, v253, 1, v7 op_sel:[1,0,0,0]
ds_add_u32 v189, v16
v_cmpx_lt_i32 vcc, 122, v32
v_mad_u32_u16 v190, v254, 1, v7 op_sel:[1,0,0,0]
ds_add_u32 v190, v16
v_cmpx_lt_i32 vcc, 123, v32
v_mad_u32_u16 v191, v255, 1, v7 op_sel:[1,0,0,0]
ds_add_u32 v191, v16
LE_c:
s_mov_b64 exec, -1
ds_read_b128 v[24:27], v35
s_waitcnt lgkmcnt(0)
v_add_u32 v24, 3, v24
v_lshrrev_b32 v24, 2, v24
v_max_u32 v24, v24, v18
v_add_u32 v25, 3, v25
v_lshrrev_b32 v25, 2, v25
v_max_u32 v25, v25, v19
v_add_u32 v26, 3, v26
v_lshrrev_b32 v26, 2, v26
v_max_u32 v26, v26, v20
v_add_u32 v27, 3, v27
v_lshrrev_b32 v27, 2, v27
v_max_u32 v27, v27, v21
v_add_u32 v33, v24, v25
v_add3_u32 v33, v33, v26, v27
v_mov_b32 v64, v33
s_nop 1
v_add_u32_dpp v64, v64, v64 row_shr:1 row_mask:0xf bank_mask:0xf
s_nop 1
v_add_u32_dpp v64, v64, v64 row_shr:2 row_mask:0xf bank_mask:0xf
s_nop 1
v_add_u32_dpp v64, v64, v64 row_shr:4 row_mask:0xf bank_mask:0xf
s_nop 1
v_add_u32_dpp v64, v64, v64 row_shr:8 row_mask:0xf bank_mask:0xf
s_nop 1
v_add_u32_dpp v64, v64, v64 row_bcast:15 row_mask:0xa bank_mask:0xf
s_nop 1
v_add_u32_dpp v64, v64, v64 row_bcast:31 row_mask:0xc bank_mask:0xf
s_nop 1
v_readlane_b32 s44, v64, 63
v_sub_u32 v28, v64, v33
v_add_u32 v29, v28, v24
v_add_u32 v30, v29, v25
v_add_u32 v31, v30, v26
v_add3_u32 v33, v28, v24, -1
v_lshlrev_b32 v34, v33, v18
v_lshrrev_b32 v33, 5, v33
v_lshl_add_u32 v33, v33, 2, v36
ds_or_b32 v33, v34 offset:20480
v_lshl_add_u32 v28, v28, 4, v36
v_add3_u32 v33, v29, v25, -1
v_lshlrev_b32 v34, v33, v19
v_lshrrev_b32 v33, 5, v33
v_lshl_add_u32 v33, v33, 2, v36
ds_or_b32 v33, v34 offset:20480
v_lshl_add_u32 v29, v29, 4, v36
v_add3_u32 v33, v30, v26, -1
v_lshlrev_b32 v34, v33, v20
v_lshrrev_b32 v33, 5, v33
v_lshl_add_u32 v33, v33, 2, v36
ds_or_b32 v33, v34 offset:20480
v_lshl_add_u32 v30, v30, 4, v36
v_add3_u32 v33, v31, v27, -1
v_lshlrev_b32 v34, v33, v21
v_lshrrev_b32 v33, 5, v33
v_lshl_add_u32 v33, v33, 2, v36
ds_or_b32 v33, v34 offset:20480
v_lshl_add_u32 v31, v31, 4, v36
ds_write_b128 v35, v[28:31]
s_add_u32 s44, s44, 31
s_lshr_b32 s44, s44, 5
v_cmpx_lt_i32 vcc, 0, v32
s_cbranch_execz LE_p
ds_add_rtn_u32 v128, v128, v17
v_cmpx_lt_i32 vcc, 1, v32
ds_add_rtn_u32 v129, v129, v17
v_cmpx_lt_i32 vcc, 2, v32
ds_add_rtn_u32 v130, v130, v17
v_cmpx_lt_i32 vcc, 3, v32
ds_add_rtn_u32 v131, v131, v17
v_cmpx_lt_i32 vcc, 8, v32
s_cbranch_execz LE_p
ds_add_rtn_u32 v132, v132, v17
v_cmpx_lt_i32 vcc, 9, v32
ds_add_rtn_u32 v133, v133, v17
v_cmpx_lt_i32 vcc, 10, v32
ds_add_rtn_u32 v134, v134, v17
v_cmpx_lt_i32 vcc, 11, v32
ds_add_rtn_u32 v135, v135, v17
v_cmpx_lt_i32 vcc, 16, v32
s_cbranch_execz LE_p
ds_add_rtn_u32 v136, v136, v17
v_cmpx_lt_i32 vcc, 17, v32
ds_add_rtn_u32 v137, v137, v17
v_cmpx_lt_i32 vcc, 18, v32
ds_add_rtn_u32 v138, v138, v17
v_cmpx_lt_i32 vcc, 19, v32
ds_add_rtn_u32 v139, v139, v17
v_cmpx_lt_i32 vcc, 24, v32
s_cbranch_execz LE_p
ds_add_rtn_u32 v140, v140, v17
v_cmpx_lt_i32 vcc, 25, v32
ds_add_rtn_u32 v141, v141, v17
v_cmpx_lt_i32 vcc, 26, v32
ds_add_rtn_u32 v142, v142, v17
v_cmpx_lt_i32 vcc, 27, v32
ds_add_rtn_u32 v143, v143, v17
v_cmpx_lt_i32 vcc, 32, v32
s_cbranch_execz LE_p
ds_add_rtn_u32 v144, v144, v17
v_cmpx_lt_i32 vcc, 33, v32
ds_add_rtn_u32 v145, v145, v17
v_cmpx_lt_i32 vcc, 34, v32
ds_add_rtn_u32 v146, v146, v17
v_cmpx_lt_i32 vcc, 35, v32
ds_add_rtn_u32 v147, v147, v17
v_cmpx_lt_i32 vcc, 40, v32
s_cbranch_execz LE_p
ds_add_rtn_u32 v148, v148, v17
v_cmpx_lt_i32 vcc, 41, v32
ds_add_rtn_u32 v149, v149, v17
v_cmpx_lt_i32 vcc, 42, v32
ds_add_rtn_u32 v150, v150, v17
v_cmpx_lt_i32 vcc, 43, v32
ds_add_rtn_u32 v151, v151, v17
v_cmpx_lt_i32 vcc, 48, v32
s_cbranch_execz LE_p
ds_add_rtn_u32 v152, v152, v17
v_cmpx_lt_i32 vcc, 49, v32
ds_add_rtn_u32 v153, v153, v17
v_cmpx_lt_i32 vcc, 50, v32
ds_add_rtn_u32 v154, v154, v17
v_cmpx_lt_i32 vcc, 51, v32
ds_add_rtn_u32 v155, v155, v17
v_cmpx_lt_i32 vcc, 56, v32
s_cbranch_execz LE_p
ds_add_rtn_u32 v156, v156, v17
v_cmpx_lt_i32 vcc, 57, v32
ds_add_rtn_u32 v157, v157, v17
v_cmpx_lt_i32 vcc, 58, v32
ds_add_rtn_u32 v158, v158, v17
v_cmpx_lt_i32 vcc, 59, v32
ds_add_rtn_u32 v159, v159, v17
v_cmpx_lt_i32 vcc, 64, v32
s_cbranch_execz LE_p
ds_add_rtn_u32 v160, v160, v17
v_cmpx_lt_i32 vcc, 65, v32
ds_add_rtn_u32 v161, v161, v17
v_cmpx_lt_i32 vcc, 66, v32
ds_add_rtn_u32 v162, v162, v17
v_cmpx_lt_i32 vcc, 67, v32
ds_add_rtn_u32 v163, v163, v17
v_cmpx_lt_i32 vcc, 72, v32
s_cbranch_execz LE_p
ds_add_rtn_u32 v164, v164, v17
v_cmpx_lt_i32 vcc, 73, v32
ds_add_rtn_u32 v165, v165, v17
v_cmpx_lt_i32 vcc, 74, v32
ds_add_rtn_u32 v166, v166, v17
v_cmpx_lt_i32 vcc, 75, v32
ds_add_rtn_u32 v167, v167, v17
v_cmpx_lt_i32 vcc, 80, v32
s_cbranch_execz LE_p
ds_add_rtn_u32 v168, v168, v17
v_cmpx_lt_i32 vcc, 81, v32
ds_add_rtn_u32 v169, v169, v17
v_cmpx_lt_i32 vcc, 82, v32
ds_add_rtn_u32 v170, v170, v17
v_cmpx_lt_i32 vcc, 83, v32
ds_add_rtn_u32 v171, v171, v17
v_cmpx_lt_i32 vcc, 88, v32
s_cbranch_execz LE_p
ds_add_rtn_u32 v172, v172, v17
v_cmpx_lt_i32 vcc, 89, v32
ds_add_rtn_u32 v173, v173, v17
v_cmpx_lt_i32 vcc, 90, v32
ds_add_rtn_u32 v174, v174, v17
v_cmpx_lt_i32 vcc, 91, v32
ds_add_rtn_u32 v175, v175, v17
v_cmpx_lt_i32 vcc, 96, v32
s_cbranch_execz LE_p
ds_add_rtn_u32 v176, v176, v17
v_cmpx_lt_i32 vcc, 97, v32
ds_add_rtn_u32 v177, v177, v17
v_cmpx_lt_i32 vcc, 98, v32
ds_add_rtn_u32 v178, v178, v17
v_cmpx_lt_i32 vcc, 99, v32
ds_add_rtn_u32 v179, v179, v17
v_cmpx_lt_i32 vcc, 104, v32
s_cbranch_execz LE_p
ds_add_rtn_u32 v180, v180, v17
v_cmpx_lt_i32 vcc, 105, v32
ds_add_rtn_u32 v181, v181, v17
v_cmpx_lt_i32 vcc, 106, v32
ds_add_rtn_u32 v182, v182, v17
v_cmpx_lt_i32 vcc, 107, v32
ds_add_rtn_u32 v183, v183, v17
v_cmpx_lt_i32 vcc, 112, v32
s_cbranch_execz LE_p
ds_add_rtn_u32 v184, v184, v17
v_cmpx_lt_i32 vcc, 113, v32
ds_add_rtn_u32 v185, v185, v17
v_cmpx_lt_i32 vcc, 114, v32
ds_add_rtn_u32 v186, v186, v17
v_cmpx_lt_i32 vcc, 115, v32
ds_add_rtn_u32 v187, v187, v17
v_cmpx_lt_i32 vcc, 120, v32
s_cbranch_execz LE_p
ds_add_rtn_u32 v188, v188, v17
v_cmpx_lt_i32 vcc, 121, v32
ds_add_rtn_u32 v189, v189, v17
v_cmpx_lt_i32 vcc, 122, v32
ds_add_rtn_u32 v190, v190, v17
v_cmpx_lt_i32 vcc, 123, v32
ds_add_rtn_u32 v191, v191, v17
LE_p:
s_mov_b64 exec, -1
v_lshl_add_u32 v33, v1, 2, v36
ds_read_b32 v37, v33 offset:20480
s_waitcnt lgkmcnt(0)
v_cmpx_lt_i32 vcc, 0, v32
s_cbranch_execz LE_w
ds_write_b32 v128, v192
v_cmpx_lt_i32 vcc, 1, v32
ds_write_b32 v129, v193
v_cmpx_lt_i32 vcc, 2, v32
ds_write_b32 v130, v194
v_cmpx_lt_i32 vcc, 3, v32
ds_write_b32 v131, v195
v_cmpx_lt_i32 vcc, 8, v32
s_cbranch_execz LE_w
ds_write_b32 v132, v196
v_cmpx_lt_i32 vcc, 9, v32
ds_write_b32 v133, v197
v_cmpx_lt_i32 vcc, 10, v32
ds_write_b32 v134, v198
v_cmpx_lt_i32 vcc, 11, v32
ds_write_b32 v135, v199
v_cmpx_lt_i32 vcc, 16, v32
s_cbranch_execz LE_w
ds_write_b32 v136, v200
v_cmpx_lt_i32 vcc, 17, v32
ds_write_b32 v137, v201
v_cmpx_lt_i32 vcc, 18, v32
ds_write_b32 v138, v202
v_cmpx_lt_i32 vcc, 19, v32
ds_write_b32 v139, v203
v_cmpx_lt_i32 vcc, 24, v32
s_cbranch_execz LE_w
ds_write_b32 v140, v204
v_cmpx_lt_i32 vcc, 25, v32
ds_write_b32 v141, v205
v_cmpx_lt_i32 vcc, 26, v32
ds_write_b32 v142, v206
v_cmpx_lt_i32 vcc, 27, v32
ds_write_b32 v143, v207
v_cmpx_lt_i32 vcc, 32, v32
s_cbranch_execz LE_w
ds_write_b32 v144, v208
v_cmpx_lt_i32 vcc, 33, v32
ds_write_b32 v145, v209
v_cmpx_lt_i32 vcc, 34, v32
ds_write_b32 v146, v210
v_cmpx_lt_i32 vcc, 35, v32
ds_write_b32 v147, v211
v_cmpx_lt_i32 vcc, 40, v32
s_cbranch_execz LE_w
ds_write_b32 v148, v212
v_cmpx_lt_i32 vcc, 41, v32
ds_write_b32 v149, v213
v_cmpx_lt_i32 vcc, 42, v32
ds_write_b32 v150, v214
v_cmpx_lt_i32 vcc, 43, v32
ds_write_b32 v151, v215
v_cmpx_lt_i32 vcc, 48, v32
s_cbranch_execz LE_w
ds_write_b32 v152, v216
v_cmpx_lt_i32 vcc, 49, v32
ds_write_b32 v153, v217
v_cmpx_lt_i32 vcc, 50, v32
ds_write_b32 v154, v218
v_cmpx_lt_i32 vcc, 51, v32
ds_write_b32 v155, v219
v_cmpx_lt_i32 vcc, 56, v32
s_cbranch_execz LE_w
ds_write_b32 v156, v220
v_cmpx_lt_i32 vcc, 57, v32
ds_write_b32 v157, v221
v_cmpx_lt_i32 vcc, 58, v32
ds_write_b32 v158, v222
v_cmpx_lt_i32 vcc, 59, v32
ds_write_b32 v159, v223
v_cmpx_lt_i32 vcc, 64, v32
s_cbranch_execz LE_w
ds_write_b32 v160, v224
v_cmpx_lt_i32 vcc, 65, v32
ds_write_b32 v161, v225
v_cmpx_lt_i32 vcc, 66, v32
ds_write_b32 v162, v226
v_cmpx_lt_i32 vcc, 67, v32
ds_write_b32 v163, v227
v_cmpx_lt_i32 vcc, 72, v32
s_cbranch_execz LE_w
ds_write_b32 v164, v228
v_cmpx_lt_i32 vcc, 73, v32
ds_write_b32 v165, v229
v_cmpx_lt_i32 vcc, 74, v32
ds_write_b32 v166, v230
v_cmpx_lt_i32 vcc, 75, v32
ds_write_b32 v167, v231
v_cmpx_lt_i32 vcc, 80, v32
s_cbranch_execz LE_w
ds_write_b32 v168, v232
v_cmpx_lt_i32 vcc, 81, v32
ds_write_b32 v169, v233
v_cmpx_lt_i32 vcc, 82, v32
ds_write_b32 v170, v234
v_cmpx_lt_i32 vcc, 83, v32
ds_write_b32 v171, v235
v_cmpx_lt_i32 vcc, 88, v32
s_cbranch_execz LE_w
ds_write_b32 v172, v236
v_cmpx_lt_i32 vcc, 89, v32
ds_write_b32 v173, v237
v_cmpx_lt_i32 vcc, 90, v32
ds_write_b32 v174, v238
v_cmpx_lt_i32 vcc, 91, v32
ds_write_b32 v175, v239
v_cmpx_lt_i32 vcc, 96, v32
s_cbranch_execz LE_w
ds_write_b32 v176, v240
v_cmpx_lt_i32 vcc, 97, v32
ds_write_b32 v177, v241
v_cmpx_lt_i32 vcc, 98, v32
ds_write_b32 v178, v242
v_cmpx_lt_i32 vcc, 99, v32
ds_write_b32 v179, v243
v_cmpx_lt_i32 vcc, 104, v32
s_cbranch_execz LE_w
ds_write_b32 v180, v244
v_cmpx_lt_i32 vcc, 105, v32
ds_write_b32 v181, v245
v_cmpx_lt_i32 vcc, 106, v32
ds_write_b32 v182, v246
v_cmpx_lt_i32 vcc, 107, v32
ds_write_b32 v183, v247
v_cmpx_lt_i32 vcc, 112, v32
s_cbranch_execz LE_w
ds_write_b32 v184, v248
v_cmpx_lt_i32 vcc, 113, v32
ds_write_b32 v185, v249
v_cmpx_lt_i32 vcc, 114, v32
ds_write_b32 v186, v250
v_cmpx_lt_i32 vcc, 115, v32
ds_write_b32 v187, v251
v_cmpx_lt_i32 vcc, 120, v32
s_cbranch_execz LE_w
ds_write_b32 v188, v252
v_cmpx_lt_i32 vcc, 121, v32
ds_write_b32 v189, v253
v_cmpx_lt_i32 vcc, 122, v32
ds_write_b32 v190, v254
v_cmpx_lt_i32 vcc, 123, v32
ds_write_b32 v191, v255
LE_w:
s_mov_b64 exec, -1
s_waitcnt vmcnt(0)
s_mov_b32 s51, 0
v_lshlrev_b32 v80, 16, v76
v_lshlrev_b32 v81, 16, v77
v_lshlrev_b32 v82, 16, v78
v_mov_b32 v34, v38
ds_read2_b32 v[52:53], v34 offset0:0 offset1:4
ds_read2_b32 v[54:55], v34 offset0:8 offset1:12
s_waitcnt lgkmcnt(0)
ds_read2_b32 v[56:57], v34 offset0:16 offset1:20
ds_read2_b32 v[58:59], v34 offset0:24 offset1:28
v_mad_u32_u16 v60, v52, s49, v2
v_mad_u32_u16 v61, v53, s49, v2
v_mad_u32_u16 v62, v54, s49, v2
v_mad_u32_u16 v63, v55, s49, v2
buffer_load_dwordx4 a[0:3], v60, s[16:19], 0 offen
buffer_load_dwordx4 a[4:7], v60, s[16:19], 0 offen offset:256
buffer_load_dwordx4 a[8:11], v61, s[16:19], 0 offen
buffer_load_dwordx4 a[12:15], v61, s[16:19], 0 offen offset:256
buffer_load_dwordx4 a[16:19], v62, s[16:19], 0 offen
buffer_load_dwordx4 a[20:23], v62, s[16:19], 0 offen offset:256
buffer_load_dwordx4 a[24:27], v63, s[16:19], 0 offen
buffer_load_dwordx4 a[28:31], v63, s[16:19], 0 offen offset:256
s_waitcnt lgkmcnt(0)
ds_read2_b32 v[52:53], v34 offset0:32 offset1:36
ds_read2_b32 v[54:55], v34 offset0:40 offset1:44
v_mad_u32_u16 v60, v56, s49, v2
v_mad_u32_u16 v61, v57, s49, v2
v_mad_u32_u16 v62, v58, s49, v2
v_mad_u32_u16 v63, v59, s49, v2
buffer_load_dwordx4 a[32:35], v60, s[16:19], 0 offen
buffer_load_dwordx4 a[36:39], v60, s[16:19], 0 offen offset:256
buffer_load_dwordx4 a[40:43], v61, s[16:19], 0 offen
buffer_load_dwordx4 a[44:47], v61, s[16:19], 0 offen offset:256
buffer_load_dwordx4 a[48:51], v62, s[16:19], 0 offen
buffer_load_dwordx4 a[52:55], v62, s[16:19], 0 offen offset:256
buffer_load_dwordx4 a[56:59], v63, s[16:19], 0 offen
buffer_load_dwordx4 a[60:63], v63, s[16:19], 0 offen offset:256
s_waitcnt lgkmcnt(0)
ds_read2_b32 v[56:57], v34 offset0:48 offset1:52
ds_read2_b32 v[58:59], v34 offset0:56 offset1:60
v_mad_u32_u16 v60, v52, s49, v2
v_mad_u32_u16 v61, v53, s49, v2
v_mad_u32_u16 v62, v54, s49, v2
v_mad_u32_u16 v63, v55, s49, v2
buffer_load_dwordx4 a[64:67], v60, s[16:19], 0 offen
buffer_load_dwordx4 a[68:71], v60, s[16:19], 0 offen offset:256
buffer_load_dwordx4 a[72:75], v61, s[16:19], 0 offen
buffer_load_dwordx4 a[76:79], v61, s[16:19], 0 offen offset:256
buffer_load_dwordx4 a[80:83], v62, s[16:19], 0 offen
buffer_load_dwordx4 a[84:87], v62, s[16:19], 0 offen offset:256
buffer_load_dwordx4 a[88:91], v63, s[16:19], 0 offen
buffer_load_dwordx4 a[92:95], v63, s[16:19], 0 offen offset:256
s_waitcnt lgkmcnt(0)
ds_read2_b32 v[52:53], v34 offset0:64 offset1:68
ds_read2_b32 v[54:55], v34 offset0:72 offset1:76
v_mad_u32_u16 v60, v56, s49, v2
v_mad_u32_u16 v61, v57, s49, v2
v_mad_u32_u16 v62, v58, s49, v2
v_mad_u32_u16 v63, v59, s49, v2
buffer_load_dwordx4 a[96:99], v60, s[16:19], 0 offen
buffer_load_dwordx4 a[100:103], v60, s[16:19], 0 offen offset:256
buffer_load_dwordx4 a[104:107], v61, s[16:19], 0 offen
buffer_load_dwordx4 a[108:111], v61, s[16:19], 0 offen offset:256
buffer_load_dwordx4 a[112:115], v62, s[16:19], 0 offen
buffer_load_dwordx4 a[116:119], v62, s[16:19], 0 offen offset:256
buffer_load_dwordx4 a[120:123], v63, s[16:19], 0 offen
buffer_load_dwordx4 a[124:127], v63, s[16:19], 0 offen offset:256
s_waitcnt lgkmcnt(0)
ds_read2_b32 v[56:57], v34 offset0:80 offset1:84
ds_read2_b32 v[58:59], v34 offset0:88 offset1:92
v_mad_u32_u16 v60, v52, s49, v2
v_mad_u32_u16 v61, v53, s49, v2
v_mad_u32_u16 v62, v54, s49, v2
v_mad_u32_u16 v63, v55, s49, v2
buffer_load_dwordx4 a[128:131], v60, s[16:19], 0 offen
buffer_load_dwordx4 a[132:135], v60, s[16:19], 0 offen offset:256
buffer_load_dwordx4 a[136:139], v61, s[16:19], 0 offen
buffer_load_dwordx4 a[140:143], v61, s[16:19], 0 offen offset:256
buffer_load_dwordx4 a[144:147], v62, s[16:19], 0 offen
buffer_load_dwordx4 a[148:151], v62, s[16:19], 0 offen offset:256
buffer_load_dwordx4 a[152:155], v63, s[16:19], 0 offen
buffer_load_dwordx4 a[156:159], v63, s[16:19], 0 offen offset:256
s_waitcnt lgkmcnt(0)
ds_read2_b32 v[52:53], v34 offset0:96 offset1:100
ds_read2_b32 v[54:55], v34 offset0:104 offset1:108
v_mad_u32_u16 v60, v56, s49, v2
v_mad_u32_u16 v61, v57, s49, v2
v_mad_u32_u16 v62, v58, s49, v2
v_mad_u32_u16 v63, v59, s49, v2
buffer_load_dwordx4 a[160:163], v60, s[16:19], 0 offen
buffer_load_dwordx4 a[164:167], v60, s[16:19], 0 offen offset:256
buffer_load_dwordx4 a[168:171], v61, s[16:19], 0 offen
buffer_load_dwordx4 a[172:175], v61, s[16:19], 0 offen offset:256
buffer_load_dwordx4 a[176:179], v62, s[16:19], 0 offen
buffer_load_dwordx4 a[180:183], v62, s[16:19], 0 offen offset:256
buffer_load_dwordx4 a[184:187], v63, s[16:19], 0 offen
buffer_load_dwordx4 a[188:191], v63, s[16:19], 0 offen offset:256
s_waitcnt lgkmcnt(0)
ds_read2_b32 v[56:57], v34 offset0:112 offset1:116
ds_read2_b32 v[58:59], v34 offset0:120 offset1:124
v_mad_u32_u16 v60, v52, s49, v2
v_mad_u32_u16 v61, v53, s49, v2
v_mad_u32_u16 v62, v54, s49, v2
v_mad_u32_u16 v63, v55, s49, v2
buffer_load_dwordx4 a[192:195], v60, s[16:19], 0 offen
buffer_load_dwordx4 a[196:199], v60, s[16:19], 0 offen offset:256
buffer_load_dwordx4 a[200:203], v61, s[16:19], 0 offen
buffer_load_dwordx4 a[204:207], v61, s[16:19], 0 offen offset:256
buffer_load_dwordx4 a[208:211], v62, s[16:19], 0 offen
buffer_load_dwordx4 a[212:215], v62, s[16:19], 0 offen offset:256
buffer_load_dwordx4 a[216:219], v63, s[16:19], 0 offen
buffer_load_dwordx4 a[220:223], v63, s[16:19], 0 offen offset:256
s_waitcnt lgkmcnt(0)
ds_read2_b32 v[52:53], v34 offset0:128 offset1:132
ds_read2_b32 v[54:55], v34 offset0:136 offset1:140
v_mad_u32_u16 v60, v56, s49, v2
v_mad_u32_u16 v61, v57, s49, v2
v_mad_u32_u16 v62, v58, s49, v2
v_mad_u32_u16 v63, v59, s49, v2
buffer_load_dwordx4 a[224:227], v60, s[16:19], 0 offen
buffer_load_dwordx4 a[228:231], v60, s[16:19], 0 offen offset:256
buffer_load_dwordx4 a[232:235], v61, s[16:19], 0 offen
buffer_load_dwordx4 a[236:239], v61, s[16:19], 0 offen offset:256
buffer_load_dwordx4 a[240:243], v62, s[16:19], 0 offen
buffer_load_dwordx4 a[244:247], v62, s[16:19], 0 offen offset:256
buffer_load_dwordx4 a[248:251], v63, s[16:19], 0 offen
buffer_load_dwordx4 a[252:255], v63, s[16:19], 0 offen offset:256
v_add_u32 v34, 512, v34
s_mov_b32 s45, 0
s_mul_i32 s47, s40, 85504
LE_loop:
v_readlane_b32 s46, v37, s45
s_add_u32 s45, s45, 1
s_waitcnt vmcnt(56)
v_mfma_f32_16x16x32_bf16 v[48:51], a[0:3], v[40:43], v[48:51]
v_mfma_f32_16x16x32_bf16 v[48:51], a[4:7], v[44:47], v[48:51]
s_bitcmp1_b32 s46, 0
s_cbranch_scc0 LE_nf0
v_readlane_b32 s57, v80, s51
s_add_u32 s51, s51, 1
s_and_b32 s51, s51, 63
s_cbranch_scc1 LE_dg0
v_mov_b32 v80, v81
v_mov_b32 v81, v82
LE_dg0:
s_nop 3
v_mul_f32 v48, s57, v48
v_mul_f32 v49, s57, v49
v_mul_f32 v50, s57, v50
v_mul_f32 v51, s57, v51
s_cmp_eq_u32 s42, 0
s_cbranch_scc1 LE_fl0
buffer_load_dwordx2 v[66:67], v39, s[20:23], s47 offen sc1
s_waitcnt vmcnt(0)
v_lshlrev_b32 v64, 16, v66
v_and_b32 v65, 0xffff0000, v66
v_add_f32 v48, v48, v64
v_add_f32 v49, v49, v65
v_lshlrev_b32 v64, 16, v67
v_and_b32 v65, 0xffff0000, v67
v_add_f32 v50, v50, v64
v_add_f32 v51, v51, v65
LE_fl0:
v_cvt_pk_bf16_f32 v64, v48, v49
v_cvt_pk_bf16_f32 v65, v50, v51
v_mov_b32 v48, 0
v_mov_b32 v49, 0
v_mov_b32 v50, 0
v_mov_b32 v51, 0
buffer_store_dwordx2 v[64:65], v39, s[20:23], s47 offen sc1
s_add_u32 s47, s47, 512
LE_nf0:
v_mfma_f32_16x16x32_bf16 v[48:51], a[8:11], v[40:43], v[48:51]
v_mfma_f32_16x16x32_bf16 v[48:51], a[12:15], v[44:47], v[48:51]
s_bitcmp1_b32 s46, 1
s_cbranch_scc0 LE_nf1
v_readlane_b32 s57, v80, s51
s_add_u32 s51, s51, 1
s_and_b32 s51, s51, 63
s_cbranch_scc1 LE_dg1
v_mov_b32 v80, v81
v_mov_b32 v81, v82
LE_dg1:
s_nop 3
v_mul_f32 v48, s57, v48
v_mul_f32 v49, s57, v49
v_mul_f32 v50, s57, v50
v_mul_f32 v51, s57, v51
s_cmp_eq_u32 s42, 0
s_cbranch_scc1 LE_fl1
buffer_load_dwordx2 v[66:67], v39, s[20:23], s47 offen sc1
s_waitcnt vmcnt(0)
v_lshlrev_b32 v64, 16, v66
v_and_b32 v65, 0xffff0000, v66
v_add_f32 v48, v48, v64
v_add_f32 v49, v49, v65
v_lshlrev_b32 v64, 16, v67
v_and_b32 v65, 0xffff0000, v67
v_add_f32 v50, v50, v64
v_add_f32 v51, v51, v65
LE_fl1:
v_cvt_pk_bf16_f32 v64, v48, v49
v_cvt_pk_bf16_f32 v65, v50, v51
v_mov_b32 v48, 0
v_mov_b32 v49, 0
v_mov_b32 v50, 0
v_mov_b32 v51, 0
buffer_store_dwordx2 v[64:65], v39, s[20:23], s47 offen sc1
s_add_u32 s47, s47, 512
LE_nf1:
v_mfma_f32_16x16x32_bf16 v[48:51], a[16:19], v[40:43], v[48:51]
v_mfma_f32_16x16x32_bf16 v[48:51], a[20:23], v[44:47], v[48:51]
s_bitcmp1_b32 s46, 2
s_cbranch_scc0 LE_nf2
v_readlane_b32 s57, v80, s51
s_add_u32 s51, s51, 1
s_and_b32 s51, s51, 63
s_cbranch_scc1 LE_dg2
v_mov_b32 v80, v81
v_mov_b32 v81, v82
LE_dg2:
s_nop 3
v_mul_f32 v48, s57, v48
v_mul_f32 v49, s57, v49
v_mul_f32 v50, s57, v50
v_mul_f32 v51, s57, v51
s_cmp_eq_u32 s42, 0
s_cbranch_scc1 LE_fl2
buffer_load_dwordx2 v[66:67], v39, s[20:23], s47 offen sc1
s_waitcnt vmcnt(0)
v_lshlrev_b32 v64, 16, v66
v_and_b32 v65, 0xffff0000, v66
v_add_f32 v48, v48, v64
v_add_f32 v49, v49, v65
v_lshlrev_b32 v64, 16, v67
v_and_b32 v65, 0xffff0000, v67
v_add_f32 v50, v50, v64
v_add_f32 v51, v51, v65
LE_fl2:
v_cvt_pk_bf16_f32 v64, v48, v49
v_cvt_pk_bf16_f32 v65, v50, v51
v_mov_b32 v48, 0
v_mov_b32 v49, 0
v_mov_b32 v50, 0
v_mov_b32 v51, 0
buffer_store_dwordx2 v[64:65], v39, s[20:23], s47 offen sc1
s_add_u32 s47, s47, 512
LE_nf2:
v_mfma_f32_16x16x32_bf16 v[48:51], a[24:27], v[40:43], v[48:51]
v_mfma_f32_16x16x32_bf16 v[48:51], a[28:31], v[44:47], v[48:51]
s_bitcmp1_b32 s46, 3
s_cbranch_scc0 LE_nf3
v_readlane_b32 s57, v80, s51
s_add_u32 s51, s51, 1
s_and_b32 s51, s51, 63
s_cbranch_scc1 LE_dg3
v_mov_b32 v80, v81
v_mov_b32 v81, v82
LE_dg3:
s_nop 3
v_mul_f32 v48, s57, v48
v_mul_f32 v49, s57, v49
v_mul_f32 v50, s57, v50
v_mul_f32 v51, s57, v51
s_cmp_eq_u32 s42, 0
s_cbranch_scc1 LE_fl3
buffer_load_dwordx2 v[66:67], v39, s[20:23], s47 offen sc1
s_waitcnt vmcnt(0)
v_lshlrev_b32 v64, 16, v66
v_and_b32 v65, 0xffff0000, v66
v_add_f32 v48, v48, v64
v_add_f32 v49, v49, v65
v_lshlrev_b32 v64, 16, v67
v_and_b32 v65, 0xffff0000, v67
v_add_f32 v50, v50, v64
v_add_f32 v51, v51, v65
LE_fl3:
v_cvt_pk_bf16_f32 v64, v48, v49
v_cvt_pk_bf16_f32 v65, v50, v51
v_mov_b32 v48, 0
v_mov_b32 v49, 0
v_mov_b32 v50, 0
v_mov_b32 v51, 0
buffer_store_dwordx2 v[64:65], v39, s[20:23], s47 offen sc1
s_add_u32 s47, s47, 512
LE_nf3:
s_waitcnt lgkmcnt(0)
ds_read2_b32 v[56:57], v34 offset0:16 offset1:20
ds_read2_b32 v[58:59], v34 offset0:24 offset1:28
v_mad_u32_u16 v60, v52, s49, v2
v_mad_u32_u16 v61, v53, s49, v2
v_mad_u32_u16 v62, v54, s49, v2
v_mad_u32_u16 v63, v55, s49, v2
buffer_load_dwordx4 a[0:3], v60, s[16:19], 0 offen
buffer_load_dwordx4 a[4:7], v60, s[16:19], 0 offen offset:256
buffer_load_dwordx4 a[8:11], v61, s[16:19], 0 offen
buffer_load_dwordx4 a[12:15], v61, s[16:19], 0 offen offset:256
buffer_load_dwordx4 a[16:19], v62, s[16:19], 0 offen
buffer_load_dwordx4 a[20:23], v62, s[16:19], 0 offen offset:256
buffer_load_dwordx4 a[24:27], v63, s[16:19], 0 offen
buffer_load_dwordx4 a[28:31], v63, s[16:19], 0 offen offset:256
s_waitcnt vmcnt(56)
v_mfma_f32_16x16x32_bf16 v[48:51], a[32:35], v[40:43], v[48:51]
v_mfma_f32_16x16x32_bf16 v[48:51], a[36:39], v[44:47], v[48:51]
s_bitcmp1_b32 s46, 4
s_cbranch_scc0 LE_nf4
v_readlane_b32 s57, v80, s51
s_add_u32 s51, s51, 1
s_and_b32 s51, s51, 63
s_cbranch_scc1 LE_dg4
v_mov_b32 v80, v81
v_mov_b32 v81, v82
LE_dg4:
s_nop 3
v_mul_f32 v48, s57, v48
v_mul_f32 v49, s57, v49
v_mul_f32 v50, s57, v50
v_mul_f32 v51, s57, v51
s_cmp_eq_u32 s42, 0
s_cbranch_scc1 LE_fl4
buffer_load_dwordx2 v[66:67], v39, s[20:23], s47 offen sc1
s_waitcnt vmcnt(0)
v_lshlrev_b32 v64, 16, v66
v_and_b32 v65, 0xffff0000, v66
v_add_f32 v48, v48, v64
v_add_f32 v49, v49, v65
v_lshlrev_b32 v64, 16, v67
v_and_b32 v65, 0xffff0000, v67
v_add_f32 v50, v50, v64
v_add_f32 v51, v51, v65
LE_fl4:
v_cvt_pk_bf16_f32 v64, v48, v49
v_cvt_pk_bf16_f32 v65, v50, v51
v_mov_b32 v48, 0
v_mov_b32 v49, 0
v_mov_b32 v50, 0
v_mov_b32 v51, 0
buffer_store_dwordx2 v[64:65], v39, s[20:23], s47 offen sc1
s_add_u32 s47, s47, 512
LE_nf4:
v_mfma_f32_16x16x32_bf16 v[48:51], a[40:43], v[40:43], v[48:51]
v_mfma_f32_16x16x32_bf16 v[48:51], a[44:47], v[44:47], v[48:51]
s_bitcmp1_b32 s46, 5
s_cbranch_scc0 LE_nf5
v_readlane_b32 s57, v80, s51
s_add_u32 s51, s51, 1
s_and_b32 s51, s51, 63
s_cbranch_scc1 LE_dg5
v_mov_b32 v80, v81
v_mov_b32 v81, v82
LE_dg5:
s_nop 3
v_mul_f32 v48, s57, v48
v_mul_f32 v49, s57, v49
v_mul_f32 v50, s57, v50
v_mul_f32 v51, s57, v51
s_cmp_eq_u32 s42, 0
s_cbranch_scc1 LE_fl5
buffer_load_dwordx2 v[66:67], v39, s[20:23], s47 offen sc1
s_waitcnt vmcnt(0)
v_lshlrev_b32 v64, 16, v66
v_and_b32 v65, 0xffff0000, v66
v_add_f32 v48, v48, v64
v_add_f32 v49, v49, v65
v_lshlrev_b32 v64, 16, v67
v_and_b32 v65, 0xffff0000, v67
v_add_f32 v50, v50, v64
v_add_f32 v51, v51, v65
LE_fl5:
v_cvt_pk_bf16_f32 v64, v48, v49
v_cvt_pk_bf16_f32 v65, v50, v51
v_mov_b32 v48, 0
v_mov_b32 v49, 0
v_mov_b32 v50, 0
v_mov_b32 v51, 0
buffer_store_dwordx2 v[64:65], v39, s[20:23], s47 offen sc1
s_add_u32 s47, s47, 512
LE_nf5:
v_mfma_f32_16x16x32_bf16 v[48:51], a[48:51], v[40:43], v[48:51]
v_mfma_f32_16x16x32_bf16 v[48:51], a[52:55], v[44:47], v[48:51]
s_bitcmp1_b32 s46, 6
s_cbranch_scc0 LE_nf6
v_readlane_b32 s57, v80, s51
s_add_u32 s51, s51, 1
s_and_b32 s51, s51, 63
s_cbranch_scc1 LE_dg6
v_mov_b32 v80, v81
v_mov_b32 v81, v82
LE_dg6:
s_nop 3
v_mul_f32 v48, s57, v48
v_mul_f32 v49, s57, v49
v_mul_f32 v50, s57, v50
v_mul_f32 v51, s57, v51
s_cmp_eq_u32 s42, 0
s_cbranch_scc1 LE_fl6
buffer_load_dwordx2 v[66:67], v39, s[20:23], s47 offen sc1
s_waitcnt vmcnt(0)
v_lshlrev_b32 v64, 16, v66
v_and_b32 v65, 0xffff0000, v66
v_add_f32 v48, v48, v64
v_add_f32 v49, v49, v65
v_lshlrev_b32 v64, 16, v67
v_and_b32 v65, 0xffff0000, v67
v_add_f32 v50, v50, v64
v_add_f32 v51, v51, v65
LE_fl6:
v_cvt_pk_bf16_f32 v64, v48, v49
v_cvt_pk_bf16_f32 v65, v50, v51
v_mov_b32 v48, 0
v_mov_b32 v49, 0
v_mov_b32 v50, 0
v_mov_b32 v51, 0
buffer_store_dwordx2 v[64:65], v39, s[20:23], s47 offen sc1
s_add_u32 s47, s47, 512
LE_nf6:
v_mfma_f32_16x16x32_bf16 v[48:51], a[56:59], v[40:43], v[48:51]
v_mfma_f32_16x16x32_bf16 v[48:51], a[60:63], v[44:47], v[48:51]
s_bitcmp1_b32 s46, 7
s_cbranch_scc0 LE_nf7
v_readlane_b32 s57, v80, s51
s_add_u32 s51, s51, 1
s_and_b32 s51, s51, 63
s_cbranch_scc1 LE_dg7
v_mov_b32 v80, v81
v_mov_b32 v81, v82
LE_dg7:
s_nop 3
v_mul_f32 v48, s57, v48
v_mul_f32 v49, s57, v49
v_mul_f32 v50, s57, v50
v_mul_f32 v51, s57, v51
s_cmp_eq_u32 s42, 0
s_cbranch_scc1 LE_fl7
buffer_load_dwordx2 v[66:67], v39, s[20:23], s47 offen sc1
s_waitcnt vmcnt(0)
v_lshlrev_b32 v64, 16, v66
v_and_b32 v65, 0xffff0000, v66
v_add_f32 v48, v48, v64
v_add_f32 v49, v49, v65
v_lshlrev_b32 v64, 16, v67
v_and_b32 v65, 0xffff0000, v67
v_add_f32 v50, v50, v64
v_add_f32 v51, v51, v65
LE_fl7:
v_cvt_pk_bf16_f32 v64, v48, v49
v_cvt_pk_bf16_f32 v65, v50, v51
v_mov_b32 v48, 0
v_mov_b32 v49, 0
v_mov_b32 v50, 0
v_mov_b32 v51, 0
buffer_store_dwordx2 v[64:65], v39, s[20:23], s47 offen sc1
s_add_u32 s47, s47, 512
LE_nf7:
s_waitcnt lgkmcnt(0)
ds_read2_b32 v[52:53], v34 offset0:32 offset1:36
ds_read2_b32 v[54:55], v34 offset0:40 offset1:44
v_mad_u32_u16 v60, v56, s49, v2
v_mad_u32_u16 v61, v57, s49, v2
v_mad_u32_u16 v62, v58, s49, v2
v_mad_u32_u16 v63, v59, s49, v2
buffer_load_dwordx4 a[32:35], v60, s[16:19], 0 offen
buffer_load_dwordx4 a[36:39], v60, s[16:19], 0 offen offset:256
buffer_load_dwordx4 a[40:43], v61, s[16:19], 0 offen
buffer_load_dwordx4 a[44:47], v61, s[16:19], 0 offen offset:256
buffer_load_dwordx4 a[48:51], v62, s[16:19], 0 offen
buffer_load_dwordx4 a[52:55], v62, s[16:19], 0 offen offset:256
buffer_load_dwordx4 a[56:59], v63, s[16:19], 0 offen
buffer_load_dwordx4 a[60:63], v63, s[16:19], 0 offen offset:256
s_waitcnt vmcnt(56)
v_mfma_f32_16x16x32_bf16 v[48:51], a[64:67], v[40:43], v[48:51]
v_mfma_f32_16x16x32_bf16 v[48:51], a[68:71], v[44:47], v[48:51]
s_bitcmp1_b32 s46, 8
s_cbranch_scc0 LE_nf8
v_readlane_b32 s57, v80, s51
s_add_u32 s51, s51, 1
s_and_b32 s51, s51, 63
s_cbranch_scc1 LE_dg8
v_mov_b32 v80, v81
v_mov_b32 v81, v82
LE_dg8:
s_nop 3
v_mul_f32 v48, s57, v48
v_mul_f32 v49, s57, v49
v_mul_f32 v50, s57, v50
v_mul_f32 v51, s57, v51
s_cmp_eq_u32 s42, 0
s_cbranch_scc1 LE_fl8
buffer_load_dwordx2 v[66:67], v39, s[20:23], s47 offen sc1
s_waitcnt vmcnt(0)
v_lshlrev_b32 v64, 16, v66
v_and_b32 v65, 0xffff0000, v66
v_add_f32 v48, v48, v64
v_add_f32 v49, v49, v65
v_lshlrev_b32 v64, 16, v67
v_and_b32 v65, 0xffff0000, v67
v_add_f32 v50, v50, v64
v_add_f32 v51, v51, v65
LE_fl8:
v_cvt_pk_bf16_f32 v64, v48, v49
v_cvt_pk_bf16_f32 v65, v50, v51
v_mov_b32 v48, 0
v_mov_b32 v49, 0
v_mov_b32 v50, 0
v_mov_b32 v51, 0
buffer_store_dwordx2 v[64:65], v39, s[20:23], s47 offen sc1
s_add_u32 s47, s47, 512
LE_nf8:
v_mfma_f32_16x16x32_bf16 v[48:51], a[72:75], v[40:43], v[48:51]
v_mfma_f32_16x16x32_bf16 v[48:51], a[76:79], v[44:47], v[48:51]
s_bitcmp1_b32 s46, 9
s_cbranch_scc0 LE_nf9
v_readlane_b32 s57, v80, s51
s_add_u32 s51, s51, 1
s_and_b32 s51, s51, 63
s_cbranch_scc1 LE_dg9
v_mov_b32 v80, v81
v_mov_b32 v81, v82
LE_dg9:
s_nop 3
v_mul_f32 v48, s57, v48
v_mul_f32 v49, s57, v49
v_mul_f32 v50, s57, v50
v_mul_f32 v51, s57, v51
s_cmp_eq_u32 s42, 0
s_cbranch_scc1 LE_fl9
buffer_load_dwordx2 v[66:67], v39, s[20:23], s47 offen sc1
s_waitcnt vmcnt(0)
v_lshlrev_b32 v64, 16, v66
v_and_b32 v65, 0xffff0000, v66
v_add_f32 v48, v48, v64
v_add_f32 v49, v49, v65
v_lshlrev_b32 v64, 16, v67
v_and_b32 v65, 0xffff0000, v67
v_add_f32 v50, v50, v64
v_add_f32 v51, v51, v65
LE_fl9:
v_cvt_pk_bf16_f32 v64, v48, v49
v_cvt_pk_bf16_f32 v65, v50, v51
v_mov_b32 v48, 0
v_mov_b32 v49, 0
v_mov_b32 v50, 0
v_mov_b32 v51, 0
buffer_store_dwordx2 v[64:65], v39, s[20:23], s47 offen sc1
s_add_u32 s47, s47, 512
LE_nf9:
v_mfma_f32_16x16x32_bf16 v[48:51], a[80:83], v[40:43], v[48:51]
v_mfma_f32_16x16x32_bf16 v[48:51], a[84:87], v[44:47], v[48:51]
s_bitcmp1_b32 s46, 10
s_cbranch_scc0 LE_nf10
v_readlane_b32 s57, v80, s51
s_add_u32 s51, s51, 1
s_and_b32 s51, s51, 63
s_cbranch_scc1 LE_dg10
v_mov_b32 v80, v81
v_mov_b32 v81, v82
LE_dg10:
s_nop 3
v_mul_f32 v48, s57, v48
v_mul_f32 v49, s57, v49
v_mul_f32 v50, s57, v50
v_mul_f32 v51, s57, v51
s_cmp_eq_u32 s42, 0
s_cbranch_scc1 LE_fl10
buffer_load_dwordx2 v[66:67], v39, s[20:23], s47 offen sc1
s_waitcnt vmcnt(0)
v_lshlrev_b32 v64, 16, v66
v_and_b32 v65, 0xffff0000, v66
v_add_f32 v48, v48, v64
v_add_f32 v49, v49, v65
v_lshlrev_b32 v64, 16, v67
v_and_b32 v65, 0xffff0000, v67
v_add_f32 v50, v50, v64
v_add_f32 v51, v51, v65
LE_fl10:
v_cvt_pk_bf16_f32 v64, v48, v49
v_cvt_pk_bf16_f32 v65, v50, v51
v_mov_b32 v48, 0
v_mov_b32 v49, 0
v_mov_b32 v50, 0
v_mov_b32 v51, 0
buffer_store_dwordx2 v[64:65], v39, s[20:23], s47 offen sc1
s_add_u32 s47, s47, 512
LE_nf10:
v_mfma_f32_16x16x32_bf16 v[48:51], a[88:91], v[40:43], v[48:51]
v_mfma_f32_16x16x32_bf16 v[48:51], a[92:95], v[44:47], v[48:51]
s_bitcmp1_b32 s46, 11
s_cbranch_scc0 LE_nf11
v_readlane_b32 s57, v80, s51
s_add_u32 s51, s51, 1
s_and_b32 s51, s51, 63
s_cbranch_scc1 LE_dg11
v_mov_b32 v80, v81
v_mov_b32 v81, v82
LE_dg11:
s_nop 3
v_mul_f32 v48, s57, v48
v_mul_f32 v49, s57, v49
v_mul_f32 v50, s57, v50
v_mul_f32 v51, s57, v51
s_cmp_eq_u32 s42, 0
s_cbranch_scc1 LE_fl11
buffer_load_dwordx2 v[66:67], v39, s[20:23], s47 offen sc1
s_waitcnt vmcnt(0)
v_lshlrev_b32 v64, 16, v66
v_and_b32 v65, 0xffff0000, v66
v_add_f32 v48, v48, v64
v_add_f32 v49, v49, v65
v_lshlrev_b32 v64, 16, v67
v_and_b32 v65, 0xffff0000, v67
v_add_f32 v50, v50, v64
v_add_f32 v51, v51, v65
LE_fl11:
v_cvt_pk_bf16_f32 v64, v48, v49
v_cvt_pk_bf16_f32 v65, v50, v51
v_mov_b32 v48, 0
v_mov_b32 v49, 0
v_mov_b32 v50, 0
v_mov_b32 v51, 0
buffer_store_dwordx2 v[64:65], v39, s[20:23], s47 offen sc1
s_add_u32 s47, s47, 512
LE_nf11:
s_waitcnt lgkmcnt(0)
ds_read2_b32 v[56:57], v34 offset0:48 offset1:52
ds_read2_b32 v[58:59], v34 offset0:56 offset1:60
v_mad_u32_u16 v60, v52, s49, v2
v_mad_u32_u16 v61, v53, s49, v2
v_mad_u32_u16 v62, v54, s49, v2
v_mad_u32_u16 v63, v55, s49, v2
buffer_load_dwordx4 a[64:67], v60, s[16:19], 0 offen
buffer_load_dwordx4 a[68:71], v60, s[16:19], 0 offen offset:256
buffer_load_dwordx4 a[72:75], v61, s[16:19], 0 offen
buffer_load_dwordx4 a[76:79], v61, s[16:19], 0 offen offset:256
buffer_load_dwordx4 a[80:83], v62, s[16:19], 0 offen
buffer_load_dwordx4 a[84:87], v62, s[16:19], 0 offen offset:256
buffer_load_dwordx4 a[88:91], v63, s[16:19], 0 offen
buffer_load_dwordx4 a[92:95], v63, s[16:19], 0 offen offset:256
s_waitcnt vmcnt(56)
v_mfma_f32_16x16x32_bf16 v[48:51], a[96:99], v[40:43], v[48:51]
v_mfma_f32_16x16x32_bf16 v[48:51], a[100:103], v[44:47], v[48:51]
s_bitcmp1_b32 s46, 12
s_cbranch_scc0 LE_nf12
v_readlane_b32 s57, v80, s51
s_add_u32 s51, s51, 1
s_and_b32 s51, s51, 63
s_cbranch_scc1 LE_dg12
v_mov_b32 v80, v81
v_mov_b32 v81, v82
LE_dg12:
s_nop 3
v_mul_f32 v48, s57, v48
v_mul_f32 v49, s57, v49
v_mul_f32 v50, s57, v50
v_mul_f32 v51, s57, v51
s_cmp_eq_u32 s42, 0
s_cbranch_scc1 LE_fl12
buffer_load_dwordx2 v[66:67], v39, s[20:23], s47 offen sc1
s_waitcnt vmcnt(0)
v_lshlrev_b32 v64, 16, v66
v_and_b32 v65, 0xffff0000, v66
v_add_f32 v48, v48, v64
v_add_f32 v49, v49, v65
v_lshlrev_b32 v64, 16, v67
v_and_b32 v65, 0xffff0000, v67
v_add_f32 v50, v50, v64
v_add_f32 v51, v51, v65
LE_fl12:
v_cvt_pk_bf16_f32 v64, v48, v49
v_cvt_pk_bf16_f32 v65, v50, v51
v_mov_b32 v48, 0
v_mov_b32 v49, 0
v_mov_b32 v50, 0
v_mov_b32 v51, 0
buffer_store_dwordx2 v[64:65], v39, s[20:23], s47 offen sc1
s_add_u32 s47, s47, 512
LE_nf12:
v_mfma_f32_16x16x32_bf16 v[48:51], a[104:107], v[40:43], v[48:51]
v_mfma_f32_16x16x32_bf16 v[48:51], a[108:111], v[44:47], v[48:51]
s_bitcmp1_b32 s46, 13
s_cbranch_scc0 LE_nf13
v_readlane_b32 s57, v80, s51
s_add_u32 s51, s51, 1
s_and_b32 s51, s51, 63
s_cbranch_scc1 LE_dg13
v_mov_b32 v80, v81
v_mov_b32 v81, v82
LE_dg13:
s_nop 3
v_mul_f32 v48, s57, v48
v_mul_f32 v49, s57, v49
v_mul_f32 v50, s57, v50
v_mul_f32 v51, s57, v51
s_cmp_eq_u32 s42, 0
s_cbranch_scc1 LE_fl13
buffer_load_dwordx2 v[66:67], v39, s[20:23], s47 offen sc1
s_waitcnt vmcnt(0)
v_lshlrev_b32 v64, 16, v66
v_and_b32 v65, 0xffff0000, v66
v_add_f32 v48, v48, v64
v_add_f32 v49, v49, v65
v_lshlrev_b32 v64, 16, v67
v_and_b32 v65, 0xffff0000, v67
v_add_f32 v50, v50, v64
v_add_f32 v51, v51, v65
LE_fl13:
v_cvt_pk_bf16_f32 v64, v48, v49
v_cvt_pk_bf16_f32 v65, v50, v51
v_mov_b32 v48, 0
v_mov_b32 v49, 0
v_mov_b32 v50, 0
v_mov_b32 v51, 0
buffer_store_dwordx2 v[64:65], v39, s[20:23], s47 offen sc1
s_add_u32 s47, s47, 512
LE_nf13:
v_mfma_f32_16x16x32_bf16 v[48:51], a[112:115], v[40:43], v[48:51]
v_mfma_f32_16x16x32_bf16 v[48:51], a[116:119], v[44:47], v[48:51]
s_bitcmp1_b32 s46, 14
s_cbranch_scc0 LE_nf14
v_readlane_b32 s57, v80, s51
s_add_u32 s51, s51, 1
s_and_b32 s51, s51, 63
s_cbranch_scc1 LE_dg14
v_mov_b32 v80, v81
v_mov_b32 v81, v82
LE_dg14:
s_nop 3
v_mul_f32 v48, s57, v48
v_mul_f32 v49, s57, v49
v_mul_f32 v50, s57, v50
v_mul_f32 v51, s57, v51
s_cmp_eq_u32 s42, 0
s_cbranch_scc1 LE_fl14
buffer_load_dwordx2 v[66:67], v39, s[20:23], s47 offen sc1
s_waitcnt vmcnt(0)
v_lshlrev_b32 v64, 16, v66
v_and_b32 v65, 0xffff0000, v66
v_add_f32 v48, v48, v64
v_add_f32 v49, v49, v65
v_lshlrev_b32 v64, 16, v67
v_and_b32 v65, 0xffff0000, v67
v_add_f32 v50, v50, v64
v_add_f32 v51, v51, v65
LE_fl14:
v_cvt_pk_bf16_f32 v64, v48, v49
v_cvt_pk_bf16_f32 v65, v50, v51
v_mov_b32 v48, 0
v_mov_b32 v49, 0
v_mov_b32 v50, 0
v_mov_b32 v51, 0
buffer_store_dwordx2 v[64:65], v39, s[20:23], s47 offen sc1
s_add_u32 s47, s47, 512
LE_nf14:
v_mfma_f32_16x16x32_bf16 v[48:51], a[120:123], v[40:43], v[48:51]
v_mfma_f32_16x16x32_bf16 v[48:51], a[124:127], v[44:47], v[48:51]
s_bitcmp1_b32 s46, 15
s_cbranch_scc0 LE_nf15
v_readlane_b32 s57, v80, s51
s_add_u32 s51, s51, 1
s_and_b32 s51, s51, 63
s_cbranch_scc1 LE_dg15
v_mov_b32 v80, v81
v_mov_b32 v81, v82
LE_dg15:
s_nop 3
v_mul_f32 v48, s57, v48
v_mul_f32 v49, s57, v49
v_mul_f32 v50, s57, v50
v_mul_f32 v51, s57, v51
s_cmp_eq_u32 s42, 0
s_cbranch_scc1 LE_fl15
buffer_load_dwordx2 v[66:67], v39, s[20:23], s47 offen sc1
s_waitcnt vmcnt(0)
v_lshlrev_b32 v64, 16, v66
v_and_b32 v65, 0xffff0000, v66
v_add_f32 v48, v48, v64
v_add_f32 v49, v49, v65
v_lshlrev_b32 v64, 16, v67
v_and_b32 v65, 0xffff0000, v67
v_add_f32 v50, v50, v64
v_add_f32 v51, v51, v65
LE_fl15:
v_cvt_pk_bf16_f32 v64, v48, v49
v_cvt_pk_bf16_f32 v65, v50, v51
v_mov_b32 v48, 0
v_mov_b32 v49, 0
v_mov_b32 v50, 0
v_mov_b32 v51, 0
buffer_store_dwordx2 v[64:65], v39, s[20:23], s47 offen sc1
s_add_u32 s47, s47, 512
LE_nf15:
s_waitcnt lgkmcnt(0)
ds_read2_b32 v[52:53], v34 offset0:64 offset1:68
ds_read2_b32 v[54:55], v34 offset0:72 offset1:76
v_mad_u32_u16 v60, v56, s49, v2
v_mad_u32_u16 v61, v57, s49, v2
v_mad_u32_u16 v62, v58, s49, v2
v_mad_u32_u16 v63, v59, s49, v2
buffer_load_dwordx4 a[96:99], v60, s[16:19], 0 offen
buffer_load_dwordx4 a[100:103], v60, s[16:19], 0 offen offset:256
buffer_load_dwordx4 a[104:107], v61, s[16:19], 0 offen
buffer_load_dwordx4 a[108:111], v61, s[16:19], 0 offen offset:256
buffer_load_dwordx4 a[112:115], v62, s[16:19], 0 offen
buffer_load_dwordx4 a[116:119], v62, s[16:19], 0 offen offset:256
buffer_load_dwordx4 a[120:123], v63, s[16:19], 0 offen
buffer_load_dwordx4 a[124:127], v63, s[16:19], 0 offen offset:256
s_waitcnt vmcnt(56)
v_mfma_f32_16x16x32_bf16 v[48:51], a[128:131], v[40:43], v[48:51]
v_mfma_f32_16x16x32_bf16 v[48:51], a[132:135], v[44:47], v[48:51]
s_bitcmp1_b32 s46, 16
s_cbranch_scc0 LE_nf16
v_readlane_b32 s57, v80, s51
s_add_u32 s51, s51, 1
s_and_b32 s51, s51, 63
s_cbranch_scc1 LE_dg16
v_mov_b32 v80, v81
v_mov_b32 v81, v82
LE_dg16:
s_nop 3
v_mul_f32 v48, s57, v48
v_mul_f32 v49, s57, v49
v_mul_f32 v50, s57, v50
v_mul_f32 v51, s57, v51
s_cmp_eq_u32 s42, 0
s_cbranch_scc1 LE_fl16
buffer_load_dwordx2 v[66:67], v39, s[20:23], s47 offen sc1
s_waitcnt vmcnt(0)
v_lshlrev_b32 v64, 16, v66
v_and_b32 v65, 0xffff0000, v66
v_add_f32 v48, v48, v64
v_add_f32 v49, v49, v65
v_lshlrev_b32 v64, 16, v67
v_and_b32 v65, 0xffff0000, v67
v_add_f32 v50, v50, v64
v_add_f32 v51, v51, v65
LE_fl16:
v_cvt_pk_bf16_f32 v64, v48, v49
v_cvt_pk_bf16_f32 v65, v50, v51
v_mov_b32 v48, 0
v_mov_b32 v49, 0
v_mov_b32 v50, 0
v_mov_b32 v51, 0
buffer_store_dwordx2 v[64:65], v39, s[20:23], s47 offen sc1
s_add_u32 s47, s47, 512
LE_nf16:
v_mfma_f32_16x16x32_bf16 v[48:51], a[136:139], v[40:43], v[48:51]
v_mfma_f32_16x16x32_bf16 v[48:51], a[140:143], v[44:47], v[48:51]
s_bitcmp1_b32 s46, 17
s_cbranch_scc0 LE_nf17
v_readlane_b32 s57, v80, s51
s_add_u32 s51, s51, 1
s_and_b32 s51, s51, 63
s_cbranch_scc1 LE_dg17
v_mov_b32 v80, v81
v_mov_b32 v81, v82
LE_dg17:
s_nop 3
v_mul_f32 v48, s57, v48
v_mul_f32 v49, s57, v49
v_mul_f32 v50, s57, v50
v_mul_f32 v51, s57, v51
s_cmp_eq_u32 s42, 0
s_cbranch_scc1 LE_fl17
buffer_load_dwordx2 v[66:67], v39, s[20:23], s47 offen sc1
s_waitcnt vmcnt(0)
v_lshlrev_b32 v64, 16, v66
v_and_b32 v65, 0xffff0000, v66
v_add_f32 v48, v48, v64
v_add_f32 v49, v49, v65
v_lshlrev_b32 v64, 16, v67
v_and_b32 v65, 0xffff0000, v67
v_add_f32 v50, v50, v64
v_add_f32 v51, v51, v65
LE_fl17:
v_cvt_pk_bf16_f32 v64, v48, v49
v_cvt_pk_bf16_f32 v65, v50, v51
v_mov_b32 v48, 0
v_mov_b32 v49, 0
v_mov_b32 v50, 0
v_mov_b32 v51, 0
buffer_store_dwordx2 v[64:65], v39, s[20:23], s47 offen sc1
s_add_u32 s47, s47, 512
LE_nf17:
v_mfma_f32_16x16x32_bf16 v[48:51], a[144:147], v[40:43], v[48:51]
v_mfma_f32_16x16x32_bf16 v[48:51], a[148:151], v[44:47], v[48:51]
s_bitcmp1_b32 s46, 18
s_cbranch_scc0 LE_nf18
v_readlane_b32 s57, v80, s51
s_add_u32 s51, s51, 1
s_and_b32 s51, s51, 63
s_cbranch_scc1 LE_dg18
v_mov_b32 v80, v81
v_mov_b32 v81, v82
LE_dg18:
s_nop 3
v_mul_f32 v48, s57, v48
v_mul_f32 v49, s57, v49
v_mul_f32 v50, s57, v50
v_mul_f32 v51, s57, v51
s_cmp_eq_u32 s42, 0
s_cbranch_scc1 LE_fl18
buffer_load_dwordx2 v[66:67], v39, s[20:23], s47 offen sc1
s_waitcnt vmcnt(0)
v_lshlrev_b32 v64, 16, v66
v_and_b32 v65, 0xffff0000, v66
v_add_f32 v48, v48, v64
v_add_f32 v49, v49, v65
v_lshlrev_b32 v64, 16, v67
v_and_b32 v65, 0xffff0000, v67
v_add_f32 v50, v50, v64
v_add_f32 v51, v51, v65
LE_fl18:
v_cvt_pk_bf16_f32 v64, v48, v49
v_cvt_pk_bf16_f32 v65, v50, v51
v_mov_b32 v48, 0
v_mov_b32 v49, 0
v_mov_b32 v50, 0
v_mov_b32 v51, 0
buffer_store_dwordx2 v[64:65], v39, s[20:23], s47 offen sc1
s_add_u32 s47, s47, 512
LE_nf18:
v_mfma_f32_16x16x32_bf16 v[48:51], a[152:155], v[40:43], v[48:51]
v_mfma_f32_16x16x32_bf16 v[48:51], a[156:159], v[44:47], v[48:51]
s_bitcmp1_b32 s46, 19
s_cbranch_scc0 LE_nf19
v_readlane_b32 s57, v80, s51
s_add_u32 s51, s51, 1
s_and_b32 s51, s51, 63
s_cbranch_scc1 LE_dg19
v_mov_b32 v80, v81
v_mov_b32 v81, v82
LE_dg19:
s_nop 3
v_mul_f32 v48, s57, v48
v_mul_f32 v49, s57, v49
v_mul_f32 v50, s57, v50
v_mul_f32 v51, s57, v51
s_cmp_eq_u32 s42, 0
s_cbranch_scc1 LE_fl19
buffer_load_dwordx2 v[66:67], v39, s[20:23], s47 offen sc1
s_waitcnt vmcnt(0)
v_lshlrev_b32 v64, 16, v66
v_and_b32 v65, 0xffff0000, v66
v_add_f32 v48, v48, v64
v_add_f32 v49, v49, v65
v_lshlrev_b32 v64, 16, v67
v_and_b32 v65, 0xffff0000, v67
v_add_f32 v50, v50, v64
v_add_f32 v51, v51, v65
LE_fl19:
v_cvt_pk_bf16_f32 v64, v48, v49
v_cvt_pk_bf16_f32 v65, v50, v51
v_mov_b32 v48, 0
v_mov_b32 v49, 0
v_mov_b32 v50, 0
v_mov_b32 v51, 0
buffer_store_dwordx2 v[64:65], v39, s[20:23], s47 offen sc1
s_add_u32 s47, s47, 512
LE_nf19:
s_waitcnt lgkmcnt(0)
ds_read2_b32 v[56:57], v34 offset0:80 offset1:84
ds_read2_b32 v[58:59], v34 offset0:88 offset1:92
v_mad_u32_u16 v60, v52, s49, v2
v_mad_u32_u16 v61, v53, s49, v2
v_mad_u32_u16 v62, v54, s49, v2
v_mad_u32_u16 v63, v55, s49, v2
buffer_load_dwordx4 a[128:131], v60, s[16:19], 0 offen
buffer_load_dwordx4 a[132:135], v60, s[16:19], 0 offen offset:256
buffer_load_dwordx4 a[136:139], v61, s[16:19], 0 offen
buffer_load_dwordx4 a[140:143], v61, s[16:19], 0 offen offset:256
buffer_load_dwordx4 a[144:147], v62, s[16:19], 0 offen
buffer_load_dwordx4 a[148:151], v62, s[16:19], 0 offen offset:256
buffer_load_dwordx4 a[152:155], v63, s[16:19], 0 offen
buffer_load_dwordx4 a[156:159], v63, s[16:19], 0 offen offset:256
s_waitcnt vmcnt(56)
v_mfma_f32_16x16x32_bf16 v[48:51], a[160:163], v[40:43], v[48:51]
v_mfma_f32_16x16x32_bf16 v[48:51], a[164:167], v[44:47], v[48:51]
s_bitcmp1_b32 s46, 20
s_cbranch_scc0 LE_nf20
v_readlane_b32 s57, v80, s51
s_add_u32 s51, s51, 1
s_and_b32 s51, s51, 63
s_cbranch_scc1 LE_dg20
v_mov_b32 v80, v81
v_mov_b32 v81, v82
LE_dg20:
s_nop 3
v_mul_f32 v48, s57, v48
v_mul_f32 v49, s57, v49
v_mul_f32 v50, s57, v50
v_mul_f32 v51, s57, v51
s_cmp_eq_u32 s42, 0
s_cbranch_scc1 LE_fl20
buffer_load_dwordx2 v[66:67], v39, s[20:23], s47 offen sc1
s_waitcnt vmcnt(0)
v_lshlrev_b32 v64, 16, v66
v_and_b32 v65, 0xffff0000, v66
v_add_f32 v48, v48, v64
v_add_f32 v49, v49, v65
v_lshlrev_b32 v64, 16, v67
v_and_b32 v65, 0xffff0000, v67
v_add_f32 v50, v50, v64
v_add_f32 v51, v51, v65
LE_fl20:
v_cvt_pk_bf16_f32 v64, v48, v49
v_cvt_pk_bf16_f32 v65, v50, v51
v_mov_b32 v48, 0
v_mov_b32 v49, 0
v_mov_b32 v50, 0
v_mov_b32 v51, 0
buffer_store_dwordx2 v[64:65], v39, s[20:23], s47 offen sc1
s_add_u32 s47, s47, 512
LE_nf20:
v_mfma_f32_16x16x32_bf16 v[48:51], a[168:171], v[40:43], v[48:51]
v_mfma_f32_16x16x32_bf16 v[48:51], a[172:175], v[44:47], v[48:51]
s_bitcmp1_b32 s46, 21
s_cbranch_scc0 LE_nf21
v_readlane_b32 s57, v80, s51
s_add_u32 s51, s51, 1
s_and_b32 s51, s51, 63
s_cbranch_scc1 LE_dg21
v_mov_b32 v80, v81
v_mov_b32 v81, v82
LE_dg21:
s_nop 3
v_mul_f32 v48, s57, v48
v_mul_f32 v49, s57, v49
v_mul_f32 v50, s57, v50
v_mul_f32 v51, s57, v51
s_cmp_eq_u32 s42, 0
s_cbranch_scc1 LE_fl21
buffer_load_dwordx2 v[66:67], v39, s[20:23], s47 offen sc1
s_waitcnt vmcnt(0)
v_lshlrev_b32 v64, 16, v66
v_and_b32 v65, 0xffff0000, v66
v_add_f32 v48, v48, v64
v_add_f32 v49, v49, v65
v_lshlrev_b32 v64, 16, v67
v_and_b32 v65, 0xffff0000, v67
v_add_f32 v50, v50, v64
v_add_f32 v51, v51, v65
LE_fl21:
v_cvt_pk_bf16_f32 v64, v48, v49
v_cvt_pk_bf16_f32 v65, v50, v51
v_mov_b32 v48, 0
v_mov_b32 v49, 0
v_mov_b32 v50, 0
v_mov_b32 v51, 0
buffer_store_dwordx2 v[64:65], v39, s[20:23], s47 offen sc1
s_add_u32 s47, s47, 512
LE_nf21:
v_mfma_f32_16x16x32_bf16 v[48:51], a[176:179], v[40:43], v[48:51]
v_mfma_f32_16x16x32_bf16 v[48:51], a[180:183], v[44:47], v[48:51]
s_bitcmp1_b32 s46, 22
s_cbranch_scc0 LE_nf22
v_readlane_b32 s57, v80, s51
s_add_u32 s51, s51, 1
s_and_b32 s51, s51, 63
s_cbranch_scc1 LE_dg22
v_mov_b32 v80, v81
v_mov_b32 v81, v82
LE_dg22:
s_nop 3
v_mul_f32 v48, s57, v48
v_mul_f32 v49, s57, v49
v_mul_f32 v50, s57, v50
v_mul_f32 v51, s57, v51
s_cmp_eq_u32 s42, 0
s_cbranch_scc1 LE_fl22
buffer_load_dwordx2 v[66:67], v39, s[20:23], s47 offen sc1
s_waitcnt vmcnt(0)
v_lshlrev_b32 v64, 16, v66
v_and_b32 v65, 0xffff0000, v66
v_add_f32 v48, v48, v64
v_add_f32 v49, v49, v65
v_lshlrev_b32 v64, 16, v67
v_and_b32 v65, 0xffff0000, v67
v_add_f32 v50, v50, v64
v_add_f32 v51, v51, v65
LE_fl22:
v_cvt_pk_bf16_f32 v64, v48, v49
v_cvt_pk_bf16_f32 v65, v50, v51
v_mov_b32 v48, 0
v_mov_b32 v49, 0
v_mov_b32 v50, 0
v_mov_b32 v51, 0
buffer_store_dwordx2 v[64:65], v39, s[20:23], s47 offen sc1
s_add_u32 s47, s47, 512
LE_nf22:
v_mfma_f32_16x16x32_bf16 v[48:51], a[184:187], v[40:43], v[48:51]
v_mfma_f32_16x16x32_bf16 v[48:51], a[188:191], v[44:47], v[48:51]
s_bitcmp1_b32 s46, 23
s_cbranch_scc0 LE_nf23
v_readlane_b32 s57, v80, s51
s_add_u32 s51, s51, 1
s_and_b32 s51, s51, 63
s_cbranch_scc1 LE_dg23
v_mov_b32 v80, v81
v_mov_b32 v81, v82
LE_dg23:
s_nop 3
v_mul_f32 v48, s57, v48
v_mul_f32 v49, s57, v49
v_mul_f32 v50, s57, v50
v_mul_f32 v51, s57, v51
s_cmp_eq_u32 s42, 0
s_cbranch_scc1 LE_fl23
buffer_load_dwordx2 v[66:67], v39, s[20:23], s47 offen sc1
s_waitcnt vmcnt(0)
v_lshlrev_b32 v64, 16, v66
v_and_b32 v65, 0xffff0000, v66
v_add_f32 v48, v48, v64
v_add_f32 v49, v49, v65
v_lshlrev_b32 v64, 16, v67
v_and_b32 v65, 0xffff0000, v67
v_add_f32 v50, v50, v64
v_add_f32 v51, v51, v65
LE_fl23:
v_cvt_pk_bf16_f32 v64, v48, v49
v_cvt_pk_bf16_f32 v65, v50, v51
v_mov_b32 v48, 0
v_mov_b32 v49, 0
v_mov_b32 v50, 0
v_mov_b32 v51, 0
buffer_store_dwordx2 v[64:65], v39, s[20:23], s47 offen sc1
s_add_u32 s47, s47, 512
LE_nf23:
s_waitcnt lgkmcnt(0)
ds_read2_b32 v[52:53], v34 offset0:96 offset1:100
ds_read2_b32 v[54:55], v34 offset0:104 offset1:108
v_mad_u32_u16 v60, v56, s49, v2
v_mad_u32_u16 v61, v57, s49, v2
v_mad_u32_u16 v62, v58, s49, v2
v_mad_u32_u16 v63, v59, s49, v2
buffer_load_dwordx4 a[160:163], v60, s[16:19], 0 offen
buffer_load_dwordx4 a[164:167], v60, s[16:19], 0 offen offset:256
buffer_load_dwordx4 a[168:171], v61, s[16:19], 0 offen
buffer_load_dwordx4 a[172:175], v61, s[16:19], 0 offen offset:256
buffer_load_dwordx4 a[176:179], v62, s[16:19], 0 offen
buffer_load_dwordx4 a[180:183], v62, s[16:19], 0 offen offset:256
buffer_load_dwordx4 a[184:187], v63, s[16:19], 0 offen
buffer_load_dwordx4 a[188:191], v63, s[16:19], 0 offen offset:256
s_waitcnt vmcnt(56)
v_mfma_f32_16x16x32_bf16 v[48:51], a[192:195], v[40:43], v[48:51]
v_mfma_f32_16x16x32_bf16 v[48:51], a[196:199], v[44:47], v[48:51]
s_bitcmp1_b32 s46, 24
s_cbranch_scc0 LE_nf24
v_readlane_b32 s57, v80, s51
s_add_u32 s51, s51, 1
s_and_b32 s51, s51, 63
s_cbranch_scc1 LE_dg24
v_mov_b32 v80, v81
v_mov_b32 v81, v82
LE_dg24:
s_nop 3
v_mul_f32 v48, s57, v48
v_mul_f32 v49, s57, v49
v_mul_f32 v50, s57, v50
v_mul_f32 v51, s57, v51
s_cmp_eq_u32 s42, 0
s_cbranch_scc1 LE_fl24
buffer_load_dwordx2 v[66:67], v39, s[20:23], s47 offen sc1
s_waitcnt vmcnt(0)
v_lshlrev_b32 v64, 16, v66
v_and_b32 v65, 0xffff0000, v66
v_add_f32 v48, v48, v64
v_add_f32 v49, v49, v65
v_lshlrev_b32 v64, 16, v67
v_and_b32 v65, 0xffff0000, v67
v_add_f32 v50, v50, v64
v_add_f32 v51, v51, v65
LE_fl24:
v_cvt_pk_bf16_f32 v64, v48, v49
v_cvt_pk_bf16_f32 v65, v50, v51
v_mov_b32 v48, 0
v_mov_b32 v49, 0
v_mov_b32 v50, 0
v_mov_b32 v51, 0
buffer_store_dwordx2 v[64:65], v39, s[20:23], s47 offen sc1
s_add_u32 s47, s47, 512
LE_nf24:
v_mfma_f32_16x16x32_bf16 v[48:51], a[200:203], v[40:43], v[48:51]
v_mfma_f32_16x16x32_bf16 v[48:51], a[204:207], v[44:47], v[48:51]
s_bitcmp1_b32 s46, 25
s_cbranch_scc0 LE_nf25
v_readlane_b32 s57, v80, s51
s_add_u32 s51, s51, 1
s_and_b32 s51, s51, 63
s_cbranch_scc1 LE_dg25
v_mov_b32 v80, v81
v_mov_b32 v81, v82
LE_dg25:
s_nop 3
v_mul_f32 v48, s57, v48
v_mul_f32 v49, s57, v49
v_mul_f32 v50, s57, v50
v_mul_f32 v51, s57, v51
s_cmp_eq_u32 s42, 0
s_cbranch_scc1 LE_fl25
buffer_load_dwordx2 v[66:67], v39, s[20:23], s47 offen sc1
s_waitcnt vmcnt(0)
v_lshlrev_b32 v64, 16, v66
v_and_b32 v65, 0xffff0000, v66
v_add_f32 v48, v48, v64
v_add_f32 v49, v49, v65
v_lshlrev_b32 v64, 16, v67
v_and_b32 v65, 0xffff0000, v67
v_add_f32 v50, v50, v64
v_add_f32 v51, v51, v65
LE_fl25:
v_cvt_pk_bf16_f32 v64, v48, v49
v_cvt_pk_bf16_f32 v65, v50, v51
v_mov_b32 v48, 0
v_mov_b32 v49, 0
v_mov_b32 v50, 0
v_mov_b32 v51, 0
buffer_store_dwordx2 v[64:65], v39, s[20:23], s47 offen sc1
s_add_u32 s47, s47, 512
LE_nf25:
v_mfma_f32_16x16x32_bf16 v[48:51], a[208:211], v[40:43], v[48:51]
v_mfma_f32_16x16x32_bf16 v[48:51], a[212:215], v[44:47], v[48:51]
s_bitcmp1_b32 s46, 26
s_cbranch_scc0 LE_nf26
v_readlane_b32 s57, v80, s51
s_add_u32 s51, s51, 1
s_and_b32 s51, s51, 63
s_cbranch_scc1 LE_dg26
v_mov_b32 v80, v81
v_mov_b32 v81, v82
LE_dg26:
s_nop 3
v_mul_f32 v48, s57, v48
v_mul_f32 v49, s57, v49
v_mul_f32 v50, s57, v50
v_mul_f32 v51, s57, v51
s_cmp_eq_u32 s42, 0
s_cbranch_scc1 LE_fl26
buffer_load_dwordx2 v[66:67], v39, s[20:23], s47 offen sc1
s_waitcnt vmcnt(0)
v_lshlrev_b32 v64, 16, v66
v_and_b32 v65, 0xffff0000, v66
v_add_f32 v48, v48, v64
v_add_f32 v49, v49, v65
v_lshlrev_b32 v64, 16, v67
v_and_b32 v65, 0xffff0000, v67
v_add_f32 v50, v50, v64
v_add_f32 v51, v51, v65
LE_fl26:
v_cvt_pk_bf16_f32 v64, v48, v49
v_cvt_pk_bf16_f32 v65, v50, v51
v_mov_b32 v48, 0
v_mov_b32 v49, 0
v_mov_b32 v50, 0
v_mov_b32 v51, 0
buffer_store_dwordx2 v[64:65], v39, s[20:23], s47 offen sc1
s_add_u32 s47, s47, 512
LE_nf26:
v_mfma_f32_16x16x32_bf16 v[48:51], a[216:219], v[40:43], v[48:51]
v_mfma_f32_16x16x32_bf16 v[48:51], a[220:223], v[44:47], v[48:51]
s_bitcmp1_b32 s46, 27
s_cbranch_scc0 LE_nf27
v_readlane_b32 s57, v80, s51
s_add_u32 s51, s51, 1
s_and_b32 s51, s51, 63
s_cbranch_scc1 LE_dg27
v_mov_b32 v80, v81
v_mov_b32 v81, v82
LE_dg27:
s_nop 3
v_mul_f32 v48, s57, v48
v_mul_f32 v49, s57, v49
v_mul_f32 v50, s57, v50
v_mul_f32 v51, s57, v51
s_cmp_eq_u32 s42, 0
s_cbranch_scc1 LE_fl27
buffer_load_dwordx2 v[66:67], v39, s[20:23], s47 offen sc1
s_waitcnt vmcnt(0)
v_lshlrev_b32 v64, 16, v66
v_and_b32 v65, 0xffff0000, v66
v_add_f32 v48, v48, v64
v_add_f32 v49, v49, v65
v_lshlrev_b32 v64, 16, v67
v_and_b32 v65, 0xffff0000, v67
v_add_f32 v50, v50, v64
v_add_f32 v51, v51, v65
LE_fl27:
v_cvt_pk_bf16_f32 v64, v48, v49
v_cvt_pk_bf16_f32 v65, v50, v51
v_mov_b32 v48, 0
v_mov_b32 v49, 0
v_mov_b32 v50, 0
v_mov_b32 v51, 0
buffer_store_dwordx2 v[64:65], v39, s[20:23], s47 offen sc1
s_add_u32 s47, s47, 512
LE_nf27:
s_waitcnt lgkmcnt(0)
ds_read2_b32 v[56:57], v34 offset0:112 offset1:116
ds_read2_b32 v[58:59], v34 offset0:120 offset1:124
v_mad_u32_u16 v60, v52, s49, v2
v_mad_u32_u16 v61, v53, s49, v2
v_mad_u32_u16 v62, v54, s49, v2
v_mad_u32_u16 v63, v55, s49, v2
buffer_load_dwordx4 a[192:195], v60, s[16:19], 0 offen
buffer_load_dwordx4 a[196:199], v60, s[16:19], 0 offen offset:256
buffer_load_dwordx4 a[200:203], v61, s[16:19], 0 offen
buffer_load_dwordx4 a[204:207], v61, s[16:19], 0 offen offset:256
buffer_load_dwordx4 a[208:211], v62, s[16:19], 0 offen
buffer_load_dwordx4 a[212:215], v62, s[16:19], 0 offen offset:256
buffer_load_dwordx4 a[216:219], v63, s[16:19], 0 offen
buffer_load_dwordx4 a[220:223], v63, s[16:19], 0 offen offset:256
s_waitcnt vmcnt(56)
v_mfma_f32_16x16x32_bf16 v[48:51], a[224:227], v[40:43], v[48:51]
v_mfma_f32_16x16x32_bf16 v[48:51], a[228:231], v[44:47], v[48:51]
s_bitcmp1_b32 s46, 28
s_cbranch_scc0 LE_nf28
v_readlane_b32 s57, v80, s51
s_add_u32 s51, s51, 1
s_and_b32 s51, s51, 63
s_cbranch_scc1 LE_dg28
v_mov_b32 v80, v81
v_mov_b32 v81, v82
LE_dg28:
s_nop 3
v_mul_f32 v48, s57, v48
v_mul_f32 v49, s57, v49
v_mul_f32 v50, s57, v50
v_mul_f32 v51, s57, v51
s_cmp_eq_u32 s42, 0
s_cbranch_scc1 LE_fl28
buffer_load_dwordx2 v[66:67], v39, s[20:23], s47 offen sc1
s_waitcnt vmcnt(0)
v_lshlrev_b32 v64, 16, v66
v_and_b32 v65, 0xffff0000, v66
v_add_f32 v48, v48, v64
v_add_f32 v49, v49, v65
v_lshlrev_b32 v64, 16, v67
v_and_b32 v65, 0xffff0000, v67
v_add_f32 v50, v50, v64
v_add_f32 v51, v51, v65
LE_fl28:
v_cvt_pk_bf16_f32 v64, v48, v49
v_cvt_pk_bf16_f32 v65, v50, v51
v_mov_b32 v48, 0
v_mov_b32 v49, 0
v_mov_b32 v50, 0
v_mov_b32 v51, 0
buffer_store_dwordx2 v[64:65], v39, s[20:23], s47 offen sc1
s_add_u32 s47, s47, 512
LE_nf28:
v_mfma_f32_16x16x32_bf16 v[48:51], a[232:235], v[40:43], v[48:51]
v_mfma_f32_16x16x32_bf16 v[48:51], a[236:239], v[44:47], v[48:51]
s_bitcmp1_b32 s46, 29
s_cbranch_scc0 LE_nf29
v_readlane_b32 s57, v80, s51
s_add_u32 s51, s51, 1
s_and_b32 s51, s51, 63
s_cbranch_scc1 LE_dg29
v_mov_b32 v80, v81
v_mov_b32 v81, v82
LE_dg29:
s_nop 3
v_mul_f32 v48, s57, v48
v_mul_f32 v49, s57, v49
v_mul_f32 v50, s57, v50
v_mul_f32 v51, s57, v51
s_cmp_eq_u32 s42, 0
s_cbranch_scc1 LE_fl29
buffer_load_dwordx2 v[66:67], v39, s[20:23], s47 offen sc1
s_waitcnt vmcnt(0)
v_lshlrev_b32 v64, 16, v66
v_and_b32 v65, 0xffff0000, v66
v_add_f32 v48, v48, v64
v_add_f32 v49, v49, v65
v_lshlrev_b32 v64, 16, v67
v_and_b32 v65, 0xffff0000, v67
v_add_f32 v50, v50, v64
v_add_f32 v51, v51, v65
LE_fl29:
v_cvt_pk_bf16_f32 v64, v48, v49
v_cvt_pk_bf16_f32 v65, v50, v51
v_mov_b32 v48, 0
v_mov_b32 v49, 0
v_mov_b32 v50, 0
v_mov_b32 v51, 0
buffer_store_dwordx2 v[64:65], v39, s[20:23], s47 offen sc1
s_add_u32 s47, s47, 512
LE_nf29:
v_mfma_f32_16x16x32_bf16 v[48:51], a[240:243], v[40:43], v[48:51]
v_mfma_f32_16x16x32_bf16 v[48:51], a[244:247], v[44:47], v[48:51]
s_bitcmp1_b32 s46, 30
s_cbranch_scc0 LE_nf30
v_readlane_b32 s57, v80, s51
s_add_u32 s51, s51, 1
s_and_b32 s51, s51, 63
s_cbranch_scc1 LE_dg30
v_mov_b32 v80, v81
v_mov_b32 v81, v82
LE_dg30:
s_nop 3
v_mul_f32 v48, s57, v48
v_mul_f32 v49, s57, v49
v_mul_f32 v50, s57, v50
v_mul_f32 v51, s57, v51
s_cmp_eq_u32 s42, 0
s_cbranch_scc1 LE_fl30
buffer_load_dwordx2 v[66:67], v39, s[20:23], s47 offen sc1
s_waitcnt vmcnt(0)
v_lshlrev_b32 v64, 16, v66
v_and_b32 v65, 0xffff0000, v66
v_add_f32 v48, v48, v64
v_add_f32 v49, v49, v65
v_lshlrev_b32 v64, 16, v67
v_and_b32 v65, 0xffff0000, v67
v_add_f32 v50, v50, v64
v_add_f32 v51, v51, v65
LE_fl30:
v_cvt_pk_bf16_f32 v64, v48, v49
v_cvt_pk_bf16_f32 v65, v50, v51
v_mov_b32 v48, 0
v_mov_b32 v49, 0
v_mov_b32 v50, 0
v_mov_b32 v51, 0
buffer_store_dwordx2 v[64:65], v39, s[20:23], s47 offen sc1
s_add_u32 s47, s47, 512
LE_nf30:
v_mfma_f32_16x16x32_bf16 v[48:51], a[248:251], v[40:43], v[48:51]
v_mfma_f32_16x16x32_bf16 v[48:51], a[252:255], v[44:47], v[48:51]
s_bitcmp1_b32 s46, 31
s_cbranch_scc0 LE_nf31
v_readlane_b32 s57, v80, s51
s_add_u32 s51, s51, 1
s_and_b32 s51, s51, 63
s_cbranch_scc1 LE_dg31
v_mov_b32 v80, v81
v_mov_b32 v81, v82
LE_dg31:
s_nop 3
v_mul_f32 v48, s57, v48
v_mul_f32 v49, s57, v49
v_mul_f32 v50, s57, v50
v_mul_f32 v51, s57, v51
s_cmp_eq_u32 s42, 0
s_cbranch_scc1 LE_fl31
buffer_load_dwordx2 v[66:67], v39, s[20:23], s47 offen sc1
s_waitcnt vmcnt(0)
v_lshlrev_b32 v64, 16, v66
v_and_b32 v65, 0xffff0000, v66
v_add_f32 v48, v48, v64
v_add_f32 v49, v49, v65
v_lshlrev_b32 v64, 16, v67
v_and_b32 v65, 0xffff0000, v67
v_add_f32 v50, v50, v64
v_add_f32 v51, v51, v65
LE_fl31:
v_cvt_pk_bf16_f32 v64, v48, v49
v_cvt_pk_bf16_f32 v65, v50, v51
v_mov_b32 v48, 0
v_mov_b32 v49, 0
v_mov_b32 v50, 0
v_mov_b32 v51, 0
buffer_store_dwordx2 v[64:65], v39, s[20:23], s47 offen sc1
s_add_u32 s47, s47, 512
LE_nf31:
s_waitcnt lgkmcnt(0)
ds_read2_b32 v[52:53], v34 offset0:128 offset1:132
ds_read2_b32 v[54:55], v34 offset0:136 offset1:140
v_mad_u32_u16 v60, v56, s49, v2
v_mad_u32_u16 v61, v57, s49, v2
v_mad_u32_u16 v62, v58, s49, v2
v_mad_u32_u16 v63, v59, s49, v2
buffer_load_dwordx4 a[224:227], v60, s[16:19], 0 offen
buffer_load_dwordx4 a[228:231], v60, s[16:19], 0 offen offset:256
buffer_load_dwordx4 a[232:235], v61, s[16:19], 0 offen
buffer_load_dwordx4 a[236:239], v61, s[16:19], 0 offen offset:256
buffer_load_dwordx4 a[240:243], v62, s[16:19], 0 offen
buffer_load_dwordx4 a[244:247], v62, s[16:19], 0 offen offset:256
buffer_load_dwordx4 a[248:251], v63, s[16:19], 0 offen
buffer_load_dwordx4 a[252:255], v63, s[16:19], 0 offen offset:256
v_add_u32 v34, 512, v34
s_cmp_lt_u32 s45, s44
s_cbranch_scc1 LE_loop
s_add_u32 s42, s42, 1
s_mul_i32 s43, s42, 128
v_cmp_lt_u32 vcc, s43, v4
s_cbranch_vccz LE_done
s_cmp_ge_u32 s42, 40
s_cbranch_scc1 LE_done
s_waitcnt vmcnt(0) lgkmcnt(0)
s_add_u32 s50, s50, 512
v_add_u32 v5, 0x80, v5
buffer_load_dwordx4 v[192:195], v6, s[12:15], s50 offen offset:0
buffer_load_dwordx4 v[196:199], v6, s[12:15], s50 offen offset:32
buffer_load_dwordx4 v[200:203], v6, s[12:15], s50 offen offset:64
buffer_load_dwordx4 v[204:207], v6, s[12:15], s50 offen offset:96
buffer_load_dwordx4 v[208:211], v6, s[12:15], s50 offen offset:128
buffer_load_dwordx4 v[212:215], v6, s[12:15], s50 offen offset:160
buffer_load_dwordx4 v[216:219], v6, s[12:15], s50 offen offset:192
buffer_load_dwordx4 v[220:223], v6, s[12:15], s50 offen offset:224
buffer_load_dwordx4 v[224:227], v6, s[12:15], s50 offen offset:256
buffer_load_dwordx4 v[228:231], v6, s[12:15], s50 offen offset:288
buffer_load_dwordx4 v[232:235], v6, s[12:15], s50 offen offset:320
buffer_load_dwordx4 v[236:239], v6, s[12:15], s50 offen offset:352
buffer_load_dwordx4 v[240:243], v6, s[12:15], s50 offen offset:384
buffer_load_dwordx4 v[244:247], v6, s[12:15], s50 offen offset:416
buffer_load_dwordx4 v[248:251], v6, s[12:15], s50 offen offset:448
buffer_load_dwordx4 v[252:255], v6, s[12:15], s50 offen offset:480
s_branch LE_pass
LE_done:
s_add_u32 s52, s4, 0x7c00000
s_addc_u32 s53, s5, 0
s_mov_b32 s54, 0x2000
s_mov_b32 s55, 0x00020000
v_mov_b32 v20, 5120
v_mov_b32 v21, 1
s_mov_b64 exec, 1
s_waitcnt vmcnt(0)
buffer_atomic_add v21, v20, s[52:55], 0 offen
s_mov_b64 exec, -1
s_getpc_b64 s[52:53]
LE_pc:
s_sub_u32 s52, s52, LE_pc-L2_tails
s_subb_u32 s53, s53, 0
s_mov_b32 s54, LT_disp-L2_tails
s_mov_b32 s55, 0x00020000
s_mov_b64 exec, -1
v_lshlrev_b32 v30, 7, v1
s_mov_b32 s56, 0x0
buffer_load_dword v32, v30, s[52:55], s56 offen
s_mov_b32 s56, 0x2000
buffer_load_dword v33, v30, s[52:55], s56 offen
s_mov_b32 s56, 0x4000
buffer_load_dword v34, v30, s[52:55], s56 offen
s_mov_b32 s56, 0x6000
buffer_load_dword v35, v30, s[52:55], s56 offen
s_mov_b32 s56, 0x8000
buffer_load_dword v36, v30, s[52:55], s56 offen
s_mov_b32 s56, 0xa000
buffer_load_dword v37, v30, s[52:55], s56 offen
s_mov_b32 s56, 0xc000
buffer_load_dword v38, v30, s[52:55], s56 offen
s_cmp_ge_u32 s2, 240
s_cbranch_scc1 LC_help
s_branch L2_end
LC_help:
s_waitcnt vmcnt(0)
s_mov_b32 s100, 0
s_load_dwordx2 s[6:7], s[0:1], 0
s_load_dwordx2 s[18:19], s[0:1], 72
s_mov_b32 s34, s41
v_mbcnt_lo_u32_b32 v252, -1, 0
v_mbcnt_hi_u32_b32 v252, -1, v252
v_lshlrev_b32 v252, 4, v252
s_and_b32 s32, s2, 7
s_mul_i32 s32, s32, 5
s_bfe_u32 s33, s2, 0x10003
s_mul_i32 s35, s33, 3
s_add_u32 s32, s32, s35
s_add_u32 s35, s32, 0
s_lshl_b32 s48, s35, 7
s_lshl_b32 s52, s35, 17
s_add_u32 s52, s52, 122880
s_add_u32 s35, s32, 1
s_lshl_b32 s49, s35, 7
s_lshl_b32 s53, s35, 17
s_add_u32 s53, s53, 122880
s_add_u32 s35, s32, 2
s_lshl_b32 s50, s35, 7
s_lshl_b32 s54, s35, 17
s_add_u32 s54, s54, 122880
s_cmp_eq_u32 s49, 4992
s_cselect_b32 s53, 5111808, s53
s_cmp_eq_u32 s33, 1
s_cselect_b32 s54, 0x7fff0000, s54
s_cselect_b32 s50, s48, s50
s_mov_b32 s15, 0x7fff0000
s_mov_b32 s14, 0
s_mov_b32 s99, 0
s_mov_b32 s51, 0
s_mov_b32 s98, 2
s_waitcnt lgkmcnt(0)
s_add_u32 s24, s4, 0x6000000
s_addc_u32 s25, s5, 0
s_mov_b32 s26, 0x9c800
s_mov_b32 s27, 0x00020000
s_add_u32 s56, s4, 0x1000000
s_addc_u32 s57, s5, 0
s_mov_b32 s58, 0x6c02000
s_mov_b32 s59, 0x00020000
s_branch LC_common
L2_fin:
L2_end:
s_endpgm
.section .rodata,"a"
.p2align 6
.amdhsa_kernel k1_kernel
  .amdhsa_next_free_vgpr 256
  .amdhsa_next_free_sgpr 102
  .amdhsa_accum_offset 256
  .amdhsa_group_segment_fixed_size 0
  .amdhsa_kernarg_size 96
  .amdhsa_user_sgpr_count 2
  .amdhsa_user_sgpr_kernarg_segment_ptr 1
  .amdhsa_system_sgpr_workgroup_id_x 1
.end_amdhsa_kernel
.p2align 6
.amdhsa_kernel k2_kernel
  .amdhsa_next_free_vgpr 512
  .amdhsa_next_free_sgpr 102
  .amdhsa_accum_offset 256
  .amdhsa_group_segment_fixed_size 0
  .amdhsa_kernarg_size 96
  .amdhsa_user_sgpr_count 2
  .amdhsa_user_sgpr_kernarg_segment_ptr 1
  .amdhsa_system_sgpr_workgroup_id_x 1
.end_amdhsa_kernel
```

```asm
; @launch kernel=k1_kernel grid=(249,1,1) block=(512,1,1) lds=163840
; @launch kernel=k2_kernel grid=(256,1,1) block=(256,1,1) lds=163840
.amdgcn_target "amdgcn-amd-amdhsa--gfx950"
.text
.globl k1_kernel
.p2align 8
.type k1_kernel,@function
k1_kernel:
s_getpc_b64 s[56:57]
s_load_dwordx16 s[16:31], s[0:1], 0
s_load_dwordx8 s[32:39], s[0:1], 64
s_cmp_ge_u32 s2, 249
s_cbranch_scc1 L1_end
v_lshrrev_b32 v1, 6, v0
v_and_b32 v2, 63, v0
s_lshr_b32 s3, s2, 3
v_readfirstlane_b32 s60, v1
s_mul_i32 s5, s3, 8
s_add_u32 s5, s5, s60
s_and_b32 s56, s56, 0xffffff00
s_mov_b32 s58, L2_end-k1_kernel
s_mov_b32 s59, 0x00020000
s_and_b32 s6, s5, 15
s_lshl_b32 s6, s6, 13
v_lshlrev_b32 v10, 7, v2
buffer_load_dword v255, v10, s[56:59], s6 offen
v_and_b32 v3, 15, v2
v_lshrrev_b32 v4, 4, v2
s_and_b32 s62, s3, 7
s_sub_u32 s4, s2, 40
s_cmp_lt_u32 s2, 40
s_cbranch_scc1 L1_notq
s_mov_b32 s61, 0
v_lshlrev_b32 v16, 4, v2
s_mul_i32 s63, s60, 6144
s_mul_i32 s6, s4, 24576
s_mul_i32 s7, s60, 3072
s_add_u32 s64, s6, s7
s_add_u32 s65, s64, 4096
s_lshl_b32 s7, s60, 6
v_lshrrev_b32 v5, 2, v2
v_and_b32 v6, 3, v2
v_lshrrev_b32 v7, 5, v2
v_lshlrev_b32 v7, 1, v7
v_xor_b32 v6, v6, v7
v_lshl_add_u32 v5, v5, 9, s7
v_lshl_add_u32 v17, v6, 4, v5
v_add_u32 v18, 0x1c00, v17
s_xor_b32 s6, s62, 0
s_lshl_b32 s66, s6, 14
s_xor_b32 s6, s62, 1
s_lshl_b32 s67, s6, 14
s_xor_b32 s6, s62, 2
s_lshl_b32 s68, s6, 14
s_xor_b32 s6, s62, 3
s_lshl_b32 s69, s6, 14
s_xor_b32 s6, s62, 4
s_lshl_b32 s70, s6, 14
s_xor_b32 s6, s62, 5
s_lshl_b32 s71, s6, 14
s_xor_b32 s6, s62, 6
s_lshl_b32 s72, s6, 14
s_xor_b32 s6, s62, 7
s_lshl_b32 s73, s6, 14
s_waitcnt lgkmcnt(0)
s_add_u32 s40, s16, 0x0
s_addc_u32 s41, s17, 0
s_mov_b32 s42, 0x4e2000
s_mov_b32 s43, 0x00020000
s_add_u32 s44, s26, 0x0
s_addc_u32 s45, s27, 0
s_mov_b32 s46, 0x20000
s_mov_b32 s47, 0x00020000
buffer_load_dwordx4 v[40:43], v16, s[40:43], s64 offen offset:0
buffer_load_dwordx4 v[44:47], v16, s[40:43], s64 offen offset:1024
buffer_load_dwordx4 v[48:51], v16, s[40:43], s64 offen offset:2048
s_add_u32 m0, s63, 0x0
s_nop 0
buffer_load_dwordx4 v17, s[44:47], s66 offen offset:0 lds
buffer_load_dwordx4 v18, s[44:47], s66 offen offset:1024 lds
s_add_u32 m0, s63, 0x800
s_nop 0
buffer_load_dwordx4 v17, s[44:47], s67 offen offset:0 lds
buffer_load_dwordx4 v18, s[44:47], s67 offen offset:1024 lds
v_bfe_u32 v5, v2, 2, 3
v_xor_b32 v5, s62, v5
v_and_b32 v6, 3, v2
v_lshlrev_b32 v7, 10, v5
v_lshl_add_u32 v7, v6, 8, v7
v_add_u32 v7, 0xc000, v7
v_and_b32 v5, 1, v5
v_lshl_or_b32 v6, v5, 2, v6
v_lshrrev_b32 v5, 5, v2
s_mul_i32 s6, s60, 6
v_add3_u32 v8, v5, s6, 0
v_lshrrev_b32 v9, 4, v8
v_lshl_add_u32 v9, v9, 13, v7
v_and_b32 v8, 15, v8
v_xor_b32 v8, v8, v6
v_lshl_add_u32 v36, v8, 4, v9
v_add3_u32 v8, v5, s6, 2
v_lshrrev_b32 v9, 4, v8
v_lshl_add_u32 v9, v9, 13, v7
v_and_b32 v8, 15, v8
v_xor_b32 v8, v8, v6
v_lshl_add_u32 v37, v8, 4, v9
v_add3_u32 v8, v5, s6, 4
v_lshrrev_b32 v9, 4, v8
v_lshl_add_u32 v9, v9, 13, v7
v_and_b32 v8, 15, v8
v_xor_b32 v8, v8, v6
v_lshl_add_u32 v38, v8, 4, v9
v_xor_b32 v5, v3, v4
v_lshlrev_b32 v5, 4, v5
v_lshl_add_u32 v5, v4, 8, v5
v_add_u32 v31, 0xc000, v5
v_xor_b32 v32, 64, v31
v_lshrrev_b32 v5, 2, v3
v_and_b32 v6, 3, v3
v_and_b32 v7, 1, v4
v_lshlrev_b32 v7, 1, v7
v_lshl_add_u32 v8, v4, 3, v5
v_lshlrev_b32 v8, 6, v8
v_add_u32 v8, s63, v8
v_and_b32 v9, 1, v6
v_lshl_add_u32 v8, v9, 3, v8
v_lshrrev_b32 v6, 1, v6
v_xor_b32 v6, v6, v7
v_xor_b32 v9, 0, v6
v_lshl_add_u32 v25, v9, 4, v8
v_xor_b32 v9, 2, v6
v_lshl_add_u32 v26, v9, 4, v8
v_lshrrev_b32 v5, 3, v2
v_and_b32 v6, 7, v2
v_lshrrev_b32 v7, 1, v5
v_xor_b32 v6, v6, v7
v_and_b32 v7, 4, v5
v_add_u32 v5, v5, v7
s_mul_i32 s6, s60, 16384
v_lshl_add_u32 v5, v5, 9, s6
v_lshl_add_u32 v21, v6, 4, v5
v_xor_b32 v6, 4, v6
v_lshl_add_u32 v22, v6, 4, v5
v_add_u32 v22, 0x1c00, v22
s_lshr_b32 s7, s62, 1
s_xor_b32 s6, s7, 0
s_lshl_b32 s74, s6, 7
s_add_u32 s75, s74, 2048
s_xor_b32 s6, s7, 1
s_lshl_b32 s76, s6, 7
s_add_u32 s77, s76, 2048
s_xor_b32 s6, s7, 2
s_lshl_b32 s78, s6, 7
s_add_u32 s79, s78, 2048
s_xor_b32 s6, s7, 3
s_lshl_b32 s80, s6, 7
s_add_u32 s81, s80, 2048
s_and_b32 s6, s62, 1
s_lshl_b32 s6, s6, 2
v_lshrrev_b32 v5, 1, v3
v_xor_b32 v5, v5, v4
v_xor_b32 v5, s6, v5
v_lshl_add_u32 v6, v3, 7, s63
v_lshl_add_u32 v29, v5, 4, v6
v_xor_b32 v30, 64, v29
s_mul_i32 s6, s60, 1
s_xor_b32 s6, s6, s62
s_lshl_b32 s6, s6, 10
s_add_u32 s6, s6, 0x12000
v_lshrrev_b32 v5, 1, v4
v_and_b32 v6, 1, v4
v_lshl_add_u32 v5, v5, 8, s6
v_lshl_add_u32 v5, v6, 3, v5
v_lshl_add_u32 v33, v3, 4, v5
v_xor_b32 v34, 0x400, v33
v_add_u32 v35, 0x12000, v16
s_mul_i32 s6, s4, 24576
s_mul_i32 s7, s60, 1024
s_add_u32 s82, s6, s7
s_add_u32 s83, s82, 8192
s_add_u32 s84, s82, 16384
s_mov_b32 s86, 0x3db8aa3b
s_mov_b32 s87, 0x3db8aa3b
s_mov_b32 s88, 0x3727c5ac
s_mov_b32 s89, 0x3b800000
s_mov_b32 s90, 0xffff0000
s_add_u32 s48, s28, 0x0
s_addc_u32 s49, s29, 0
s_mov_b32 s50, 0x20000
s_mov_b32 s51, 0x00020000
s_add_u32 s52, s38, 0x0
s_addc_u32 s53, s39, 0
s_mov_b32 s54, 0x4e4000
s_mov_b32 s55, 0x00020000
s_add_u32 s56, s38, 0x6800000
s_addc_u32 s57, s39, 0
s_mov_b32 s58, 0x4e4000
s_mov_b32 s59, 0x00020000
v_lshlrev_b32 v11, 4, v4
s_lshr_b32 s8, s66, 8
buffer_load_dwordx4 v[172:175], v11, s[48:51], s8 offen
s_lshr_b32 s8, s67, 8
buffer_load_dwordx4 v[176:179], v11, s[48:51], s8 offen
s_lshr_b32 s8, s68, 8
buffer_load_dwordx4 v[180:183], v11, s[48:51], s8 offen
s_lshr_b32 s8, s69, 8
buffer_load_dwordx4 v[184:187], v11, s[48:51], s8 offen
s_lshr_b32 s8, s70, 8
buffer_load_dwordx4 v[188:191], v11, s[48:51], s8 offen
s_lshr_b32 s8, s71, 8
buffer_load_dwordx4 v[192:195], v11, s[48:51], s8 offen
s_lshr_b32 s8, s72, 8
buffer_load_dwordx4 v[196:199], v11, s[48:51], s8 offen
s_lshr_b32 s8, s73, 8
buffer_load_dwordx4 v[200:203], v11, s[48:51], s8 offen
s_waitcnt vmcnt(14)
v_lshlrev_b32 v76, 16, v40
v_and_b32 v77, s90, v40
v_lshlrev_b32 v78, 16, v41
v_and_b32 v79, s90, v41
v_lshlrev_b32 v80, 16, v42
v_and_b32 v81, s90, v42
v_lshlrev_b32 v82, 16, v43
v_and_b32 v83, s90, v43
v_pk_add_f32 v[100:101], v[76:77], v[78:79]
v_pk_mul_f32 v[102:103], v[76:77], v[76:77]
v_pk_add_f32 v[40:41], v[80:81], v[82:83]
v_pk_fma_f32 v[102:103], v[78:79], v[78:79], v[102:103]
v_pk_add_f32 v[100:101], v[100:101], v[40:41]
v_pk_fma_f32 v[102:103], v[80:81], v[80:81], v[102:103]
v_add_f32 v100, v100, v101
v_pk_fma_f32 v[102:103], v[82:83], v[82:83], v[102:103]
v_add_f32 v102, v102, v103
s_waitcnt vmcnt(13)
v_lshlrev_b32 v84, 16, v44
v_and_b32 v85, s90, v44
v_lshlrev_b32 v86, 16, v45
v_and_b32 v87, s90, v45
v_lshlrev_b32 v88, 16, v46
v_and_b32 v89, s90, v46
v_lshlrev_b32 v90, 16, v47
v_and_b32 v91, s90, v47
v_pk_add_f32 v[104:105], v[84:85], v[86:87]
v_pk_mul_f32 v[106:107], v[84:85], v[84:85]
v_pk_add_f32 v[44:45], v[88:89], v[90:91]
v_pk_fma_f32 v[106:107], v[86:87], v[86:87], v[106:107]
v_pk_add_f32 v[104:105], v[104:105], v[44:45]
v_pk_fma_f32 v[106:107], v[88:89], v[88:89], v[106:107]
v_add_f32 v104, v104, v105
v_pk_fma_f32 v[106:107], v[90:91], v[90:91], v[106:107]
v_add_f32 v106, v106, v107
s_waitcnt vmcnt(12)
v_lshlrev_b32 v92, 16, v48
v_and_b32 v93, s90, v48
v_lshlrev_b32 v94, 16, v49
v_and_b32 v95, s90, v49
v_lshlrev_b32 v96, 16, v50
v_and_b32 v97, s90, v50
v_lshlrev_b32 v98, 16, v51
v_and_b32 v99, s90, v51
v_pk_add_f32 v[108:109], v[92:93], v[94:95]
v_pk_mul_f32 v[110:111], v[92:93], v[92:93]
v_pk_add_f32 v[48:49], v[96:97], v[98:99]
v_pk_fma_f32 v[110:111], v[94:95], v[94:95], v[110:111]
v_pk_add_f32 v[108:109], v[108:109], v[48:49]
v_pk_fma_f32 v[110:111], v[96:97], v[96:97], v[110:111]
v_add_f32 v108, v108, v109
v_pk_fma_f32 v[110:111], v[98:99], v[98:99], v[110:111]
v_add_f32 v110, v110, v111
v_permlane16_swap_b32 v100, v102
v_permlane16_swap_b32 v104, v106
v_permlane16_swap_b32 v108, v110
v_add_f32 v100, v100, v102
v_add_f32 v104, v104, v106
v_add_f32 v108, v108, v110
v_add_f32_dpp v101, v100, v100 row_ror:8 row_mask:0xf bank_mask:0x3
v_add_f32_dpp v101, v104, v104 row_ror:8 row_mask:0xf bank_mask:0xc
v_add_f32_dpp v109, v108, v108 row_ror:8 row_mask:0xf bank_mask:0xf
s_nop 0
v_add_f32_dpp v102, v101, v101 row_half_mirror row_mask:0xf bank_mask:0x5
v_add_f32_dpp v102, v109, v109 row_half_mirror row_mask:0xf bank_mask:0xa
s_nop 1
v_add_f32_dpp v102, v102, v102 quad_perm:[1,0,3,2] row_mask:0xf bank_mask:0xf
s_nop 1
v_add_f32_dpp v102, v102, v102 quad_perm:[2,3,0,1] row_mask:0xf bank_mask:0xf
v_mov_b32 v103, v102
s_nop 1
v_permlane16_swap_b32 v103, v102
v_mul_f32 v103, s89, v103
v_mul_f32 v102, s89, v102
v_fma_f32 v102, -v103, v103, v102
v_max_f32 v102, 0, v102
v_cvt_pk_bf16_f32 v102, v102, v102
v_and_b32 v102, s90, v102
v_add_f32 v102, s88, v102
v_cvt_pk_bf16_f32 v102, v102, v102
v_and_b32 v102, s90, v102
v_sqrt_f32 v102, v102
s_nop 0
v_cvt_pk_bf16_f32 v102, v102, v102
v_and_b32 v102, s90, v102
v_rcp_f32 v102, v102
s_nop 0
v_mul_f32 v103, -v103, v102
s_nop 1
v_mov_b64_dpp v[100:101], v[102:103] row_newbcast:0 row_mask:0xf bank_mask:0xf
v_mov_b64_dpp v[104:105], v[102:103] row_newbcast:8 row_mask:0xf bank_mask:0xf
v_mov_b64_dpp v[108:109], v[102:103] row_newbcast:4 row_mask:0xf bank_mask:0xf
v_fma_f32 v76, v76, v100, v101
v_fma_f32 v77, v77, v100, v101
v_fma_f32 v78, v78, v100, v101
v_fma_f32 v79, v79, v100, v101
v_fma_f32 v80, v80, v100, v101
v_fma_f32 v81, v81, v100, v101
v_fma_f32 v82, v82, v100, v101
v_fma_f32 v83, v83, v100, v101
v_cvt_pk_bf16_f32 v40, v76, v77
v_cvt_pk_bf16_f32 v41, v78, v79
v_cvt_pk_bf16_f32 v42, v80, v81
v_cvt_pk_bf16_f32 v43, v82, v83
ds_write_b128 v36, v[40:43]
v_fma_f32 v84, v84, v104, v105
v_fma_f32 v85, v85, v104, v105
v_fma_f32 v86, v86, v104, v105
v_fma_f32 v87, v87, v104, v105
v_fma_f32 v88, v88, v104, v105
v_fma_f32 v89, v89, v104, v105
v_fma_f32 v90, v90, v104, v105
v_fma_f32 v91, v91, v104, v105
v_cvt_pk_bf16_f32 v44, v84, v85
v_cvt_pk_bf16_f32 v45, v86, v87
v_cvt_pk_bf16_f32 v46, v88, v89
v_cvt_pk_bf16_f32 v47, v90, v91
ds_write_b128 v37, v[44:47]
v_fma_f32 v92, v92, v108, v109
v_fma_f32 v93, v93, v108, v109
v_fma_f32 v94, v94, v108, v109
v_fma_f32 v95, v95, v108, v109
v_fma_f32 v96, v96, v108, v109
v_fma_f32 v97, v97, v108, v109
v_fma_f32 v98, v98, v108, v109
v_fma_f32 v99, v99, v108, v109
v_cvt_pk_bf16_f32 v48, v92, v93
v_cvt_pk_bf16_f32 v49, v94, v95
v_cvt_pk_bf16_f32 v50, v96, v97
v_cvt_pk_bf16_f32 v51, v98, v99
ds_write_b128 v38, v[48:51]
s_add_u32 m0, s63, 0x1000
s_nop 0
buffer_load_dwordx4 v17, s[44:47], s68 offen offset:0 lds
buffer_load_dwordx4 v18, s[44:47], s68 offen offset:1024 lds
s_waitcnt vmcnt(12)
ds_read_b64_tr_b16 v[100:101], v25 offset:0
ds_read_b64_tr_b16 v[102:103], v25 offset:256
ds_read_b64_tr_b16 v[104:105], v26 offset:0
ds_read_b64_tr_b16 v[106:107], v26 offset:256
s_waitcnt lgkmcnt(4)
s_barrier
ds_read_b128 v[124:127], v31 offset:0
ds_read_b128 v[128:131], v31 offset:8192
ds_read_b128 v[132:135], v31 offset:16384
ds_read_b128 v[136:139], v32 offset:1024
s_waitcnt vmcnt(10)
ds_read_b64_tr_b16 v[108:109], v25 offset:2048
ds_read_b64_tr_b16 v[110:111], v25 offset:2304
s_waitcnt lgkmcnt(5)
v_mfma_f32_16x16x32_bf16 v[52:55], v[100:103], v[124:127], 0
ds_read_b128 v[140:143], v32 offset:9216
s_waitcnt lgkmcnt(5)
v_mfma_f32_16x16x32_bf16 v[56:59], v[100:103], v[128:131], 0
ds_read_b128 v[144:147], v32 offset:17408
s_waitcnt lgkmcnt(5)
v_mfma_f32_16x16x32_bf16 v[60:63], v[100:103], v[132:135], 0
ds_read_b64_tr_b16 v[112:113], v26 offset:2048
ds_read_b64_tr_b16 v[114:115], v26 offset:2304
v_mfma_f32_16x16x32_bf16 v[64:67], v[104:107], v[124:127], 0
s_add_u32 m0, s63, 0x0
s_nop 0
buffer_load_dwordx4 v17, s[44:47], s69 offen offset:0 lds
buffer_load_dwordx4 v18, s[44:47], s69 offen offset:1024 lds
v_mfma_f32_16x16x32_bf16 v[68:71], v[104:107], v[128:131], 0
v_and_b32 v5, 31, v2
v_lshrrev_b32 v6, 5, v2
v_mfma_f32_16x16x32_bf16 v[72:75], v[104:107], v[132:135], 0
ds_read_b128 v[148:151], v31 offset:2048
s_waitcnt vmcnt(2)
ds_read_b64_tr_b16 v[116:117], v25 offset:4096
ds_read_b64_tr_b16 v[118:119], v25 offset:4352
s_waitcnt lgkmcnt(7)
v_mfma_f32_16x16x32_bf16 v[52:55], v[108:111], v[136:139], v[52:55]
ds_read_b128 v[152:155], v31 offset:10240
s_lshr_b32 s6, s64, 9
s_waitcnt lgkmcnt(7)
v_mfma_f32_16x16x32_bf16 v[56:59], v[108:111], v[140:143], v[56:59]
ds_read_b128 v[156:159], v31 offset:18432
v_cmp_eq_u32 vcc, 0, v5
s_waitcnt lgkmcnt(7)
v_mfma_f32_16x16x32_bf16 v[60:63], v[108:111], v[144:147], v[60:63]
ds_read_b64_tr_b16 v[120:121], v26 offset:4096
ds_read_b64_tr_b16 v[122:123], v26 offset:4352
s_waitcnt lgkmcnt(7)
v_mfma_f32_16x16x32_bf16 v[64:67], v[112:115], v[136:139], v[64:67]
s_add_u32 m0, s63, 0x800
s_nop 0
buffer_load_dwordx4 v17, s[44:47], s70 offen offset:0 lds
buffer_load_dwordx4 v18, s[44:47], s70 offen offset:1024 lds
v_mfma_f32_16x16x32_bf16 v[68:71], v[112:115], v[140:143], v[68:71]
s_sub_u32 s6, 10000, s6
v_mov_b32 v7, 0x7fffffff
v_mfma_f32_16x16x32_bf16 v[72:75], v[112:115], v[144:147], v[72:75]
ds_read_b128 v[160:163], v32 offset:3072
s_waitcnt vmcnt(2)
ds_read_b64_tr_b16 v[100:101], v25 offset:0
ds_read_b64_tr_b16 v[102:103], v25 offset:256
s_waitcnt lgkmcnt(7)
v_mfma_f32_16x16x32_bf16 v[52:55], v[116:119], v[148:151], v[52:55]
ds_read_b128 v[164:167], v32 offset:11264
v_cndmask_b32 v6, v7, v6, vcc
s_waitcnt lgkmcnt(7)
v_mfma_f32_16x16x32_bf16 v[56:59], v[116:119], v[152:155], v[56:59]
ds_read_b128 v[168:171], v32 offset:19456
v_cmp_gt_i32 vcc, s6, v6
s_waitcnt lgkmcnt(7)
v_mfma_f32_16x16x32_bf16 v[60:63], v[116:119], v[156:159], v[60:63]
ds_read_b64_tr_b16 v[104:105], v26 offset:0
ds_read_b64_tr_b16 v[106:107], v26 offset:256
s_waitcnt lgkmcnt(7)
v_mfma_f32_16x16x32_bf16 v[64:67], v[120:123], v[148:151], v[64:67]
s_add_u32 m0, s63, 0x1000
s_nop 0
buffer_load_dwordx4 v17, s[44:47], s71 offen offset:0 lds
buffer_load_dwordx4 v18, s[44:47], s71 offen offset:1024 lds
v_mfma_f32_16x16x32_bf16 v[68:71], v[120:123], v[152:155], v[68:71]
v_and_b32 v5, s90, v40
v_or_b32 v5, 0x3f80, v5
v_mfma_f32_16x16x32_bf16 v[72:75], v[120:123], v[156:159], v[72:75]
ds_read_b128 v[124:127], v31 offset:4096
s_waitcnt vmcnt(2)
ds_read_b64_tr_b16 v[108:109], v25 offset:2048
ds_read_b64_tr_b16 v[110:111], v25 offset:2304
s_waitcnt lgkmcnt(7)
v_mfma_f32_16x16x32_bf16 v[52:55], v[100:103], v[160:163], v[52:55]
ds_read_b128 v[128:131], v31 offset:12288
s_sub_u32 s6, s6, 2
s_waitcnt lgkmcnt(7)
v_mfma_f32_16x16x32_bf16 v[56:59], v[100:103], v[164:167], v[56:59]
ds_read_b128 v[132:135], v31 offset:20480
v_cndmask_b32 v40, v40, v5, vcc
s_waitcnt lgkmcnt(7)
v_mfma_f32_16x16x32_bf16 v[60:63], v[100:103], v[168:171], v[60:63]
ds_read_b64_tr_b16 v[112:113], v26 offset:2048
ds_read_b64_tr_b16 v[114:115], v26 offset:2304
s_waitcnt lgkmcnt(7)
v_mfma_f32_16x16x32_bf16 v[64:67], v[104:107], v[160:163], v[64:67]
s_add_u32 m0, s63, 0x0
s_nop 0
buffer_load_dwordx4 v17, s[44:47], s72 offen offset:0 lds
buffer_load_dwordx4 v18, s[44:47], s72 offen offset:1024 lds
v_mfma_f32_16x16x32_bf16 v[68:71], v[104:107], v[164:167], v[68:71]
v_cmp_gt_i32 vcc, s6, v6
v_and_b32 v5, s90, v44
v_mfma_f32_16x16x32_bf16 v[72:75], v[104:107], v[168:171], v[72:75]
ds_read_b128 v[136:139], v32 offset:5120
s_waitcnt vmcnt(2)
ds_read_b64_tr_b16 v[116:117], v25 offset:4096
ds_read_b64_tr_b16 v[118:119], v25 offset:4352
s_waitcnt lgkmcnt(7)
v_mfma_f32_16x16x32_bf16 v[52:55], v[108:111], v[124:127], v[52:55]
ds_read_b128 v[140:143], v32 offset:13312
v_or_b32 v5, 0x3f80, v5
s_waitcnt lgkmcnt(7)
v_mfma_f32_16x16x32_bf16 v[56:59], v[108:111], v[128:131], v[56:59]
ds_read_b128 v[144:147], v32 offset:21504
s_sub_u32 s6, s6, 2
s_waitcnt lgkmcnt(7)
v_mfma_f32_16x16x32_bf16 v[60:63], v[108:111], v[132:135], v[60:63]
ds_read_b64_tr_b16 v[120:121], v26 offset:4096
ds_read_b64_tr_b16 v[122:123], v26 offset:4352
s_waitcnt lgkmcnt(7)
v_mfma_f32_16x16x32_bf16 v[64:67], v[112:115], v[124:127], v[64:67]
s_add_u32 m0, s63, 0x800
s_nop 0
buffer_load_dwordx4 v17, s[44:47], s73 offen offset:0 lds
buffer_load_dwordx4 v18, s[44:47], s73 offen offset:1024 lds
v_mfma_f32_16x16x32_bf16 v[68:71], v[112:115], v[128:131], v[68:71]
v_cndmask_b32 v44, v44, v5, vcc
v_cmp_gt_i32 vcc, s6, v6
v_mfma_f32_16x16x32_bf16 v[72:75], v[112:115], v[132:135], v[72:75]
ds_read_b128 v[148:151], v31 offset:6144
s_waitcnt vmcnt(2)
ds_read_b64_tr_b16 v[100:101], v25 offset:0
ds_read_b64_tr_b16 v[102:103], v25 offset:256
s_waitcnt lgkmcnt(7)
v_mfma_f32_16x16x32_bf16 v[52:55], v[116:119], v[136:139], v[52:55]
ds_read_b128 v[152:155], v31 offset:14336
v_and_b32 v5, s90, v48
s_waitcnt lgkmcnt(7)
v_mfma_f32_16x16x32_bf16 v[56:59], v[116:119], v[140:143], v[56:59]
ds_read_b128 v[156:159], v31 offset:22528
v_or_b32 v5, 0x3f80, v5
s_waitcnt lgkmcnt(7)
v_mfma_f32_16x16x32_bf16 v[60:63], v[116:119], v[144:147], v[60:63]
ds_read_b64_tr_b16 v[104:105], v26 offset:0
ds_read_b64_tr_b16 v[106:107], v26 offset:256
s_waitcnt lgkmcnt(7)
v_mfma_f32_16x16x32_bf16 v[64:67], v[120:123], v[136:139], v[64:67]
s_add_u32 m0, s63, 0x1000
s_nop 0
buffer_load_dwordx4 v21, s[48:51], s74 offen offset:0 lds
buffer_load_dwordx4 v22, s[48:51], s74 offen offset:1024 lds
v_mfma_f32_16x16x32_bf16 v[68:71], v[120:123], v[140:143], v[68:71]
s_sub_u32 s6, s6, 2
v_cndmask_b32 v48, v48, v5, vcc
v_mfma_f32_16x16x32_bf16 v[72:75], v[120:123], v[144:147], v[72:75]
ds_read_b128 v[160:163], v32 offset:7168
s_waitcnt vmcnt(2)
ds_read_b64_tr_b16 v[108:109], v25 offset:2048
ds_read_b64_tr_b16 v[110:111], v25 offset:2304
s_waitcnt lgkmcnt(7)
v_mfma_f32_16x16x32_bf16 v[52:55], v[100:103], v[148:151], v[52:55]
ds_read_b128 v[164:167], v32 offset:15360
s_waitcnt lgkmcnt(7)
v_mfma_f32_16x16x32_bf16 v[56:59], v[100:103], v[152:155], v[56:59]
ds_read_b128 v[168:171], v32 offset:23552
s_waitcnt lgkmcnt(7)
v_mfma_f32_16x16x32_bf16 v[60:63], v[100:103], v[156:159], v[60:63]
ds_read_b64_tr_b16 v[112:113], v26 offset:2048
ds_read_b64_tr_b16 v[114:115], v26 offset:2304
s_waitcnt lgkmcnt(7)
v_mfma_f32_16x16x32_bf16 v[64:67], v[104:107], v[148:151], v[64:67]
s_add_u32 m0, s63, 0x0
s_nop 0
buffer_load_dwordx4 v21, s[48:51], s75 offen offset:0 lds
buffer_load_dwordx4 v22, s[48:51], s75 offen offset:1024 lds
v_mfma_f32_16x16x32_bf16 v[68:71], v[104:107], v[152:155], v[68:71]
v_mfma_f32_16x16x32_bf16 v[72:75], v[104:107], v[156:159], v[72:75]
s_waitcnt lgkmcnt(4)
v_mfma_f32_16x16x32_bf16 v[52:55], v[108:111], v[160:163], v[52:55]
s_waitcnt lgkmcnt(3)
v_mfma_f32_16x16x32_bf16 v[56:59], v[108:111], v[164:167], v[56:59]
s_waitcnt lgkmcnt(2)
v_mfma_f32_16x16x32_bf16 v[60:63], v[108:111], v[168:171], v[60:63]
s_waitcnt lgkmcnt(0)
v_mfma_f32_16x16x32_bf16 v[64:67], v[112:115], v[160:163], v[64:67]
s_nop 1
v_cvt_pk_bf16_f32 v52, v52, v53
v_cvt_pk_bf16_f32 v53, v54, v55
ds_write_b64 v33, v[52:53] offset:0
s_add_u32 m0, s63, 0x800
s_nop 0
buffer_load_dwordx4 v21, s[48:51], s76 offen offset:0 lds
buffer_load_dwordx4 v22, s[48:51], s76 offen offset:1024 lds
v_mfma_f32_16x16x32_bf16 v[68:71], v[112:115], v[164:167], v[68:71]
v_cvt_pk_bf16_f32 v56, v56, v57
v_cvt_pk_bf16_f32 v57, v58, v59
ds_write_b64 v33, v[56:57] offset:8192
v_mfma_f32_16x16x32_bf16 v[72:75], v[112:115], v[168:171], v[72:75]
v_cvt_pk_bf16_f32 v60, v60, v61
v_cvt_pk_bf16_f32 v61, v62, v63
ds_write_b64 v33, v[60:61] offset:16384
v_cvt_pk_bf16_f32 v64, v64, v65
v_cvt_pk_bf16_f32 v65, v66, v67
ds_write_b64 v33, v[64:65] offset:512
v_cvt_pk_bf16_f32 v68, v68, v69
v_cvt_pk_bf16_f32 v69, v70, v71
ds_write_b64 v33, v[68:69] offset:8704
v_cvt_pk_bf16_f32 v72, v72, v73
v_cvt_pk_bf16_f32 v73, v74, v75
ds_write_b64 v33, v[72:73] offset:16896
s_waitcnt vmcnt(4)
ds_read_b128 v[116:119], v29 offset:4096
ds_read_b128 v[120:123], v30 offset:4096
s_waitcnt lgkmcnt(2)
s_barrier
ds_read_b128 v[124:127], v35 offset:0
ds_read_b128 v[128:131], v35 offset:8192
ds_read_b128 v[132:135], v35 offset:16384
ds_read_b128 v[136:139], v35 offset:1024
s_waitcnt lgkmcnt(3)
v_mfma_f32_16x16x32_bf16 v[76:79], v[116:119], v[124:127], 0
ds_read_b128 v[140:143], v35 offset:9216
s_waitcnt lgkmcnt(3)
v_mfma_f32_16x16x32_bf16 v[84:87], v[116:119], v[128:131], 0
ds_read_b128 v[144:147], v35 offset:17408
s_waitcnt lgkmcnt(3)
v_mfma_f32_16x16x32_bf16 v[92:95], v[116:119], v[132:135], 0
v_mfma_f32_16x16x32_bf16 v[204:207], v[172:175], v[124:127], 0
v_mfma_f32_16x16x32_bf16 v[208:211], v[172:175], v[128:131], 0
v_mfma_f32_16x16x32_bf16 v[212:215], v[172:175], v[132:135], 0
s_waitcnt vmcnt(2)
ds_read_b128 v[100:103], v29 offset:0
s_waitcnt lgkmcnt(3)
v_mfma_f32_16x16x32_bf16 v[76:79], v[120:123], v[136:139], v[76:79]
s_add_u32 m0, s63, 0x1000
s_nop 0
buffer_load_dwordx4 v21, s[48:51], s77 offen offset:0 lds
buffer_load_dwordx4 v22, s[48:51], s77 offen offset:1024 lds
s_waitcnt lgkmcnt(2)
v_mfma_f32_16x16x32_bf16 v[84:87], v[120:123], v[140:143], v[84:87]
s_waitcnt lgkmcnt(1)
v_mfma_f32_16x16x32_bf16 v[92:95], v[120:123], v[144:147], v[92:95]
ds_read_b128 v[104:107], v30 offset:0
v_mfma_f32_16x16x32_bf16 v[204:207], v[176:179], v[136:139], v[204:207]
v_mfma_f32_16x16x32_bf16 v[208:211], v[176:179], v[140:143], v[208:211]
v_mfma_f32_16x16x32_bf16 v[212:215], v[176:179], v[144:147], v[212:215]
ds_read_b128 v[148:151], v35 offset:2048
s_waitcnt vmcnt(2)
ds_read_b128 v[108:111], v29 offset:2048
s_waitcnt lgkmcnt(3)
v_mfma_f32_16x16x32_bf16 v[80:83], v[100:103], v[124:127], 0
ds_read_b128 v[152:155], v35 offset:10240
v_mfma_f32_16x16x32_bf16 v[88:91], v[100:103], v[128:131], 0
ds_read_b128 v[156:159], v35 offset:18432
v_mfma_f32_16x16x32_bf16 v[96:99], v[100:103], v[132:135], 0
s_waitcnt lgkmcnt(4)
v_mfma_f32_16x16x32_bf16 v[80:83], v[104:107], v[136:139], v[80:83]
s_add_u32 m0, s63, 0x0
s_nop 0
buffer_load_dwordx4 v21, s[48:51], s78 offen offset:0 lds
buffer_load_dwordx4 v22, s[48:51], s78 offen offset:1024 lds
v_mfma_f32_16x16x32_bf16 v[88:91], v[104:107], v[140:143], v[88:91]
v_mfma_f32_16x16x32_bf16 v[96:99], v[104:107], v[144:147], v[96:99]
ds_read_b128 v[160:163], v35 offset:3072
ds_read_b128 v[112:115], v30 offset:2048
s_waitcnt lgkmcnt(4)
v_mfma_f32_16x16x32_bf16 v[76:79], v[108:111], v[148:151], v[76:79]
ds_read_b128 v[164:167], v35 offset:11264
s_waitcnt lgkmcnt(4)
v_mfma_f32_16x16x32_bf16 v[84:87], v[108:111], v[152:155], v[84:87]
ds_read_b128 v[168:171], v35 offset:19456
s_waitcnt lgkmcnt(4)
v_mfma_f32_16x16x32_bf16 v[92:95], v[108:111], v[156:159], v[92:95]
v_mfma_f32_16x16x32_bf16 v[204:207], v[180:183], v[148:151], v[204:207]
v_mfma_f32_16x16x32_bf16 v[208:211], v[180:183], v[152:155], v[208:211]
v_mfma_f32_16x16x32_bf16 v[212:215], v[180:183], v[156:159], v[212:215]
s_waitcnt vmcnt(2)
ds_read_b128 v[116:119], v29 offset:4096
s_waitcnt lgkmcnt(3)
v_mfma_f32_16x16x32_bf16 v[76:79], v[112:115], v[160:163], v[76:79]
s_add_u32 m0, s63, 0x800
s_nop 0
buffer_load_dwordx4 v21, s[48:51], s79 offen offset:0 lds
buffer_load_dwordx4 v22, s[48:51], s79 offen offset:1024 lds
s_waitcnt lgkmcnt(2)
v_mfma_f32_16x16x32_bf16 v[84:87], v[112:115], v[164:167], v[84:87]
s_waitcnt lgkmcnt(1)
v_mfma_f32_16x16x32_bf16 v[92:95], v[112:115], v[168:171], v[92:95]
ds_read_b128 v[120:123], v30 offset:4096
v_mfma_f32_16x16x32_bf16 v[204:207], v[184:187], v[160:163], v[204:207]
v_mfma_f32_16x16x32_bf16 v[208:211], v[184:187], v[164:167], v[208:211]
v_mfma_f32_16x16x32_bf16 v[212:215], v[184:187], v[168:171], v[212:215]
ds_read_b128 v[124:127], v35 offset:4096
s_waitcnt vmcnt(2)
ds_read_b128 v[100:103], v29 offset:0
s_waitcnt lgkmcnt(3)
v_mfma_f32_16x16x32_bf16 v[80:83], v[116:119], v[148:151], v[80:83]
ds_read_b128 v[128:131], v35 offset:12288
v_mfma_f32_16x16x32_bf16 v[88:91], v[116:119], v[152:155], v[88:91]
ds_read_b128 v[132:135], v35 offset:20480
v_mfma_f32_16x16x32_bf16 v[96:99], v[116:119], v[156:159], v[96:99]
s_waitcnt lgkmcnt(4)
v_mfma_f32_16x16x32_bf16 v[80:83], v[120:123], v[160:163], v[80:83]
s_add_u32 m0, s63, 0x1000
s_nop 0
buffer_load_dwordx4 v21, s[48:51], s80 offen offset:0 lds
buffer_load_dwordx4 v22, s[48:51], s80 offen offset:1024 lds
v_mfma_f32_16x16x32_bf16 v[88:91], v[120:123], v[164:167], v[88:91]
v_mfma_f32_16x16x32_bf16 v[96:99], v[120:123], v[168:171], v[96:99]
ds_read_b128 v[136:139], v35 offset:5120
ds_read_b128 v[104:107], v30 offset:0
s_waitcnt lgkmcnt(4)
v_mfma_f32_16x16x32_bf16 v[76:79], v[100:103], v[124:127], v[76:79]
ds_read_b128 v[140:143], v35 offset:13312
s_waitcnt lgkmcnt(4)
v_mfma_f32_16x16x32_bf16 v[84:87], v[100:103], v[128:131], v[84:87]
ds_read_b128 v[144:147], v35 offset:21504
s_waitcnt lgkmcnt(4)
v_mfma_f32_16x16x32_bf16 v[92:95], v[100:103], v[132:135], v[92:95]
v_mfma_f32_16x16x32_bf16 v[204:207], v[188:191], v[124:127], v[204:207]
v_mfma_f32_16x16x32_bf16 v[208:211], v[188:191], v[128:131], v[208:211]
v_mfma_f32_16x16x32_bf16 v[212:215], v[188:191], v[132:135], v[212:215]
s_waitcnt vmcnt(2)
ds_read_b128 v[108:111], v29 offset:2048
s_waitcnt lgkmcnt(3)
v_mfma_f32_16x16x32_bf16 v[76:79], v[104:107], v[136:139], v[76:79]
s_add_u32 m0, s63, 0x0
s_nop 0
buffer_load_dwordx4 v21, s[48:51], s81 offen offset:0 lds
buffer_load_dwordx4 v22, s[48:51], s81 offen offset:1024 lds
s_waitcnt lgkmcnt(2)
v_mfma_f32_16x16x32_bf16 v[84:87], v[104:107], v[140:143], v[84:87]
buffer_store_dwordx4 v[40:43], v16, s[56:59], s64 offen offset:0 sc1
buffer_store_dwordx4 v[44:47], v16, s[56:59], s64 offen offset:1024 sc1
s_waitcnt lgkmcnt(1)
v_mfma_f32_16x16x32_bf16 v[92:95], v[104:107], v[144:147], v[92:95]
ds_read_b128 v[112:115], v30 offset:2048
buffer_store_dwordx4 v[48:51], v16, s[56:59], s64 offen offset:2048 sc1
v_mfma_f32_16x16x32_bf16 v[204:207], v[192:195], v[136:139], v[204:207]
v_mfma_f32_16x16x32_bf16 v[208:211], v[192:195], v[140:143], v[208:211]
v_mfma_f32_16x16x32_bf16 v[212:215], v[192:195], v[144:147], v[212:215]
ds_read_b128 v[148:151], v35 offset:6144
s_waitcnt vmcnt(5)
ds_read_b128 v[116:119], v29 offset:4096
s_waitcnt lgkmcnt(3)
v_mfma_f32_16x16x32_bf16 v[80:83], v[108:111], v[124:127], v[80:83]
ds_read_b128 v[152:155], v35 offset:14336
v_mfma_f32_16x16x32_bf16 v[88:91], v[108:111], v[128:131], v[88:91]
ds_read_b128 v[156:159], v35 offset:22528
v_mfma_f32_16x16x32_bf16 v[96:99], v[108:111], v[132:135], v[96:99]
s_waitcnt lgkmcnt(4)
v_mfma_f32_16x16x32_bf16 v[80:83], v[112:115], v[136:139], v[80:83]
v_mfma_f32_16x16x32_bf16 v[88:91], v[112:115], v[140:143], v[88:91]
v_mfma_f32_16x16x32_bf16 v[96:99], v[112:115], v[144:147], v[96:99]
ds_read_b128 v[160:163], v35 offset:7168
ds_read_b128 v[120:123], v30 offset:4096
s_waitcnt lgkmcnt(4)
v_mfma_f32_16x16x32_bf16 v[76:79], v[116:119], v[148:151], v[76:79]
ds_read_b128 v[164:167], v35 offset:15360
s_waitcnt lgkmcnt(4)
v_mfma_f32_16x16x32_bf16 v[84:87], v[116:119], v[152:155], v[84:87]
ds_read_b128 v[168:171], v35 offset:23552
s_waitcnt lgkmcnt(4)
v_mfma_f32_16x16x32_bf16 v[92:95], v[116:119], v[156:159], v[92:95]
v_mfma_f32_16x16x32_bf16 v[204:207], v[196:199], v[148:151], v[204:207]
v_mfma_f32_16x16x32_bf16 v[208:211], v[196:199], v[152:155], v[208:211]
v_mfma_f32_16x16x32_bf16 v[212:215], v[196:199], v[156:159], v[212:215]
s_waitcnt vmcnt(3)
ds_read_b128 v[100:103], v29 offset:0
s_waitcnt lgkmcnt(3)
v_mfma_f32_16x16x32_bf16 v[76:79], v[120:123], v[160:163], v[76:79]
s_waitcnt lgkmcnt(2)
v_mfma_f32_16x16x32_bf16 v[84:87], v[120:123], v[164:167], v[84:87]
s_waitcnt lgkmcnt(1)
v_mfma_f32_16x16x32_bf16 v[92:95], v[120:123], v[168:171], v[92:95]
ds_read_b128 v[104:107], v30 offset:0
v_mfma_f32_16x16x32_bf16 v[204:207], v[200:203], v[160:163], v[204:207]
v_mfma_f32_16x16x32_bf16 v[208:211], v[200:203], v[164:167], v[208:211]
v_mfma_f32_16x16x32_bf16 v[212:215], v[200:203], v[168:171], v[212:215]
s_waitcnt lgkmcnt(1)
v_mfma_f32_16x16x32_bf16 v[80:83], v[100:103], v[148:151], v[80:83]
s_nop 3
v_mul_f32 v204, -v204, s86
v_mfma_f32_16x16x32_bf16 v[88:91], v[100:103], v[152:155], v[88:91]
v_mul_f32 v208, -v208, s86
v_mfma_f32_16x16x32_bf16 v[96:99], v[100:103], v[156:159], v[96:99]
v_mul_f32 v212, -v212, s86
s_waitcnt lgkmcnt(0)
v_mfma_f32_16x16x32_bf16 v[80:83], v[104:107], v[160:163], v[80:83]
v_mfma_f32_16x16x32_bf16 v[88:91], v[104:107], v[164:167], v[88:91]
v_mfma_f32_16x16x32_bf16 v[96:99], v[104:107], v[168:171], v[96:99]
v_fma_f32 v76, v76, s86, v204
v_fma_f32 v77, v77, s86, v204
v_fma_f32 v78, v78, s86, v204
v_fma_f32 v79, v79, s86, v204
s_nop 1
v_fma_f32 v80, v80, s86, v204
v_fma_f32 v81, v81, s86, v204
v_fma_f32 v82, v82, s86, v204
v_fma_f32 v83, v83, s86, v204
v_cvt_pk_bf16_f32 v76, v76, v77
v_cvt_pk_bf16_f32 v77, v78, v79
v_cvt_pk_bf16_f32 v78, v80, v81
v_cvt_pk_bf16_f32 v79, v82, v83
buffer_store_dwordx4 v[76:79], v16, s[52:55], s82 offen offset:0 sc1
v_fma_f32 v84, v84, s86, v208
v_fma_f32 v85, v85, s86, v208
v_fma_f32 v86, v86, s86, v208
v_fma_f32 v87, v87, s86, v208
v_fma_f32 v88, v88, s86, v208
v_fma_f32 v89, v89, s86, v208
v_fma_f32 v90, v90, s86, v208
v_fma_f32 v91, v91, s86, v208
v_cvt_pk_bf16_f32 v84, v84, v85
v_cvt_pk_bf16_f32 v85, v86, v87
v_cvt_pk_bf16_f32 v86, v88, v89
v_cvt_pk_bf16_f32 v87, v90, v91
buffer_store_dwordx4 v[84:87], v16, s[52:55], s83 offen offset:0 sc1
v_fma_f32 v92, v92, s86, v212
v_fma_f32 v93, v93, s86, v212
v_fma_f32 v94, v94, s86, v212
v_fma_f32 v95, v95, s86, v212
v_fma_f32 v96, v96, s86, v212
v_fma_f32 v97, v97, s86, v212
v_fma_f32 v98, v98, s86, v212
v_fma_f32 v99, v99, s86, v212
v_cvt_pk_bf16_f32 v92, v92, v93
v_cvt_pk_bf16_f32 v93, v94, v95
v_cvt_pk_bf16_f32 v94, v96, v97
v_cvt_pk_bf16_f32 v95, v98, v99
buffer_store_dwordx4 v[92:95], v16, s[52:55], s84 offen offset:0 sc1
s_branch L1_fin
L1_notq:
s_sub_u32 s4, s2, 32
s_cmp_lt_u32 s2, 32
s_cbranch_scc1 L1_edge
s_mov_b32 s61, 1
v_lshlrev_b32 v16, 4, v2
s_mul_i32 s63, s60, 6144
s_and_b32 s6, s4, 3
s_lshl_b32 s6, s6, 6
s_mul_i32 s7, s60, 8
s_add_u32 s6, s6, s7
v_lshrrev_b32 v5, 5, v2
v_and_b32 v6, 31, v2
v_lshlrev_b32 v6, 4, v6
v_mov_b32 v176, v6
s_cmp_ge_u32 s4, 4
s_cselect_b64 vcc, -1, 0
v_add3_u32 v7, v5, s6, 0
v_and_b32 v8, 0x80, v7
v_bfe_u32 v9, v7, 2, 1
v_lshl_or_b32 v8, v9, 6, v8
v_bfe_u32 v9, v7, 4, 1
v_lshl_or_b32 v8, v9, 5, v8
v_and_b32 v9, 3, v7
v_lshl_or_b32 v8, v9, 3, v8
v_bfe_u32 v9, v7, 5, 2
v_lshl_or_b32 v8, v9, 1, v8
v_bfe_u32 v9, v7, 3, 1
v_or_b32 v8, v9, v8
v_cndmask_b32 v8, v8, v7, vcc
v_lshl_add_u32 v40, v8, 9, v6
v_add3_u32 v7, v5, s6, 2
v_and_b32 v8, 0x80, v7
v_bfe_u32 v9, v7, 2, 1
v_lshl_or_b32 v8, v9, 6, v8
v_bfe_u32 v9, v7, 4, 1
v_lshl_or_b32 v8, v9, 5, v8
v_and_b32 v9, 3, v7
v_lshl_or_b32 v8, v9, 3, v8
v_bfe_u32 v9, v7, 5, 2
v_lshl_or_b32 v8, v9, 1, v8
v_bfe_u32 v9, v7, 3, 1
v_or_b32 v8, v9, v8
v_cndmask_b32 v8, v8, v7, vcc
v_lshl_add_u32 v44, v8, 9, v6
v_add3_u32 v7, v5, s6, 4
v_and_b32 v8, 0x80, v7
v_bfe_u32 v9, v7, 2, 1
v_lshl_or_b32 v8, v9, 6, v8
v_bfe_u32 v9, v7, 4, 1
v_lshl_or_b32 v8, v9, 5, v8
v_and_b32 v9, 3, v7
v_lshl_or_b32 v8, v9, 3, v8
v_bfe_u32 v9, v7, 5, 2
v_lshl_or_b32 v8, v9, 1, v8
v_bfe_u32 v9, v7, 3, 1
v_or_b32 v8, v9, v8
v_cndmask_b32 v8, v8, v7, vcc
v_lshl_add_u32 v48, v8, 9, v6
v_add3_u32 v7, v5, s6, 6
v_and_b32 v8, 0x80, v7
v_bfe_u32 v9, v7, 2, 1
v_lshl_or_b32 v8, v9, 6, v8
v_bfe_u32 v9, v7, 4, 1
v_lshl_or_b32 v8, v9, 5, v8
v_and_b32 v9, 3, v7
v_lshl_or_b32 v8, v9, 3, v8
v_bfe_u32 v9, v7, 5, 2
v_lshl_or_b32 v8, v9, 1, v8
v_bfe_u32 v9, v7, 3, 1
v_or_b32 v8, v9, v8
v_cndmask_b32 v8, v8, v7, vcc
v_lshl_add_u32 v52, v8, 9, v6
s_lshl_b32 s7, s60, 6
v_lshrrev_b32 v5, 2, v2
v_and_b32 v6, 3, v2
v_lshrrev_b32 v7, 5, v2
v_lshlrev_b32 v7, 1, v7
v_xor_b32 v6, v6, v7
v_lshl_add_u32 v5, v5, 9, s7
v_lshl_add_u32 v17, v6, 4, v5
v_add_u32 v18, 0x1c00, v17
s_xor_b32 s6, s62, 0
s_lshl_b32 s66, s6, 14
s_xor_b32 s6, s62, 1
s_lshl_b32 s67, s6, 14
s_xor_b32 s6, s62, 2
s_lshl_b32 s68, s6, 14
s_xor_b32 s6, s62, 3
s_lshl_b32 s69, s6, 14
s_xor_b32 s6, s62, 4
s_lshl_b32 s70, s6, 14
s_xor_b32 s6, s62, 5
s_lshl_b32 s71, s6, 14
s_xor_b32 s6, s62, 6
s_lshl_b32 s72, s6, 14
s_xor_b32 s6, s62, 7
s_lshl_b32 s73, s6, 14
s_waitcnt lgkmcnt(0)
s_cmp_ge_u32 s4, 4
s_cselect_b32 s6, s30, s24
s_cselect_b32 s7, s31, s25
s_add_u32 s40, s6, 0x0
s_addc_u32 s41, s7, 0
s_mov_b32 s42, 0x20000
s_mov_b32 s43, 0x00020000
s_add_u32 s44, s32, 0x0
s_addc_u32 s45, s33, 0
s_mov_b32 s46, 0x20000
s_mov_b32 s47, 0x00020000
buffer_load_dwordx4 v[40:43], v40, s[40:43], 0 offen
buffer_load_dwordx4 v[44:47], v44, s[40:43], 0 offen
buffer_load_dwordx4 v[48:51], v48, s[40:43], 0 offen
buffer_load_dwordx4 v[52:55], v52, s[40:43], 0 offen
buffer_load_dwordx4 v[176:179], v176, s[40:43], 0 offen
s_add_u32 m0, s63, 0x0
s_nop 0
buffer_load_dwordx4 v17, s[44:47], s66 offen offset:0 lds
buffer_load_dwordx4 v18, s[44:47], s66 offen offset:1024 lds
s_add_u32 m0, s63, 0x800
s_nop 0
buffer_load_dwordx4 v17, s[44:47], s67 offen offset:0 lds
buffer_load_dwordx4 v18, s[44:47], s67 offen offset:1024 lds
v_bfe_u32 v5, v2, 2, 3
v_xor_b32 v5, s62, v5
v_and_b32 v6, 3, v2
v_lshlrev_b32 v7, 10, v5
v_lshl_add_u32 v7, v6, 8, v7
v_add_u32 v7, 0xc000, v7
v_and_b32 v5, 1, v5
v_lshl_or_b32 v6, v5, 2, v6
v_lshrrev_b32 v5, 5, v2
s_mul_i32 s6, s60, 8
v_add3_u32 v8, v5, s6, 0
v_lshrrev_b32 v9, 4, v8
v_lshl_add_u32 v9, v9, 13, v7
v_and_b32 v8, 15, v8
v_xor_b32 v8, v8, v6
v_lshl_add_u32 v36, v8, 4, v9
v_add3_u32 v8, v5, s6, 2
v_lshrrev_b32 v9, 4, v8
v_lshl_add_u32 v9, v9, 13, v7
v_and_b32 v8, 15, v8
v_xor_b32 v8, v8, v6
v_lshl_add_u32 v37, v8, 4, v9
v_add3_u32 v8, v5, s6, 4
v_lshrrev_b32 v9, 4, v8
v_lshl_add_u32 v9, v9, 13, v7
v_and_b32 v8, 15, v8
v_xor_b32 v8, v8, v6
v_lshl_add_u32 v38, v8, 4, v9
v_add3_u32 v8, v5, s6, 6
v_lshrrev_b32 v9, 4, v8
v_lshl_add_u32 v9, v9, 13, v7
v_and_b32 v8, 15, v8
v_xor_b32 v8, v8, v6
v_lshl_add_u32 v39, v8, 4, v9
v_xor_b32 v5, v3, v4
v_lshlrev_b32 v5, 4, v5
v_lshl_add_u32 v5, v4, 8, v5
v_add_u32 v31, 0xc000, v5
v_xor_b32 v32, 64, v31
v_lshrrev_b32 v5, 2, v3
v_and_b32 v6, 3, v3
v_and_b32 v7, 1, v4
v_lshlrev_b32 v7, 1, v7
v_lshl_add_u32 v8, v4, 3, v5
v_lshlrev_b32 v8, 6, v8
v_add_u32 v8, s63, v8
v_xor_b32 v6, v6, v7
v_xor_b32 v9, 0, v6
v_lshl_add_u32 v25, v9, 4, v8
v_add_u32 v26, 8, v25
s_lshr_b32 s6, s4, 2
s_lshl_b32 s6, s6, 17
s_and_b32 s7, s4, 3
s_lshl_b32 s7, s7, 12
s_add_u32 s6, s6, s7
s_mul_i32 s7, s60, 16384
s_add_u32 s82, s6, s7
s_add_u32 s83, s82, 16384
s_add_u32 s52, s38, 0x1000000
s_addc_u32 s53, s39, 0
s_mov_b32 s54, 0x40000
s_mov_b32 s55, 0x00020000
s_mov_b32 s90, 0xffff0000
s_waitcnt vmcnt(4)
v_lshlrev_b32 v180, 16, v176
v_and_b32 v181, s90, v176
v_lshlrev_b32 v182, 16, v177
v_and_b32 v183, s90, v177
v_lshlrev_b32 v184, 16, v178
v_and_b32 v185, s90, v178
v_lshlrev_b32 v186, 16, v179
v_and_b32 v187, s90, v179
v_lshlrev_b32 v176, 16, v40
v_and_b32 v177, s90, v40
v_sub_f32 v176, v176, v180
v_sub_f32 v177, v177, v181
v_cvt_pk_bf16_f32 v40, v176, v177
v_lshlrev_b32 v176, 16, v41
v_and_b32 v177, s90, v41
v_sub_f32 v176, v176, v182
v_sub_f32 v177, v177, v183
v_cvt_pk_bf16_f32 v41, v176, v177
v_lshlrev_b32 v176, 16, v42
v_and_b32 v177, s90, v42
v_sub_f32 v176, v176, v184
v_sub_f32 v177, v177, v185
v_cvt_pk_bf16_f32 v42, v176, v177
v_lshlrev_b32 v176, 16, v43
v_and_b32 v177, s90, v43
v_sub_f32 v176, v176, v186
v_sub_f32 v177, v177, v187
v_cvt_pk_bf16_f32 v43, v176, v177
v_lshlrev_b32 v176, 16, v44
v_and_b32 v177, s90, v44
v_sub_f32 v176, v176, v180
v_sub_f32 v177, v177, v181
v_cvt_pk_bf16_f32 v44, v176, v177
v_lshlrev_b32 v176, 16, v45
v_and_b32 v177, s90, v45
v_sub_f32 v176, v176, v182
v_sub_f32 v177, v177, v183
v_cvt_pk_bf16_f32 v45, v176, v177
v_lshlrev_b32 v176, 16, v46
v_and_b32 v177, s90, v46
v_sub_f32 v176, v176, v184
v_sub_f32 v177, v177, v185
v_cvt_pk_bf16_f32 v46, v176, v177
v_lshlrev_b32 v176, 16, v47
v_and_b32 v177, s90, v47
v_sub_f32 v176, v176, v186
v_sub_f32 v177, v177, v187
v_cvt_pk_bf16_f32 v47, v176, v177
v_lshlrev_b32 v176, 16, v48
v_and_b32 v177, s90, v48
v_sub_f32 v176, v176, v180
v_sub_f32 v177, v177, v181
v_cvt_pk_bf16_f32 v48, v176, v177
v_lshlrev_b32 v176, 16, v49
v_and_b32 v177, s90, v49
v_sub_f32 v176, v176, v182
v_sub_f32 v177, v177, v183
v_cvt_pk_bf16_f32 v49, v176, v177
v_lshlrev_b32 v176, 16, v50
v_and_b32 v177, s90, v50
v_sub_f32 v176, v176, v184
v_sub_f32 v177, v177, v185
v_cvt_pk_bf16_f32 v50, v176, v177
v_lshlrev_b32 v176, 16, v51
v_and_b32 v177, s90, v51
v_sub_f32 v176, v176, v186
v_sub_f32 v177, v177, v187
v_cvt_pk_bf16_f32 v51, v176, v177
v_lshlrev_b32 v176, 16, v52
v_and_b32 v177, s90, v52
v_sub_f32 v176, v176, v180
v_sub_f32 v177, v177, v181
v_cvt_pk_bf16_f32 v52, v176, v177
v_lshlrev_b32 v176, 16, v53
v_and_b32 v177, s90, v53
v_sub_f32 v176, v176, v182
v_sub_f32 v177, v177, v183
v_cvt_pk_bf16_f32 v53, v176, v177
v_lshlrev_b32 v176, 16, v54
v_and_b32 v177, s90, v54
v_sub_f32 v176, v176, v184
v_sub_f32 v177, v177, v185
v_cvt_pk_bf16_f32 v54, v176, v177
v_lshlrev_b32 v176, 16, v55
v_and_b32 v177, s90, v55
v_sub_f32 v176, v176, v186
v_sub_f32 v177, v177, v187
v_cvt_pk_bf16_f32 v55, v176, v177
ds_write_b128 v36, v[40:43]
ds_write_b128 v37, v[44:47]
ds_write_b128 v38, v[48:51]
ds_write_b128 v39, v[52:55]
s_add_u32 m0, s63, 0x1000
s_nop 0
buffer_load_dwordx4 v17, s[44:47], s68 offen offset:0 lds
buffer_load_dwordx4 v18, s[44:47], s68 offen offset:1024 lds
s_waitcnt vmcnt(4)
ds_read_b64_tr_b16 v[88:89], v25 offset:0
ds_read_b64_tr_b16 v[90:91], v25 offset:256
ds_read_b64_tr_b16 v[92:93], v26 offset:0
ds_read_b64_tr_b16 v[94:95], v26 offset:256
s_waitcnt lgkmcnt(4)
s_barrier
ds_read_b128 v[112:115], v31 offset:0
ds_read_b128 v[116:119], v31 offset:8192
ds_read_b128 v[120:123], v31 offset:16384
ds_read_b128 v[124:127], v31 offset:24576
ds_read_b128 v[128:131], v32 offset:1024
s_waitcnt vmcnt(2)
ds_read_b64_tr_b16 v[96:97], v25 offset:2048
ds_read_b64_tr_b16 v[98:99], v25 offset:2304
s_waitcnt lgkmcnt(6)
v_mfma_f32_16x16x32_bf16 v[56:59], v[112:115], v[88:91], 0
ds_read_b128 v[132:135], v32 offset:9216
s_waitcnt lgkmcnt(6)
v_mfma_f32_16x16x32_bf16 v[60:63], v[116:119], v[88:91], 0
ds_read_b128 v[136:139], v32 offset:17408
s_waitcnt lgkmcnt(6)
v_mfma_f32_16x16x32_bf16 v[64:67], v[120:123], v[88:91], 0
ds_read_b128 v[140:143], v32 offset:25600
s_waitcnt lgkmcnt(6)
v_mfma_f32_16x16x32_bf16 v[68:71], v[124:127], v[88:91], 0
ds_read_b64_tr_b16 v[100:101], v26 offset:2048
ds_read_b64_tr_b16 v[102:103], v26 offset:2304
v_mfma_f32_16x16x32_bf16 v[72:75], v[112:115], v[92:95], 0
s_add_u32 m0, s63, 0x0
s_nop 0
buffer_load_dwordx4 v17, s[44:47], s69 offen offset:0 lds
buffer_load_dwordx4 v18, s[44:47], s69 offen offset:1024 lds
v_mfma_f32_16x16x32_bf16 v[76:79], v[116:119], v[92:95], 0
v_mfma_f32_16x16x32_bf16 v[80:83], v[120:123], v[92:95], 0
v_mfma_f32_16x16x32_bf16 v[84:87], v[124:127], v[92:95], 0
ds_read_b128 v[144:147], v31 offset:2048
s_waitcnt vmcnt(2)
ds_read_b64_tr_b16 v[104:105], v25 offset:4096
ds_read_b64_tr_b16 v[106:107], v25 offset:4352
s_waitcnt lgkmcnt(8)
v_mfma_f32_16x16x32_bf16 v[56:59], v[128:131], v[96:99], v[56:59]
ds_read_b128 v[148:151], v31 offset:10240
s_waitcnt lgkmcnt(8)
v_mfma_f32_16x16x32_bf16 v[60:63], v[132:135], v[96:99], v[60:63]
ds_read_b128 v[152:155], v31 offset:18432
s_waitcnt lgkmcnt(8)
v_mfma_f32_16x16x32_bf16 v[64:67], v[136:139], v[96:99], v[64:67]
ds_read_b128 v[156:159], v31 offset:26624
s_waitcnt lgkmcnt(8)
v_mfma_f32_16x16x32_bf16 v[68:71], v[140:143], v[96:99], v[68:71]
ds_read_b64_tr_b16 v[108:109], v26 offset:4096
ds_read_b64_tr_b16 v[110:111], v26 offset:4352
s_waitcnt lgkmcnt(8)
v_mfma_f32_16x16x32_bf16 v[72:75], v[128:131], v[100:103], v[72:75]
s_add_u32 m0, s63, 0x800
s_nop 0
buffer_load_dwordx4 v17, s[44:47], s70 offen offset:0 lds
buffer_load_dwordx4 v18, s[44:47], s70 offen offset:1024 lds
v_mfma_f32_16x16x32_bf16 v[76:79], v[132:135], v[100:103], v[76:79]
v_mfma_f32_16x16x32_bf16 v[80:83], v[136:139], v[100:103], v[80:83]
v_mfma_f32_16x16x32_bf16 v[84:87], v[140:143], v[100:103], v[84:87]
ds_read_b128 v[160:163], v32 offset:3072
s_waitcnt vmcnt(2)
ds_read_b64_tr_b16 v[88:89], v25 offset:0
ds_read_b64_tr_b16 v[90:91], v25 offset:256
s_waitcnt lgkmcnt(8)
v_mfma_f32_16x16x32_bf16 v[56:59], v[144:147], v[104:107], v[56:59]
ds_read_b128 v[164:167], v32 offset:11264
s_waitcnt lgkmcnt(8)
v_mfma_f32_16x16x32_bf16 v[60:63], v[148:151], v[104:107], v[60:63]
ds_read_b128 v[168:171], v32 offset:19456
s_waitcnt lgkmcnt(8)
v_mfma_f32_16x16x32_bf16 v[64:67], v[152:155], v[104:107], v[64:67]
ds_read_b128 v[172:175], v32 offset:27648
s_waitcnt lgkmcnt(8)
v_mfma_f32_16x16x32_bf16 v[68:71], v[156:159], v[104:107], v[68:71]
ds_read_b64_tr_b16 v[92:93], v26 offset:0
ds_read_b64_tr_b16 v[94:95], v26 offset:256
s_waitcnt lgkmcnt(8)
v_mfma_f32_16x16x32_bf16 v[72:75], v[144:147], v[108:111], v[72:75]
s_add_u32 m0, s63, 0x1000
s_nop 0
buffer_load_dwordx4 v17, s[44:47], s71 offen offset:0 lds
buffer_load_dwordx4 v18, s[44:47], s71 offen offset:1024 lds
v_mfma_f32_16x16x32_bf16 v[76:79], v[148:151], v[108:111], v[76:79]
v_mfma_f32_16x16x32_bf16 v[80:83], v[152:155], v[108:111], v[80:83]
v_mfma_f32_16x16x32_bf16 v[84:87], v[156:159], v[108:111], v[84:87]
ds_read_b128 v[112:115], v31 offset:4096
s_waitcnt vmcnt(2)
ds_read_b64_tr_b16 v[96:97], v25 offset:2048
ds_read_b64_tr_b16 v[98:99], v25 offset:2304
s_waitcnt lgkmcnt(8)
v_mfma_f32_16x16x32_bf16 v[56:59], v[160:163], v[88:91], v[56:59]
ds_read_b128 v[116:119], v31 offset:12288
s_waitcnt lgkmcnt(8)
v_mfma_f32_16x16x32_bf16 v[60:63], v[164:167], v[88:91], v[60:63]
ds_read_b128 v[120:123], v31 offset:20480
s_waitcnt lgkmcnt(8)
v_mfma_f32_16x16x32_bf16 v[64:67], v[168:171], v[88:91], v[64:67]
ds_read_b128 v[124:127], v31 offset:28672
s_waitcnt lgkmcnt(8)
v_mfma_f32_16x16x32_bf16 v[68:71], v[172:175], v[88:91], v[68:71]
ds_read_b64_tr_b16 v[100:101], v26 offset:2048
ds_read_b64_tr_b16 v[102:103], v26 offset:2304
s_waitcnt lgkmcnt(8)
v_mfma_f32_16x16x32_bf16 v[72:75], v[160:163], v[92:95], v[72:75]
s_add_u32 m0, s63, 0x0
s_nop 0
buffer_load_dwordx4 v17, s[44:47], s72 offen offset:0 lds
buffer_load_dwordx4 v18, s[44:47], s72 offen offset:1024 lds
v_mfma_f32_16x16x32_bf16 v[76:79], v[164:167], v[92:95], v[76:79]
v_mfma_f32_16x16x32_bf16 v[80:83], v[168:171], v[92:95], v[80:83]
v_mfma_f32_16x16x32_bf16 v[84:87], v[172:175], v[92:95], v[84:87]
ds_read_b128 v[128:131], v32 offset:5120
s_waitcnt vmcnt(2)
ds_read_b64_tr_b16 v[104:105], v25 offset:4096
ds_read_b64_tr_b16 v[106:107], v25 offset:4352
s_waitcnt lgkmcnt(8)
v_mfma_f32_16x16x32_bf16 v[56:59], v[112:115], v[96:99], v[56:59]
ds_read_b128 v[132:135], v32 offset:13312
s_waitcnt lgkmcnt(8)
v_mfma_f32_16x16x32_bf16 v[60:63], v[116:119], v[96:99], v[60:63]
ds_read_b128 v[136:139], v32 offset:21504
s_waitcnt lgkmcnt(8)
v_mfma_f32_16x16x32_bf16 v[64:67], v[120:123], v[96:99], v[64:67]
ds_read_b128 v[140:143], v32 offset:29696
s_waitcnt lgkmcnt(8)
v_mfma_f32_16x16x32_bf16 v[68:71], v[124:127], v[96:99], v[68:71]
ds_read_b64_tr_b16 v[108:109], v26 offset:4096
ds_read_b64_tr_b16 v[110:111], v26 offset:4352
s_waitcnt lgkmcnt(8)
v_mfma_f32_16x16x32_bf16 v[72:75], v[112:115], v[100:103], v[72:75]
s_add_u32 m0, s63, 0x800
s_nop 0
buffer_load_dwordx4 v17, s[44:47], s73 offen offset:0 lds
buffer_load_dwordx4 v18, s[44:47], s73 offen offset:1024 lds
v_mfma_f32_16x16x32_bf16 v[76:79], v[116:119], v[100:103], v[76:79]
v_mfma_f32_16x16x32_bf16 v[80:83], v[120:123], v[100:103], v[80:83]
v_mfma_f32_16x16x32_bf16 v[84:87], v[124:127], v[100:103], v[84:87]
ds_read_b128 v[144:147], v31 offset:6144
s_waitcnt vmcnt(2)
ds_read_b64_tr_b16 v[88:89], v25 offset:0
ds_read_b64_tr_b16 v[90:91], v25 offset:256
s_waitcnt lgkmcnt(8)
v_mfma_f32_16x16x32_bf16 v[56:59], v[128:131], v[104:107], v[56:59]
ds_read_b128 v[148:151], v31 offset:14336
s_waitcnt lgkmcnt(8)
v_mfma_f32_16x16x32_bf16 v[60:63], v[132:135], v[104:107], v[60:63]
ds_read_b128 v[152:155], v31 offset:22528
s_waitcnt lgkmcnt(8)
v_mfma_f32_16x16x32_bf16 v[64:67], v[136:139], v[104:107], v[64:67]
ds_read_b128 v[156:159], v31 offset:30720
s_waitcnt lgkmcnt(8)
v_mfma_f32_16x16x32_bf16 v[68:71], v[140:143], v[104:107], v[68:71]
ds_read_b64_tr_b16 v[92:93], v26 offset:0
ds_read_b64_tr_b16 v[94:95], v26 offset:256
s_waitcnt lgkmcnt(8)
v_mfma_f32_16x16x32_bf16 v[72:75], v[128:131], v[108:111], v[72:75]
v_mfma_f32_16x16x32_bf16 v[76:79], v[132:135], v[108:111], v[76:79]
v_mfma_f32_16x16x32_bf16 v[80:83], v[136:139], v[108:111], v[80:83]
v_mfma_f32_16x16x32_bf16 v[84:87], v[140:143], v[108:111], v[84:87]
ds_read_b128 v[160:163], v32 offset:7168
s_waitcnt vmcnt(0)
ds_read_b64_tr_b16 v[96:97], v25 offset:2048
ds_read_b64_tr_b16 v[98:99], v25 offset:2304
s_waitcnt lgkmcnt(8)
v_mfma_f32_16x16x32_bf16 v[56:59], v[144:147], v[88:91], v[56:59]
ds_read_b128 v[164:167], v32 offset:15360
s_waitcnt lgkmcnt(8)
v_mfma_f32_16x16x32_bf16 v[60:63], v[148:151], v[88:91], v[60:63]
ds_read_b128 v[168:171], v32 offset:23552
s_waitcnt lgkmcnt(8)
v_mfma_f32_16x16x32_bf16 v[64:67], v[152:155], v[88:91], v[64:67]
ds_read_b128 v[172:175], v32 offset:31744
s_waitcnt lgkmcnt(8)
v_mfma_f32_16x16x32_bf16 v[68:71], v[156:159], v[88:91], v[68:71]
ds_read_b64_tr_b16 v[100:101], v26 offset:2048
ds_read_b64_tr_b16 v[102:103], v26 offset:2304
s_waitcnt lgkmcnt(8)
v_mfma_f32_16x16x32_bf16 v[72:75], v[144:147], v[92:95], v[72:75]
v_mfma_f32_16x16x32_bf16 v[76:79], v[148:151], v[92:95], v[76:79]
v_mfma_f32_16x16x32_bf16 v[80:83], v[152:155], v[92:95], v[80:83]
v_mfma_f32_16x16x32_bf16 v[84:87], v[156:159], v[92:95], v[84:87]
s_waitcnt lgkmcnt(5)
v_mfma_f32_16x16x32_bf16 v[56:59], v[160:163], v[96:99], v[56:59]
s_waitcnt lgkmcnt(4)
v_mfma_f32_16x16x32_bf16 v[60:63], v[164:167], v[96:99], v[60:63]
s_waitcnt lgkmcnt(3)
v_mfma_f32_16x16x32_bf16 v[64:67], v[168:171], v[96:99], v[64:67]
s_waitcnt lgkmcnt(2)
v_mfma_f32_16x16x32_bf16 v[68:71], v[172:175], v[96:99], v[68:71]
s_waitcnt lgkmcnt(0)
v_mfma_f32_16x16x32_bf16 v[72:75], v[160:163], v[100:103], v[72:75]
v_cvt_pk_bf16_f32 v56, v56, v57
v_cvt_pk_bf16_f32 v57, v58, v59
v_cvt_pk_bf16_f32 v58, v60, v61
v_cvt_pk_bf16_f32 v59, v62, v63
buffer_store_dwordx4 v[56:59], v16, s[52:55], s82 offen offset:0 sc1
v_mfma_f32_16x16x32_bf16 v[76:79], v[164:167], v[100:103], v[76:79]
v_mfma_f32_16x16x32_bf16 v[80:83], v[168:171], v[100:103], v[80:83]
v_cvt_pk_bf16_f32 v64, v64, v65
v_cvt_pk_bf16_f32 v65, v66, v67
v_cvt_pk_bf16_f32 v66, v68, v69
v_cvt_pk_bf16_f32 v67, v70, v71
buffer_store_dwordx4 v[64:67], v16, s[52:55], s82 offen offset:2048 sc1
v_mfma_f32_16x16x32_bf16 v[84:87], v[172:175], v[100:103], v[84:87]
v_cvt_pk_bf16_f32 v72, v72, v73
v_cvt_pk_bf16_f32 v73, v74, v75
v_cvt_pk_bf16_f32 v74, v76, v77
v_cvt_pk_bf16_f32 v75, v78, v79
buffer_store_dwordx4 v[72:75], v16, s[52:55], s82 offen offset:1024 sc1
v_cvt_pk_bf16_f32 v80, v80, v81
v_cvt_pk_bf16_f32 v81, v82, v83
s_nop 0
v_cvt_pk_bf16_f32 v82, v84, v85
v_cvt_pk_bf16_f32 v83, v86, v87
buffer_store_dwordx4 v[80:83], v16, s[52:55], s82 offen offset:3072 sc1
s_branch L1_fin
L1_edge:
s_mov_b32 s61, 4
s_mov_b32 s4, s2
s_mul_i32 s6, s4, 20000
v_lshlrev_b32 v5, 4, v0
v_lshlrev_b32 v6, 2, v2
v_add_u32 v6, 0x10000, v6
v_mov_b32 v7, 0
ds_write_b32 v6, v7
s_mov_b32 s66, 0
s_mov_b32 s67, 8192
s_mov_b32 s68, 16384
s_waitcnt lgkmcnt(0)
s_add_u32 s56, s38, 0x7c00000
s_addc_u32 s57, s39, 0
s_mov_b32 s58, 0x2000
s_mov_b32 s59, 0x00020000
s_cmp_eq_u32 s4, 0
s_cselect_b32 s9, 0, 0x7fff0000
v_mov_b32 v8, 0
v_mov_b32 v9, 0
v_mov_b32 v10, 0
v_mov_b32 v11, 0
buffer_store_dwordx4 v[8:11], v5, s[56:59], s9 offen
s_add_u32 s40, s20, 0x0
s_addc_u32 s41, s21, 0
s_add_u32 s40, s40, s6
s_addc_u32 s41, s41, 0
s_mov_b32 s42, 0x4e20
s_mov_b32 s43, 0x00020000
s_add_u32 s44, s18, 0x0
s_addc_u32 s45, s19, 0
s_add_u32 s44, s44, s6
s_addc_u32 s45, s45, 0
s_mov_b32 s46, 0x4e20
s_mov_b32 s47, 0x00020000
buffer_load_dwordx4 v[16:19], v5, s[40:43], s66 offen
buffer_load_dwordx4 v[20:23], v5, s[40:43], s67 offen
buffer_load_dwordx4 v[24:27], v5, s[40:43], s68 offen
buffer_load_dwordx4 v[28:31], v5, s[44:47], s66 offen
buffer_load_dwordx4 v[32:35], v5, s[44:47], s67 offen
buffer_load_dwordx4 v[36:39], v5, s[44:47], s68 offen
s_add_u32 s48, s38, 0x8000000
s_addc_u32 s49, s39, 0
s_mov_b32 s50, 0x2800000
s_mov_b32 s51, 0x00020000
s_add_u32 s52, s38, 0x7800000
s_addc_u32 s53, s39, 0
s_mov_b32 s54, 0x2000
s_mov_b32 s55, 0x00020000
s_mov_b32 s9, 6279
s_mov_b32 s10, 4294967129
s_mov_b32 s11, 0x10000
v_mov_b32 v7, 1
v_cmp_gt_u32 vcc, 0xe2, v0
s_mov_b64 s[12:13], vcc
s_barrier
s_waitcnt vmcnt(5)
v_mul_u32_u24 v40, s9, v16
v_lshrrev_b32 v40, 20, v40
v_lshl_add_u32 v52, v40, 2, s11
ds_add_rtn_u32 v52, v52, v7
v_mad_i32_i24 v16, v40, s10, v16
v_mul_u32_u24 v41, s9, v17
v_lshrrev_b32 v41, 20, v41
v_lshl_add_u32 v53, v41, 2, s11
ds_add_rtn_u32 v53, v53, v7
v_mad_i32_i24 v17, v41, s10, v17
v_mul_u32_u24 v42, s9, v18
v_lshrrev_b32 v42, 20, v42
v_lshl_add_u32 v54, v42, 2, s11
ds_add_rtn_u32 v54, v54, v7
v_mad_i32_i24 v18, v42, s10, v18
v_mul_u32_u24 v43, s9, v19
v_lshrrev_b32 v43, 20, v43
v_lshl_add_u32 v55, v43, 2, s11
ds_add_rtn_u32 v55, v55, v7
v_mad_i32_i24 v19, v43, s10, v19
s_waitcnt vmcnt(4)
v_mul_u32_u24 v44, s9, v20
v_lshrrev_b32 v44, 20, v44
v_lshl_add_u32 v56, v44, 2, s11
ds_add_rtn_u32 v56, v56, v7
v_mad_i32_i24 v20, v44, s10, v20
v_mul_u32_u24 v45, s9, v21
v_lshrrev_b32 v45, 20, v45
v_lshl_add_u32 v57, v45, 2, s11
ds_add_rtn_u32 v57, v57, v7
v_mad_i32_i24 v21, v45, s10, v21
v_mul_u32_u24 v46, s9, v22
v_lshrrev_b32 v46, 20, v46
v_lshl_add_u32 v58, v46, 2, s11
ds_add_rtn_u32 v58, v58, v7
v_mad_i32_i24 v22, v46, s10, v22
v_mul_u32_u24 v47, s9, v23
v_lshrrev_b32 v47, 20, v47
v_lshl_add_u32 v59, v47, 2, s11
ds_add_rtn_u32 v59, v59, v7
v_mad_i32_i24 v23, v47, s10, v23
s_waitcnt vmcnt(3)
s_mov_b64 exec, s[12:13]
v_mul_u32_u24 v48, s9, v24
v_lshrrev_b32 v48, 20, v48
v_lshl_add_u32 v60, v48, 2, s11
ds_add_rtn_u32 v60, v60, v7
v_mad_i32_i24 v24, v48, s10, v24
v_mul_u32_u24 v49, s9, v25
v_lshrrev_b32 v49, 20, v49
v_lshl_add_u32 v61, v49, 2, s11
ds_add_rtn_u32 v61, v61, v7
v_mad_i32_i24 v25, v49, s10, v25
v_mul_u32_u24 v50, s9, v26
v_lshrrev_b32 v50, 20, v50
v_lshl_add_u32 v62, v50, 2, s11
ds_add_rtn_u32 v62, v62, v7
v_mad_i32_i24 v26, v50, s10, v26
v_mul_u32_u24 v51, s9, v27
v_lshrrev_b32 v51, 20, v51
v_lshl_add_u32 v63, v51, 2, s11
ds_add_rtn_u32 v63, v63, v7
v_mad_i32_i24 v27, v51, s10, v27
s_mov_b64 exec, -1
s_waitcnt vmcnt(2) lgkmcnt(4)
v_and_b32 v8, 0x7f, v52
v_lshl_or_b32 v28, v16, 18, v28
v_lshlrev_b32 v8, 2, v8
v_lshl_add_u32 v8, v40, 9, v8
ds_write_b32 v8, v28
v_and_b32 v8, 0x7f, v53
v_lshl_or_b32 v29, v17, 18, v29
v_lshlrev_b32 v8, 2, v8
v_lshl_add_u32 v8, v41, 9, v8
ds_write_b32 v8, v29
v_and_b32 v8, 0x7f, v54
v_lshl_or_b32 v30, v18, 18, v30
v_lshlrev_b32 v8, 2, v8
v_lshl_add_u32 v8, v42, 9, v8
ds_write_b32 v8, v30
v_and_b32 v8, 0x7f, v55
v_lshl_or_b32 v31, v19, 18, v31
v_lshlrev_b32 v8, 2, v8
v_lshl_add_u32 v8, v43, 9, v8
ds_write_b32 v8, v31
s_waitcnt vmcnt(1) lgkmcnt(4)
v_and_b32 v8, 0x7f, v56
v_lshl_or_b32 v32, v20, 18, v32
v_lshlrev_b32 v8, 2, v8
v_lshl_add_u32 v8, v44, 9, v8
ds_write_b32 v8, v32
v_and_b32 v8, 0x7f, v57
v_lshl_or_b32 v33, v21, 18, v33
v_lshlrev_b32 v8, 2, v8
v_lshl_add_u32 v8, v45, 9, v8
ds_write_b32 v8, v33
v_and_b32 v8, 0x7f, v58
v_lshl_or_b32 v34, v22, 18, v34
v_lshlrev_b32 v8, 2, v8
v_lshl_add_u32 v8, v46, 9, v8
ds_write_b32 v8, v34
v_and_b32 v8, 0x7f, v59
v_lshl_or_b32 v35, v23, 18, v35
v_lshlrev_b32 v8, 2, v8
v_lshl_add_u32 v8, v47, 9, v8
ds_write_b32 v8, v35
s_waitcnt vmcnt(0) lgkmcnt(8)
s_mov_b64 exec, s[12:13]
v_and_b32 v8, 0x7f, v60
v_lshl_or_b32 v36, v24, 18, v36
v_lshlrev_b32 v8, 2, v8
v_lshl_add_u32 v8, v48, 9, v8
ds_write_b32 v8, v36
v_and_b32 v8, 0x7f, v61
v_lshl_or_b32 v37, v25, 18, v37
v_lshlrev_b32 v8, 2, v8
v_lshl_add_u32 v8, v49, 9, v8
ds_write_b32 v8, v37
v_and_b32 v8, 0x7f, v62
v_lshl_or_b32 v38, v26, 18, v38
v_lshlrev_b32 v8, 2, v8
v_lshl_add_u32 v8, v50, 9, v8
ds_write_b32 v8, v38
v_and_b32 v8, 0x7f, v63
v_lshl_or_b32 v39, v27, 18, v39
v_lshlrev_b32 v8, 2, v8
v_lshl_add_u32 v8, v51, 9, v8
ds_write_b32 v8, v39
s_mov_b64 exec, -1
s_waitcnt lgkmcnt(0)
s_barrier
ds_read_b32 v8, v6
s_mul_i32 s6, s60, 4096
v_lshlrev_b32 v10, 4, v2
v_add_u32 v9, s6, v10
ds_read_b128 v[64:67], v9 offset:0
ds_read_b128 v[68:71], v9 offset:1024
ds_read_b128 v[72:75], v9 offset:2048
ds_read_b128 v[76:79], v9 offset:3072
v_lshrrev_b32 v11, 5, v2
v_mul_u32_u24 v11, 0x9fe00, v11
v_add_u32 v10, v10, v11
s_mul_i32 s6, s60, 5242880
s_mul_i32 s7, s4, 20480
s_add_u32 s6, s6, s7
v_lshlrev_b32 v9, 7, v2
s_lshl_b32 s8, s4, 2
s_cmp_eq_u32 s60, 0
s_cselect_b32 s8, s8, 0x7fff0000
s_waitcnt lgkmcnt(4)
buffer_store_dword v8, v9, s[52:55], s8 offen sc1
v_cmp_lt_u32 vcc, 0x80, v8
s_cbranch_vccnz L1_eslow
s_waitcnt lgkmcnt(3)
buffer_store_dwordx4 v[64:67], v10, s[48:51], s6 offen sc1
s_add_u32 s6, s6, 1310720
s_waitcnt lgkmcnt(2)
buffer_store_dwordx4 v[68:71], v10, s[48:51], s6 offen sc1
s_add_u32 s6, s6, 1310720
s_waitcnt lgkmcnt(1)
buffer_store_dwordx4 v[72:75], v10, s[48:51], s6 offen sc1
s_add_u32 s6, s6, 1310720
s_waitcnt lgkmcnt(0)
buffer_store_dwordx4 v[76:79], v10, s[48:51], s6 offen sc1
s_add_u32 s6, s6, 1310720
s_branch L1_fin
L1_eslow:
s_mov_b32 s9, 655360
v_mul_u32_u24 v40, s9, v40
v_lshl_add_u32 v40, v52, 2, v40
v_mul_u32_u24 v41, s9, v41
v_lshl_add_u32 v41, v53, 2, v41
v_mul_u32_u24 v42, s9, v42
v_lshl_add_u32 v42, v54, 2, v42
v_mul_u32_u24 v43, s9, v43
v_lshl_add_u32 v43, v55, 2, v43
v_mul_u32_u24 v44, s9, v44
v_lshl_add_u32 v44, v56, 2, v44
v_mul_u32_u24 v45, s9, v45
v_lshl_add_u32 v45, v57, 2, v45
v_mul_u32_u24 v46, s9, v46
v_lshl_add_u32 v46, v58, 2, v46
v_mul_u32_u24 v47, s9, v47
v_lshl_add_u32 v47, v59, 2, v47
v_mul_u32_u24 v48, s9, v48
v_lshl_add_u32 v48, v60, 2, v48
v_mul_u32_u24 v49, s9, v49
v_lshl_add_u32 v49, v61, 2, v49
v_mul_u32_u24 v50, s9, v50
v_lshl_add_u32 v50, v62, 2, v50
v_mul_u32_u24 v51, s9, v51
v_lshl_add_u32 v51, v63, 2, v51
buffer_store_dword v28, v40, s[48:51], s7 offen
buffer_store_dword v29, v41, s[48:51], s7 offen
buffer_store_dword v30, v42, s[48:51], s7 offen
buffer_store_dword v31, v43, s[48:51], s7 offen
buffer_store_dword v32, v44, s[48:51], s7 offen
buffer_store_dword v33, v45, s[48:51], s7 offen
buffer_store_dword v34, v46, s[48:51], s7 offen
buffer_store_dword v35, v47, s[48:51], s7 offen
s_mov_b64 exec, s[12:13]
buffer_store_dword v36, v48, s[48:51], s7 offen
buffer_store_dword v37, v49, s[48:51], s7 offen
buffer_store_dword v38, v50, s[48:51], s7 offen
buffer_store_dword v39, v51, s[48:51], s7 offen
s_mov_b64 exec, -1
L1_fin:
L1_end:
s_endpgm
.globl k2_kernel
.p2align 8
.type k2_kernel,@function
k2_kernel:
s_load_dwordx2 s[4:5], s[0:1], 88
s_load_dwordx2 s[6:7], s[0:1], 0
s_load_dwordx2 s[18:19], s[0:1], 72
s_and_b32 s35, s2, 7
s_lshr_b32 s37, s2, 3
s_cmp_ge_u32 s37, 30
s_cbranch_scc1 LE_start
s_mul_i32 s38, s37, 52
s_lshr_b32 s38, s38, 8
s_mul_i32 s39, s38, 5
s_sub_u32 s39, s37, s39
s_mov_b32 s37, s38
s_mul_i32 s38, s35, 5
s_add_u32 s38, s38, s39
v_lshrrev_b32 v1, 6, v0
v_and_b32 v252, 63, v0
v_lshlrev_b32 v252, 4, v252
v_readfirstlane_b32 s34, v1
s_mov_b32 s50, 0xe1a06800
s_mov_b32 s51, 0x4e608d04
s_mul_i32 s39, s37, 9
s_lshr_b64 s[50:51], s[50:51], s39
s_and_b32 s39, s50, 0x1ff
s_bfe_u32 s49, s50, 0x90009
s_sub_u32 s29, s49, s39
s_lshl_b32 s50, s37, 2
s_lshr_b32 s59, 0x766666, s50
s_and_b32 s59, s59, 15
s_sub_u32 s31, s29, s59
s_lshr_b32 s31, s31, 1
s_sub_u32 s31, s31, 1
s_lshl_b32 s39, s39, 14
s_lshl_b32 s49, s49, 14
s_add_u32 s28, s39, 0x4000
s_cmp_eq_u32 s37, 5
s_cselect_b32 s33, 0xff800000, 0
s_mov_b32 s32, 0xffff
v_and_b32 v2, 63, v0
v_bfe_u32 v3, v2, 3, 2
v_bfe_u32 v4, v2, 2, 1
v_lshlrev_b32 v251, 12, v3
v_lshl_or_b32 v251, v4, 9, v251
v_lshl_or_b32 v251, v1, 7, v251
v_lshrrev_b32 v4, 5, v2
v_lshl_or_b32 v251, v4, 6, v251
v_and_b32 v3, 2, v3
v_and_b32 v4, 3, v2
v_xor_b32 v3, v3, v4
v_lshl_or_b32 v251, v3, 4, v251
s_cmp_eq_u32 s38, 39
s_cbranch_scc1 LT_disp
s_lshl_b32 s30, s34, 12
s_mov_b32 m0, s30
s_waitcnt lgkmcnt(0)
s_add_u32 s12, s4, 0x6800000
s_addc_u32 s13, s5, 0
s_mov_b32 s14, s49
s_mov_b32 s15, 0x00020000
buffer_load_dwordx4 v251, s[12:15], s39 offen offset:0 lds
buffer_load_dwordx4 v251, s[12:15], s39 offen offset:1024 lds
buffer_load_dwordx4 v251, s[12:15], s39 offen offset:2048 lds
buffer_load_dwordx4 v251, s[12:15], s39 offen offset:3072 lds
s_add_u32 m0, s30, 0x4000
s_nop 0
buffer_load_dwordx4 v251, s[12:15], s28 offen offset:0 lds
buffer_load_dwordx4 v251, s[12:15], s28 offen offset:1024 lds
s_add_u32 s8, s4, 0x0
s_addc_u32 s9, s5, 0
s_mov_b32 s10, 0x4e4000
s_mov_b32 s11, 0x00020000
s_mul_i32 s35, s37, 0x600000
s_add_u32 s20, s4, 0x2000000
s_addc_u32 s21, s5, 0
s_add_u32 s20, s20, s35
s_addc_u32 s21, s21, 0
s_mov_b32 s22, 0x4e4000
s_mov_b32 s23, 0x00020000
s_add_u32 s24, s4, 0x6000000
s_addc_u32 s25, s5, 0
s_mov_b32 s26, 0x9c800
s_mov_b32 s27, 0x00020000
s_lshl_b32 s35, s38, 4
s_lshl_b32 s41, s34, 2
s_add_u32 s35, s35, s41
s_mul_i32 s41, s37, 3
s_sub_u32 s42, s34, s41
s_and_b32 s42, s42, 3
s_add_u32 s41, s41, s42
s_lshr_b32 s41, s41, 2
s_cmp_eq_u32 s37, 5
s_cselect_b32 s42, 3, s42
s_cmp_lt_u32 s42, 3
s_cselect_b32 s41, s41, 0
s_cselect_b32 s50, 1, 0
s_add_u32 s35, s35, s41
s_lshl_b32 s40, s35, 13
s_lshl_b32 s48, s35, 10
s_lshl_b32 s35, s37, 3
s_add_u32 s48, s48, s35
s_xor_b32 s41, s40, 8192
s_xor_b32 s42, s40, 16384
s_xor_b32 s43, s40, 24576
s_add_u32 s44, s40, 4096
s_add_u32 s45, s41, 4096
s_add_u32 s46, s42, 4096
s_add_u32 s47, s43, 4096
s_mul_i32 s35, s37, 3
s_and_b32 s36, s35, 3
s_lshl_b32 s36, s36, 2
s_lshr_b32 s52, s35, 2
s_add_u32 s36, s36, s52
s_lshl_b32 s52, s38, 4
s_add_u32 s52, s52, s36
s_lshl_b32 s52, s52, 13
s_add_u32 s35, s35, 1
s_and_b32 s36, s35, 3
s_lshl_b32 s36, s36, 2
s_lshr_b32 s53, s35, 2
s_add_u32 s36, s36, s53
s_lshl_b32 s53, s38, 4
s_add_u32 s53, s53, s36
s_lshl_b32 s53, s53, 13
s_add_u32 s35, s35, 1
s_and_b32 s36, s35, 3
s_lshl_b32 s36, s36, 2
s_lshr_b32 s54, s35, 2
s_add_u32 s36, s36, s54
s_lshl_b32 s54, s38, 4
s_add_u32 s54, s54, s36
s_lshl_b32 s54, s54, 13
v_mov_b32 v208, 0
v_mov_b32 v209, 0
v_mov_b32 v210, 0
v_mov_b32 v211, 0
buffer_load_dwordx4 v[0:3], v252, s[8:11], s40 offen offset:0
buffer_load_dwordx4 v[32:35], v252, s[8:11], s41 offen offset:0
v_mfma_f32_32x32x16_bf16 a[0:15], v[208:211], v[208:211], 0
buffer_load_dwordx4 v[64:67], v252, s[8:11], s42 offen offset:0
v_mfma_f32_32x32x16_bf16 a[16:31], v[208:211], v[208:211], 0
buffer_load_dwordx4 v[96:99], v252, s[8:11], s43 offen offset:0
buffer_load_dwordx4 v[4:7], v252, s[8:11], s40 offen offset:1024
v_mfma_f32_32x32x16_bf16 a[32:47], v[208:211], v[208:211], 0
buffer_load_dwordx4 v[36:39], v252, s[8:11], s41 offen offset:1024
v_mfma_f32_32x32x16_bf16 a[48:63], v[208:211], v[208:211], 0
buffer_load_dwordx4 v[68:71], v252, s[8:11], s42 offen offset:1024
buffer_load_dwordx4 v[100:103], v252, s[8:11], s43 offen offset:1024
v_mfma_f32_32x32x16_bf16 a[64:79], v[208:211], v[208:211], 0
buffer_load_dwordx4 v[8:11], v252, s[8:11], s40 offen offset:2048
v_mfma_f32_32x32x16_bf16 a[80:95], v[208:211], v[208:211], 0
buffer_load_dwordx4 v[40:43], v252, s[8:11], s41 offen offset:2048
buffer_load_dwordx4 v[72:75], v252, s[8:11], s42 offen offset:2048
v_mfma_f32_32x32x16_bf16 a[96:111], v[208:211], v[208:211], 0
buffer_load_dwordx4 v[104:107], v252, s[8:11], s43 offen offset:2048
v_mfma_f32_32x32x16_bf16 a[112:127], v[208:211], v[208:211], 0
buffer_load_dwordx4 v[12:15], v252, s[8:11], s40 offen offset:3072
buffer_load_dwordx4 v[44:47], v252, s[8:11], s41 offen offset:3072
v_mfma_f32_32x32x16_bf16 a[128:143], v[208:211], v[208:211], 0
buffer_load_dwordx4 v[76:79], v252, s[8:11], s42 offen offset:3072
v_mfma_f32_32x32x16_bf16 a[144:159], v[208:211], v[208:211], 0
buffer_load_dwordx4 v[108:111], v252, s[8:11], s43 offen offset:3072
buffer_load_dwordx4 v[16:19], v252, s[8:11], s44 offen offset:0
v_mfma_f32_32x32x16_bf16 a[160:175], v[208:211], v[208:211], 0
buffer_load_dwordx4 v[48:51], v252, s[8:11], s45 offen offset:0
v_mfma_f32_32x32x16_bf16 a[176:191], v[208:211], v[208:211], 0
buffer_load_dwordx4 v[80:83], v252, s[8:11], s46 offen offset:0
buffer_load_dwordx4 v[112:115], v252, s[8:11], s47 offen offset:0
v_mfma_f32_32x32x16_bf16 a[192:207], v[208:211], v[208:211], 0
buffer_load_dwordx4 v[20:23], v252, s[8:11], s44 offen offset:1024
v_mfma_f32_32x32x16_bf16 a[208:223], v[208:211], v[208:211], 0
buffer_load_dwordx4 v[52:55], v252, s[8:11], s45 offen offset:1024
buffer_load_dwordx4 v[84:87], v252, s[8:11], s46 offen offset:1024
v_mfma_f32_32x32x16_bf16 a[224:239], v[208:211], v[208:211], 0
buffer_load_dwordx4 v[116:119], v252, s[8:11], s47 offen offset:1024
v_mfma_f32_32x32x16_bf16 a[240:255], v[208:211], v[208:211], 0
v_bfe_u32 v248, v252, 4, 3
v_lshlrev_b32 v248, 6, v248
v_bfe_u32 v253, v252, 7, 1
v_lshl_or_b32 v248, v253, 10, v248
v_bfe_u32 v253, v252, 8, 2
v_lshl_or_b32 v248, v253, 4, v248
v_bfe_u32 v253, v252, 6, 1
v_lshlrev_b32 v253, 5, v253
v_xor_b32 v248, v248, v253
v_and_b32 v249, 0x1c0, v252
v_bfe_u32 v253, v252, 9, 1
v_lshl_or_b32 v249, v253, 10, v249
v_bfe_u32 v253, v252, 8, 1
v_lshl_or_b32 v249, v253, 5, v249
v_bfe_u32 v253, v252, 4, 2
v_lshl_or_b32 v249, v253, 3, v249
v_xor_b32 v250, 32, v249
s_waitcnt vmcnt(24)
s_barrier
ds_read_b128 v[224:227], v248 offset:0
ds_read_b128 v[228:231], v248 offset:512
ds_read_b128 v[232:235], v248 offset:2048
ds_read_b128 v[236:239], v248 offset:2560
s_waitcnt lgkmcnt(2)
s_waitcnt vmcnt(16)
v_mfma_f32_16x16x32_bf16 v[160:163], v[224:227], v[0:3], 0
ds_read_b128 v[240:243], v248 offset:16384
v_mfma_f32_16x16x32_bf16 v[160:163], v[228:231], v[4:7], v[160:163]
buffer_load_dwordx4 v[24:27], v252, s[8:11], s44 offen offset:2048
v_mfma_f32_16x16x32_bf16 v[164:167], v[224:227], v[32:35], 0
v_mfma_f32_16x16x32_bf16 v[164:167], v[228:231], v[36:39], v[164:167]
buffer_load_dwordx4 v[56:59], v252, s[8:11], s45 offen offset:2048
v_mfma_f32_16x16x32_bf16 v[168:171], v[224:227], v[64:67], 0
ds_read_b128 v[244:247], v248 offset:16896
v_mfma_f32_16x16x32_bf16 v[168:171], v[228:231], v[68:71], v[168:171]
buffer_load_dwordx4 v[88:91], v252, s[8:11], s46 offen offset:2048
v_mfma_f32_16x16x32_bf16 v[172:175], v[224:227], v[96:99], 0
v_mfma_f32_16x16x32_bf16 v[172:175], v[228:231], v[100:103], v[172:175]
s_waitcnt lgkmcnt(2)
buffer_load_dwordx4 v[120:123], v252, s[8:11], s47 offen offset:2048
v_mfma_f32_16x16x32_bf16 v[176:179], v[232:235], v[0:3], 0
ds_read_b128 v[224:227], v248 offset:4096
v_mfma_f32_16x16x32_bf16 v[176:179], v[236:239], v[4:7], v[176:179]
buffer_load_dwordx4 v[28:31], v252, s[8:11], s44 offen offset:3072
v_mfma_f32_16x16x32_bf16 v[180:183], v[232:235], v[32:35], 0
v_mfma_f32_16x16x32_bf16 v[180:183], v[236:239], v[36:39], v[180:183]
buffer_load_dwordx4 v[60:63], v252, s[8:11], s45 offen offset:3072
v_mfma_f32_16x16x32_bf16 v[184:187], v[232:235], v[64:67], 0
ds_read_b128 v[228:231], v248 offset:4608
v_mfma_f32_16x16x32_bf16 v[184:187], v[236:239], v[68:71], v[184:187]
buffer_load_dwordx4 v[92:95], v252, s[8:11], s46 offen offset:3072
v_mfma_f32_16x16x32_bf16 v[188:191], v[232:235], v[96:99], 0
v_mfma_f32_16x16x32_bf16 v[188:191], v[236:239], v[100:103], v[188:191]
s_waitcnt lgkmcnt(2)
buffer_load_dwordx4 v[124:127], v252, s[8:11], s47 offen offset:3072
v_mfma_f32_16x16x32_bf16 v[192:195], v[240:243], v[0:3], 0
ds_read_b128 v[232:235], v248 offset:6144
v_mfma_f32_16x16x32_bf16 v[192:195], v[244:247], v[4:7], v[192:195]
v_mfma_f32_16x16x32_bf16 v[196:199], v[240:243], v[32:35], 0
v_mfma_f32_16x16x32_bf16 v[196:199], v[244:247], v[36:39], v[196:199]
v_mfma_f32_16x16x32_bf16 v[200:203], v[240:243], v[64:67], 0
ds_read_b128 v[236:239], v248 offset:6656
v_mfma_f32_16x16x32_bf16 v[200:203], v[244:247], v[68:71], v[200:203]
v_mfma_f32_16x16x32_bf16 v[204:207], v[240:243], v[96:99], 0
v_mfma_f32_16x16x32_bf16 v[204:207], v[244:247], v[100:103], v[204:207]
s_waitcnt lgkmcnt(2)
s_waitcnt vmcnt(16)
v_mfma_f32_16x16x32_bf16 v[160:163], v[224:227], v[8:11], v[160:163]
ds_read_b128 v[240:243], v248 offset:20480
v_mfma_f32_16x16x32_bf16 v[160:163], v[228:231], v[12:15], v[160:163]
buffer_load_dwordx4 v251, s[12:15], s28 offen offset:2048 lds
v_mfma_f32_16x16x32_bf16 v[164:167], v[224:227], v[40:43], v[164:167]
v_mfma_f32_16x16x32_bf16 v[164:167], v[228:231], v[44:47], v[164:167]
buffer_load_dwordx4 v251, s[12:15], s28 offen offset:3072 lds
v_mfma_f32_16x16x32_bf16 v[168:171], v[224:227], v[72:75], v[168:171]
ds_read_b128 v[244:247], v248 offset:20992
v_mfma_f32_16x16x32_bf16 v[168:171], v[228:231], v[76:79], v[168:171]
s_add_u32 s28, s28, 0x4000
s_add_u32 m0, s30, 0x8000
s_nop 0
v_mfma_f32_16x16x32_bf16 v[172:175], v[224:227], v[104:107], v[172:175]
v_mfma_f32_16x16x32_bf16 v[172:175], v[228:231], v[108:111], v[172:175]
s_waitcnt lgkmcnt(2)
buffer_load_dwordx4 v251, s[12:15], s28 offen offset:0 lds
v_mfma_f32_16x16x32_bf16 v[176:179], v[232:235], v[8:11], v[176:179]
ds_read_b128 v[224:227], v248 offset:8192
v_mfma_f32_16x16x32_bf16 v[176:179], v[236:239], v[12:15], v[176:179]
buffer_load_dwordx4 v251, s[12:15], s28 offen offset:1024 lds
v_mfma_f32_16x16x32_bf16 v[180:183], v[232:235], v[40:43], v[180:183]
v_mfma_f32_16x16x32_bf16 v[180:183], v[236:239], v[44:47], v[180:183]
buffer_load_dwordx4 v251, s[12:15], s28 offen offset:2048 lds
v_mfma_f32_16x16x32_bf16 v[184:187], v[232:235], v[72:75], v[184:187]
ds_read_b128 v[228:231], v248 offset:8704
v_mfma_f32_16x16x32_bf16 v[184:187], v[236:239], v[76:79], v[184:187]
buffer_load_dwordx4 v251, s[12:15], s28 offen offset:3072 lds
v_mfma_f32_16x16x32_bf16 v[188:191], v[232:235], v[104:107], v[188:191]
v_mfma_f32_16x16x32_bf16 v[188:191], v[236:239], v[108:111], v[188:191]
s_waitcnt lgkmcnt(2)
v_mfma_f32_16x16x32_bf16 v[192:195], v[240:243], v[8:11], v[192:195]
ds_read_b128 v[232:235], v248 offset:10240
v_mfma_f32_16x16x32_bf16 v[192:195], v[244:247], v[12:15], v[192:195]
v_mfma_f32_16x16x32_bf16 v[196:199], v[240:243], v[40:43], v[196:199]
v_mfma_f32_16x16x32_bf16 v[196:199], v[244:247], v[44:47], v[196:199]
v_mfma_f32_16x16x32_bf16 v[200:203], v[240:243], v[72:75], v[200:203]
ds_read_b128 v[236:239], v248 offset:10752
v_mfma_f32_16x16x32_bf16 v[200:203], v[244:247], v[76:79], v[200:203]
v_mfma_f32_16x16x32_bf16 v[204:207], v[240:243], v[104:107], v[204:207]
v_mfma_f32_16x16x32_bf16 v[204:207], v[244:247], v[108:111], v[204:207]
s_waitcnt lgkmcnt(2)
s_waitcnt vmcnt(14)
v_mfma_f32_16x16x32_bf16 v[160:163], v[224:227], v[16:19], v[160:163]
ds_read_b128 v[240:243], v248 offset:24576
v_mfma_f32_16x16x32_bf16 v[160:163], v[228:231], v[20:23], v[160:163]
s_add_u32 s28, s28, 0x4000
s_add_u32 m0, s30, 0xc000
s_nop 0
v_mfma_f32_16x16x32_bf16 v[164:167], v[224:227], v[48:51], v[164:167]
v_mfma_f32_16x16x32_bf16 v[164:167], v[228:231], v[52:55], v[164:167]
buffer_load_dwordx4 v251, s[12:15], s28 offen offset:0 lds
v_mfma_f32_16x16x32_bf16 v[168:171], v[224:227], v[80:83], v[168:171]
ds_read_b128 v[244:247], v248 offset:25088
v_mfma_f32_16x16x32_bf16 v[168:171], v[228:231], v[84:87], v[168:171]
buffer_load_dwordx4 v251, s[12:15], s28 offen offset:1024 lds
v_mfma_f32_16x16x32_bf16 v[172:175], v[224:227], v[112:115], v[172:175]
v_mfma_f32_16x16x32_bf16 v[172:175], v[228:231], v[116:119], v[172:175]
s_waitcnt lgkmcnt(2)
buffer_load_dwordx4 v251, s[12:15], s28 offen offset:2048 lds
v_mfma_f32_16x16x32_bf16 v[176:179], v[232:235], v[16:19], v[176:179]
ds_read_b128 v[224:227], v248 offset:12288
v_mfma_f32_16x16x32_bf16 v[176:179], v[236:239], v[20:23], v[176:179]
buffer_load_dwordx4 v251, s[12:15], s28 offen offset:3072 lds
v_mfma_f32_16x16x32_bf16 v[180:183], v[232:235], v[48:51], v[180:183]
v_mfma_f32_16x16x32_bf16 v[180:183], v[236:239], v[52:55], v[180:183]
v_mfma_f32_16x16x32_bf16 v[184:187], v[232:235], v[80:83], v[184:187]
ds_read_b128 v[228:231], v248 offset:12800
v_mfma_f32_16x16x32_bf16 v[184:187], v[236:239], v[84:87], v[184:187]
v_mfma_f32_16x16x32_bf16 v[188:191], v[232:235], v[112:115], v[188:191]
v_mfma_f32_16x16x32_bf16 v[188:191], v[236:239], v[116:119], v[188:191]
s_waitcnt lgkmcnt(2)
v_mfma_f32_16x16x32_bf16 v[192:195], v[240:243], v[16:19], v[192:195]
ds_read_b128 v[232:235], v248 offset:14336
v_mfma_f32_16x16x32_bf16 v[192:195], v[244:247], v[20:23], v[192:195]
v_mfma_f32_16x16x32_bf16 v[196:199], v[240:243], v[48:51], v[196:199]
v_mfma_f32_16x16x32_bf16 v[196:199], v[244:247], v[52:55], v[196:199]
v_mfma_f32_16x16x32_bf16 v[200:203], v[240:243], v[80:83], v[200:203]
ds_read_b128 v[236:239], v248 offset:14848
v_mfma_f32_16x16x32_bf16 v[200:203], v[244:247], v[84:87], v[200:203]
v_mfma_f32_16x16x32_bf16 v[204:207], v[240:243], v[112:115], v[204:207]
v_mfma_f32_16x16x32_bf16 v[204:207], v[244:247], v[116:119], v[204:207]
s_waitcnt lgkmcnt(2)
s_waitcnt vmcnt(10)
v_mfma_f32_16x16x32_bf16 v[160:163], v[224:227], v[24:27], v[160:163]
ds_read_b128 v[240:243], v248 offset:28672
v_mfma_f32_16x16x32_bf16 v[160:163], v[228:231], v[28:31], v[160:163]
s_add_u32 s28, s28, 0x4000
s_add_u32 m0, s30, 0x10000
s_nop 0
v_mfma_f32_16x16x32_bf16 v[164:167], v[224:227], v[56:59], v[164:167]
v_mfma_f32_16x16x32_bf16 v[164:167], v[228:231], v[60:63], v[164:167]
buffer_load_dwordx4 v251, s[12:15], s28 offen offset:0 lds
v_mfma_f32_16x16x32_bf16 v[168:171], v[224:227], v[88:91], v[168:171]
ds_read_b128 v[244:247], v248 offset:29184
v_mfma_f32_16x16x32_bf16 v[168:171], v[228:231], v[92:95], v[168:171]
buffer_load_dwordx4 v251, s[12:15], s28 offen offset:1024 lds
v_mfma_f32_16x16x32_bf16 v[172:175], v[224:227], v[120:123], v[172:175]
v_mfma_f32_16x16x32_bf16 v[172:175], v[228:231], v[124:127], v[172:175]
s_waitcnt lgkmcnt(2)
buffer_load_dwordx4 v251, s[12:15], s28 offen offset:2048 lds
v_mfma_f32_16x16x32_bf16 v[176:179], v[232:235], v[24:27], v[176:179]
v_mfma_f32_16x16x32_bf16 v[176:179], v[236:239], v[28:31], v[176:179]
buffer_load_dwordx4 v251, s[12:15], s28 offen offset:3072 lds
v_mfma_f32_16x16x32_bf16 v[180:183], v[232:235], v[56:59], v[180:183]
v_mfma_f32_16x16x32_bf16 v[180:183], v[236:239], v[60:63], v[180:183]
v_mfma_f32_16x16x32_bf16 v[184:187], v[232:235], v[88:91], v[184:187]
v_mfma_f32_16x16x32_bf16 v[184:187], v[236:239], v[92:95], v[184:187]
v_mfma_f32_16x16x32_bf16 v[188:191], v[232:235], v[120:123], v[188:191]
v_mfma_f32_16x16x32_bf16 v[188:191], v[236:239], v[124:127], v[188:191]
s_waitcnt lgkmcnt(0)
v_mfma_f32_16x16x32_bf16 v[192:195], v[240:243], v[24:27], v[192:195]
v_mfma_f32_16x16x32_bf16 v[192:195], v[244:247], v[28:31], v[192:195]
v_mfma_f32_16x16x32_bf16 v[196:199], v[240:243], v[56:59], v[196:199]
v_mfma_f32_16x16x32_bf16 v[196:199], v[244:247], v[60:63], v[196:199]
v_mfma_f32_16x16x32_bf16 v[200:203], v[240:243], v[88:91], v[200:203]
v_mfma_f32_16x16x32_bf16 v[200:203], v[244:247], v[92:95], v[200:203]
v_mfma_f32_16x16x32_bf16 v[204:207], v[240:243], v[120:123], v[204:207]
v_mfma_f32_16x16x32_bf16 v[204:207], v[244:247], v[124:127], v[204:207]
s_nop 3
v_max3_f32 v224, v160, v161, v162
v_max3_f32 v225, v164, v165, v166
v_max3_f32 v226, v168, v169, v170
v_max3_f32 v227, v172, v173, v174
v_max3_f32 v224, v224, v163, v176
v_max3_f32 v225, v225, v167, v180
v_max3_f32 v226, v226, v171, v184
v_max3_f32 v227, v227, v175, v188
v_max3_f32 v224, v224, v177, v178
v_max3_f32 v225, v225, v181, v182
v_max3_f32 v226, v226, v185, v186
v_max3_f32 v227, v227, v189, v190
v_max_f32 v224, v224, v179
v_max_f32 v225, v225, v183
v_max_f32 v226, v226, v187
v_max_f32 v227, v227, v191
s_add_u32 s28, s28, 0x4000
s_xor_b32 s30, s30, 0x10000
v_mov_b32 v228, v224
v_mov_b32 v229, v225
v_mov_b32 v230, v226
v_mov_b32 v231, v227
v_permlane32_swap_b32 v224, v228
v_permlane32_swap_b32 v225, v229
v_permlane32_swap_b32 v226, v230
v_permlane32_swap_b32 v227, v231
v_max_f32 v224, v224, v228
v_max_f32 v225, v225, v229
v_max_f32 v226, v226, v230
v_max_f32 v227, v227, v231
v_mov_b32 v228, v224
v_mov_b32 v229, v225
v_mov_b32 v230, v226
v_mov_b32 v231, v227
v_permlane16_swap_b32 v224, v228
v_permlane16_swap_b32 v225, v229
v_permlane16_swap_b32 v226, v230
v_permlane16_swap_b32 v227, v231
v_max_f32 v224, v224, v228
v_max_f32 v225, v225, v229
v_max_f32 v226, v226, v230
v_max_f32 v227, v227, v231
s_waitcnt vmcnt(8)
s_barrier
ds_read_b128 v[232:235], v248 offset:18432
ds_read_b128 v[236:239], v248 offset:18944
ds_read_b128 v[240:243], v248 offset:22528
ds_read_b128 v[244:247], v248 offset:23040
v_cvt_pk_bf16_f32 v228, -v224, -v224
v_cvt_pk_bf16_f32 v229, -v225, -v225
v_cvt_pk_bf16_f32 v230, -v226, -v226
v_cvt_pk_bf16_f32 v231, -v227, -v227
v_lshlrev_b32 v253, 2, v252
v_lshlrev_b32 v147, 16, v228
v_lshlrev_b32 v151, 16, v229
v_lshlrev_b32 v155, 16, v230
v_lshlrev_b32 v159, 16, v231
s_mov_b64 exec, 0xffff
v_bfi_b32 v0, s32, v228, v0
v_bfi_b32 v32, s32, v229, v32
v_bfi_b32 v64, s32, v230, v64
v_bfi_b32 v96, s32, v231, v96
v_xor_b32 v224, 0x80000000, v147
v_xor_b32 v225, 0x80000000, v151
v_xor_b32 v226, 0x80000000, v155
v_xor_b32 v227, 0x80000000, v159
s_xor_b32 s35, s48, 0
buffer_store_dword v224, v253, s[24:27], s35 offen offset:0 sc1
s_xor_b32 s35, s48, 1024
buffer_store_dword v225, v253, s[24:27], s35 offen offset:0 sc1
s_xor_b32 s35, s48, 2048
buffer_store_dword v226, v253, s[24:27], s35 offen offset:0 sc1
s_xor_b32 s35, s48, 3072
buffer_store_dword v227, v253, s[24:27], s35 offen offset:0 sc1
s_mov_b64 exec, -1
s_waitcnt lgkmcnt(2)
v_mfma_f32_16x16x32_bf16 v[208:211], v[232:235], v[0:3], 0
ds_read_b128 v[224:227], v248 offset:26624
v_add_f32 v192, v192, v147
v_add_f32 v193, v193, v147
v_add_f32 v194, v194, v147
v_mfma_f32_16x16x32_bf16 v[208:211], v[236:239], v[4:7], v[208:211]
v_add_f32 v195, v195, v147
v_exp_f32 v192, v192
v_mfma_f32_16x16x32_bf16 v[212:215], v[232:235], v[32:35], 0
v_exp_f32 v193, v193
v_exp_f32 v194, v194
v_mfma_f32_16x16x32_bf16 v[212:215], v[236:239], v[36:39], v[212:215]
v_exp_f32 v195, v195
v_add_f32 v196, v196, v151
v_add_f32 v197, v197, v151
v_mfma_f32_16x16x32_bf16 v[216:219], v[232:235], v[64:67], 0
ds_read_b128 v[228:231], v248 offset:27136
v_cvt_pk_bf16_f32 v144, v192, v193
v_cvt_pk_bf16_f32 v145, v194, v195
v_add_f32 v198, v198, v151
v_mfma_f32_16x16x32_bf16 v[216:219], v[236:239], v[68:71], v[216:219]
v_add_f32 v199, v199, v151
v_exp_f32 v196, v196
v_mfma_f32_16x16x32_bf16 v[220:223], v[232:235], v[96:99], 0
v_exp_f32 v197, v197
v_exp_f32 v198, v198
v_mfma_f32_16x16x32_bf16 v[220:223], v[236:239], v[100:103], v[220:223]
s_waitcnt lgkmcnt(2)
v_exp_f32 v199, v199
v_cvt_pk_bf16_f32 v148, v196, v197
v_mfma_f32_16x16x32_bf16 v[208:211], v[240:243], v[8:11], v[208:211]
ds_read_b128 v[232:235], v248 offset:30720
v_cvt_pk_bf16_f32 v149, v198, v199
v_add_f32 v200, v200, v155
v_add_f32 v201, v201, v155
v_mfma_f32_16x16x32_bf16 v[208:211], v[244:247], v[12:15], v[208:211]
v_add_f32 v202, v202, v155
v_add_f32 v203, v203, v155
v_exp_f32 v200, v200
v_mfma_f32_16x16x32_bf16 v[212:215], v[240:243], v[40:43], v[212:215]
v_exp_f32 v201, v201
v_exp_f32 v202, v202
v_mfma_f32_16x16x32_bf16 v[212:215], v[244:247], v[44:47], v[212:215]
v_exp_f32 v203, v203
v_add_f32 v204, v204, v159
v_add_f32 v205, v205, v159
v_mfma_f32_16x16x32_bf16 v[216:219], v[240:243], v[72:75], v[216:219]
ds_read_b128 v[236:239], v248 offset:31232
v_cvt_pk_bf16_f32 v152, v200, v201
v_cvt_pk_bf16_f32 v153, v202, v203
v_add_f32 v206, v206, v159
v_mfma_f32_16x16x32_bf16 v[216:219], v[244:247], v[76:79], v[216:219]
v_add_f32 v207, v207, v159
v_exp_f32 v204, v204
v_mfma_f32_16x16x32_bf16 v[220:223], v[240:243], v[104:107], v[220:223]
v_exp_f32 v205, v205
v_exp_f32 v206, v206
v_mfma_f32_16x16x32_bf16 v[220:223], v[244:247], v[108:111], v[220:223]
s_waitcnt lgkmcnt(2)
v_exp_f32 v207, v207
v_cvt_pk_bf16_f32 v156, v204, v205
v_mfma_f32_16x16x32_bf16 v[208:211], v[224:227], v[16:19], v[208:211]
ds_read_b128 v[240:243], v248 offset:32768
v_cvt_pk_bf16_f32 v157, v206, v207
v_add_f32 v160, v160, v147
v_add_f32 v161, v161, v147
v_mfma_f32_16x16x32_bf16 v[208:211], v[228:231], v[20:23], v[208:211]
v_add_f32 v162, v162, v147
v_add_f32 v163, v163, v147
v_exp_f32 v160, v160
v_mfma_f32_16x16x32_bf16 v[212:215], v[224:227], v[48:51], v[212:215]
v_exp_f32 v161, v161
v_exp_f32 v162, v162
v_mfma_f32_16x16x32_bf16 v[212:215], v[228:231], v[52:55], v[212:215]
v_exp_f32 v163, v163
v_add_f32 v164, v164, v151
v_add_f32 v165, v165, v151
v_mfma_f32_16x16x32_bf16 v[216:219], v[224:227], v[80:83], v[216:219]
ds_read_b128 v[244:247], v248 offset:33280
v_cvt_pk_bf16_f32 v128, v160, v161
v_cvt_pk_bf16_f32 v129, v162, v163
v_add_f32 v166, v166, v151
v_mfma_f32_16x16x32_bf16 v[216:219], v[228:231], v[84:87], v[216:219]
v_add_f32 v167, v167, v151
v_exp_f32 v164, v164
v_mfma_f32_16x16x32_bf16 v[220:223], v[224:227], v[112:115], v[220:223]
v_exp_f32 v165, v165
v_exp_f32 v166, v166
v_mfma_f32_16x16x32_bf16 v[220:223], v[228:231], v[116:119], v[220:223]
s_waitcnt lgkmcnt(2)
v_exp_f32 v167, v167
v_cvt_pk_bf16_f32 v132, v164, v165
v_mfma_f32_16x16x32_bf16 v[208:211], v[232:235], v[24:27], v[208:211]
ds_read_b128 v[224:227], v248 offset:36864
v_cvt_pk_bf16_f32 v133, v166, v167
v_add_f32 v168, v168, v155
v_add_f32 v169, v169, v155
v_mfma_f32_16x16x32_bf16 v[208:211], v[236:239], v[28:31], v[208:211]
v_add_f32 v170, v170, v155
v_add_f32 v171, v171, v155
v_exp_f32 v168, v168
v_mfma_f32_16x16x32_bf16 v[212:215], v[232:235], v[56:59], v[212:215]
v_exp_f32 v169, v169
v_exp_f32 v170, v170
v_mfma_f32_16x16x32_bf16 v[212:215], v[236:239], v[60:63], v[212:215]
v_exp_f32 v171, v171
v_add_f32 v172, v172, v159
v_add_f32 v173, v173, v159
v_mfma_f32_16x16x32_bf16 v[216:219], v[232:235], v[88:91], v[216:219]
ds_read_b128 v[228:231], v248 offset:37376
v_cvt_pk_bf16_f32 v136, v168, v169
v_cvt_pk_bf16_f32 v137, v170, v171
v_add_f32 v174, v174, v159
v_mfma_f32_16x16x32_bf16 v[216:219], v[236:239], v[92:95], v[216:219]
v_add_f32 v175, v175, v159
v_exp_f32 v172, v172
v_mfma_f32_16x16x32_bf16 v[220:223], v[232:235], v[120:123], v[220:223]
v_exp_f32 v173, v173
v_exp_f32 v174, v174
v_mfma_f32_16x16x32_bf16 v[220:223], v[236:239], v[124:127], v[220:223]
s_waitcnt lgkmcnt(2)
v_exp_f32 v175, v175
v_cvt_pk_bf16_f32 v140, v172, v173
v_mfma_f32_16x16x32_bf16 v[192:195], v[240:243], v[0:3], 0
ds_read_b128 v[232:235], v248 offset:40960
v_cvt_pk_bf16_f32 v141, v174, v175
v_add_f32 v176, v176, v147
v_add_f32 v177, v177, v147
v_mfma_f32_16x16x32_bf16 v[192:195], v[244:247], v[4:7], v[192:195]
v_add_f32 v178, v178, v147
v_add_f32 v179, v179, v147
v_exp_f32 v176, v176
v_mfma_f32_16x16x32_bf16 v[196:199], v[240:243], v[32:35], 0
v_exp_f32 v177, v177
v_exp_f32 v178, v178
v_mfma_f32_16x16x32_bf16 v[196:199], v[244:247], v[36:39], v[196:199]
v_exp_f32 v179, v179
v_add_f32 v180, v180, v151
v_add_f32 v181, v181, v151
v_mfma_f32_16x16x32_bf16 v[200:203], v[240:243], v[64:67], 0
ds_read_b128 v[236:239], v248 offset:41472
v_cvt_pk_bf16_f32 v130, v176, v177
v_cvt_pk_bf16_f32 v131, v178, v179
v_add_f32 v182, v182, v151
v_mfma_f32_16x16x32_bf16 v[200:203], v[244:247], v[68:71], v[200:203]
v_add_f32 v183, v183, v151
v_exp_f32 v180, v180
v_mfma_f32_16x16x32_bf16 v[204:207], v[240:243], v[96:99], 0
v_exp_f32 v181, v181
v_exp_f32 v182, v182
v_mfma_f32_16x16x32_bf16 v[204:207], v[244:247], v[100:103], v[204:207]
s_waitcnt lgkmcnt(2)
v_exp_f32 v183, v183
v_cvt_pk_bf16_f32 v134, v180, v181
v_mfma_f32_16x16x32_bf16 v[192:195], v[224:227], v[8:11], v[192:195]
ds_read_b128 v[240:243], v248 offset:45056
v_cvt_pk_bf16_f32 v135, v182, v183
v_add_f32 v184, v184, v155
v_add_f32 v185, v185, v155
v_mfma_f32_16x16x32_bf16 v[192:195], v[228:231], v[12:15], v[192:195]
v_add_f32 v186, v186, v155
v_add_f32 v187, v187, v155
v_exp_f32 v184, v184
v_mfma_f32_16x16x32_bf16 v[196:199], v[224:227], v[40:43], v[196:199]
v_exp_f32 v185, v185
v_exp_f32 v186, v186
v_mfma_f32_16x16x32_bf16 v[196:199], v[228:231], v[44:47], v[196:199]
v_exp_f32 v187, v187
v_add_f32 v188, v188, v159
v_add_f32 v189, v189, v159
v_mfma_f32_16x16x32_bf16 v[200:203], v[224:227], v[72:75], v[200:203]
ds_read_b128 v[244:247], v248 offset:45568
v_cvt_pk_bf16_f32 v138, v184, v185
v_cvt_pk_bf16_f32 v139, v186, v187
v_add_f32 v190, v190, v159
v_mfma_f32_16x16x32_bf16 v[200:203], v[228:231], v[76:79], v[200:203]
v_add_f32 v191, v191, v159
v_exp_f32 v188, v188
v_mfma_f32_16x16x32_bf16 v[204:207], v[224:227], v[104:107], v[204:207]
v_exp_f32 v189, v189
v_exp_f32 v190, v190
v_mfma_f32_16x16x32_bf16 v[204:207], v[228:231], v[108:111], v[204:207]
s_waitcnt lgkmcnt(2)
v_exp_f32 v191, v191
v_cvt_pk_bf16_f32 v142, v188, v189
v_mfma_f32_16x16x32_bf16 v[192:195], v[232:235], v[16:19], v[192:195]
ds_read_b64_tr_b16 v[224:225], v249 offset:0
v_cvt_pk_bf16_f32 v143, v190, v191
v_exp_f32 v208, v208
v_mfma_f32_16x16x32_bf16 v[192:195], v[236:239], v[20:23], v[192:195]
v_exp_f32 v209, v209
v_exp_f32 v210, v210
v_mfma_f32_16x16x32_bf16 v[196:199], v[232:235], v[48:51], v[196:199]
ds_read_b64_tr_b16 v[226:227], v249 offset:2048
v_exp_f32 v211, v211
v_cvt_pk_bf16_f32 v146, v208, v209
v_mfma_f32_16x16x32_bf16 v[196:199], v[236:239], v[52:55], v[196:199]
v_cvt_pk_bf16_f32 v147, v210, v211
v_exp_f32 v212, v212
v_mfma_f32_16x16x32_bf16 v[200:203], v[232:235], v[80:83], v[200:203]
ds_read_b64_tr_b16 v[228:229], v249 offset:16384
v_exp_f32 v213, v213
v_mfma_f32_16x16x32_bf16 v[200:203], v[236:239], v[84:87], v[200:203]
v_exp_f32 v214, v214
v_exp_f32 v215, v215
v_mfma_f32_16x16x32_bf16 v[204:207], v[232:235], v[112:115], v[204:207]
ds_read_b64_tr_b16 v[230:231], v249 offset:18432
v_cvt_pk_bf16_f32 v150, v212, v213
v_cvt_pk_bf16_f32 v151, v214, v215
v_mfma_f32_16x16x32_bf16 v[204:207], v[236:239], v[116:119], v[204:207]
s_waitcnt lgkmcnt(4)
v_exp_f32 v216, v216
v_mfma_f32_16x16x32_bf16 v[192:195], v[240:243], v[24:27], v[192:195]
ds_read_b64_tr_b16 v[232:233], v250 offset:0
v_exp_f32 v217, v217
v_mfma_f32_16x16x32_bf16 v[192:195], v[244:247], v[28:31], v[192:195]
v_exp_f32 v218, v218
v_exp_f32 v219, v219
v_mfma_f32_16x16x32_bf16 v[196:199], v[240:243], v[56:59], v[196:199]
ds_read_b64_tr_b16 v[234:235], v250 offset:2048
v_cvt_pk_bf16_f32 v154, v216, v217
v_cvt_pk_bf16_f32 v155, v218, v219
v_mfma_f32_16x16x32_bf16 v[196:199], v[244:247], v[60:63], v[196:199]
v_exp_f32 v220, v220
v_exp_f32 v221, v221
v_mfma_f32_16x16x32_bf16 v[200:203], v[240:243], v[88:91], v[200:203]
ds_read_b64_tr_b16 v[236:237], v250 offset:16384
v_exp_f32 v222, v222
v_cvt_pk_bf16_f32 v158, v220, v221
v_mfma_f32_16x16x32_bf16 v[200:203], v[244:247], v[92:95], v[200:203]
v_exp_f32 v223, v223
v_mfma_f32_16x16x32_bf16 v[204:207], v[240:243], v[120:123], v[204:207]
ds_read_b64_tr_b16 v[238:239], v250 offset:18432
v_cvt_pk_bf16_f32 v159, v222, v223
v_mfma_f32_16x16x32_bf16 v[204:207], v[244:247], v[124:127], v[204:207]
s_cmp_eq_u32 s50, 1
s_cselect_b32 s40, 0x7fff0000, s40
s_cselect_b32 s44, 0x7fff0000, s44
.p2align 6
L2_loop:
s_waitcnt lgkmcnt(4)
v_mfma_f32_16x16x32_bf16 a[0:3], v[224:227], v[128:131], a[0:3]
ds_read_b64_tr_b16 v[240:241], v249 offset:512
v_mfma_f32_16x16x32_bf16 a[0:3], v[228:231], v[144:147], a[0:3]
v_mfma_f32_16x16x32_bf16 a[4:7], v[224:227], v[132:135], a[4:7]
ds_read_b64_tr_b16 v[242:243], v249 offset:2560
v_mfma_f32_16x16x32_bf16 a[4:7], v[228:231], v[148:151], a[4:7]
v_exp_f32 v192, v192
v_mfma_f32_16x16x32_bf16 a[8:11], v[224:227], v[136:139], a[8:11]
ds_read_b64_tr_b16 v[244:245], v249 offset:16896
v_mfma_f32_16x16x32_bf16 a[8:11], v[228:231], v[152:155], a[8:11]
v_exp_f32 v193, v193
v_mfma_f32_16x16x32_bf16 a[12:15], v[224:227], v[140:143], a[12:15]
ds_read_b64_tr_b16 v[246:247], v249 offset:18944
v_cvt_pk_bf16_f32 v160, v192, v193
v_mfma_f32_16x16x32_bf16 a[12:15], v[228:231], v[156:159], a[12:15]
s_waitcnt lgkmcnt(4)
v_mfma_f32_16x16x32_bf16 a[16:19], v[232:235], v[128:131], a[16:19]
ds_read_b64_tr_b16 v[176:177], v250 offset:512
v_mfma_f32_16x16x32_bf16 a[16:19], v[236:239], v[144:147], a[16:19]
v_exp_f32 v194, v194
v_mfma_f32_16x16x32_bf16 a[20:23], v[232:235], v[132:135], a[20:23]
ds_read_b64_tr_b16 v[178:179], v250 offset:2560
v_mfma_f32_16x16x32_bf16 a[20:23], v[236:239], v[148:151], a[20:23]
v_exp_f32 v195, v195
v_mfma_f32_16x16x32_bf16 a[24:27], v[232:235], v[136:139], a[24:27]
ds_read_b64_tr_b16 v[180:181], v250 offset:16896
v_cvt_pk_bf16_f32 v161, v194, v195
v_mfma_f32_16x16x32_bf16 a[24:27], v[236:239], v[152:155], a[24:27]
v_exp_f32 v196, v196
v_mfma_f32_16x16x32_bf16 a[28:31], v[232:235], v[140:143], a[28:31]
ds_read_b64_tr_b16 v[182:183], v250 offset:18944
v_mfma_f32_16x16x32_bf16 a[28:31], v[236:239], v[156:159], a[28:31]
s_waitcnt lgkmcnt(4)
v_mfma_f32_16x16x32_bf16 a[32:35], v[240:243], v[128:131], a[32:35]
ds_read_b128 v[224:227], v248 offset:34816
v_mfma_f32_16x16x32_bf16 a[32:35], v[244:247], v[144:147], a[32:35]
v_exp_f32 v197, v197
v_mfma_f32_16x16x32_bf16 a[36:39], v[240:243], v[132:135], a[36:39]
v_exp_f32 v198, v198
v_mfma_f32_16x16x32_bf16 a[36:39], v[244:247], v[148:151], a[36:39]
v_exp_f32 v199, v199
v_mfma_f32_16x16x32_bf16 a[40:43], v[240:243], v[136:139], a[40:43]
ds_read_b128 v[228:231], v248 offset:35328
v_cvt_pk_bf16_f32 v164, v196, v197
v_mfma_f32_16x16x32_bf16 a[40:43], v[244:247], v[152:155], a[40:43]
v_cvt_pk_bf16_f32 v165, v198, v199
v_mfma_f32_16x16x32_bf16 a[44:47], v[240:243], v[140:143], a[44:47]
v_exp_f32 v200, v200
v_mfma_f32_16x16x32_bf16 a[44:47], v[244:247], v[156:159], a[44:47]
s_waitcnt lgkmcnt(2)
v_mfma_f32_16x16x32_bf16 a[48:51], v[176:179], v[128:131], a[48:51]
ds_read_b128 v[232:235], v248 offset:38912
v_mfma_f32_16x16x32_bf16 a[48:51], v[180:183], v[144:147], a[48:51]
v_exp_f32 v201, v201
v_mfma_f32_16x16x32_bf16 a[52:55], v[176:179], v[132:135], a[52:55]
v_exp_f32 v202, v202
v_mfma_f32_16x16x32_bf16 a[52:55], v[180:183], v[148:151], a[52:55]
v_exp_f32 v203, v203
v_mfma_f32_16x16x32_bf16 a[56:59], v[176:179], v[136:139], a[56:59]
ds_read_b128 v[236:239], v248 offset:39424
v_cvt_pk_bf16_f32 v168, v200, v201
v_mfma_f32_16x16x32_bf16 a[56:59], v[180:183], v[152:155], a[56:59]
v_cvt_pk_bf16_f32 v169, v202, v203
v_mfma_f32_16x16x32_bf16 a[60:63], v[176:179], v[140:143], a[60:63]
v_exp_f32 v204, v204
v_mfma_f32_16x16x32_bf16 a[60:63], v[180:183], v[156:159], a[60:63]
s_waitcnt lgkmcnt(2)
v_mfma_f32_16x16x32_bf16 v[208:211], v[224:227], v[0:3], 0
ds_read_b128 v[240:243], v248 offset:43008
v_mfma_f32_16x16x32_bf16 v[208:211], v[228:231], v[4:7], v[208:211]
v_exp_f32 v205, v205
v_mfma_f32_16x16x32_bf16 v[212:215], v[224:227], v[32:35], 0
v_exp_f32 v206, v206
v_mfma_f32_16x16x32_bf16 v[212:215], v[228:231], v[36:39], v[212:215]
v_exp_f32 v207, v207
v_mfma_f32_16x16x32_bf16 v[216:219], v[224:227], v[64:67], 0
ds_read_b128 v[244:247], v248 offset:43520
v_cvt_pk_bf16_f32 v172, v204, v205
v_mfma_f32_16x16x32_bf16 v[216:219], v[228:231], v[68:71], v[216:219]
v_cvt_pk_bf16_f32 v173, v206, v207
v_mfma_f32_16x16x32_bf16 v[220:223], v[224:227], v[96:99], 0
v_mfma_f32_16x16x32_bf16 v[220:223], v[228:231], v[100:103], v[220:223]
s_waitcnt lgkmcnt(2)
v_mfma_f32_16x16x32_bf16 v[208:211], v[232:235], v[8:11], v[208:211]
ds_read_b128 v[176:179], v248 offset:47104
v_mfma_f32_16x16x32_bf16 v[208:211], v[236:239], v[12:15], v[208:211]
v_mfma_f32_16x16x32_bf16 v[212:215], v[232:235], v[40:43], v[212:215]
v_mfma_f32_16x16x32_bf16 v[212:215], v[236:239], v[44:47], v[212:215]
v_mfma_f32_16x16x32_bf16 v[216:219], v[232:235], v[72:75], v[216:219]
ds_read_b128 v[180:183], v248 offset:47616
v_mfma_f32_16x16x32_bf16 v[216:219], v[236:239], v[76:79], v[216:219]
v_mfma_f32_16x16x32_bf16 v[220:223], v[232:235], v[104:107], v[220:223]
v_mfma_f32_16x16x32_bf16 v[220:223], v[236:239], v[108:111], v[220:223]
s_waitcnt lgkmcnt(2)
v_mfma_f32_16x16x32_bf16 v[208:211], v[240:243], v[16:19], v[208:211]
ds_read_b64_tr_b16 v[224:225], v249 offset:4096
v_mfma_f32_16x16x32_bf16 v[208:211], v[244:247], v[20:23], v[208:211]
v_mfma_f32_16x16x32_bf16 v[212:215], v[240:243], v[48:51], v[212:215]
ds_read_b64_tr_b16 v[226:227], v249 offset:6144
v_mfma_f32_16x16x32_bf16 v[212:215], v[244:247], v[52:55], v[212:215]
v_mfma_f32_16x16x32_bf16 v[216:219], v[240:243], v[80:83], v[216:219]
ds_read_b64_tr_b16 v[228:229], v249 offset:20480
v_mfma_f32_16x16x32_bf16 v[216:219], v[244:247], v[84:87], v[216:219]
v_mfma_f32_16x16x32_bf16 v[220:223], v[240:243], v[112:115], v[220:223]
ds_read_b64_tr_b16 v[230:231], v249 offset:22528
v_mfma_f32_16x16x32_bf16 v[220:223], v[244:247], v[116:119], v[220:223]
s_waitcnt lgkmcnt(4)
v_mfma_f32_16x16x32_bf16 v[208:211], v[176:179], v[24:27], v[208:211]
ds_read_b64_tr_b16 v[232:233], v250 offset:4096
v_mfma_f32_16x16x32_bf16 v[208:211], v[180:183], v[28:31], v[208:211]
v_mfma_f32_16x16x32_bf16 v[212:215], v[176:179], v[56:59], v[212:215]
ds_read_b64_tr_b16 v[234:235], v250 offset:6144
v_mfma_f32_16x16x32_bf16 v[212:215], v[180:183], v[60:63], v[212:215]
v_mfma_f32_16x16x32_bf16 v[216:219], v[176:179], v[88:91], v[216:219]
ds_read_b64_tr_b16 v[236:237], v250 offset:20480
v_mfma_f32_16x16x32_bf16 v[216:219], v[180:183], v[92:95], v[216:219]
v_mfma_f32_16x16x32_bf16 v[220:223], v[176:179], v[120:123], v[220:223]
ds_read_b64_tr_b16 v[238:239], v250 offset:22528
v_mfma_f32_16x16x32_bf16 v[220:223], v[180:183], v[124:127], v[220:223]
s_waitcnt lgkmcnt(4)
v_mfma_f32_16x16x32_bf16 a[64:67], v[224:227], v[128:131], a[64:67]
ds_read_b64_tr_b16 v[240:241], v249 offset:4608
v_mfma_f32_16x16x32_bf16 a[64:67], v[228:231], v[144:147], a[64:67]
v_mfma_f32_16x16x32_bf16 a[68:71], v[224:227], v[132:135], a[68:71]
ds_read_b64_tr_b16 v[242:243], v249 offset:6656
v_mfma_f32_16x16x32_bf16 a[68:71], v[228:231], v[148:151], a[68:71]
v_exp_f32 v208, v208
v_mfma_f32_16x16x32_bf16 a[72:75], v[224:227], v[136:139], a[72:75]
ds_read_b64_tr_b16 v[244:245], v249 offset:20992
v_mfma_f32_16x16x32_bf16 a[72:75], v[228:231], v[152:155], a[72:75]
v_exp_f32 v209, v209
v_mfma_f32_16x16x32_bf16 a[76:79], v[224:227], v[140:143], a[76:79]
ds_read_b64_tr_b16 v[246:247], v249 offset:23040
v_cvt_pk_bf16_f32 v162, v208, v209
v_mfma_f32_16x16x32_bf16 a[76:79], v[228:231], v[156:159], a[76:79]
s_waitcnt lgkmcnt(4)
s_waitcnt vmcnt(0)
s_barrier
s_add_u32 m0, s30, 0x4000
v_mfma_f32_16x16x32_bf16 a[80:83], v[232:235], v[128:131], a[80:83]
ds_read_b64_tr_b16 v[224:225], v250 offset:4608
v_mfma_f32_16x16x32_bf16 a[80:83], v[236:239], v[144:147], a[80:83]
buffer_load_dwordx4 v251, s[12:15], s28 offen offset:0 lds
v_mfma_f32_16x16x32_bf16 a[84:87], v[232:235], v[132:135], a[84:87]
ds_read_b64_tr_b16 v[226:227], v250 offset:6656
v_mfma_f32_16x16x32_bf16 a[84:87], v[236:239], v[148:151], a[84:87]
v_exp_f32 v210, v210
v_mfma_f32_16x16x32_bf16 a[88:91], v[232:235], v[136:139], a[88:91]
ds_read_b64_tr_b16 v[228:229], v250 offset:20992
v_mfma_f32_16x16x32_bf16 a[88:91], v[236:239], v[152:155], a[88:91]
v_exp_f32 v211, v211
v_mfma_f32_16x16x32_bf16 a[92:95], v[232:235], v[140:143], a[92:95]
ds_read_b64_tr_b16 v[230:231], v250 offset:23040
v_cvt_pk_bf16_f32 v163, v210, v211
v_mfma_f32_16x16x32_bf16 a[92:95], v[236:239], v[156:159], a[92:95]
s_waitcnt lgkmcnt(4)
v_mfma_f32_16x16x32_bf16 a[96:99], v[240:243], v[128:131], a[96:99]
ds_read_b128 v[232:235], v248 offset:49152
v_mfma_f32_16x16x32_bf16 a[96:99], v[244:247], v[144:147], a[96:99]
buffer_load_dwordx4 v251, s[12:15], s28 offen offset:1024 lds
v_mfma_f32_16x16x32_bf16 a[100:103], v[240:243], v[132:135], a[100:103]
v_exp_f32 v212, v212
v_mfma_f32_16x16x32_bf16 a[100:103], v[244:247], v[148:151], a[100:103]
v_exp_f32 v213, v213
v_mfma_f32_16x16x32_bf16 a[104:107], v[240:243], v[136:139], a[104:107]
ds_read_b128 v[236:239], v248 offset:49664
v_cvt_pk_bf16_f32 v166, v212, v213
v_mfma_f32_16x16x32_bf16 a[104:107], v[244:247], v[152:155], a[104:107]
v_exp_f32 v214, v214
v_mfma_f32_16x16x32_bf16 a[108:111], v[240:243], v[140:143], a[108:111]
v_exp_f32 v215, v215
v_mfma_f32_16x16x32_bf16 a[108:111], v[244:247], v[156:159], a[108:111]
s_waitcnt lgkmcnt(2)
v_cvt_pk_bf16_f32 v167, v214, v215
v_mfma_f32_16x16x32_bf16 a[112:115], v[224:227], v[128:131], a[112:115]
ds_read_b128 v[240:243], v248 offset:53248
v_mfma_f32_16x16x32_bf16 a[112:115], v[228:231], v[144:147], a[112:115]
buffer_load_dwordx4 v251, s[12:15], s28 offen offset:2048 lds
v_mfma_f32_16x16x32_bf16 a[116:119], v[224:227], v[132:135], a[116:119]
v_exp_f32 v216, v216
v_mfma_f32_16x16x32_bf16 a[116:119], v[228:231], v[148:151], a[116:119]
v_exp_f32 v217, v217
v_mfma_f32_16x16x32_bf16 a[120:123], v[224:227], v[136:139], a[120:123]
ds_read_b128 v[244:247], v248 offset:53760
v_cvt_pk_bf16_f32 v170, v216, v217
v_mfma_f32_16x16x32_bf16 a[120:123], v[228:231], v[152:155], a[120:123]
v_exp_f32 v218, v218
v_mfma_f32_16x16x32_bf16 a[124:127], v[224:227], v[140:143], a[124:127]
v_exp_f32 v219, v219
v_mfma_f32_16x16x32_bf16 a[124:127], v[228:231], v[156:159], a[124:127]
s_waitcnt lgkmcnt(2)
v_cvt_pk_bf16_f32 v171, v218, v219
v_mfma_f32_16x16x32_bf16 v[192:195], v[232:235], v[0:3], 0
ds_read_b128 v[224:227], v248 offset:57344
v_mfma_f32_16x16x32_bf16 v[192:195], v[236:239], v[4:7], v[192:195]
buffer_load_dwordx4 v251, s[12:15], s28 offen offset:3072 lds
v_mfma_f32_16x16x32_bf16 v[196:199], v[232:235], v[32:35], 0
v_exp_f32 v220, v220
v_mfma_f32_16x16x32_bf16 v[196:199], v[236:239], v[36:39], v[196:199]
s_add_u32 s28, s28, 0x4000
v_mfma_f32_16x16x32_bf16 v[200:203], v[232:235], v[64:67], 0
ds_read_b128 v[228:231], v248 offset:57856
v_mfma_f32_16x16x32_bf16 v[200:203], v[236:239], v[68:71], v[200:203]
v_exp_f32 v221, v221
v_mfma_f32_16x16x32_bf16 v[204:207], v[232:235], v[96:99], 0
v_exp_f32 v222, v222
v_mfma_f32_16x16x32_bf16 v[204:207], v[236:239], v[100:103], v[204:207]
s_waitcnt lgkmcnt(2)
s_add_u32 m0, s30, 0x8000
v_mfma_f32_16x16x32_bf16 v[192:195], v[240:243], v[8:11], v[192:195]
ds_read_b128 v[232:235], v248 offset:61440
v_cvt_pk_bf16_f32 v174, v220, v221
v_mfma_f32_16x16x32_bf16 v[192:195], v[244:247], v[12:15], v[192:195]
buffer_load_dwordx4 v251, s[12:15], s28 offen offset:0 lds
v_mfma_f32_16x16x32_bf16 v[196:199], v[240:243], v[40:43], v[196:199]
v_exp_f32 v223, v223
v_mfma_f32_16x16x32_bf16 v[196:199], v[244:247], v[44:47], v[196:199]
v_mfma_f32_16x16x32_bf16 v[200:203], v[240:243], v[72:75], v[200:203]
ds_read_b128 v[236:239], v248 offset:61952
v_cvt_pk_bf16_f32 v175, v222, v223
v_mfma_f32_16x16x32_bf16 v[200:203], v[244:247], v[76:79], v[200:203]
v_mfma_f32_16x16x32_bf16 v[204:207], v[240:243], v[104:107], v[204:207]
v_mfma_f32_16x16x32_bf16 v[204:207], v[244:247], v[108:111], v[204:207]
s_waitcnt lgkmcnt(2)
v_mfma_f32_16x16x32_bf16 v[192:195], v[224:227], v[16:19], v[192:195]
ds_read_b64_tr_b16 v[240:241], v249 offset:8192
v_mfma_f32_16x16x32_bf16 v[192:195], v[228:231], v[20:23], v[192:195]
buffer_load_dwordx4 v251, s[12:15], s28 offen offset:1024 lds
v_mfma_f32_16x16x32_bf16 v[196:199], v[224:227], v[48:51], v[196:199]
ds_read_b64_tr_b16 v[242:243], v249 offset:10240
v_mfma_f32_16x16x32_bf16 v[196:199], v[228:231], v[52:55], v[196:199]
v_mfma_f32_16x16x32_bf16 v[200:203], v[224:227], v[80:83], v[200:203]
ds_read_b64_tr_b16 v[244:245], v249 offset:24576
v_mfma_f32_16x16x32_bf16 v[200:203], v[228:231], v[84:87], v[200:203]
v_mfma_f32_16x16x32_bf16 v[204:207], v[224:227], v[112:115], v[204:207]
ds_read_b64_tr_b16 v[246:247], v249 offset:26624
v_mfma_f32_16x16x32_bf16 v[204:207], v[228:231], v[116:119], v[204:207]
s_waitcnt lgkmcnt(4)
v_mfma_f32_16x16x32_bf16 v[192:195], v[232:235], v[24:27], v[192:195]
ds_read_b64_tr_b16 v[224:225], v250 offset:8192
v_mfma_f32_16x16x32_bf16 v[192:195], v[236:239], v[28:31], v[192:195]
buffer_load_dwordx4 v251, s[12:15], s28 offen offset:2048 lds
v_mfma_f32_16x16x32_bf16 v[196:199], v[232:235], v[56:59], v[196:199]
ds_read_b64_tr_b16 v[226:227], v250 offset:10240
v_mfma_f32_16x16x32_bf16 v[196:199], v[236:239], v[60:63], v[196:199]
v_mfma_f32_16x16x32_bf16 v[200:203], v[232:235], v[88:91], v[200:203]
ds_read_b64_tr_b16 v[228:229], v250 offset:24576
v_mfma_f32_16x16x32_bf16 v[200:203], v[236:239], v[92:95], v[200:203]
v_mfma_f32_16x16x32_bf16 v[204:207], v[232:235], v[120:123], v[204:207]
ds_read_b64_tr_b16 v[230:231], v250 offset:26624
v_mfma_f32_16x16x32_bf16 v[204:207], v[236:239], v[124:127], v[204:207]
s_waitcnt lgkmcnt(4)
v_mfma_f32_16x16x32_bf16 a[128:131], v[240:243], v[128:131], a[128:131]
ds_read_b64_tr_b16 v[232:233], v249 offset:8704
v_mfma_f32_16x16x32_bf16 a[128:131], v[244:247], v[144:147], a[128:131]
buffer_load_dwordx4 v251, s[12:15], s28 offen offset:3072 lds
v_mfma_f32_16x16x32_bf16 a[132:135], v[240:243], v[132:135], a[132:135]
ds_read_b64_tr_b16 v[234:235], v249 offset:10752
v_mfma_f32_16x16x32_bf16 a[132:135], v[244:247], v[148:151], a[132:135]
s_add_u32 s28, s28, 0x4000
v_mfma_f32_16x16x32_bf16 a[136:139], v[240:243], v[136:139], a[136:139]
ds_read_b64_tr_b16 v[236:237], v249 offset:25088
v_mfma_f32_16x16x32_bf16 a[136:139], v[244:247], v[152:155], a[136:139]
v_exp_f32 v192, v192
v_mfma_f32_16x16x32_bf16 a[140:143], v[240:243], v[140:143], a[140:143]
ds_read_b64_tr_b16 v[238:239], v249 offset:27136
v_mfma_f32_16x16x32_bf16 a[140:143], v[244:247], v[156:159], a[140:143]
s_waitcnt lgkmcnt(4)
v_mfma_f32_16x16x32_bf16 a[144:147], v[224:227], v[128:131], a[144:147]
ds_read_b64_tr_b16 v[240:241], v250 offset:8704
v_mfma_f32_16x16x32_bf16 a[144:147], v[228:231], v[144:147], a[144:147]
v_exp_f32 v193, v193
v_mfma_f32_16x16x32_bf16 a[148:151], v[224:227], v[132:135], a[148:151]
ds_read_b64_tr_b16 v[242:243], v250 offset:10752
v_cvt_pk_bf16_f32 v176, v192, v193
v_mfma_f32_16x16x32_bf16 a[148:151], v[228:231], v[148:151], a[148:151]
v_exp_f32 v194, v194
v_mfma_f32_16x16x32_bf16 a[152:155], v[224:227], v[136:139], a[152:155]
ds_read_b64_tr_b16 v[244:245], v250 offset:25088
v_mfma_f32_16x16x32_bf16 a[152:155], v[228:231], v[152:155], a[152:155]
v_exp_f32 v195, v195
v_mfma_f32_16x16x32_bf16 a[156:159], v[224:227], v[140:143], a[156:159]
ds_read_b64_tr_b16 v[246:247], v250 offset:27136
v_cvt_pk_bf16_f32 v177, v194, v195
v_mfma_f32_16x16x32_bf16 a[156:159], v[228:231], v[156:159], a[156:159]
s_waitcnt lgkmcnt(4)
v_mfma_f32_16x16x32_bf16 a[160:163], v[232:235], v[128:131], a[160:163]
ds_read_b128 v[224:227], v248 offset:51200
v_mfma_f32_16x16x32_bf16 a[160:163], v[236:239], v[144:147], a[160:163]
v_exp_f32 v196, v196
v_mfma_f32_16x16x32_bf16 a[164:167], v[232:235], v[132:135], a[164:167]
v_exp_f32 v197, v197
v_mfma_f32_16x16x32_bf16 a[164:167], v[236:239], v[148:151], a[164:167]
v_exp_f32 v198, v198
v_mfma_f32_16x16x32_bf16 a[168:171], v[232:235], v[136:139], a[168:171]
ds_read_b128 v[228:231], v248 offset:51712
v_cvt_pk_bf16_f32 v180, v196, v197
v_mfma_f32_16x16x32_bf16 a[168:171], v[236:239], v[152:155], a[168:171]
v_exp_f32 v199, v199
v_mfma_f32_16x16x32_bf16 a[172:175], v[232:235], v[140:143], a[172:175]
v_exp_f32 v200, v200
v_mfma_f32_16x16x32_bf16 a[172:175], v[236:239], v[156:159], a[172:175]
s_waitcnt lgkmcnt(2)
v_cvt_pk_bf16_f32 v181, v198, v199
v_mfma_f32_16x16x32_bf16 a[176:179], v[240:243], v[128:131], a[176:179]
ds_read_b128 v[232:235], v248 offset:55296
v_mfma_f32_16x16x32_bf16 a[176:179], v[244:247], v[144:147], a[176:179]
v_exp_f32 v201, v201
v_mfma_f32_16x16x32_bf16 a[180:183], v[240:243], v[132:135], a[180:183]
v_exp_f32 v202, v202
v_mfma_f32_16x16x32_bf16 a[180:183], v[244:247], v[148:151], a[180:183]
v_exp_f32 v203, v203
v_mfma_f32_16x16x32_bf16 a[184:187], v[240:243], v[136:139], a[184:187]
ds_read_b128 v[236:239], v248 offset:55808
v_cvt_pk_bf16_f32 v184, v200, v201
v_mfma_f32_16x16x32_bf16 a[184:187], v[244:247], v[152:155], a[184:187]
v_cvt_pk_bf16_f32 v185, v202, v203
v_mfma_f32_16x16x32_bf16 a[188:191], v[240:243], v[140:143], a[188:191]
v_exp_f32 v204, v204
v_mfma_f32_16x16x32_bf16 a[188:191], v[244:247], v[156:159], a[188:191]
s_waitcnt lgkmcnt(2)
v_mfma_f32_16x16x32_bf16 v[208:211], v[224:227], v[0:3], 0
ds_read_b128 v[240:243], v248 offset:59392
v_mfma_f32_16x16x32_bf16 v[208:211], v[228:231], v[4:7], v[208:211]
v_exp_f32 v205, v205
v_mfma_f32_16x16x32_bf16 v[212:215], v[224:227], v[32:35], 0
v_exp_f32 v206, v206
v_mfma_f32_16x16x32_bf16 v[212:215], v[228:231], v[36:39], v[212:215]
v_exp_f32 v207, v207
v_mfma_f32_16x16x32_bf16 v[216:219], v[224:227], v[64:67], 0
ds_read_b128 v[244:247], v248 offset:59904
v_cvt_pk_bf16_f32 v188, v204, v205
v_mfma_f32_16x16x32_bf16 v[216:219], v[228:231], v[68:71], v[216:219]
v_cvt_pk_bf16_f32 v189, v206, v207
v_mfma_f32_16x16x32_bf16 v[220:223], v[224:227], v[96:99], 0
v_mfma_f32_16x16x32_bf16 v[220:223], v[228:231], v[100:103], v[220:223]
s_waitcnt lgkmcnt(2)
v_mfma_f32_16x16x32_bf16 v[208:211], v[232:235], v[8:11], v[208:211]
ds_read_b128 v[224:227], v248 offset:63488
v_mfma_f32_16x16x32_bf16 v[208:211], v[236:239], v[12:15], v[208:211]
v_mfma_f32_16x16x32_bf16 v[212:215], v[232:235], v[40:43], v[212:215]
v_mfma_f32_16x16x32_bf16 v[212:215], v[236:239], v[44:47], v[212:215]
v_mfma_f32_16x16x32_bf16 v[216:219], v[232:235], v[72:75], v[216:219]
ds_read_b128 v[228:231], v248 offset:64000
v_mfma_f32_16x16x32_bf16 v[216:219], v[236:239], v[76:79], v[216:219]
v_mfma_f32_16x16x32_bf16 v[220:223], v[232:235], v[104:107], v[220:223]
v_mfma_f32_16x16x32_bf16 v[220:223], v[236:239], v[108:111], v[220:223]
s_waitcnt lgkmcnt(2)
v_mfma_f32_16x16x32_bf16 v[208:211], v[240:243], v[16:19], v[208:211]
ds_read_b64_tr_b16 v[232:233], v249 offset:12288
v_mfma_f32_16x16x32_bf16 v[208:211], v[244:247], v[20:23], v[208:211]
v_mfma_f32_16x16x32_bf16 v[212:215], v[240:243], v[48:51], v[212:215]
ds_read_b64_tr_b16 v[234:235], v249 offset:14336
v_mfma_f32_16x16x32_bf16 v[212:215], v[244:247], v[52:55], v[212:215]
v_mfma_f32_16x16x32_bf16 v[216:219], v[240:243], v[80:83], v[216:219]
ds_read_b64_tr_b16 v[236:237], v249 offset:28672
v_mfma_f32_16x16x32_bf16 v[216:219], v[244:247], v[84:87], v[216:219]
v_mfma_f32_16x16x32_bf16 v[220:223], v[240:243], v[112:115], v[220:223]
ds_read_b64_tr_b16 v[238:239], v249 offset:30720
v_mfma_f32_16x16x32_bf16 v[220:223], v[244:247], v[116:119], v[220:223]
s_waitcnt lgkmcnt(4)
v_mfma_f32_16x16x32_bf16 v[208:211], v[224:227], v[24:27], v[208:211]
ds_read_b64_tr_b16 v[240:241], v250 offset:12288
v_mfma_f32_16x16x32_bf16 v[208:211], v[228:231], v[28:31], v[208:211]
v_mfma_f32_16x16x32_bf16 v[212:215], v[224:227], v[56:59], v[212:215]
ds_read_b64_tr_b16 v[242:243], v250 offset:14336
v_mfma_f32_16x16x32_bf16 v[212:215], v[228:231], v[60:63], v[212:215]
v_mfma_f32_16x16x32_bf16 v[216:219], v[224:227], v[88:91], v[216:219]
ds_read_b64_tr_b16 v[244:245], v250 offset:28672
v_mfma_f32_16x16x32_bf16 v[216:219], v[228:231], v[92:95], v[216:219]
v_mfma_f32_16x16x32_bf16 v[220:223], v[224:227], v[120:123], v[220:223]
ds_read_b64_tr_b16 v[246:247], v250 offset:30720
v_xor_b32 v248, 0x10000, v248
v_mfma_f32_16x16x32_bf16 v[220:223], v[228:231], v[124:127], v[220:223]
s_waitcnt lgkmcnt(4)
v_mfma_f32_16x16x32_bf16 a[192:195], v[232:235], v[128:131], a[192:195]
ds_read_b64_tr_b16 v[224:225], v249 offset:12800
v_mfma_f32_16x16x32_bf16 a[192:195], v[236:239], v[144:147], a[192:195]
v_mfma_f32_16x16x32_bf16 a[196:199], v[232:235], v[132:135], a[196:199]
ds_read_b64_tr_b16 v[226:227], v249 offset:14848
v_mfma_f32_16x16x32_bf16 a[196:199], v[236:239], v[148:151], a[196:199]
v_exp_f32 v208, v208
v_mfma_f32_16x16x32_bf16 a[200:203], v[232:235], v[136:139], a[200:203]
ds_read_b64_tr_b16 v[228:229], v249 offset:29184
v_mfma_f32_16x16x32_bf16 a[200:203], v[236:239], v[152:155], a[200:203]
v_exp_f32 v209, v209
v_mfma_f32_16x16x32_bf16 a[204:207], v[232:235], v[140:143], a[204:207]
ds_read_b64_tr_b16 v[230:231], v249 offset:31232
v_cvt_pk_bf16_f32 v178, v208, v209
v_mfma_f32_16x16x32_bf16 a[204:207], v[236:239], v[156:159], a[204:207]
s_waitcnt lgkmcnt(4)
v_mfma_f32_16x16x32_bf16 a[208:211], v[240:243], v[128:131], a[208:211]
ds_read_b64_tr_b16 v[232:233], v250 offset:12800
v_mfma_f32_16x16x32_bf16 a[208:211], v[244:247], v[144:147], a[208:211]
v_exp_f32 v210, v210
v_mfma_f32_16x16x32_bf16 a[212:215], v[240:243], v[132:135], a[212:215]
ds_read_b64_tr_b16 v[234:235], v250 offset:14848
v_mfma_f32_16x16x32_bf16 a[212:215], v[244:247], v[148:151], a[212:215]
v_exp_f32 v211, v211
v_mfma_f32_16x16x32_bf16 a[216:219], v[240:243], v[136:139], a[216:219]
ds_read_b64_tr_b16 v[236:237], v250 offset:29184
v_cvt_pk_bf16_f32 v179, v210, v211
v_mfma_f32_16x16x32_bf16 a[216:219], v[244:247], v[152:155], a[216:219]
v_exp_f32 v212, v212
v_mfma_f32_16x16x32_bf16 a[220:223], v[240:243], v[140:143], a[220:223]
ds_read_b64_tr_b16 v[238:239], v250 offset:31232
v_mfma_f32_16x16x32_bf16 a[220:223], v[244:247], v[156:159], a[220:223]
s_waitcnt lgkmcnt(4)
v_mfma_f32_16x16x32_bf16 a[224:227], v[224:227], v[128:131], a[224:227]
ds_read_b128 v[240:243], v248 offset:0
v_mfma_f32_16x16x32_bf16 a[224:227], v[228:231], v[144:147], a[224:227]
v_exp_f32 v213, v213
v_mfma_f32_16x16x32_bf16 a[228:231], v[224:227], v[132:135], a[228:231]
v_exp_f32 v214, v214
v_mfma_f32_16x16x32_bf16 a[228:231], v[228:231], v[148:151], a[228:231]
v_exp_f32 v215, v215
v_mfma_f32_16x16x32_bf16 a[232:235], v[224:227], v[136:139], a[232:235]
ds_read_b128 v[244:247], v248 offset:512
v_cvt_pk_bf16_f32 v182, v212, v213
v_mfma_f32_16x16x32_bf16 a[232:235], v[228:231], v[152:155], a[232:235]
v_cvt_pk_bf16_f32 v183, v214, v215
v_mfma_f32_16x16x32_bf16 a[236:239], v[224:227], v[140:143], a[236:239]
v_exp_f32 v216, v216
v_mfma_f32_16x16x32_bf16 a[236:239], v[228:231], v[156:159], a[236:239]
s_waitcnt lgkmcnt(2)
v_mfma_f32_16x16x32_bf16 a[240:243], v[232:235], v[128:131], a[240:243]
ds_read_b128 v[224:227], v248 offset:4096
v_mfma_f32_16x16x32_bf16 a[240:243], v[236:239], v[144:147], a[240:243]
v_exp_f32 v217, v217
v_mfma_f32_16x16x32_bf16 a[244:247], v[232:235], v[132:135], a[244:247]
v_exp_f32 v218, v218
v_mfma_f32_16x16x32_bf16 a[244:247], v[236:239], v[148:151], a[244:247]
v_exp_f32 v219, v219
v_mfma_f32_16x16x32_bf16 a[248:251], v[232:235], v[136:139], a[248:251]
ds_read_b128 v[228:231], v248 offset:4608
v_cvt_pk_bf16_f32 v186, v216, v217
v_mfma_f32_16x16x32_bf16 a[248:251], v[236:239], v[152:155], a[248:251]
v_cvt_pk_bf16_f32 v187, v218, v219
v_mfma_f32_16x16x32_bf16 a[252:255], v[232:235], v[140:143], a[252:255]
v_exp_f32 v220, v220
v_mfma_f32_16x16x32_bf16 a[252:255], v[236:239], v[156:159], a[252:255]
s_waitcnt lgkmcnt(2)
v_mfma_f32_16x16x32_bf16 v[192:195], v[240:243], v[0:3], 0
ds_read_b128 v[232:235], v248 offset:8192
v_mfma_f32_16x16x32_bf16 v[192:195], v[244:247], v[4:7], v[192:195]
v_exp_f32 v221, v221
v_mfma_f32_16x16x32_bf16 v[196:199], v[240:243], v[32:35], 0
v_exp_f32 v222, v222
v_mfma_f32_16x16x32_bf16 v[196:199], v[244:247], v[36:39], v[196:199]
v_exp_f32 v223, v223
v_mfma_f32_16x16x32_bf16 v[200:203], v[240:243], v[64:67], 0
ds_read_b128 v[236:239], v248 offset:8704
v_cvt_pk_bf16_f32 v190, v220, v221
v_mfma_f32_16x16x32_bf16 v[200:203], v[244:247], v[68:71], v[200:203]
v_cvt_pk_bf16_f32 v191, v222, v223
v_mfma_f32_16x16x32_bf16 v[204:207], v[240:243], v[96:99], 0
v_mfma_f32_16x16x32_bf16 v[204:207], v[244:247], v[100:103], v[204:207]
s_waitcnt lgkmcnt(2)
v_mfma_f32_16x16x32_bf16 v[192:195], v[224:227], v[8:11], v[192:195]
ds_read_b128 v[240:243], v248 offset:12288
v_mfma_f32_16x16x32_bf16 v[192:195], v[228:231], v[12:15], v[192:195]
v_mfma_f32_16x16x32_bf16 v[196:199], v[224:227], v[40:43], v[196:199]
v_mfma_f32_16x16x32_bf16 v[196:199], v[228:231], v[44:47], v[196:199]
v_mfma_f32_16x16x32_bf16 v[200:203], v[224:227], v[72:75], v[200:203]
ds_read_b128 v[244:247], v248 offset:12800
v_mfma_f32_16x16x32_bf16 v[200:203], v[228:231], v[76:79], v[200:203]
v_mfma_f32_16x16x32_bf16 v[204:207], v[224:227], v[104:107], v[204:207]
v_mfma_f32_16x16x32_bf16 v[204:207], v[228:231], v[108:111], v[204:207]
s_waitcnt lgkmcnt(2)
v_mfma_f32_16x16x32_bf16 v[192:195], v[232:235], v[16:19], v[192:195]
ds_read_b64_tr_b16 v[224:225], v249 offset:32768
v_mfma_f32_16x16x32_bf16 v[192:195], v[236:239], v[20:23], v[192:195]
v_mfma_f32_16x16x32_bf16 v[196:199], v[232:235], v[48:51], v[196:199]
ds_read_b64_tr_b16 v[226:227], v249 offset:34816
v_mfma_f32_16x16x32_bf16 v[196:199], v[236:239], v[52:55], v[196:199]
v_mfma_f32_16x16x32_bf16 v[200:203], v[232:235], v[80:83], v[200:203]
ds_read_b64_tr_b16 v[228:229], v249 offset:49152
v_mfma_f32_16x16x32_bf16 v[200:203], v[236:239], v[84:87], v[200:203]
v_mfma_f32_16x16x32_bf16 v[204:207], v[232:235], v[112:115], v[204:207]
ds_read_b64_tr_b16 v[230:231], v249 offset:51200
v_mfma_f32_16x16x32_bf16 v[204:207], v[236:239], v[116:119], v[204:207]
s_waitcnt lgkmcnt(4)
v_mfma_f32_16x16x32_bf16 v[192:195], v[240:243], v[24:27], v[192:195]
ds_read_b64_tr_b16 v[232:233], v250 offset:32768
v_mfma_f32_16x16x32_bf16 v[192:195], v[244:247], v[28:31], v[192:195]
v_mfma_f32_16x16x32_bf16 v[196:199], v[240:243], v[56:59], v[196:199]
ds_read_b64_tr_b16 v[234:235], v250 offset:34816
v_mfma_f32_16x16x32_bf16 v[196:199], v[244:247], v[60:63], v[196:199]
v_mfma_f32_16x16x32_bf16 v[200:203], v[240:243], v[88:91], v[200:203]
ds_read_b64_tr_b16 v[236:237], v250 offset:49152
v_mfma_f32_16x16x32_bf16 v[200:203], v[244:247], v[92:95], v[200:203]
s_sub_u32 s31, s31, 1
v_mfma_f32_16x16x32_bf16 v[204:207], v[240:243], v[120:123], v[204:207]
ds_read_b64_tr_b16 v[238:239], v250 offset:51200
v_mfma_f32_16x16x32_bf16 v[204:207], v[244:247], v[124:127], v[204:207]
s_cbranch_scc1 L2_tail_1
s_waitcnt lgkmcnt(4)
v_mfma_f32_16x16x32_bf16 a[0:3], v[224:227], v[160:163], a[0:3]
ds_read_b64_tr_b16 v[240:241], v249 offset:33280
v_mfma_f32_16x16x32_bf16 a[0:3], v[228:231], v[176:179], a[0:3]
v_mfma_f32_16x16x32_bf16 a[4:7], v[224:227], v[164:167], a[4:7]
ds_read_b64_tr_b16 v[242:243], v249 offset:35328
v_mfma_f32_16x16x32_bf16 a[4:7], v[228:231], v[180:183], a[4:7]
v_exp_f32 v192, v192
v_mfma_f32_16x16x32_bf16 a[8:11], v[224:227], v[168:171], a[8:11]
ds_read_b64_tr_b16 v[244:245], v249 offset:49664
v_mfma_f32_16x16x32_bf16 a[8:11], v[228:231], v[184:187], a[8:11]
v_exp_f32 v193, v193
v_mfma_f32_16x16x32_bf16 a[12:15], v[224:227], v[172:175], a[12:15]
ds_read_b64_tr_b16 v[246:247], v249 offset:51712
v_cvt_pk_bf16_f32 v128, v192, v193
v_mfma_f32_16x16x32_bf16 a[12:15], v[228:231], v[188:191], a[12:15]
s_waitcnt lgkmcnt(4)
v_mfma_f32_16x16x32_bf16 a[16:19], v[232:235], v[160:163], a[16:19]
ds_read_b64_tr_b16 v[144:145], v250 offset:33280
v_mfma_f32_16x16x32_bf16 a[16:19], v[236:239], v[176:179], a[16:19]
v_exp_f32 v194, v194
v_mfma_f32_16x16x32_bf16 a[20:23], v[232:235], v[164:167], a[20:23]
ds_read_b64_tr_b16 v[146:147], v250 offset:35328
v_mfma_f32_16x16x32_bf16 a[20:23], v[236:239], v[180:183], a[20:23]
v_exp_f32 v195, v195
v_mfma_f32_16x16x32_bf16 a[24:27], v[232:235], v[168:171], a[24:27]
ds_read_b64_tr_b16 v[148:149], v250 offset:49664
v_cvt_pk_bf16_f32 v129, v194, v195
v_mfma_f32_16x16x32_bf16 a[24:27], v[236:239], v[184:187], a[24:27]
v_exp_f32 v196, v196
v_mfma_f32_16x16x32_bf16 a[28:31], v[232:235], v[172:175], a[28:31]
ds_read_b64_tr_b16 v[150:151], v250 offset:51712
v_mfma_f32_16x16x32_bf16 a[28:31], v[236:239], v[188:191], a[28:31]
s_waitcnt lgkmcnt(4)
v_mfma_f32_16x16x32_bf16 a[32:35], v[240:243], v[160:163], a[32:35]
ds_read_b128 v[224:227], v248 offset:2048
v_mfma_f32_16x16x32_bf16 a[32:35], v[244:247], v[176:179], a[32:35]
v_exp_f32 v197, v197
v_mfma_f32_16x16x32_bf16 a[36:39], v[240:243], v[164:167], a[36:39]
v_exp_f32 v198, v198
v_mfma_f32_16x16x32_bf16 a[36:39], v[244:247], v[180:183], a[36:39]
v_exp_f32 v199, v199
v_mfma_f32_16x16x32_bf16 a[40:43], v[240:243], v[168:171], a[40:43]
ds_read_b128 v[228:231], v248 offset:2560
v_cvt_pk_bf16_f32 v132, v196, v197
v_mfma_f32_16x16x32_bf16 a[40:43], v[244:247], v[184:187], a[40:43]
v_cvt_pk_bf16_f32 v133, v198, v199
v_mfma_f32_16x16x32_bf16 a[44:47], v[240:243], v[172:175], a[44:47]
v_exp_f32 v200, v200
v_mfma_f32_16x16x32_bf16 a[44:47], v[244:247], v[188:191], a[44:47]
s_waitcnt lgkmcnt(2)
v_mfma_f32_16x16x32_bf16 a[48:51], v[144:147], v[160:163], a[48:51]
ds_read_b128 v[232:235], v248 offset:6144
v_mfma_f32_16x16x32_bf16 a[48:51], v[148:151], v[176:179], a[48:51]
v_exp_f32 v201, v201
v_mfma_f32_16x16x32_bf16 a[52:55], v[144:147], v[164:167], a[52:55]
v_exp_f32 v202, v202
v_mfma_f32_16x16x32_bf16 a[52:55], v[148:151], v[180:183], a[52:55]
v_exp_f32 v203, v203
v_mfma_f32_16x16x32_bf16 a[56:59], v[144:147], v[168:171], a[56:59]
ds_read_b128 v[236:239], v248 offset:6656
v_cvt_pk_bf16_f32 v136, v200, v201
v_mfma_f32_16x16x32_bf16 a[56:59], v[148:151], v[184:187], a[56:59]
v_cvt_pk_bf16_f32 v137, v202, v203
v_mfma_f32_16x16x32_bf16 a[60:63], v[144:147], v[172:175], a[60:63]
v_exp_f32 v204, v204
v_mfma_f32_16x16x32_bf16 a[60:63], v[148:151], v[188:191], a[60:63]
s_waitcnt lgkmcnt(2)
v_mfma_f32_16x16x32_bf16 v[208:211], v[224:227], v[0:3], 0
ds_read_b128 v[240:243], v248 offset:10240
v_mfma_f32_16x16x32_bf16 v[208:211], v[228:231], v[4:7], v[208:211]
v_exp_f32 v205, v205
v_mfma_f32_16x16x32_bf16 v[212:215], v[224:227], v[32:35], 0
v_exp_f32 v206, v206
v_mfma_f32_16x16x32_bf16 v[212:215], v[228:231], v[36:39], v[212:215]
v_exp_f32 v207, v207
v_mfma_f32_16x16x32_bf16 v[216:219], v[224:227], v[64:67], 0
ds_read_b128 v[244:247], v248 offset:10752
v_cvt_pk_bf16_f32 v140, v204, v205
v_mfma_f32_16x16x32_bf16 v[216:219], v[228:231], v[68:71], v[216:219]
v_cvt_pk_bf16_f32 v141, v206, v207
v_mfma_f32_16x16x32_bf16 v[220:223], v[224:227], v[96:99], 0
v_mfma_f32_16x16x32_bf16 v[220:223], v[228:231], v[100:103], v[220:223]
s_waitcnt lgkmcnt(2)
v_mfma_f32_16x16x32_bf16 v[208:211], v[232:235], v[8:11], v[208:211]
ds_read_b128 v[144:147], v248 offset:14336
v_mfma_f32_16x16x32_bf16 v[208:211], v[236:239], v[12:15], v[208:211]
v_mfma_f32_16x16x32_bf16 v[212:215], v[232:235], v[40:43], v[212:215]
v_mfma_f32_16x16x32_bf16 v[212:215], v[236:239], v[44:47], v[212:215]
v_mfma_f32_16x16x32_bf16 v[216:219], v[232:235], v[72:75], v[216:219]
ds_read_b128 v[148:151], v248 offset:14848
v_mfma_f32_16x16x32_bf16 v[216:219], v[236:239], v[76:79], v[216:219]
v_mfma_f32_16x16x32_bf16 v[220:223], v[232:235], v[104:107], v[220:223]
v_mfma_f32_16x16x32_bf16 v[220:223], v[236:239], v[108:111], v[220:223]
s_waitcnt lgkmcnt(2)
v_mfma_f32_16x16x32_bf16 v[208:211], v[240:243], v[16:19], v[208:211]
ds_read_b64_tr_b16 v[224:225], v249 offset:36864
v_mfma_f32_16x16x32_bf16 v[208:211], v[244:247], v[20:23], v[208:211]
v_mfma_f32_16x16x32_bf16 v[212:215], v[240:243], v[48:51], v[212:215]
ds_read_b64_tr_b16 v[226:227], v249 offset:38912
v_mfma_f32_16x16x32_bf16 v[212:215], v[244:247], v[52:55], v[212:215]
v_mfma_f32_16x16x32_bf16 v[216:219], v[240:243], v[80:83], v[216:219]
ds_read_b64_tr_b16 v[228:229], v249 offset:53248
v_mfma_f32_16x16x32_bf16 v[216:219], v[244:247], v[84:87], v[216:219]
v_mfma_f32_16x16x32_bf16 v[220:223], v[240:243], v[112:115], v[220:223]
ds_read_b64_tr_b16 v[230:231], v249 offset:55296
v_mfma_f32_16x16x32_bf16 v[220:223], v[244:247], v[116:119], v[220:223]
s_waitcnt lgkmcnt(4)
v_mfma_f32_16x16x32_bf16 v[208:211], v[144:147], v[24:27], v[208:211]
ds_read_b64_tr_b16 v[232:233], v250 offset:36864
v_mfma_f32_16x16x32_bf16 v[208:211], v[148:151], v[28:31], v[208:211]
v_mfma_f32_16x16x32_bf16 v[212:215], v[144:147], v[56:59], v[212:215]
ds_read_b64_tr_b16 v[234:235], v250 offset:38912
v_mfma_f32_16x16x32_bf16 v[212:215], v[148:151], v[60:63], v[212:215]
v_mfma_f32_16x16x32_bf16 v[216:219], v[144:147], v[88:91], v[216:219]
ds_read_b64_tr_b16 v[236:237], v250 offset:53248
v_mfma_f32_16x16x32_bf16 v[216:219], v[148:151], v[92:95], v[216:219]
v_mfma_f32_16x16x32_bf16 v[220:223], v[144:147], v[120:123], v[220:223]
ds_read_b64_tr_b16 v[238:239], v250 offset:55296
v_mfma_f32_16x16x32_bf16 v[220:223], v[148:151], v[124:127], v[220:223]
s_waitcnt lgkmcnt(4)
v_mfma_f32_16x16x32_bf16 a[64:67], v[224:227], v[160:163], a[64:67]
ds_read_b64_tr_b16 v[240:241], v249 offset:37376
v_mfma_f32_16x16x32_bf16 a[64:67], v[228:231], v[176:179], a[64:67]
v_mfma_f32_16x16x32_bf16 a[68:71], v[224:227], v[164:167], a[68:71]
ds_read_b64_tr_b16 v[242:243], v249 offset:39424
v_mfma_f32_16x16x32_bf16 a[68:71], v[228:231], v[180:183], a[68:71]
v_exp_f32 v208, v208
v_mfma_f32_16x16x32_bf16 a[72:75], v[224:227], v[168:171], a[72:75]
ds_read_b64_tr_b16 v[244:245], v249 offset:53760
v_mfma_f32_16x16x32_bf16 a[72:75], v[228:231], v[184:187], a[72:75]
v_exp_f32 v209, v209
v_mfma_f32_16x16x32_bf16 a[76:79], v[224:227], v[172:175], a[76:79]
ds_read_b64_tr_b16 v[246:247], v249 offset:55808
v_cvt_pk_bf16_f32 v130, v208, v209
v_mfma_f32_16x16x32_bf16 a[76:79], v[228:231], v[188:191], a[76:79]
s_waitcnt lgkmcnt(4)
s_waitcnt vmcnt(0)
s_barrier
s_add_u32 m0, s30, 0xc000
v_mfma_f32_16x16x32_bf16 a[80:83], v[232:235], v[160:163], a[80:83]
ds_read_b64_tr_b16 v[224:225], v250 offset:37376
v_mfma_f32_16x16x32_bf16 a[80:83], v[236:239], v[176:179], a[80:83]
buffer_load_dwordx4 v251, s[12:15], s28 offen offset:0 lds
v_mfma_f32_16x16x32_bf16 a[84:87], v[232:235], v[164:167], a[84:87]
ds_read_b64_tr_b16 v[226:227], v250 offset:39424
v_mfma_f32_16x16x32_bf16 a[84:87], v[236:239], v[180:183], a[84:87]
v_exp_f32 v210, v210
v_mfma_f32_16x16x32_bf16 a[88:91], v[232:235], v[168:171], a[88:91]
ds_read_b64_tr_b16 v[228:229], v250 offset:53760
v_mfma_f32_16x16x32_bf16 a[88:91], v[236:239], v[184:187], a[88:91]
v_exp_f32 v211, v211
v_mfma_f32_16x16x32_bf16 a[92:95], v[232:235], v[172:175], a[92:95]
ds_read_b64_tr_b16 v[230:231], v250 offset:55808
v_cvt_pk_bf16_f32 v131, v210, v211
v_mfma_f32_16x16x32_bf16 a[92:95], v[236:239], v[188:191], a[92:95]
s_waitcnt lgkmcnt(4)
v_mfma_f32_16x16x32_bf16 a[96:99], v[240:243], v[160:163], a[96:99]
ds_read_b128 v[232:235], v248 offset:16384
v_mfma_f32_16x16x32_bf16 a[96:99], v[244:247], v[176:179], a[96:99]
buffer_load_dwordx4 v251, s[12:15], s28 offen offset:1024 lds
v_mfma_f32_16x16x32_bf16 a[100:103], v[240:243], v[164:167], a[100:103]
v_exp_f32 v212, v212
v_mfma_f32_16x16x32_bf16 a[100:103], v[244:247], v[180:183], a[100:103]
v_exp_f32 v213, v213
v_mfma_f32_16x16x32_bf16 a[104:107], v[240:243], v[168:171], a[104:107]
ds_read_b128 v[236:239], v248 offset:16896
v_cvt_pk_bf16_f32 v134, v212, v213
v_mfma_f32_16x16x32_bf16 a[104:107], v[244:247], v[184:187], a[104:107]
v_exp_f32 v214, v214
v_mfma_f32_16x16x32_bf16 a[108:111], v[240:243], v[172:175], a[108:111]
v_exp_f32 v215, v215
v_mfma_f32_16x16x32_bf16 a[108:111], v[244:247], v[188:191], a[108:111]
s_waitcnt lgkmcnt(2)
v_cvt_pk_bf16_f32 v135, v214, v215
v_mfma_f32_16x16x32_bf16 a[112:115], v[224:227], v[160:163], a[112:115]
ds_read_b128 v[240:243], v248 offset:20480
v_mfma_f32_16x16x32_bf16 a[112:115], v[228:231], v[176:179], a[112:115]
buffer_load_dwordx4 v251, s[12:15], s28 offen offset:2048 lds
v_mfma_f32_16x16x32_bf16 a[116:119], v[224:227], v[164:167], a[116:119]
v_exp_f32 v216, v216
v_mfma_f32_16x16x32_bf16 a[116:119], v[228:231], v[180:183], a[116:119]
v_exp_f32 v217, v217
v_mfma_f32_16x16x32_bf16 a[120:123], v[224:227], v[168:171], a[120:123]
ds_read_b128 v[244:247], v248 offset:20992
v_cvt_pk_bf16_f32 v138, v216, v217
v_mfma_f32_16x16x32_bf16 a[120:123], v[228:231], v[184:187], a[120:123]
v_exp_f32 v218, v218
v_mfma_f32_16x16x32_bf16 a[124:127], v[224:227], v[172:175], a[124:127]
v_exp_f32 v219, v219
v_mfma_f32_16x16x32_bf16 a[124:127], v[228:231], v[188:191], a[124:127]
s_waitcnt lgkmcnt(2)
v_cvt_pk_bf16_f32 v139, v218, v219
v_mfma_f32_16x16x32_bf16 v[192:195], v[232:235], v[0:3], 0
ds_read_b128 v[224:227], v248 offset:24576
v_mfma_f32_16x16x32_bf16 v[192:195], v[236:239], v[4:7], v[192:195]
buffer_load_dwordx4 v251, s[12:15], s28 offen offset:3072 lds
v_mfma_f32_16x16x32_bf16 v[196:199], v[232:235], v[32:35], 0
s_xor_b32 s30, s30, 0x10000
v_mfma_f32_16x16x32_bf16 v[196:199], v[236:239], v[36:39], v[196:199]
s_add_u32 s28, s28, 0x4000
v_mfma_f32_16x16x32_bf16 v[200:203], v[232:235], v[64:67], 0
ds_read_b128 v[228:231], v248 offset:25088
v_mfma_f32_16x16x32_bf16 v[200:203], v[236:239], v[68:71], v[200:203]
v_exp_f32 v220, v220
v_mfma_f32_16x16x32_bf16 v[204:207], v[232:235], v[96:99], 0
v_exp_f32 v221, v221
v_mfma_f32_16x16x32_bf16 v[204:207], v[236:239], v[100:103], v[204:207]
s_waitcnt lgkmcnt(2)
s_add_u32 m0, s30, 0x0
v_mfma_f32_16x16x32_bf16 v[192:195], v[240:243], v[8:11], v[192:195]
ds_read_b128 v[232:235], v248 offset:28672
v_cvt_pk_bf16_f32 v142, v220, v221
v_mfma_f32_16x16x32_bf16 v[192:195], v[244:247], v[12:15], v[192:195]
buffer_load_dwordx4 v251, s[12:15], s28 offen offset:0 lds
v_mfma_f32_16x16x32_bf16 v[196:199], v[240:243], v[40:43], v[196:199]
v_exp_f32 v222, v222
v_mfma_f32_16x16x32_bf16 v[196:199], v[244:247], v[44:47], v[196:199]
v_exp_f32 v223, v223
v_mfma_f32_16x16x32_bf16 v[200:203], v[240:243], v[72:75], v[200:203]
ds_read_b128 v[236:239], v248 offset:29184
v_cvt_pk_bf16_f32 v143, v222, v223
v_mfma_f32_16x16x32_bf16 v[200:203], v[244:247], v[76:79], v[200:203]
v_mfma_f32_16x16x32_bf16 v[204:207], v[240:243], v[104:107], v[204:207]
v_mfma_f32_16x16x32_bf16 v[204:207], v[244:247], v[108:111], v[204:207]
s_waitcnt lgkmcnt(2)
v_mfma_f32_16x16x32_bf16 v[192:195], v[224:227], v[16:19], v[192:195]
ds_read_b64_tr_b16 v[240:241], v249 offset:40960
v_mfma_f32_16x16x32_bf16 v[192:195], v[228:231], v[20:23], v[192:195]
buffer_load_dwordx4 v251, s[12:15], s28 offen offset:1024 lds
v_mfma_f32_16x16x32_bf16 v[196:199], v[224:227], v[48:51], v[196:199]
ds_read_b64_tr_b16 v[242:243], v249 offset:43008
v_mfma_f32_16x16x32_bf16 v[196:199], v[228:231], v[52:55], v[196:199]
v_mfma_f32_16x16x32_bf16 v[200:203], v[224:227], v[80:83], v[200:203]
ds_read_b64_tr_b16 v[244:245], v249 offset:57344
v_mfma_f32_16x16x32_bf16 v[200:203], v[228:231], v[84:87], v[200:203]
v_mfma_f32_16x16x32_bf16 v[204:207], v[224:227], v[112:115], v[204:207]
ds_read_b64_tr_b16 v[246:247], v249 offset:59392
v_mfma_f32_16x16x32_bf16 v[204:207], v[228:231], v[116:119], v[204:207]
s_waitcnt lgkmcnt(4)
v_mfma_f32_16x16x32_bf16 v[192:195], v[232:235], v[24:27], v[192:195]
ds_read_b64_tr_b16 v[224:225], v250 offset:40960
v_mfma_f32_16x16x32_bf16 v[192:195], v[236:239], v[28:31], v[192:195]
buffer_load_dwordx4 v251, s[12:15], s28 offen offset:2048 lds
v_mfma_f32_16x16x32_bf16 v[196:199], v[232:235], v[56:59], v[196:199]
ds_read_b64_tr_b16 v[226:227], v250 offset:43008
v_mfma_f32_16x16x32_bf16 v[196:199], v[236:239], v[60:63], v[196:199]
v_mfma_f32_16x16x32_bf16 v[200:203], v[232:235], v[88:91], v[200:203]
ds_read_b64_tr_b16 v[228:229], v250 offset:57344
v_mfma_f32_16x16x32_bf16 v[200:203], v[236:239], v[92:95], v[200:203]
v_mfma_f32_16x16x32_bf16 v[204:207], v[232:235], v[120:123], v[204:207]
ds_read_b64_tr_b16 v[230:231], v250 offset:59392
v_mfma_f32_16x16x32_bf16 v[204:207], v[236:239], v[124:127], v[204:207]
s_waitcnt lgkmcnt(4)
v_mfma_f32_16x16x32_bf16 a[128:131], v[240:243], v[160:163], a[128:131]
ds_read_b64_tr_b16 v[232:233], v249 offset:41472
v_mfma_f32_16x16x32_bf16 a[128:131], v[244:247], v[176:179], a[128:131]
buffer_load_dwordx4 v251, s[12:15], s28 offen offset:3072 lds
v_mfma_f32_16x16x32_bf16 a[132:135], v[240:243], v[164:167], a[132:135]
ds_read_b64_tr_b16 v[234:235], v249 offset:43520
v_mfma_f32_16x16x32_bf16 a[132:135], v[244:247], v[180:183], a[132:135]
s_add_u32 s28, s28, 0x4000
v_mfma_f32_16x16x32_bf16 a[136:139], v[240:243], v[168:171], a[136:139]
ds_read_b64_tr_b16 v[236:237], v249 offset:57856
v_mfma_f32_16x16x32_bf16 a[136:139], v[244:247], v[184:187], a[136:139]
v_exp_f32 v192, v192
v_mfma_f32_16x16x32_bf16 a[140:143], v[240:243], v[172:175], a[140:143]
ds_read_b64_tr_b16 v[238:239], v249 offset:59904
v_mfma_f32_16x16x32_bf16 a[140:143], v[244:247], v[188:191], a[140:143]
s_waitcnt lgkmcnt(4)
v_mfma_f32_16x16x32_bf16 a[144:147], v[224:227], v[160:163], a[144:147]
ds_read_b64_tr_b16 v[240:241], v250 offset:41472
v_mfma_f32_16x16x32_bf16 a[144:147], v[228:231], v[176:179], a[144:147]
v_exp_f32 v193, v193
v_mfma_f32_16x16x32_bf16 a[148:151], v[224:227], v[164:167], a[148:151]
ds_read_b64_tr_b16 v[242:243], v250 offset:43520
v_cvt_pk_bf16_f32 v144, v192, v193
v_mfma_f32_16x16x32_bf16 a[148:151], v[228:231], v[180:183], a[148:151]
v_exp_f32 v194, v194
v_mfma_f32_16x16x32_bf16 a[152:155], v[224:227], v[168:171], a[152:155]
ds_read_b64_tr_b16 v[244:245], v250 offset:57856
v_mfma_f32_16x16x32_bf16 a[152:155], v[228:231], v[184:187], a[152:155]
v_exp_f32 v195, v195
v_mfma_f32_16x16x32_bf16 a[156:159], v[224:227], v[172:175], a[156:159]
ds_read_b64_tr_b16 v[246:247], v250 offset:59904
v_cvt_pk_bf16_f32 v145, v194, v195
v_mfma_f32_16x16x32_bf16 a[156:159], v[228:231], v[188:191], a[156:159]
s_waitcnt lgkmcnt(4)
v_mfma_f32_16x16x32_bf16 a[160:163], v[232:235], v[160:163], a[160:163]
ds_read_b128 v[224:227], v248 offset:18432
v_mfma_f32_16x16x32_bf16 a[160:163], v[236:239], v[176:179], a[160:163]
v_exp_f32 v196, v196
v_mfma_f32_16x16x32_bf16 a[164:167], v[232:235], v[164:167], a[164:167]
v_exp_f32 v197, v197
v_mfma_f32_16x16x32_bf16 a[164:167], v[236:239], v[180:183], a[164:167]
v_exp_f32 v198, v198
v_mfma_f32_16x16x32_bf16 a[168:171], v[232:235], v[168:171], a[168:171]
ds_read_b128 v[228:231], v248 offset:18944
v_cvt_pk_bf16_f32 v148, v196, v197
v_mfma_f32_16x16x32_bf16 a[168:171], v[236:239], v[184:187], a[168:171]
v_exp_f32 v199, v199
v_mfma_f32_16x16x32_bf16 a[172:175], v[232:235], v[172:175], a[172:175]
v_exp_f32 v200, v200
v_mfma_f32_16x16x32_bf16 a[172:175], v[236:239], v[188:191], a[172:175]
s_waitcnt lgkmcnt(2)
v_cvt_pk_bf16_f32 v149, v198, v199
v_mfma_f32_16x16x32_bf16 a[176:179], v[240:243], v[160:163], a[176:179]
ds_read_b128 v[232:235], v248 offset:22528
v_mfma_f32_16x16x32_bf16 a[176:179], v[244:247], v[176:179], a[176:179]
v_exp_f32 v201, v201
v_mfma_f32_16x16x32_bf16 a[180:183], v[240:243], v[164:167], a[180:183]
v_exp_f32 v202, v202
v_mfma_f32_16x16x32_bf16 a[180:183], v[244:247], v[180:183], a[180:183]
v_exp_f32 v203, v203
v_mfma_f32_16x16x32_bf16 a[184:187], v[240:243], v[168:171], a[184:187]
ds_read_b128 v[236:239], v248 offset:23040
v_cvt_pk_bf16_f32 v152, v200, v201
v_mfma_f32_16x16x32_bf16 a[184:187], v[244:247], v[184:187], a[184:187]
v_cvt_pk_bf16_f32 v153, v202, v203
v_mfma_f32_16x16x32_bf16 a[188:191], v[240:243], v[172:175], a[188:191]
v_exp_f32 v204, v204
v_mfma_f32_16x16x32_bf16 a[188:191], v[244:247], v[188:191], a[188:191]
s_waitcnt lgkmcnt(2)
v_mfma_f32_16x16x32_bf16 v[208:211], v[224:227], v[0:3], 0
ds_read_b128 v[240:243], v248 offset:26624
v_mfma_f32_16x16x32_bf16 v[208:211], v[228:231], v[4:7], v[208:211]
v_exp_f32 v205, v205
v_mfma_f32_16x16x32_bf16 v[212:215], v[224:227], v[32:35], 0
v_exp_f32 v206, v206
v_mfma_f32_16x16x32_bf16 v[212:215], v[228:231], v[36:39], v[212:215]
v_exp_f32 v207, v207
v_mfma_f32_16x16x32_bf16 v[216:219], v[224:227], v[64:67], 0
ds_read_b128 v[244:247], v248 offset:27136
v_cvt_pk_bf16_f32 v156, v204, v205
v_mfma_f32_16x16x32_bf16 v[216:219], v[228:231], v[68:71], v[216:219]
v_cvt_pk_bf16_f32 v157, v206, v207
v_mfma_f32_16x16x32_bf16 v[220:223], v[224:227], v[96:99], 0
v_mfma_f32_16x16x32_bf16 v[220:223], v[228:231], v[100:103], v[220:223]
s_waitcnt lgkmcnt(2)
v_mfma_f32_16x16x32_bf16 v[208:211], v[232:235], v[8:11], v[208:211]
ds_read_b128 v[224:227], v248 offset:30720
v_mfma_f32_16x16x32_bf16 v[208:211], v[236:239], v[12:15], v[208:211]
v_mfma_f32_16x16x32_bf16 v[212:215], v[232:235], v[40:43], v[212:215]
v_mfma_f32_16x16x32_bf16 v[212:215], v[236:239], v[44:47], v[212:215]
v_mfma_f32_16x16x32_bf16 v[216:219], v[232:235], v[72:75], v[216:219]
ds_read_b128 v[228:231], v248 offset:31232
v_mfma_f32_16x16x32_bf16 v[216:219], v[236:239], v[76:79], v[216:219]
v_mfma_f32_16x16x32_bf16 v[220:223], v[232:235], v[104:107], v[220:223]
v_mfma_f32_16x16x32_bf16 v[220:223], v[236:239], v[108:111], v[220:223]
s_waitcnt lgkmcnt(2)
v_mfma_f32_16x16x32_bf16 v[208:211], v[240:243], v[16:19], v[208:211]
ds_read_b64_tr_b16 v[232:233], v249 offset:45056
v_mfma_f32_16x16x32_bf16 v[208:211], v[244:247], v[20:23], v[208:211]
v_mfma_f32_16x16x32_bf16 v[212:215], v[240:243], v[48:51], v[212:215]
ds_read_b64_tr_b16 v[234:235], v249 offset:47104
v_mfma_f32_16x16x32_bf16 v[212:215], v[244:247], v[52:55], v[212:215]
v_mfma_f32_16x16x32_bf16 v[216:219], v[240:243], v[80:83], v[216:219]
ds_read_b64_tr_b16 v[236:237], v249 offset:61440
v_mfma_f32_16x16x32_bf16 v[216:219], v[244:247], v[84:87], v[216:219]
v_mfma_f32_16x16x32_bf16 v[220:223], v[240:243], v[112:115], v[220:223]
ds_read_b64_tr_b16 v[238:239], v249 offset:63488
v_mfma_f32_16x16x32_bf16 v[220:223], v[244:247], v[116:119], v[220:223]
s_waitcnt lgkmcnt(4)
v_mfma_f32_16x16x32_bf16 v[208:211], v[224:227], v[24:27], v[208:211]
ds_read_b64_tr_b16 v[240:241], v250 offset:45056
v_mfma_f32_16x16x32_bf16 v[208:211], v[228:231], v[28:31], v[208:211]
v_mfma_f32_16x16x32_bf16 v[212:215], v[224:227], v[56:59], v[212:215]
ds_read_b64_tr_b16 v[242:243], v250 offset:47104
v_mfma_f32_16x16x32_bf16 v[212:215], v[228:231], v[60:63], v[212:215]
v_mfma_f32_16x16x32_bf16 v[216:219], v[224:227], v[88:91], v[216:219]
ds_read_b64_tr_b16 v[244:245], v250 offset:61440
v_mfma_f32_16x16x32_bf16 v[216:219], v[228:231], v[92:95], v[216:219]
v_mfma_f32_16x16x32_bf16 v[220:223], v[224:227], v[120:123], v[220:223]
ds_read_b64_tr_b16 v[246:247], v250 offset:63488
v_mfma_f32_16x16x32_bf16 v[220:223], v[228:231], v[124:127], v[220:223]
s_waitcnt lgkmcnt(4)
v_mfma_f32_16x16x32_bf16 a[192:195], v[232:235], v[160:163], a[192:195]
ds_read_b64_tr_b16 v[224:225], v249 offset:45568
v_mfma_f32_16x16x32_bf16 a[192:195], v[236:239], v[176:179], a[192:195]
v_mfma_f32_16x16x32_bf16 a[196:199], v[232:235], v[164:167], a[196:199]
ds_read_b64_tr_b16 v[226:227], v249 offset:47616
v_mfma_f32_16x16x32_bf16 a[196:199], v[236:239], v[180:183], a[196:199]
v_exp_f32 v208, v208
v_mfma_f32_16x16x32_bf16 a[200:203], v[232:235], v[168:171], a[200:203]
ds_read_b64_tr_b16 v[228:229], v249 offset:61952
v_mfma_f32_16x16x32_bf16 a[200:203], v[236:239], v[184:187], a[200:203]
v_exp_f32 v209, v209
v_mfma_f32_16x16x32_bf16 a[204:207], v[232:235], v[172:175], a[204:207]
ds_read_b64_tr_b16 v[230:231], v249 offset:64000
v_cvt_pk_bf16_f32 v146, v208, v209
v_mfma_f32_16x16x32_bf16 a[204:207], v[236:239], v[188:191], a[204:207]
s_waitcnt lgkmcnt(4)
v_mfma_f32_16x16x32_bf16 a[208:211], v[240:243], v[160:163], a[208:211]
ds_read_b64_tr_b16 v[232:233], v250 offset:45568
v_mfma_f32_16x16x32_bf16 a[208:211], v[244:247], v[176:179], a[208:211]
v_exp_f32 v210, v210
v_mfma_f32_16x16x32_bf16 a[212:215], v[240:243], v[164:167], a[212:215]
ds_read_b64_tr_b16 v[234:235], v250 offset:47616
v_mfma_f32_16x16x32_bf16 a[212:215], v[244:247], v[180:183], a[212:215]
v_exp_f32 v211, v211
v_mfma_f32_16x16x32_bf16 a[216:219], v[240:243], v[168:171], a[216:219]
ds_read_b64_tr_b16 v[236:237], v250 offset:61952
v_cvt_pk_bf16_f32 v147, v210, v211
v_mfma_f32_16x16x32_bf16 a[216:219], v[244:247], v[184:187], a[216:219]
v_exp_f32 v212, v212
v_mfma_f32_16x16x32_bf16 a[220:223], v[240:243], v[172:175], a[220:223]
ds_read_b64_tr_b16 v[238:239], v250 offset:64000
v_mfma_f32_16x16x32_bf16 a[220:223], v[244:247], v[188:191], a[220:223]
s_waitcnt lgkmcnt(4)
v_mfma_f32_16x16x32_bf16 a[224:227], v[224:227], v[160:163], a[224:227]
ds_read_b128 v[240:243], v248 offset:32768
v_mfma_f32_16x16x32_bf16 a[224:227], v[228:231], v[176:179], a[224:227]
v_exp_f32 v213, v213
v_mfma_f32_16x16x32_bf16 a[228:231], v[224:227], v[164:167], a[228:231]
v_exp_f32 v214, v214
v_mfma_f32_16x16x32_bf16 a[228:231], v[228:231], v[180:183], a[228:231]
v_exp_f32 v215, v215
v_mfma_f32_16x16x32_bf16 a[232:235], v[224:227], v[168:171], a[232:235]
ds_read_b128 v[244:247], v248 offset:33280
v_cvt_pk_bf16_f32 v150, v212, v213
v_mfma_f32_16x16x32_bf16 a[232:235], v[228:231], v[184:187], a[232:235]
v_cvt_pk_bf16_f32 v151, v214, v215
v_mfma_f32_16x16x32_bf16 a[236:239], v[224:227], v[172:175], a[236:239]
v_exp_f32 v216, v216
v_mfma_f32_16x16x32_bf16 a[236:239], v[228:231], v[188:191], a[236:239]
s_waitcnt lgkmcnt(2)
v_mfma_f32_16x16x32_bf16 a[240:243], v[232:235], v[160:163], a[240:243]
ds_read_b128 v[224:227], v248 offset:36864
v_mfma_f32_16x16x32_bf16 a[240:243], v[236:239], v[176:179], a[240:243]
v_exp_f32 v217, v217
v_mfma_f32_16x16x32_bf16 a[244:247], v[232:235], v[164:167], a[244:247]
v_exp_f32 v218, v218
v_mfma_f32_16x16x32_bf16 a[244:247], v[236:239], v[180:183], a[244:247]
v_exp_f32 v219, v219
v_mfma_f32_16x16x32_bf16 a[248:251], v[232:235], v[168:171], a[248:251]
ds_read_b128 v[228:231], v248 offset:37376
v_cvt_pk_bf16_f32 v154, v216, v217
v_mfma_f32_16x16x32_bf16 a[248:251], v[236:239], v[184:187], a[248:251]
v_cvt_pk_bf16_f32 v155, v218, v219
v_mfma_f32_16x16x32_bf16 a[252:255], v[232:235], v[172:175], a[252:255]
v_exp_f32 v220, v220
v_mfma_f32_16x16x32_bf16 a[252:255], v[236:239], v[188:191], a[252:255]
s_waitcnt lgkmcnt(2)
v_mfma_f32_16x16x32_bf16 v[192:195], v[240:243], v[0:3], 0
ds_read_b128 v[232:235], v248 offset:40960
v_mfma_f32_16x16x32_bf16 v[192:195], v[244:247], v[4:7], v[192:195]
v_xor_b32 v249, 0x10000, v249
v_mfma_f32_16x16x32_bf16 v[196:199], v[240:243], v[32:35], 0
v_exp_f32 v221, v221
v_mfma_f32_16x16x32_bf16 v[196:199], v[244:247], v[36:39], v[196:199]
v_xor_b32 v250, 0x10000, v250
v_cvt_pk_bf16_f32 v158, v220, v221
v_mfma_f32_16x16x32_bf16 v[200:203], v[240:243], v[64:67], 0
ds_read_b128 v[236:239], v248 offset:41472
v_mfma_f32_16x16x32_bf16 v[200:203], v[244:247], v[68:71], v[200:203]
v_exp_f32 v222, v222
v_mfma_f32_16x16x32_bf16 v[204:207], v[240:243], v[96:99], 0
v_exp_f32 v223, v223
v_mfma_f32_16x16x32_bf16 v[204:207], v[244:247], v[100:103], v[204:207]
s_waitcnt lgkmcnt(2)
v_cvt_pk_bf16_f32 v159, v222, v223
v_mfma_f32_16x16x32_bf16 v[192:195], v[224:227], v[8:11], v[192:195]
ds_read_b128 v[240:243], v248 offset:45056
v_mfma_f32_16x16x32_bf16 v[192:195], v[228:231], v[12:15], v[192:195]
v_mfma_f32_16x16x32_bf16 v[196:199], v[224:227], v[40:43], v[196:199]
v_mfma_f32_16x16x32_bf16 v[196:199], v[228:231], v[44:47], v[196:199]
v_mfma_f32_16x16x32_bf16 v[200:203], v[224:227], v[72:75], v[200:203]
ds_read_b128 v[244:247], v248 offset:45568
v_mfma_f32_16x16x32_bf16 v[200:203], v[228:231], v[76:79], v[200:203]
v_mfma_f32_16x16x32_bf16 v[204:207], v[224:227], v[104:107], v[204:207]
v_mfma_f32_16x16x32_bf16 v[204:207], v[228:231], v[108:111], v[204:207]
s_waitcnt lgkmcnt(2)
v_mfma_f32_16x16x32_bf16 v[192:195], v[232:235], v[16:19], v[192:195]
ds_read_b64_tr_b16 v[224:225], v249 offset:0
v_mfma_f32_16x16x32_bf16 v[192:195], v[236:239], v[20:23], v[192:195]
v_mfma_f32_16x16x32_bf16 v[196:199], v[232:235], v[48:51], v[196:199]
ds_read_b64_tr_b16 v[226:227], v249 offset:2048
v_mfma_f32_16x16x32_bf16 v[196:199], v[236:239], v[52:55], v[196:199]
v_mfma_f32_16x16x32_bf16 v[200:203], v[232:235], v[80:83], v[200:203]
ds_read_b64_tr_b16 v[228:229], v249 offset:16384
v_mfma_f32_16x16x32_bf16 v[200:203], v[236:239], v[84:87], v[200:203]
v_mfma_f32_16x16x32_bf16 v[204:207], v[232:235], v[112:115], v[204:207]
ds_read_b64_tr_b16 v[230:231], v249 offset:18432
v_mfma_f32_16x16x32_bf16 v[204:207], v[236:239], v[116:119], v[204:207]
s_waitcnt lgkmcnt(4)
v_mfma_f32_16x16x32_bf16 v[192:195], v[240:243], v[24:27], v[192:195]
ds_read_b64_tr_b16 v[232:233], v250 offset:0
v_mfma_f32_16x16x32_bf16 v[192:195], v[244:247], v[28:31], v[192:195]
v_mfma_f32_16x16x32_bf16 v[196:199], v[240:243], v[56:59], v[196:199]
ds_read_b64_tr_b16 v[234:235], v250 offset:2048
v_mfma_f32_16x16x32_bf16 v[196:199], v[244:247], v[60:63], v[196:199]
v_mfma_f32_16x16x32_bf16 v[200:203], v[240:243], v[88:91], v[200:203]
ds_read_b64_tr_b16 v[236:237], v250 offset:16384
v_mfma_f32_16x16x32_bf16 v[200:203], v[244:247], v[92:95], v[200:203]
s_sub_u32 s31, s31, 1
v_mfma_f32_16x16x32_bf16 v[204:207], v[240:243], v[120:123], v[204:207]
ds_read_b64_tr_b16 v[238:239], v250 offset:18432
v_mfma_f32_16x16x32_bf16 v[204:207], v[244:247], v[124:127], v[204:207]
s_cbranch_scc0 L2_loop
L2_tails:
L2_tail_1:
s_cmp_eq_u32 s59, 7
s_cbranch_scc1 L2_tail_1_7
L2_tail_1_6:
s_waitcnt lgkmcnt(4)
v_mfma_f32_16x16x32_bf16 a[0:3], v[224:227], v[160:163], a[0:3]
ds_read_b128 v[240:243], v248 offset:2048
v_mfma_f32_16x16x32_bf16 a[0:3], v[228:231], v[176:179], a[0:3]
s_lshl_b32 s36, s34, 13
v_mfma_f32_16x16x32_bf16 a[4:7], v[224:227], v[164:167], a[4:7]
s_add_u32 s56, s4, 0x1000000
s_addc_u32 s57, s5, 0
v_mfma_f32_16x16x32_bf16 a[4:7], v[228:231], v[180:183], a[4:7]
s_add_u32 s36, s36, 0x20000
s_mov_b32 s58, 0x6c02000
v_mfma_f32_16x16x32_bf16 a[8:11], v[224:227], v[168:171], a[8:11]
ds_read_b128 v[244:247], v248 offset:2560
s_mov_b32 s59, 0x00020000
v_mfma_f32_16x16x32_bf16 a[8:11], v[228:231], v[184:187], a[8:11]
v_add_u32 v255, s36, v252
s_lshr_b32 s35, s2, 1
v_mfma_f32_16x16x32_bf16 a[12:15], v[224:227], v[172:175], a[12:15]
s_and_b32 s35, s35, 28
s_add_u32 s35, s35, s34
v_mfma_f32_16x16x32_bf16 a[12:15], v[228:231], v[188:191], a[12:15]
s_waitcnt lgkmcnt(2)
s_lshl_b32 s35, s35, 13
v_mfma_f32_16x16x32_bf16 a[16:19], v[232:235], v[160:163], a[16:19]
ds_read_b128 v[224:227], v248 offset:6144
v_lshlrev_b32 v253, 3, v252
v_mfma_f32_16x16x32_bf16 a[16:19], v[236:239], v[176:179], a[16:19]
buffer_load_dword v253, v253, s[56:59], s35 offen
ds_write_b128 v255, v[160:163] offset:0
v_mfma_f32_16x16x32_bf16 a[20:23], v[232:235], v[164:167], a[20:23]
v_exp_f32 v192, v192
v_mfma_f32_16x16x32_bf16 a[20:23], v[236:239], v[180:183], a[20:23]
v_exp_f32 v193, v193
v_mfma_f32_16x16x32_bf16 a[24:27], v[232:235], v[168:171], a[24:27]
ds_read_b128 v[228:231], v248 offset:6656
v_cvt_pk_bf16_f32 v128, v192, v193
v_mfma_f32_16x16x32_bf16 a[24:27], v[236:239], v[184:187], a[24:27]
v_exp_f32 v194, v194
v_mfma_f32_16x16x32_bf16 a[28:31], v[232:235], v[172:175], a[28:31]
v_exp_f32 v195, v195
v_mfma_f32_16x16x32_bf16 a[28:31], v[236:239], v[188:191], a[28:31]
s_waitcnt lgkmcnt(3)
v_cvt_pk_bf16_f32 v129, v194, v195
v_mfma_f32_16x16x32_bf16 v[208:211], v[240:243], v[0:3], 0
ds_read_b128 v[232:235], v248 offset:10240
ds_write_b128 v255, v[164:167] offset:1024
v_mfma_f32_16x16x32_bf16 v[208:211], v[244:247], v[4:7], v[208:211]
v_exp_f32 v196, v196
v_mfma_f32_16x16x32_bf16 v[212:215], v[240:243], v[32:35], 0
v_exp_f32 v197, v197
v_mfma_f32_16x16x32_bf16 v[212:215], v[244:247], v[36:39], v[212:215]
v_exp_f32 v198, v198
v_mfma_f32_16x16x32_bf16 v[216:219], v[240:243], v[64:67], 0
ds_read_b128 v[236:239], v248 offset:10752
v_cvt_pk_bf16_f32 v132, v196, v197
v_mfma_f32_16x16x32_bf16 v[216:219], v[244:247], v[68:71], v[216:219]
v_exp_f32 v199, v199
v_mfma_f32_16x16x32_bf16 v[220:223], v[240:243], v[96:99], 0
v_exp_f32 v200, v200
v_mfma_f32_16x16x32_bf16 v[220:223], v[244:247], v[100:103], v[220:223]
s_waitcnt lgkmcnt(3)
v_cvt_pk_bf16_f32 v133, v198, v199
v_mfma_f32_16x16x32_bf16 v[208:211], v[224:227], v[8:11], v[208:211]
ds_read_b128 v[240:243], v248 offset:14336
ds_write_b128 v255, v[168:171] offset:2048
v_mfma_f32_16x16x32_bf16 v[208:211], v[228:231], v[12:15], v[208:211]
v_exp_f32 v201, v201
v_mfma_f32_16x16x32_bf16 v[212:215], v[224:227], v[40:43], v[212:215]
v_exp_f32 v202, v202
v_mfma_f32_16x16x32_bf16 v[212:215], v[228:231], v[44:47], v[212:215]
v_exp_f32 v203, v203
v_mfma_f32_16x16x32_bf16 v[216:219], v[224:227], v[72:75], v[216:219]
ds_read_b128 v[244:247], v248 offset:14848
v_cvt_pk_bf16_f32 v136, v200, v201
v_mfma_f32_16x16x32_bf16 v[216:219], v[228:231], v[76:79], v[216:219]
v_cvt_pk_bf16_f32 v137, v202, v203
ds_write_b128 v255, v[172:175] offset:3072
v_mfma_f32_16x16x32_bf16 v[220:223], v[224:227], v[104:107], v[220:223]
v_exp_f32 v204, v204
v_mfma_f32_16x16x32_bf16 v[220:223], v[228:231], v[108:111], v[220:223]
s_waitcnt lgkmcnt(4)
s_waitcnt vmcnt(1)
s_barrier
v_mfma_f32_16x16x32_bf16 v[208:211], v[232:235], v[16:19], v[208:211]
ds_read_b128 v[224:227], v248 offset:16384
s_add_u32 m0, s30, 0xc000
v_mfma_f32_16x16x32_bf16 v[208:211], v[236:239], v[20:23], v[208:211]
s_and_b32 s100, s30, 0x10000
buffer_load_dwordx4 v251, s[12:15], s28 offen offset:0 lds
v_mfma_f32_16x16x32_bf16 v[212:215], v[232:235], v[48:51], v[212:215]
s_xor_b32 s100, s100, 0x10000
v_mfma_f32_16x16x32_bf16 v[212:215], v[236:239], v[52:55], v[212:215]
v_exp_f32 v205, v205
v_mfma_f32_16x16x32_bf16 v[216:219], v[232:235], v[80:83], v[216:219]
ds_read_b128 v[228:231], v248 offset:16896
v_cvt_pk_bf16_f32 v140, v204, v205
v_mfma_f32_16x16x32_bf16 v[216:219], v[236:239], v[84:87], v[216:219]
v_exp_f32 v206, v206
v_mfma_f32_16x16x32_bf16 v[220:223], v[232:235], v[112:115], v[220:223]
v_exp_f32 v207, v207
v_mfma_f32_16x16x32_bf16 v[220:223], v[236:239], v[116:119], v[220:223]
s_waitcnt lgkmcnt(3)
v_cvt_pk_bf16_f32 v141, v206, v207
v_mfma_f32_16x16x32_bf16 v[208:211], v[240:243], v[24:27], v[208:211]
ds_read_b128 v[232:235], v248 offset:20480
buffer_load_dwordx4 v251, s[12:15], s28 offen offset:1024 lds
v_mfma_f32_16x16x32_bf16 v[208:211], v[244:247], v[28:31], v[208:211]
v_mfma_f32_16x16x32_bf16 v[212:215], v[240:243], v[56:59], v[212:215]
buffer_load_dwordx4 v251, s[12:15], s28 offen offset:2048 lds
v_mfma_f32_16x16x32_bf16 v[212:215], v[244:247], v[60:63], v[212:215]
v_mfma_f32_16x16x32_bf16 v[216:219], v[240:243], v[88:91], v[216:219]
ds_read_b128 v[236:239], v248 offset:20992
buffer_load_dwordx4 v251, s[12:15], s28 offen offset:3072 lds
v_mfma_f32_16x16x32_bf16 v[216:219], v[244:247], v[92:95], v[216:219]
v_mfma_f32_16x16x32_bf16 v[220:223], v[240:243], v[120:123], v[220:223]
s_add_u32 s28, s28, 0x4000
v_mfma_f32_16x16x32_bf16 v[220:223], v[244:247], v[124:127], v[220:223]
s_waitcnt lgkmcnt(2)
v_mfma_f32_16x16x32_bf16 v[192:195], v[224:227], v[0:3], 0
ds_read_b128 v[240:243], v248 offset:24576
v_mfma_f32_16x16x32_bf16 v[192:195], v[228:231], v[4:7], v[192:195]
v_exp_f32 v208, v208
v_mfma_f32_16x16x32_bf16 v[196:199], v[224:227], v[32:35], 0
v_exp_f32 v209, v209
v_mfma_f32_16x16x32_bf16 v[196:199], v[228:231], v[36:39], v[196:199]
v_exp_f32 v210, v210
v_mfma_f32_16x16x32_bf16 v[200:203], v[224:227], v[64:67], 0
ds_read_b128 v[244:247], v248 offset:25088
v_cvt_pk_bf16_f32 v130, v208, v209
v_mfma_f32_16x16x32_bf16 v[200:203], v[228:231], v[68:71], v[200:203]
v_exp_f32 v211, v211
v_mfma_f32_16x16x32_bf16 v[204:207], v[224:227], v[96:99], 0
v_exp_f32 v212, v212
v_mfma_f32_16x16x32_bf16 v[204:207], v[228:231], v[100:103], v[204:207]
s_waitcnt lgkmcnt(2)
v_cvt_pk_bf16_f32 v131, v210, v211
v_mfma_f32_16x16x32_bf16 v[192:195], v[232:235], v[8:11], v[192:195]
ds_read_b128 v[224:227], v248 offset:28672
v_mfma_f32_16x16x32_bf16 v[192:195], v[236:239], v[12:15], v[192:195]
v_exp_f32 v213, v213
v_mfma_f32_16x16x32_bf16 v[196:199], v[232:235], v[40:43], v[196:199]
v_exp_f32 v214, v214
v_mfma_f32_16x16x32_bf16 v[196:199], v[236:239], v[44:47], v[196:199]
v_exp_f32 v215, v215
v_mfma_f32_16x16x32_bf16 v[200:203], v[232:235], v[72:75], v[200:203]
ds_read_b128 v[228:231], v248 offset:29184
v_cvt_pk_bf16_f32 v134, v212, v213
v_mfma_f32_16x16x32_bf16 v[200:203], v[236:239], v[76:79], v[200:203]
v_cvt_pk_bf16_f32 v135, v214, v215
v_mfma_f32_16x16x32_bf16 v[204:207], v[232:235], v[104:107], v[204:207]
v_exp_f32 v216, v216
v_mfma_f32_16x16x32_bf16 v[204:207], v[236:239], v[108:111], v[204:207]
s_waitcnt lgkmcnt(2)
v_mfma_f32_16x16x32_bf16 v[192:195], v[240:243], v[16:19], v[192:195]
ds_read_b128 v[232:235], v248 offset:18432
v_mfma_f32_16x16x32_bf16 v[192:195], v[244:247], v[20:23], v[192:195]
v_exp_f32 v217, v217
v_mfma_f32_16x16x32_bf16 v[196:199], v[240:243], v[48:51], v[196:199]
v_exp_f32 v218, v218
v_mfma_f32_16x16x32_bf16 v[196:199], v[244:247], v[52:55], v[196:199]
v_exp_f32 v219, v219
v_mfma_f32_16x16x32_bf16 v[200:203], v[240:243], v[80:83], v[200:203]
ds_read_b128 v[236:239], v248 offset:18944
v_cvt_pk_bf16_f32 v138, v216, v217
v_mfma_f32_16x16x32_bf16 v[200:203], v[244:247], v[84:87], v[200:203]
v_cvt_pk_bf16_f32 v139, v218, v219
v_mfma_f32_16x16x32_bf16 v[204:207], v[240:243], v[112:115], v[204:207]
v_exp_f32 v220, v220
v_mfma_f32_16x16x32_bf16 v[204:207], v[244:247], v[116:119], v[204:207]
s_waitcnt lgkmcnt(2)
v_mfma_f32_16x16x32_bf16 v[192:195], v[224:227], v[24:27], v[192:195]
ds_read_b128 v[240:243], v248 offset:22528
v_mfma_f32_16x16x32_bf16 v[192:195], v[228:231], v[28:31], v[192:195]
v_exp_f32 v221, v221
v_mfma_f32_16x16x32_bf16 v[196:199], v[224:227], v[56:59], v[196:199]
v_exp_f32 v222, v222
v_mfma_f32_16x16x32_bf16 v[196:199], v[228:231], v[60:63], v[196:199]
v_exp_f32 v223, v223
v_mfma_f32_16x16x32_bf16 v[200:203], v[224:227], v[88:91], v[200:203]
ds_read_b128 v[244:247], v248 offset:23040
v_cvt_pk_bf16_f32 v142, v220, v221
v_mfma_f32_16x16x32_bf16 v[200:203], v[228:231], v[92:95], v[200:203]
v_cvt_pk_bf16_f32 v143, v222, v223
v_mfma_f32_16x16x32_bf16 v[204:207], v[224:227], v[120:123], v[204:207]
v_mfma_f32_16x16x32_bf16 v[204:207], v[228:231], v[124:127], v[204:207]
s_waitcnt lgkmcnt(2)
v_mfma_f32_16x16x32_bf16 v[208:211], v[232:235], v[0:3], 0
ds_read_b128 v[224:227], v248 offset:26624
v_mfma_f32_16x16x32_bf16 v[208:211], v[236:239], v[4:7], v[208:211]
v_exp_f32 v192, v192
v_mfma_f32_16x16x32_bf16 v[212:215], v[232:235], v[32:35], 0
v_exp_f32 v193, v193
v_mfma_f32_16x16x32_bf16 v[212:215], v[236:239], v[36:39], v[212:215]
v_exp_f32 v194, v194
v_mfma_f32_16x16x32_bf16 v[216:219], v[232:235], v[64:67], 0
ds_read_b128 v[228:231], v248 offset:27136
v_cvt_pk_bf16_f32 v144, v192, v193
v_mfma_f32_16x16x32_bf16 v[216:219], v[236:239], v[68:71], v[216:219]
v_exp_f32 v195, v195
v_mfma_f32_16x16x32_bf16 v[220:223], v[232:235], v[96:99], 0
v_exp_f32 v196, v196
v_mfma_f32_16x16x32_bf16 v[220:223], v[236:239], v[100:103], v[220:223]
s_waitcnt lgkmcnt(2)
v_cvt_pk_bf16_f32 v145, v194, v195
v_mfma_f32_16x16x32_bf16 v[208:211], v[240:243], v[8:11], v[208:211]
ds_read_b128 v[232:235], v248 offset:30720
v_mfma_f32_16x16x32_bf16 v[208:211], v[244:247], v[12:15], v[208:211]
v_exp_f32 v197, v197
v_mfma_f32_16x16x32_bf16 v[212:215], v[240:243], v[40:43], v[212:215]
v_exp_f32 v198, v198
v_mfma_f32_16x16x32_bf16 v[212:215], v[244:247], v[44:47], v[212:215]
v_exp_f32 v199, v199
v_mfma_f32_16x16x32_bf16 v[216:219], v[240:243], v[72:75], v[216:219]
ds_read_b128 v[236:239], v248 offset:31232
v_cvt_pk_bf16_f32 v148, v196, v197
v_mfma_f32_16x16x32_bf16 v[216:219], v[244:247], v[76:79], v[216:219]
v_cvt_pk_bf16_f32 v149, v198, v199
v_mfma_f32_16x16x32_bf16 v[220:223], v[240:243], v[104:107], v[220:223]
v_exp_f32 v200, v200
v_mfma_f32_16x16x32_bf16 v[220:223], v[244:247], v[108:111], v[220:223]
s_waitcnt lgkmcnt(2)
v_mfma_f32_16x16x32_bf16 v[208:211], v[224:227], v[16:19], v[208:211]
ds_read_b128 v[240:243], v248 offset:32768
v_mfma_f32_16x16x32_bf16 v[208:211], v[228:231], v[20:23], v[208:211]
v_exp_f32 v201, v201
v_mfma_f32_16x16x32_bf16 v[212:215], v[224:227], v[48:51], v[212:215]
v_exp_f32 v202, v202
v_mfma_f32_16x16x32_bf16 v[212:215], v[228:231], v[52:55], v[212:215]
v_exp_f32 v203, v203
v_mfma_f32_16x16x32_bf16 v[216:219], v[224:227], v[80:83], v[216:219]
ds_read_b128 v[244:247], v248 offset:33280
v_cvt_pk_bf16_f32 v152, v200, v201
v_mfma_f32_16x16x32_bf16 v[216:219], v[228:231], v[84:87], v[216:219]
v_cvt_pk_bf16_f32 v153, v202, v203
v_mfma_f32_16x16x32_bf16 v[220:223], v[224:227], v[112:115], v[220:223]
v_exp_f32 v204, v204
v_mfma_f32_16x16x32_bf16 v[220:223], v[228:231], v[116:119], v[220:223]
s_waitcnt lgkmcnt(2)
v_mfma_f32_16x16x32_bf16 v[208:211], v[232:235], v[24:27], v[208:211]
ds_read_b128 v[224:227], v248 offset:36864
v_mfma_f32_16x16x32_bf16 v[208:211], v[236:239], v[28:31], v[208:211]
v_exp_f32 v205, v205
v_mfma_f32_16x16x32_bf16 v[212:215], v[232:235], v[56:59], v[212:215]
v_exp_f32 v206, v206
v_mfma_f32_16x16x32_bf16 v[212:215], v[236:239], v[60:63], v[212:215]
v_exp_f32 v207, v207
v_mfma_f32_16x16x32_bf16 v[216:219], v[232:235], v[88:91], v[216:219]
ds_read_b128 v[228:231], v248 offset:37376
v_cvt_pk_bf16_f32 v156, v204, v205
v_mfma_f32_16x16x32_bf16 v[216:219], v[236:239], v[92:95], v[216:219]
v_cvt_pk_bf16_f32 v157, v206, v207
v_mfma_f32_16x16x32_bf16 v[220:223], v[232:235], v[120:123], v[220:223]
v_mfma_f32_16x16x32_bf16 v[220:223], v[236:239], v[124:127], v[220:223]
s_waitcnt lgkmcnt(2)
v_mfma_f32_16x16x32_bf16 v[192:195], v[240:243], v[0:3], 0
ds_read_b128 v[232:235], v248 offset:40960
v_mfma_f32_16x16x32_bf16 v[192:195], v[244:247], v[4:7], v[192:195]
v_exp_f32 v208, v208
v_mfma_f32_16x16x32_bf16 v[196:199], v[240:243], v[32:35], 0
v_exp_f32 v209, v209
v_mfma_f32_16x16x32_bf16 v[196:199], v[244:247], v[36:39], v[196:199]
v_exp_f32 v210, v210
v_mfma_f32_16x16x32_bf16 v[200:203], v[240:243], v[64:67], 0
ds_read_b128 v[236:239], v248 offset:41472
v_cvt_pk_bf16_f32 v146, v208, v209
v_mfma_f32_16x16x32_bf16 v[200:203], v[244:247], v[68:71], v[200:203]
v_exp_f32 v211, v211
v_mfma_f32_16x16x32_bf16 v[204:207], v[240:243], v[96:99], 0
v_exp_f32 v212, v212
v_mfma_f32_16x16x32_bf16 v[204:207], v[244:247], v[100:103], v[204:207]
s_waitcnt lgkmcnt(2)
v_cvt_pk_bf16_f32 v147, v210, v211
v_mfma_f32_16x16x32_bf16 v[192:195], v[224:227], v[8:11], v[192:195]
ds_read_b128 v[240:243], v248 offset:45056
v_mfma_f32_16x16x32_bf16 v[192:195], v[228:231], v[12:15], v[192:195]
v_exp_f32 v213, v213
v_mfma_f32_16x16x32_bf16 v[196:199], v[224:227], v[40:43], v[196:199]
v_exp_f32 v214, v214
v_mfma_f32_16x16x32_bf16 v[196:199], v[228:231], v[44:47], v[196:199]
v_exp_f32 v215, v215
v_mfma_f32_16x16x32_bf16 v[200:203], v[224:227], v[72:75], v[200:203]
ds_read_b128 v[244:247], v248 offset:45568
v_cvt_pk_bf16_f32 v150, v212, v213
v_mfma_f32_16x16x32_bf16 v[200:203], v[228:231], v[76:79], v[200:203]
v_cvt_pk_bf16_f32 v151, v214, v215
v_mfma_f32_16x16x32_bf16 v[204:207], v[224:227], v[104:107], v[204:207]
v_exp_f32 v216, v216
v_mfma_f32_16x16x32_bf16 v[204:207], v[228:231], v[108:111], v[204:207]
s_waitcnt lgkmcnt(2)
v_mfma_f32_16x16x32_bf16 v[192:195], v[232:235], v[16:19], v[192:195]
ds_read_b128 v[224:227], v248 offset:34816
v_mfma_f32_16x16x32_bf16 v[192:195], v[236:239], v[20:23], v[192:195]
v_exp_f32 v217, v217
v_mfma_f32_16x16x32_bf16 v[196:199], v[232:235], v[48:51], v[196:199]
v_exp_f32 v218, v218
v_mfma_f32_16x16x32_bf16 v[196:199], v[236:239], v[52:55], v[196:199]
v_exp_f32 v219, v219
v_mfma_f32_16x16x32_bf16 v[200:203], v[232:235], v[80:83], v[200:203]
ds_read_b128 v[228:231], v248 offset:35328
v_cvt_pk_bf16_f32 v154, v216, v217
v_mfma_f32_16x16x32_bf16 v[200:203], v[236:239], v[84:87], v[200:203]
v_cvt_pk_bf16_f32 v155, v218, v219
v_mfma_f32_16x16x32_bf16 v[204:207], v[232:235], v[112:115], v[204:207]
v_exp_f32 v220, v220
v_mfma_f32_16x16x32_bf16 v[204:207], v[236:239], v[116:119], v[204:207]
s_waitcnt lgkmcnt(2)
v_mfma_f32_16x16x32_bf16 v[192:195], v[240:243], v[24:27], v[192:195]
ds_read_b128 v[232:235], v248 offset:38912
v_mfma_f32_16x16x32_bf16 v[192:195], v[244:247], v[28:31], v[192:195]
v_exp_f32 v221, v221
v_mfma_f32_16x16x32_bf16 v[196:199], v[240:243], v[56:59], v[196:199]
v_exp_f32 v222, v222
v_mfma_f32_16x16x32_bf16 v[196:199], v[244:247], v[60:63], v[196:199]
v_exp_f32 v223, v223
v_mfma_f32_16x16x32_bf16 v[200:203], v[240:243], v[88:91], v[200:203]
ds_read_b128 v[236:239], v248 offset:39424
v_cvt_pk_bf16_f32 v158, v220, v221
v_mfma_f32_16x16x32_bf16 v[200:203], v[244:247], v[92:95], v[200:203]
v_cvt_pk_bf16_f32 v159, v222, v223
v_mfma_f32_16x16x32_bf16 v[204:207], v[240:243], v[120:123], v[204:207]
v_mfma_f32_16x16x32_bf16 v[204:207], v[244:247], v[124:127], v[204:207]
s_waitcnt lgkmcnt(2)
v_mfma_f32_16x16x32_bf16 v[208:211], v[224:227], v[0:3], 0
ds_read_b128 v[240:243], v248 offset:43008
v_mfma_f32_16x16x32_bf16 v[208:211], v[228:231], v[4:7], v[208:211]
v_exp_f32 v192, v192
v_mfma_f32_16x16x32_bf16 v[212:215], v[224:227], v[32:35], 0
v_exp_f32 v193, v193
v_mfma_f32_16x16x32_bf16 v[212:215], v[228:231], v[36:39], v[212:215]
v_exp_f32 v194, v194
v_mfma_f32_16x16x32_bf16 v[216:219], v[224:227], v[64:67], 0
ds_read_b128 v[244:247], v248 offset:43520
v_cvt_pk_bf16_f32 v160, v192, v193
v_mfma_f32_16x16x32_bf16 v[216:219], v[228:231], v[68:71], v[216:219]
v_exp_f32 v195, v195
v_mfma_f32_16x16x32_bf16 v[220:223], v[224:227], v[96:99], 0
v_exp_f32 v196, v196
v_mfma_f32_16x16x32_bf16 v[220:223], v[228:231], v[100:103], v[220:223]
s_waitcnt lgkmcnt(2)
v_cvt_pk_bf16_f32 v161, v194, v195
v_mfma_f32_16x16x32_bf16 v[208:211], v[232:235], v[8:11], v[208:211]
ds_read_b128 v[224:227], v248 offset:47104
v_mfma_f32_16x16x32_bf16 v[208:211], v[236:239], v[12:15], v[208:211]
v_exp_f32 v197, v197
v_mfma_f32_16x16x32_bf16 v[212:215], v[232:235], v[40:43], v[212:215]
v_exp_f32 v198, v198
v_mfma_f32_16x16x32_bf16 v[212:215], v[236:239], v[44:47], v[212:215]
v_exp_f32 v199, v199
v_mfma_f32_16x16x32_bf16 v[216:219], v[232:235], v[72:75], v[216:219]
ds_read_b128 v[228:231], v248 offset:47616
v_cvt_pk_bf16_f32 v164, v196, v197
v_mfma_f32_16x16x32_bf16 v[216:219], v[236:239], v[76:79], v[216:219]
v_cvt_pk_bf16_f32 v165, v198, v199
v_mfma_f32_16x16x32_bf16 v[220:223], v[232:235], v[104:107], v[220:223]
v_exp_f32 v200, v200
v_mfma_f32_16x16x32_bf16 v[220:223], v[236:239], v[108:111], v[220:223]
s_waitcnt lgkmcnt(2)
s_waitcnt vmcnt(0)
s_barrier
v_mfma_f32_16x16x32_bf16 v[208:211], v[240:243], v[16:19], v[208:211]
ds_read_b128 v[232:235], v248 offset:49152
s_add_u32 s8, s6, 0x0
s_addc_u32 s9, s7, 0
v_mfma_f32_16x16x32_bf16 v[208:211], v[244:247], v[20:23], v[208:211]
v_exp_f32 v201, v201
s_mov_b32 s10, 0x4e2000
v_mfma_f32_16x16x32_bf16 v[212:215], v[240:243], v[48:51], v[212:215]
v_exp_f32 v202, v202
s_mov_b32 s11, 0x00020000
v_mfma_f32_16x16x32_bf16 v[212:215], v[244:247], v[52:55], v[212:215]
v_exp_f32 v203, v203
s_lshl_b32 s55, s34, 13
v_mfma_f32_16x16x32_bf16 v[216:219], v[240:243], v[80:83], v[216:219]
ds_read_b128 v[236:239], v248 offset:49664
v_cvt_pk_bf16_f32 v168, v200, v201
s_add_u32 s55, s55, 0x21000
v_mfma_f32_16x16x32_bf16 v[216:219], v[244:247], v[84:87], v[216:219]
v_cvt_pk_bf16_f32 v169, v202, v203
s_lshl_b32 s36, s34, 7
v_bfe_u32 v253, v252, 4, 3
v_mfma_f32_16x16x32_bf16 v[220:223], v[240:243], v[112:115], v[220:223]
v_exp_f32 v204, v204
v_lshrrev_b32 v254, 7, v252
v_mfma_f32_16x16x32_bf16 v[220:223], v[244:247], v[116:119], v[220:223]
s_waitcnt lgkmcnt(2)
v_xor_b32 v253, v253, v254
v_lshl_add_u32 v254, v254, 9, s36
v_mfma_f32_16x16x32_bf16 v[208:211], v[224:227], v[24:27], v[208:211]
ds_read_b128 v[240:243], v248 offset:53248
v_lshl_add_u32 v253, v253, 4, v254
s_add_u32 m0, s55, 0
v_mfma_f32_16x16x32_bf16 v[208:211], v[228:231], v[28:31], v[208:211]
v_exp_f32 v205, v205
s_add_u32 s35, s52, 0
v_mfma_f32_16x16x32_bf16 v[212:215], v[224:227], v[56:59], v[212:215]
v_exp_f32 v206, v206
buffer_load_dwordx4 v253, s[8:11], s35 offen lds
v_mfma_f32_16x16x32_bf16 v[212:215], v[228:231], v[60:63], v[212:215]
v_exp_f32 v207, v207
s_add_u32 m0, s55, 1024
v_mfma_f32_16x16x32_bf16 v[216:219], v[224:227], v[88:91], v[216:219]
ds_read_b128 v[244:247], v248 offset:53760
v_cvt_pk_bf16_f32 v172, v204, v205
s_add_u32 s35, s52, 4096
v_mfma_f32_16x16x32_bf16 v[216:219], v[228:231], v[92:95], v[216:219]
v_cvt_pk_bf16_f32 v173, v206, v207
buffer_load_dwordx4 v253, s[8:11], s35 offen lds
s_add_u32 m0, s55, 2048
v_mfma_f32_16x16x32_bf16 v[220:223], v[224:227], v[120:123], v[220:223]
s_add_u32 s35, s53, 0
buffer_load_dwordx4 v253, s[8:11], s35 offen lds
s_add_u32 m0, s55, 3072
v_mfma_f32_16x16x32_bf16 v[220:223], v[228:231], v[124:127], v[220:223]
s_waitcnt lgkmcnt(2)
s_add_u32 s35, s53, 4096
buffer_load_dwordx4 v253, s[8:11], s35 offen lds
v_mfma_f32_16x16x32_bf16 v[192:195], v[232:235], v[0:3], 0
ds_read_b128 v[224:227], v248 offset:57344
v_mfma_f32_16x16x32_bf16 v[192:195], v[236:239], v[4:7], v[192:195]
v_exp_f32 v208, v208
v_mfma_f32_16x16x32_bf16 v[196:199], v[232:235], v[32:35], 0
v_exp_f32 v209, v209
v_mfma_f32_16x16x32_bf16 v[196:199], v[236:239], v[36:39], v[196:199]
v_exp_f32 v210, v210
v_mfma_f32_16x16x32_bf16 v[200:203], v[232:235], v[64:67], 0
ds_read_b128 v[228:231], v248 offset:57856
v_cvt_pk_bf16_f32 v162, v208, v209
v_mfma_f32_16x16x32_bf16 v[200:203], v[236:239], v[68:71], v[200:203]
v_exp_f32 v211, v211
v_mfma_f32_16x16x32_bf16 v[204:207], v[232:235], v[96:99], 0
v_exp_f32 v212, v212
v_mfma_f32_16x16x32_bf16 v[204:207], v[236:239], v[100:103], v[204:207]
s_waitcnt lgkmcnt(2)
v_cvt_pk_bf16_f32 v163, v210, v211
v_mfma_f32_16x16x32_bf16 v[192:195], v[240:243], v[8:11], v[192:195]
ds_read_b128 v[232:235], v248 offset:61440
v_mfma_f32_16x16x32_bf16 v[192:195], v[244:247], v[12:15], v[192:195]
v_exp_f32 v213, v213
v_mfma_f32_16x16x32_bf16 v[196:199], v[240:243], v[40:43], v[196:199]
v_exp_f32 v214, v214
v_mfma_f32_16x16x32_bf16 v[196:199], v[244:247], v[44:47], v[196:199]
v_exp_f32 v215, v215
v_mfma_f32_16x16x32_bf16 v[200:203], v[240:243], v[72:75], v[200:203]
ds_read_b128 v[236:239], v248 offset:61952
v_cvt_pk_bf16_f32 v166, v212, v213
v_mfma_f32_16x16x32_bf16 v[200:203], v[244:247], v[76:79], v[200:203]
v_cvt_pk_bf16_f32 v167, v214, v215
v_mfma_f32_16x16x32_bf16 v[204:207], v[240:243], v[104:107], v[204:207]
v_exp_f32 v216, v216
v_mfma_f32_16x16x32_bf16 v[204:207], v[244:247], v[108:111], v[204:207]
s_waitcnt lgkmcnt(2)
v_mfma_f32_16x16x32_bf16 v[192:195], v[224:227], v[16:19], v[192:195]
ds_read_b128 v[240:243], v248 offset:51200
v_mfma_f32_16x16x32_bf16 v[192:195], v[228:231], v[20:23], v[192:195]
v_exp_f32 v217, v217
v_mfma_f32_16x16x32_bf16 v[196:199], v[224:227], v[48:51], v[196:199]
v_exp_f32 v218, v218
v_mfma_f32_16x16x32_bf16 v[196:199], v[228:231], v[52:55], v[196:199]
v_exp_f32 v219, v219
v_mfma_f32_16x16x32_bf16 v[200:203], v[224:227], v[80:83], v[200:203]
ds_read_b128 v[244:247], v248 offset:51712
v_cvt_pk_bf16_f32 v170, v216, v217
v_mfma_f32_16x16x32_bf16 v[200:203], v[228:231], v[84:87], v[200:203]
v_cvt_pk_bf16_f32 v171, v218, v219
v_mfma_f32_16x16x32_bf16 v[204:207], v[224:227], v[112:115], v[204:207]
v_exp_f32 v220, v220
v_mfma_f32_16x16x32_bf16 v[204:207], v[228:231], v[116:119], v[204:207]
s_waitcnt lgkmcnt(2)
v_mfma_f32_16x16x32_bf16 v[192:195], v[232:235], v[24:27], v[192:195]
ds_read_b128 v[224:227], v248 offset:55296
v_mfma_f32_16x16x32_bf16 v[192:195], v[236:239], v[28:31], v[192:195]
v_exp_f32 v221, v221
v_mfma_f32_16x16x32_bf16 v[196:199], v[232:235], v[56:59], v[196:199]
v_exp_f32 v222, v222
v_mfma_f32_16x16x32_bf16 v[196:199], v[236:239], v[60:63], v[196:199]
v_exp_f32 v223, v223
v_mfma_f32_16x16x32_bf16 v[200:203], v[232:235], v[88:91], v[200:203]
ds_read_b128 v[228:231], v248 offset:55808
v_cvt_pk_bf16_f32 v174, v220, v221
v_mfma_f32_16x16x32_bf16 v[200:203], v[236:239], v[92:95], v[200:203]
v_cvt_pk_bf16_f32 v175, v222, v223
v_mfma_f32_16x16x32_bf16 v[204:207], v[232:235], v[120:123], v[204:207]
v_mfma_f32_16x16x32_bf16 v[204:207], v[236:239], v[124:127], v[204:207]
s_waitcnt lgkmcnt(2)
v_mfma_f32_16x16x32_bf16 v[208:211], v[240:243], v[0:3], 0
ds_read_b128 v[232:235], v248 offset:59392
v_mfma_f32_16x16x32_bf16 v[208:211], v[244:247], v[4:7], v[208:211]
v_exp_f32 v192, v192
v_mfma_f32_16x16x32_bf16 v[212:215], v[240:243], v[32:35], 0
v_exp_f32 v193, v193
v_mfma_f32_16x16x32_bf16 v[212:215], v[244:247], v[36:39], v[212:215]
v_exp_f32 v194, v194
v_mfma_f32_16x16x32_bf16 v[216:219], v[240:243], v[64:67], 0
ds_read_b128 v[236:239], v248 offset:59904
v_cvt_pk_bf16_f32 v0, v192, v193
v_mfma_f32_16x16x32_bf16 v[216:219], v[244:247], v[68:71], v[216:219]
v_exp_f32 v195, v195
v_mfma_f32_16x16x32_bf16 v[220:223], v[240:243], v[96:99], 0
v_exp_f32 v196, v196
v_mfma_f32_16x16x32_bf16 v[220:223], v[244:247], v[100:103], v[220:223]
s_waitcnt lgkmcnt(2)
v_cvt_pk_bf16_f32 v1, v194, v195
v_mfma_f32_16x16x32_bf16 v[208:211], v[224:227], v[8:11], v[208:211]
ds_read_b128 v[240:243], v248 offset:63488
v_mfma_f32_16x16x32_bf16 v[208:211], v[228:231], v[12:15], v[208:211]
v_exp_f32 v197, v197
v_mfma_f32_16x16x32_bf16 v[212:215], v[224:227], v[40:43], v[212:215]
ds_read_b128 v[4:7], v255 offset:0
ds_read_b128 v[36:39], v255 offset:1024
v_mfma_f32_16x16x32_bf16 v[212:215], v[228:231], v[44:47], v[212:215]
v_exp_f32 v198, v198
v_mfma_f32_16x16x32_bf16 v[216:219], v[224:227], v[72:75], v[216:219]
ds_read_b128 v[244:247], v248 offset:64000
v_xor_b32 v12, 0x10000, v249
v_mfma_f32_16x16x32_bf16 v[216:219], v[228:231], v[76:79], v[216:219]
v_xor_b32 v13, 0x10000, v250
v_cvt_pk_bf16_f32 v32, v196, v197
v_mfma_f32_16x16x32_bf16 v[220:223], v[224:227], v[104:107], v[220:223]
ds_read_b128 v[68:71], v255 offset:2048
ds_read_b128 v[100:103], v255 offset:3072
v_mfma_f32_16x16x32_bf16 v[220:223], v[228:231], v[108:111], v[220:223]
s_waitcnt lgkmcnt(6)
v_mfma_f32_16x16x32_bf16 v[208:211], v[232:235], v[16:19], v[208:211]
ds_read_b64_tr_b16 v[224:225], v12 offset:0
ds_read_b64_tr_b16 v[226:227], v12 offset:2048
v_mfma_f32_16x16x32_bf16 v[208:211], v[236:239], v[20:23], v[208:211]
v_exp_f32 v199, v199
v_mfma_f32_16x16x32_bf16 v[212:215], v[232:235], v[48:51], v[212:215]
v_cvt_pk_bf16_f32 v33, v198, v199
v_mfma_f32_16x16x32_bf16 v[212:215], v[236:239], v[52:55], v[212:215]
v_exp_f32 v200, v200
v_mfma_f32_16x16x32_bf16 v[216:219], v[232:235], v[80:83], v[216:219]
ds_read_b64_tr_b16 v[228:229], v12 offset:16384
ds_read_b64_tr_b16 v[230:231], v12 offset:18432
v_mfma_f32_16x16x32_bf16 v[216:219], v[236:239], v[84:87], v[216:219]
v_exp_f32 v201, v201
v_mfma_f32_16x16x32_bf16 v[220:223], v[232:235], v[112:115], v[220:223]
v_exp_f32 v202, v202
v_mfma_f32_16x16x32_bf16 v[220:223], v[236:239], v[116:119], v[220:223]
s_waitcnt lgkmcnt(6)
v_cvt_pk_bf16_f32 v64, v200, v201
v_mfma_f32_16x16x32_bf16 v[208:211], v[240:243], v[24:27], v[208:211]
ds_read_b64_tr_b16 v[232:233], v13 offset:0
ds_read_b64_tr_b16 v[234:235], v13 offset:2048
v_mfma_f32_16x16x32_bf16 v[208:211], v[244:247], v[28:31], v[208:211]
v_exp_f32 v203, v203
v_mfma_f32_16x16x32_bf16 v[212:215], v[240:243], v[56:59], v[212:215]
v_cvt_pk_bf16_f32 v65, v202, v203
v_mfma_f32_16x16x32_bf16 v[212:215], v[244:247], v[60:63], v[212:215]
v_exp_f32 v204, v204
v_mfma_f32_16x16x32_bf16 v[216:219], v[240:243], v[88:91], v[216:219]
ds_read_b64_tr_b16 v[236:237], v13 offset:16384
ds_read_b64_tr_b16 v[238:239], v13 offset:18432
v_mfma_f32_16x16x32_bf16 v[216:219], v[244:247], v[92:95], v[216:219]
v_exp_f32 v205, v205
v_mfma_f32_16x16x32_bf16 v[220:223], v[240:243], v[120:123], v[220:223]
v_exp_f32 v206, v206
v_mfma_f32_16x16x32_bf16 v[220:223], v[244:247], v[124:127], v[220:223]
s_waitcnt lgkmcnt(4)
v_mfma_f32_16x16x32_bf16 a[0:3], v[224:227], v[128:131], a[0:3]
ds_read_b64_tr_b16 v[240:241], v249 offset:33280
ds_read_b64_tr_b16 v[242:243], v249 offset:35328
v_mfma_f32_16x16x32_bf16 a[0:3], v[228:231], v[144:147], a[0:3]
v_exp_f32 v207, v207
v_mfma_f32_16x16x32_bf16 a[4:7], v[224:227], v[132:135], a[4:7]
v_cvt_pk_bf16_f32 v96, v204, v205
v_cvt_pk_bf16_f32 v97, v206, v207
v_mfma_f32_16x16x32_bf16 a[4:7], v[228:231], v[148:151], a[4:7]
v_exp_f32 v208, v208
v_mfma_f32_16x16x32_bf16 a[8:11], v[224:227], v[136:139], a[8:11]
ds_read_b64_tr_b16 v[244:245], v249 offset:49664
ds_read_b64_tr_b16 v[246:247], v249 offset:51712
v_mfma_f32_16x16x32_bf16 a[8:11], v[228:231], v[152:155], a[8:11]
v_exp_f32 v209, v209
v_mfma_f32_16x16x32_bf16 a[12:15], v[224:227], v[140:143], a[12:15]
v_exp_f32 v210, v210
v_mfma_f32_16x16x32_bf16 a[12:15], v[228:231], v[156:159], a[12:15]
s_waitcnt lgkmcnt(4)
v_cvt_pk_bf16_f32 v2, v208, v209
v_mfma_f32_16x16x32_bf16 a[16:19], v[232:235], v[128:131], a[16:19]
ds_read_b64_tr_b16 v[224:225], v12 offset:512
ds_read_b64_tr_b16 v[226:227], v12 offset:2560
v_mfma_f32_16x16x32_bf16 a[16:19], v[236:239], v[144:147], a[16:19]
v_exp_f32 v211, v211
v_mfma_f32_16x16x32_bf16 a[20:23], v[232:235], v[132:135], a[20:23]
v_cvt_pk_bf16_f32 v3, v210, v211
v_mfma_f32_16x16x32_bf16 a[20:23], v[236:239], v[148:151], a[20:23]
v_exp_f32 v212, v212
v_mfma_f32_16x16x32_bf16 a[24:27], v[232:235], v[136:139], a[24:27]
ds_read_b64_tr_b16 v[228:229], v12 offset:16896
ds_read_b64_tr_b16 v[230:231], v12 offset:18944
v_mfma_f32_16x16x32_bf16 a[24:27], v[236:239], v[152:155], a[24:27]
v_exp_f32 v213, v213
v_mfma_f32_16x16x32_bf16 a[28:31], v[232:235], v[140:143], a[28:31]
v_exp_f32 v214, v214
v_mfma_f32_16x16x32_bf16 a[28:31], v[236:239], v[156:159], a[28:31]
s_waitcnt lgkmcnt(4)
v_cvt_pk_bf16_f32 v34, v212, v213
v_mfma_f32_16x16x32_bf16 a[32:35], v[240:243], v[4:7], a[32:35]
ds_read_b64_tr_b16 v[232:233], v250 offset:33280
ds_read_b64_tr_b16 v[234:235], v250 offset:35328
v_mfma_f32_16x16x32_bf16 a[32:35], v[244:247], v[176:179], a[32:35]
v_exp_f32 v215, v215
v_mfma_f32_16x16x32_bf16 a[36:39], v[240:243], v[36:39], a[36:39]
v_cvt_pk_bf16_f32 v35, v214, v215
v_mfma_f32_16x16x32_bf16 a[36:39], v[244:247], v[180:183], a[36:39]
v_exp_f32 v216, v216
v_mfma_f32_16x16x32_bf16 a[40:43], v[240:243], v[68:71], a[40:43]
ds_read_b64_tr_b16 v[236:237], v250 offset:49664
ds_read_b64_tr_b16 v[238:239], v250 offset:51712
v_mfma_f32_16x16x32_bf16 a[40:43], v[244:247], v[184:187], a[40:43]
v_exp_f32 v217, v217
v_mfma_f32_16x16x32_bf16 a[44:47], v[240:243], v[100:103], a[44:47]
v_exp_f32 v218, v218
v_mfma_f32_16x16x32_bf16 a[44:47], v[244:247], v[188:191], a[44:47]
s_waitcnt lgkmcnt(4)
v_cvt_pk_bf16_f32 v66, v216, v217
v_mfma_f32_16x16x32_bf16 a[32:35], v[224:227], v[128:131], a[32:35]
ds_read_b64_tr_b16 v[240:241], v12 offset:32768
ds_read_b64_tr_b16 v[242:243], v12 offset:34816
v_mfma_f32_16x16x32_bf16 a[32:35], v[228:231], v[144:147], a[32:35]
v_exp_f32 v219, v219
v_mfma_f32_16x16x32_bf16 a[36:39], v[224:227], v[132:135], a[36:39]
v_cvt_pk_bf16_f32 v67, v218, v219
v_mfma_f32_16x16x32_bf16 a[36:39], v[228:231], v[148:151], a[36:39]
v_exp_f32 v220, v220
v_mfma_f32_16x16x32_bf16 a[40:43], v[224:227], v[136:139], a[40:43]
ds_read_b64_tr_b16 v[244:245], v12 offset:49152
ds_read_b64_tr_b16 v[246:247], v12 offset:51200
v_mfma_f32_16x16x32_bf16 a[40:43], v[228:231], v[152:155], a[40:43]
v_exp_f32 v221, v221
v_mfma_f32_16x16x32_bf16 a[44:47], v[224:227], v[140:143], a[44:47]
v_exp_f32 v222, v222
v_mfma_f32_16x16x32_bf16 a[44:47], v[228:231], v[156:159], a[44:47]
s_waitcnt lgkmcnt(4)
v_cvt_pk_bf16_f32 v98, v220, v221
v_mfma_f32_16x16x32_bf16 a[48:51], v[232:235], v[4:7], a[48:51]
ds_read_b64_tr_b16 v[224:225], v13 offset:32768
ds_read_b64_tr_b16 v[226:227], v13 offset:34816
v_mfma_f32_16x16x32_bf16 a[48:51], v[236:239], v[176:179], a[48:51]
v_exp_f32 v223, v223
v_mfma_f32_16x16x32_bf16 a[52:55], v[232:235], v[36:39], a[52:55]
v_cvt_pk_bf16_f32 v99, v222, v223
v_mfma_f32_16x16x32_bf16 a[52:55], v[236:239], v[180:183], a[52:55]
v_mfma_f32_16x16x32_bf16 a[56:59], v[232:235], v[68:71], a[56:59]
ds_read_b64_tr_b16 v[228:229], v13 offset:49152
ds_read_b64_tr_b16 v[230:231], v13 offset:51200
v_mfma_f32_16x16x32_bf16 a[56:59], v[236:239], v[184:187], a[56:59]
v_mfma_f32_16x16x32_bf16 a[60:63], v[232:235], v[100:103], a[60:63]
v_mfma_f32_16x16x32_bf16 a[60:63], v[236:239], v[188:191], a[60:63]
s_waitcnt lgkmcnt(4)
v_mfma_f32_16x16x32_bf16 a[0:3], v[240:243], v[160:163], a[0:3]
ds_read_b64_tr_b16 v[232:233], v12 offset:33280
ds_read_b64_tr_b16 v[234:235], v12 offset:35328
v_mfma_f32_16x16x32_bf16 a[0:3], v[244:247], v[0:3], a[0:3]
v_mfma_f32_16x16x32_bf16 a[4:7], v[240:243], v[164:167], a[4:7]
v_mfma_f32_16x16x32_bf16 a[4:7], v[244:247], v[32:35], a[4:7]
v_mfma_f32_16x16x32_bf16 a[8:11], v[240:243], v[168:171], a[8:11]
ds_read_b64_tr_b16 v[236:237], v12 offset:49664
ds_read_b64_tr_b16 v[238:239], v12 offset:51712
v_mfma_f32_16x16x32_bf16 a[8:11], v[244:247], v[64:67], a[8:11]
v_mfma_f32_16x16x32_bf16 a[12:15], v[240:243], v[172:175], a[12:15]
v_mfma_f32_16x16x32_bf16 a[12:15], v[244:247], v[96:99], a[12:15]
s_waitcnt lgkmcnt(4)
v_mfma_f32_16x16x32_bf16 a[16:19], v[224:227], v[160:163], a[16:19]
ds_read_b64_tr_b16 v[240:241], v13 offset:512
ds_read_b64_tr_b16 v[242:243], v13 offset:2560
v_mfma_f32_16x16x32_bf16 a[16:19], v[228:231], v[0:3], a[16:19]
v_mfma_f32_16x16x32_bf16 a[20:23], v[224:227], v[164:167], a[20:23]
v_mfma_f32_16x16x32_bf16 a[20:23], v[228:231], v[32:35], a[20:23]
v_mfma_f32_16x16x32_bf16 a[24:27], v[224:227], v[168:171], a[24:27]
ds_read_b64_tr_b16 v[244:245], v13 offset:16896
ds_read_b64_tr_b16 v[246:247], v13 offset:18944
v_accvgpr_read_b32 v192, a0
v_mfma_f32_16x16x32_bf16 a[24:27], v[228:231], v[64:67], a[24:27]
v_accvgpr_read_b32 v193, a4
v_accvgpr_read_b32 v194, a8
v_accvgpr_read_b32 v195, a12
v_mfma_f32_16x16x32_bf16 a[28:31], v[224:227], v[172:175], a[28:31]
v_lshlrev_b32 v253, 2, v252
v_subrev_u32 v196, 0x0d800000, v192
v_subrev_u32 v197, 0x0d800000, v193
v_mfma_f32_16x16x32_bf16 a[28:31], v[228:231], v[96:99], a[28:31]
s_waitcnt lgkmcnt(4)
v_subrev_u32 v198, 0x0d800000, v194
v_subrev_u32 v199, 0x0d800000, v195
v_mfma_f32_16x16x32_bf16 a[32:35], v[232:235], v[160:163], a[32:35]
ds_read_b64_tr_b16 v[224:225], v13 offset:33280
ds_read_b64_tr_b16 v[226:227], v13 offset:35328
v_max3_u32 v254, v196, v197, v198
v_mfma_f32_16x16x32_bf16 a[32:35], v[236:239], v[0:3], a[32:35]
v_max_u32 v254, v254, v199
v_mfma_f32_16x16x32_bf16 a[36:39], v[232:235], v[164:167], a[36:39]
s_mov_b64 exec, 0xffff
s_xor_b32 s35, s48, 0
buffer_store_dword v192, v253, s[24:27], s35 offen offset:4 sc1
s_xor_b32 s35, s48, 1024
buffer_store_dword v193, v253, s[24:27], s35 offen offset:4 sc1
s_xor_b32 s35, s48, 2048
buffer_store_dword v194, v253, s[24:27], s35 offen offset:4 sc1
s_xor_b32 s35, s48, 3072
buffer_store_dword v195, v253, s[24:27], s35 offen offset:4 sc1
v_cmp_le_u32 vcc, 0x64000000, v254
s_mov_b64 exec, -1
v_mfma_f32_16x16x32_bf16 a[36:39], v[236:239], v[32:35], a[36:39]
v_accvgpr_read_b32 v192, a0
v_accvgpr_read_b32 v193, a1
v_mfma_f32_16x16x32_bf16 a[40:43], v[232:235], v[168:171], a[40:43]
ds_read_b64_tr_b16 v[228:229], v13 offset:49664
ds_read_b64_tr_b16 v[230:231], v13 offset:51712
v_mfma_f32_16x16x32_bf16 a[40:43], v[236:239], v[64:67], a[40:43]
v_accvgpr_read_b32 v194, a2
v_accvgpr_read_b32 v195, a3
v_mfma_f32_16x16x32_bf16 a[44:47], v[232:235], v[172:175], a[44:47]
v_cvt_pk_bf16_f32 v16, v192, v193
v_cvt_pk_bf16_f32 v17, v194, v195
v_mfma_f32_16x16x32_bf16 a[44:47], v[236:239], v[96:99], a[44:47]
s_waitcnt lgkmcnt(4)
v_accvgpr_read_b32 v200, a4
v_mfma_f32_16x16x32_bf16 a[48:51], v[240:243], v[128:131], a[48:51]
ds_read_b64_tr_b16 v[232:233], v249 offset:36864
ds_read_b64_tr_b16 v[234:235], v249 offset:38912
v_mfma_f32_16x16x32_bf16 a[48:51], v[244:247], v[144:147], a[48:51]
v_accvgpr_read_b32 v201, a5
v_accvgpr_read_b32 v202, a6
v_mfma_f32_16x16x32_bf16 a[52:55], v[240:243], v[132:135], a[52:55]
v_accvgpr_read_b32 v203, a7
v_cvt_pk_bf16_f32 v48, v200, v201
v_mfma_f32_16x16x32_bf16 a[52:55], v[244:247], v[148:151], a[52:55]
v_cvt_pk_bf16_f32 v49, v202, v203
v_accvgpr_read_b32 v208, a8
v_mfma_f32_16x16x32_bf16 a[56:59], v[240:243], v[136:139], a[56:59]
ds_read_b64_tr_b16 v[236:237], v249 offset:53248
ds_read_b64_tr_b16 v[238:239], v249 offset:55296
v_mfma_f32_16x16x32_bf16 a[56:59], v[244:247], v[152:155], a[56:59]
v_accvgpr_read_b32 v209, a9
v_accvgpr_read_b32 v210, a10
v_mfma_f32_16x16x32_bf16 a[60:63], v[240:243], v[140:143], a[60:63]
v_accvgpr_read_b32 v211, a11
v_cvt_pk_bf16_f32 v80, v208, v209
v_mfma_f32_16x16x32_bf16 a[60:63], v[244:247], v[156:159], a[60:63]
s_waitcnt lgkmcnt(4)
v_cvt_pk_bf16_f32 v81, v210, v211
v_mfma_f32_16x16x32_bf16 a[48:51], v[224:227], v[160:163], a[48:51]
ds_read_b64_tr_b16 v[240:241], v12 offset:4096
ds_read_b64_tr_b16 v[242:243], v12 offset:6144
v_mfma_f32_16x16x32_bf16 a[48:51], v[228:231], v[0:3], a[48:51]
v_accvgpr_read_b32 v216, a12
v_accvgpr_read_b32 v217, a13
v_mfma_f32_16x16x32_bf16 a[52:55], v[224:227], v[164:167], a[52:55]
v_accvgpr_read_b32 v218, a14
v_accvgpr_read_b32 v219, a15
v_mfma_f32_16x16x32_bf16 a[52:55], v[228:231], v[32:35], a[52:55]
v_cvt_pk_bf16_f32 v112, v216, v217
v_cvt_pk_bf16_f32 v113, v218, v219
v_mfma_f32_16x16x32_bf16 a[56:59], v[224:227], v[168:171], a[56:59]
ds_read_b64_tr_b16 v[244:245], v12 offset:20480
ds_read_b64_tr_b16 v[246:247], v12 offset:22528
v_mfma_f32_16x16x32_bf16 a[56:59], v[228:231], v[64:67], a[56:59]
v_accvgpr_read_b32 v196, a16
v_accvgpr_read_b32 v197, a17
v_mfma_f32_16x16x32_bf16 a[60:63], v[224:227], v[172:175], a[60:63]
v_accvgpr_read_b32 v198, a18
v_accvgpr_read_b32 v199, a19
v_mfma_f32_16x16x32_bf16 a[60:63], v[228:231], v[96:99], a[60:63]
s_waitcnt lgkmcnt(4)
v_cvt_pk_bf16_f32 v18, v196, v197
v_mfma_f32_16x16x32_bf16 a[64:67], v[232:235], v[4:7], a[64:67]
ds_read_b64_tr_b16 v[224:225], v12 offset:36864
ds_read_b64_tr_b16 v[226:227], v12 offset:38912
v_mfma_f32_16x16x32_bf16 a[64:67], v[236:239], v[176:179], a[64:67]
v_cvt_pk_bf16_f32 v19, v198, v199
buffer_store_dwordx4 v[16:19], v252, s[20:23], s40 offen offset:0 sc1
v_mfma_f32_16x16x32_bf16 a[68:71], v[232:235], v[36:39], a[68:71]
ds_write_b128 v255, v[16:19] offset:0
v_accvgpr_read_b32 v204, a20
v_mfma_f32_16x16x32_bf16 a[68:71], v[236:239], v[180:183], a[68:71]
v_accvgpr_read_b32 v205, a21
v_accvgpr_read_b32 v206, a22
v_mfma_f32_16x16x32_bf16 a[72:75], v[232:235], v[68:71], a[72:75]
ds_read_b64_tr_b16 v[228:229], v12 offset:53248
ds_read_b64_tr_b16 v[230:231], v12 offset:55296
v_mfma_f32_16x16x32_bf16 a[72:75], v[236:239], v[184:187], a[72:75]
v_accvgpr_read_b32 v207, a23
v_cvt_pk_bf16_f32 v50, v204, v205
v_mfma_f32_16x16x32_bf16 a[76:79], v[232:235], v[100:103], a[76:79]
v_cvt_pk_bf16_f32 v51, v206, v207
buffer_store_dwordx4 v[48:51], v252, s[20:23], s41 offen offset:0 sc1
v_mfma_f32_16x16x32_bf16 a[76:79], v[236:239], v[188:191], a[76:79]
s_waitcnt lgkmcnt(5)
v_accvgpr_read_b32 v212, a24
v_mfma_f32_16x16x32_bf16 a[64:67], v[240:243], v[128:131], a[64:67]
ds_read_b64_tr_b16 v[232:233], v250 offset:36864
ds_read_b64_tr_b16 v[234:235], v250 offset:38912
v_mfma_f32_16x16x32_bf16 a[64:67], v[244:247], v[144:147], a[64:67]
v_accvgpr_read_b32 v213, a25
v_accvgpr_read_b32 v214, a26
v_mfma_f32_16x16x32_bf16 a[68:71], v[240:243], v[132:135], a[68:71]
v_accvgpr_read_b32 v215, a27
v_cvt_pk_bf16_f32 v82, v212, v213
v_mfma_f32_16x16x32_bf16 a[68:71], v[244:247], v[148:151], a[68:71]
v_cvt_pk_bf16_f32 v83, v214, v215
buffer_store_dwordx4 v[80:83], v252, s[20:23], s42 offen offset:0 sc1
v_mfma_f32_16x16x32_bf16 a[72:75], v[240:243], v[136:139], a[72:75]
ds_read_b64_tr_b16 v[236:237], v250 offset:53248
ds_read_b64_tr_b16 v[238:239], v250 offset:55296
v_mfma_f32_16x16x32_bf16 a[72:75], v[244:247], v[152:155], a[72:75]
v_accvgpr_read_b32 v220, a28
v_accvgpr_read_b32 v221, a29
v_mfma_f32_16x16x32_bf16 a[76:79], v[240:243], v[140:143], a[76:79]
v_accvgpr_read_b32 v222, a30
v_accvgpr_read_b32 v223, a31
v_mfma_f32_16x16x32_bf16 a[76:79], v[244:247], v[156:159], a[76:79]
s_waitcnt lgkmcnt(4)
v_cvt_pk_bf16_f32 v114, v220, v221
v_mfma_f32_16x16x32_bf16 a[64:67], v[224:227], v[160:163], a[64:67]
ds_read_b64_tr_b16 v[240:241], v13 offset:4096
ds_read_b64_tr_b16 v[242:243], v13 offset:6144
v_mfma_f32_16x16x32_bf16 a[64:67], v[228:231], v[0:3], a[64:67]
v_cvt_pk_bf16_f32 v115, v222, v223
buffer_store_dwordx4 v[112:115], v252, s[20:23], s43 offen offset:0 sc1
v_mfma_f32_16x16x32_bf16 a[68:71], v[224:227], v[164:167], a[68:71]
v_accvgpr_read_b32 v192, a32
v_accvgpr_read_b32 v193, a33
v_mfma_f32_16x16x32_bf16 a[68:71], v[228:231], v[32:35], a[68:71]
v_accvgpr_read_b32 v194, a34
v_accvgpr_read_b32 v195, a35
v_mfma_f32_16x16x32_bf16 a[72:75], v[224:227], v[168:171], a[72:75]
ds_read_b64_tr_b16 v[244:245], v13 offset:20480
ds_read_b64_tr_b16 v[246:247], v13 offset:22528
v_mfma_f32_16x16x32_bf16 a[72:75], v[228:231], v[64:67], a[72:75]
v_cvt_pk_bf16_f32 v20, v192, v193
v_cvt_pk_bf16_f32 v21, v194, v195
v_mfma_f32_16x16x32_bf16 a[76:79], v[224:227], v[172:175], a[76:79]
v_accvgpr_read_b32 v200, a36
v_accvgpr_read_b32 v201, a37
v_mfma_f32_16x16x32_bf16 a[76:79], v[228:231], v[96:99], a[76:79]
s_waitcnt lgkmcnt(4)
v_accvgpr_read_b32 v202, a38
v_mfma_f32_16x16x32_bf16 a[80:83], v[232:235], v[4:7], a[80:83]
ds_read_b64_tr_b16 v[224:225], v13 offset:36864
ds_read_b64_tr_b16 v[226:227], v13 offset:38912
v_mfma_f32_16x16x32_bf16 a[80:83], v[236:239], v[176:179], a[80:83]
v_accvgpr_read_b32 v203, a39
v_cvt_pk_bf16_f32 v52, v200, v201
v_mfma_f32_16x16x32_bf16 a[84:87], v[232:235], v[36:39], a[84:87]
v_cvt_pk_bf16_f32 v53, v202, v203
v_accvgpr_read_b32 v208, a40
v_mfma_f32_16x16x32_bf16 a[84:87], v[236:239], v[180:183], a[84:87]
v_accvgpr_read_b32 v209, a41
v_accvgpr_read_b32 v210, a42
v_mfma_f32_16x16x32_bf16 a[88:91], v[232:235], v[68:71], a[88:91]
ds_read_b64_tr_b16 v[228:229], v13 offset:53248
ds_read_b64_tr_b16 v[230:231], v13 offset:55296
v_mfma_f32_16x16x32_bf16 a[88:91], v[236:239], v[184:187], a[88:91]
v_accvgpr_read_b32 v211, a43
v_cvt_pk_bf16_f32 v84, v208, v209
v_mfma_f32_16x16x32_bf16 a[92:95], v[232:235], v[100:103], a[92:95]
v_cvt_pk_bf16_f32 v85, v210, v211
v_accvgpr_read_b32 v216, a44
v_mfma_f32_16x16x32_bf16 a[92:95], v[236:239], v[188:191], a[92:95]
s_waitcnt lgkmcnt(4)
v_accvgpr_read_b32 v217, a45
v_mfma_f32_16x16x32_bf16 a[80:83], v[240:243], v[128:131], a[80:83]
ds_read_b64_tr_b16 v[232:233], v249 offset:37376
ds_read_b64_tr_b16 v[234:235], v249 offset:39424
v_mfma_f32_16x16x32_bf16 a[80:83], v[244:247], v[144:147], a[80:83]
v_accvgpr_read_b32 v218, a46
v_accvgpr_read_b32 v219, a47
v_mfma_f32_16x16x32_bf16 a[84:87], v[240:243], v[132:135], a[84:87]
v_cvt_pk_bf16_f32 v116, v216, v217
v_cvt_pk_bf16_f32 v117, v218, v219
v_mfma_f32_16x16x32_bf16 a[84:87], v[244:247], v[148:151], a[84:87]
v_accvgpr_read_b32 v196, a48
v_accvgpr_read_b32 v197, a49
v_mfma_f32_16x16x32_bf16 a[88:91], v[240:243], v[136:139], a[88:91]
ds_read_b64_tr_b16 v[236:237], v249 offset:53760
ds_read_b64_tr_b16 v[238:239], v249 offset:55808
v_mfma_f32_16x16x32_bf16 a[88:91], v[244:247], v[152:155], a[88:91]
v_accvgpr_read_b32 v198, a50
v_accvgpr_read_b32 v199, a51
v_mfma_f32_16x16x32_bf16 a[92:95], v[240:243], v[140:143], a[92:95]
v_cvt_pk_bf16_f32 v22, v196, v197
v_cvt_pk_bf16_f32 v23, v198, v199
v_mfma_f32_16x16x32_bf16 a[92:95], v[244:247], v[156:159], a[92:95]
s_waitcnt lgkmcnt(4)
buffer_store_dwordx4 v[20:23], v252, s[20:23], s40 offen offset:1024 sc1
v_mfma_f32_16x16x32_bf16 a[80:83], v[224:227], v[160:163], a[80:83]
ds_read_b64_tr_b16 v[240:241], v12 offset:4608
ds_read_b64_tr_b16 v[242:243], v12 offset:6656
v_mfma_f32_16x16x32_bf16 a[80:83], v[228:231], v[0:3], a[80:83]
ds_write_b128 v255, v[20:23] offset:1024
v_accvgpr_read_b32 v204, a52
v_mfma_f32_16x16x32_bf16 a[84:87], v[224:227], v[164:167], a[84:87]
v_accvgpr_read_b32 v205, a53
v_accvgpr_read_b32 v206, a54
v_mfma_f32_16x16x32_bf16 a[84:87], v[228:231], v[32:35], a[84:87]
v_accvgpr_read_b32 v207, a55
v_cvt_pk_bf16_f32 v54, v204, v205
v_mfma_f32_16x16x32_bf16 a[88:91], v[224:227], v[168:171], a[88:91]
ds_read_b64_tr_b16 v[244:245], v12 offset:20992
ds_read_b64_tr_b16 v[246:247], v12 offset:23040
v_mfma_f32_16x16x32_bf16 a[88:91], v[228:231], v[64:67], a[88:91]
v_cvt_pk_bf16_f32 v55, v206, v207
buffer_store_dwordx4 v[52:55], v252, s[20:23], s41 offen offset:1024 sc1
v_mfma_f32_16x16x32_bf16 a[92:95], v[224:227], v[172:175], a[92:95]
v_accvgpr_read_b32 v212, a56
v_accvgpr_read_b32 v213, a57
v_mfma_f32_16x16x32_bf16 a[92:95], v[228:231], v[96:99], a[92:95]
s_waitcnt lgkmcnt(5)
v_accvgpr_read_b32 v214, a58
v_mfma_f32_16x16x32_bf16 a[96:99], v[232:235], v[4:7], a[96:99]
ds_read_b64_tr_b16 v[224:225], v12 offset:37376
ds_read_b64_tr_b16 v[226:227], v12 offset:39424
v_mfma_f32_16x16x32_bf16 a[96:99], v[236:239], v[176:179], a[96:99]
v_accvgpr_read_b32 v215, a59
v_cvt_pk_bf16_f32 v86, v212, v213
v_mfma_f32_16x16x32_bf16 a[100:103], v[232:235], v[36:39], a[100:103]
v_cvt_pk_bf16_f32 v87, v214, v215
buffer_store_dwordx4 v[84:87], v252, s[20:23], s42 offen offset:1024 sc1
v_mfma_f32_16x16x32_bf16 a[100:103], v[236:239], v[180:183], a[100:103]
v_accvgpr_read_b32 v220, a60
v_accvgpr_read_b32 v221, a61
v_mfma_f32_16x16x32_bf16 a[104:107], v[232:235], v[68:71], a[104:107]
ds_read_b64_tr_b16 v[228:229], v12 offset:53760
ds_read_b64_tr_b16 v[230:231], v12 offset:55808
v_mfma_f32_16x16x32_bf16 a[104:107], v[236:239], v[184:187], a[104:107]
v_accvgpr_read_b32 v222, a62
v_accvgpr_read_b32 v223, a63
v_mfma_f32_16x16x32_bf16 a[108:111], v[232:235], v[100:103], a[108:111]
v_cvt_pk_bf16_f32 v118, v220, v221
v_cvt_pk_bf16_f32 v119, v222, v223
v_mfma_f32_16x16x32_bf16 a[108:111], v[236:239], v[188:191], a[108:111]
s_waitcnt lgkmcnt(4)
buffer_store_dwordx4 v[116:119], v252, s[20:23], s43 offen offset:1024 sc1
v_mfma_f32_16x16x32_bf16 a[96:99], v[240:243], v[128:131], a[96:99]
ds_read_b64_tr_b16 v[232:233], v250 offset:37376
ds_read_b64_tr_b16 v[234:235], v250 offset:39424
v_mfma_f32_16x16x32_bf16 a[96:99], v[244:247], v[144:147], a[96:99]
v_accvgpr_read_b32 v192, a64
v_accvgpr_read_b32 v193, a65
v_mfma_f32_16x16x32_bf16 a[100:103], v[240:243], v[132:135], a[100:103]
v_accvgpr_read_b32 v194, a66
v_accvgpr_read_b32 v195, a67
v_mfma_f32_16x16x32_bf16 a[100:103], v[244:247], v[148:151], a[100:103]
v_cvt_pk_bf16_f32 v24, v192, v193
v_cvt_pk_bf16_f32 v25, v194, v195
v_mfma_f32_16x16x32_bf16 a[104:107], v[240:243], v[136:139], a[104:107]
ds_read_b64_tr_b16 v[236:237], v250 offset:53760
ds_read_b64_tr_b16 v[238:239], v250 offset:55808
v_mfma_f32_16x16x32_bf16 a[104:107], v[244:247], v[152:155], a[104:107]
v_accvgpr_read_b32 v200, a68
v_accvgpr_read_b32 v201, a69
v_mfma_f32_16x16x32_bf16 a[108:111], v[240:243], v[140:143], a[108:111]
v_accvgpr_read_b32 v202, a70
v_accvgpr_read_b32 v203, a71
v_mfma_f32_16x16x32_bf16 a[108:111], v[244:247], v[156:159], a[108:111]
s_waitcnt lgkmcnt(4)
v_cvt_pk_bf16_f32 v56, v200, v201
v_mfma_f32_16x16x32_bf16 a[96:99], v[224:227], v[160:163], a[96:99]
ds_read_b64_tr_b16 v[240:241], v13 offset:4608
ds_read_b64_tr_b16 v[242:243], v13 offset:6656
v_mfma_f32_16x16x32_bf16 a[96:99], v[228:231], v[0:3], a[96:99]
v_cvt_pk_bf16_f32 v57, v202, v203
v_accvgpr_read_b32 v208, a72
v_mfma_f32_16x16x32_bf16 a[100:103], v[224:227], v[164:167], a[100:103]
v_accvgpr_read_b32 v209, a73
v_accvgpr_read_b32 v210, a74
v_mfma_f32_16x16x32_bf16 a[100:103], v[228:231], v[32:35], a[100:103]
v_accvgpr_read_b32 v211, a75
v_cvt_pk_bf16_f32 v88, v208, v209
v_mfma_f32_16x16x32_bf16 a[104:107], v[224:227], v[168:171], a[104:107]
ds_read_b64_tr_b16 v[244:245], v13 offset:20992
ds_read_b64_tr_b16 v[246:247], v13 offset:23040
v_mfma_f32_16x16x32_bf16 a[104:107], v[228:231], v[64:67], a[104:107]
v_cvt_pk_bf16_f32 v89, v210, v211
v_accvgpr_read_b32 v216, a76
v_mfma_f32_16x16x32_bf16 a[108:111], v[224:227], v[172:175], a[108:111]
v_accvgpr_read_b32 v217, a77
v_accvgpr_read_b32 v218, a78
v_mfma_f32_16x16x32_bf16 a[108:111], v[228:231], v[96:99], a[108:111]
s_waitcnt lgkmcnt(4)
v_accvgpr_read_b32 v219, a79
v_mfma_f32_16x16x32_bf16 a[112:115], v[232:235], v[4:7], a[112:115]
ds_read_b64_tr_b16 v[224:225], v13 offset:37376
ds_read_b64_tr_b16 v[226:227], v13 offset:39424
v_mfma_f32_16x16x32_bf16 a[112:115], v[236:239], v[176:179], a[112:115]
v_cvt_pk_bf16_f32 v120, v216, v217
v_cvt_pk_bf16_f32 v121, v218, v219
v_mfma_f32_16x16x32_bf16 a[116:119], v[232:235], v[36:39], a[116:119]
v_accvgpr_read_b32 v196, a80
v_accvgpr_read_b32 v197, a81
v_mfma_f32_16x16x32_bf16 a[116:119], v[236:239], v[180:183], a[116:119]
v_accvgpr_read_b32 v198, a82
v_accvgpr_read_b32 v199, a83
v_mfma_f32_16x16x32_bf16 a[120:123], v[232:235], v[68:71], a[120:123]
ds_read_b64_tr_b16 v[228:229], v13 offset:53760
ds_read_b64_tr_b16 v[230:231], v13 offset:55808
v_mfma_f32_16x16x32_bf16 a[120:123], v[236:239], v[184:187], a[120:123]
v_cvt_pk_bf16_f32 v26, v196, v197
v_cvt_pk_bf16_f32 v27, v198, v199
v_mfma_f32_16x16x32_bf16 a[124:127], v[232:235], v[100:103], a[124:127]
buffer_store_dwordx4 v[24:27], v252, s[20:23], s40 offen offset:2048 sc1
ds_write_b128 v255, v[24:27] offset:2048
v_mfma_f32_16x16x32_bf16 a[124:127], v[236:239], v[188:191], a[124:127]
s_waitcnt lgkmcnt(5)
v_accvgpr_read_b32 v204, a84
v_mfma_f32_16x16x32_bf16 a[112:115], v[240:243], v[128:131], a[112:115]
ds_read_b64_tr_b16 v[232:233], v249 offset:40960
ds_read_b64_tr_b16 v[234:235], v249 offset:43008
v_mfma_f32_16x16x32_bf16 a[112:115], v[244:247], v[144:147], a[112:115]
v_accvgpr_read_b32 v205, a85
v_accvgpr_read_b32 v206, a86
v_mfma_f32_16x16x32_bf16 a[116:119], v[240:243], v[132:135], a[116:119]
v_accvgpr_read_b32 v207, a87
v_cvt_pk_bf16_f32 v58, v204, v205
v_mfma_f32_16x16x32_bf16 a[116:119], v[244:247], v[148:151], a[116:119]
v_cvt_pk_bf16_f32 v59, v206, v207
buffer_store_dwordx4 v[56:59], v252, s[20:23], s41 offen offset:2048 sc1
v_mfma_f32_16x16x32_bf16 a[120:123], v[240:243], v[136:139], a[120:123]
ds_read_b64_tr_b16 v[236:237], v249 offset:57344
ds_read_b64_tr_b16 v[238:239], v249 offset:59392
v_mfma_f32_16x16x32_bf16 a[120:123], v[244:247], v[152:155], a[120:123]
v_accvgpr_read_b32 v212, a88
v_accvgpr_read_b32 v213, a89
v_mfma_f32_16x16x32_bf16 a[124:127], v[240:243], v[140:143], a[124:127]
v_accvgpr_read_b32 v214, a90
v_accvgpr_read_b32 v215, a91
v_mfma_f32_16x16x32_bf16 a[124:127], v[244:247], v[156:159], a[124:127]
s_waitcnt lgkmcnt(5)
v_cvt_pk_bf16_f32 v90, v212, v213
v_mfma_f32_16x16x32_bf16 a[112:115], v[224:227], v[160:163], a[112:115]
ds_read_b64_tr_b16 v[240:241], v12 offset:8192
ds_read_b64_tr_b16 v[242:243], v12 offset:10240
v_mfma_f32_16x16x32_bf16 a[112:115], v[228:231], v[0:3], a[112:115]
v_cvt_pk_bf16_f32 v91, v214, v215
buffer_store_dwordx4 v[88:91], v252, s[20:23], s42 offen offset:2048 sc1
v_mfma_f32_16x16x32_bf16 a[116:119], v[224:227], v[164:167], a[116:119]
v_accvgpr_read_b32 v220, a92
v_accvgpr_read_b32 v221, a93
v_mfma_f32_16x16x32_bf16 a[116:119], v[228:231], v[32:35], a[116:119]
v_accvgpr_read_b32 v222, a94
v_accvgpr_read_b32 v223, a95
v_mfma_f32_16x16x32_bf16 a[120:123], v[224:227], v[168:171], a[120:123]
ds_read_b64_tr_b16 v[244:245], v12 offset:24576
ds_read_b64_tr_b16 v[246:247], v12 offset:26624
v_mfma_f32_16x16x32_bf16 a[120:123], v[228:231], v[64:67], a[120:123]
v_cvt_pk_bf16_f32 v122, v220, v221
v_cvt_pk_bf16_f32 v123, v222, v223
v_mfma_f32_16x16x32_bf16 a[124:127], v[224:227], v[172:175], a[124:127]
buffer_store_dwordx4 v[120:123], v252, s[20:23], s43 offen offset:2048 sc1
v_accvgpr_read_b32 v192, a96
v_mfma_f32_16x16x32_bf16 a[124:127], v[228:231], v[96:99], a[124:127]
s_waitcnt lgkmcnt(4)
v_accvgpr_read_b32 v193, a97
v_mfma_f32_16x16x32_bf16 a[128:131], v[232:235], v[4:7], a[128:131]
ds_read_b64_tr_b16 v[224:225], v12 offset:40960
ds_read_b64_tr_b16 v[226:227], v12 offset:43008
v_mfma_f32_16x16x32_bf16 a[128:131], v[236:239], v[176:179], a[128:131]
v_accvgpr_read_b32 v194, a98
v_accvgpr_read_b32 v195, a99
v_mfma_f32_16x16x32_bf16 a[132:135], v[232:235], v[36:39], a[132:135]
v_cvt_pk_bf16_f32 v28, v192, v193
v_cvt_pk_bf16_f32 v29, v194, v195
v_mfma_f32_16x16x32_bf16 a[132:135], v[236:239], v[180:183], a[132:135]
v_accvgpr_read_b32 v200, a100
v_accvgpr_read_b32 v201, a101
v_mfma_f32_16x16x32_bf16 a[136:139], v[232:235], v[68:71], a[136:139]
ds_read_b64_tr_b16 v[228:229], v12 offset:57344
ds_read_b64_tr_b16 v[230:231], v12 offset:59392
v_mfma_f32_16x16x32_bf16 a[136:139], v[236:239], v[184:187], a[136:139]
v_accvgpr_read_b32 v202, a102
v_accvgpr_read_b32 v203, a103
v_mfma_f32_16x16x32_bf16 a[140:143], v[232:235], v[100:103], a[140:143]
v_cvt_pk_bf16_f32 v60, v200, v201
v_cvt_pk_bf16_f32 v61, v202, v203
v_mfma_f32_16x16x32_bf16 a[140:143], v[236:239], v[188:191], a[140:143]
s_waitcnt lgkmcnt(4)
v_accvgpr_read_b32 v208, a104
v_mfma_f32_16x16x32_bf16 a[128:131], v[240:243], v[128:131], a[128:131]
ds_read_b64_tr_b16 v[232:233], v250 offset:40960
ds_read_b64_tr_b16 v[234:235], v250 offset:43008
v_mfma_f32_16x16x32_bf16 a[128:131], v[244:247], v[144:147], a[128:131]
v_accvgpr_read_b32 v209, a105
v_accvgpr_read_b32 v210, a106
v_mfma_f32_16x16x32_bf16 a[132:135], v[240:243], v[132:135], a[132:135]
v_accvgpr_read_b32 v211, a107
v_cvt_pk_bf16_f32 v92, v208, v209
v_mfma_f32_16x16x32_bf16 a[132:135], v[244:247], v[148:151], a[132:135]
v_cvt_pk_bf16_f32 v93, v210, v211
v_accvgpr_read_b32 v216, a108
v_mfma_f32_16x16x32_bf16 a[136:139], v[240:243], v[136:139], a[136:139]
ds_read_b64_tr_b16 v[236:237], v250 offset:57344
ds_read_b64_tr_b16 v[238:239], v250 offset:59392
v_mfma_f32_16x16x32_bf16 a[136:139], v[244:247], v[152:155], a[136:139]
v_accvgpr_read_b32 v217, a109
v_accvgpr_read_b32 v218, a110
v_mfma_f32_16x16x32_bf16 a[140:143], v[240:243], v[140:143], a[140:143]
v_accvgpr_read_b32 v219, a111
v_cvt_pk_bf16_f32 v124, v216, v217
v_mfma_f32_16x16x32_bf16 a[140:143], v[244:247], v[156:159], a[140:143]
s_waitcnt lgkmcnt(4)
v_cvt_pk_bf16_f32 v125, v218, v219
v_mfma_f32_16x16x32_bf16 a[128:131], v[224:227], v[160:163], a[128:131]
ds_read_b64_tr_b16 v[240:241], v13 offset:8192
ds_read_b64_tr_b16 v[242:243], v13 offset:10240
v_mfma_f32_16x16x32_bf16 a[128:131], v[228:231], v[0:3], a[128:131]
v_accvgpr_read_b32 v196, a112
v_accvgpr_read_b32 v197, a113
v_mfma_f32_16x16x32_bf16 a[132:135], v[224:227], v[164:167], a[132:135]
v_accvgpr_read_b32 v198, a114
v_accvgpr_read_b32 v199, a115
v_mfma_f32_16x16x32_bf16 a[132:135], v[228:231], v[32:35], a[132:135]
v_cvt_pk_bf16_f32 v30, v196, v197
v_cvt_pk_bf16_f32 v31, v198, v199
v_mfma_f32_16x16x32_bf16 a[136:139], v[224:227], v[168:171], a[136:139]
ds_read_b64_tr_b16 v[244:245], v13 offset:24576
ds_read_b64_tr_b16 v[246:247], v13 offset:26624
v_mfma_f32_16x16x32_bf16 a[136:139], v[228:231], v[64:67], a[136:139]
buffer_store_dwordx4 v[28:31], v252, s[20:23], s40 offen offset:3072 sc1
ds_write_b128 v255, v[28:31] offset:3072
v_mfma_f32_16x16x32_bf16 a[140:143], v[224:227], v[172:175], a[140:143]
v_accvgpr_read_b32 v204, a116
v_accvgpr_read_b32 v205, a117
v_mfma_f32_16x16x32_bf16 a[140:143], v[228:231], v[96:99], a[140:143]
s_waitcnt lgkmcnt(5)
v_accvgpr_read_b32 v206, a118
v_mfma_f32_16x16x32_bf16 a[144:147], v[232:235], v[4:7], a[144:147]
ds_read_b64_tr_b16 v[224:225], v13 offset:40960
ds_read_b64_tr_b16 v[226:227], v13 offset:43008
v_mfma_f32_16x16x32_bf16 a[144:147], v[236:239], v[176:179], a[144:147]
v_accvgpr_read_b32 v207, a119
v_cvt_pk_bf16_f32 v62, v204, v205
v_mfma_f32_16x16x32_bf16 a[148:151], v[232:235], v[36:39], a[148:151]
v_cvt_pk_bf16_f32 v63, v206, v207
buffer_store_dwordx4 v[60:63], v252, s[20:23], s41 offen offset:3072 sc1
v_mfma_f32_16x16x32_bf16 a[148:151], v[236:239], v[180:183], a[148:151]
v_accvgpr_read_b32 v212, a120
v_accvgpr_read_b32 v213, a121
v_mfma_f32_16x16x32_bf16 a[152:155], v[232:235], v[68:71], a[152:155]
ds_read_b64_tr_b16 v[228:229], v13 offset:57344
ds_read_b64_tr_b16 v[230:231], v13 offset:59392
v_mfma_f32_16x16x32_bf16 a[152:155], v[236:239], v[184:187], a[152:155]
v_accvgpr_read_b32 v214, a122
v_accvgpr_read_b32 v215, a123
v_mfma_f32_16x16x32_bf16 a[156:159], v[232:235], v[100:103], a[156:159]
v_cvt_pk_bf16_f32 v94, v212, v213
v_cvt_pk_bf16_f32 v95, v214, v215
v_mfma_f32_16x16x32_bf16 a[156:159], v[236:239], v[188:191], a[156:159]
s_waitcnt lgkmcnt(5)
buffer_store_dwordx4 v[92:95], v252, s[20:23], s42 offen offset:3072 sc1
v_mfma_f32_16x16x32_bf16 a[144:147], v[240:243], v[128:131], a[144:147]
ds_read_b64_tr_b16 v[232:233], v249 offset:41472
ds_read_b64_tr_b16 v[234:235], v249 offset:43520
v_mfma_f32_16x16x32_bf16 a[144:147], v[244:247], v[144:147], a[144:147]
v_accvgpr_read_b32 v220, a124
v_accvgpr_read_b32 v221, a125
v_mfma_f32_16x16x32_bf16 a[148:151], v[240:243], v[132:135], a[148:151]
v_accvgpr_read_b32 v222, a126
v_accvgpr_read_b32 v223, a127
v_mfma_f32_16x16x32_bf16 a[148:151], v[244:247], v[148:151], a[148:151]
v_cvt_pk_bf16_f32 v126, v220, v221
v_cvt_pk_bf16_f32 v127, v222, v223
v_mfma_f32_16x16x32_bf16 a[152:155], v[240:243], v[136:139], a[152:155]
ds_read_b64_tr_b16 v[236:237], v249 offset:57856
ds_read_b64_tr_b16 v[238:239], v249 offset:59904
v_mfma_f32_16x16x32_bf16 a[152:155], v[244:247], v[152:155], a[152:155]
buffer_store_dwordx4 v[124:127], v252, s[20:23], s43 offen offset:3072 sc1
v_accvgpr_read_b32 v192, a128
v_mfma_f32_16x16x32_bf16 a[156:159], v[240:243], v[140:143], a[156:159]
v_accvgpr_read_b32 v193, a129
v_accvgpr_read_b32 v194, a130
v_mfma_f32_16x16x32_bf16 a[156:159], v[244:247], v[156:159], a[156:159]
s_waitcnt lgkmcnt(4)
v_accvgpr_read_b32 v195, a131
v_mfma_f32_16x16x32_bf16 a[144:147], v[224:227], v[160:163], a[144:147]
ds_read_b64_tr_b16 v[240:241], v12 offset:8704
ds_read_b64_tr_b16 v[242:243], v12 offset:10752
v_mfma_f32_16x16x32_bf16 a[144:147], v[228:231], v[0:3], a[144:147]
v_cvt_pk_bf16_f32 v16, v192, v193
v_cvt_pk_bf16_f32 v17, v194, v195
v_mfma_f32_16x16x32_bf16 a[148:151], v[224:227], v[164:167], a[148:151]
v_accvgpr_read_b32 v200, a132
v_accvgpr_read_b32 v201, a133
v_mfma_f32_16x16x32_bf16 a[148:151], v[228:231], v[32:35], a[148:151]
v_accvgpr_read_b32 v202, a134
v_accvgpr_read_b32 v203, a135
v_mfma_f32_16x16x32_bf16 a[152:155], v[224:227], v[168:171], a[152:155]
ds_read_b64_tr_b16 v[244:245], v12 offset:25088
ds_read_b64_tr_b16 v[246:247], v12 offset:27136
v_mfma_f32_16x16x32_bf16 a[152:155], v[228:231], v[64:67], a[152:155]
v_cvt_pk_bf16_f32 v48, v200, v201
v_cvt_pk_bf16_f32 v49, v202, v203
v_mfma_f32_16x16x32_bf16 a[156:159], v[224:227], v[172:175], a[156:159]
v_accvgpr_read_b32 v208, a136
v_accvgpr_read_b32 v209, a137
v_mfma_f32_16x16x32_bf16 a[156:159], v[228:231], v[96:99], a[156:159]
s_waitcnt lgkmcnt(4)
v_accvgpr_read_b32 v210, a138
v_mfma_f32_16x16x32_bf16 a[160:163], v[232:235], v[4:7], a[160:163]
ds_read_b64_tr_b16 v[224:225], v12 offset:41472
ds_read_b64_tr_b16 v[226:227], v12 offset:43520
v_mfma_f32_16x16x32_bf16 a[160:163], v[236:239], v[176:179], a[160:163]
v_accvgpr_read_b32 v211, a139
v_cvt_pk_bf16_f32 v80, v208, v209
v_mfma_f32_16x16x32_bf16 a[164:167], v[232:235], v[36:39], a[164:167]
v_cvt_pk_bf16_f32 v81, v210, v211
v_accvgpr_read_b32 v216, a140
v_mfma_f32_16x16x32_bf16 a[164:167], v[236:239], v[180:183], a[164:167]
v_accvgpr_read_b32 v217, a141
v_accvgpr_read_b32 v218, a142
v_mfma_f32_16x16x32_bf16 a[168:171], v[232:235], v[68:71], a[168:171]
ds_read_b64_tr_b16 v[228:229], v12 offset:57856
ds_read_b64_tr_b16 v[230:231], v12 offset:59904
v_mfma_f32_16x16x32_bf16 a[168:171], v[236:239], v[184:187], a[168:171]
v_accvgpr_read_b32 v219, a143
v_cvt_pk_bf16_f32 v112, v216, v217
v_mfma_f32_16x16x32_bf16 a[172:175], v[232:235], v[100:103], a[172:175]
v_cvt_pk_bf16_f32 v113, v218, v219
v_accvgpr_read_b32 v196, a144
v_mfma_f32_16x16x32_bf16 a[172:175], v[236:239], v[188:191], a[172:175]
s_waitcnt lgkmcnt(4)
v_accvgpr_read_b32 v197, a145
v_mfma_f32_16x16x32_bf16 a[160:163], v[240:243], v[128:131], a[160:163]
ds_read_b64_tr_b16 v[232:233], v250 offset:41472
ds_read_b64_tr_b16 v[234:235], v250 offset:43520
v_mfma_f32_16x16x32_bf16 a[160:163], v[244:247], v[144:147], a[160:163]
v_accvgpr_read_b32 v198, a146
v_accvgpr_read_b32 v199, a147
v_mfma_f32_16x16x32_bf16 a[164:167], v[240:243], v[132:135], a[164:167]
v_cvt_pk_bf16_f32 v18, v196, v197
v_cvt_pk_bf16_f32 v19, v198, v199
v_mfma_f32_16x16x32_bf16 a[164:167], v[244:247], v[148:151], a[164:167]
buffer_store_dwordx4 v[16:19], v252, s[20:23], s44 offen offset:0 sc1
v_accvgpr_read_b32 v204, a148
v_mfma_f32_16x16x32_bf16 a[168:171], v[240:243], v[136:139], a[168:171]
ds_read_b64_tr_b16 v[236:237], v250 offset:57856
ds_read_b64_tr_b16 v[238:239], v250 offset:59904
v_mfma_f32_16x16x32_bf16 a[168:171], v[244:247], v[152:155], a[168:171]
v_accvgpr_read_b32 v205, a149
v_accvgpr_read_b32 v206, a150
v_mfma_f32_16x16x32_bf16 a[172:175], v[240:243], v[140:143], a[172:175]
v_accvgpr_read_b32 v207, a151
v_cvt_pk_bf16_f32 v50, v204, v205
s_mov_b32 s33, 0x6c01400
v_mfma_f32_16x16x32_bf16 a[172:175], v[244:247], v[156:159], a[172:175]
s_waitcnt lgkmcnt(4)
v_cvt_pk_bf16_f32 v51, v206, v207
buffer_load_dword v254, off, s[56:59], s33 sc1
v_mfma_f32_16x16x32_bf16 a[160:163], v[224:227], v[160:163], a[160:163]
ds_read_b64_tr_b16 v[240:241], v13 offset:8704
ds_read_b64_tr_b16 v[242:243], v13 offset:10752
v_mfma_f32_16x16x32_bf16 a[160:163], v[228:231], v[0:3], a[160:163]
buffer_store_dwordx4 v[48:51], v252, s[20:23], s45 offen offset:0 sc1
v_accvgpr_read_b32 v212, a152
v_mfma_f32_16x16x32_bf16 a[164:167], v[224:227], v[164:167], a[164:167]
v_accvgpr_read_b32 v213, a153
v_accvgpr_read_b32 v214, a154
v_mfma_f32_16x16x32_bf16 a[164:167], v[228:231], v[32:35], a[164:167]
v_accvgpr_read_b32 v215, a155
v_cvt_pk_bf16_f32 v82, v212, v213
v_mfma_f32_16x16x32_bf16 a[168:171], v[224:227], v[168:171], a[168:171]
ds_read_b64_tr_b16 v[244:245], v13 offset:25088
ds_read_b64_tr_b16 v[246:247], v13 offset:27136
v_mfma_f32_16x16x32_bf16 a[168:171], v[228:231], v[64:67], a[168:171]
v_cvt_pk_bf16_f32 v83, v214, v215
buffer_store_dwordx4 v[80:83], v252, s[20:23], s46 offen offset:0 sc1
v_mfma_f32_16x16x32_bf16 a[172:175], v[224:227], v[172:175], a[172:175]
v_accvgpr_read_b32 v220, a156
v_accvgpr_read_b32 v221, a157
v_mfma_f32_16x16x32_bf16 a[172:175], v[228:231], v[96:99], a[172:175]
s_waitcnt lgkmcnt(4)
v_accvgpr_read_b32 v222, a158
v_mfma_f32_16x16x32_bf16 a[176:179], v[232:235], v[4:7], a[176:179]
ds_read_b64_tr_b16 v[224:225], v13 offset:41472
ds_read_b64_tr_b16 v[226:227], v13 offset:43520
v_mfma_f32_16x16x32_bf16 a[176:179], v[236:239], v[176:179], a[176:179]
v_accvgpr_read_b32 v223, a159
v_cvt_pk_bf16_f32 v114, v220, v221
v_mfma_f32_16x16x32_bf16 a[180:183], v[232:235], v[36:39], a[180:183]
v_cvt_pk_bf16_f32 v115, v222, v223
buffer_store_dwordx4 v[112:115], v252, s[20:23], s47 offen offset:0 sc1
v_mfma_f32_16x16x32_bf16 a[180:183], v[236:239], v[180:183], a[180:183]
v_accvgpr_read_b32 v192, a160
v_accvgpr_read_b32 v193, a161
v_mfma_f32_16x16x32_bf16 a[184:187], v[232:235], v[68:71], a[184:187]
ds_read_b64_tr_b16 v[228:229], v13 offset:57856
ds_read_b64_tr_b16 v[230:231], v13 offset:59904
v_mfma_f32_16x16x32_bf16 a[184:187], v[236:239], v[184:187], a[184:187]
v_accvgpr_read_b32 v194, a162
v_accvgpr_read_b32 v195, a163
v_mfma_f32_16x16x32_bf16 a[188:191], v[232:235], v[100:103], a[188:191]
v_cvt_pk_bf16_f32 v20, v192, v193
v_cvt_pk_bf16_f32 v21, v194, v195
v_mfma_f32_16x16x32_bf16 a[188:191], v[236:239], v[188:191], a[188:191]
s_waitcnt lgkmcnt(4)
v_accvgpr_read_b32 v200, a164
v_mfma_f32_16x16x32_bf16 a[176:179], v[240:243], v[128:131], a[176:179]
ds_read_b64_tr_b16 v[232:233], v249 offset:45056
ds_read_b64_tr_b16 v[234:235], v249 offset:47104
v_mfma_f32_16x16x32_bf16 a[176:179], v[244:247], v[144:147], a[176:179]
v_accvgpr_read_b32 v201, a165
v_accvgpr_read_b32 v202, a166
v_mfma_f32_16x16x32_bf16 a[180:183], v[240:243], v[132:135], a[180:183]
v_accvgpr_read_b32 v203, a167
v_cvt_pk_bf16_f32 v52, v200, v201
v_mfma_f32_16x16x32_bf16 a[180:183], v[244:247], v[148:151], a[180:183]
v_cvt_pk_bf16_f32 v53, v202, v203
v_accvgpr_read_b32 v208, a168
v_mfma_f32_16x16x32_bf16 a[184:187], v[240:243], v[136:139], a[184:187]
ds_read_b64_tr_b16 v[236:237], v249 offset:61440
ds_read_b64_tr_b16 v[238:239], v249 offset:63488
v_mfma_f32_16x16x32_bf16 a[184:187], v[244:247], v[152:155], a[184:187]
v_accvgpr_read_b32 v209, a169
v_accvgpr_read_b32 v210, a170
v_mfma_f32_16x16x32_bf16 a[188:191], v[240:243], v[140:143], a[188:191]
v_accvgpr_read_b32 v211, a171
v_cvt_pk_bf16_f32 v84, v208, v209
v_mfma_f32_16x16x32_bf16 a[188:191], v[244:247], v[156:159], a[188:191]
s_waitcnt lgkmcnt(4)
v_cvt_pk_bf16_f32 v85, v210, v211
v_mfma_f32_16x16x32_bf16 a[176:179], v[224:227], v[160:163], a[176:179]
ds_read_b64_tr_b16 v[240:241], v12 offset:12288
ds_read_b64_tr_b16 v[242:243], v12 offset:14336
v_mfma_f32_16x16x32_bf16 a[176:179], v[228:231], v[0:3], a[176:179]
v_accvgpr_read_b32 v216, a172
v_accvgpr_read_b32 v217, a173
v_mfma_f32_16x16x32_bf16 a[180:183], v[224:227], v[164:167], a[180:183]
v_accvgpr_read_b32 v218, a174
v_accvgpr_read_b32 v219, a175
v_mfma_f32_16x16x32_bf16 a[180:183], v[228:231], v[32:35], a[180:183]
v_cvt_pk_bf16_f32 v116, v216, v217
v_cvt_pk_bf16_f32 v117, v218, v219
v_mfma_f32_16x16x32_bf16 a[184:187], v[224:227], v[168:171], a[184:187]
ds_read_b64_tr_b16 v[244:245], v12 offset:28672
ds_read_b64_tr_b16 v[246:247], v12 offset:30720
v_mfma_f32_16x16x32_bf16 a[184:187], v[228:231], v[64:67], a[184:187]
v_mfma_f32_16x16x32_bf16 a[188:191], v[224:227], v[172:175], a[188:191]
v_accvgpr_read_b32 v196, a176
v_accvgpr_read_b32 v197, a177
v_mfma_f32_16x16x32_bf16 a[188:191], v[228:231], v[96:99], a[188:191]
s_waitcnt lgkmcnt(4)
v_accvgpr_read_b32 v198, a178
v_mfma_f32_16x16x32_bf16 a[192:195], v[232:235], v[4:7], a[192:195]
ds_read_b64_tr_b16 v[224:225], v12 offset:45056
ds_read_b64_tr_b16 v[226:227], v12 offset:47104
v_mfma_f32_16x16x32_bf16 a[192:195], v[236:239], v[176:179], a[192:195]
v_accvgpr_read_b32 v199, a179
v_cvt_pk_bf16_f32 v22, v196, v197
v_mfma_f32_16x16x32_bf16 a[196:199], v[232:235], v[36:39], a[196:199]
v_cvt_pk_bf16_f32 v23, v198, v199
buffer_store_dwordx4 v[20:23], v252, s[20:23], s44 offen offset:1024 sc1
v_mfma_f32_16x16x32_bf16 a[196:199], v[236:239], v[180:183], a[196:199]
v_accvgpr_read_b32 v204, a180
v_accvgpr_read_b32 v205, a181
v_mfma_f32_16x16x32_bf16 a[200:203], v[232:235], v[68:71], a[200:203]
ds_read_b64_tr_b16 v[228:229], v12 offset:61440
ds_read_b64_tr_b16 v[230:231], v12 offset:63488
v_mfma_f32_16x16x32_bf16 a[200:203], v[236:239], v[184:187], a[200:203]
v_accvgpr_read_b32 v206, a182
v_accvgpr_read_b32 v207, a183
v_mfma_f32_16x16x32_bf16 a[204:207], v[232:235], v[100:103], a[204:207]
v_cvt_pk_bf16_f32 v54, v204, v205
v_cvt_pk_bf16_f32 v55, v206, v207
v_mfma_f32_16x16x32_bf16 a[204:207], v[236:239], v[188:191], a[204:207]
s_waitcnt lgkmcnt(4)
buffer_store_dwordx4 v[52:55], v252, s[20:23], s45 offen offset:1024 sc1
v_mfma_f32_16x16x32_bf16 a[192:195], v[240:243], v[128:131], a[192:195]
ds_read_b64_tr_b16 v[232:233], v250 offset:45056
ds_read_b64_tr_b16 v[234:235], v250 offset:47104
v_mfma_f32_16x16x32_bf16 a[192:195], v[244:247], v[144:147], a[192:195]
v_accvgpr_read_b32 v212, a184
v_accvgpr_read_b32 v213, a185
v_mfma_f32_16x16x32_bf16 a[196:199], v[240:243], v[132:135], a[196:199]
v_accvgpr_read_b32 v214, a186
v_accvgpr_read_b32 v215, a187
v_mfma_f32_16x16x32_bf16 a[196:199], v[244:247], v[148:151], a[196:199]
v_cvt_pk_bf16_f32 v86, v212, v213
v_cvt_pk_bf16_f32 v87, v214, v215
v_mfma_f32_16x16x32_bf16 a[200:203], v[240:243], v[136:139], a[200:203]
ds_read_b64_tr_b16 v[236:237], v250 offset:61440
ds_read_b64_tr_b16 v[238:239], v250 offset:63488
v_mfma_f32_16x16x32_bf16 a[200:203], v[244:247], v[152:155], a[200:203]
buffer_store_dwordx4 v[84:87], v252, s[20:23], s46 offen offset:1024 sc1
v_accvgpr_read_b32 v220, a188
v_mfma_f32_16x16x32_bf16 a[204:207], v[240:243], v[140:143], a[204:207]
v_accvgpr_read_b32 v221, a189
v_accvgpr_read_b32 v222, a190
v_mfma_f32_16x16x32_bf16 a[204:207], v[244:247], v[156:159], a[204:207]
s_waitcnt lgkmcnt(4)
v_accvgpr_read_b32 v223, a191
v_mfma_f32_16x16x32_bf16 a[192:195], v[224:227], v[160:163], a[192:195]
ds_read_b64_tr_b16 v[240:241], v13 offset:12288
ds_read_b64_tr_b16 v[242:243], v13 offset:14336
v_mfma_f32_16x16x32_bf16 a[192:195], v[228:231], v[0:3], a[192:195]
v_cvt_pk_bf16_f32 v118, v220, v221
v_cvt_pk_bf16_f32 v119, v222, v223
v_mfma_f32_16x16x32_bf16 a[196:199], v[224:227], v[164:167], a[196:199]
buffer_store_dwordx4 v[116:119], v252, s[20:23], s47 offen offset:1024 sc1
v_mfma_f32_16x16x32_bf16 a[196:199], v[228:231], v[32:35], a[196:199]
v_mfma_f32_16x16x32_bf16 a[200:203], v[224:227], v[168:171], a[200:203]
ds_read_b64_tr_b16 v[244:245], v13 offset:28672
ds_read_b64_tr_b16 v[246:247], v13 offset:30720
v_mfma_f32_16x16x32_bf16 a[200:203], v[228:231], v[64:67], a[200:203]
v_mfma_f32_16x16x32_bf16 a[204:207], v[224:227], v[172:175], a[204:207]
v_accvgpr_read_b32 v192, a192
v_accvgpr_read_b32 v193, a193
v_mfma_f32_16x16x32_bf16 a[204:207], v[228:231], v[96:99], a[204:207]
s_waitcnt lgkmcnt(4)
v_accvgpr_read_b32 v194, a194
v_mfma_f32_16x16x32_bf16 a[208:211], v[232:235], v[4:7], a[208:211]
ds_read_b64_tr_b16 v[224:225], v13 offset:45056
ds_read_b64_tr_b16 v[226:227], v13 offset:47104
v_mfma_f32_16x16x32_bf16 a[208:211], v[236:239], v[176:179], a[208:211]
v_accvgpr_read_b32 v195, a195
v_cvt_pk_bf16_f32 v24, v192, v193
v_mfma_f32_16x16x32_bf16 a[212:215], v[232:235], v[36:39], a[212:215]
v_cvt_pk_bf16_f32 v25, v194, v195
v_accvgpr_read_b32 v200, a196
v_mfma_f32_16x16x32_bf16 a[212:215], v[236:239], v[180:183], a[212:215]
v_accvgpr_read_b32 v201, a197
v_accvgpr_read_b32 v202, a198
v_mfma_f32_16x16x32_bf16 a[216:219], v[232:235], v[68:71], a[216:219]
ds_read_b64_tr_b16 v[228:229], v13 offset:61440
ds_read_b64_tr_b16 v[230:231], v13 offset:63488
v_mfma_f32_16x16x32_bf16 a[216:219], v[236:239], v[184:187], a[216:219]
v_accvgpr_read_b32 v203, a199
v_cvt_pk_bf16_f32 v56, v200, v201
v_mfma_f32_16x16x32_bf16 a[220:223], v[232:235], v[100:103], a[220:223]
v_cvt_pk_bf16_f32 v57, v202, v203
v_accvgpr_read_b32 v208, a200
v_mfma_f32_16x16x32_bf16 a[220:223], v[236:239], v[188:191], a[220:223]
s_waitcnt lgkmcnt(4)
v_accvgpr_read_b32 v209, a201
v_mfma_f32_16x16x32_bf16 a[208:211], v[240:243], v[128:131], a[208:211]
ds_read_b64_tr_b16 v[232:233], v249 offset:45568
ds_read_b64_tr_b16 v[234:235], v249 offset:47616
v_mfma_f32_16x16x32_bf16 a[208:211], v[244:247], v[144:147], a[208:211]
v_accvgpr_read_b32 v210, a202
v_accvgpr_read_b32 v211, a203
v_mfma_f32_16x16x32_bf16 a[212:215], v[240:243], v[132:135], a[212:215]
v_cvt_pk_bf16_f32 v88, v208, v209
v_cvt_pk_bf16_f32 v89, v210, v211
v_mfma_f32_16x16x32_bf16 a[212:215], v[244:247], v[148:151], a[212:215]
v_accvgpr_read_b32 v216, a204
v_accvgpr_read_b32 v217, a205
v_mfma_f32_16x16x32_bf16 a[216:219], v[240:243], v[136:139], a[216:219]
ds_read_b64_tr_b16 v[236:237], v249 offset:61952
ds_read_b64_tr_b16 v[238:239], v249 offset:64000
v_mfma_f32_16x16x32_bf16 a[216:219], v[244:247], v[152:155], a[216:219]
v_accvgpr_read_b32 v218, a206
v_accvgpr_read_b32 v219, a207
v_mfma_f32_16x16x32_bf16 a[220:223], v[240:243], v[140:143], a[220:223]
v_cvt_pk_bf16_f32 v120, v216, v217
v_cvt_pk_bf16_f32 v121, v218, v219
v_mfma_f32_16x16x32_bf16 a[220:223], v[244:247], v[156:159], a[220:223]
s_waitcnt lgkmcnt(4)
v_mfma_f32_16x16x32_bf16 a[208:211], v[224:227], v[160:163], a[208:211]
ds_read_b64_tr_b16 v[240:241], v12 offset:12800
ds_read_b64_tr_b16 v[242:243], v12 offset:14848
v_mfma_f32_16x16x32_bf16 a[208:211], v[228:231], v[0:3], a[208:211]
v_mfma_f32_16x16x32_bf16 a[212:215], v[224:227], v[164:167], a[212:215]
v_mfma_f32_16x16x32_bf16 a[212:215], v[228:231], v[32:35], a[212:215]
v_mfma_f32_16x16x32_bf16 a[216:219], v[224:227], v[168:171], a[216:219]
ds_read_b64_tr_b16 v[244:245], v12 offset:29184
ds_read_b64_tr_b16 v[246:247], v12 offset:31232
v_mfma_f32_16x16x32_bf16 a[216:219], v[228:231], v[64:67], a[216:219]
v_mfma_f32_16x16x32_bf16 a[220:223], v[224:227], v[172:175], a[220:223]
s_nop 0
v_accvgpr_read_b32 v196, a208
v_accvgpr_read_b32 v197, a209
v_mfma_f32_16x16x32_bf16 a[220:223], v[228:231], v[96:99], a[220:223]
s_waitcnt lgkmcnt(4)
v_accvgpr_read_b32 v198, a210
v_mfma_f32_16x16x32_bf16 a[224:227], v[232:235], v[4:7], a[224:227]
ds_read_b64_tr_b16 v[224:225], v12 offset:45568
ds_read_b64_tr_b16 v[226:227], v12 offset:47616
v_mfma_f32_16x16x32_bf16 a[224:227], v[236:239], v[176:179], a[224:227]
v_accvgpr_read_b32 v199, a211
v_cvt_pk_bf16_f32 v26, v196, v197
v_mfma_f32_16x16x32_bf16 a[228:231], v[232:235], v[36:39], a[228:231]
v_cvt_pk_bf16_f32 v27, v198, v199
buffer_store_dwordx4 v[24:27], v252, s[20:23], s44 offen offset:2048 sc1
v_mfma_f32_16x16x32_bf16 a[228:231], v[236:239], v[180:183], a[228:231]
v_accvgpr_read_b32 v204, a212
v_accvgpr_read_b32 v205, a213
v_mfma_f32_16x16x32_bf16 a[232:235], v[232:235], v[68:71], a[232:235]
ds_read_b64_tr_b16 v[228:229], v12 offset:61952
ds_read_b64_tr_b16 v[230:231], v12 offset:64000
v_mfma_f32_16x16x32_bf16 a[232:235], v[236:239], v[184:187], a[232:235]
v_accvgpr_read_b32 v206, a214
v_accvgpr_read_b32 v207, a215
v_mfma_f32_16x16x32_bf16 a[236:239], v[232:235], v[100:103], a[236:239]
v_cvt_pk_bf16_f32 v58, v204, v205
v_cvt_pk_bf16_f32 v59, v206, v207
v_mfma_f32_16x16x32_bf16 a[236:239], v[236:239], v[188:191], a[236:239]
s_waitcnt lgkmcnt(4)
buffer_store_dwordx4 v[56:59], v252, s[20:23], s45 offen offset:2048 sc1
v_mfma_f32_16x16x32_bf16 a[224:227], v[240:243], v[128:131], a[224:227]
ds_read_b64_tr_b16 v[232:233], v250 offset:45568
ds_read_b64_tr_b16 v[234:235], v250 offset:47616
v_mfma_f32_16x16x32_bf16 a[224:227], v[244:247], v[144:147], a[224:227]
v_accvgpr_read_b32 v212, a216
v_accvgpr_read_b32 v213, a217
v_mfma_f32_16x16x32_bf16 a[228:231], v[240:243], v[132:135], a[228:231]
v_accvgpr_read_b32 v214, a218
v_accvgpr_read_b32 v215, a219
v_mfma_f32_16x16x32_bf16 a[228:231], v[244:247], v[148:151], a[228:231]
v_cvt_pk_bf16_f32 v90, v212, v213
v_cvt_pk_bf16_f32 v91, v214, v215
v_mfma_f32_16x16x32_bf16 a[232:235], v[240:243], v[136:139], a[232:235]
ds_read_b64_tr_b16 v[236:237], v250 offset:61952
ds_read_b64_tr_b16 v[238:239], v250 offset:64000
v_mfma_f32_16x16x32_bf16 a[232:235], v[244:247], v[152:155], a[232:235]
buffer_store_dwordx4 v[88:91], v252, s[20:23], s46 offen offset:2048 sc1
v_accvgpr_read_b32 v220, a220
v_mfma_f32_16x16x32_bf16 a[236:239], v[240:243], v[140:143], a[236:239]
v_accvgpr_read_b32 v221, a221
v_accvgpr_read_b32 v222, a222
v_mfma_f32_16x16x32_bf16 a[236:239], v[244:247], v[156:159], a[236:239]
s_waitcnt lgkmcnt(4)
v_accvgpr_read_b32 v223, a223
v_mfma_f32_16x16x32_bf16 a[224:227], v[224:227], v[160:163], a[224:227]
ds_read_b64_tr_b16 v[240:241], v13 offset:12800
ds_read_b64_tr_b16 v[242:243], v13 offset:14848
v_mfma_f32_16x16x32_bf16 a[224:227], v[228:231], v[0:3], a[224:227]
v_cvt_pk_bf16_f32 v122, v220, v221
v_cvt_pk_bf16_f32 v123, v222, v223
v_mfma_f32_16x16x32_bf16 a[228:231], v[224:227], v[164:167], a[228:231]
buffer_store_dwordx4 v[120:123], v252, s[20:23], s47 offen offset:2048 sc1
v_mfma_f32_16x16x32_bf16 a[228:231], v[228:231], v[32:35], a[228:231]
v_mfma_f32_16x16x32_bf16 a[232:235], v[224:227], v[168:171], a[232:235]
ds_read_b64_tr_b16 v[244:245], v13 offset:29184
ds_read_b64_tr_b16 v[246:247], v13 offset:31232
v_mfma_f32_16x16x32_bf16 a[232:235], v[228:231], v[64:67], a[232:235]
v_mfma_f32_16x16x32_bf16 a[236:239], v[224:227], v[172:175], a[236:239]
v_accvgpr_read_b32 v192, a224
v_accvgpr_read_b32 v193, a225
v_mfma_f32_16x16x32_bf16 a[236:239], v[228:231], v[96:99], a[236:239]
s_waitcnt lgkmcnt(4)
v_accvgpr_read_b32 v194, a226
v_mfma_f32_16x16x32_bf16 a[240:243], v[232:235], v[4:7], a[240:243]
ds_read_b64_tr_b16 v[224:225], v13 offset:45568
ds_read_b64_tr_b16 v[226:227], v13 offset:47616
v_mfma_f32_16x16x32_bf16 a[240:243], v[236:239], v[176:179], a[240:243]
v_accvgpr_read_b32 v195, a227
v_cvt_pk_bf16_f32 v28, v192, v193
v_mfma_f32_16x16x32_bf16 a[244:247], v[232:235], v[36:39], a[244:247]
v_cvt_pk_bf16_f32 v29, v194, v195
v_accvgpr_read_b32 v200, a228
v_mfma_f32_16x16x32_bf16 a[244:247], v[236:239], v[180:183], a[244:247]
v_accvgpr_read_b32 v201, a229
v_accvgpr_read_b32 v202, a230
v_mfma_f32_16x16x32_bf16 a[248:251], v[232:235], v[68:71], a[248:251]
ds_read_b64_tr_b16 v[228:229], v13 offset:61952
ds_read_b64_tr_b16 v[230:231], v13 offset:64000
v_mfma_f32_16x16x32_bf16 a[248:251], v[236:239], v[184:187], a[248:251]
v_accvgpr_read_b32 v203, a231
v_cvt_pk_bf16_f32 v60, v200, v201
v_mfma_f32_16x16x32_bf16 a[252:255], v[232:235], v[100:103], a[252:255]
v_cvt_pk_bf16_f32 v61, v202, v203
v_accvgpr_read_b32 v208, a232
v_mfma_f32_16x16x32_bf16 a[252:255], v[236:239], v[188:191], a[252:255]
s_waitcnt lgkmcnt(4)
v_accvgpr_read_b32 v209, a233
v_mfma_f32_16x16x32_bf16 a[240:243], v[240:243], v[128:131], a[240:243]
v_accvgpr_read_b32 v210, a234
v_accvgpr_read_b32 v211, a235
v_mfma_f32_16x16x32_bf16 a[240:243], v[244:247], v[144:147], a[240:243]
v_cvt_pk_bf16_f32 v92, v208, v209
v_cvt_pk_bf16_f32 v93, v210, v211
v_mfma_f32_16x16x32_bf16 a[244:247], v[240:243], v[132:135], a[244:247]
v_accvgpr_read_b32 v216, a236
v_accvgpr_read_b32 v217, a237
v_mfma_f32_16x16x32_bf16 a[244:247], v[244:247], v[148:151], a[244:247]
v_accvgpr_read_b32 v218, a238
v_accvgpr_read_b32 v219, a239
v_mfma_f32_16x16x32_bf16 a[248:251], v[240:243], v[136:139], a[248:251]
v_cvt_pk_bf16_f32 v124, v216, v217
v_cvt_pk_bf16_f32 v125, v218, v219
v_mfma_f32_16x16x32_bf16 a[248:251], v[244:247], v[152:155], a[248:251]
v_mfma_f32_16x16x32_bf16 a[252:255], v[240:243], v[140:143], a[252:255]
v_mfma_f32_16x16x32_bf16 a[252:255], v[244:247], v[156:159], a[252:255]
s_waitcnt lgkmcnt(0)
v_mfma_f32_16x16x32_bf16 a[240:243], v[224:227], v[160:163], a[240:243]
v_mfma_f32_16x16x32_bf16 a[240:243], v[228:231], v[0:3], a[240:243]
v_mfma_f32_16x16x32_bf16 a[244:247], v[224:227], v[164:167], a[244:247]
v_mfma_f32_16x16x32_bf16 a[244:247], v[228:231], v[32:35], a[244:247]
v_mfma_f32_16x16x32_bf16 a[248:251], v[224:227], v[168:171], a[248:251]
v_mfma_f32_16x16x32_bf16 a[248:251], v[228:231], v[64:67], a[248:251]
v_mfma_f32_16x16x32_bf16 a[252:255], v[224:227], v[172:175], a[252:255]
s_nop 2
v_accvgpr_read_b32 v196, a240
v_accvgpr_read_b32 v197, a241
v_accvgpr_read_b32 v198, a242
v_accvgpr_read_b32 v199, a243
v_mfma_f32_16x16x32_bf16 a[252:255], v[228:231], v[96:99], a[252:255]
v_cvt_pk_bf16_f32 v30, v196, v197
v_cvt_pk_bf16_f32 v31, v198, v199
buffer_store_dwordx4 v[28:31], v252, s[20:23], s44 offen offset:3072 sc1
v_accvgpr_read_b32 v204, a244
v_accvgpr_read_b32 v205, a245
v_accvgpr_read_b32 v206, a246
v_accvgpr_read_b32 v207, a247
v_cvt_pk_bf16_f32 v62, v204, v205
v_cvt_pk_bf16_f32 v63, v206, v207
buffer_store_dwordx4 v[60:63], v252, s[20:23], s45 offen offset:3072 sc1
v_accvgpr_read_b32 v212, a248
v_accvgpr_read_b32 v213, a249
v_accvgpr_read_b32 v214, a250
v_accvgpr_read_b32 v215, a251
v_cvt_pk_bf16_f32 v94, v212, v213
v_cvt_pk_bf16_f32 v95, v214, v215
buffer_store_dwordx4 v[92:95], v252, s[20:23], s46 offen offset:3072 sc1
v_accvgpr_read_b32 v220, a252
v_accvgpr_read_b32 v221, a253
v_accvgpr_read_b32 v222, a254
v_accvgpr_read_b32 v223, a255
v_cvt_pk_bf16_f32 v126, v220, v221
v_cvt_pk_bf16_f32 v127, v222, v223
buffer_store_dwordx4 v[124:127], v252, s[20:23], s47 offen offset:3072 sc1
s_waitcnt vmcnt(15)
v_readfirstlane_b32 s99, v254
s_branch L2_chk
L2_tail_1_7:
s_waitcnt lgkmcnt(4)
v_mfma_f32_16x16x32_bf16 a[0:3], v[224:227], v[160:163], a[0:3]
ds_read_b128 v[240:243], v248 offset:2048
v_mfma_f32_16x16x32_bf16 a[0:3], v[228:231], v[176:179], a[0:3]
s_lshl_b32 s36, s34, 13
v_mfma_f32_16x16x32_bf16 a[4:7], v[224:227], v[164:167], a[4:7]
s_add_u32 s56, s4, 0x1000000
s_addc_u32 s57, s5, 0
v_mfma_f32_16x16x32_bf16 a[4:7], v[228:231], v[180:183], a[4:7]
s_add_u32 s36, s36, 0x20000
s_mov_b32 s58, 0x6c02000
v_mfma_f32_16x16x32_bf16 a[8:11], v[224:227], v[168:171], a[8:11]
ds_read_b128 v[244:247], v248 offset:2560
s_mov_b32 s59, 0x00020000
v_mfma_f32_16x16x32_bf16 a[8:11], v[228:231], v[184:187], a[8:11]
v_add_u32 v255, s36, v252
s_lshr_b32 s35, s2, 1
v_mfma_f32_16x16x32_bf16 a[12:15], v[224:227], v[172:175], a[12:15]
s_and_b32 s35, s35, 28
s_add_u32 s35, s35, s34
v_mfma_f32_16x16x32_bf16 a[12:15], v[228:231], v[188:191], a[12:15]
s_waitcnt lgkmcnt(2)
s_lshl_b32 s35, s35, 13
v_mfma_f32_16x16x32_bf16 a[16:19], v[232:235], v[160:163], a[16:19]
ds_read_b128 v[224:227], v248 offset:6144
v_lshlrev_b32 v253, 3, v252
v_mfma_f32_16x16x32_bf16 a[16:19], v[236:239], v[176:179], a[16:19]
buffer_load_dword v253, v253, s[56:59], s35 offen
ds_write_b128 v255, v[160:163] offset:0
v_mfma_f32_16x16x32_bf16 a[20:23], v[232:235], v[164:167], a[20:23]
v_exp_f32 v192, v192
v_mfma_f32_16x16x32_bf16 a[20:23], v[236:239], v[180:183], a[20:23]
v_exp_f32 v193, v193
v_mfma_f32_16x16x32_bf16 a[24:27], v[232:235], v[168:171], a[24:27]
ds_read_b128 v[228:231], v248 offset:6656
v_cvt_pk_bf16_f32 v128, v192, v193
v_mfma_f32_16x16x32_bf16 a[24:27], v[236:239], v[184:187], a[24:27]
v_exp_f32 v194, v194
v_mfma_f32_16x16x32_bf16 a[28:31], v[232:235], v[172:175], a[28:31]
v_exp_f32 v195, v195
v_mfma_f32_16x16x32_bf16 a[28:31], v[236:239], v[188:191], a[28:31]
s_waitcnt lgkmcnt(3)
v_cvt_pk_bf16_f32 v129, v194, v195
v_mfma_f32_16x16x32_bf16 v[208:211], v[240:243], v[0:3], 0
ds_read_b128 v[232:235], v248 offset:10240
ds_write_b128 v255, v[164:167] offset:1024
v_mfma_f32_16x16x32_bf16 v[208:211], v[244:247], v[4:7], v[208:211]
v_exp_f32 v196, v196
v_mfma_f32_16x16x32_bf16 v[212:215], v[240:243], v[32:35], 0
v_exp_f32 v197, v197
v_mfma_f32_16x16x32_bf16 v[212:215], v[244:247], v[36:39], v[212:215]
v_exp_f32 v198, v198
v_mfma_f32_16x16x32_bf16 v[216:219], v[240:243], v[64:67], 0
ds_read_b128 v[236:239], v248 offset:10752
v_cvt_pk_bf16_f32 v132, v196, v197
v_mfma_f32_16x16x32_bf16 v[216:219], v[244:247], v[68:71], v[216:219]
v_exp_f32 v199, v199
v_mfma_f32_16x16x32_bf16 v[220:223], v[240:243], v[96:99], 0
v_exp_f32 v200, v200
v_mfma_f32_16x16x32_bf16 v[220:223], v[244:247], v[100:103], v[220:223]
s_waitcnt lgkmcnt(3)
v_cvt_pk_bf16_f32 v133, v198, v199
v_mfma_f32_16x16x32_bf16 v[208:211], v[224:227], v[8:11], v[208:211]
ds_read_b128 v[240:243], v248 offset:14336
ds_write_b128 v255, v[168:171] offset:2048
v_mfma_f32_16x16x32_bf16 v[208:211], v[228:231], v[12:15], v[208:211]
v_exp_f32 v201, v201
v_mfma_f32_16x16x32_bf16 v[212:215], v[224:227], v[40:43], v[212:215]
v_exp_f32 v202, v202
v_mfma_f32_16x16x32_bf16 v[212:215], v[228:231], v[44:47], v[212:215]
v_exp_f32 v203, v203
v_mfma_f32_16x16x32_bf16 v[216:219], v[224:227], v[72:75], v[216:219]
ds_read_b128 v[244:247], v248 offset:14848
v_cvt_pk_bf16_f32 v136, v200, v201
v_mfma_f32_16x16x32_bf16 v[216:219], v[228:231], v[76:79], v[216:219]
v_cvt_pk_bf16_f32 v137, v202, v203
ds_write_b128 v255, v[172:175] offset:3072
v_mfma_f32_16x16x32_bf16 v[220:223], v[224:227], v[104:107], v[220:223]
v_exp_f32 v204, v204
v_mfma_f32_16x16x32_bf16 v[220:223], v[228:231], v[108:111], v[220:223]
s_waitcnt lgkmcnt(4)
s_waitcnt vmcnt(1)
s_barrier
v_mfma_f32_16x16x32_bf16 v[208:211], v[232:235], v[16:19], v[208:211]
ds_read_b128 v[224:227], v248 offset:16384
s_add_u32 m0, s30, 0xc000
v_mfma_f32_16x16x32_bf16 v[208:211], v[236:239], v[20:23], v[208:211]
s_and_b32 s100, s30, 0x10000
buffer_load_dwordx4 v251, s[12:15], s28 offen offset:0 lds
v_mfma_f32_16x16x32_bf16 v[212:215], v[232:235], v[48:51], v[212:215]
s_xor_b32 s100, s100, 0x10000
ds_write_b128 v255, v[176:179] offset:4096
v_mfma_f32_16x16x32_bf16 v[212:215], v[236:239], v[52:55], v[212:215]
s_mov_b32 s99, 0
buffer_load_dwordx4 v251, s[12:15], s28 offen offset:1024 lds
v_mfma_f32_16x16x32_bf16 v[216:219], v[232:235], v[80:83], v[216:219]
ds_read_b128 v[228:231], v248 offset:16896
ds_write_b128 v255, v[180:183] offset:5120
v_mfma_f32_16x16x32_bf16 v[216:219], v[236:239], v[84:87], v[216:219]
v_exp_f32 v205, v205
v_mfma_f32_16x16x32_bf16 v[220:223], v[232:235], v[112:115], v[220:223]
v_exp_f32 v206, v206
v_mfma_f32_16x16x32_bf16 v[220:223], v[236:239], v[116:119], v[220:223]
s_waitcnt lgkmcnt(5)
v_cvt_pk_bf16_f32 v140, v204, v205
v_mfma_f32_16x16x32_bf16 v[208:211], v[240:243], v[24:27], v[208:211]
ds_read_b128 v[232:235], v248 offset:20480
buffer_load_dwordx4 v251, s[12:15], s28 offen offset:2048 lds
v_mfma_f32_16x16x32_bf16 v[208:211], v[244:247], v[28:31], v[208:211]
v_exp_f32 v207, v207
v_mfma_f32_16x16x32_bf16 v[212:215], v[240:243], v[56:59], v[212:215]
buffer_load_dwordx4 v251, s[12:15], s28 offen offset:3072 lds
ds_write_b128 v255, v[184:187] offset:6144
v_mfma_f32_16x16x32_bf16 v[212:215], v[244:247], v[60:63], v[212:215]
ds_write_b128 v255, v[188:191] offset:7168
v_mfma_f32_16x16x32_bf16 v[216:219], v[240:243], v[88:91], v[216:219]
ds_read_b128 v[236:239], v248 offset:20992
v_cvt_pk_bf16_f32 v141, v206, v207
v_mfma_f32_16x16x32_bf16 v[216:219], v[244:247], v[92:95], v[216:219]
s_add_u32 s28, s28, 0x4000
s_xor_b32 s30, s30, 0x10000
v_mfma_f32_16x16x32_bf16 v[220:223], v[240:243], v[120:123], v[220:223]
s_add_u32 m0, s30, 0x0
v_mfma_f32_16x16x32_bf16 v[220:223], v[244:247], v[124:127], v[220:223]
s_waitcnt lgkmcnt(5)
buffer_load_dwordx4 v251, s[12:15], s28 offen offset:0 lds
v_mfma_f32_16x16x32_bf16 v[192:195], v[224:227], v[0:3], 0
ds_read_b128 v[240:243], v248 offset:24576
v_mfma_f32_16x16x32_bf16 v[192:195], v[228:231], v[4:7], v[192:195]
v_exp_f32 v208, v208
v_mfma_f32_16x16x32_bf16 v[196:199], v[224:227], v[32:35], 0
v_exp_f32 v209, v209
v_mfma_f32_16x16x32_bf16 v[196:199], v[228:231], v[36:39], v[196:199]
v_exp_f32 v210, v210
v_mfma_f32_16x16x32_bf16 v[200:203], v[224:227], v[64:67], 0
ds_read_b128 v[244:247], v248 offset:25088
v_cvt_pk_bf16_f32 v130, v208, v209
v_mfma_f32_16x16x32_bf16 v[200:203], v[228:231], v[68:71], v[200:203]
v_exp_f32 v211, v211
v_mfma_f32_16x16x32_bf16 v[204:207], v[224:227], v[96:99], 0
v_exp_f32 v212, v212
v_mfma_f32_16x16x32_bf16 v[204:207], v[228:231], v[100:103], v[204:207]
s_waitcnt lgkmcnt(2)
v_cvt_pk_bf16_f32 v131, v210, v211
v_mfma_f32_16x16x32_bf16 v[192:195], v[232:235], v[8:11], v[192:195]
ds_read_b128 v[224:227], v248 offset:28672
buffer_load_dwordx4 v251, s[12:15], s28 offen offset:1024 lds
v_mfma_f32_16x16x32_bf16 v[192:195], v[236:239], v[12:15], v[192:195]
v_exp_f32 v213, v213
v_mfma_f32_16x16x32_bf16 v[196:199], v[232:235], v[40:43], v[196:199]
v_exp_f32 v214, v214
v_mfma_f32_16x16x32_bf16 v[196:199], v[236:239], v[44:47], v[196:199]
v_exp_f32 v215, v215
v_mfma_f32_16x16x32_bf16 v[200:203], v[232:235], v[72:75], v[200:203]
ds_read_b128 v[228:231], v248 offset:29184
v_cvt_pk_bf16_f32 v134, v212, v213
v_mfma_f32_16x16x32_bf16 v[200:203], v[236:239], v[76:79], v[200:203]
v_cvt_pk_bf16_f32 v135, v214, v215
buffer_load_dwordx4 v251, s[12:15], s28 offen offset:2048 lds
v_mfma_f32_16x16x32_bf16 v[204:207], v[232:235], v[104:107], v[204:207]
v_exp_f32 v216, v216
v_mfma_f32_16x16x32_bf16 v[204:207], v[236:239], v[108:111], v[204:207]
s_waitcnt lgkmcnt(2)
buffer_load_dwordx4 v251, s[12:15], s28 offen offset:3072 lds
v_mfma_f32_16x16x32_bf16 v[192:195], v[240:243], v[16:19], v[192:195]
ds_read_b128 v[232:235], v248 offset:18432
v_mfma_f32_16x16x32_bf16 v[192:195], v[244:247], v[20:23], v[192:195]
v_exp_f32 v217, v217
v_mfma_f32_16x16x32_bf16 v[196:199], v[240:243], v[48:51], v[196:199]
v_exp_f32 v218, v218
v_mfma_f32_16x16x32_bf16 v[196:199], v[244:247], v[52:55], v[196:199]
v_exp_f32 v219, v219
v_mfma_f32_16x16x32_bf16 v[200:203], v[240:243], v[80:83], v[200:203]
ds_read_b128 v[236:239], v248 offset:18944
v_cvt_pk_bf16_f32 v138, v216, v217
v_mfma_f32_16x16x32_bf16 v[200:203], v[244:247], v[84:87], v[200:203]
v_cvt_pk_bf16_f32 v139, v218, v219
s_add_u32 s28, s28, 0x4000
v_mfma_f32_16x16x32_bf16 v[204:207], v[240:243], v[112:115], v[204:207]
v_exp_f32 v220, v220
v_mfma_f32_16x16x32_bf16 v[204:207], v[244:247], v[116:119], v[204:207]
s_waitcnt lgkmcnt(2)
v_mfma_f32_16x16x32_bf16 v[192:195], v[224:227], v[24:27], v[192:195]
ds_read_b128 v[240:243], v248 offset:22528
v_mfma_f32_16x16x32_bf16 v[192:195], v[228:231], v[28:31], v[192:195]
v_exp_f32 v221, v221
v_mfma_f32_16x16x32_bf16 v[196:199], v[224:227], v[56:59], v[196:199]
v_exp_f32 v222, v222
v_mfma_f32_16x16x32_bf16 v[196:199], v[228:231], v[60:63], v[196:199]
v_exp_f32 v223, v223
v_mfma_f32_16x16x32_bf16 v[200:203], v[224:227], v[88:91], v[200:203]
ds_read_b128 v[244:247], v248 offset:23040
v_cvt_pk_bf16_f32 v142, v220, v221
v_mfma_f32_16x16x32_bf16 v[200:203], v[228:231], v[92:95], v[200:203]
v_cvt_pk_bf16_f32 v143, v222, v223
v_mfma_f32_16x16x32_bf16 v[204:207], v[224:227], v[120:123], v[204:207]
v_mfma_f32_16x16x32_bf16 v[204:207], v[228:231], v[124:127], v[204:207]
s_waitcnt lgkmcnt(2)
v_mfma_f32_16x16x32_bf16 v[208:211], v[232:235], v[0:3], 0
ds_read_b128 v[224:227], v248 offset:26624
v_mfma_f32_16x16x32_bf16 v[208:211], v[236:239], v[4:7], v[208:211]
v_exp_f32 v192, v192
v_mfma_f32_16x16x32_bf16 v[212:215], v[232:235], v[32:35], 0
v_exp_f32 v193, v193
v_mfma_f32_16x16x32_bf16 v[212:215], v[236:239], v[36:39], v[212:215]
v_exp_f32 v194, v194
v_mfma_f32_16x16x32_bf16 v[216:219], v[232:235], v[64:67], 0
ds_read_b128 v[228:231], v248 offset:27136
v_cvt_pk_bf16_f32 v144, v192, v193
v_mfma_f32_16x16x32_bf16 v[216:219], v[236:239], v[68:71], v[216:219]
v_exp_f32 v195, v195
v_mfma_f32_16x16x32_bf16 v[220:223], v[232:235], v[96:99], 0
v_exp_f32 v196, v196
v_mfma_f32_16x16x32_bf16 v[220:223], v[236:239], v[100:103], v[220:223]
s_waitcnt lgkmcnt(2)
v_cvt_pk_bf16_f32 v145, v194, v195
v_mfma_f32_16x16x32_bf16 v[208:211], v[240:243], v[8:11], v[208:211]
ds_read_b128 v[232:235], v248 offset:30720
v_mfma_f32_16x16x32_bf16 v[208:211], v[244:247], v[12:15], v[208:211]
v_exp_f32 v197, v197
v_mfma_f32_16x16x32_bf16 v[212:215], v[240:243], v[40:43], v[212:215]
v_exp_f32 v198, v198
v_mfma_f32_16x16x32_bf16 v[212:215], v[244:247], v[44:47], v[212:215]
v_exp_f32 v199, v199
v_mfma_f32_16x16x32_bf16 v[216:219], v[240:243], v[72:75], v[216:219]
ds_read_b128 v[236:239], v248 offset:31232
v_cvt_pk_bf16_f32 v148, v196, v197
v_mfma_f32_16x16x32_bf16 v[216:219], v[244:247], v[76:79], v[216:219]
v_cvt_pk_bf16_f32 v149, v198, v199
v_mfma_f32_16x16x32_bf16 v[220:223], v[240:243], v[104:107], v[220:223]
v_exp_f32 v200, v200
v_mfma_f32_16x16x32_bf16 v[220:223], v[244:247], v[108:111], v[220:223]
s_waitcnt lgkmcnt(2)
v_mfma_f32_16x16x32_bf16 v[208:211], v[224:227], v[16:19], v[208:211]
ds_read_b128 v[240:243], v248 offset:32768
v_mfma_f32_16x16x32_bf16 v[208:211], v[228:231], v[20:23], v[208:211]
v_exp_f32 v201, v201
v_mfma_f32_16x16x32_bf16 v[212:215], v[224:227], v[48:51], v[212:215]
v_exp_f32 v202, v202
v_mfma_f32_16x16x32_bf16 v[212:215], v[228:231], v[52:55], v[212:215]
v_exp_f32 v203, v203
v_mfma_f32_16x16x32_bf16 v[216:219], v[224:227], v[80:83], v[216:219]
ds_read_b128 v[244:247], v248 offset:33280
v_cvt_pk_bf16_f32 v152, v200, v201
v_mfma_f32_16x16x32_bf16 v[216:219], v[228:231], v[84:87], v[216:219]
v_cvt_pk_bf16_f32 v153, v202, v203
v_mfma_f32_16x16x32_bf16 v[220:223], v[224:227], v[112:115], v[220:223]
v_exp_f32 v204, v204
v_mfma_f32_16x16x32_bf16 v[220:223], v[228:231], v[116:119], v[220:223]
s_waitcnt lgkmcnt(2)
v_mfma_f32_16x16x32_bf16 v[208:211], v[232:235], v[24:27], v[208:211]
ds_read_b128 v[224:227], v248 offset:36864
v_mfma_f32_16x16x32_bf16 v[208:211], v[236:239], v[28:31], v[208:211]
v_exp_f32 v205, v205
v_mfma_f32_16x16x32_bf16 v[212:215], v[232:235], v[56:59], v[212:215]
v_exp_f32 v206, v206
v_mfma_f32_16x16x32_bf16 v[212:215], v[236:239], v[60:63], v[212:215]
v_exp_f32 v207, v207
v_mfma_f32_16x16x32_bf16 v[216:219], v[232:235], v[88:91], v[216:219]
ds_read_b128 v[228:231], v248 offset:37376
v_cvt_pk_bf16_f32 v156, v204, v205
v_mfma_f32_16x16x32_bf16 v[216:219], v[236:239], v[92:95], v[216:219]
v_cvt_pk_bf16_f32 v157, v206, v207
v_mfma_f32_16x16x32_bf16 v[220:223], v[232:235], v[120:123], v[220:223]
v_mfma_f32_16x16x32_bf16 v[220:223], v[236:239], v[124:127], v[220:223]
s_waitcnt lgkmcnt(2)
v_mfma_f32_16x16x32_bf16 v[192:195], v[240:243], v[0:3], 0
ds_read_b128 v[232:235], v248 offset:40960
v_mfma_f32_16x16x32_bf16 v[192:195], v[244:247], v[4:7], v[192:195]
v_exp_f32 v208, v208
v_mfma_f32_16x16x32_bf16 v[196:199], v[240:243], v[32:35], 0
v_exp_f32 v209, v209
v_mfma_f32_16x16x32_bf16 v[196:199], v[244:247], v[36:39], v[196:199]
v_exp_f32 v210, v210
v_mfma_f32_16x16x32_bf16 v[200:203], v[240:243], v[64:67], 0
ds_read_b128 v[236:239], v248 offset:41472
v_cvt_pk_bf16_f32 v146, v208, v209
v_mfma_f32_16x16x32_bf16 v[200:203], v[244:247], v[68:71], v[200:203]
v_exp_f32 v211, v211
v_mfma_f32_16x16x32_bf16 v[204:207], v[240:243], v[96:99], 0
v_exp_f32 v212, v212
v_mfma_f32_16x16x32_bf16 v[204:207], v[244:247], v[100:103], v[204:207]
s_waitcnt lgkmcnt(2)
v_cvt_pk_bf16_f32 v147, v210, v211
v_mfma_f32_16x16x32_bf16 v[192:195], v[224:227], v[8:11], v[192:195]
ds_read_b128 v[240:243], v248 offset:45056
v_mfma_f32_16x16x32_bf16 v[192:195], v[228:231], v[12:15], v[192:195]
v_exp_f32 v213, v213
v_mfma_f32_16x16x32_bf16 v[196:199], v[224:227], v[40:43], v[196:199]
v_exp_f32 v214, v214
v_mfma_f32_16x16x32_bf16 v[196:199], v[228:231], v[44:47], v[196:199]
v_exp_f32 v215, v215
v_mfma_f32_16x16x32_bf16 v[200:203], v[224:227], v[72:75], v[200:203]
ds_read_b128 v[244:247], v248 offset:45568
v_cvt_pk_bf16_f32 v150, v212, v213
v_mfma_f32_16x16x32_bf16 v[200:203], v[228:231], v[76:79], v[200:203]
v_cvt_pk_bf16_f32 v151, v214, v215
v_mfma_f32_16x16x32_bf16 v[204:207], v[224:227], v[104:107], v[204:207]
v_exp_f32 v216, v216
v_mfma_f32_16x16x32_bf16 v[204:207], v[228:231], v[108:111], v[204:207]
s_waitcnt lgkmcnt(2)
v_mfma_f32_16x16x32_bf16 v[192:195], v[232:235], v[16:19], v[192:195]
ds_read_b128 v[224:227], v248 offset:34816
v_mfma_f32_16x16x32_bf16 v[192:195], v[236:239], v[20:23], v[192:195]
v_exp_f32 v217, v217
v_mfma_f32_16x16x32_bf16 v[196:199], v[232:235], v[48:51], v[196:199]
v_exp_f32 v218, v218
v_mfma_f32_16x16x32_bf16 v[196:199], v[236:239], v[52:55], v[196:199]
v_exp_f32 v219, v219
v_mfma_f32_16x16x32_bf16 v[200:203], v[232:235], v[80:83], v[200:203]
ds_read_b128 v[228:231], v248 offset:35328
v_cvt_pk_bf16_f32 v154, v216, v217
v_mfma_f32_16x16x32_bf16 v[200:203], v[236:239], v[84:87], v[200:203]
v_cvt_pk_bf16_f32 v155, v218, v219
v_mfma_f32_16x16x32_bf16 v[204:207], v[232:235], v[112:115], v[204:207]
v_exp_f32 v220, v220
v_mfma_f32_16x16x32_bf16 v[204:207], v[236:239], v[116:119], v[204:207]
s_waitcnt lgkmcnt(2)
v_mfma_f32_16x16x32_bf16 v[192:195], v[240:243], v[24:27], v[192:195]
ds_read_b128 v[232:235], v248 offset:38912
v_mfma_f32_16x16x32_bf16 v[192:195], v[244:247], v[28:31], v[192:195]
v_exp_f32 v221, v221
v_mfma_f32_16x16x32_bf16 v[196:199], v[240:243], v[56:59], v[196:199]
v_exp_f32 v222, v222
v_mfma_f32_16x16x32_bf16 v[196:199], v[244:247], v[60:63], v[196:199]
v_exp_f32 v223, v223
v_mfma_f32_16x16x32_bf16 v[200:203], v[240:243], v[88:91], v[200:203]
ds_read_b128 v[236:239], v248 offset:39424
v_cvt_pk_bf16_f32 v158, v220, v221
v_mfma_f32_16x16x32_bf16 v[200:203], v[244:247], v[92:95], v[200:203]
v_cvt_pk_bf16_f32 v159, v222, v223
v_mfma_f32_16x16x32_bf16 v[204:207], v[240:243], v[120:123], v[204:207]
v_mfma_f32_16x16x32_bf16 v[204:207], v[244:247], v[124:127], v[204:207]
s_waitcnt lgkmcnt(2)
v_mfma_f32_16x16x32_bf16 v[208:211], v[224:227], v[0:3], 0
ds_read_b128 v[240:243], v248 offset:43008
v_mfma_f32_16x16x32_bf16 v[208:211], v[228:231], v[4:7], v[208:211]
v_exp_f32 v192, v192
v_mfma_f32_16x16x32_bf16 v[212:215], v[224:227], v[32:35], 0
v_exp_f32 v193, v193
v_mfma_f32_16x16x32_bf16 v[212:215], v[228:231], v[36:39], v[212:215]
v_exp_f32 v194, v194
v_mfma_f32_16x16x32_bf16 v[216:219], v[224:227], v[64:67], 0
ds_read_b128 v[244:247], v248 offset:43520
v_cvt_pk_bf16_f32 v160, v192, v193
v_mfma_f32_16x16x32_bf16 v[216:219], v[228:231], v[68:71], v[216:219]
v_exp_f32 v195, v195
v_mfma_f32_16x16x32_bf16 v[220:223], v[224:227], v[96:99], 0
v_exp_f32 v196, v196
v_mfma_f32_16x16x32_bf16 v[220:223], v[228:231], v[100:103], v[220:223]
s_waitcnt lgkmcnt(2)
v_cvt_pk_bf16_f32 v161, v194, v195
v_mfma_f32_16x16x32_bf16 v[208:211], v[232:235], v[8:11], v[208:211]
ds_read_b128 v[224:227], v248 offset:47104
v_mfma_f32_16x16x32_bf16 v[208:211], v[236:239], v[12:15], v[208:211]
v_exp_f32 v197, v197
v_mfma_f32_16x16x32_bf16 v[212:215], v[232:235], v[40:43], v[212:215]
v_exp_f32 v198, v198
v_mfma_f32_16x16x32_bf16 v[212:215], v[236:239], v[44:47], v[212:215]
v_exp_f32 v199, v199
v_mfma_f32_16x16x32_bf16 v[216:219], v[232:235], v[72:75], v[216:219]
ds_read_b128 v[228:231], v248 offset:47616
v_cvt_pk_bf16_f32 v164, v196, v197
v_mfma_f32_16x16x32_bf16 v[216:219], v[236:239], v[76:79], v[216:219]
v_cvt_pk_bf16_f32 v165, v198, v199
v_mfma_f32_16x16x32_bf16 v[220:223], v[232:235], v[104:107], v[220:223]
v_exp_f32 v200, v200
v_mfma_f32_16x16x32_bf16 v[220:223], v[236:239], v[108:111], v[220:223]
s_waitcnt lgkmcnt(2)
s_waitcnt vmcnt(0)
s_barrier
v_mfma_f32_16x16x32_bf16 v[208:211], v[240:243], v[16:19], v[208:211]
ds_read_b128 v[232:235], v248 offset:49152
v_mfma_f32_16x16x32_bf16 v[208:211], v[244:247], v[20:23], v[208:211]
v_exp_f32 v201, v201
v_mfma_f32_16x16x32_bf16 v[212:215], v[240:243], v[48:51], v[212:215]
v_exp_f32 v202, v202
v_mfma_f32_16x16x32_bf16 v[212:215], v[244:247], v[52:55], v[212:215]
v_exp_f32 v203, v203
v_mfma_f32_16x16x32_bf16 v[216:219], v[240:243], v[80:83], v[216:219]
ds_read_b128 v[236:239], v248 offset:49664
v_cvt_pk_bf16_f32 v168, v200, v201
v_mfma_f32_16x16x32_bf16 v[216:219], v[244:247], v[84:87], v[216:219]
v_cvt_pk_bf16_f32 v169, v202, v203
v_mfma_f32_16x16x32_bf16 v[220:223], v[240:243], v[112:115], v[220:223]
v_exp_f32 v204, v204
v_mfma_f32_16x16x32_bf16 v[220:223], v[244:247], v[116:119], v[220:223]
s_waitcnt lgkmcnt(2)
v_mfma_f32_16x16x32_bf16 v[208:211], v[224:227], v[24:27], v[208:211]
ds_read_b128 v[240:243], v248 offset:53248
v_mfma_f32_16x16x32_bf16 v[208:211], v[228:231], v[28:31], v[208:211]
v_exp_f32 v205, v205
v_mfma_f32_16x16x32_bf16 v[212:215], v[224:227], v[56:59], v[212:215]
v_exp_f32 v206, v206
v_mfma_f32_16x16x32_bf16 v[212:215], v[228:231], v[60:63], v[212:215]
v_exp_f32 v207, v207
v_mfma_f32_16x16x32_bf16 v[216:219], v[224:227], v[88:91], v[216:219]
ds_read_b128 v[244:247], v248 offset:53760
v_cvt_pk_bf16_f32 v172, v204, v205
v_mfma_f32_16x16x32_bf16 v[216:219], v[228:231], v[92:95], v[216:219]
v_cvt_pk_bf16_f32 v173, v206, v207
v_mfma_f32_16x16x32_bf16 v[220:223], v[224:227], v[120:123], v[220:223]
v_mfma_f32_16x16x32_bf16 v[220:223], v[228:231], v[124:127], v[220:223]
s_waitcnt lgkmcnt(2)
v_mfma_f32_16x16x32_bf16 v[192:195], v[232:235], v[0:3], 0
ds_read_b128 v[224:227], v248 offset:57344
v_mfma_f32_16x16x32_bf16 v[192:195], v[236:239], v[4:7], v[192:195]
v_exp_f32 v208, v208
v_mfma_f32_16x16x32_bf16 v[196:199], v[232:235], v[32:35], 0
v_exp_f32 v209, v209
v_mfma_f32_16x16x32_bf16 v[196:199], v[236:239], v[36:39], v[196:199]
v_exp_f32 v210, v210
v_mfma_f32_16x16x32_bf16 v[200:203], v[232:235], v[64:67], 0
ds_read_b128 v[228:231], v248 offset:57856
v_cvt_pk_bf16_f32 v162, v208, v209
v_mfma_f32_16x16x32_bf16 v[200:203], v[236:239], v[68:71], v[200:203]
v_exp_f32 v211, v211
v_mfma_f32_16x16x32_bf16 v[204:207], v[232:235], v[96:99], 0
v_exp_f32 v212, v212
v_mfma_f32_16x16x32_bf16 v[204:207], v[236:239], v[100:103], v[204:207]
s_waitcnt lgkmcnt(2)
v_cvt_pk_bf16_f32 v163, v210, v211
v_mfma_f32_16x16x32_bf16 v[192:195], v[240:243], v[8:11], v[192:195]
ds_read_b128 v[232:235], v248 offset:61440
v_mfma_f32_16x16x32_bf16 v[192:195], v[244:247], v[12:15], v[192:195]
v_exp_f32 v213, v213
v_mfma_f32_16x16x32_bf16 v[196:199], v[240:243], v[40:43], v[196:199]
v_exp_f32 v214, v214
v_mfma_f32_16x16x32_bf16 v[196:199], v[244:247], v[44:47], v[196:199]
v_exp_f32 v215, v215
v_mfma_f32_16x16x32_bf16 v[200:203], v[240:243], v[72:75], v[200:203]
ds_read_b128 v[236:239], v248 offset:61952
v_cvt_pk_bf16_f32 v166, v212, v213
v_mfma_f32_16x16x32_bf16 v[200:203], v[244:247], v[76:79], v[200:203]
v_cvt_pk_bf16_f32 v167, v214, v215
v_mfma_f32_16x16x32_bf16 v[204:207], v[240:243], v[104:107], v[204:207]
v_exp_f32 v216, v216
v_mfma_f32_16x16x32_bf16 v[204:207], v[244:247], v[108:111], v[204:207]
s_waitcnt lgkmcnt(2)
v_mfma_f32_16x16x32_bf16 v[192:195], v[224:227], v[16:19], v[192:195]
ds_read_b128 v[240:243], v248 offset:51200
v_mfma_f32_16x16x32_bf16 v[192:195], v[228:231], v[20:23], v[192:195]
v_exp_f32 v217, v217
v_mfma_f32_16x16x32_bf16 v[196:199], v[224:227], v[48:51], v[196:199]
v_exp_f32 v218, v218
v_mfma_f32_16x16x32_bf16 v[196:199], v[228:231], v[52:55], v[196:199]
v_exp_f32 v219, v219
v_mfma_f32_16x16x32_bf16 v[200:203], v[224:227], v[80:83], v[200:203]
ds_read_b128 v[244:247], v248 offset:51712
v_cvt_pk_bf16_f32 v170, v216, v217
v_mfma_f32_16x16x32_bf16 v[200:203], v[228:231], v[84:87], v[200:203]
v_cvt_pk_bf16_f32 v171, v218, v219
v_mfma_f32_16x16x32_bf16 v[204:207], v[224:227], v[112:115], v[204:207]
v_exp_f32 v220, v220
v_mfma_f32_16x16x32_bf16 v[204:207], v[228:231], v[116:119], v[204:207]
s_waitcnt lgkmcnt(2)
v_mfma_f32_16x16x32_bf16 v[192:195], v[232:235], v[24:27], v[192:195]
ds_read_b128 v[224:227], v248 offset:55296
v_mfma_f32_16x16x32_bf16 v[192:195], v[236:239], v[28:31], v[192:195]
v_exp_f32 v221, v221
v_mfma_f32_16x16x32_bf16 v[196:199], v[232:235], v[56:59], v[196:199]
v_exp_f32 v222, v222
v_mfma_f32_16x16x32_bf16 v[196:199], v[236:239], v[60:63], v[196:199]
v_exp_f32 v223, v223
v_mfma_f32_16x16x32_bf16 v[200:203], v[232:235], v[88:91], v[200:203]
ds_read_b128 v[228:231], v248 offset:55808
v_cvt_pk_bf16_f32 v174, v220, v221
v_mfma_f32_16x16x32_bf16 v[200:203], v[236:239], v[92:95], v[200:203]
v_cvt_pk_bf16_f32 v175, v222, v223
v_mfma_f32_16x16x32_bf16 v[204:207], v[232:235], v[120:123], v[204:207]
v_mfma_f32_16x16x32_bf16 v[204:207], v[236:239], v[124:127], v[204:207]
s_waitcnt lgkmcnt(2)
v_mfma_f32_16x16x32_bf16 v[208:211], v[240:243], v[0:3], 0
ds_read_b128 v[232:235], v248 offset:59392
v_mfma_f32_16x16x32_bf16 v[208:211], v[244:247], v[4:7], v[208:211]
v_exp_f32 v192, v192
v_mfma_f32_16x16x32_bf16 v[212:215], v[240:243], v[32:35], 0
v_exp_f32 v193, v193
v_mfma_f32_16x16x32_bf16 v[212:215], v[244:247], v[36:39], v[212:215]
v_exp_f32 v194, v194
v_mfma_f32_16x16x32_bf16 v[216:219], v[240:243], v[64:67], 0
ds_read_b128 v[236:239], v248 offset:59904
v_cvt_pk_bf16_f32 v176, v192, v193
v_mfma_f32_16x16x32_bf16 v[216:219], v[244:247], v[68:71], v[216:219]
v_exp_f32 v195, v195
v_mfma_f32_16x16x32_bf16 v[220:223], v[240:243], v[96:99], 0
v_exp_f32 v196, v196
v_mfma_f32_16x16x32_bf16 v[220:223], v[244:247], v[100:103], v[220:223]
s_waitcnt lgkmcnt(2)
v_cvt_pk_bf16_f32 v177, v194, v195
v_mfma_f32_16x16x32_bf16 v[208:211], v[224:227], v[8:11], v[208:211]
ds_read_b128 v[240:243], v248 offset:63488
v_mfma_f32_16x16x32_bf16 v[208:211], v[228:231], v[12:15], v[208:211]
v_exp_f32 v197, v197
v_mfma_f32_16x16x32_bf16 v[212:215], v[224:227], v[40:43], v[212:215]
v_exp_f32 v198, v198
v_mfma_f32_16x16x32_bf16 v[212:215], v[228:231], v[44:47], v[212:215]
v_exp_f32 v199, v199
v_mfma_f32_16x16x32_bf16 v[216:219], v[224:227], v[72:75], v[216:219]
ds_read_b128 v[244:247], v248 offset:64000
v_cvt_pk_bf16_f32 v180, v196, v197
v_mfma_f32_16x16x32_bf16 v[216:219], v[228:231], v[76:79], v[216:219]
v_cvt_pk_bf16_f32 v181, v198, v199
v_mfma_f32_16x16x32_bf16 v[220:223], v[224:227], v[104:107], v[220:223]
v_exp_f32 v200, v200
v_mfma_f32_16x16x32_bf16 v[220:223], v[228:231], v[108:111], v[220:223]
s_waitcnt lgkmcnt(2)
v_xor_b32 v248, 0x10000, v248
v_mfma_f32_16x16x32_bf16 v[208:211], v[232:235], v[16:19], v[208:211]
ds_read_b128 v[224:227], v248 offset:0
v_mfma_f32_16x16x32_bf16 v[208:211], v[236:239], v[20:23], v[208:211]
v_exp_f32 v201, v201
v_mfma_f32_16x16x32_bf16 v[212:215], v[232:235], v[48:51], v[212:215]
v_exp_f32 v202, v202
v_mfma_f32_16x16x32_bf16 v[212:215], v[236:239], v[52:55], v[212:215]
v_exp_f32 v203, v203
v_mfma_f32_16x16x32_bf16 v[216:219], v[232:235], v[80:83], v[216:219]
ds_read_b128 v[228:231], v248 offset:512
v_cvt_pk_bf16_f32 v184, v200, v201
v_mfma_f32_16x16x32_bf16 v[216:219], v[236:239], v[84:87], v[216:219]
v_cvt_pk_bf16_f32 v185, v202, v203
v_mfma_f32_16x16x32_bf16 v[220:223], v[232:235], v[112:115], v[220:223]
v_exp_f32 v204, v204
v_mfma_f32_16x16x32_bf16 v[220:223], v[236:239], v[116:119], v[220:223]
s_waitcnt lgkmcnt(2)
v_mfma_f32_16x16x32_bf16 v[208:211], v[240:243], v[24:27], v[208:211]
ds_read_b128 v[232:235], v248 offset:4096
v_mfma_f32_16x16x32_bf16 v[208:211], v[244:247], v[28:31], v[208:211]
v_exp_f32 v205, v205
v_mfma_f32_16x16x32_bf16 v[212:215], v[240:243], v[56:59], v[212:215]
v_exp_f32 v206, v206
v_mfma_f32_16x16x32_bf16 v[212:215], v[244:247], v[60:63], v[212:215]
v_exp_f32 v207, v207
v_mfma_f32_16x16x32_bf16 v[216:219], v[240:243], v[88:91], v[216:219]
ds_read_b128 v[236:239], v248 offset:4608
v_cvt_pk_bf16_f32 v188, v204, v205
v_mfma_f32_16x16x32_bf16 v[216:219], v[244:247], v[92:95], v[216:219]
v_cvt_pk_bf16_f32 v189, v206, v207
v_mfma_f32_16x16x32_bf16 v[220:223], v[240:243], v[120:123], v[220:223]
v_mfma_f32_16x16x32_bf16 v[220:223], v[244:247], v[124:127], v[220:223]
s_waitcnt lgkmcnt(2)
v_mfma_f32_16x16x32_bf16 v[192:195], v[224:227], v[0:3], 0
ds_read_b128 v[240:243], v248 offset:8192
v_mfma_f32_16x16x32_bf16 v[192:195], v[228:231], v[4:7], v[192:195]
v_exp_f32 v208, v208
v_mfma_f32_16x16x32_bf16 v[196:199], v[224:227], v[32:35], 0
v_exp_f32 v209, v209
v_mfma_f32_16x16x32_bf16 v[196:199], v[228:231], v[36:39], v[196:199]
v_exp_f32 v210, v210
v_mfma_f32_16x16x32_bf16 v[200:203], v[224:227], v[64:67], 0
ds_read_b128 v[244:247], v248 offset:8704
v_cvt_pk_bf16_f32 v178, v208, v209
v_mfma_f32_16x16x32_bf16 v[200:203], v[228:231], v[68:71], v[200:203]
v_exp_f32 v211, v211
v_mfma_f32_16x16x32_bf16 v[204:207], v[224:227], v[96:99], 0
v_exp_f32 v212, v212
v_mfma_f32_16x16x32_bf16 v[204:207], v[228:231], v[100:103], v[204:207]
s_waitcnt lgkmcnt(2)
v_cvt_pk_bf16_f32 v179, v210, v211
v_mfma_f32_16x16x32_bf16 v[192:195], v[232:235], v[8:11], v[192:195]
ds_read_b128 v[224:227], v248 offset:12288
v_mfma_f32_16x16x32_bf16 v[192:195], v[236:239], v[12:15], v[192:195]
v_exp_f32 v213, v213
v_mfma_f32_16x16x32_bf16 v[196:199], v[232:235], v[40:43], v[196:199]
v_exp_f32 v214, v214
v_mfma_f32_16x16x32_bf16 v[196:199], v[236:239], v[44:47], v[196:199]
v_exp_f32 v215, v215
v_mfma_f32_16x16x32_bf16 v[200:203], v[232:235], v[72:75], v[200:203]
ds_read_b128 v[228:231], v248 offset:12800
v_cvt_pk_bf16_f32 v182, v212, v213
v_mfma_f32_16x16x32_bf16 v[200:203], v[236:239], v[76:79], v[200:203]
v_cvt_pk_bf16_f32 v183, v214, v215
v_mfma_f32_16x16x32_bf16 v[204:207], v[232:235], v[104:107], v[204:207]
v_exp_f32 v216, v216
v_mfma_f32_16x16x32_bf16 v[204:207], v[236:239], v[108:111], v[204:207]
s_waitcnt lgkmcnt(2)
v_mfma_f32_16x16x32_bf16 v[192:195], v[240:243], v[16:19], v[192:195]
ds_read_b128 v[232:235], v248 offset:2048
v_mfma_f32_16x16x32_bf16 v[192:195], v[244:247], v[20:23], v[192:195]
v_exp_f32 v217, v217
v_mfma_f32_16x16x32_bf16 v[196:199], v[240:243], v[48:51], v[196:199]
v_exp_f32 v218, v218
v_mfma_f32_16x16x32_bf16 v[196:199], v[244:247], v[52:55], v[196:199]
v_exp_f32 v219, v219
v_mfma_f32_16x16x32_bf16 v[200:203], v[240:243], v[80:83], v[200:203]
ds_read_b128 v[236:239], v248 offset:2560
v_cvt_pk_bf16_f32 v186, v216, v217
v_mfma_f32_16x16x32_bf16 v[200:203], v[244:247], v[84:87], v[200:203]
v_cvt_pk_bf16_f32 v187, v218, v219
v_mfma_f32_16x16x32_bf16 v[204:207], v[240:243], v[112:115], v[204:207]
v_exp_f32 v220, v220
v_mfma_f32_16x16x32_bf16 v[204:207], v[244:247], v[116:119], v[204:207]
s_waitcnt lgkmcnt(2)
v_mfma_f32_16x16x32_bf16 v[192:195], v[224:227], v[24:27], v[192:195]
ds_read_b128 v[240:243], v248 offset:6144
v_mfma_f32_16x16x32_bf16 v[192:195], v[228:231], v[28:31], v[192:195]
v_exp_f32 v221, v221
v_mfma_f32_16x16x32_bf16 v[196:199], v[224:227], v[56:59], v[196:199]
v_exp_f32 v222, v222
v_mfma_f32_16x16x32_bf16 v[196:199], v[228:231], v[60:63], v[196:199]
v_exp_f32 v223, v223
v_mfma_f32_16x16x32_bf16 v[200:203], v[224:227], v[88:91], v[200:203]
ds_read_b128 v[244:247], v248 offset:6656
v_cvt_pk_bf16_f32 v190, v220, v221
v_mfma_f32_16x16x32_bf16 v[200:203], v[228:231], v[92:95], v[200:203]
v_cvt_pk_bf16_f32 v191, v222, v223
v_mfma_f32_16x16x32_bf16 v[204:207], v[224:227], v[120:123], v[204:207]
v_mfma_f32_16x16x32_bf16 v[204:207], v[228:231], v[124:127], v[204:207]
s_waitcnt lgkmcnt(2)
v_mfma_f32_16x16x32_bf16 v[208:211], v[232:235], v[0:3], 0
ds_read_b128 v[224:227], v248 offset:10240
v_mfma_f32_16x16x32_bf16 v[208:211], v[236:239], v[4:7], v[208:211]
v_exp_f32 v192, v192
v_mfma_f32_16x16x32_bf16 v[212:215], v[232:235], v[32:35], 0
v_exp_f32 v193, v193
v_mfma_f32_16x16x32_bf16 v[212:215], v[236:239], v[36:39], v[212:215]
v_exp_f32 v194, v194
v_mfma_f32_16x16x32_bf16 v[216:219], v[232:235], v[64:67], 0
ds_read_b128 v[228:231], v248 offset:10752
v_cvt_pk_bf16_f32 v0, v192, v193
v_mfma_f32_16x16x32_bf16 v[216:219], v[236:239], v[68:71], v[216:219]
v_exp_f32 v195, v195
v_mfma_f32_16x16x32_bf16 v[220:223], v[232:235], v[96:99], 0
v_exp_f32 v196, v196
v_mfma_f32_16x16x32_bf16 v[220:223], v[236:239], v[100:103], v[220:223]
s_waitcnt lgkmcnt(2)
v_cvt_pk_bf16_f32 v1, v194, v195
v_mfma_f32_16x16x32_bf16 v[208:211], v[240:243], v[8:11], v[208:211]
ds_read_b128 v[232:235], v248 offset:14336
v_mfma_f32_16x16x32_bf16 v[208:211], v[244:247], v[12:15], v[208:211]
v_exp_f32 v197, v197
v_mfma_f32_16x16x32_bf16 v[212:215], v[240:243], v[40:43], v[212:215]
ds_read_b128 v[4:7], v255 offset:0
ds_read_b128 v[36:39], v255 offset:1024
v_mfma_f32_16x16x32_bf16 v[212:215], v[244:247], v[44:47], v[212:215]
v_exp_f32 v198, v198
v_mfma_f32_16x16x32_bf16 v[216:219], v[240:243], v[72:75], v[216:219]
ds_read_b128 v[236:239], v248 offset:14848
v_xor_b32 v12, 0x10000, v249
v_mfma_f32_16x16x32_bf16 v[216:219], v[244:247], v[76:79], v[216:219]
v_xor_b32 v13, 0x10000, v250
v_cvt_pk_bf16_f32 v32, v196, v197
v_mfma_f32_16x16x32_bf16 v[220:223], v[240:243], v[104:107], v[220:223]
ds_read_b128 v[68:71], v255 offset:2048
ds_read_b128 v[100:103], v255 offset:3072
v_mfma_f32_16x16x32_bf16 v[220:223], v[244:247], v[108:111], v[220:223]
s_waitcnt lgkmcnt(6)
v_mfma_f32_16x16x32_bf16 v[208:211], v[224:227], v[16:19], v[208:211]
ds_read_b64_tr_b16 v[240:241], v12 offset:0
ds_read_b64_tr_b16 v[242:243], v12 offset:2048
v_mfma_f32_16x16x32_bf16 v[208:211], v[228:231], v[20:23], v[208:211]
v_exp_f32 v199, v199
v_mfma_f32_16x16x32_bf16 v[212:215], v[224:227], v[48:51], v[212:215]
ds_read_b128 v[8:11], v255 offset:4096
ds_read_b128 v[40:43], v255 offset:5120
v_mfma_f32_16x16x32_bf16 v[212:215], v[228:231], v[52:55], v[212:215]
v_cvt_pk_bf16_f32 v33, v198, v199
v_mfma_f32_16x16x32_bf16 v[216:219], v[224:227], v[80:83], v[216:219]
ds_read_b64_tr_b16 v[244:245], v12 offset:16384
ds_read_b64_tr_b16 v[246:247], v12 offset:18432
v_mfma_f32_16x16x32_bf16 v[216:219], v[228:231], v[84:87], v[216:219]
v_exp_f32 v200, v200
v_mfma_f32_16x16x32_bf16 v[220:223], v[224:227], v[112:115], v[220:223]
ds_read_b128 v[72:75], v255 offset:6144
ds_read_b128 v[104:107], v255 offset:7168
v_mfma_f32_16x16x32_bf16 v[220:223], v[228:231], v[116:119], v[220:223]
s_waitcnt lgkmcnt(10)
v_mfma_f32_16x16x32_bf16 v[208:211], v[232:235], v[24:27], v[208:211]
ds_read_b64_tr_b16 v[224:225], v12 offset:32768
ds_read_b64_tr_b16 v[226:227], v12 offset:34816
v_mfma_f32_16x16x32_bf16 v[208:211], v[236:239], v[28:31], v[208:211]
v_exp_f32 v201, v201
v_mfma_f32_16x16x32_bf16 v[212:215], v[232:235], v[56:59], v[212:215]
v_exp_f32 v202, v202
v_mfma_f32_16x16x32_bf16 v[212:215], v[236:239], v[60:63], v[212:215]
v_exp_f32 v203, v203
v_mfma_f32_16x16x32_bf16 v[216:219], v[232:235], v[88:91], v[216:219]
ds_read_b64_tr_b16 v[228:229], v12 offset:49152
ds_read_b64_tr_b16 v[230:231], v12 offset:51200
v_mfma_f32_16x16x32_bf16 v[216:219], v[236:239], v[92:95], v[216:219]
v_cvt_pk_bf16_f32 v64, v200, v201
v_cvt_pk_bf16_f32 v65, v202, v203
v_mfma_f32_16x16x32_bf16 v[220:223], v[232:235], v[120:123], v[220:223]
v_exp_f32 v204, v204
v_mfma_f32_16x16x32_bf16 v[220:223], v[236:239], v[124:127], v[220:223]
s_waitcnt lgkmcnt(6)
s_waitcnt lgkmcnt(4)
v_mfma_f32_16x16x32_bf16 a[0:3], v[240:243], v[128:131], a[0:3]
ds_read_b64_tr_b16 v[232:233], v13 offset:0
ds_read_b64_tr_b16 v[234:235], v13 offset:2048
v_mfma_f32_16x16x32_bf16 a[0:3], v[244:247], v[144:147], a[0:3]
v_exp_f32 v205, v205
v_mfma_f32_16x16x32_bf16 a[4:7], v[240:243], v[132:135], a[4:7]
v_exp_f32 v206, v206
v_mfma_f32_16x16x32_bf16 a[4:7], v[244:247], v[148:151], a[4:7]
v_exp_f32 v207, v207
v_mfma_f32_16x16x32_bf16 a[8:11], v[240:243], v[136:139], a[8:11]
ds_read_b64_tr_b16 v[236:237], v13 offset:16384
ds_read_b64_tr_b16 v[238:239], v13 offset:18432
v_mfma_f32_16x16x32_bf16 a[8:11], v[244:247], v[152:155], a[8:11]
v_cvt_pk_bf16_f32 v96, v204, v205
v_cvt_pk_bf16_f32 v97, v206, v207
v_mfma_f32_16x16x32_bf16 a[12:15], v[240:243], v[140:143], a[12:15]
v_exp_f32 v208, v208
v_mfma_f32_16x16x32_bf16 a[12:15], v[244:247], v[156:159], a[12:15]
s_waitcnt lgkmcnt(4)
v_mfma_f32_16x16x32_bf16 a[0:3], v[224:227], v[160:163], a[0:3]
ds_read_b64_tr_b16 v[240:241], v13 offset:32768
ds_read_b64_tr_b16 v[242:243], v13 offset:34816
v_mfma_f32_16x16x32_bf16 a[0:3], v[228:231], v[176:179], a[0:3]
v_exp_f32 v209, v209
v_mfma_f32_16x16x32_bf16 a[4:7], v[224:227], v[164:167], a[4:7]
v_exp_f32 v210, v210
v_mfma_f32_16x16x32_bf16 a[4:7], v[228:231], v[180:183], a[4:7]
v_exp_f32 v211, v211
v_mfma_f32_16x16x32_bf16 a[8:11], v[224:227], v[168:171], a[8:11]
ds_read_b64_tr_b16 v[244:245], v13 offset:49152
ds_read_b64_tr_b16 v[246:247], v13 offset:51200
v_mfma_f32_16x16x32_bf16 a[8:11], v[228:231], v[184:187], a[8:11]
v_cvt_pk_bf16_f32 v2, v208, v209
v_cvt_pk_bf16_f32 v3, v210, v211
v_mfma_f32_16x16x32_bf16 a[12:15], v[224:227], v[172:175], a[12:15]
v_exp_f32 v212, v212
v_mfma_f32_16x16x32_bf16 a[12:15], v[228:231], v[188:191], a[12:15]
s_waitcnt lgkmcnt(4)
v_mfma_f32_16x16x32_bf16 a[16:19], v[232:235], v[128:131], a[16:19]
ds_read_b64_tr_b16 v[224:225], v249 offset:33280
ds_read_b64_tr_b16 v[226:227], v249 offset:35328
v_mfma_f32_16x16x32_bf16 a[16:19], v[236:239], v[144:147], a[16:19]
v_exp_f32 v213, v213
v_mfma_f32_16x16x32_bf16 a[20:23], v[232:235], v[132:135], a[20:23]
v_exp_f32 v214, v214
v_mfma_f32_16x16x32_bf16 a[20:23], v[236:239], v[148:151], a[20:23]
v_exp_f32 v215, v215
v_mfma_f32_16x16x32_bf16 a[24:27], v[232:235], v[136:139], a[24:27]
ds_read_b64_tr_b16 v[228:229], v249 offset:49664
ds_read_b64_tr_b16 v[230:231], v249 offset:51712
v_mfma_f32_16x16x32_bf16 a[24:27], v[236:239], v[152:155], a[24:27]
v_cvt_pk_bf16_f32 v34, v212, v213
v_cvt_pk_bf16_f32 v35, v214, v215
v_mfma_f32_16x16x32_bf16 a[28:31], v[232:235], v[140:143], a[28:31]
v_exp_f32 v216, v216
v_mfma_f32_16x16x32_bf16 a[28:31], v[236:239], v[156:159], a[28:31]
s_waitcnt lgkmcnt(4)
v_mfma_f32_16x16x32_bf16 a[16:19], v[240:243], v[160:163], a[16:19]
ds_read_b64_tr_b16 v[232:233], v249 offset:0
ds_read_b64_tr_b16 v[234:235], v249 offset:2048
v_mfma_f32_16x16x32_bf16 a[16:19], v[244:247], v[176:179], a[16:19]
v_exp_f32 v217, v217
v_mfma_f32_16x16x32_bf16 a[20:23], v[240:243], v[164:167], a[20:23]
v_exp_f32 v218, v218
v_mfma_f32_16x16x32_bf16 a[20:23], v[244:247], v[180:183], a[20:23]
v_exp_f32 v219, v219
v_mfma_f32_16x16x32_bf16 a[24:27], v[240:243], v[168:171], a[24:27]
ds_read_b64_tr_b16 v[236:237], v250 offset:0
ds_read_b64_tr_b16 v[238:239], v250 offset:2048
v_mfma_f32_16x16x32_bf16 a[24:27], v[244:247], v[184:187], a[24:27]
v_cvt_pk_bf16_f32 v66, v216, v217
v_cvt_pk_bf16_f32 v67, v218, v219
v_mfma_f32_16x16x32_bf16 a[28:31], v[240:243], v[172:175], a[28:31]
v_exp_f32 v220, v220
v_mfma_f32_16x16x32_bf16 a[28:31], v[244:247], v[188:191], a[28:31]
s_waitcnt lgkmcnt(4)
v_mfma_f32_16x16x32_bf16 a[32:35], v[224:227], v[4:7], a[32:35]
ds_read_b64_tr_b16 v[240:241], v12 offset:512
ds_read_b64_tr_b16 v[242:243], v12 offset:2560
v_mfma_f32_16x16x32_bf16 a[32:35], v[228:231], v[8:11], a[32:35]
v_exp_f32 v221, v221
v_mfma_f32_16x16x32_bf16 a[36:39], v[224:227], v[36:39], a[36:39]
v_exp_f32 v222, v222
v_mfma_f32_16x16x32_bf16 a[36:39], v[228:231], v[40:43], a[36:39]
v_exp_f32 v223, v223
v_mfma_f32_16x16x32_bf16 a[40:43], v[224:227], v[68:71], a[40:43]
ds_read_b64_tr_b16 v[244:245], v12 offset:16896
ds_read_b64_tr_b16 v[246:247], v12 offset:18944
v_mfma_f32_16x16x32_bf16 a[40:43], v[228:231], v[72:75], a[40:43]
v_cvt_pk_bf16_f32 v98, v220, v221
v_cvt_pk_bf16_f32 v99, v222, v223
v_mfma_f32_16x16x32_bf16 a[44:47], v[224:227], v[100:103], a[44:47]
v_mfma_f32_16x16x32_bf16 a[44:47], v[228:231], v[104:107], a[44:47]
s_waitcnt lgkmcnt(4)
v_mfma_f32_16x16x32_bf16 a[0:3], v[232:235], v[0:3], a[0:3]
ds_read_b64_tr_b16 v[224:225], v12 offset:33280
ds_read_b64_tr_b16 v[226:227], v12 offset:35328
v_mfma_f32_16x16x32_bf16 a[4:7], v[232:235], v[32:35], a[4:7]
v_mfma_f32_16x16x32_bf16 a[8:11], v[232:235], v[64:67], a[8:11]
v_mfma_f32_16x16x32_bf16 a[12:15], v[232:235], v[96:99], a[12:15]
v_mfma_f32_16x16x32_bf16 a[16:19], v[236:239], v[0:3], a[16:19]
ds_read_b64_tr_b16 v[228:229], v12 offset:49664
ds_read_b64_tr_b16 v[230:231], v12 offset:51712
v_mfma_f32_16x16x32_bf16 a[20:23], v[236:239], v[32:35], a[20:23]
v_mfma_f32_16x16x32_bf16 a[24:27], v[236:239], v[64:67], a[24:27]
v_mfma_f32_16x16x32_bf16 a[28:31], v[236:239], v[96:99], a[28:31]
s_waitcnt lgkmcnt(4)
v_mfma_f32_16x16x32_bf16 a[32:35], v[240:243], v[128:131], a[32:35]
ds_read_b64_tr_b16 v[232:233], v249 offset:512
ds_read_b64_tr_b16 v[234:235], v249 offset:2560
v_mfma_f32_16x16x32_bf16 a[32:35], v[244:247], v[144:147], a[32:35]
v_mfma_f32_16x16x32_bf16 a[36:39], v[240:243], v[132:135], a[36:39]
v_mfma_f32_16x16x32_bf16 a[36:39], v[244:247], v[148:151], a[36:39]
v_mfma_f32_16x16x32_bf16 a[40:43], v[240:243], v[136:139], a[40:43]
ds_read_b64_tr_b16 v[236:237], v250 offset:512
ds_read_b64_tr_b16 v[238:239], v250 offset:2560
v_accvgpr_read_b32 v192, a0
v_mfma_f32_16x16x32_bf16 a[40:43], v[244:247], v[152:155], a[40:43]
v_accvgpr_read_b32 v193, a4
v_accvgpr_read_b32 v194, a8
v_accvgpr_read_b32 v195, a12
v_mfma_f32_16x16x32_bf16 a[44:47], v[240:243], v[140:143], a[44:47]
v_lshlrev_b32 v253, 2, v252
v_subrev_u32 v196, 0x0d800000, v192
v_subrev_u32 v197, 0x0d800000, v193
v_mfma_f32_16x16x32_bf16 a[44:47], v[244:247], v[156:159], a[44:47]
s_waitcnt lgkmcnt(4)
v_subrev_u32 v198, 0x0d800000, v194
v_subrev_u32 v199, 0x0d800000, v195
v_mfma_f32_16x16x32_bf16 a[32:35], v[224:227], v[160:163], a[32:35]
ds_read_b64_tr_b16 v[240:241], v250 offset:33280
ds_read_b64_tr_b16 v[242:243], v250 offset:35328
v_max3_u32 v254, v196, v197, v198
v_mfma_f32_16x16x32_bf16 a[32:35], v[228:231], v[176:179], a[32:35]
v_max_u32 v254, v254, v199
v_mfma_f32_16x16x32_bf16 a[36:39], v[224:227], v[164:167], a[36:39]
s_mov_b64 exec, 0xffff
s_xor_b32 s35, s48, 0
buffer_store_dword v192, v253, s[24:27], s35 offen offset:4 sc1
s_xor_b32 s35, s48, 1024
buffer_store_dword v193, v253, s[24:27], s35 offen offset:4 sc1
s_xor_b32 s35, s48, 2048
buffer_store_dword v194, v253, s[24:27], s35 offen offset:4 sc1
s_xor_b32 s35, s48, 3072
buffer_store_dword v195, v253, s[24:27], s35 offen offset:4 sc1
v_cmp_le_u32 vcc, 0x64000000, v254
s_mov_b64 exec, -1
v_mfma_f32_16x16x32_bf16 a[36:39], v[228:231], v[180:183], a[36:39]
v_accvgpr_read_b32 v192, a0
v_accvgpr_read_b32 v193, a1
v_mfma_f32_16x16x32_bf16 a[40:43], v[224:227], v[168:171], a[40:43]
ds_read_b64_tr_b16 v[244:245], v250 offset:49664
ds_read_b64_tr_b16 v[246:247], v250 offset:51712
v_mfma_f32_16x16x32_bf16 a[40:43], v[228:231], v[184:187], a[40:43]
v_accvgpr_read_b32 v194, a2
v_accvgpr_read_b32 v195, a3
v_mfma_f32_16x16x32_bf16 a[44:47], v[224:227], v[172:175], a[44:47]
v_cvt_pk_bf16_f32 v16, v192, v193
v_cvt_pk_bf16_f32 v17, v194, v195
v_mfma_f32_16x16x32_bf16 a[44:47], v[228:231], v[188:191], a[44:47]
s_waitcnt lgkmcnt(4)
v_accvgpr_read_b32 v200, a4
v_mfma_f32_16x16x32_bf16 a[32:35], v[232:235], v[0:3], a[32:35]
ds_read_b64_tr_b16 v[224:225], v13 offset:512
ds_read_b64_tr_b16 v[226:227], v13 offset:2560
v_mfma_f32_16x16x32_bf16 a[36:39], v[232:235], v[32:35], a[36:39]
v_accvgpr_read_b32 v201, a5
v_accvgpr_read_b32 v202, a6
v_mfma_f32_16x16x32_bf16 a[40:43], v[232:235], v[64:67], a[40:43]
v_accvgpr_read_b32 v203, a7
v_cvt_pk_bf16_f32 v48, v200, v201
v_mfma_f32_16x16x32_bf16 a[44:47], v[232:235], v[96:99], a[44:47]
v_cvt_pk_bf16_f32 v49, v202, v203
v_accvgpr_read_b32 v208, a8
v_mfma_f32_16x16x32_bf16 a[48:51], v[236:239], v[0:3], a[48:51]
ds_read_b64_tr_b16 v[228:229], v13 offset:16896
ds_read_b64_tr_b16 v[230:231], v13 offset:18944
v_mfma_f32_16x16x32_bf16 a[52:55], v[236:239], v[32:35], a[52:55]
v_accvgpr_read_b32 v209, a9
v_accvgpr_read_b32 v210, a10
v_mfma_f32_16x16x32_bf16 a[56:59], v[236:239], v[64:67], a[56:59]
v_accvgpr_read_b32 v211, a11
v_cvt_pk_bf16_f32 v80, v208, v209
v_mfma_f32_16x16x32_bf16 a[60:63], v[236:239], v[96:99], a[60:63]
s_waitcnt lgkmcnt(4)
v_cvt_pk_bf16_f32 v81, v210, v211
v_mfma_f32_16x16x32_bf16 a[48:51], v[240:243], v[4:7], a[48:51]
ds_read_b64_tr_b16 v[232:233], v13 offset:33280
ds_read_b64_tr_b16 v[234:235], v13 offset:35328
v_mfma_f32_16x16x32_bf16 a[48:51], v[244:247], v[8:11], a[48:51]
v_accvgpr_read_b32 v216, a12
v_accvgpr_read_b32 v217, a13
v_mfma_f32_16x16x32_bf16 a[52:55], v[240:243], v[36:39], a[52:55]
v_accvgpr_read_b32 v218, a14
v_accvgpr_read_b32 v219, a15
v_mfma_f32_16x16x32_bf16 a[52:55], v[244:247], v[40:43], a[52:55]
v_cvt_pk_bf16_f32 v112, v216, v217
v_cvt_pk_bf16_f32 v113, v218, v219
v_mfma_f32_16x16x32_bf16 a[56:59], v[240:243], v[68:71], a[56:59]
ds_read_b64_tr_b16 v[236:237], v13 offset:49664
ds_read_b64_tr_b16 v[238:239], v13 offset:51712
v_mfma_f32_16x16x32_bf16 a[56:59], v[244:247], v[72:75], a[56:59]
v_accvgpr_read_b32 v196, a16
v_accvgpr_read_b32 v197, a17
v_mfma_f32_16x16x32_bf16 a[60:63], v[240:243], v[100:103], a[60:63]
v_accvgpr_read_b32 v198, a18
v_accvgpr_read_b32 v199, a19
v_mfma_f32_16x16x32_bf16 a[60:63], v[244:247], v[104:107], a[60:63]
s_waitcnt lgkmcnt(4)
v_cvt_pk_bf16_f32 v18, v196, v197
v_mfma_f32_16x16x32_bf16 a[48:51], v[224:227], v[128:131], a[48:51]
ds_read_b64_tr_b16 v[240:241], v249 offset:36864
ds_read_b64_tr_b16 v[242:243], v249 offset:38912
v_mfma_f32_16x16x32_bf16 a[48:51], v[228:231], v[144:147], a[48:51]
v_cvt_pk_bf16_f32 v19, v198, v199
buffer_store_dwordx4 v[16:19], v252, s[20:23], s40 offen offset:0 sc1
v_mfma_f32_16x16x32_bf16 a[52:55], v[224:227], v[132:135], a[52:55]
v_accvgpr_read_b32 v204, a20
v_accvgpr_read_b32 v205, a21
v_mfma_f32_16x16x32_bf16 a[52:55], v[228:231], v[148:151], a[52:55]
v_accvgpr_read_b32 v206, a22
v_accvgpr_read_b32 v207, a23
v_mfma_f32_16x16x32_bf16 a[56:59], v[224:227], v[136:139], a[56:59]
ds_read_b64_tr_b16 v[244:245], v249 offset:53248
ds_read_b64_tr_b16 v[246:247], v249 offset:55296
v_mfma_f32_16x16x32_bf16 a[56:59], v[228:231], v[152:155], a[56:59]
v_cvt_pk_bf16_f32 v50, v204, v205
v_cvt_pk_bf16_f32 v51, v206, v207
v_mfma_f32_16x16x32_bf16 a[60:63], v[224:227], v[140:143], a[60:63]
buffer_store_dwordx4 v[48:51], v252, s[20:23], s41 offen offset:0 sc1
v_accvgpr_read_b32 v212, a24
v_mfma_f32_16x16x32_bf16 a[60:63], v[228:231], v[156:159], a[60:63]
s_waitcnt lgkmcnt(4)
v_accvgpr_read_b32 v213, a25
v_mfma_f32_16x16x32_bf16 a[48:51], v[232:235], v[160:163], a[48:51]
ds_read_b64_tr_b16 v[224:225], v12 offset:4096
ds_read_b64_tr_b16 v[226:227], v12 offset:6144
v_mfma_f32_16x16x32_bf16 a[48:51], v[236:239], v[176:179], a[48:51]
v_accvgpr_read_b32 v214, a26
v_accvgpr_read_b32 v215, a27
v_mfma_f32_16x16x32_bf16 a[52:55], v[232:235], v[164:167], a[52:55]
v_cvt_pk_bf16_f32 v82, v212, v213
v_cvt_pk_bf16_f32 v83, v214, v215
v_mfma_f32_16x16x32_bf16 a[52:55], v[236:239], v[180:183], a[52:55]
buffer_store_dwordx4 v[80:83], v252, s[20:23], s42 offen offset:0 sc1
v_accvgpr_read_b32 v220, a28
v_mfma_f32_16x16x32_bf16 a[56:59], v[232:235], v[168:171], a[56:59]
ds_read_b64_tr_b16 v[228:229], v12 offset:20480
ds_read_b64_tr_b16 v[230:231], v12 offset:22528
v_mfma_f32_16x16x32_bf16 a[56:59], v[236:239], v[184:187], a[56:59]
v_accvgpr_read_b32 v221, a29
v_accvgpr_read_b32 v222, a30
v_mfma_f32_16x16x32_bf16 a[60:63], v[232:235], v[172:175], a[60:63]
v_accvgpr_read_b32 v223, a31
v_cvt_pk_bf16_f32 v114, v220, v221
v_mfma_f32_16x16x32_bf16 a[60:63], v[236:239], v[188:191], a[60:63]
s_waitcnt lgkmcnt(4)
v_cvt_pk_bf16_f32 v115, v222, v223
v_mfma_f32_16x16x32_bf16 a[64:67], v[240:243], v[4:7], a[64:67]
ds_read_b64_tr_b16 v[232:233], v12 offset:36864
ds_read_b64_tr_b16 v[234:235], v12 offset:38912
v_mfma_f32_16x16x32_bf16 a[64:67], v[244:247], v[8:11], a[64:67]
buffer_store_dwordx4 v[112:115], v252, s[20:23], s43 offen offset:0 sc1
v_accvgpr_read_b32 v192, a32
v_mfma_f32_16x16x32_bf16 a[68:71], v[240:243], v[36:39], a[68:71]
v_accvgpr_read_b32 v193, a33
v_accvgpr_read_b32 v194, a34
v_mfma_f32_16x16x32_bf16 a[68:71], v[244:247], v[40:43], a[68:71]
v_accvgpr_read_b32 v195, a35
v_cvt_pk_bf16_f32 v20, v192, v193
v_mfma_f32_16x16x32_bf16 a[72:75], v[240:243], v[68:71], a[72:75]
ds_read_b64_tr_b16 v[236:237], v12 offset:53248
ds_read_b64_tr_b16 v[238:239], v12 offset:55296
v_mfma_f32_16x16x32_bf16 a[72:75], v[244:247], v[72:75], a[72:75]
v_cvt_pk_bf16_f32 v21, v194, v195
v_accvgpr_read_b32 v200, a36
v_mfma_f32_16x16x32_bf16 a[76:79], v[240:243], v[100:103], a[76:79]
v_accvgpr_read_b32 v201, a37
v_accvgpr_read_b32 v202, a38
v_mfma_f32_16x16x32_bf16 a[76:79], v[244:247], v[104:107], a[76:79]
s_waitcnt lgkmcnt(4)
v_accvgpr_read_b32 v203, a39
v_mfma_f32_16x16x32_bf16 a[64:67], v[224:227], v[128:131], a[64:67]
ds_read_b64_tr_b16 v[240:241], v249 offset:4096
ds_read_b64_tr_b16 v[242:243], v249 offset:6144
v_mfma_f32_16x16x32_bf16 a[64:67], v[228:231], v[144:147], a[64:67]
v_cvt_pk_bf16_f32 v52, v200, v201
v_cvt_pk_bf16_f32 v53, v202, v203
v_mfma_f32_16x16x32_bf16 a[68:71], v[224:227], v[132:135], a[68:71]
v_accvgpr_read_b32 v208, a40
v_accvgpr_read_b32 v209, a41
v_mfma_f32_16x16x32_bf16 a[68:71], v[228:231], v[148:151], a[68:71]
v_accvgpr_read_b32 v210, a42
v_accvgpr_read_b32 v211, a43
v_mfma_f32_16x16x32_bf16 a[72:75], v[224:227], v[136:139], a[72:75]
ds_read_b64_tr_b16 v[244:245], v250 offset:4096
ds_read_b64_tr_b16 v[246:247], v250 offset:6144
v_mfma_f32_16x16x32_bf16 a[72:75], v[228:231], v[152:155], a[72:75]
v_cvt_pk_bf16_f32 v84, v208, v209
v_cvt_pk_bf16_f32 v85, v210, v211
v_mfma_f32_16x16x32_bf16 a[76:79], v[224:227], v[140:143], a[76:79]
v_accvgpr_read_b32 v216, a44
v_accvgpr_read_b32 v217, a45
v_mfma_f32_16x16x32_bf16 a[76:79], v[228:231], v[156:159], a[76:79]
s_waitcnt lgkmcnt(4)
v_accvgpr_read_b32 v218, a46
v_mfma_f32_16x16x32_bf16 a[64:67], v[232:235], v[160:163], a[64:67]
ds_read_b64_tr_b16 v[224:225], v250 offset:36864
ds_read_b64_tr_b16 v[226:227], v250 offset:38912
v_mfma_f32_16x16x32_bf16 a[64:67], v[236:239], v[176:179], a[64:67]
v_accvgpr_read_b32 v219, a47
v_cvt_pk_bf16_f32 v116, v216, v217
v_mfma_f32_16x16x32_bf16 a[68:71], v[232:235], v[164:167], a[68:71]
v_cvt_pk_bf16_f32 v117, v218, v219
v_accvgpr_read_b32 v196, a48
v_mfma_f32_16x16x32_bf16 a[68:71], v[236:239], v[180:183], a[68:71]
v_accvgpr_read_b32 v197, a49
v_accvgpr_read_b32 v198, a50
v_mfma_f32_16x16x32_bf16 a[72:75], v[232:235], v[168:171], a[72:75]
ds_read_b64_tr_b16 v[228:229], v250 offset:53248
ds_read_b64_tr_b16 v[230:231], v250 offset:55296
v_mfma_f32_16x16x32_bf16 a[72:75], v[236:239], v[184:187], a[72:75]
v_accvgpr_read_b32 v199, a51
v_cvt_pk_bf16_f32 v22, v196, v197
v_mfma_f32_16x16x32_bf16 a[76:79], v[232:235], v[172:175], a[76:79]
v_cvt_pk_bf16_f32 v23, v198, v199
buffer_store_dwordx4 v[20:23], v252, s[20:23], s40 offen offset:1024 sc1
v_mfma_f32_16x16x32_bf16 a[76:79], v[236:239], v[188:191], a[76:79]
s_waitcnt lgkmcnt(4)
v_accvgpr_read_b32 v204, a52
v_mfma_f32_16x16x32_bf16 a[64:67], v[240:243], v[0:3], a[64:67]
ds_read_b64_tr_b16 v[232:233], v13 offset:4096
ds_read_b64_tr_b16 v[234:235], v13 offset:6144
v_mfma_f32_16x16x32_bf16 a[68:71], v[240:243], v[32:35], a[68:71]
v_accvgpr_read_b32 v205, a53
v_accvgpr_read_b32 v206, a54
v_mfma_f32_16x16x32_bf16 a[72:75], v[240:243], v[64:67], a[72:75]
v_accvgpr_read_b32 v207, a55
v_cvt_pk_bf16_f32 v54, v204, v205
v_mfma_f32_16x16x32_bf16 a[76:79], v[240:243], v[96:99], a[76:79]
v_cvt_pk_bf16_f32 v55, v206, v207
buffer_store_dwordx4 v[52:55], v252, s[20:23], s41 offen offset:1024 sc1
v_mfma_f32_16x16x32_bf16 a[80:83], v[244:247], v[0:3], a[80:83]
ds_read_b64_tr_b16 v[236:237], v13 offset:20480
ds_read_b64_tr_b16 v[238:239], v13 offset:22528
v_mfma_f32_16x16x32_bf16 a[84:87], v[244:247], v[32:35], a[84:87]
v_accvgpr_read_b32 v212, a56
v_accvgpr_read_b32 v213, a57
v_mfma_f32_16x16x32_bf16 a[88:91], v[244:247], v[64:67], a[88:91]
v_accvgpr_read_b32 v214, a58
v_accvgpr_read_b32 v215, a59
v_mfma_f32_16x16x32_bf16 a[92:95], v[244:247], v[96:99], a[92:95]
s_waitcnt lgkmcnt(4)
v_cvt_pk_bf16_f32 v86, v212, v213
v_mfma_f32_16x16x32_bf16 a[80:83], v[224:227], v[4:7], a[80:83]
ds_read_b64_tr_b16 v[240:241], v13 offset:36864
ds_read_b64_tr_b16 v[242:243], v13 offset:38912
v_mfma_f32_16x16x32_bf16 a[80:83], v[228:231], v[8:11], a[80:83]
v_cvt_pk_bf16_f32 v87, v214, v215
buffer_store_dwordx4 v[84:87], v252, s[20:23], s42 offen offset:1024 sc1
v_mfma_f32_16x16x32_bf16 a[84:87], v[224:227], v[36:39], a[84:87]
v_accvgpr_read_b32 v220, a60
v_accvgpr_read_b32 v221, a61
v_mfma_f32_16x16x32_bf16 a[84:87], v[228:231], v[40:43], a[84:87]
v_accvgpr_read_b32 v222, a62
v_accvgpr_read_b32 v223, a63
v_mfma_f32_16x16x32_bf16 a[88:91], v[224:227], v[68:71], a[88:91]
ds_read_b64_tr_b16 v[244:245], v13 offset:53248
ds_read_b64_tr_b16 v[246:247], v13 offset:55296
v_mfma_f32_16x16x32_bf16 a[88:91], v[228:231], v[72:75], a[88:91]
v_cvt_pk_bf16_f32 v118, v220, v221
v_cvt_pk_bf16_f32 v119, v222, v223
v_mfma_f32_16x16x32_bf16 a[92:95], v[224:227], v[100:103], a[92:95]
buffer_store_dwordx4 v[116:119], v252, s[20:23], s43 offen offset:1024 sc1
v_accvgpr_read_b32 v192, a64
v_mfma_f32_16x16x32_bf16 a[92:95], v[228:231], v[104:107], a[92:95]
s_waitcnt lgkmcnt(4)
v_accvgpr_read_b32 v193, a65
v_mfma_f32_16x16x32_bf16 a[80:83], v[232:235], v[128:131], a[80:83]
ds_read_b64_tr_b16 v[224:225], v249 offset:37376
ds_read_b64_tr_b16 v[226:227], v249 offset:39424
v_mfma_f32_16x16x32_bf16 a[80:83], v[236:239], v[144:147], a[80:83]
v_accvgpr_read_b32 v194, a66
v_accvgpr_read_b32 v195, a67
v_mfma_f32_16x16x32_bf16 a[84:87], v[232:235], v[132:135], a[84:87]
v_cvt_pk_bf16_f32 v24, v192, v193
v_cvt_pk_bf16_f32 v25, v194, v195
v_mfma_f32_16x16x32_bf16 a[84:87], v[236:239], v[148:151], a[84:87]
v_accvgpr_read_b32 v200, a68
v_accvgpr_read_b32 v201, a69
v_mfma_f32_16x16x32_bf16 a[88:91], v[232:235], v[136:139], a[88:91]
ds_read_b64_tr_b16 v[228:229], v249 offset:53760
ds_read_b64_tr_b16 v[230:231], v249 offset:55808
v_mfma_f32_16x16x32_bf16 a[88:91], v[236:239], v[152:155], a[88:91]
v_accvgpr_read_b32 v202, a70
v_accvgpr_read_b32 v203, a71
v_mfma_f32_16x16x32_bf16 a[92:95], v[232:235], v[140:143], a[92:95]
v_cvt_pk_bf16_f32 v56, v200, v201
v_cvt_pk_bf16_f32 v57, v202, v203
v_mfma_f32_16x16x32_bf16 a[92:95], v[236:239], v[156:159], a[92:95]
s_waitcnt lgkmcnt(4)
v_accvgpr_read_b32 v208, a72
v_mfma_f32_16x16x32_bf16 a[80:83], v[240:243], v[160:163], a[80:83]
ds_read_b64_tr_b16 v[232:233], v12 offset:4608
ds_read_b64_tr_b16 v[234:235], v12 offset:6656
v_mfma_f32_16x16x32_bf16 a[80:83], v[244:247], v[176:179], a[80:83]
v_accvgpr_read_b32 v209, a73
v_accvgpr_read_b32 v210, a74
v_mfma_f32_16x16x32_bf16 a[84:87], v[240:243], v[164:167], a[84:87]
v_accvgpr_read_b32 v211, a75
v_cvt_pk_bf16_f32 v88, v208, v209
v_mfma_f32_16x16x32_bf16 a[84:87], v[244:247], v[180:183], a[84:87]
v_cvt_pk_bf16_f32 v89, v210, v211
v_accvgpr_read_b32 v216, a76
v_mfma_f32_16x16x32_bf16 a[88:91], v[240:243], v[168:171], a[88:91]
ds_read_b64_tr_b16 v[236:237], v12 offset:20992
ds_read_b64_tr_b16 v[238:239], v12 offset:23040
v_mfma_f32_16x16x32_bf16 a[88:91], v[244:247], v[184:187], a[88:91]
v_accvgpr_read_b32 v217, a77
v_accvgpr_read_b32 v218, a78
v_mfma_f32_16x16x32_bf16 a[92:95], v[240:243], v[172:175], a[92:95]
v_accvgpr_read_b32 v219, a79
v_cvt_pk_bf16_f32 v120, v216, v217
v_mfma_f32_16x16x32_bf16 a[92:95], v[244:247], v[188:191], a[92:95]
s_waitcnt lgkmcnt(4)
v_cvt_pk_bf16_f32 v121, v218, v219
v_mfma_f32_16x16x32_bf16 a[96:99], v[224:227], v[4:7], a[96:99]
ds_read_b64_tr_b16 v[240:241], v12 offset:37376
ds_read_b64_tr_b16 v[242:243], v12 offset:39424
v_mfma_f32_16x16x32_bf16 a[96:99], v[228:231], v[8:11], a[96:99]
v_accvgpr_read_b32 v196, a80
v_accvgpr_read_b32 v197, a81
v_mfma_f32_16x16x32_bf16 a[100:103], v[224:227], v[36:39], a[100:103]
v_accvgpr_read_b32 v198, a82
v_accvgpr_read_b32 v199, a83
v_mfma_f32_16x16x32_bf16 a[100:103], v[228:231], v[40:43], a[100:103]
v_cvt_pk_bf16_f32 v26, v196, v197
v_cvt_pk_bf16_f32 v27, v198, v199
v_mfma_f32_16x16x32_bf16 a[104:107], v[224:227], v[68:71], a[104:107]
ds_read_b64_tr_b16 v[244:245], v12 offset:53760
ds_read_b64_tr_b16 v[246:247], v12 offset:55808
v_mfma_f32_16x16x32_bf16 a[104:107], v[228:231], v[72:75], a[104:107]
buffer_store_dwordx4 v[24:27], v252, s[20:23], s40 offen offset:2048 sc1
v_accvgpr_read_b32 v204, a84
v_mfma_f32_16x16x32_bf16 a[108:111], v[224:227], v[100:103], a[108:111]
v_accvgpr_read_b32 v205, a85
v_accvgpr_read_b32 v206, a86
v_mfma_f32_16x16x32_bf16 a[108:111], v[228:231], v[104:107], a[108:111]
s_waitcnt lgkmcnt(4)
v_accvgpr_read_b32 v207, a87
v_mfma_f32_16x16x32_bf16 a[96:99], v[232:235], v[128:131], a[96:99]
ds_read_b64_tr_b16 v[224:225], v249 offset:4608
ds_read_b64_tr_b16 v[226:227], v249 offset:6656
v_mfma_f32_16x16x32_bf16 a[96:99], v[236:239], v[144:147], a[96:99]
v_cvt_pk_bf16_f32 v58, v204, v205
v_cvt_pk_bf16_f32 v59, v206, v207
v_mfma_f32_16x16x32_bf16 a[100:103], v[232:235], v[132:135], a[100:103]
buffer_store_dwordx4 v[56:59], v252, s[20:23], s41 offen offset:2048 sc1
v_accvgpr_read_b32 v212, a88
v_mfma_f32_16x16x32_bf16 a[100:103], v[236:239], v[148:151], a[100:103]
v_accvgpr_read_b32 v213, a89
v_accvgpr_read_b32 v214, a90
v_mfma_f32_16x16x32_bf16 a[104:107], v[232:235], v[136:139], a[104:107]
ds_read_b64_tr_b16 v[228:229], v250 offset:4608
ds_read_b64_tr_b16 v[230:231], v250 offset:6656
v_mfma_f32_16x16x32_bf16 a[104:107], v[236:239], v[152:155], a[104:107]
v_accvgpr_read_b32 v215, a91
v_cvt_pk_bf16_f32 v90, v212, v213
v_mfma_f32_16x16x32_bf16 a[108:111], v[232:235], v[140:143], a[108:111]
v_cvt_pk_bf16_f32 v91, v214, v215
buffer_store_dwordx4 v[88:91], v252, s[20:23], s42 offen offset:2048 sc1
v_mfma_f32_16x16x32_bf16 a[108:111], v[236:239], v[156:159], a[108:111]
s_waitcnt lgkmcnt(4)
v_accvgpr_read_b32 v220, a92
v_mfma_f32_16x16x32_bf16 a[96:99], v[240:243], v[160:163], a[96:99]
ds_read_b64_tr_b16 v[232:233], v250 offset:37376
ds_read_b64_tr_b16 v[234:235], v250 offset:39424
v_mfma_f32_16x16x32_bf16 a[96:99], v[244:247], v[176:179], a[96:99]
v_accvgpr_read_b32 v221, a93
v_accvgpr_read_b32 v222, a94
v_mfma_f32_16x16x32_bf16 a[100:103], v[240:243], v[164:167], a[100:103]
v_accvgpr_read_b32 v223, a95
v_cvt_pk_bf16_f32 v122, v220, v221
v_mfma_f32_16x16x32_bf16 a[100:103], v[244:247], v[180:183], a[100:103]
v_cvt_pk_bf16_f32 v123, v222, v223
buffer_store_dwordx4 v[120:123], v252, s[20:23], s43 offen offset:2048 sc1
v_mfma_f32_16x16x32_bf16 a[104:107], v[240:243], v[168:171], a[104:107]
ds_read_b64_tr_b16 v[236:237], v250 offset:53760
ds_read_b64_tr_b16 v[238:239], v250 offset:55808
v_mfma_f32_16x16x32_bf16 a[104:107], v[244:247], v[184:187], a[104:107]
v_mfma_f32_16x16x32_bf16 a[108:111], v[240:243], v[172:175], a[108:111]
v_mfma_f32_16x16x32_bf16 a[108:111], v[244:247], v[188:191], a[108:111]
s_waitcnt lgkmcnt(4)
v_mfma_f32_16x16x32_bf16 a[96:99], v[224:227], v[0:3], a[96:99]
ds_read_b64_tr_b16 v[240:241], v13 offset:4608
ds_read_b64_tr_b16 v[242:243], v13 offset:6656
v_mfma_f32_16x16x32_bf16 a[100:103], v[224:227], v[32:35], a[100:103]
v_mfma_f32_16x16x32_bf16 a[104:107], v[224:227], v[64:67], a[104:107]
v_mfma_f32_16x16x32_bf16 a[108:111], v[224:227], v[96:99], a[108:111]
v_mfma_f32_16x16x32_bf16 a[112:115], v[228:231], v[0:3], a[112:115]
ds_read_b64_tr_b16 v[244:245], v13 offset:20992
ds_read_b64_tr_b16 v[246:247], v13 offset:23040
v_mfma_f32_16x16x32_bf16 a[116:119], v[228:231], v[32:35], a[116:119]
v_accvgpr_read_b32 v192, a96
v_accvgpr_read_b32 v193, a97
v_mfma_f32_16x16x32_bf16 a[120:123], v[228:231], v[64:67], a[120:123]
v_accvgpr_read_b32 v194, a98
v_accvgpr_read_b32 v195, a99
v_mfma_f32_16x16x32_bf16 a[124:127], v[228:231], v[96:99], a[124:127]
s_waitcnt lgkmcnt(4)
v_cvt_pk_bf16_f32 v28, v192, v193
v_mfma_f32_16x16x32_bf16 a[112:115], v[232:235], v[4:7], a[112:115]
ds_read_b64_tr_b16 v[224:225], v13 offset:37376
ds_read_b64_tr_b16 v[226:227], v13 offset:39424
v_mfma_f32_16x16x32_bf16 a[112:115], v[236:239], v[8:11], a[112:115]
v_cvt_pk_bf16_f32 v29, v194, v195
v_accvgpr_read_b32 v200, a100
v_mfma_f32_16x16x32_bf16 a[116:119], v[232:235], v[36:39], a[116:119]
v_accvgpr_read_b32 v201, a101
v_accvgpr_read_b32 v202, a102
v_mfma_f32_16x16x32_bf16 a[116:119], v[236:239], v[40:43], a[116:119]
v_accvgpr_read_b32 v203, a103
v_cvt_pk_bf16_f32 v60, v200, v201
v_mfma_f32_16x16x32_bf16 a[120:123], v[232:235], v[68:71], a[120:123]
ds_read_b64_tr_b16 v[228:229], v13 offset:53760
ds_read_b64_tr_b16 v[230:231], v13 offset:55808
v_mfma_f32_16x16x32_bf16 a[120:123], v[236:239], v[72:75], a[120:123]
v_cvt_pk_bf16_f32 v61, v202, v203
v_accvgpr_read_b32 v208, a104
v_mfma_f32_16x16x32_bf16 a[124:127], v[232:235], v[100:103], a[124:127]
v_accvgpr_read_b32 v209, a105
v_accvgpr_read_b32 v210, a106
v_mfma_f32_16x16x32_bf16 a[124:127], v[236:239], v[104:107], a[124:127]
s_waitcnt lgkmcnt(4)
v_accvgpr_read_b32 v211, a107
v_mfma_f32_16x16x32_bf16 a[112:115], v[240:243], v[128:131], a[112:115]
ds_read_b64_tr_b16 v[232:233], v249 offset:40960
ds_read_b64_tr_b16 v[234:235], v249 offset:43008
v_mfma_f32_16x16x32_bf16 a[112:115], v[244:247], v[144:147], a[112:115]
v_cvt_pk_bf16_f32 v92, v208, v209
v_cvt_pk_bf16_f32 v93, v210, v211
v_mfma_f32_16x16x32_bf16 a[116:119], v[240:243], v[132:135], a[116:119]
v_accvgpr_read_b32 v216, a108
v_accvgpr_read_b32 v217, a109
v_mfma_f32_16x16x32_bf16 a[116:119], v[244:247], v[148:151], a[116:119]
v_accvgpr_read_b32 v218, a110
v_accvgpr_read_b32 v219, a111
v_mfma_f32_16x16x32_bf16 a[120:123], v[240:243], v[136:139], a[120:123]
ds_read_b64_tr_b16 v[236:237], v249 offset:57344
ds_read_b64_tr_b16 v[238:239], v249 offset:59392
v_mfma_f32_16x16x32_bf16 a[120:123], v[244:247], v[152:155], a[120:123]
v_cvt_pk_bf16_f32 v124, v216, v217
v_cvt_pk_bf16_f32 v125, v218, v219
v_mfma_f32_16x16x32_bf16 a[124:127], v[240:243], v[140:143], a[124:127]
v_mfma_f32_16x16x32_bf16 a[124:127], v[244:247], v[156:159], a[124:127]
s_waitcnt lgkmcnt(4)
v_mfma_f32_16x16x32_bf16 a[112:115], v[224:227], v[160:163], a[112:115]
ds_read_b64_tr_b16 v[240:241], v12 offset:8192
ds_read_b64_tr_b16 v[242:243], v12 offset:10240
v_mfma_f32_16x16x32_bf16 a[112:115], v[228:231], v[176:179], a[112:115]
v_mfma_f32_16x16x32_bf16 a[116:119], v[224:227], v[164:167], a[116:119]
v_mfma_f32_16x16x32_bf16 a[116:119], v[228:231], v[180:183], a[116:119]
v_mfma_f32_16x16x32_bf16 a[120:123], v[224:227], v[168:171], a[120:123]
ds_read_b64_tr_b16 v[244:245], v12 offset:24576
ds_read_b64_tr_b16 v[246:247], v12 offset:26624
v_mfma_f32_16x16x32_bf16 a[120:123], v[228:231], v[184:187], a[120:123]
v_mfma_f32_16x16x32_bf16 a[124:127], v[224:227], v[172:175], a[124:127]
s_nop 0
v_accvgpr_read_b32 v196, a112
v_accvgpr_read_b32 v197, a113
v_mfma_f32_16x16x32_bf16 a[124:127], v[228:231], v[188:191], a[124:127]
s_waitcnt lgkmcnt(4)
v_accvgpr_read_b32 v198, a114
v_mfma_f32_16x16x32_bf16 a[128:131], v[232:235], v[4:7], a[128:131]
ds_read_b64_tr_b16 v[224:225], v12 offset:40960
ds_read_b64_tr_b16 v[226:227], v12 offset:43008
v_mfma_f32_16x16x32_bf16 a[128:131], v[236:239], v[8:11], a[128:131]
v_accvgpr_read_b32 v199, a115
v_cvt_pk_bf16_f32 v30, v196, v197
v_mfma_f32_16x16x32_bf16 a[132:135], v[232:235], v[36:39], a[132:135]
v_cvt_pk_bf16_f32 v31, v198, v199
buffer_store_dwordx4 v[28:31], v252, s[20:23], s40 offen offset:3072 sc1
v_mfma_f32_16x16x32_bf16 a[132:135], v[236:239], v[40:43], a[132:135]
v_accvgpr_read_b32 v204, a116
v_accvgpr_read_b32 v205, a117
v_mfma_f32_16x16x32_bf16 a[136:139], v[232:235], v[68:71], a[136:139]
ds_read_b64_tr_b16 v[228:229], v12 offset:57344
ds_read_b64_tr_b16 v[230:231], v12 offset:59392
v_mfma_f32_16x16x32_bf16 a[136:139], v[236:239], v[72:75], a[136:139]
v_accvgpr_read_b32 v206, a118
v_accvgpr_read_b32 v207, a119
v_mfma_f32_16x16x32_bf16 a[140:143], v[232:235], v[100:103], a[140:143]
v_cvt_pk_bf16_f32 v62, v204, v205
v_cvt_pk_bf16_f32 v63, v206, v207
v_mfma_f32_16x16x32_bf16 a[140:143], v[236:239], v[104:107], a[140:143]
s_waitcnt lgkmcnt(4)
buffer_store_dwordx4 v[60:63], v252, s[20:23], s41 offen offset:3072 sc1
v_mfma_f32_16x16x32_bf16 a[128:131], v[240:243], v[128:131], a[128:131]
ds_read_b64_tr_b16 v[232:233], v249 offset:8192
ds_read_b64_tr_b16 v[234:235], v249 offset:10240
v_mfma_f32_16x16x32_bf16 a[128:131], v[244:247], v[144:147], a[128:131]
v_accvgpr_read_b32 v212, a120
v_accvgpr_read_b32 v213, a121
v_mfma_f32_16x16x32_bf16 a[132:135], v[240:243], v[132:135], a[132:135]
v_accvgpr_read_b32 v214, a122
v_accvgpr_read_b32 v215, a123
v_mfma_f32_16x16x32_bf16 a[132:135], v[244:247], v[148:151], a[132:135]
v_cvt_pk_bf16_f32 v94, v212, v213
v_cvt_pk_bf16_f32 v95, v214, v215
v_mfma_f32_16x16x32_bf16 a[136:139], v[240:243], v[136:139], a[136:139]
ds_read_b64_tr_b16 v[236:237], v250 offset:8192
ds_read_b64_tr_b16 v[238:239], v250 offset:10240
v_mfma_f32_16x16x32_bf16 a[136:139], v[244:247], v[152:155], a[136:139]
buffer_store_dwordx4 v[92:95], v252, s[20:23], s42 offen offset:3072 sc1
v_accvgpr_read_b32 v220, a124
v_mfma_f32_16x16x32_bf16 a[140:143], v[240:243], v[140:143], a[140:143]
v_accvgpr_read_b32 v221, a125
v_accvgpr_read_b32 v222, a126
v_mfma_f32_16x16x32_bf16 a[140:143], v[244:247], v[156:159], a[140:143]
s_waitcnt lgkmcnt(4)
v_accvgpr_read_b32 v223, a127
v_mfma_f32_16x16x32_bf16 a[128:131], v[224:227], v[160:163], a[128:131]
ds_read_b64_tr_b16 v[240:241], v250 offset:40960
ds_read_b64_tr_b16 v[242:243], v250 offset:43008
v_mfma_f32_16x16x32_bf16 a[128:131], v[228:231], v[176:179], a[128:131]
v_cvt_pk_bf16_f32 v126, v220, v221
v_cvt_pk_bf16_f32 v127, v222, v223
v_mfma_f32_16x16x32_bf16 a[132:135], v[224:227], v[164:167], a[132:135]
buffer_store_dwordx4 v[124:127], v252, s[20:23], s43 offen offset:3072 sc1
v_mfma_f32_16x16x32_bf16 a[132:135], v[228:231], v[180:183], a[132:135]
v_mfma_f32_16x16x32_bf16 a[136:139], v[224:227], v[168:171], a[136:139]
ds_read_b64_tr_b16 v[244:245], v250 offset:57344
ds_read_b64_tr_b16 v[246:247], v250 offset:59392
v_mfma_f32_16x16x32_bf16 a[136:139], v[228:231], v[184:187], a[136:139]
v_mfma_f32_16x16x32_bf16 a[140:143], v[224:227], v[172:175], a[140:143]
v_mfma_f32_16x16x32_bf16 a[140:143], v[228:231], v[188:191], a[140:143]
s_waitcnt lgkmcnt(4)
v_mfma_f32_16x16x32_bf16 a[128:131], v[232:235], v[0:3], a[128:131]
ds_read_b64_tr_b16 v[224:225], v13 offset:8192
ds_read_b64_tr_b16 v[226:227], v13 offset:10240
v_mfma_f32_16x16x32_bf16 a[132:135], v[232:235], v[32:35], a[132:135]
v_mfma_f32_16x16x32_bf16 a[136:139], v[232:235], v[64:67], a[136:139]
v_mfma_f32_16x16x32_bf16 a[140:143], v[232:235], v[96:99], a[140:143]
v_mfma_f32_16x16x32_bf16 a[144:147], v[236:239], v[0:3], a[144:147]
ds_read_b64_tr_b16 v[228:229], v13 offset:24576
ds_read_b64_tr_b16 v[230:231], v13 offset:26624
v_mfma_f32_16x16x32_bf16 a[148:151], v[236:239], v[32:35], a[148:151]
v_accvgpr_read_b32 v192, a128
v_accvgpr_read_b32 v193, a129
v_mfma_f32_16x16x32_bf16 a[152:155], v[236:239], v[64:67], a[152:155]
v_accvgpr_read_b32 v194, a130
v_accvgpr_read_b32 v195, a131
v_mfma_f32_16x16x32_bf16 a[156:159], v[236:239], v[96:99], a[156:159]
s_waitcnt lgkmcnt(4)
v_cvt_pk_bf16_f32 v16, v192, v193
v_mfma_f32_16x16x32_bf16 a[144:147], v[240:243], v[4:7], a[144:147]
ds_read_b64_tr_b16 v[232:233], v13 offset:40960
ds_read_b64_tr_b16 v[234:235], v13 offset:43008
v_mfma_f32_16x16x32_bf16 a[144:147], v[244:247], v[8:11], a[144:147]
v_cvt_pk_bf16_f32 v17, v194, v195
v_accvgpr_read_b32 v200, a132
v_mfma_f32_16x16x32_bf16 a[148:151], v[240:243], v[36:39], a[148:151]
v_accvgpr_read_b32 v201, a133
v_accvgpr_read_b32 v202, a134
v_mfma_f32_16x16x32_bf16 a[148:151], v[244:247], v[40:43], a[148:151]
v_accvgpr_read_b32 v203, a135
v_cvt_pk_bf16_f32 v48, v200, v201
v_mfma_f32_16x16x32_bf16 a[152:155], v[240:243], v[68:71], a[152:155]
ds_read_b64_tr_b16 v[236:237], v13 offset:57344
ds_read_b64_tr_b16 v[238:239], v13 offset:59392
v_mfma_f32_16x16x32_bf16 a[152:155], v[244:247], v[72:75], a[152:155]
v_cvt_pk_bf16_f32 v49, v202, v203
v_accvgpr_read_b32 v208, a136
v_mfma_f32_16x16x32_bf16 a[156:159], v[240:243], v[100:103], a[156:159]
v_accvgpr_read_b32 v209, a137
v_accvgpr_read_b32 v210, a138
v_mfma_f32_16x16x32_bf16 a[156:159], v[244:247], v[104:107], a[156:159]
s_waitcnt lgkmcnt(4)
v_accvgpr_read_b32 v211, a139
v_mfma_f32_16x16x32_bf16 a[144:147], v[224:227], v[128:131], a[144:147]
ds_read_b64_tr_b16 v[240:241], v249 offset:41472
ds_read_b64_tr_b16 v[242:243], v249 offset:43520
v_mfma_f32_16x16x32_bf16 a[144:147], v[228:231], v[144:147], a[144:147]
v_cvt_pk_bf16_f32 v80, v208, v209
v_cvt_pk_bf16_f32 v81, v210, v211
v_mfma_f32_16x16x32_bf16 a[148:151], v[224:227], v[132:135], a[148:151]
v_accvgpr_read_b32 v216, a140
v_accvgpr_read_b32 v217, a141
v_mfma_f32_16x16x32_bf16 a[148:151], v[228:231], v[148:151], a[148:151]
v_accvgpr_read_b32 v218, a142
v_accvgpr_read_b32 v219, a143
v_mfma_f32_16x16x32_bf16 a[152:155], v[224:227], v[136:139], a[152:155]
ds_read_b64_tr_b16 v[244:245], v249 offset:57856
ds_read_b64_tr_b16 v[246:247], v249 offset:59904
v_mfma_f32_16x16x32_bf16 a[152:155], v[228:231], v[152:155], a[152:155]
v_cvt_pk_bf16_f32 v112, v216, v217
v_cvt_pk_bf16_f32 v113, v218, v219
v_mfma_f32_16x16x32_bf16 a[156:159], v[224:227], v[140:143], a[156:159]
v_mfma_f32_16x16x32_bf16 a[156:159], v[228:231], v[156:159], a[156:159]
s_waitcnt lgkmcnt(4)
v_mfma_f32_16x16x32_bf16 a[144:147], v[232:235], v[160:163], a[144:147]
ds_read_b64_tr_b16 v[224:225], v12 offset:8704
ds_read_b64_tr_b16 v[226:227], v12 offset:10752
v_mfma_f32_16x16x32_bf16 a[144:147], v[236:239], v[176:179], a[144:147]
v_mfma_f32_16x16x32_bf16 a[148:151], v[232:235], v[164:167], a[148:151]
v_mfma_f32_16x16x32_bf16 a[148:151], v[236:239], v[180:183], a[148:151]
v_mfma_f32_16x16x32_bf16 a[152:155], v[232:235], v[168:171], a[152:155]
ds_read_b64_tr_b16 v[228:229], v12 offset:25088
ds_read_b64_tr_b16 v[230:231], v12 offset:27136
v_mfma_f32_16x16x32_bf16 a[152:155], v[236:239], v[184:187], a[152:155]
v_mfma_f32_16x16x32_bf16 a[156:159], v[232:235], v[172:175], a[156:159]
s_nop 0
v_accvgpr_read_b32 v196, a144
v_accvgpr_read_b32 v197, a145
v_mfma_f32_16x16x32_bf16 a[156:159], v[236:239], v[188:191], a[156:159]
s_waitcnt lgkmcnt(4)
v_accvgpr_read_b32 v198, a146
v_mfma_f32_16x16x32_bf16 a[160:163], v[240:243], v[4:7], a[160:163]
ds_read_b64_tr_b16 v[232:233], v12 offset:41472
ds_read_b64_tr_b16 v[234:235], v12 offset:43520
v_mfma_f32_16x16x32_bf16 a[160:163], v[244:247], v[8:11], a[160:163]
v_accvgpr_read_b32 v199, a147
v_cvt_pk_bf16_f32 v18, v196, v197
v_mfma_f32_16x16x32_bf16 a[164:167], v[240:243], v[36:39], a[164:167]
v_cvt_pk_bf16_f32 v19, v198, v199
buffer_store_dwordx4 v[16:19], v252, s[20:23], s44 offen offset:0 sc1
v_mfma_f32_16x16x32_bf16 a[164:167], v[244:247], v[40:43], a[164:167]
v_accvgpr_read_b32 v204, a148
v_accvgpr_read_b32 v205, a149
v_mfma_f32_16x16x32_bf16 a[168:171], v[240:243], v[68:71], a[168:171]
ds_read_b64_tr_b16 v[236:237], v12 offset:57856
ds_read_b64_tr_b16 v[238:239], v12 offset:59904
v_mfma_f32_16x16x32_bf16 a[168:171], v[244:247], v[72:75], a[168:171]
v_accvgpr_read_b32 v206, a150
v_accvgpr_read_b32 v207, a151
v_mfma_f32_16x16x32_bf16 a[172:175], v[240:243], v[100:103], a[172:175]
v_cvt_pk_bf16_f32 v50, v204, v205
v_cvt_pk_bf16_f32 v51, v206, v207
v_mfma_f32_16x16x32_bf16 a[172:175], v[244:247], v[104:107], a[172:175]
s_waitcnt lgkmcnt(4)
buffer_store_dwordx4 v[48:51], v252, s[20:23], s45 offen offset:0 sc1
v_mfma_f32_16x16x32_bf16 a[160:163], v[224:227], v[128:131], a[160:163]
ds_read_b64_tr_b16 v[240:241], v249 offset:8704
ds_read_b64_tr_b16 v[242:243], v249 offset:10752
v_mfma_f32_16x16x32_bf16 a[160:163], v[228:231], v[144:147], a[160:163]
v_accvgpr_read_b32 v212, a152
v_accvgpr_read_b32 v213, a153
v_mfma_f32_16x16x32_bf16 a[164:167], v[224:227], v[132:135], a[164:167]
v_accvgpr_read_b32 v214, a154
v_accvgpr_read_b32 v215, a155
v_mfma_f32_16x16x32_bf16 a[164:167], v[228:231], v[148:151], a[164:167]
v_cvt_pk_bf16_f32 v82, v212, v213
v_cvt_pk_bf16_f32 v83, v214, v215
v_mfma_f32_16x16x32_bf16 a[168:171], v[224:227], v[136:139], a[168:171]
ds_read_b64_tr_b16 v[244:245], v250 offset:8704
ds_read_b64_tr_b16 v[246:247], v250 offset:10752
v_mfma_f32_16x16x32_bf16 a[168:171], v[228:231], v[152:155], a[168:171]
buffer_store_dwordx4 v[80:83], v252, s[20:23], s46 offen offset:0 sc1
v_accvgpr_read_b32 v220, a156
v_mfma_f32_16x16x32_bf16 a[172:175], v[224:227], v[140:143], a[172:175]
v_accvgpr_read_b32 v221, a157
v_accvgpr_read_b32 v222, a158
v_mfma_f32_16x16x32_bf16 a[172:175], v[228:231], v[156:159], a[172:175]
s_waitcnt lgkmcnt(4)
v_accvgpr_read_b32 v223, a159
v_mfma_f32_16x16x32_bf16 a[160:163], v[232:235], v[160:163], a[160:163]
ds_read_b64_tr_b16 v[224:225], v250 offset:41472
ds_read_b64_tr_b16 v[226:227], v250 offset:43520
v_mfma_f32_16x16x32_bf16 a[160:163], v[236:239], v[176:179], a[160:163]
v_cvt_pk_bf16_f32 v114, v220, v221
v_cvt_pk_bf16_f32 v115, v222, v223
v_mfma_f32_16x16x32_bf16 a[164:167], v[232:235], v[164:167], a[164:167]
buffer_store_dwordx4 v[112:115], v252, s[20:23], s47 offen offset:0 sc1
v_mfma_f32_16x16x32_bf16 a[164:167], v[236:239], v[180:183], a[164:167]
v_mfma_f32_16x16x32_bf16 a[168:171], v[232:235], v[168:171], a[168:171]
ds_read_b64_tr_b16 v[228:229], v250 offset:57856
ds_read_b64_tr_b16 v[230:231], v250 offset:59904
v_mfma_f32_16x16x32_bf16 a[168:171], v[236:239], v[184:187], a[168:171]
v_mfma_f32_16x16x32_bf16 a[172:175], v[232:235], v[172:175], a[172:175]
v_mfma_f32_16x16x32_bf16 a[172:175], v[236:239], v[188:191], a[172:175]
s_waitcnt lgkmcnt(4)
v_mfma_f32_16x16x32_bf16 a[160:163], v[240:243], v[0:3], a[160:163]
ds_read_b64_tr_b16 v[232:233], v13 offset:8704
ds_read_b64_tr_b16 v[234:235], v13 offset:10752
v_mfma_f32_16x16x32_bf16 a[164:167], v[240:243], v[32:35], a[164:167]
v_mfma_f32_16x16x32_bf16 a[168:171], v[240:243], v[64:67], a[168:171]
v_mfma_f32_16x16x32_bf16 a[172:175], v[240:243], v[96:99], a[172:175]
v_mfma_f32_16x16x32_bf16 a[176:179], v[244:247], v[0:3], a[176:179]
ds_read_b64_tr_b16 v[236:237], v13 offset:25088
ds_read_b64_tr_b16 v[238:239], v13 offset:27136
v_mfma_f32_16x16x32_bf16 a[180:183], v[244:247], v[32:35], a[180:183]
v_accvgpr_read_b32 v192, a160
v_accvgpr_read_b32 v193, a161
v_mfma_f32_16x16x32_bf16 a[184:187], v[244:247], v[64:67], a[184:187]
v_accvgpr_read_b32 v194, a162
v_accvgpr_read_b32 v195, a163
v_mfma_f32_16x16x32_bf16 a[188:191], v[244:247], v[96:99], a[188:191]
s_waitcnt lgkmcnt(4)
v_cvt_pk_bf16_f32 v20, v192, v193
v_mfma_f32_16x16x32_bf16 a[176:179], v[224:227], v[4:7], a[176:179]
ds_read_b64_tr_b16 v[240:241], v13 offset:41472
ds_read_b64_tr_b16 v[242:243], v13 offset:43520
v_mfma_f32_16x16x32_bf16 a[176:179], v[228:231], v[8:11], a[176:179]
v_cvt_pk_bf16_f32 v21, v194, v195
v_accvgpr_read_b32 v200, a164
v_mfma_f32_16x16x32_bf16 a[180:183], v[224:227], v[36:39], a[180:183]
v_accvgpr_read_b32 v201, a165
v_accvgpr_read_b32 v202, a166
v_mfma_f32_16x16x32_bf16 a[180:183], v[228:231], v[40:43], a[180:183]
v_accvgpr_read_b32 v203, a167
v_cvt_pk_bf16_f32 v52, v200, v201
v_mfma_f32_16x16x32_bf16 a[184:187], v[224:227], v[68:71], a[184:187]
ds_read_b64_tr_b16 v[244:245], v13 offset:57856
ds_read_b64_tr_b16 v[246:247], v13 offset:59904
v_mfma_f32_16x16x32_bf16 a[184:187], v[228:231], v[72:75], a[184:187]
v_cvt_pk_bf16_f32 v53, v202, v203
v_accvgpr_read_b32 v208, a168
v_mfma_f32_16x16x32_bf16 a[188:191], v[224:227], v[100:103], a[188:191]
v_accvgpr_read_b32 v209, a169
v_accvgpr_read_b32 v210, a170
v_mfma_f32_16x16x32_bf16 a[188:191], v[228:231], v[104:107], a[188:191]
s_waitcnt lgkmcnt(4)
v_accvgpr_read_b32 v211, a171
v_mfma_f32_16x16x32_bf16 a[176:179], v[232:235], v[128:131], a[176:179]
ds_read_b64_tr_b16 v[224:225], v249 offset:45056
ds_read_b64_tr_b16 v[226:227], v249 offset:47104
v_mfma_f32_16x16x32_bf16 a[176:179], v[236:239], v[144:147], a[176:179]
v_cvt_pk_bf16_f32 v84, v208, v209
v_cvt_pk_bf16_f32 v85, v210, v211
v_mfma_f32_16x16x32_bf16 a[180:183], v[232:235], v[132:135], a[180:183]
v_accvgpr_read_b32 v216, a172
v_accvgpr_read_b32 v217, a173
v_mfma_f32_16x16x32_bf16 a[180:183], v[236:239], v[148:151], a[180:183]
v_accvgpr_read_b32 v218, a174
v_accvgpr_read_b32 v219, a175
v_mfma_f32_16x16x32_bf16 a[184:187], v[232:235], v[136:139], a[184:187]
ds_read_b64_tr_b16 v[228:229], v249 offset:61440
ds_read_b64_tr_b16 v[230:231], v249 offset:63488
v_mfma_f32_16x16x32_bf16 a[184:187], v[236:239], v[152:155], a[184:187]
v_cvt_pk_bf16_f32 v116, v216, v217
v_cvt_pk_bf16_f32 v117, v218, v219
v_mfma_f32_16x16x32_bf16 a[188:191], v[232:235], v[140:143], a[188:191]
v_mfma_f32_16x16x32_bf16 a[188:191], v[236:239], v[156:159], a[188:191]
s_waitcnt lgkmcnt(4)
v_mfma_f32_16x16x32_bf16 a[176:179], v[240:243], v[160:163], a[176:179]
ds_read_b64_tr_b16 v[232:233], v12 offset:12288
ds_read_b64_tr_b16 v[234:235], v12 offset:14336
v_mfma_f32_16x16x32_bf16 a[176:179], v[244:247], v[176:179], a[176:179]
v_mfma_f32_16x16x32_bf16 a[180:183], v[240:243], v[164:167], a[180:183]
v_mfma_f32_16x16x32_bf16 a[180:183], v[244:247], v[180:183], a[180:183]
v_mfma_f32_16x16x32_bf16 a[184:187], v[240:243], v[168:171], a[184:187]
ds_read_b64_tr_b16 v[236:237], v12 offset:28672
ds_read_b64_tr_b16 v[238:239], v12 offset:30720
v_mfma_f32_16x16x32_bf16 a[184:187], v[244:247], v[184:187], a[184:187]
v_mfma_f32_16x16x32_bf16 a[188:191], v[240:243], v[172:175], a[188:191]
s_nop 0
v_accvgpr_read_b32 v196, a176
v_accvgpr_read_b32 v197, a177
v_mfma_f32_16x16x32_bf16 a[188:191], v[244:247], v[188:191], a[188:191]
s_waitcnt lgkmcnt(4)
v_accvgpr_read_b32 v198, a178
v_mfma_f32_16x16x32_bf16 a[192:195], v[224:227], v[4:7], a[192:195]
ds_read_b64_tr_b16 v[240:241], v12 offset:45056
ds_read_b64_tr_b16 v[242:243], v12 offset:47104
v_mfma_f32_16x16x32_bf16 a[192:195], v[228:231], v[8:11], a[192:195]
v_accvgpr_read_b32 v199, a179
v_cvt_pk_bf16_f32 v22, v196, v197
v_mfma_f32_16x16x32_bf16 a[196:199], v[224:227], v[36:39], a[196:199]
v_cvt_pk_bf16_f32 v23, v198, v199
buffer_store_dwordx4 v[20:23], v252, s[20:23], s44 offen offset:1024 sc1
v_mfma_f32_16x16x32_bf16 a[196:199], v[228:231], v[40:43], a[196:199]
v_accvgpr_read_b32 v204, a180
v_accvgpr_read_b32 v205, a181
v_mfma_f32_16x16x32_bf16 a[200:203], v[224:227], v[68:71], a[200:203]
ds_read_b64_tr_b16 v[244:245], v12 offset:61440
ds_read_b64_tr_b16 v[246:247], v12 offset:63488
v_mfma_f32_16x16x32_bf16 a[200:203], v[228:231], v[72:75], a[200:203]
v_accvgpr_read_b32 v206, a182
v_accvgpr_read_b32 v207, a183
v_mfma_f32_16x16x32_bf16 a[204:207], v[224:227], v[100:103], a[204:207]
v_cvt_pk_bf16_f32 v54, v204, v205
v_cvt_pk_bf16_f32 v55, v206, v207
v_mfma_f32_16x16x32_bf16 a[204:207], v[228:231], v[104:107], a[204:207]
s_waitcnt lgkmcnt(4)
buffer_store_dwordx4 v[52:55], v252, s[20:23], s45 offen offset:1024 sc1
v_mfma_f32_16x16x32_bf16 a[192:195], v[232:235], v[128:131], a[192:195]
ds_read_b64_tr_b16 v[224:225], v249 offset:12288
ds_read_b64_tr_b16 v[226:227], v249 offset:14336
v_mfma_f32_16x16x32_bf16 a[192:195], v[236:239], v[144:147], a[192:195]
v_accvgpr_read_b32 v212, a184
v_accvgpr_read_b32 v213, a185
v_mfma_f32_16x16x32_bf16 a[196:199], v[232:235], v[132:135], a[196:199]
v_accvgpr_read_b32 v214, a186
v_accvgpr_read_b32 v215, a187
v_mfma_f32_16x16x32_bf16 a[196:199], v[236:239], v[148:151], a[196:199]
v_cvt_pk_bf16_f32 v86, v212, v213
v_cvt_pk_bf16_f32 v87, v214, v215
v_mfma_f32_16x16x32_bf16 a[200:203], v[232:235], v[136:139], a[200:203]
ds_read_b64_tr_b16 v[228:229], v250 offset:12288
ds_read_b64_tr_b16 v[230:231], v250 offset:14336
v_mfma_f32_16x16x32_bf16 a[200:203], v[236:239], v[152:155], a[200:203]
buffer_store_dwordx4 v[84:87], v252, s[20:23], s46 offen offset:1024 sc1
v_accvgpr_read_b32 v220, a188
v_mfma_f32_16x16x32_bf16 a[204:207], v[232:235], v[140:143], a[204:207]
v_accvgpr_read_b32 v221, a189
v_accvgpr_read_b32 v222, a190
v_mfma_f32_16x16x32_bf16 a[204:207], v[236:239], v[156:159], a[204:207]
s_waitcnt lgkmcnt(4)
v_accvgpr_read_b32 v223, a191
v_mfma_f32_16x16x32_bf16 a[192:195], v[240:243], v[160:163], a[192:195]
ds_read_b64_tr_b16 v[232:233], v250 offset:45056
ds_read_b64_tr_b16 v[234:235], v250 offset:47104
v_mfma_f32_16x16x32_bf16 a[192:195], v[244:247], v[176:179], a[192:195]
v_cvt_pk_bf16_f32 v118, v220, v221
v_cvt_pk_bf16_f32 v119, v222, v223
v_mfma_f32_16x16x32_bf16 a[196:199], v[240:243], v[164:167], a[196:199]
buffer_store_dwordx4 v[116:119], v252, s[20:23], s47 offen offset:1024 sc1
v_mfma_f32_16x16x32_bf16 a[196:199], v[244:247], v[180:183], a[196:199]
v_mfma_f32_16x16x32_bf16 a[200:203], v[240:243], v[168:171], a[200:203]
ds_read_b64_tr_b16 v[236:237], v250 offset:61440
ds_read_b64_tr_b16 v[238:239], v250 offset:63488
v_mfma_f32_16x16x32_bf16 a[200:203], v[244:247], v[184:187], a[200:203]
v_mfma_f32_16x16x32_bf16 a[204:207], v[240:243], v[172:175], a[204:207]
v_mfma_f32_16x16x32_bf16 a[204:207], v[244:247], v[188:191], a[204:207]
s_waitcnt lgkmcnt(4)
v_mfma_f32_16x16x32_bf16 a[192:195], v[224:227], v[0:3], a[192:195]
ds_read_b64_tr_b16 v[240:241], v13 offset:12288
ds_read_b64_tr_b16 v[242:243], v13 offset:14336
v_mfma_f32_16x16x32_bf16 a[196:199], v[224:227], v[32:35], a[196:199]
v_mfma_f32_16x16x32_bf16 a[200:203], v[224:227], v[64:67], a[200:203]
v_mfma_f32_16x16x32_bf16 a[204:207], v[224:227], v[96:99], a[204:207]
v_mfma_f32_16x16x32_bf16 a[208:211], v[228:231], v[0:3], a[208:211]
ds_read_b64_tr_b16 v[244:245], v13 offset:28672
ds_read_b64_tr_b16 v[246:247], v13 offset:30720
v_mfma_f32_16x16x32_bf16 a[212:215], v[228:231], v[32:35], a[212:215]
v_accvgpr_read_b32 v192, a192
v_accvgpr_read_b32 v193, a193
v_mfma_f32_16x16x32_bf16 a[216:219], v[228:231], v[64:67], a[216:219]
v_accvgpr_read_b32 v194, a194
v_accvgpr_read_b32 v195, a195
v_mfma_f32_16x16x32_bf16 a[220:223], v[228:231], v[96:99], a[220:223]
s_waitcnt lgkmcnt(4)
v_cvt_pk_bf16_f32 v24, v192, v193
v_mfma_f32_16x16x32_bf16 a[208:211], v[232:235], v[4:7], a[208:211]
ds_read_b64_tr_b16 v[224:225], v13 offset:45056
ds_read_b64_tr_b16 v[226:227], v13 offset:47104
v_mfma_f32_16x16x32_bf16 a[208:211], v[236:239], v[8:11], a[208:211]
v_cvt_pk_bf16_f32 v25, v194, v195
v_accvgpr_read_b32 v200, a196
v_mfma_f32_16x16x32_bf16 a[212:215], v[232:235], v[36:39], a[212:215]
v_accvgpr_read_b32 v201, a197
v_accvgpr_read_b32 v202, a198
v_mfma_f32_16x16x32_bf16 a[212:215], v[236:239], v[40:43], a[212:215]
v_accvgpr_read_b32 v203, a199
v_cvt_pk_bf16_f32 v56, v200, v201
v_mfma_f32_16x16x32_bf16 a[216:219], v[232:235], v[68:71], a[216:219]
ds_read_b64_tr_b16 v[228:229], v13 offset:61440
ds_read_b64_tr_b16 v[230:231], v13 offset:63488
v_mfma_f32_16x16x32_bf16 a[216:219], v[236:239], v[72:75], a[216:219]
v_cvt_pk_bf16_f32 v57, v202, v203
v_accvgpr_read_b32 v208, a200
v_mfma_f32_16x16x32_bf16 a[220:223], v[232:235], v[100:103], a[220:223]
v_accvgpr_read_b32 v209, a201
v_accvgpr_read_b32 v210, a202
v_mfma_f32_16x16x32_bf16 a[220:223], v[236:239], v[104:107], a[220:223]
s_waitcnt lgkmcnt(4)
v_accvgpr_read_b32 v211, a203
v_mfma_f32_16x16x32_bf16 a[208:211], v[240:243], v[128:131], a[208:211]
ds_read_b64_tr_b16 v[232:233], v249 offset:45568
ds_read_b64_tr_b16 v[234:235], v249 offset:47616
v_mfma_f32_16x16x32_bf16 a[208:211], v[244:247], v[144:147], a[208:211]
v_cvt_pk_bf16_f32 v88, v208, v209
v_cvt_pk_bf16_f32 v89, v210, v211
v_mfma_f32_16x16x32_bf16 a[212:215], v[240:243], v[132:135], a[212:215]
v_accvgpr_read_b32 v216, a204
v_accvgpr_read_b32 v217, a205
v_mfma_f32_16x16x32_bf16 a[212:215], v[244:247], v[148:151], a[212:215]
v_accvgpr_read_b32 v218, a206
v_accvgpr_read_b32 v219, a207
v_mfma_f32_16x16x32_bf16 a[216:219], v[240:243], v[136:139], a[216:219]
ds_read_b64_tr_b16 v[236:237], v249 offset:61952
ds_read_b64_tr_b16 v[238:239], v249 offset:64000
v_mfma_f32_16x16x32_bf16 a[216:219], v[244:247], v[152:155], a[216:219]
v_cvt_pk_bf16_f32 v120, v216, v217
v_cvt_pk_bf16_f32 v121, v218, v219
v_mfma_f32_16x16x32_bf16 a[220:223], v[240:243], v[140:143], a[220:223]
v_mfma_f32_16x16x32_bf16 a[220:223], v[244:247], v[156:159], a[220:223]
s_waitcnt lgkmcnt(4)
v_mfma_f32_16x16x32_bf16 a[208:211], v[224:227], v[160:163], a[208:211]
ds_read_b64_tr_b16 v[240:241], v12 offset:12800
ds_read_b64_tr_b16 v[242:243], v12 offset:14848
v_mfma_f32_16x16x32_bf16 a[208:211], v[228:231], v[176:179], a[208:211]
v_mfma_f32_16x16x32_bf16 a[212:215], v[224:227], v[164:167], a[212:215]
v_mfma_f32_16x16x32_bf16 a[212:215], v[228:231], v[180:183], a[212:215]
v_mfma_f32_16x16x32_bf16 a[216:219], v[224:227], v[168:171], a[216:219]
ds_read_b64_tr_b16 v[244:245], v12 offset:29184
ds_read_b64_tr_b16 v[246:247], v12 offset:31232
v_mfma_f32_16x16x32_bf16 a[216:219], v[228:231], v[184:187], a[216:219]
v_mfma_f32_16x16x32_bf16 a[220:223], v[224:227], v[172:175], a[220:223]
s_nop 0
v_accvgpr_read_b32 v196, a208
v_accvgpr_read_b32 v197, a209
v_mfma_f32_16x16x32_bf16 a[220:223], v[228:231], v[188:191], a[220:223]
s_waitcnt lgkmcnt(4)
v_accvgpr_read_b32 v198, a210
v_mfma_f32_16x16x32_bf16 a[224:227], v[232:235], v[4:7], a[224:227]
ds_read_b64_tr_b16 v[224:225], v12 offset:45568
ds_read_b64_tr_b16 v[226:227], v12 offset:47616
v_mfma_f32_16x16x32_bf16 a[224:227], v[236:239], v[8:11], a[224:227]
v_accvgpr_read_b32 v199, a211
v_cvt_pk_bf16_f32 v26, v196, v197
v_mfma_f32_16x16x32_bf16 a[228:231], v[232:235], v[36:39], a[228:231]
v_cvt_pk_bf16_f32 v27, v198, v199
buffer_store_dwordx4 v[24:27], v252, s[20:23], s44 offen offset:2048 sc1
v_mfma_f32_16x16x32_bf16 a[228:231], v[236:239], v[40:43], a[228:231]
v_accvgpr_read_b32 v204, a212
v_accvgpr_read_b32 v205, a213
v_mfma_f32_16x16x32_bf16 a[232:235], v[232:235], v[68:71], a[232:235]
ds_read_b64_tr_b16 v[228:229], v12 offset:61952
ds_read_b64_tr_b16 v[230:231], v12 offset:64000
v_mfma_f32_16x16x32_bf16 a[232:235], v[236:239], v[72:75], a[232:235]
v_accvgpr_read_b32 v206, a214
v_accvgpr_read_b32 v207, a215
v_mfma_f32_16x16x32_bf16 a[236:239], v[232:235], v[100:103], a[236:239]
v_cvt_pk_bf16_f32 v58, v204, v205
v_cvt_pk_bf16_f32 v59, v206, v207
v_mfma_f32_16x16x32_bf16 a[236:239], v[236:239], v[104:107], a[236:239]
s_waitcnt lgkmcnt(4)
buffer_store_dwordx4 v[56:59], v252, s[20:23], s45 offen offset:2048 sc1
v_mfma_f32_16x16x32_bf16 a[224:227], v[240:243], v[128:131], a[224:227]
ds_read_b64_tr_b16 v[232:233], v249 offset:12800
ds_read_b64_tr_b16 v[234:235], v249 offset:14848
v_mfma_f32_16x16x32_bf16 a[224:227], v[244:247], v[144:147], a[224:227]
v_accvgpr_read_b32 v212, a216
v_accvgpr_read_b32 v213, a217
v_mfma_f32_16x16x32_bf16 a[228:231], v[240:243], v[132:135], a[228:231]
v_accvgpr_read_b32 v214, a218
v_accvgpr_read_b32 v215, a219
v_mfma_f32_16x16x32_bf16 a[228:231], v[244:247], v[148:151], a[228:231]
v_cvt_pk_bf16_f32 v90, v212, v213
v_cvt_pk_bf16_f32 v91, v214, v215
v_mfma_f32_16x16x32_bf16 a[232:235], v[240:243], v[136:139], a[232:235]
ds_read_b64_tr_b16 v[236:237], v250 offset:12800
ds_read_b64_tr_b16 v[238:239], v250 offset:14848
v_mfma_f32_16x16x32_bf16 a[232:235], v[244:247], v[152:155], a[232:235]
buffer_store_dwordx4 v[88:91], v252, s[20:23], s46 offen offset:2048 sc1
v_accvgpr_read_b32 v220, a220
v_mfma_f32_16x16x32_bf16 a[236:239], v[240:243], v[140:143], a[236:239]
v_accvgpr_read_b32 v221, a221
v_accvgpr_read_b32 v222, a222
v_mfma_f32_16x16x32_bf16 a[236:239], v[244:247], v[156:159], a[236:239]
s_waitcnt lgkmcnt(4)
v_accvgpr_read_b32 v223, a223
v_mfma_f32_16x16x32_bf16 a[224:227], v[224:227], v[160:163], a[224:227]
ds_read_b64_tr_b16 v[240:241], v250 offset:45568
ds_read_b64_tr_b16 v[242:243], v250 offset:47616
v_mfma_f32_16x16x32_bf16 a[224:227], v[228:231], v[176:179], a[224:227]
v_cvt_pk_bf16_f32 v122, v220, v221
v_cvt_pk_bf16_f32 v123, v222, v223
v_mfma_f32_16x16x32_bf16 a[228:231], v[224:227], v[164:167], a[228:231]
buffer_store_dwordx4 v[120:123], v252, s[20:23], s47 offen offset:2048 sc1
v_mfma_f32_16x16x32_bf16 a[228:231], v[228:231], v[180:183], a[228:231]
v_mfma_f32_16x16x32_bf16 a[232:235], v[224:227], v[168:171], a[232:235]
ds_read_b64_tr_b16 v[244:245], v250 offset:61952
ds_read_b64_tr_b16 v[246:247], v250 offset:64000
v_mfma_f32_16x16x32_bf16 a[232:235], v[228:231], v[184:187], a[232:235]
v_mfma_f32_16x16x32_bf16 a[236:239], v[224:227], v[172:175], a[236:239]
v_mfma_f32_16x16x32_bf16 a[236:239], v[228:231], v[188:191], a[236:239]
s_waitcnt lgkmcnt(4)
v_mfma_f32_16x16x32_bf16 a[224:227], v[232:235], v[0:3], a[224:227]
ds_read_b64_tr_b16 v[224:225], v13 offset:12800
ds_read_b64_tr_b16 v[226:227], v13 offset:14848
v_mfma_f32_16x16x32_bf16 a[228:231], v[232:235], v[32:35], a[228:231]
v_mfma_f32_16x16x32_bf16 a[232:235], v[232:235], v[64:67], a[232:235]
v_mfma_f32_16x16x32_bf16 a[236:239], v[232:235], v[96:99], a[236:239]
v_mfma_f32_16x16x32_bf16 a[240:243], v[236:239], v[0:3], a[240:243]
ds_read_b64_tr_b16 v[228:229], v13 offset:29184
ds_read_b64_tr_b16 v[230:231], v13 offset:31232
v_mfma_f32_16x16x32_bf16 a[244:247], v[236:239], v[32:35], a[244:247]
v_accvgpr_read_b32 v192, a224
v_accvgpr_read_b32 v193, a225
v_mfma_f32_16x16x32_bf16 a[248:251], v[236:239], v[64:67], a[248:251]
v_accvgpr_read_b32 v194, a226
v_accvgpr_read_b32 v195, a227
v_mfma_f32_16x16x32_bf16 a[252:255], v[236:239], v[96:99], a[252:255]
s_waitcnt lgkmcnt(4)
v_cvt_pk_bf16_f32 v28, v192, v193
v_mfma_f32_16x16x32_bf16 a[240:243], v[240:243], v[4:7], a[240:243]
ds_read_b64_tr_b16 v[232:233], v13 offset:45568
ds_read_b64_tr_b16 v[234:235], v13 offset:47616
v_mfma_f32_16x16x32_bf16 a[240:243], v[244:247], v[8:11], a[240:243]
v_cvt_pk_bf16_f32 v29, v194, v195
v_accvgpr_read_b32 v200, a228
v_mfma_f32_16x16x32_bf16 a[244:247], v[240:243], v[36:39], a[244:247]
v_accvgpr_read_b32 v201, a229
v_accvgpr_read_b32 v202, a230
v_mfma_f32_16x16x32_bf16 a[244:247], v[244:247], v[40:43], a[244:247]
v_accvgpr_read_b32 v203, a231
v_cvt_pk_bf16_f32 v60, v200, v201
v_mfma_f32_16x16x32_bf16 a[248:251], v[240:243], v[68:71], a[248:251]
ds_read_b64_tr_b16 v[236:237], v13 offset:61952
ds_read_b64_tr_b16 v[238:239], v13 offset:64000
v_mfma_f32_16x16x32_bf16 a[248:251], v[244:247], v[72:75], a[248:251]
v_cvt_pk_bf16_f32 v61, v202, v203
v_accvgpr_read_b32 v208, a232
v_mfma_f32_16x16x32_bf16 a[252:255], v[240:243], v[100:103], a[252:255]
v_accvgpr_read_b32 v209, a233
v_accvgpr_read_b32 v210, a234
v_mfma_f32_16x16x32_bf16 a[252:255], v[244:247], v[104:107], a[252:255]
s_waitcnt lgkmcnt(4)
v_accvgpr_read_b32 v211, a235
v_mfma_f32_16x16x32_bf16 a[240:243], v[224:227], v[128:131], a[240:243]
v_cvt_pk_bf16_f32 v92, v208, v209
v_cvt_pk_bf16_f32 v93, v210, v211
v_mfma_f32_16x16x32_bf16 a[240:243], v[228:231], v[144:147], a[240:243]
v_accvgpr_read_b32 v216, a236
v_accvgpr_read_b32 v217, a237
v_mfma_f32_16x16x32_bf16 a[244:247], v[224:227], v[132:135], a[244:247]
v_accvgpr_read_b32 v218, a238
v_accvgpr_read_b32 v219, a239
v_mfma_f32_16x16x32_bf16 a[244:247], v[228:231], v[148:151], a[244:247]
v_cvt_pk_bf16_f32 v124, v216, v217
v_cvt_pk_bf16_f32 v125, v218, v219
v_mfma_f32_16x16x32_bf16 a[248:251], v[224:227], v[136:139], a[248:251]
v_mfma_f32_16x16x32_bf16 a[248:251], v[228:231], v[152:155], a[248:251]
v_mfma_f32_16x16x32_bf16 a[252:255], v[224:227], v[140:143], a[252:255]
v_mfma_f32_16x16x32_bf16 a[252:255], v[228:231], v[156:159], a[252:255]
s_waitcnt lgkmcnt(0)
v_mfma_f32_16x16x32_bf16 a[240:243], v[232:235], v[160:163], a[240:243]
v_mfma_f32_16x16x32_bf16 a[240:243], v[236:239], v[176:179], a[240:243]
v_mfma_f32_16x16x32_bf16 a[244:247], v[232:235], v[164:167], a[244:247]
v_mfma_f32_16x16x32_bf16 a[244:247], v[236:239], v[180:183], a[244:247]
v_mfma_f32_16x16x32_bf16 a[248:251], v[232:235], v[168:171], a[248:251]
v_mfma_f32_16x16x32_bf16 a[248:251], v[236:239], v[184:187], a[248:251]
v_mfma_f32_16x16x32_bf16 a[252:255], v[232:235], v[172:175], a[252:255]
s_nop 2
v_accvgpr_read_b32 v196, a240
v_accvgpr_read_b32 v197, a241
v_accvgpr_read_b32 v198, a242
v_accvgpr_read_b32 v199, a243
v_mfma_f32_16x16x32_bf16 a[252:255], v[236:239], v[188:191], a[252:255]
v_cvt_pk_bf16_f32 v30, v196, v197
v_cvt_pk_bf16_f32 v31, v198, v199
buffer_store_dwordx4 v[28:31], v252, s[20:23], s44 offen offset:3072 sc1
v_accvgpr_read_b32 v204, a244
v_accvgpr_read_b32 v205, a245
v_accvgpr_read_b32 v206, a246
v_accvgpr_read_b32 v207, a247
v_cvt_pk_bf16_f32 v62, v204, v205
v_cvt_pk_bf16_f32 v63, v206, v207
buffer_store_dwordx4 v[60:63], v252, s[20:23], s45 offen offset:3072 sc1
v_accvgpr_read_b32 v212, a248
v_accvgpr_read_b32 v213, a249
v_accvgpr_read_b32 v214, a250
v_accvgpr_read_b32 v215, a251
v_cvt_pk_bf16_f32 v94, v212, v213
v_cvt_pk_bf16_f32 v95, v214, v215
buffer_store_dwordx4 v[92:95], v252, s[20:23], s46 offen offset:3072 sc1
v_accvgpr_read_b32 v220, a252
v_accvgpr_read_b32 v221, a253
v_accvgpr_read_b32 v222, a254
v_accvgpr_read_b32 v223, a255
v_cvt_pk_bf16_f32 v126, v220, v221
v_cvt_pk_bf16_f32 v127, v222, v223
buffer_store_dwordx4 v[124:127], v252, s[20:23], s47 offen offset:3072 sc1
s_branch L2_chk
L2_chk:
LC_start:
s_cmp_lg_u64 vcc, 0
s_cselect_b32 s98, 1, 0
LC_again:
s_lshl_b32 s48, s38, 7
s_lshl_b32 s49, s38, 7
s_lshl_b32 s50, s38, 7
s_mov_b32 s51, s37
s_cmp_eq_u32 s37, 5
s_cselect_b32 s14, 1, 0
s_cselect_b32 s52, 0x7fff0000, s52
s_cselect_b32 s53, 0x7fff0000, s53
s_cselect_b32 s54, 0x7fff0000, s54
s_cmp_eq_u32 s34, 0
s_cselect_b32 s15, 0x6c00000, s52
s_cselect_b32 s15, s15, 0x7fff0000
LC_common:
s_nop 0
s_bfe_u32 s3, s2, 0x30003
s_lshl_b32 s13, s34, 4
s_or_b32 s13, s13, s3
s_lshl_b32 s13, s13, 11
s_lshr_b32 s101, s3, 1
s_xor_b32 s101, s101, s34
s_lshl_b32 s101, s101, 10
s_add_u32 s101, s101, s100
s_cmp_eq_u32 s14, 1
s_cselect_b32 s13, 0x7fff0000, s13
s_add_u32 s28, s4, 0x7000000
s_addc_u32 s29, s5, 0
s_mov_b32 s30, 0x4e2000
s_mov_b32 s31, 0x00020000
s_lshl_b32 s33, s34, 7
v_bfe_u32 v5, v252, 4, 3
v_lshrrev_b32 v6, 8, v252
v_xor_b32 v5, v5, v6
v_lshrrev_b32 v6, 7, v252
v_lshl_add_u32 v6, v6, 9, s33
v_lshl_add_u32 v5, v5, 4, v6
v_xor_b32 v6, 64, v5
v_add_u32 v6, 0x1000, v6
s_cmp_ge_u32 s99, 60
s_cbranch_scc0 LC_side
LC_sideok:
s_add_u32 m0, s101, 0
s_nop 0
buffer_load_dwordx4 v5, s[28:31], s52 offen sc1 lds
s_add_u32 m0, s101, 4096
s_nop 0
buffer_load_dwordx4 v6, s[28:31], s52 offen sc1 lds
s_add_u32 m0, s101, 8192
s_nop 0
buffer_load_dwordx4 v5, s[28:31], s53 offen sc1 lds
s_add_u32 m0, s101, 12288
s_nop 0
buffer_load_dwordx4 v6, s[28:31], s53 offen sc1 lds
s_add_u32 m0, s101, 16384
s_nop 0
buffer_load_dwordx4 v5, s[28:31], s54 offen sc1 lds
s_add_u32 m0, s101, 20480
s_nop 0
buffer_load_dwordx4 v6, s[28:31], s54 offen sc1 lds
s_xor_b32 s33, s13, 0x0
buffer_load_dwordx4 a[0:3], v252, s[56:59], s33 offen offset:0
buffer_load_dwordx4 a[4:7], v252, s[56:59], s33 offen offset:1024
s_xor_b32 s35, s13, 0x4000
buffer_load_dwordx4 a[64:67], v252, s[56:59], s35 offen offset:0
buffer_load_dwordx4 a[68:71], v252, s[56:59], s35 offen offset:1024
s_xor_b32 s39, s13, 0x800
buffer_load_dwordx4 a[8:11], v252, s[56:59], s39 offen offset:0
buffer_load_dwordx4 a[12:15], v252, s[56:59], s39 offen offset:1024
s_xor_b32 s32, s13, 0x4800
buffer_load_dwordx4 a[72:75], v252, s[56:59], s32 offen offset:0
buffer_load_dwordx4 a[76:79], v252, s[56:59], s32 offen offset:1024
s_lshl_b32 s32, s34, 2
s_add_u32 s32, s32, s100
s_and_b32 s33, s98, 1
v_mov_b32 v42, s32
v_mov_b32 v43, s33
ds_write_b32 v42, v43 offset:24576
v_lshrrev_b32 v0, 4, v252
v_and_b32 v2, 15, v0
v_lshrrev_b32 v3, 4, v0
s_add_u32 s8, s6, 0x0
s_addc_u32 s9, s7, 0
s_mov_b32 s10, 0x4e2000
s_mov_b32 s11, 0x00020000
s_lshl_b32 s55, s34, 13
s_add_u32 s55, s55, 0x21000
s_lshl_b32 s33, s34, 7
v_bfe_u32 v9, v252, 4, 3
v_lshrrev_b32 v1, 7, v252
v_xor_b32 v9, v9, v1
v_lshl_add_u32 v1, v1, 9, s33
v_lshl_add_u32 v9, v9, 4, v1
s_lshl_b32 s73, s34, 11
s_add_u32 s73, s73, 0xe000
v_mov_b32 v4, 0x7fff0000
v_cmp_eq_u32 vcc, 0, v3
v_mov_b32 v1, s52
s_nop 0
v_cndmask_b32 v4, v4, v1, vcc
v_cmp_eq_u32 vcc, 1, v3
v_mov_b32 v1, s53
s_nop 0
v_cndmask_b32 v4, v4, v1, vcc
v_cmp_eq_u32 vcc, 2, v3
v_mov_b32 v1, s54
s_nop 0
v_cndmask_b32 v4, v4, v1, vcc
v_lshl_add_u32 v4, v2, 9, v4
v_lshrrev_b32 v7, 3, v4
s_add_u32 s20, s4, 0x2000000
s_addc_u32 s21, s5, 0
s_mov_b32 s22, 0x22e4000
s_mov_b32 s23, 0x00020000
s_add_u32 s40, s18, 0x0
s_addc_u32 s41, s19, 0
s_mov_b32 s42, 0x4e2000
s_mov_b32 s43, 0x00020000
s_add_u32 s60, s4, 0x7c00000
s_addc_u32 s61, s5, 0
s_mov_b32 s12, 0xffff0000
v_mov_b32 v40, s48
s_lshl_b32 s33, s34, 11
v_add_u32 v10, s33, v252
s_lshl_b32 s32, s3, 10
v_xor_b32 v38, s32, v10
v_add_u32 v38, 0x8000, v38
v_xor_b32 v39, 0x400, v38
v_lshrrev_b32 v1, 1, v2
v_xor_b32 v1, v1, v3
v_lshrrev_b32 v11, 3, v2
v_lshlrev_b32 v11, 12, v11
v_lshl_add_u32 v11, v1, 4, v11
v_and_b32 v1, 7, v2
v_lshl_add_u32 v11, v1, 7, v11
s_and_b32 s32, s3, 1
s_lshl_b32 s32, s32, 6
v_xor_b32 v11, s32, v11
v_add_u32 v11, s100, v11
v_xor_b32 v12, 64, v11
s_lshl_b32 s33, s34, 12
s_add_u32 s33, s33, 0x18000
v_lshl_add_u32 v13, v0, 6, s33
s_lshl_b32 s32, s51, 2
s_add_u32 s33, s33, s32
v_lshl_add_u32 v14, v2, 6, s33
v_xor_b32 v1, v1, v3
v_lshlrev_b32 v1, 4, v1
v_lshl_add_u32 v1, v2, 7, v1
v_add_u32 v32, s55, v1
v_xor_b32 v33, 64, v32
v_add_u32 v35, s73, v1
v_xor_b32 v36, 64, v35
v_add_u32 v34, s55, v252
v_add_u32 v37, s73, v252
s_lshl_b32 s32, s34, 11
s_cmp_lt_u32 s34, 2
s_cselect_b32 s33, 0x20000, s32
s_cselect_b32 s33, s33, 0x1b000
s_cselect_b32 s35, 13, 12
s_add_u32 s32, s32, s33
s_mul_i32 s33, s51, 3
s_add_u32 s39, s33, 0
s_and_b32 s39, s39, 3
s_lshl_b32 s39, s39, s35
s_add_u32 s39, s39, s32
v_add_u32 v44, s39, v252
s_add_u32 s39, s33, 1
s_and_b32 s39, s39, 3
s_lshl_b32 s39, s39, s35
s_add_u32 s39, s39, s32
v_add_u32 v45, s39, v252
s_add_u32 s39, s33, 2
s_and_b32 s39, s39, 3
s_lshl_b32 s39, s39, s35
s_add_u32 s39, s39, s32
v_add_u32 v46, s39, v252
s_add_u32 s32, s51, 1
s_sub_u32 s33, s32, 6
s_cselect_b32 s32, s32, s33
s_mul_i32 s44, s32, 0x600000
s_add_u32 s32, s51, 2
s_sub_u32 s33, s32, 6
s_cselect_b32 s32, s32, s33
s_mul_i32 s45, s32, 0x600000
s_add_u32 s32, s51, 3
s_sub_u32 s33, s32, 6
s_cselect_b32 s32, s32, s33
s_mul_i32 s46, s32, 0x600000
s_add_u32 s32, s51, 4
s_sub_u32 s33, s32, 6
s_cselect_b32 s32, s32, s33
s_mul_i32 s47, s32, 0x600000
v_mov_b32 v41, 1
v_and_b32 v42, 3, v0
v_lshl_add_u32 v42, v42, 2, s100
s_lshl_b32 s33, s34, 12
s_cmp_lt_u32 s98, 2
s_cselect_b32 s33, s33, 0x100000
v_add_u32 v1, s33, v252
v_add_u32 v1, 0x1c000, v1
s_waitcnt vmcnt(14)
s_waitcnt lgkmcnt(0)
s_barrier
ds_read_b32 v43, v42 offset:24576
ds_write_b128 v1, v[16:19] offset:0
ds_write_b128 v1, v[20:23] offset:1024
ds_write_b128 v1, v[24:27] offset:2048
ds_write_b128 v1, v[28:31] offset:3072
s_waitcnt lgkmcnt(4)
v_cmp_ne_u32 vcc, 0, v43
s_cbranch_vccnz LC_slow
s_mov_b64 exec, 1
buffer_atomic_add v41, v40, s[56:59], s15 offen
s_mov_b64 exec, -1
s_cmp_eq_u32 s14, 1
s_cbranch_scc1 L2_fin
s_add_u32 s32, s51, 5
s_sub_u32 s33, s32, 6
s_cselect_b32 s32, s32, s33
s_mul_i32 s15, s32, 0x600000
s_add_u32 m0, s73, 0
s_add_u32 s33, s54, 0
buffer_load_dwordx4 v9, s[8:11], s33 offen lds
s_add_u32 m0, s73, 1024
s_add_u32 s35, s54, 4096
buffer_load_dwordx4 v9, s[8:11], s35 offen lds
s_xor_b32 s39, s13, 0x1000
buffer_load_dwordx4 a[16:19], v252, s[56:59], s39 offen offset:0
buffer_load_dwordx4 a[20:23], v252, s[56:59], s39 offen offset:1024
s_xor_b32 s32, s13, 0x5000
buffer_load_dwordx4 a[80:83], v252, s[56:59], s32 offen offset:0
buffer_load_dwordx4 a[84:87], v252, s[56:59], s32 offen offset:1024
s_xor_b32 s33, s13, 0x1800
buffer_load_dwordx4 a[24:27], v252, s[56:59], s33 offen offset:0
buffer_load_dwordx4 a[28:31], v252, s[56:59], s33 offen offset:1024
s_xor_b32 s35, s13, 0x5800
buffer_load_dwordx4 a[88:91], v252, s[56:59], s35 offen offset:0
buffer_load_dwordx4 a[92:95], v252, s[56:59], s35 offen offset:1024
s_xor_b32 s39, s13, 0x2000
buffer_load_dwordx4 a[32:35], v252, s[56:59], s39 offen offset:0
buffer_load_dwordx4 a[36:39], v252, s[56:59], s39 offen offset:1024
ds_read_b128 v[52:55], v32 offset:0
ds_read_b128 v[60:63], v33 offset:0
s_waitcnt lgkmcnt(1)
v_lshlrev_b32 v48, 16, v52
v_and_b32 v49, s12, v52
v_lshlrev_b32 v50, 16, v53
v_and_b32 v51, s12, v53
v_lshlrev_b32 v52, 16, v54
v_and_b32 v53, s12, v54
v_lshlrev_b32 v54, 16, v55
v_and_b32 v55, s12, v55
s_waitcnt lgkmcnt(0)
v_lshlrev_b32 v56, 16, v60
v_and_b32 v57, s12, v60
v_lshlrev_b32 v58, 16, v61
v_and_b32 v59, s12, v61
v_lshlrev_b32 v60, 16, v62
v_and_b32 v61, s12, v62
v_lshlrev_b32 v62, 16, v63
v_and_b32 v63, s12, v63
ds_read_b128 v[68:71], v32 offset:2048
ds_read_b128 v[76:79], v33 offset:2048
s_waitcnt lgkmcnt(1)
v_lshlrev_b32 v64, 16, v68
v_and_b32 v65, s12, v68
v_lshlrev_b32 v66, 16, v69
v_and_b32 v67, s12, v69
v_lshlrev_b32 v68, 16, v70
v_and_b32 v69, s12, v70
v_lshlrev_b32 v70, 16, v71
v_and_b32 v71, s12, v71
s_waitcnt lgkmcnt(0)
v_lshlrev_b32 v72, 16, v76
v_and_b32 v73, s12, v76
v_lshlrev_b32 v74, 16, v77
v_and_b32 v75, s12, v77
v_lshlrev_b32 v76, 16, v78
v_and_b32 v77, s12, v78
v_lshlrev_b32 v78, 16, v79
v_and_b32 v79, s12, v79
s_waitcnt vmcnt(11)
s_xor_b32 s32, s13, 0x6000
buffer_load_dwordx4 a[96:99], v252, s[56:59], s32 offen offset:0
s_waitcnt vmcnt(11)
buffer_load_dwordx4 a[100:103], v252, s[56:59], s32 offen offset:1024
s_waitcnt vmcnt(11)
s_xor_b32 s33, s13, 0x2800
buffer_load_dwordx4 a[40:43], v252, s[56:59], s33 offen offset:0
s_waitcnt vmcnt(11)
buffer_load_dwordx4 a[44:47], v252, s[56:59], s33 offen offset:1024
s_waitcnt vmcnt(11)
s_xor_b32 s35, s13, 0x6800
buffer_load_dwordx4 a[104:107], v252, s[56:59], s35 offen offset:0
s_waitcnt vmcnt(11)
buffer_load_dwordx4 a[108:111], v252, s[56:59], s35 offen offset:1024
s_waitcnt vmcnt(11)
s_mov_b32 s70, 0
s_atomic_add s70, s[60:61], s48 glc
s_waitcnt vmcnt(10)
s_xor_b32 s39, s13, 0x3000
buffer_load_dwordx4 a[48:51], v252, s[56:59], s39 offen offset:0
s_waitcnt vmcnt(10)
buffer_load_dwordx4 a[52:55], v252, s[56:59], s39 offen offset:1024
s_waitcnt vmcnt(10)
s_xor_b32 s32, s13, 0x7000
buffer_load_dwordx4 a[112:115], v252, s[56:59], s32 offen offset:0
s_waitcnt vmcnt(10)
buffer_load_dwordx4 a[116:119], v252, s[56:59], s32 offen offset:1024
s_waitcnt vmcnt(10)
s_xor_b32 s33, s13, 0x3800
buffer_load_dwordx4 a[56:59], v252, s[56:59], s33 offen offset:0
s_waitcnt vmcnt(10)
buffer_load_dwordx4 a[60:63], v252, s[56:59], s33 offen offset:1024
s_waitcnt vmcnt(10)
s_xor_b32 s35, s13, 0x7800
buffer_load_dwordx4 a[120:123], v252, s[56:59], s35 offen offset:0
s_waitcnt vmcnt(10)
buffer_load_dwordx4 a[124:127], v252, s[56:59], s35 offen offset:1024
s_waitcnt lgkmcnt(0)
s_cmp_lt_u32 s70, 6
s_cbranch_scc1 LC_poll
s_cmp_ge_u32 s98, 2
s_cbranch_scc1 LC_poll
LC_got:
buffer_load_dwordx4 v[156:159], v7, s[24:27], 0 offen offset:0 sc1
buffer_load_dwordx4 v[160:163], v7, s[24:27], 0 offen offset:16 sc1
buffer_load_dwordx4 v[164:167], v7, s[24:27], 0 offen offset:32 sc1
s_add_u32 s39, s52, s44
buffer_load_dwordx4 v[168:171], v10, s[20:23], s39 offen offset:0 sc1
s_add_u32 s32, s52, s45
buffer_load_dwordx4 v[172:175], v10, s[20:23], s32 offen offset:0 sc1
s_add_u32 s33, s52, s46
buffer_load_dwordx4 v[176:179], v10, s[20:23], s33 offen offset:0 sc1
s_add_u32 s35, s52, s47
buffer_load_dwordx4 v[180:183], v10, s[20:23], s35 offen offset:0 sc1
s_add_u32 s39, s52, s15
buffer_load_dwordx4 v[184:187], v10, s[20:23], s39 offen offset:0 sc1
s_add_u32 s32, s52, s44
buffer_load_dwordx4 v[188:191], v10, s[20:23], s32 offen offset:1024 sc1
s_add_u32 s33, s52, s45
buffer_load_dwordx4 v[192:195], v10, s[20:23], s33 offen offset:1024 sc1
s_add_u32 s35, s52, s46
buffer_load_dwordx4 v[196:199], v10, s[20:23], s35 offen offset:1024 sc1
s_add_u32 s39, s52, s47
buffer_load_dwordx4 v[200:203], v10, s[20:23], s39 offen offset:1024 sc1
s_add_u32 s32, s52, s15
buffer_load_dwordx4 v[204:207], v10, s[20:23], s32 offen offset:1024 sc1
s_xor_b32 s33, s13, 0x20000
buffer_load_dwordx4 a[128:131], v252, s[56:59], s33 offen offset:0
s_barrier
ds_read_b128 v[132:135], v11 offset:0
ds_read_b128 v[136:139], v11 offset:8192
ds_read_b128 v[140:143], v11 offset:16384
ds_read_b128 v[144:147], v12 offset:0
ds_read_b128 v[148:151], v12 offset:8192
s_waitcnt vmcnt(24)
s_waitcnt vmcnt(23)
s_waitcnt vmcnt(22)
s_waitcnt vmcnt(21)
s_waitcnt vmcnt(20)
s_waitcnt vmcnt(19)
s_waitcnt vmcnt(18)
s_waitcnt vmcnt(17)
s_waitcnt vmcnt(16)
s_waitcnt vmcnt(15)
s_waitcnt vmcnt(14)
s_waitcnt lgkmcnt(4)
v_mfma_f32_16x16x32_bf16 v[48:51], a[0:3], v[132:135], v[48:51]
ds_read_b128 v[152:155], v12 offset:16384
v_mfma_f32_16x16x32_bf16 v[52:55], a[4:7], v[132:135], v[52:55]
v_mfma_f32_16x16x32_bf16 v[56:59], a[64:67], v[132:135], v[56:59]
v_mfma_f32_16x16x32_bf16 v[60:63], a[68:71], v[132:135], v[60:63]
s_waitcnt lgkmcnt(4)
v_mfma_f32_16x16x32_bf16 v[64:67], a[0:3], v[136:139], v[64:67]
ds_read_b128 v[132:135], v11 offset:1024
v_mfma_f32_16x16x32_bf16 v[68:71], a[4:7], v[136:139], v[68:71]
v_mfma_f32_16x16x32_bf16 v[72:75], a[64:67], v[136:139], v[72:75]
v_mfma_f32_16x16x32_bf16 v[76:79], a[68:71], v[136:139], v[76:79]
ds_read_b128 v[84:87], v35 offset:0
ds_read_b128 v[92:95], v36 offset:0
s_waitcnt lgkmcnt(1)
v_lshlrev_b32 v80, 16, v84
v_and_b32 v81, s12, v84
v_lshlrev_b32 v82, 16, v85
v_and_b32 v83, s12, v85
v_lshlrev_b32 v84, 16, v86
v_and_b32 v85, s12, v86
v_lshlrev_b32 v86, 16, v87
v_and_b32 v87, s12, v87
s_waitcnt lgkmcnt(0)
v_lshlrev_b32 v88, 16, v92
v_and_b32 v89, s12, v92
v_lshlrev_b32 v90, 16, v93
v_and_b32 v91, s12, v93
v_lshlrev_b32 v92, 16, v94
v_and_b32 v93, s12, v94
v_lshlrev_b32 v94, 16, v95
v_and_b32 v95, s12, v95
v_mfma_f32_16x16x32_bf16 v[80:83], a[0:3], v[140:143], v[80:83]
ds_read_b128 v[136:139], v11 offset:9216
v_mfma_f32_16x16x32_bf16 v[84:87], a[4:7], v[140:143], v[84:87]
v_mfma_f32_16x16x32_bf16 v[88:91], a[64:67], v[140:143], v[88:91]
v_mfma_f32_16x16x32_bf16 v[92:95], a[68:71], v[140:143], v[92:95]
v_mfma_f32_16x16x32_bf16 v[48:51], a[8:11], v[144:147], v[48:51]
ds_read_b128 v[140:143], v11 offset:17408
v_mfma_f32_16x16x32_bf16 v[52:55], a[12:15], v[144:147], v[52:55]
v_mfma_f32_16x16x32_bf16 v[56:59], a[72:75], v[144:147], v[56:59]
v_mfma_f32_16x16x32_bf16 v[60:63], a[76:79], v[144:147], v[60:63]
v_mfma_f32_16x16x32_bf16 v[64:67], a[8:11], v[148:151], v[64:67]
ds_read_b128 v[144:147], v12 offset:1024
v_mfma_f32_16x16x32_bf16 v[68:71], a[12:15], v[148:151], v[68:71]
v_mfma_f32_16x16x32_bf16 v[72:75], a[72:75], v[148:151], v[72:75]
v_mfma_f32_16x16x32_bf16 v[76:79], a[76:79], v[148:151], v[76:79]
v_mfma_f32_16x16x32_bf16 v[80:83], a[8:11], v[152:155], v[80:83]
ds_read_b128 v[148:151], v12 offset:9216
v_mfma_f32_16x16x32_bf16 v[84:87], a[12:15], v[152:155], v[84:87]
v_mfma_f32_16x16x32_bf16 v[88:91], a[72:75], v[152:155], v[88:91]
v_mfma_f32_16x16x32_bf16 v[92:95], a[76:79], v[152:155], v[92:95]
v_mfma_f32_16x16x32_bf16 v[48:51], a[16:19], v[132:135], v[48:51]
ds_read_b128 v[152:155], v12 offset:17408
v_mfma_f32_16x16x32_bf16 v[52:55], a[20:23], v[132:135], v[52:55]
v_mfma_f32_16x16x32_bf16 v[56:59], a[80:83], v[132:135], v[56:59]
v_mfma_f32_16x16x32_bf16 v[60:63], a[84:87], v[132:135], v[60:63]
s_waitcnt lgkmcnt(4)
v_mfma_f32_16x16x32_bf16 v[64:67], a[16:19], v[136:139], v[64:67]
ds_read_b128 v[132:135], v11 offset:2048
v_mfma_f32_16x16x32_bf16 v[68:71], a[20:23], v[136:139], v[68:71]
v_mfma_f32_16x16x32_bf16 v[72:75], a[80:83], v[136:139], v[72:75]
v_mfma_f32_16x16x32_bf16 v[76:79], a[84:87], v[136:139], v[76:79]
s_waitcnt lgkmcnt(4)
v_mfma_f32_16x16x32_bf16 v[80:83], a[16:19], v[140:143], v[80:83]
ds_read_b128 v[136:139], v11 offset:10240
v_mfma_f32_16x16x32_bf16 v[84:87], a[20:23], v[140:143], v[84:87]
v_mfma_f32_16x16x32_bf16 v[88:91], a[80:83], v[140:143], v[88:91]
v_mfma_f32_16x16x32_bf16 v[92:95], a[84:87], v[140:143], v[92:95]
s_waitcnt lgkmcnt(4)
v_mfma_f32_16x16x32_bf16 v[48:51], a[24:27], v[144:147], v[48:51]
ds_read_b128 v[140:143], v11 offset:18432
v_mfma_f32_16x16x32_bf16 v[52:55], a[28:31], v[144:147], v[52:55]
v_mfma_f32_16x16x32_bf16 v[56:59], a[88:91], v[144:147], v[56:59]
v_mfma_f32_16x16x32_bf16 v[60:63], a[92:95], v[144:147], v[60:63]
s_waitcnt lgkmcnt(4)
v_mfma_f32_16x16x32_bf16 v[64:67], a[24:27], v[148:151], v[64:67]
ds_read_b128 v[144:147], v12 offset:2048
v_mfma_f32_16x16x32_bf16 v[68:71], a[28:31], v[148:151], v[68:71]
v_mfma_f32_16x16x32_bf16 v[72:75], a[88:91], v[148:151], v[72:75]
v_mfma_f32_16x16x32_bf16 v[76:79], a[92:95], v[148:151], v[76:79]
s_waitcnt lgkmcnt(4)
v_mfma_f32_16x16x32_bf16 v[80:83], a[24:27], v[152:155], v[80:83]
ds_read_b128 v[148:151], v12 offset:10240
v_mfma_f32_16x16x32_bf16 v[84:87], a[28:31], v[152:155], v[84:87]
v_mfma_f32_16x16x32_bf16 v[88:91], a[88:91], v[152:155], v[88:91]
v_mfma_f32_16x16x32_bf16 v[92:95], a[92:95], v[152:155], v[92:95]
s_waitcnt lgkmcnt(4)
v_mfma_f32_16x16x32_bf16 v[48:51], a[32:35], v[132:135], v[48:51]
ds_read_b128 v[152:155], v12 offset:18432
v_mfma_f32_16x16x32_bf16 v[52:55], a[36:39], v[132:135], v[52:55]
v_mfma_f32_16x16x32_bf16 v[56:59], a[96:99], v[132:135], v[56:59]
v_mfma_f32_16x16x32_bf16 v[60:63], a[100:103], v[132:135], v[60:63]
s_waitcnt lgkmcnt(4)
v_mfma_f32_16x16x32_bf16 v[64:67], a[32:35], v[136:139], v[64:67]
ds_read_b128 v[132:135], v11 offset:3072
v_mfma_f32_16x16x32_bf16 v[68:71], a[36:39], v[136:139], v[68:71]
v_mfma_f32_16x16x32_bf16 v[72:75], a[96:99], v[136:139], v[72:75]
v_mfma_f32_16x16x32_bf16 v[76:79], a[100:103], v[136:139], v[76:79]
s_waitcnt lgkmcnt(4)
v_mfma_f32_16x16x32_bf16 v[80:83], a[32:35], v[140:143], v[80:83]
ds_read_b128 v[136:139], v11 offset:11264
v_mfma_f32_16x16x32_bf16 v[84:87], a[36:39], v[140:143], v[84:87]
v_mfma_f32_16x16x32_bf16 v[88:91], a[96:99], v[140:143], v[88:91]
v_mfma_f32_16x16x32_bf16 v[92:95], a[100:103], v[140:143], v[92:95]
s_waitcnt lgkmcnt(4)
v_mfma_f32_16x16x32_bf16 v[48:51], a[40:43], v[144:147], v[48:51]
ds_read_b128 v[140:143], v11 offset:19456
v_mfma_f32_16x16x32_bf16 v[52:55], a[44:47], v[144:147], v[52:55]
v_mfma_f32_16x16x32_bf16 v[56:59], a[104:107], v[144:147], v[56:59]
v_mfma_f32_16x16x32_bf16 v[60:63], a[108:111], v[144:147], v[60:63]
s_waitcnt lgkmcnt(4)
v_mfma_f32_16x16x32_bf16 v[64:67], a[40:43], v[148:151], v[64:67]
ds_read_b128 v[144:147], v12 offset:3072
v_mfma_f32_16x16x32_bf16 v[68:71], a[44:47], v[148:151], v[68:71]
v_mfma_f32_16x16x32_bf16 v[72:75], a[104:107], v[148:151], v[72:75]
v_mfma_f32_16x16x32_bf16 v[76:79], a[108:111], v[148:151], v[76:79]
s_waitcnt lgkmcnt(4)
v_mfma_f32_16x16x32_bf16 v[80:83], a[40:43], v[152:155], v[80:83]
ds_read_b128 v[148:151], v12 offset:11264
v_mfma_f32_16x16x32_bf16 v[84:87], a[44:47], v[152:155], v[84:87]
v_mfma_f32_16x16x32_bf16 v[88:91], a[104:107], v[152:155], v[88:91]
v_mfma_f32_16x16x32_bf16 v[92:95], a[108:111], v[152:155], v[92:95]
s_waitcnt lgkmcnt(4)
v_mfma_f32_16x16x32_bf16 v[48:51], a[48:51], v[132:135], v[48:51]
ds_read_b128 v[152:155], v12 offset:19456
v_mfma_f32_16x16x32_bf16 v[52:55], a[52:55], v[132:135], v[52:55]
v_mfma_f32_16x16x32_bf16 v[56:59], a[112:115], v[132:135], v[56:59]
v_mfma_f32_16x16x32_bf16 v[60:63], a[116:119], v[132:135], v[60:63]
s_waitcnt lgkmcnt(4)
v_mfma_f32_16x16x32_bf16 v[64:67], a[48:51], v[136:139], v[64:67]
v_mfma_f32_16x16x32_bf16 v[68:71], a[52:55], v[136:139], v[68:71]
v_mfma_f32_16x16x32_bf16 v[72:75], a[112:115], v[136:139], v[72:75]
v_mfma_f32_16x16x32_bf16 v[76:79], a[116:119], v[136:139], v[76:79]
s_waitcnt lgkmcnt(3)
v_mfma_f32_16x16x32_bf16 v[80:83], a[48:51], v[140:143], v[80:83]
v_mfma_f32_16x16x32_bf16 v[84:87], a[52:55], v[140:143], v[84:87]
v_mfma_f32_16x16x32_bf16 v[88:91], a[112:115], v[140:143], v[88:91]
v_mfma_f32_16x16x32_bf16 v[92:95], a[116:119], v[140:143], v[92:95]
s_waitcnt lgkmcnt(2)
v_mfma_f32_16x16x32_bf16 v[48:51], a[56:59], v[144:147], v[48:51]
v_mfma_f32_16x16x32_bf16 v[52:55], a[60:63], v[144:147], v[52:55]
v_mfma_f32_16x16x32_bf16 v[56:59], a[120:123], v[144:147], v[56:59]
v_mfma_f32_16x16x32_bf16 v[60:63], a[124:127], v[144:147], v[60:63]
s_waitcnt lgkmcnt(1)
v_mfma_f32_16x16x32_bf16 v[64:67], a[56:59], v[148:151], v[64:67]
v_mfma_f32_16x16x32_bf16 v[68:71], a[60:63], v[148:151], v[68:71]
v_mfma_f32_16x16x32_bf16 v[72:75], a[120:123], v[148:151], v[72:75]
v_mfma_f32_16x16x32_bf16 v[76:79], a[124:127], v[148:151], v[76:79]
s_waitcnt lgkmcnt(0)
v_mfma_f32_16x16x32_bf16 v[80:83], a[56:59], v[152:155], v[80:83]
v_mfma_f32_16x16x32_bf16 v[84:87], a[60:63], v[152:155], v[84:87]
v_mfma_f32_16x16x32_bf16 v[88:91], a[120:123], v[152:155], v[88:91]
v_mfma_f32_16x16x32_bf16 v[92:95], a[124:127], v[152:155], v[92:95]
s_waitcnt vmcnt(13)
buffer_load_dwordx4 a[132:135], v252, s[56:59], s33 offen offset:1024
s_waitcnt vmcnt(13)
s_xor_b32 s35, s13, 0x24000
buffer_load_dwordx4 a[192:195], v252, s[56:59], s35 offen offset:0
s_waitcnt vmcnt(13)
buffer_load_dwordx4 a[196:199], v252, s[56:59], s35 offen offset:1024
v_max3_f32 v1, v156, v158, v160
v_max3_f32 v117, v162, v164, v166
v_max_f32 v1, v1, v117
v_sub_f32 v156, v156, v1
v_sub_f32 v158, v158, v1
v_sub_f32 v160, v160, v1
v_sub_f32 v162, v162, v1
v_sub_f32 v164, v164, v1
v_sub_f32 v166, v166, v1
v_exp_f32 v156, v156
v_exp_f32 v158, v158
v_exp_f32 v160, v160
v_exp_f32 v162, v162
v_exp_f32 v164, v164
v_exp_f32 v166, v166
s_nop 0
v_mul_f32 v1, v156, v157
v_fmac_f32 v1, v158, v159
v_fmac_f32 v1, v160, v161
v_fmac_f32 v1, v162, v163
v_fmac_f32 v1, v164, v165
v_fmac_f32 v1, v166, v167
v_rcp_f32 v1, v1
s_nop 0
v_mul_f32 v108, v156, v1
v_mul_f32 v109, v158, v1
v_mul_f32 v110, v160, v1
v_mul_f32 v111, v162, v1
v_mul_f32 v112, v164, v1
v_mul_f32 v113, v166, v1
v_mul_f32 v114, v156, v1
v_mul_f32 v115, v158, v1
ds_write_b128 v13, v[108:111]
ds_write_b128 v13, v[112:115] offset:16
ds_write_b64 v13, v[110:111] offset:32
ds_write_b64 v13, v[112:113] offset:40
ds_read2_b32 v[100:101], v14 offset0:1 offset1:2
ds_read2_b32 v[102:103], v14 offset0:3 offset1:4
ds_read2_b32 v[104:105], v14 offset0:5 offset1:6
v_add_u32 v14, 0x400, v14
s_waitcnt vmcnt(13)
s_xor_b32 s39, s13, 0x20800
buffer_load_dwordx4 a[136:139], v252, s[56:59], s39 offen offset:0
ds_read_b128 v[96:99], v44 offset:0
s_waitcnt lgkmcnt(1)
v_lshlrev_b32 v118, 16, v168
v_and_b32 v119, s12, v168
v_mul_f32 v108, v118, v100
v_mul_f32 v109, v119, v100
v_lshlrev_b32 v120, 16, v169
v_and_b32 v121, s12, v169
v_mul_f32 v110, v120, v100
v_mul_f32 v111, v121, v100
v_lshlrev_b32 v122, 16, v170
v_and_b32 v123, s12, v170
v_mul_f32 v112, v122, v100
v_mul_f32 v113, v123, v100
v_lshlrev_b32 v116, 16, v171
v_and_b32 v117, s12, v171
v_mul_f32 v114, v116, v100
v_mul_f32 v115, v117, v100
s_waitcnt vmcnt(13)
buffer_load_dwordx4 a[140:143], v252, s[56:59], s39 offen offset:1024
v_lshlrev_b32 v118, 16, v172
v_and_b32 v119, s12, v172
v_fmac_f32 v108, v118, v101
v_fmac_f32 v109, v119, v101
v_lshlrev_b32 v120, 16, v173
v_and_b32 v121, s12, v173
v_fmac_f32 v110, v120, v101
v_fmac_f32 v111, v121, v101
v_lshlrev_b32 v122, 16, v174
v_and_b32 v123, s12, v174
v_fmac_f32 v112, v122, v101
v_fmac_f32 v113, v123, v101
v_lshlrev_b32 v116, 16, v175
v_and_b32 v117, s12, v175
v_fmac_f32 v114, v116, v101
v_fmac_f32 v115, v117, v101
s_waitcnt lgkmcnt(0)
v_lshlrev_b32 v118, 16, v96
v_and_b32 v119, s12, v96
v_fmac_f32 v108, v118, v105
v_fmac_f32 v109, v119, v105
v_lshlrev_b32 v120, 16, v97
v_and_b32 v121, s12, v97
v_fmac_f32 v110, v120, v105
v_fmac_f32 v111, v121, v105
v_lshlrev_b32 v122, 16, v98
v_and_b32 v123, s12, v98
v_fmac_f32 v112, v122, v105
v_fmac_f32 v113, v123, v105
v_lshlrev_b32 v116, 16, v99
v_and_b32 v117, s12, v99
v_fmac_f32 v114, v116, v105
v_fmac_f32 v115, v117, v105
s_waitcnt vmcnt(13)
s_xor_b32 s32, s13, 0x24800
buffer_load_dwordx4 a[200:203], v252, s[56:59], s32 offen offset:0
v_lshlrev_b32 v118, 16, v176
v_and_b32 v119, s12, v176
v_fmac_f32 v108, v118, v102
v_fmac_f32 v109, v119, v102
v_lshlrev_b32 v120, 16, v177
v_and_b32 v121, s12, v177
v_fmac_f32 v110, v120, v102
v_fmac_f32 v111, v121, v102
v_lshlrev_b32 v122, 16, v178
v_and_b32 v123, s12, v178
v_fmac_f32 v112, v122, v102
v_fmac_f32 v113, v123, v102
v_lshlrev_b32 v116, 16, v179
v_and_b32 v117, s12, v179
v_fmac_f32 v114, v116, v102
v_fmac_f32 v115, v117, v102
s_waitcnt vmcnt(13)
buffer_load_dwordx4 a[204:207], v252, s[56:59], s32 offen offset:1024
v_lshlrev_b32 v118, 16, v180
v_and_b32 v119, s12, v180
v_fmac_f32 v108, v118, v103
v_fmac_f32 v109, v119, v103
v_lshlrev_b32 v120, 16, v181
v_and_b32 v121, s12, v181
v_fmac_f32 v110, v120, v103
v_fmac_f32 v111, v121, v103
v_lshlrev_b32 v122, 16, v182
v_and_b32 v123, s12, v182
v_fmac_f32 v112, v122, v103
v_fmac_f32 v113, v123, v103
v_lshlrev_b32 v116, 16, v183
v_and_b32 v117, s12, v183
v_fmac_f32 v114, v116, v103
v_fmac_f32 v115, v117, v103
s_waitcnt vmcnt(13)
s_add_u32 s33, s53, s44
buffer_load_dwordx4 v[208:211], v10, s[20:23], s33 offen offset:0 sc1
v_lshlrev_b32 v118, 16, v184
v_and_b32 v119, s12, v184
v_fmac_f32 v108, v118, v104
v_fmac_f32 v109, v119, v104
v_lshlrev_b32 v120, 16, v185
v_and_b32 v121, s12, v185
v_fmac_f32 v110, v120, v104
v_fmac_f32 v111, v121, v104
v_lshlrev_b32 v122, 16, v186
v_and_b32 v123, s12, v186
v_fmac_f32 v112, v122, v104
v_fmac_f32 v113, v123, v104
v_lshlrev_b32 v116, 16, v187
v_and_b32 v117, s12, v187
v_fmac_f32 v114, v116, v104
v_fmac_f32 v115, v117, v104
v_cvt_pk_bf16_f32 v116, v108, v109
v_cvt_pk_bf16_f32 v117, v110, v111
v_cvt_pk_bf16_f32 v118, v112, v113
v_cvt_pk_bf16_f32 v119, v114, v115
ds_write_b128 v38, v[116:119] offset:0
s_waitcnt vmcnt(13)
s_xor_b32 s35, s13, 0x21000
buffer_load_dwordx4 a[144:147], v252, s[56:59], s35 offen offset:0
ds_read_b128 v[96:99], v44 offset:1024
v_lshlrev_b32 v118, 16, v188
v_and_b32 v119, s12, v188
v_mul_f32 v108, v118, v100
v_mul_f32 v109, v119, v100
v_lshlrev_b32 v120, 16, v189
v_and_b32 v121, s12, v189
v_mul_f32 v110, v120, v100
v_mul_f32 v111, v121, v100
v_lshlrev_b32 v122, 16, v190
v_and_b32 v123, s12, v190
v_mul_f32 v112, v122, v100
v_mul_f32 v113, v123, v100
v_lshlrev_b32 v116, 16, v191
v_and_b32 v117, s12, v191
v_mul_f32 v114, v116, v100
v_mul_f32 v115, v117, v100
s_waitcnt vmcnt(13)
buffer_load_dwordx4 a[148:151], v252, s[56:59], s35 offen offset:1024
v_lshlrev_b32 v118, 16, v192
v_and_b32 v119, s12, v192
v_fmac_f32 v108, v118, v101
v_fmac_f32 v109, v119, v101
v_lshlrev_b32 v120, 16, v193
v_and_b32 v121, s12, v193
v_fmac_f32 v110, v120, v101
v_fmac_f32 v111, v121, v101
v_lshlrev_b32 v122, 16, v194
v_and_b32 v123, s12, v194
v_fmac_f32 v112, v122, v101
v_fmac_f32 v113, v123, v101
v_lshlrev_b32 v116, 16, v195
v_and_b32 v117, s12, v195
v_fmac_f32 v114, v116, v101
v_fmac_f32 v115, v117, v101
s_waitcnt lgkmcnt(0)
v_lshlrev_b32 v118, 16, v96
v_and_b32 v119, s12, v96
v_fmac_f32 v108, v118, v105
v_fmac_f32 v109, v119, v105
v_lshlrev_b32 v120, 16, v97
v_and_b32 v121, s12, v97
v_fmac_f32 v110, v120, v105
v_fmac_f32 v111, v121, v105
v_lshlrev_b32 v122, 16, v98
v_and_b32 v123, s12, v98
v_fmac_f32 v112, v122, v105
v_fmac_f32 v113, v123, v105
v_lshlrev_b32 v116, 16, v99
v_and_b32 v117, s12, v99
v_fmac_f32 v114, v116, v105
v_fmac_f32 v115, v117, v105
s_waitcnt vmcnt(13)
s_add_u32 s39, s53, s45
buffer_load_dwordx4 v[212:215], v10, s[20:23], s39 offen offset:0 sc1
v_lshlrev_b32 v118, 16, v196
v_and_b32 v119, s12, v196
v_fmac_f32 v108, v118, v102
v_fmac_f32 v109, v119, v102
v_lshlrev_b32 v120, 16, v197
v_and_b32 v121, s12, v197
v_fmac_f32 v110, v120, v102
v_fmac_f32 v111, v121, v102
v_lshlrev_b32 v122, 16, v198
v_and_b32 v123, s12, v198
v_fmac_f32 v112, v122, v102
v_fmac_f32 v113, v123, v102
v_lshlrev_b32 v116, 16, v199
v_and_b32 v117, s12, v199
v_fmac_f32 v114, v116, v102
v_fmac_f32 v115, v117, v102
s_waitcnt vmcnt(13)
s_xor_b32 s32, s13, 0x25000
buffer_load_dwordx4 a[208:211], v252, s[56:59], s32 offen offset:0
v_lshlrev_b32 v118, 16, v200
v_and_b32 v119, s12, v200
v_fmac_f32 v108, v118, v103
v_fmac_f32 v109, v119, v103
v_lshlrev_b32 v120, 16, v201
v_and_b32 v121, s12, v201
v_fmac_f32 v110, v120, v103
v_fmac_f32 v111, v121, v103
v_lshlrev_b32 v122, 16, v202
v_and_b32 v123, s12, v202
v_fmac_f32 v112, v122, v103
v_fmac_f32 v113, v123, v103
v_lshlrev_b32 v116, 16, v203
v_and_b32 v117, s12, v203
v_fmac_f32 v114, v116, v103
v_fmac_f32 v115, v117, v103
s_waitcnt vmcnt(13)
buffer_load_dwordx4 a[212:215], v252, s[56:59], s32 offen offset:1024
v_lshlrev_b32 v118, 16, v204
v_and_b32 v119, s12, v204
v_fmac_f32 v108, v118, v104
v_fmac_f32 v109, v119, v104
v_lshlrev_b32 v120, 16, v205
v_and_b32 v121, s12, v205
v_fmac_f32 v110, v120, v104
v_fmac_f32 v111, v121, v104
v_lshlrev_b32 v122, 16, v206
v_and_b32 v123, s12, v206
v_fmac_f32 v112, v122, v104
v_fmac_f32 v113, v123, v104
v_lshlrev_b32 v116, 16, v207
v_and_b32 v117, s12, v207
v_fmac_f32 v114, v116, v104
v_fmac_f32 v115, v117, v104
ds_read2_b32 v[100:101], v14 offset0:1 offset1:2
ds_read2_b32 v[102:103], v14 offset0:3 offset1:4
ds_read2_b32 v[104:105], v14 offset0:5 offset1:6
v_add_u32 v14, 0x400, v14
v_cvt_pk_bf16_f32 v116, v108, v109
v_cvt_pk_bf16_f32 v117, v110, v111
v_cvt_pk_bf16_f32 v118, v112, v113
v_cvt_pk_bf16_f32 v119, v114, v115
ds_write_b128 v39, v[116:119] offset:0
s_waitcnt vmcnt(13)
s_add_u32 s33, s53, s46
buffer_load_dwordx4 v[216:219], v10, s[20:23], s33 offen offset:0 sc1
s_waitcnt vmcnt(13)
s_xor_b32 s35, s13, 0x21800
buffer_load_dwordx4 a[152:155], v252, s[56:59], s35 offen offset:0
s_waitcnt vmcnt(13)
buffer_load_dwordx4 a[156:159], v252, s[56:59], s35 offen offset:1024
s_waitcnt vmcnt(13)
s_add_u32 s39, s53, s47
buffer_load_dwordx4 v[220:223], v10, s[20:23], s39 offen offset:0 sc1
s_waitcnt vmcnt(13)
s_xor_b32 s32, s13, 0x25800
buffer_load_dwordx4 a[216:219], v252, s[56:59], s32 offen offset:0
s_waitcnt vmcnt(13)
buffer_load_dwordx4 a[220:223], v252, s[56:59], s32 offen offset:1024
s_waitcnt vmcnt(13)
s_add_u32 s33, s53, s15
buffer_load_dwordx4 v[224:227], v10, s[20:23], s33 offen offset:0 sc1
s_waitcnt vmcnt(13)
s_xor_b32 s35, s13, 0x22000
buffer_load_dwordx4 a[160:163], v252, s[56:59], s35 offen offset:0
s_waitcnt lgkmcnt(0)
s_barrier
ds_read_b128 v[132:135], v252 offset:32768
ds_read_b128 v[136:139], v252 offset:33792
ds_read_b128 v[140:143], v252 offset:34816
ds_read_b128 v[144:147], v252 offset:35840
ds_read_b128 v[148:151], v252 offset:36864
s_waitcnt lgkmcnt(4)
v_mfma_f32_16x16x32_bf16 v[48:51], a[128:131], v[132:135], v[48:51]
ds_read_b128 v[152:155], v252 offset:37888
v_mfma_f32_16x16x32_bf16 v[52:55], a[132:135], v[132:135], v[52:55]
v_mfma_f32_16x16x32_bf16 v[56:59], a[192:195], v[132:135], v[56:59]
v_mfma_f32_16x16x32_bf16 v[60:63], a[196:199], v[132:135], v[60:63]
s_waitcnt vmcnt(13)
buffer_load_dwordx4 a[164:167], v252, s[56:59], s35 offen offset:1024
s_waitcnt lgkmcnt(4)
v_mfma_f32_16x16x32_bf16 v[48:51], a[136:139], v[136:139], v[48:51]
ds_read_b128 v[132:135], v252 offset:38912
ds_read_b128 v[96:99], v45 offset:0
v_lshlrev_b32 v118, 16, v208
v_and_b32 v119, s12, v208
v_mfma_f32_16x16x32_bf16 v[52:55], a[140:143], v[136:139], v[52:55]
v_mul_f32 v108, v118, v100
v_mul_f32 v109, v119, v100
v_lshlrev_b32 v120, 16, v209
v_mfma_f32_16x16x32_bf16 v[56:59], a[200:203], v[136:139], v[56:59]
v_and_b32 v121, s12, v209
v_mul_f32 v110, v120, v100
v_mul_f32 v111, v121, v100
v_mfma_f32_16x16x32_bf16 v[60:63], a[204:207], v[136:139], v[60:63]
v_lshlrev_b32 v122, 16, v210
v_and_b32 v123, s12, v210
v_mul_f32 v112, v122, v100
v_mul_f32 v113, v123, v100
v_lshlrev_b32 v116, 16, v211
v_and_b32 v117, s12, v211
v_mul_f32 v114, v116, v100
v_mul_f32 v115, v117, v100
s_waitcnt vmcnt(13)
s_add_u32 s39, s53, s44
buffer_load_dwordx4 v[228:231], v10, s[20:23], s39 offen offset:1024 sc1
s_waitcnt vmcnt(13)
s_xor_b32 s32, s13, 0x26000
buffer_load_dwordx4 a[224:227], v252, s[56:59], s32 offen offset:0
s_waitcnt vmcnt(13)
buffer_load_dwordx4 a[228:231], v252, s[56:59], s32 offen offset:1024
v_lshlrev_b32 v118, 16, v212
v_and_b32 v119, s12, v212
v_fmac_f32 v108, v118, v101
v_fmac_f32 v109, v119, v101
v_lshlrev_b32 v120, 16, v213
v_and_b32 v121, s12, v213
v_fmac_f32 v110, v120, v101
v_fmac_f32 v111, v121, v101
v_lshlrev_b32 v122, 16, v214
v_and_b32 v123, s12, v214
v_fmac_f32 v112, v122, v101
v_fmac_f32 v113, v123, v101
v_lshlrev_b32 v116, 16, v215
v_and_b32 v117, s12, v215
v_fmac_f32 v114, v116, v101
v_fmac_f32 v115, v117, v101
s_waitcnt lgkmcnt(0)
v_lshlrev_b32 v118, 16, v96
v_and_b32 v119, s12, v96
v_fmac_f32 v108, v118, v105
v_fmac_f32 v109, v119, v105
v_lshlrev_b32 v120, 16, v97
v_and_b32 v121, s12, v97
v_fmac_f32 v110, v120, v105
v_fmac_f32 v111, v121, v105
v_lshlrev_b32 v122, 16, v98
v_and_b32 v123, s12, v98
v_fmac_f32 v112, v122, v105
v_fmac_f32 v113, v123, v105
v_lshlrev_b32 v116, 16, v99
v_and_b32 v117, s12, v99
v_fmac_f32 v114, v116, v105
v_fmac_f32 v115, v117, v105
s_waitcnt vmcnt(13)
s_add_u32 s33, s53, s45
buffer_load_dwordx4 v[232:235], v10, s[20:23], s33 offen offset:1024 sc1
s_waitcnt vmcnt(13)
s_xor_b32 s35, s13, 0x22800
buffer_load_dwordx4 a[168:171], v252, s[56:59], s35 offen offset:0
v_mfma_f32_16x16x32_bf16 v[48:51], a[144:147], v[140:143], v[48:51]
v_mfma_f32_16x16x32_bf16 v[52:55], a[148:151], v[140:143], v[52:55]
v_mfma_f32_16x16x32_bf16 v[56:59], a[208:211], v[140:143], v[56:59]
v_mfma_f32_16x16x32_bf16 v[60:63], a[212:215], v[140:143], v[60:63]
s_waitcnt vmcnt(13)
buffer_load_dwordx4 a[172:175], v252, s[56:59], s35 offen offset:1024
v_lshlrev_b32 v118, 16, v216
v_and_b32 v119, s12, v216
v_fmac_f32 v108, v118, v102
v_fmac_f32 v109, v119, v102
v_lshlrev_b32 v120, 16, v217
v_and_b32 v121, s12, v217
v_fmac_f32 v110, v120, v102
v_fmac_f32 v111, v121, v102
v_lshlrev_b32 v122, 16, v218
v_and_b32 v123, s12, v218
v_fmac_f32 v112, v122, v102
v_fmac_f32 v113, v123, v102
v_lshlrev_b32 v116, 16, v219
v_and_b32 v117, s12, v219
v_fmac_f32 v114, v116, v102
v_fmac_f32 v115, v117, v102
s_waitcnt vmcnt(13)
s_add_u32 s39, s53, s46
buffer_load_dwordx4 v[236:239], v10, s[20:23], s39 offen offset:1024 sc1
s_waitcnt vmcnt(13)
s_xor_b32 s32, s13, 0x26800
buffer_load_dwordx4 a[232:235], v252, s[56:59], s32 offen offset:0
s_waitcnt vmcnt(13)
buffer_load_dwordx4 a[236:239], v252, s[56:59], s32 offen offset:1024
v_lshlrev_b32 v118, 16, v220
v_and_b32 v119, s12, v220
v_fmac_f32 v108, v118, v103
v_fmac_f32 v109, v119, v103
v_lshlrev_b32 v120, 16, v221
v_and_b32 v121, s12, v221
v_fmac_f32 v110, v120, v103
v_fmac_f32 v111, v121, v103
v_lshlrev_b32 v122, 16, v222
v_and_b32 v123, s12, v222
v_fmac_f32 v112, v122, v103
v_fmac_f32 v113, v123, v103
v_lshlrev_b32 v116, 16, v223
v_and_b32 v117, s12, v223
v_fmac_f32 v114, v116, v103
v_fmac_f32 v115, v117, v103
s_waitcnt vmcnt(13)
s_add_u32 s33, s53, s47
buffer_load_dwordx4 v[240:243], v10, s[20:23], s33 offen offset:1024 sc1
s_waitcnt vmcnt(13)
s_xor_b32 s35, s13, 0x23000
buffer_load_dwordx4 a[176:179], v252, s[56:59], s35 offen offset:0
v_mfma_f32_16x16x32_bf16 v[48:51], a[152:155], v[144:147], v[48:51]
v_mfma_f32_16x16x32_bf16 v[52:55], a[156:159], v[144:147], v[52:55]
v_mfma_f32_16x16x32_bf16 v[56:59], a[216:219], v[144:147], v[56:59]
v_mfma_f32_16x16x32_bf16 v[60:63], a[220:223], v[144:147], v[60:63]
s_waitcnt vmcnt(13)
buffer_load_dwordx4 a[180:183], v252, s[56:59], s35 offen offset:1024
v_lshlrev_b32 v118, 16, v224
v_and_b32 v119, s12, v224
v_fmac_f32 v108, v118, v104
v_fmac_f32 v109, v119, v104
v_lshlrev_b32 v120, 16, v225
v_and_b32 v121, s12, v225
v_fmac_f32 v110, v120, v104
v_fmac_f32 v111, v121, v104
v_lshlrev_b32 v122, 16, v226
v_and_b32 v123, s12, v226
v_fmac_f32 v112, v122, v104
v_fmac_f32 v113, v123, v104
v_lshlrev_b32 v116, 16, v227
v_and_b32 v117, s12, v227
v_fmac_f32 v114, v116, v104
v_fmac_f32 v115, v117, v104
v_cvt_pk_bf16_f32 v116, v108, v109
v_cvt_pk_bf16_f32 v117, v110, v111
v_cvt_pk_bf16_f32 v118, v112, v113
v_cvt_pk_bf16_f32 v119, v114, v115
ds_write_b128 v38, v[116:119] offset:8192
s_waitcnt vmcnt(13)
s_add_u32 s39, s53, s15
buffer_load_dwordx4 v[244:247], v10, s[20:23], s39 offen offset:1024 sc1
s_waitcnt vmcnt(13)
s_xor_b32 s32, s13, 0x27000
buffer_load_dwordx4 a[240:243], v252, s[56:59], s32 offen offset:0
s_waitcnt vmcnt(13)
buffer_load_dwordx4 a[244:247], v252, s[56:59], s32 offen offset:1024
ds_read_b128 v[96:99], v45 offset:1024
v_lshlrev_b32 v118, 16, v228
v_and_b32 v119, s12, v228
v_mul_f32 v108, v118, v100
v_mul_f32 v109, v119, v100
v_lshlrev_b32 v120, 16, v229
v_and_b32 v121, s12, v229
v_mul_f32 v110, v120, v100
v_mul_f32 v111, v121, v100
v_lshlrev_b32 v122, 16, v230
v_and_b32 v123, s12, v230
v_mul_f32 v112, v122, v100
v_mul_f32 v113, v123, v100
v_lshlrev_b32 v116, 16, v231
v_and_b32 v117, s12, v231
v_mul_f32 v114, v116, v100
v_mul_f32 v115, v117, v100
s_waitcnt vmcnt(13)
s_xor_b32 s33, s13, 0x23800
buffer_load_dwordx4 a[184:187], v252, s[56:59], s33 offen offset:0
s_waitcnt vmcnt(13)
buffer_load_dwordx4 a[188:191], v252, s[56:59], s33 offen offset:1024
v_mfma_f32_16x16x32_bf16 v[48:51], a[160:163], v[148:151], v[48:51]
v_mfma_f32_16x16x32_bf16 v[52:55], a[164:167], v[148:151], v[52:55]
v_mfma_f32_16x16x32_bf16 v[56:59], a[224:227], v[148:151], v[56:59]
v_mfma_f32_16x16x32_bf16 v[60:63], a[228:231], v[148:151], v[60:63]
s_waitcnt vmcnt(13)
s_xor_b32 s35, s13, 0x27800
buffer_load_dwordx4 a[248:251], v252, s[56:59], s35 offen offset:0
v_lshlrev_b32 v118, 16, v232
v_and_b32 v119, s12, v232
v_fmac_f32 v108, v118, v101
v_fmac_f32 v109, v119, v101
v_lshlrev_b32 v120, 16, v233
v_and_b32 v121, s12, v233
v_fmac_f32 v110, v120, v101
v_fmac_f32 v111, v121, v101
v_lshlrev_b32 v122, 16, v234
v_and_b32 v123, s12, v234
v_fmac_f32 v112, v122, v101
v_fmac_f32 v113, v123, v101
v_lshlrev_b32 v116, 16, v235
v_and_b32 v117, s12, v235
v_fmac_f32 v114, v116, v101
v_fmac_f32 v115, v117, v101
s_waitcnt lgkmcnt(0)
v_lshlrev_b32 v118, 16, v96
v_and_b32 v119, s12, v96
v_fmac_f32 v108, v118, v105
v_fmac_f32 v109, v119, v105
v_lshlrev_b32 v120, 16, v97
v_and_b32 v121, s12, v97
v_fmac_f32 v110, v120, v105
v_fmac_f32 v111, v121, v105
v_lshlrev_b32 v122, 16, v98
v_and_b32 v123, s12, v98
v_fmac_f32 v112, v122, v105
v_fmac_f32 v113, v123, v105
v_lshlrev_b32 v116, 16, v99
v_and_b32 v117, s12, v99
v_fmac_f32 v114, v116, v105
v_fmac_f32 v115, v117, v105
s_waitcnt vmcnt(13)
buffer_load_dwordx4 a[252:255], v252, s[56:59], s35 offen offset:1024
s_waitcnt vmcnt(13)
s_add_u32 s39, s54, s44
buffer_load_dwordx4 v[156:159], v10, s[20:23], s39 offen offset:0 sc1
s_waitcnt vmcnt(13)
s_add_u32 s32, s54, s45
buffer_load_dwordx4 v[160:163], v10, s[20:23], s32 offen offset:0 sc1
v_lshlrev_b32 v118, 16, v236
v_and_b32 v119, s12, v236
v_fmac_f32 v108, v118, v102
v_fmac_f32 v109, v119, v102
v_lshlrev_b32 v120, 16, v237
v_and_b32 v121, s12, v237
v_fmac_f32 v110, v120, v102
v_fmac_f32 v111, v121, v102
v_lshlrev_b32 v122, 16, v238
v_and_b32 v123, s12, v238
v_fmac_f32 v112, v122, v102
v_fmac_f32 v113, v123, v102
v_lshlrev_b32 v116, 16, v239
v_and_b32 v117, s12, v239
v_fmac_f32 v114, v116, v102
v_fmac_f32 v115, v117, v102
s_waitcnt vmcnt(13)
s_add_u32 s33, s54, s46
buffer_load_dwordx4 v[164:167], v10, s[20:23], s33 offen offset:0 sc1
s_waitcnt vmcnt(13)
s_add_u32 s35, s54, s47
buffer_load_dwordx4 v[168:171], v10, s[20:23], s35 offen offset:0 sc1
v_mfma_f32_16x16x32_bf16 v[48:51], a[168:171], v[152:155], v[48:51]
v_mfma_f32_16x16x32_bf16 v[52:55], a[172:175], v[152:155], v[52:55]
v_mfma_f32_16x16x32_bf16 v[56:59], a[232:235], v[152:155], v[56:59]
v_mfma_f32_16x16x32_bf16 v[60:63], a[236:239], v[152:155], v[60:63]
s_waitcnt vmcnt(13)
s_add_u32 s39, s54, s15
buffer_load_dwordx4 v[172:175], v10, s[20:23], s39 offen offset:0 sc1
v_lshlrev_b32 v118, 16, v240
v_and_b32 v119, s12, v240
v_fmac_f32 v108, v118, v103
v_fmac_f32 v109, v119, v103
v_lshlrev_b32 v120, 16, v241
v_and_b32 v121, s12, v241
v_fmac_f32 v110, v120, v103
v_fmac_f32 v111, v121, v103
v_lshlrev_b32 v122, 16, v242
v_and_b32 v123, s12, v242
v_fmac_f32 v112, v122, v103
v_fmac_f32 v113, v123, v103
v_lshlrev_b32 v116, 16, v243
v_and_b32 v117, s12, v243
v_fmac_f32 v114, v116, v103
v_fmac_f32 v115, v117, v103
s_waitcnt vmcnt(13)
s_add_u32 s32, s54, s44
buffer_load_dwordx4 v[176:179], v10, s[20:23], s32 offen offset:1024 sc1
s_waitcnt vmcnt(13)
s_add_u32 s33, s54, s45
buffer_load_dwordx4 v[180:183], v10, s[20:23], s33 offen offset:1024 sc1
s_waitcnt vmcnt(13)
s_add_u32 s35, s54, s46
buffer_load_dwordx4 v[184:187], v10, s[20:23], s35 offen offset:1024 sc1
v_lshlrev_b32 v118, 16, v244
v_and_b32 v119, s12, v244
v_fmac_f32 v108, v118, v104
v_fmac_f32 v109, v119, v104
v_lshlrev_b32 v120, 16, v245
v_and_b32 v121, s12, v245
v_fmac_f32 v110, v120, v104
v_fmac_f32 v111, v121, v104
v_lshlrev_b32 v122, 16, v246
v_and_b32 v123, s12, v246
v_fmac_f32 v112, v122, v104
v_fmac_f32 v113, v123, v104
v_lshlrev_b32 v116, 16, v247
v_and_b32 v117, s12, v247
v_fmac_f32 v114, v116, v104
v_fmac_f32 v115, v117, v104
ds_read2_b32 v[100:101], v14 offset0:1 offset1:2
ds_read2_b32 v[102:103], v14 offset0:3 offset1:4
ds_read2_b32 v[104:105], v14 offset0:5 offset1:6
v_cvt_pk_bf16_f32 v116, v108, v109
v_cvt_pk_bf16_f32 v117, v110, v111
v_cvt_pk_bf16_f32 v118, v112, v113
v_cvt_pk_bf16_f32 v119, v114, v115
ds_write_b128 v39, v[116:119] offset:8192
s_waitcnt vmcnt(13)
s_add_u32 s39, s54, s47
buffer_load_dwordx4 v[188:191], v10, s[20:23], s39 offen offset:1024 sc1
s_waitcnt vmcnt(13)
s_add_u32 s32, s54, s15
buffer_load_dwordx4 v[192:195], v10, s[20:23], s32 offen offset:1024 sc1
v_mfma_f32_16x16x32_bf16 v[48:51], a[176:179], v[132:135], v[48:51]
v_mfma_f32_16x16x32_bf16 v[52:55], a[180:183], v[132:135], v[52:55]
v_mfma_f32_16x16x32_bf16 v[56:59], a[240:243], v[132:135], v[56:59]
v_mfma_f32_16x16x32_bf16 v[60:63], a[244:247], v[132:135], v[60:63]
s_waitcnt vmcnt(13)
s_waitcnt vmcnt(12)
s_waitcnt vmcnt(11)
s_waitcnt vmcnt(10)
s_waitcnt lgkmcnt(0)
s_barrier
ds_read_b128 v[136:139], v252 offset:39936
ds_read_b128 v[140:143], v252 offset:40960
ds_read_b128 v[144:147], v252 offset:41984
ds_read_b128 v[148:151], v252 offset:43008
ds_read_b128 v[152:155], v252 offset:44032
s_waitcnt lgkmcnt(4)
v_mfma_f32_16x16x32_bf16 v[48:51], a[184:187], v[136:139], v[48:51]
ds_read_b128 v[132:135], v252 offset:45056
v_mfma_f32_16x16x32_bf16 v[52:55], a[188:191], v[136:139], v[52:55]
v_mfma_f32_16x16x32_bf16 v[56:59], a[248:251], v[136:139], v[56:59]
v_mfma_f32_16x16x32_bf16 v[60:63], a[252:255], v[136:139], v[60:63]
s_waitcnt lgkmcnt(4)
v_mfma_f32_16x16x32_bf16 v[64:67], a[128:131], v[140:143], v[64:67]
ds_read_b128 v[136:139], v252 offset:46080
v_mfma_f32_16x16x32_bf16 v[68:71], a[132:135], v[140:143], v[68:71]
v_mfma_f32_16x16x32_bf16 v[72:75], a[192:195], v[140:143], v[72:75]
v_mfma_f32_16x16x32_bf16 v[76:79], a[196:199], v[140:143], v[76:79]
v_cvt_pk_bf16_f32 v48, v48, v49
v_cvt_pk_bf16_f32 v49, v50, v51
v_cvt_pk_bf16_f32 v50, v52, v53
v_cvt_pk_bf16_f32 v51, v54, v55
ds_write_b128 v32, v[48:51] offset:0
v_cvt_pk_bf16_f32 v56, v56, v57
v_cvt_pk_bf16_f32 v57, v58, v59
v_cvt_pk_bf16_f32 v58, v60, v61
v_cvt_pk_bf16_f32 v59, v62, v63
ds_write_b128 v33, v[56:59] offset:0
ds_read_b128 v[52:55], v34 offset:0
ds_read_b128 v[60:63], v34 offset:1024
s_waitcnt lgkmcnt(8)
v_mfma_f32_16x16x32_bf16 v[64:67], a[136:139], v[144:147], v[64:67]
ds_read_b128 v[140:143], v252 offset:47104
v_mfma_f32_16x16x32_bf16 v[68:71], a[140:143], v[144:147], v[68:71]
v_mfma_f32_16x16x32_bf16 v[72:75], a[200:203], v[144:147], v[72:75]
v_mfma_f32_16x16x32_bf16 v[76:79], a[204:207], v[144:147], v[76:79]
s_waitcnt lgkmcnt(8)
v_mfma_f32_16x16x32_bf16 v[64:67], a[144:147], v[148:151], v[64:67]
ds_read_b128 v[144:147], v252 offset:48128
v_mfma_f32_16x16x32_bf16 v[68:71], a[148:151], v[148:151], v[68:71]
v_mfma_f32_16x16x32_bf16 v[72:75], a[208:211], v[148:151], v[72:75]
v_mfma_f32_16x16x32_bf16 v[76:79], a[212:215], v[148:151], v[76:79]
s_waitcnt lgkmcnt(8)
v_mfma_f32_16x16x32_bf16 v[64:67], a[152:155], v[152:155], v[64:67]
v_mfma_f32_16x16x32_bf16 v[68:71], a[156:159], v[152:155], v[68:71]
v_mfma_f32_16x16x32_bf16 v[72:75], a[216:219], v[152:155], v[72:75]
v_mfma_f32_16x16x32_bf16 v[76:79], a[220:223], v[152:155], v[76:79]
s_waitcnt lgkmcnt(7)
v_mfma_f32_16x16x32_bf16 v[64:67], a[160:163], v[132:135], v[64:67]
v_mfma_f32_16x16x32_bf16 v[68:71], a[164:167], v[132:135], v[68:71]
v_mfma_f32_16x16x32_bf16 v[72:75], a[224:227], v[132:135], v[72:75]
v_mfma_f32_16x16x32_bf16 v[76:79], a[228:231], v[132:135], v[76:79]
s_waitcnt lgkmcnt(6)
v_mfma_f32_16x16x32_bf16 v[64:67], a[168:171], v[136:139], v[64:67]
v_mfma_f32_16x16x32_bf16 v[68:71], a[172:175], v[136:139], v[68:71]
v_mfma_f32_16x16x32_bf16 v[72:75], a[232:235], v[136:139], v[72:75]
v_mfma_f32_16x16x32_bf16 v[76:79], a[236:239], v[136:139], v[76:79]
s_waitcnt lgkmcnt(1)
v_mfma_f32_16x16x32_bf16 v[64:67], a[176:179], v[140:143], v[64:67]
v_mfma_f32_16x16x32_bf16 v[68:71], a[180:183], v[140:143], v[68:71]
v_mfma_f32_16x16x32_bf16 v[72:75], a[240:243], v[140:143], v[72:75]
v_mfma_f32_16x16x32_bf16 v[76:79], a[244:247], v[140:143], v[76:79]
s_waitcnt lgkmcnt(0)
v_mfma_f32_16x16x32_bf16 v[64:67], a[184:187], v[144:147], v[64:67]
v_mfma_f32_16x16x32_bf16 v[68:71], a[188:191], v[144:147], v[68:71]
v_mfma_f32_16x16x32_bf16 v[72:75], a[248:251], v[144:147], v[72:75]
v_mfma_f32_16x16x32_bf16 v[76:79], a[252:255], v[144:147], v[76:79]
s_waitcnt vmcnt(9)
s_add_u32 s33, s52, 0
buffer_store_dwordx4 v[52:55], v9, s[40:43], s33 offen sc1
s_add_u32 s35, s52, 4096
buffer_store_dwordx4 v[60:63], v9, s[40:43], s35 offen sc1
v_cvt_pk_bf16_f32 v64, v64, v65
v_cvt_pk_bf16_f32 v65, v66, v67
v_cvt_pk_bf16_f32 v66, v68, v69
v_cvt_pk_bf16_f32 v67, v70, v71
ds_write_b128 v32, v[64:67] offset:2048
v_cvt_pk_bf16_f32 v72, v72, v73
v_cvt_pk_bf16_f32 v73, v74, v75
v_cvt_pk_bf16_f32 v74, v76, v77
v_cvt_pk_bf16_f32 v75, v78, v79
ds_write_b128 v33, v[72:75] offset:2048
ds_read_b128 v[68:71], v34 offset:2048
ds_read_b128 v[76:79], v34 offset:3072
ds_read_b128 v[96:99], v46 offset:0
v_lshlrev_b32 v118, 16, v156
v_and_b32 v119, s12, v156
v_mul_f32 v108, v118, v100
v_mul_f32 v109, v119, v100
v_lshlrev_b32 v120, 16, v157
v_and_b32 v121, s12, v157
v_mul_f32 v110, v120, v100
v_mul_f32 v111, v121, v100
v_lshlrev_b32 v122, 16, v158
v_and_b32 v123, s12, v158
v_mul_f32 v112, v122, v100
v_mul_f32 v113, v123, v100
v_lshlrev_b32 v116, 16, v159
v_and_b32 v117, s12, v159
v_mul_f32 v114, v116, v100
v_mul_f32 v115, v117, v100
s_waitcnt vmcnt(10)
s_add_u32 s39, s53, 0
s_waitcnt lgkmcnt(2)
buffer_store_dwordx4 v[68:71], v9, s[40:43], s39 offen sc1
s_add_u32 s32, s53, 4096
s_waitcnt lgkmcnt(1)
buffer_store_dwordx4 v[76:79], v9, s[40:43], s32 offen sc1
v_lshlrev_b32 v118, 16, v160
v_and_b32 v119, s12, v160
v_fmac_f32 v108, v118, v101
v_fmac_f32 v109, v119, v101
v_lshlrev_b32 v120, 16, v161
v_and_b32 v121, s12, v161
v_fmac_f32 v110, v120, v101
v_fmac_f32 v111, v121, v101
v_lshlrev_b32 v122, 16, v162
v_and_b32 v123, s12, v162
v_fmac_f32 v112, v122, v101
v_fmac_f32 v113, v123, v101
v_lshlrev_b32 v116, 16, v163
v_and_b32 v117, s12, v163
v_fmac_f32 v114, v116, v101
v_fmac_f32 v115, v117, v101
s_waitcnt lgkmcnt(0)
v_lshlrev_b32 v118, 16, v96
v_and_b32 v119, s12, v96
v_fmac_f32 v108, v118, v105
v_fmac_f32 v109, v119, v105
v_lshlrev_b32 v120, 16, v97
v_and_b32 v121, s12, v97
v_fmac_f32 v110, v120, v105
v_fmac_f32 v111, v121, v105
v_lshlrev_b32 v122, 16, v98
v_and_b32 v123, s12, v98
v_fmac_f32 v112, v122, v105
v_fmac_f32 v113, v123, v105
v_lshlrev_b32 v116, 16, v99
v_and_b32 v117, s12, v99
v_fmac_f32 v114, v116, v105
v_fmac_f32 v115, v117, v105
s_waitcnt vmcnt(11)
v_lshlrev_b32 v118, 16, v164
v_and_b32 v119, s12, v164
v_fmac_f32 v108, v118, v102
v_fmac_f32 v109, v119, v102
v_lshlrev_b32 v120, 16, v165
v_and_b32 v121, s12, v165
v_fmac_f32 v110, v120, v102
v_fmac_f32 v111, v121, v102
v_lshlrev_b32 v122, 16, v166
v_and_b32 v123, s12, v166
v_fmac_f32 v112, v122, v102
v_fmac_f32 v113, v123, v102
v_lshlrev_b32 v116, 16, v167
v_and_b32 v117, s12, v167
v_fmac_f32 v114, v116, v102
v_fmac_f32 v115, v117, v102
s_waitcnt vmcnt(10)
v_lshlrev_b32 v118, 16, v168
v_and_b32 v119, s12, v168
v_fmac_f32 v108, v118, v103
v_fmac_f32 v109, v119, v103
v_lshlrev_b32 v120, 16, v169
v_and_b32 v121, s12, v169
v_fmac_f32 v110, v120, v103
v_fmac_f32 v111, v121, v103
v_lshlrev_b32 v122, 16, v170
v_and_b32 v123, s12, v170
v_fmac_f32 v112, v122, v103
v_fmac_f32 v113, v123, v103
v_lshlrev_b32 v116, 16, v171
v_and_b32 v117, s12, v171
v_fmac_f32 v114, v116, v103
v_fmac_f32 v115, v117, v103
s_waitcnt vmcnt(9)
v_lshlrev_b32 v118, 16, v172
v_and_b32 v119, s12, v172
v_fmac_f32 v108, v118, v104
v_fmac_f32 v109, v119, v104
v_lshlrev_b32 v120, 16, v173
v_and_b32 v121, s12, v173
v_fmac_f32 v110, v120, v104
v_fmac_f32 v111, v121, v104
v_lshlrev_b32 v122, 16, v174
v_and_b32 v123, s12, v174
v_fmac_f32 v112, v122, v104
v_fmac_f32 v113, v123, v104
v_lshlrev_b32 v116, 16, v175
v_and_b32 v117, s12, v175
v_fmac_f32 v114, v116, v104
v_fmac_f32 v115, v117, v104
v_cvt_pk_bf16_f32 v116, v108, v109
v_cvt_pk_bf16_f32 v117, v110, v111
v_cvt_pk_bf16_f32 v118, v112, v113
v_cvt_pk_bf16_f32 v119, v114, v115
ds_write_b128 v38, v[116:119] offset:16384
s_waitcnt vmcnt(8)
ds_read_b128 v[96:99], v46 offset:1024
v_lshlrev_b32 v118, 16, v176
v_and_b32 v119, s12, v176
v_mul_f32 v108, v118, v100
v_mul_f32 v109, v119, v100
v_lshlrev_b32 v120, 16, v177
v_and_b32 v121, s12, v177
v_mul_f32 v110, v120, v100
v_mul_f32 v111, v121, v100
v_lshlrev_b32 v122, 16, v178
v_and_b32 v123, s12, v178
v_mul_f32 v112, v122, v100
v_mul_f32 v113, v123, v100
v_lshlrev_b32 v116, 16, v179
v_and_b32 v117, s12, v179
v_mul_f32 v114, v116, v100
v_mul_f32 v115, v117, v100
s_waitcnt vmcnt(7)
v_lshlrev_b32 v118, 16, v180
v_and_b32 v119, s12, v180
v_fmac_f32 v108, v118, v101
v_fmac_f32 v109, v119, v101
v_lshlrev_b32 v120, 16, v181
v_and_b32 v121, s12, v181
v_fmac_f32 v110, v120, v101
v_fmac_f32 v111, v121, v101
v_lshlrev_b32 v122, 16, v182
v_and_b32 v123, s12, v182
v_fmac_f32 v112, v122, v101
v_fmac_f32 v113, v123, v101
v_lshlrev_b32 v116, 16, v183
v_and_b32 v117, s12, v183
v_fmac_f32 v114, v116, v101
v_fmac_f32 v115, v117, v101
s_waitcnt lgkmcnt(0)
v_lshlrev_b32 v118, 16, v96
v_and_b32 v119, s12, v96
v_fmac_f32 v108, v118, v105
v_fmac_f32 v109, v119, v105
v_lshlrev_b32 v120, 16, v97
v_and_b32 v121, s12, v97
v_fmac_f32 v110, v120, v105
v_fmac_f32 v111, v121, v105
v_lshlrev_b32 v122, 16, v98
v_and_b32 v123, s12, v98
v_fmac_f32 v112, v122, v105
v_fmac_f32 v113, v123, v105
v_lshlrev_b32 v116, 16, v99
v_and_b32 v117, s12, v99
v_fmac_f32 v114, v116, v105
v_fmac_f32 v115, v117, v105
s_waitcnt vmcnt(6)
v_lshlrev_b32 v118, 16, v184
v_and_b32 v119, s12, v184
v_fmac_f32 v108, v118, v102
v_fmac_f32 v109, v119, v102
v_lshlrev_b32 v120, 16, v185
v_and_b32 v121, s12, v185
v_fmac_f32 v110, v120, v102
v_fmac_f32 v111, v121, v102
v_lshlrev_b32 v122, 16, v186
v_and_b32 v123, s12, v186
v_fmac_f32 v112, v122, v102
v_fmac_f32 v113, v123, v102
v_lshlrev_b32 v116, 16, v187
v_and_b32 v117, s12, v187
v_fmac_f32 v114, v116, v102
v_fmac_f32 v115, v117, v102
s_waitcnt vmcnt(5)
v_lshlrev_b32 v118, 16, v188
v_and_b32 v119, s12, v188
v_fmac_f32 v108, v118, v103
v_fmac_f32 v109, v119, v103
v_lshlrev_b32 v120, 16, v189
v_and_b32 v121, s12, v189
v_fmac_f32 v110, v120, v103
v_fmac_f32 v111, v121, v103
v_lshlrev_b32 v122, 16, v190
v_and_b32 v123, s12, v190
v_fmac_f32 v112, v122, v103
v_fmac_f32 v113, v123, v103
v_lshlrev_b32 v116, 16, v191
v_and_b32 v117, s12, v191
v_fmac_f32 v114, v116, v103
v_fmac_f32 v115, v117, v103
s_waitcnt vmcnt(4)
v_lshlrev_b32 v118, 16, v192
v_and_b32 v119, s12, v192
v_fmac_f32 v108, v118, v104
v_fmac_f32 v109, v119, v104
v_lshlrev_b32 v120, 16, v193
v_and_b32 v121, s12, v193
v_fmac_f32 v110, v120, v104
v_fmac_f32 v111, v121, v104
v_lshlrev_b32 v122, 16, v194
v_and_b32 v123, s12, v194
v_fmac_f32 v112, v122, v104
v_fmac_f32 v113, v123, v104
v_lshlrev_b32 v116, 16, v195
v_and_b32 v117, s12, v195
v_fmac_f32 v114, v116, v104
v_fmac_f32 v115, v117, v104
v_cvt_pk_bf16_f32 v116, v108, v109
v_cvt_pk_bf16_f32 v117, v110, v111
v_cvt_pk_bf16_f32 v118, v112, v113
v_cvt_pk_bf16_f32 v119, v114, v115
ds_write_b128 v39, v[116:119] offset:16384
s_waitcnt lgkmcnt(0)
s_barrier
ds_read_b128 v[148:151], v252 offset:49152
ds_read_b128 v[152:155], v252 offset:50176
ds_read_b128 v[132:135], v252 offset:51200
ds_read_b128 v[136:139], v252 offset:52224
ds_read_b128 v[140:143], v252 offset:53248
s_waitcnt lgkmcnt(4)
v_mfma_f32_16x16x32_bf16 v[80:83], a[128:131], v[148:151], v[80:83]
ds_read_b128 v[144:147], v252 offset:54272
v_mfma_f32_16x16x32_bf16 v[84:87], a[132:135], v[148:151], v[84:87]
v_mfma_f32_16x16x32_bf16 v[88:91], a[192:195], v[148:151], v[88:91]
v_mfma_f32_16x16x32_bf16 v[92:95], a[196:199], v[148:151], v[92:95]
s_waitcnt lgkmcnt(4)
v_mfma_f32_16x16x32_bf16 v[80:83], a[136:139], v[152:155], v[80:83]
ds_read_b128 v[148:151], v252 offset:55296
v_mfma_f32_16x16x32_bf16 v[84:87], a[140:143], v[152:155], v[84:87]
v_mfma_f32_16x16x32_bf16 v[88:91], a[200:203], v[152:155], v[88:91]
v_mfma_f32_16x16x32_bf16 v[92:95], a[204:207], v[152:155], v[92:95]
s_waitcnt lgkmcnt(4)
v_mfma_f32_16x16x32_bf16 v[80:83], a[144:147], v[132:135], v[80:83]
ds_read_b128 v[152:155], v252 offset:56320
v_mfma_f32_16x16x32_bf16 v[84:87], a[148:151], v[132:135], v[84:87]
v_mfma_f32_16x16x32_bf16 v[88:91], a[208:211], v[132:135], v[88:91]
v_mfma_f32_16x16x32_bf16 v[92:95], a[212:215], v[132:135], v[92:95]
s_waitcnt lgkmcnt(4)
v_mfma_f32_16x16x32_bf16 v[80:83], a[152:155], v[136:139], v[80:83]
v_mfma_f32_16x16x32_bf16 v[84:87], a[156:159], v[136:139], v[84:87]
v_mfma_f32_16x16x32_bf16 v[88:91], a[216:219], v[136:139], v[88:91]
v_mfma_f32_16x16x32_bf16 v[92:95], a[220:223], v[136:139], v[92:95]
s_waitcnt lgkmcnt(3)
v_mfma_f32_16x16x32_bf16 v[80:83], a[160:163], v[140:143], v[80:83]
v_mfma_f32_16x16x32_bf16 v[84:87], a[164:167], v[140:143], v[84:87]
v_mfma_f32_16x16x32_bf16 v[88:91], a[224:227], v[140:143], v[88:91]
v_mfma_f32_16x16x32_bf16 v[92:95], a[228:231], v[140:143], v[92:95]
s_waitcnt lgkmcnt(2)
v_mfma_f32_16x16x32_bf16 v[80:83], a[168:171], v[144:147], v[80:83]
v_mfma_f32_16x16x32_bf16 v[84:87], a[172:175], v[144:147], v[84:87]
v_mfma_f32_16x16x32_bf16 v[88:91], a[232:235], v[144:147], v[88:91]
v_mfma_f32_16x16x32_bf16 v[92:95], a[236:239], v[144:147], v[92:95]
s_waitcnt lgkmcnt(1)
v_mfma_f32_16x16x32_bf16 v[80:83], a[176:179], v[148:151], v[80:83]
v_mfma_f32_16x16x32_bf16 v[84:87], a[180:183], v[148:151], v[84:87]
v_mfma_f32_16x16x32_bf16 v[88:91], a[240:243], v[148:151], v[88:91]
v_mfma_f32_16x16x32_bf16 v[92:95], a[244:247], v[148:151], v[92:95]
s_waitcnt lgkmcnt(0)
v_mfma_f32_16x16x32_bf16 v[80:83], a[184:187], v[152:155], v[80:83]
v_mfma_f32_16x16x32_bf16 v[84:87], a[188:191], v[152:155], v[84:87]
v_mfma_f32_16x16x32_bf16 v[88:91], a[248:251], v[152:155], v[88:91]
v_mfma_f32_16x16x32_bf16 v[92:95], a[252:255], v[152:155], v[92:95]
s_nop 4
v_cvt_pk_bf16_f32 v80, v80, v81
v_cvt_pk_bf16_f32 v81, v82, v83
v_cvt_pk_bf16_f32 v82, v84, v85
v_cvt_pk_bf16_f32 v83, v86, v87
ds_write_b128 v35, v[80:83] offset:0
v_cvt_pk_bf16_f32 v88, v88, v89
v_cvt_pk_bf16_f32 v89, v90, v91
v_cvt_pk_bf16_f32 v90, v92, v93
v_cvt_pk_bf16_f32 v91, v94, v95
ds_write_b128 v36, v[88:91] offset:0
ds_read_b128 v[84:87], v37 offset:0
ds_read_b128 v[92:95], v37 offset:1024
s_add_u32 s33, s54, 0
s_waitcnt lgkmcnt(1)
buffer_store_dwordx4 v[84:87], v9, s[40:43], s33 offen sc1
s_add_u32 s35, s54, 4096
s_waitcnt lgkmcnt(0)
buffer_store_dwordx4 v[92:95], v9, s[40:43], s35 offen sc1
s_branch L2_fin
LC_poll:
s_mov_b32 s36, 0
s_cmp_lt_u32 s98, 2
s_cselect_b32 s33, 0xfff, -1
s_cselect_b32 s35, 6, 0x6
LC_poll2:
s_mov_b32 s70, 0
s_atomic_add s70, s[60:61], s48 glc
s_cmp_lt_u32 s2, 240
s_cbranch_scc1 LC_poll3
s_mov_b32 s71, 0
s_atomic_add s71, s[60:61], s49 glc
s_mov_b32 s72, 0
s_atomic_add s72, s[60:61], s50 glc
s_waitcnt lgkmcnt(0)
s_min_u32 s70, s70, s71
s_min_u32 s70, s70, s72
LC_poll3:
s_waitcnt lgkmcnt(0)
s_and_b32 s70, s70, s33
s_cmp_ge_u32 s70, s35
s_cbranch_scc1 LC_poll4
s_sleep 2
s_add_u32 s36, s36, 1
s_cmp_gt_u32 s36, 0x40000
s_cbranch_scc0 LC_poll2
LC_poll4:
s_cmp_lt_u32 s98, 2
s_cbranch_scc1 LC_got
s_mul_i32 s33, s51, 0x600000
v_readfirstlane_b32 s32, v44
s_add_u32 s35, s33, s52
s_mov_b32 m0, s32
s_nop 0
buffer_load_dwordx4 v10, s[20:23], s35 offen offset:0 sc1 lds
buffer_load_dwordx4 v10, s[20:23], s35 offen offset:1024 sc1 lds
v_readfirstlane_b32 s32, v45
s_add_u32 s35, s33, s53
s_mov_b32 m0, s32
s_nop 0
buffer_load_dwordx4 v10, s[20:23], s35 offen offset:0 sc1 lds
buffer_load_dwordx4 v10, s[20:23], s35 offen offset:1024 sc1 lds
v_readfirstlane_b32 s32, v46
s_add_u32 s35, s33, s54
s_mov_b32 m0, s32
s_nop 0
buffer_load_dwordx4 v10, s[20:23], s35 offen offset:0 sc1 lds
buffer_load_dwordx4 v10, s[20:23], s35 offen offset:1024 sc1 lds
s_waitcnt vmcnt(0)
s_branch LC_got
LC_side:
s_cmp_eq_u32 s14, 1
s_cbranch_scc1 LC_sideok
s_cmp_lt_u32 s2, 240
s_cbranch_scc1 LC_side1
s_barrier
LC_side1:
s_mov_b32 s36, 0
s_mov_b32 s33, 0x6c01400
LC_side2:
buffer_load_dword v1, off, s[56:59], s33 sc1
s_waitcnt vmcnt(0)
v_readfirstlane_b32 s99, v1
s_add_u32 s36, s36, 1
s_cmp_gt_u32 s36, 0x40000
s_cbranch_scc1 LC_side3
s_cmp_ge_u32 s99, 60
s_cbranch_scc1 LC_side3
s_sleep 8
s_branch LC_side2
LC_side3:
s_cmp_lt_u32 s98, 2
s_cbranch_scc1 LC_sideok
s_add_u32 s8, s6, 0x0
s_addc_u32 s9, s7, 0
s_mov_b32 s10, 0x4e2000
s_mov_b32 s11, 0x00020000
s_lshl_b32 s55, s34, 13
s_add_u32 s55, s55, 0x21000
s_lshl_b32 s33, s34, 7
v_bfe_u32 v9, v252, 4, 3
v_lshrrev_b32 v1, 7, v252
v_xor_b32 v9, v9, v1
v_lshl_add_u32 v1, v1, 9, s33
v_lshl_add_u32 v9, v9, 4, v1
s_add_u32 m0, s55, 0
s_add_u32 s39, s52, 0
buffer_load_dwordx4 v9, s[8:11], s39 offen lds
s_add_u32 m0, s55, 1024
s_add_u32 s32, s52, 4096
buffer_load_dwordx4 v9, s[8:11], s32 offen lds
s_add_u32 m0, s55, 2048
s_add_u32 s33, s53, 0
buffer_load_dwordx4 v9, s[8:11], s33 offen lds
s_add_u32 m0, s55, 3072
s_add_u32 s35, s53, 4096
buffer_load_dwordx4 v9, s[8:11], s35 offen lds
s_waitcnt vmcnt(0)
s_branch LC_sideok
LC_slow:
s_waitcnt vmcnt(0) lgkmcnt(0)
s_barrier
s_mov_b32 s50, 0xe1a06800
s_mov_b32 s51, 0x4e608d04
s_mul_i32 s39, s37, 9
s_lshr_b64 s[50:51], s[50:51], s39
s_and_b32 s39, s50, 0x1ff
s_bfe_u32 s49, s50, 0x90009
s_sub_u32 s29, s49, s39
s_lshl_b32 s50, s37, 2
s_lshr_b32 s59, 0x766666, s50
s_and_b32 s59, s59, 15
s_sub_u32 s31, s29, s59
s_lshr_b32 s31, s31, 1
s_sub_u32 s31, s31, 1
s_lshl_b32 s39, s39, 14
s_lshl_b32 s49, s49, 14
s_add_u32 s28, s39, 0x4000
s_cmp_eq_u32 s37, 5
s_cselect_b32 s33, 0xff800000, 0
s_mov_b32 s32, 0xffff
s_add_u32 s12, s4, 0x6800000
s_addc_u32 s13, s5, 0
s_mov_b32 s14, s49
s_mov_b32 s15, 0x00020000
s_add_u32 s8, s4, 0x0
s_addc_u32 s9, s5, 0
s_mov_b32 s10, 0x4e4000
s_mov_b32 s11, 0x00020000
s_mul_i32 s35, s37, 0x600000
s_add_u32 s20, s4, 0x2000000
s_addc_u32 s21, s5, 0
s_add_u32 s20, s20, s35
s_addc_u32 s21, s21, 0
s_mov_b32 s22, 0x4e4000
s_mov_b32 s23, 0x00020000
s_add_u32 s24, s4, 0x6000000
s_addc_u32 s25, s5, 0
s_mov_b32 s26, 0x9c800
s_mov_b32 s27, 0x00020000
s_lshl_b32 s35, s38, 4
s_lshl_b32 s41, s34, 2
s_add_u32 s35, s35, s41
s_lshl_b32 s40, s35, 13
s_lshl_b32 s48, s35, 10
s_lshl_b32 s35, s37, 3
s_add_u32 s48, s48, s35
v_bfe_u32 v248, v252, 4, 3
v_lshlrev_b32 v248, 6, v248
v_bfe_u32 v253, v252, 7, 1
v_lshl_or_b32 v248, v253, 10, v248
v_bfe_u32 v253, v252, 8, 2
v_lshl_or_b32 v248, v253, 4, v248
v_bfe_u32 v253, v252, 6, 1
v_lshlrev_b32 v253, 5, v253
v_xor_b32 v248, v248, v253
v_and_b32 v249, 0x1c0, v252
v_bfe_u32 v253, v252, 9, 1
v_lshl_or_b32 v249, v253, 10, v249
v_bfe_u32 v253, v252, 8, 1
v_lshl_or_b32 v249, v253, 5, v249
v_bfe_u32 v253, v252, 4, 2
v_lshl_or_b32 v249, v253, 3, v249
v_xor_b32 v250, 32, v249
v_and_b32 v251, 0xfffffe7f, v251
s_mul_i32 s36, s34, 0xa000
s_mov_b32 s56, s36
s_add_u32 s57, s56, 32768
s_mov_b32 s55, 4
v_bfe_i32 v188, v252, 8, 1
LS_q:
s_add_u32 s44, s40, 4096
buffer_load_dwordx4 v[0:3], v252, s[8:11], s40 offen offset:0
buffer_load_dwordx4 v[4:7], v252, s[8:11], s40 offen offset:1024
buffer_load_dwordx4 v[8:11], v252, s[8:11], s40 offen offset:2048
buffer_load_dwordx4 v[12:15], v252, s[8:11], s40 offen offset:3072
buffer_load_dwordx4 v[16:19], v252, s[8:11], s44 offen offset:0
buffer_load_dwordx4 v[20:23], v252, s[8:11], s44 offen offset:1024
buffer_load_dwordx4 v[24:27], v252, s[8:11], s44 offen offset:2048
buffer_load_dwordx4 v[28:31], v252, s[8:11], s44 offen offset:3072
s_mov_b32 s53, s56
s_mov_b32 s58, s39
s_add_u32 m0, s53, 0
s_add_u32 s54, s58, 0
buffer_load_dwordx4 v251, s[12:15], s54 offen offset:0 lds
buffer_load_dwordx4 v251, s[12:15], s54 offen offset:1024 lds
buffer_load_dwordx4 v251, s[12:15], s54 offen offset:2048 lds
buffer_load_dwordx4 v251, s[12:15], s54 offen offset:3072 lds
s_add_u32 m0, s53, 4096
s_add_u32 s54, s58, 128
buffer_load_dwordx4 v251, s[12:15], s54 offen offset:0 lds
buffer_load_dwordx4 v251, s[12:15], s54 offen offset:1024 lds
buffer_load_dwordx4 v251, s[12:15], s54 offen offset:2048 lds
buffer_load_dwordx4 v251, s[12:15], s54 offen offset:3072 lds
s_add_u32 m0, s53, 8192
s_add_u32 s54, s58, 256
buffer_load_dwordx4 v251, s[12:15], s54 offen offset:0 lds
buffer_load_dwordx4 v251, s[12:15], s54 offen offset:1024 lds
buffer_load_dwordx4 v251, s[12:15], s54 offen offset:2048 lds
buffer_load_dwordx4 v251, s[12:15], s54 offen offset:3072 lds
s_add_u32 m0, s53, 12288
s_add_u32 s54, s58, 384
buffer_load_dwordx4 v251, s[12:15], s54 offen offset:0 lds
buffer_load_dwordx4 v251, s[12:15], s54 offen offset:1024 lds
buffer_load_dwordx4 v251, s[12:15], s54 offen offset:2048 lds
buffer_load_dwordx4 v251, s[12:15], s54 offen offset:3072 lds
s_add_u32 s53, s53, 0x4000
s_cmp_eq_u32 s53, s57
s_cselect_b32 s53, s56, s53
s_add_u32 s58, s58, 0x4000
s_mov_b32 s51, s29
s_mov_b32 s52, s56
v_mov_b32 v172, 0xff800000
v_accvgpr_write_b32 a0, 0
v_accvgpr_write_b32 a1, 0
v_accvgpr_write_b32 a2, 0
v_accvgpr_write_b32 a3, 0
v_accvgpr_write_b32 a4, 0
v_accvgpr_write_b32 a5, 0
v_accvgpr_write_b32 a6, 0
v_accvgpr_write_b32 a7, 0
v_accvgpr_write_b32 a8, 0
v_accvgpr_write_b32 a9, 0
v_accvgpr_write_b32 a10, 0
v_accvgpr_write_b32 a11, 0
v_accvgpr_write_b32 a12, 0
v_accvgpr_write_b32 a13, 0
v_accvgpr_write_b32 a14, 0
v_accvgpr_write_b32 a15, 0
v_accvgpr_write_b32 a16, 0
v_accvgpr_write_b32 a17, 0
v_accvgpr_write_b32 a18, 0
v_accvgpr_write_b32 a19, 0
v_accvgpr_write_b32 a20, 0
v_accvgpr_write_b32 a21, 0
v_accvgpr_write_b32 a22, 0
v_accvgpr_write_b32 a23, 0
v_accvgpr_write_b32 a24, 0
v_accvgpr_write_b32 a25, 0
v_accvgpr_write_b32 a26, 0
v_accvgpr_write_b32 a27, 0
v_accvgpr_write_b32 a28, 0
v_accvgpr_write_b32 a29, 0
v_accvgpr_write_b32 a30, 0
v_accvgpr_write_b32 a31, 0
v_accvgpr_write_b32 a32, 0
v_accvgpr_write_b32 a33, 0
v_accvgpr_write_b32 a34, 0
v_accvgpr_write_b32 a35, 0
v_accvgpr_write_b32 a36, 0
v_accvgpr_write_b32 a37, 0
v_accvgpr_write_b32 a38, 0
v_accvgpr_write_b32 a39, 0
v_accvgpr_write_b32 a40, 0
v_accvgpr_write_b32 a41, 0
v_accvgpr_write_b32 a42, 0
v_accvgpr_write_b32 a43, 0
v_accvgpr_write_b32 a44, 0
v_accvgpr_write_b32 a45, 0
v_accvgpr_write_b32 a46, 0
v_accvgpr_write_b32 a47, 0
v_accvgpr_write_b32 a48, 0
v_accvgpr_write_b32 a49, 0
v_accvgpr_write_b32 a50, 0
v_accvgpr_write_b32 a51, 0
v_accvgpr_write_b32 a52, 0
v_accvgpr_write_b32 a53, 0
v_accvgpr_write_b32 a54, 0
v_accvgpr_write_b32 a55, 0
v_accvgpr_write_b32 a56, 0
v_accvgpr_write_b32 a57, 0
v_accvgpr_write_b32 a58, 0
v_accvgpr_write_b32 a59, 0
v_accvgpr_write_b32 a60, 0
v_accvgpr_write_b32 a61, 0
v_accvgpr_write_b32 a62, 0
v_accvgpr_write_b32 a63, 0
LS_loop:
s_add_u32 m0, s53, 0
s_add_u32 s54, s58, 0
buffer_load_dwordx4 v251, s[12:15], s54 offen offset:0 lds
buffer_load_dwordx4 v251, s[12:15], s54 offen offset:1024 lds
buffer_load_dwordx4 v251, s[12:15], s54 offen offset:2048 lds
buffer_load_dwordx4 v251, s[12:15], s54 offen offset:3072 lds
s_add_u32 m0, s53, 4096
s_add_u32 s54, s58, 128
buffer_load_dwordx4 v251, s[12:15], s54 offen offset:0 lds
buffer_load_dwordx4 v251, s[12:15], s54 offen offset:1024 lds
buffer_load_dwordx4 v251, s[12:15], s54 offen offset:2048 lds
buffer_load_dwordx4 v251, s[12:15], s54 offen offset:3072 lds
s_add_u32 m0, s53, 8192
s_add_u32 s54, s58, 256
buffer_load_dwordx4 v251, s[12:15], s54 offen offset:0 lds
buffer_load_dwordx4 v251, s[12:15], s54 offen offset:1024 lds
buffer_load_dwordx4 v251, s[12:15], s54 offen offset:2048 lds
buffer_load_dwordx4 v251, s[12:15], s54 offen offset:3072 lds
s_add_u32 m0, s53, 12288
s_add_u32 s54, s58, 384
buffer_load_dwordx4 v251, s[12:15], s54 offen offset:0 lds
buffer_load_dwordx4 v251, s[12:15], s54 offen offset:1024 lds
buffer_load_dwordx4 v251, s[12:15], s54 offen offset:2048 lds
buffer_load_dwordx4 v251, s[12:15], s54 offen offset:3072 lds
s_add_u32 s53, s53, 0x4000
s_cmp_eq_u32 s53, s57
s_cselect_b32 s53, s56, s53
s_add_u32 s58, s58, 0x4000
v_add_u32 v177, s52, v248
v_add_u32 v178, s52, v249
v_add_u32 v179, s52, v250
s_add_u32 s52, s52, 0x4000
s_cmp_eq_u32 s52, s57
s_cselect_b32 s52, s56, s52
s_cmp_eq_u32 s51, 1
s_cselect_b32 s54, s33, 0
v_and_b32 v192, s54, v188
v_and_b32 v193, s54, v188
v_and_b32 v194, s54, v188
v_and_b32 v195, s54, v188
s_waitcnt vmcnt(16)
ds_read_b128 v[32:35], v177 offset:0
ds_read_b128 v[64:67], v177 offset:2048
ds_read_b128 v[36:39], v177 offset:512
ds_read_b128 v[68:71], v177 offset:2560
ds_read_b128 v[40:43], v177 offset:4096
ds_read_b128 v[72:75], v177 offset:6144
ds_read_b128 v[44:47], v177 offset:4608
ds_read_b128 v[76:79], v177 offset:6656
ds_read_b128 v[48:51], v177 offset:8192
ds_read_b128 v[80:83], v177 offset:10240
ds_read_b128 v[52:55], v177 offset:8704
ds_read_b128 v[84:87], v177 offset:10752
ds_read_b128 v[56:59], v177 offset:12288
ds_read_b128 v[88:91], v177 offset:14336
ds_read_b128 v[60:63], v177 offset:12800
ds_read_b128 v[92:95], v177 offset:14848
s_waitcnt lgkmcnt(14)
v_mfma_f32_16x16x32_bf16 v[160:163], v[32:35], v[0:3], v[192:195]
v_mfma_f32_16x16x32_bf16 v[164:167], v[64:67], v[0:3], v[192:195]
s_waitcnt lgkmcnt(12)
v_mfma_f32_16x16x32_bf16 v[160:163], v[36:39], v[4:7], v[160:163]
v_mfma_f32_16x16x32_bf16 v[164:167], v[68:71], v[4:7], v[164:167]
s_waitcnt lgkmcnt(10)
v_mfma_f32_16x16x32_bf16 v[160:163], v[40:43], v[8:11], v[160:163]
v_mfma_f32_16x16x32_bf16 v[164:167], v[72:75], v[8:11], v[164:167]
s_waitcnt lgkmcnt(8)
v_mfma_f32_16x16x32_bf16 v[160:163], v[44:47], v[12:15], v[160:163]
v_mfma_f32_16x16x32_bf16 v[164:167], v[76:79], v[12:15], v[164:167]
s_waitcnt lgkmcnt(6)
v_mfma_f32_16x16x32_bf16 v[160:163], v[48:51], v[16:19], v[160:163]
v_mfma_f32_16x16x32_bf16 v[164:167], v[80:83], v[16:19], v[164:167]
s_waitcnt lgkmcnt(4)
v_mfma_f32_16x16x32_bf16 v[160:163], v[52:55], v[20:23], v[160:163]
v_mfma_f32_16x16x32_bf16 v[164:167], v[84:87], v[20:23], v[164:167]
s_waitcnt lgkmcnt(2)
v_mfma_f32_16x16x32_bf16 v[160:163], v[56:59], v[24:27], v[160:163]
v_mfma_f32_16x16x32_bf16 v[164:167], v[88:91], v[24:27], v[164:167]
s_waitcnt lgkmcnt(0)
v_mfma_f32_16x16x32_bf16 v[160:163], v[60:63], v[28:31], v[160:163]
v_mfma_f32_16x16x32_bf16 v[164:167], v[92:95], v[28:31], v[164:167]
ds_read_b64_tr_b16 v[96:97], v178 offset:0
ds_read_b64_tr_b16 v[98:99], v178 offset:2048
ds_read_b64_tr_b16 v[100:101], v179 offset:0
ds_read_b64_tr_b16 v[102:103], v179 offset:2048
ds_read_b64_tr_b16 v[104:105], v178 offset:512
ds_read_b64_tr_b16 v[106:107], v178 offset:2560
ds_read_b64_tr_b16 v[108:109], v179 offset:512
ds_read_b64_tr_b16 v[110:111], v179 offset:2560
ds_read_b64_tr_b16 v[112:113], v178 offset:4096
ds_read_b64_tr_b16 v[114:115], v178 offset:6144
ds_read_b64_tr_b16 v[116:117], v179 offset:4096
ds_read_b64_tr_b16 v[118:119], v179 offset:6144
ds_read_b64_tr_b16 v[120:121], v178 offset:4608
ds_read_b64_tr_b16 v[122:123], v178 offset:6656
ds_read_b64_tr_b16 v[124:125], v179 offset:4608
ds_read_b64_tr_b16 v[126:127], v179 offset:6656
ds_read_b64_tr_b16 v[128:129], v178 offset:8192
ds_read_b64_tr_b16 v[130:131], v178 offset:10240
ds_read_b64_tr_b16 v[132:133], v179 offset:8192
ds_read_b64_tr_b16 v[134:135], v179 offset:10240
ds_read_b64_tr_b16 v[136:137], v178 offset:8704
ds_read_b64_tr_b16 v[138:139], v178 offset:10752
ds_read_b64_tr_b16 v[140:141], v179 offset:8704
ds_read_b64_tr_b16 v[142:143], v179 offset:10752
ds_read_b64_tr_b16 v[144:145], v178 offset:12288
ds_read_b64_tr_b16 v[146:147], v178 offset:14336
ds_read_b64_tr_b16 v[148:149], v179 offset:12288
ds_read_b64_tr_b16 v[150:151], v179 offset:14336
ds_read_b64_tr_b16 v[152:153], v178 offset:12800
ds_read_b64_tr_b16 v[154:155], v178 offset:14848
ds_read_b64_tr_b16 v[156:157], v179 offset:12800
ds_read_b64_tr_b16 v[158:159], v179 offset:14848
s_nop 7
v_max3_f32 v175, v160, v161, v162
v_max3_f32 v175, v175, v163, v164
v_max3_f32 v175, v175, v165, v166
v_max3_f32 v175, v175, v167, v172
v_mov_b32 v176, v175
s_nop 1
v_permlane32_swap_b32 v175, v176
s_nop 1
v_max_f32 v175, v175, v176
v_mov_b32 v176, v175
s_nop 1
v_permlane16_swap_b32 v175, v176
s_nop 1
v_max_f32 v175, v175, v176
v_sub_f32 v174, v172, v175
v_exp_f32 v174, v174
v_mov_b32 v172, v175
v_sub_f32 v160, v160, v172
v_sub_f32 v161, v161, v172
v_sub_f32 v162, v162, v172
v_sub_f32 v163, v163, v172
v_sub_f32 v164, v164, v172
v_sub_f32 v165, v165, v172
v_sub_f32 v166, v166, v172
v_sub_f32 v167, v167, v172
v_exp_f32 v160, v160
v_exp_f32 v161, v161
v_exp_f32 v162, v162
v_exp_f32 v163, v163
v_exp_f32 v164, v164
v_exp_f32 v165, v165
v_exp_f32 v166, v166
v_exp_f32 v167, v167
v_cmp_neq_f32 vcc, 1.0, v174
v_cvt_pk_bf16_f32 v168, v160, v161
v_cvt_pk_bf16_f32 v169, v162, v163
v_cvt_pk_bf16_f32 v170, v164, v165
v_cvt_pk_bf16_f32 v171, v166, v167
s_cbranch_vccz LS_nors
v_accvgpr_read_b32 v180, a0
v_accvgpr_read_b32 v181, a1
v_accvgpr_read_b32 v182, a2
v_accvgpr_read_b32 v183, a3
v_accvgpr_read_b32 v184, a4
v_accvgpr_read_b32 v185, a5
v_accvgpr_read_b32 v186, a6
v_accvgpr_read_b32 v187, a7
v_mul_f32 v180, v180, v174
v_mul_f32 v181, v181, v174
v_mul_f32 v182, v182, v174
v_mul_f32 v183, v183, v174
v_mul_f32 v184, v184, v174
v_mul_f32 v185, v185, v174
v_mul_f32 v186, v186, v174
v_mul_f32 v187, v187, v174
v_accvgpr_write_b32 a0, v180
v_accvgpr_write_b32 a1, v181
v_accvgpr_write_b32 a2, v182
v_accvgpr_write_b32 a3, v183
v_accvgpr_write_b32 a4, v184
v_accvgpr_write_b32 a5, v185
v_accvgpr_write_b32 a6, v186
v_accvgpr_write_b32 a7, v187
v_accvgpr_read_b32 v180, a8
v_accvgpr_read_b32 v181, a9
v_accvgpr_read_b32 v182, a10
v_accvgpr_read_b32 v183, a11
v_accvgpr_read_b32 v184, a12
v_accvgpr_read_b32 v185, a13
v_accvgpr_read_b32 v186, a14
v_accvgpr_read_b32 v187, a15
v_mul_f32 v180, v180, v174
v_mul_f32 v181, v181, v174
v_mul_f32 v182, v182, v174
v_mul_f32 v183, v183, v174
v_mul_f32 v184, v184, v174
v_mul_f32 v185, v185, v174
v_mul_f32 v186, v186, v174
v_mul_f32 v187, v187, v174
v_accvgpr_write_b32 a8, v180
v_accvgpr_write_b32 a9, v181
v_accvgpr_write_b32 a10, v182
v_accvgpr_write_b32 a11, v183
v_accvgpr_write_b32 a12, v184
v_accvgpr_write_b32 a13, v185
v_accvgpr_write_b32 a14, v186
v_accvgpr_write_b32 a15, v187
v_accvgpr_read_b32 v180, a16
v_accvgpr_read_b32 v181, a17
v_accvgpr_read_b32 v182, a18
v_accvgpr_read_b32 v183, a19
v_accvgpr_read_b32 v184, a20
v_accvgpr_read_b32 v185, a21
v_accvgpr_read_b32 v186, a22
v_accvgpr_read_b32 v187, a23
v_mul_f32 v180, v180, v174
v_mul_f32 v181, v181, v174
v_mul_f32 v182, v182, v174
v_mul_f32 v183, v183, v174
v_mul_f32 v184, v184, v174
v_mul_f32 v185, v185, v174
v_mul_f32 v186, v186, v174
v_mul_f32 v187, v187, v174
v_accvgpr_write_b32 a16, v180
v_accvgpr_write_b32 a17, v181
v_accvgpr_write_b32 a18, v182
v_accvgpr_write_b32 a19, v183
v_accvgpr_write_b32 a20, v184
v_accvgpr_write_b32 a21, v185
v_accvgpr_write_b32 a22, v186
v_accvgpr_write_b32 a23, v187
v_accvgpr_read_b32 v180, a24
v_accvgpr_read_b32 v181, a25
v_accvgpr_read_b32 v182, a26
v_accvgpr_read_b32 v183, a27
v_accvgpr_read_b32 v184, a28
v_accvgpr_read_b32 v185, a29
v_accvgpr_read_b32 v186, a30
v_accvgpr_read_b32 v187, a31
v_mul_f32 v180, v180, v174
v_mul_f32 v181, v181, v174
v_mul_f32 v182, v182, v174
v_mul_f32 v183, v183, v174
v_mul_f32 v184, v184, v174
v_mul_f32 v185, v185, v174
v_mul_f32 v186, v186, v174
v_mul_f32 v187, v187, v174
v_accvgpr_write_b32 a24, v180
v_accvgpr_write_b32 a25, v181
v_accvgpr_write_b32 a26, v182
v_accvgpr_write_b32 a27, v183
v_accvgpr_write_b32 a28, v184
v_accvgpr_write_b32 a29, v185
v_accvgpr_write_b32 a30, v186
v_accvgpr_write_b32 a31, v187
v_accvgpr_read_b32 v180, a32
v_accvgpr_read_b32 v181, a33
v_accvgpr_read_b32 v182, a34
v_accvgpr_read_b32 v183, a35
v_accvgpr_read_b32 v184, a36
v_accvgpr_read_b32 v185, a37
v_accvgpr_read_b32 v186, a38
v_accvgpr_read_b32 v187, a39
v_mul_f32 v180, v180, v174
v_mul_f32 v181, v181, v174
v_mul_f32 v182, v182, v174
v_mul_f32 v183, v183, v174
v_mul_f32 v184, v184, v174
v_mul_f32 v185, v185, v174
v_mul_f32 v186, v186, v174
v_mul_f32 v187, v187, v174
v_accvgpr_write_b32 a32, v180
v_accvgpr_write_b32 a33, v181
v_accvgpr_write_b32 a34, v182
v_accvgpr_write_b32 a35, v183
v_accvgpr_write_b32 a36, v184
v_accvgpr_write_b32 a37, v185
v_accvgpr_write_b32 a38, v186
v_accvgpr_write_b32 a39, v187
v_accvgpr_read_b32 v180, a40
v_accvgpr_read_b32 v181, a41
v_accvgpr_read_b32 v182, a42
v_accvgpr_read_b32 v183, a43
v_accvgpr_read_b32 v184, a44
v_accvgpr_read_b32 v185, a45
v_accvgpr_read_b32 v186, a46
v_accvgpr_read_b32 v187, a47
v_mul_f32 v180, v180, v174
v_mul_f32 v181, v181, v174
v_mul_f32 v182, v182, v174
v_mul_f32 v183, v183, v174
v_mul_f32 v184, v184, v174
v_mul_f32 v185, v185, v174
v_mul_f32 v186, v186, v174
v_mul_f32 v187, v187, v174
v_accvgpr_write_b32 a40, v180
v_accvgpr_write_b32 a41, v181
v_accvgpr_write_b32 a42, v182
v_accvgpr_write_b32 a43, v183
v_accvgpr_write_b32 a44, v184
v_accvgpr_write_b32 a45, v185
v_accvgpr_write_b32 a46, v186
v_accvgpr_write_b32 a47, v187
v_accvgpr_read_b32 v180, a48
v_accvgpr_read_b32 v181, a49
v_accvgpr_read_b32 v182, a50
v_accvgpr_read_b32 v183, a51
v_accvgpr_read_b32 v184, a52
v_accvgpr_read_b32 v185, a53
v_accvgpr_read_b32 v186, a54
v_accvgpr_read_b32 v187, a55
v_mul_f32 v180, v180, v174
v_mul_f32 v181, v181, v174
v_mul_f32 v182, v182, v174
v_mul_f32 v183, v183, v174
v_mul_f32 v184, v184, v174
v_mul_f32 v185, v185, v174
v_mul_f32 v186, v186, v174
v_mul_f32 v187, v187, v174
v_accvgpr_write_b32 a48, v180
v_accvgpr_write_b32 a49, v181
v_accvgpr_write_b32 a50, v182
v_accvgpr_write_b32 a51, v183
v_accvgpr_write_b32 a52, v184
v_accvgpr_write_b32 a53, v185
v_accvgpr_write_b32 a54, v186
v_accvgpr_write_b32 a55, v187
v_accvgpr_read_b32 v180, a56
v_accvgpr_read_b32 v181, a57
v_accvgpr_read_b32 v182, a58
v_accvgpr_read_b32 v183, a59
v_accvgpr_read_b32 v184, a60
v_accvgpr_read_b32 v185, a61
v_accvgpr_read_b32 v186, a62
v_accvgpr_read_b32 v187, a63
v_mul_f32 v180, v180, v174
v_mul_f32 v181, v181, v174
v_mul_f32 v182, v182, v174
v_mul_f32 v183, v183, v174
v_mul_f32 v184, v184, v174
v_mul_f32 v185, v185, v174
v_mul_f32 v186, v186, v174
v_mul_f32 v187, v187, v174
v_accvgpr_write_b32 a56, v180
v_accvgpr_write_b32 a57, v181
v_accvgpr_write_b32 a58, v182
v_accvgpr_write_b32 a59, v183
v_accvgpr_write_b32 a60, v184
v_accvgpr_write_b32 a61, v185
v_accvgpr_write_b32 a62, v186
v_accvgpr_write_b32 a63, v187
LS_nors:
s_waitcnt lgkmcnt(0)
s_nop 1
v_mfma_f32_16x16x32_bf16 a[0:3], v[96:99], v[168:171], a[0:3]
v_mfma_f32_16x16x32_bf16 a[4:7], v[100:103], v[168:171], a[4:7]
v_mfma_f32_16x16x32_bf16 a[8:11], v[104:107], v[168:171], a[8:11]
v_mfma_f32_16x16x32_bf16 a[12:15], v[108:111], v[168:171], a[12:15]
v_mfma_f32_16x16x32_bf16 a[16:19], v[112:115], v[168:171], a[16:19]
v_mfma_f32_16x16x32_bf16 a[20:23], v[116:119], v[168:171], a[20:23]
v_mfma_f32_16x16x32_bf16 a[24:27], v[120:123], v[168:171], a[24:27]
v_mfma_f32_16x16x32_bf16 a[28:31], v[124:127], v[168:171], a[28:31]
v_mfma_f32_16x16x32_bf16 a[32:35], v[128:131], v[168:171], a[32:35]
v_mfma_f32_16x16x32_bf16 a[36:39], v[132:135], v[168:171], a[36:39]
v_mfma_f32_16x16x32_bf16 a[40:43], v[136:139], v[168:171], a[40:43]
v_mfma_f32_16x16x32_bf16 a[44:47], v[140:143], v[168:171], a[44:47]
v_mfma_f32_16x16x32_bf16 a[48:51], v[144:147], v[168:171], a[48:51]
v_mfma_f32_16x16x32_bf16 a[52:55], v[148:151], v[168:171], a[52:55]
v_mfma_f32_16x16x32_bf16 a[56:59], v[152:155], v[168:171], a[56:59]
v_mfma_f32_16x16x32_bf16 a[60:63], v[156:159], v[168:171], a[60:63]
s_sub_u32 s51, s51, 1
s_cmp_lg_u32 s51, 0
s_cbranch_scc1 LS_loop
s_nop 15
v_accvgpr_read_b32 v173, a0
v_accvgpr_read_b32 v180, a0
v_accvgpr_read_b32 v181, a1
v_accvgpr_read_b32 v182, a2
v_accvgpr_read_b32 v183, a3
v_accvgpr_read_b32 v184, a4
v_accvgpr_read_b32 v185, a5
v_accvgpr_read_b32 v186, a6
v_accvgpr_read_b32 v187, a7
v_cvt_pk_bf16_f32 v32, v180, v181
v_cvt_pk_bf16_f32 v33, v182, v183
v_cvt_pk_bf16_f32 v34, v184, v185
v_cvt_pk_bf16_f32 v35, v186, v187
buffer_store_dwordx4 v[32:35], v252, s[20:23], s40 offen offset:0 sc1
v_accvgpr_read_b32 v180, a8
v_accvgpr_read_b32 v181, a9
v_accvgpr_read_b32 v182, a10
v_accvgpr_read_b32 v183, a11
v_accvgpr_read_b32 v184, a12
v_accvgpr_read_b32 v185, a13
v_accvgpr_read_b32 v186, a14
v_accvgpr_read_b32 v187, a15
v_cvt_pk_bf16_f32 v36, v180, v181
v_cvt_pk_bf16_f32 v37, v182, v183
v_cvt_pk_bf16_f32 v38, v184, v185
v_cvt_pk_bf16_f32 v39, v186, v187
buffer_store_dwordx4 v[36:39], v252, s[20:23], s40 offen offset:1024 sc1
v_accvgpr_read_b32 v180, a16
v_accvgpr_read_b32 v181, a17
v_accvgpr_read_b32 v182, a18
v_accvgpr_read_b32 v183, a19
v_accvgpr_read_b32 v184, a20
v_accvgpr_read_b32 v185, a21
v_accvgpr_read_b32 v186, a22
v_accvgpr_read_b32 v187, a23
v_cvt_pk_bf16_f32 v40, v180, v181
v_cvt_pk_bf16_f32 v41, v182, v183
v_cvt_pk_bf16_f32 v42, v184, v185
v_cvt_pk_bf16_f32 v43, v186, v187
buffer_store_dwordx4 v[40:43], v252, s[20:23], s40 offen offset:2048 sc1
v_accvgpr_read_b32 v180, a24
v_accvgpr_read_b32 v181, a25
v_accvgpr_read_b32 v182, a26
v_accvgpr_read_b32 v183, a27
v_accvgpr_read_b32 v184, a28
v_accvgpr_read_b32 v185, a29
v_accvgpr_read_b32 v186, a30
v_accvgpr_read_b32 v187, a31
v_cvt_pk_bf16_f32 v44, v180, v181
v_cvt_pk_bf16_f32 v45, v182, v183
v_cvt_pk_bf16_f32 v46, v184, v185
v_cvt_pk_bf16_f32 v47, v186, v187
buffer_store_dwordx4 v[44:47], v252, s[20:23], s40 offen offset:3072 sc1
v_accvgpr_read_b32 v180, a32
v_accvgpr_read_b32 v181, a33
v_accvgpr_read_b32 v182, a34
v_accvgpr_read_b32 v183, a35
v_accvgpr_read_b32 v184, a36
v_accvgpr_read_b32 v185, a37
v_accvgpr_read_b32 v186, a38
v_accvgpr_read_b32 v187, a39
v_cvt_pk_bf16_f32 v48, v180, v181
v_cvt_pk_bf16_f32 v49, v182, v183
v_cvt_pk_bf16_f32 v50, v184, v185
v_cvt_pk_bf16_f32 v51, v186, v187
buffer_store_dwordx4 v[48:51], v252, s[20:23], s44 offen offset:0 sc1
v_accvgpr_read_b32 v180, a40
v_accvgpr_read_b32 v181, a41
v_accvgpr_read_b32 v182, a42
v_accvgpr_read_b32 v183, a43
v_accvgpr_read_b32 v184, a44
v_accvgpr_read_b32 v185, a45
v_accvgpr_read_b32 v186, a46
v_accvgpr_read_b32 v187, a47
v_cvt_pk_bf16_f32 v52, v180, v181
v_cvt_pk_bf16_f32 v53, v182, v183
v_cvt_pk_bf16_f32 v54, v184, v185
v_cvt_pk_bf16_f32 v55, v186, v187
buffer_store_dwordx4 v[52:55], v252, s[20:23], s44 offen offset:1024 sc1
v_accvgpr_read_b32 v180, a48
v_accvgpr_read_b32 v181, a49
v_accvgpr_read_b32 v182, a50
v_accvgpr_read_b32 v183, a51
v_accvgpr_read_b32 v184, a52
v_accvgpr_read_b32 v185, a53
v_accvgpr_read_b32 v186, a54
v_accvgpr_read_b32 v187, a55
v_cvt_pk_bf16_f32 v56, v180, v181
v_cvt_pk_bf16_f32 v57, v182, v183
v_cvt_pk_bf16_f32 v58, v184, v185
v_cvt_pk_bf16_f32 v59, v186, v187
buffer_store_dwordx4 v[56:59], v252, s[20:23], s44 offen offset:2048 sc1
v_accvgpr_read_b32 v180, a56
v_accvgpr_read_b32 v181, a57
v_accvgpr_read_b32 v182, a58
v_accvgpr_read_b32 v183, a59
v_accvgpr_read_b32 v184, a60
v_accvgpr_read_b32 v185, a61
v_accvgpr_read_b32 v186, a62
v_accvgpr_read_b32 v187, a63
v_cvt_pk_bf16_f32 v60, v180, v181
v_cvt_pk_bf16_f32 v61, v182, v183
v_cvt_pk_bf16_f32 v62, v184, v185
v_cvt_pk_bf16_f32 v63, v186, v187
buffer_store_dwordx4 v[60:63], v252, s[20:23], s44 offen offset:3072 sc1
v_lshlrev_b32 v175, 2, v252
s_mov_b64 exec, 0xffff
buffer_store_dwordx2 v[172:173], v175, s[24:27], s48 offen sc1
s_mov_b64 exec, -1
s_waitcnt vmcnt(0)
s_add_u32 s40, s40, 8192
s_add_u32 s48, s48, 1024
s_sub_u32 s55, s55, 1
s_cmp_lg_u32 s55, 0
s_cbranch_scc1 LS_q
s_barrier
s_add_u32 s56, s4, 0x1000000
s_addc_u32 s57, s5, 0
s_mov_b32 s58, 0x6c02000
s_mov_b32 s59, 0x00020000
s_mul_i32 s35, s37, 3
s_and_b32 s36, s35, 3
s_lshl_b32 s36, s36, 2
s_lshr_b32 s52, s35, 2
s_add_u32 s36, s36, s52
s_lshl_b32 s52, s38, 4
s_add_u32 s52, s52, s36
s_lshl_b32 s52, s52, 13
s_add_u32 s35, s35, 1
s_and_b32 s36, s35, 3
s_lshl_b32 s36, s36, 2
s_lshr_b32 s53, s35, 2
s_add_u32 s36, s36, s53
s_lshl_b32 s53, s38, 4
s_add_u32 s53, s53, s36
s_lshl_b32 s53, s53, 13
s_add_u32 s35, s35, 1
s_and_b32 s36, s35, 3
s_lshl_b32 s36, s36, 2
s_lshr_b32 s54, s35, 2
s_add_u32 s36, s36, s54
s_lshl_b32 s54, s38, 4
s_add_u32 s54, s54, s36
s_lshl_b32 s54, s54, 13
s_mov_b32 s99, 0
s_mov_b32 s98, 2
s_branch LC_again
LT_disp:
s_cmp_eq_u32 s34, 0
s_cbranch_scc1 LT_start
s_mov_b32 s41, s34
s_mul_i32 s40, s34, 6
s_add_u32 s40, s40, s37
s_add_u32 s40, s40, 42
s_cmp_lt_u32 s40, 60
s_cbranch_scc1 LE_common
s_branch L2_end
LT_start:
s_waitcnt lgkmcnt(0)
s_add_u32 s12, s4, 0x6800000
s_addc_u32 s13, s5, 0
s_mov_b32 s14, s49
s_mov_b32 s15, 0x00020000
s_add_u32 s8, s4, 0x0
s_addc_u32 s9, s5, 0
s_mov_b32 s10, 0x4e4000
s_mov_b32 s11, 0x00020000
s_mul_i32 s35, s37, 0x600000
s_add_u32 s20, s4, 0x2000000
s_addc_u32 s21, s5, 0
s_add_u32 s20, s20, s35
s_addc_u32 s21, s21, 0
s_mov_b32 s22, 0x4e4000
s_mov_b32 s23, 0x00020000
s_add_u32 s24, s4, 0x6000000
s_addc_u32 s25, s5, 0
s_mov_b32 s26, 0x9c800
s_mov_b32 s27, 0x00020000
s_lshl_b32 s35, s38, 4
s_lshl_b32 s41, s34, 2
s_add_u32 s35, s35, s41
s_lshl_b32 s40, s35, 13
s_lshl_b32 s48, s35, 10
s_lshl_b32 s35, s37, 3
s_add_u32 s48, s48, s35
v_bfe_u32 v248, v252, 4, 3
v_lshlrev_b32 v248, 6, v248
v_bfe_u32 v253, v252, 7, 1
v_lshl_or_b32 v248, v253, 10, v248
v_bfe_u32 v253, v252, 8, 2
v_lshl_or_b32 v248, v253, 4, v248
v_bfe_u32 v253, v252, 6, 1
v_lshlrev_b32 v253, 5, v253
v_xor_b32 v248, v248, v253
v_and_b32 v249, 0x1c0, v252
v_bfe_u32 v253, v252, 9, 1
v_lshl_or_b32 v249, v253, 10, v249
v_bfe_u32 v253, v252, 8, 1
v_lshl_or_b32 v249, v253, 5, v249
v_bfe_u32 v253, v252, 4, 2
v_lshl_or_b32 v249, v253, 3, v249
v_xor_b32 v250, 32, v249
s_mov_b32 s56, 90112
s_add_u32 s57, s56, 65536
s_mov_b32 s55, 1
v_bfe_i32 v188, v252, 8, 1
LT_q:
s_add_u32 s44, s40, 4096
buffer_load_dwordx4 v[0:3], v252, s[8:11], s40 offen offset:0
buffer_load_dwordx4 v[4:7], v252, s[8:11], s40 offen offset:1024
buffer_load_dwordx4 v[8:11], v252, s[8:11], s40 offen offset:2048
buffer_load_dwordx4 v[12:15], v252, s[8:11], s40 offen offset:3072
buffer_load_dwordx4 v[16:19], v252, s[8:11], s44 offen offset:0
buffer_load_dwordx4 v[20:23], v252, s[8:11], s44 offen offset:1024
buffer_load_dwordx4 v[24:27], v252, s[8:11], s44 offen offset:2048
buffer_load_dwordx4 v[28:31], v252, s[8:11], s44 offen offset:3072
s_mov_b32 s53, s56
s_mov_b32 s58, s39
s_add_u32 m0, s53, 0
s_add_u32 s54, s58, 0
buffer_load_dwordx4 v251, s[12:15], s54 offen offset:0 lds
buffer_load_dwordx4 v251, s[12:15], s54 offen offset:1024 lds
buffer_load_dwordx4 v251, s[12:15], s54 offen offset:2048 lds
buffer_load_dwordx4 v251, s[12:15], s54 offen offset:3072 lds
s_add_u32 m0, s53, 4096
s_add_u32 s54, s58, 128
buffer_load_dwordx4 v251, s[12:15], s54 offen offset:0 lds
buffer_load_dwordx4 v251, s[12:15], s54 offen offset:1024 lds
buffer_load_dwordx4 v251, s[12:15], s54 offen offset:2048 lds
buffer_load_dwordx4 v251, s[12:15], s54 offen offset:3072 lds
s_add_u32 m0, s53, 8192
s_add_u32 s54, s58, 256
buffer_load_dwordx4 v251, s[12:15], s54 offen offset:0 lds
buffer_load_dwordx4 v251, s[12:15], s54 offen offset:1024 lds
buffer_load_dwordx4 v251, s[12:15], s54 offen offset:2048 lds
buffer_load_dwordx4 v251, s[12:15], s54 offen offset:3072 lds
s_add_u32 m0, s53, 12288
s_add_u32 s54, s58, 384
buffer_load_dwordx4 v251, s[12:15], s54 offen offset:0 lds
buffer_load_dwordx4 v251, s[12:15], s54 offen offset:1024 lds
buffer_load_dwordx4 v251, s[12:15], s54 offen offset:2048 lds
buffer_load_dwordx4 v251, s[12:15], s54 offen offset:3072 lds
s_add_u32 s53, s53, 0x4000
s_cmp_eq_u32 s53, s57
s_cselect_b32 s53, s56, s53
s_add_u32 s58, s58, 0x4000
s_add_u32 m0, s53, 0
s_add_u32 s54, s58, 0
buffer_load_dwordx4 v251, s[12:15], s54 offen offset:0 lds
buffer_load_dwordx4 v251, s[12:15], s54 offen offset:1024 lds
buffer_load_dwordx4 v251, s[12:15], s54 offen offset:2048 lds
buffer_load_dwordx4 v251, s[12:15], s54 offen offset:3072 lds
s_add_u32 m0, s53, 4096
s_add_u32 s54, s58, 128
buffer_load_dwordx4 v251, s[12:15], s54 offen offset:0 lds
buffer_load_dwordx4 v251, s[12:15], s54 offen offset:1024 lds
buffer_load_dwordx4 v251, s[12:15], s54 offen offset:2048 lds
buffer_load_dwordx4 v251, s[12:15], s54 offen offset:3072 lds
s_add_u32 m0, s53, 8192
s_add_u32 s54, s58, 256
buffer_load_dwordx4 v251, s[12:15], s54 offen offset:0 lds
buffer_load_dwordx4 v251, s[12:15], s54 offen offset:1024 lds
buffer_load_dwordx4 v251, s[12:15], s54 offen offset:2048 lds
buffer_load_dwordx4 v251, s[12:15], s54 offen offset:3072 lds
s_add_u32 m0, s53, 12288
s_add_u32 s54, s58, 384
buffer_load_dwordx4 v251, s[12:15], s54 offen offset:0 lds
buffer_load_dwordx4 v251, s[12:15], s54 offen offset:1024 lds
buffer_load_dwordx4 v251, s[12:15], s54 offen offset:2048 lds
buffer_load_dwordx4 v251, s[12:15], s54 offen offset:3072 lds
s_add_u32 s53, s53, 0x4000
s_cmp_eq_u32 s53, s57
s_cselect_b32 s53, s56, s53
s_add_u32 s58, s58, 0x4000
s_add_u32 m0, s53, 0
s_add_u32 s54, s58, 0
buffer_load_dwordx4 v251, s[12:15], s54 offen offset:0 lds
buffer_load_dwordx4 v251, s[12:15], s54 offen offset:1024 lds
buffer_load_dwordx4 v251, s[12:15], s54 offen offset:2048 lds
buffer_load_dwordx4 v251, s[12:15], s54 offen offset:3072 lds
s_add_u32 m0, s53, 4096
s_add_u32 s54, s58, 128
buffer_load_dwordx4 v251, s[12:15], s54 offen offset:0 lds
buffer_load_dwordx4 v251, s[12:15], s54 offen offset:1024 lds
buffer_load_dwordx4 v251, s[12:15], s54 offen offset:2048 lds
buffer_load_dwordx4 v251, s[12:15], s54 offen offset:3072 lds
s_add_u32 m0, s53, 8192
s_add_u32 s54, s58, 256
buffer_load_dwordx4 v251, s[12:15], s54 offen offset:0 lds
buffer_load_dwordx4 v251, s[12:15], s54 offen offset:1024 lds
buffer_load_dwordx4 v251, s[12:15], s54 offen offset:2048 lds
buffer_load_dwordx4 v251, s[12:15], s54 offen offset:3072 lds
s_add_u32 m0, s53, 12288
s_add_u32 s54, s58, 384
buffer_load_dwordx4 v251, s[12:15], s54 offen offset:0 lds
buffer_load_dwordx4 v251, s[12:15], s54 offen offset:1024 lds
buffer_load_dwordx4 v251, s[12:15], s54 offen offset:2048 lds
buffer_load_dwordx4 v251, s[12:15], s54 offen offset:3072 lds
s_add_u32 s53, s53, 0x4000
s_cmp_eq_u32 s53, s57
s_cselect_b32 s53, s56, s53
s_add_u32 s58, s58, 0x4000
s_mov_b32 s51, s29
s_mov_b32 s52, s56
v_mov_b32 v172, 0xff800000
v_accvgpr_write_b32 a0, 0
v_accvgpr_write_b32 a1, 0
v_accvgpr_write_b32 a2, 0
v_accvgpr_write_b32 a3, 0
v_accvgpr_write_b32 a4, 0
v_accvgpr_write_b32 a5, 0
v_accvgpr_write_b32 a6, 0
v_accvgpr_write_b32 a7, 0
v_accvgpr_write_b32 a8, 0
v_accvgpr_write_b32 a9, 0
v_accvgpr_write_b32 a10, 0
v_accvgpr_write_b32 a11, 0
v_accvgpr_write_b32 a12, 0
v_accvgpr_write_b32 a13, 0
v_accvgpr_write_b32 a14, 0
v_accvgpr_write_b32 a15, 0
v_accvgpr_write_b32 a16, 0
v_accvgpr_write_b32 a17, 0
v_accvgpr_write_b32 a18, 0
v_accvgpr_write_b32 a19, 0
v_accvgpr_write_b32 a20, 0
v_accvgpr_write_b32 a21, 0
v_accvgpr_write_b32 a22, 0
v_accvgpr_write_b32 a23, 0
v_accvgpr_write_b32 a24, 0
v_accvgpr_write_b32 a25, 0
v_accvgpr_write_b32 a26, 0
v_accvgpr_write_b32 a27, 0
v_accvgpr_write_b32 a28, 0
v_accvgpr_write_b32 a29, 0
v_accvgpr_write_b32 a30, 0
v_accvgpr_write_b32 a31, 0
v_accvgpr_write_b32 a32, 0
v_accvgpr_write_b32 a33, 0
v_accvgpr_write_b32 a34, 0
v_accvgpr_write_b32 a35, 0
v_accvgpr_write_b32 a36, 0
v_accvgpr_write_b32 a37, 0
v_accvgpr_write_b32 a38, 0
v_accvgpr_write_b32 a39, 0
v_accvgpr_write_b32 a40, 0
v_accvgpr_write_b32 a41, 0
v_accvgpr_write_b32 a42, 0
v_accvgpr_write_b32 a43, 0
v_accvgpr_write_b32 a44, 0
v_accvgpr_write_b32 a45, 0
v_accvgpr_write_b32 a46, 0
v_accvgpr_write_b32 a47, 0
v_accvgpr_write_b32 a48, 0
v_accvgpr_write_b32 a49, 0
v_accvgpr_write_b32 a50, 0
v_accvgpr_write_b32 a51, 0
v_accvgpr_write_b32 a52, 0
v_accvgpr_write_b32 a53, 0
v_accvgpr_write_b32 a54, 0
v_accvgpr_write_b32 a55, 0
v_accvgpr_write_b32 a56, 0
v_accvgpr_write_b32 a57, 0
v_accvgpr_write_b32 a58, 0
v_accvgpr_write_b32 a59, 0
v_accvgpr_write_b32 a60, 0
v_accvgpr_write_b32 a61, 0
v_accvgpr_write_b32 a62, 0
v_accvgpr_write_b32 a63, 0
LT_loop:
s_add_u32 m0, s53, 0
s_add_u32 s54, s58, 0
buffer_load_dwordx4 v251, s[12:15], s54 offen offset:0 lds
buffer_load_dwordx4 v251, s[12:15], s54 offen offset:1024 lds
buffer_load_dwordx4 v251, s[12:15], s54 offen offset:2048 lds
buffer_load_dwordx4 v251, s[12:15], s54 offen offset:3072 lds
s_add_u32 m0, s53, 4096
s_add_u32 s54, s58, 128
buffer_load_dwordx4 v251, s[12:15], s54 offen offset:0 lds
buffer_load_dwordx4 v251, s[12:15], s54 offen offset:1024 lds
buffer_load_dwordx4 v251, s[12:15], s54 offen offset:2048 lds
buffer_load_dwordx4 v251, s[12:15], s54 offen offset:3072 lds
s_add_u32 m0, s53, 8192
s_add_u32 s54, s58, 256
buffer_load_dwordx4 v251, s[12:15], s54 offen offset:0 lds
buffer_load_dwordx4 v251, s[12:15], s54 offen offset:1024 lds
buffer_load_dwordx4 v251, s[12:15], s54 offen offset:2048 lds
buffer_load_dwordx4 v251, s[12:15], s54 offen offset:3072 lds
s_add_u32 m0, s53, 12288
s_add_u32 s54, s58, 384
buffer_load_dwordx4 v251, s[12:15], s54 offen offset:0 lds
buffer_load_dwordx4 v251, s[12:15], s54 offen offset:1024 lds
buffer_load_dwordx4 v251, s[12:15], s54 offen offset:2048 lds
buffer_load_dwordx4 v251, s[12:15], s54 offen offset:3072 lds
s_add_u32 s53, s53, 0x4000
s_cmp_eq_u32 s53, s57
s_cselect_b32 s53, s56, s53
s_add_u32 s58, s58, 0x4000
v_add_u32 v177, s52, v248
v_add_u32 v178, s52, v249
v_add_u32 v179, s52, v250
s_add_u32 s52, s52, 0x4000
s_cmp_eq_u32 s52, s57
s_cselect_b32 s52, s56, s52
s_cmp_eq_u32 s51, 1
s_cselect_b32 s54, s33, 0
v_and_b32 v192, s54, v188
v_and_b32 v193, s54, v188
v_and_b32 v194, s54, v188
v_and_b32 v195, s54, v188
s_waitcnt vmcnt(48)
ds_read_b128 v[32:35], v177 offset:0
ds_read_b128 v[64:67], v177 offset:2048
ds_read_b128 v[36:39], v177 offset:512
ds_read_b128 v[68:71], v177 offset:2560
ds_read_b128 v[40:43], v177 offset:4096
ds_read_b128 v[72:75], v177 offset:6144
ds_read_b128 v[44:47], v177 offset:4608
ds_read_b128 v[76:79], v177 offset:6656
ds_read_b128 v[48:51], v177 offset:8192
ds_read_b128 v[80:83], v177 offset:10240
ds_read_b128 v[52:55], v177 offset:8704
ds_read_b128 v[84:87], v177 offset:10752
ds_read_b128 v[56:59], v177 offset:12288
ds_read_b128 v[88:91], v177 offset:14336
ds_read_b128 v[60:63], v177 offset:12800
ds_read_b128 v[92:95], v177 offset:14848
s_waitcnt lgkmcnt(14)
v_mfma_f32_16x16x32_bf16 v[160:163], v[32:35], v[0:3], v[192:195]
v_mfma_f32_16x16x32_bf16 v[164:167], v[64:67], v[0:3], v[192:195]
s_waitcnt lgkmcnt(12)
v_mfma_f32_16x16x32_bf16 v[160:163], v[36:39], v[4:7], v[160:163]
v_mfma_f32_16x16x32_bf16 v[164:167], v[68:71], v[4:7], v[164:167]
s_waitcnt lgkmcnt(10)
v_mfma_f32_16x16x32_bf16 v[160:163], v[40:43], v[8:11], v[160:163]
v_mfma_f32_16x16x32_bf16 v[164:167], v[72:75], v[8:11], v[164:167]
s_waitcnt lgkmcnt(8)
v_mfma_f32_16x16x32_bf16 v[160:163], v[44:47], v[12:15], v[160:163]
v_mfma_f32_16x16x32_bf16 v[164:167], v[76:79], v[12:15], v[164:167]
s_waitcnt lgkmcnt(6)
v_mfma_f32_16x16x32_bf16 v[160:163], v[48:51], v[16:19], v[160:163]
v_mfma_f32_16x16x32_bf16 v[164:167], v[80:83], v[16:19], v[164:167]
s_waitcnt lgkmcnt(4)
v_mfma_f32_16x16x32_bf16 v[160:163], v[52:55], v[20:23], v[160:163]
v_mfma_f32_16x16x32_bf16 v[164:167], v[84:87], v[20:23], v[164:167]
s_waitcnt lgkmcnt(2)
v_mfma_f32_16x16x32_bf16 v[160:163], v[56:59], v[24:27], v[160:163]
v_mfma_f32_16x16x32_bf16 v[164:167], v[88:91], v[24:27], v[164:167]
s_waitcnt lgkmcnt(0)
v_mfma_f32_16x16x32_bf16 v[160:163], v[60:63], v[28:31], v[160:163]
v_mfma_f32_16x16x32_bf16 v[164:167], v[92:95], v[28:31], v[164:167]
ds_read_b64_tr_b16 v[96:97], v178 offset:0
ds_read_b64_tr_b16 v[98:99], v178 offset:2048
ds_read_b64_tr_b16 v[100:101], v179 offset:0
ds_read_b64_tr_b16 v[102:103], v179 offset:2048
ds_read_b64_tr_b16 v[104:105], v178 offset:512
ds_read_b64_tr_b16 v[106:107], v178 offset:2560
ds_read_b64_tr_b16 v[108:109], v179 offset:512
ds_read_b64_tr_b16 v[110:111], v179 offset:2560
ds_read_b64_tr_b16 v[112:113], v178 offset:4096
ds_read_b64_tr_b16 v[114:115], v178 offset:6144
ds_read_b64_tr_b16 v[116:117], v179 offset:4096
ds_read_b64_tr_b16 v[118:119], v179 offset:6144
ds_read_b64_tr_b16 v[120:121], v178 offset:4608
ds_read_b64_tr_b16 v[122:123], v178 offset:6656
ds_read_b64_tr_b16 v[124:125], v179 offset:4608
ds_read_b64_tr_b16 v[126:127], v179 offset:6656
ds_read_b64_tr_b16 v[128:129], v178 offset:8192
ds_read_b64_tr_b16 v[130:131], v178 offset:10240
ds_read_b64_tr_b16 v[132:133], v179 offset:8192
ds_read_b64_tr_b16 v[134:135], v179 offset:10240
ds_read_b64_tr_b16 v[136:137], v178 offset:8704
ds_read_b64_tr_b16 v[138:139], v178 offset:10752
ds_read_b64_tr_b16 v[140:141], v179 offset:8704
ds_read_b64_tr_b16 v[142:143], v179 offset:10752
ds_read_b64_tr_b16 v[144:145], v178 offset:12288
ds_read_b64_tr_b16 v[146:147], v178 offset:14336
ds_read_b64_tr_b16 v[148:149], v179 offset:12288
ds_read_b64_tr_b16 v[150:151], v179 offset:14336
ds_read_b64_tr_b16 v[152:153], v178 offset:12800
ds_read_b64_tr_b16 v[154:155], v178 offset:14848
ds_read_b64_tr_b16 v[156:157], v179 offset:12800
ds_read_b64_tr_b16 v[158:159], v179 offset:14848
s_nop 7
v_max3_f32 v175, v160, v161, v162
v_max3_f32 v175, v175, v163, v164
v_max3_f32 v175, v175, v165, v166
v_max3_f32 v175, v175, v167, v172
v_mov_b32 v176, v175
s_nop 1
v_permlane32_swap_b32 v175, v176
s_nop 1
v_max_f32 v175, v175, v176
v_mov_b32 v176, v175
s_nop 1
v_permlane16_swap_b32 v175, v176
s_nop 1
v_max_f32 v175, v175, v176
v_sub_f32 v174, v172, v175
v_exp_f32 v174, v174
v_mov_b32 v172, v175
v_sub_f32 v160, v160, v172
v_sub_f32 v161, v161, v172
v_sub_f32 v162, v162, v172
v_sub_f32 v163, v163, v172
v_sub_f32 v164, v164, v172
v_sub_f32 v165, v165, v172
v_sub_f32 v166, v166, v172
v_sub_f32 v167, v167, v172
v_exp_f32 v160, v160
v_exp_f32 v161, v161
v_exp_f32 v162, v162
v_exp_f32 v163, v163
v_exp_f32 v164, v164
v_exp_f32 v165, v165
v_exp_f32 v166, v166
v_exp_f32 v167, v167
v_cmp_neq_f32 vcc, 1.0, v174
v_cvt_pk_bf16_f32 v168, v160, v161
v_cvt_pk_bf16_f32 v169, v162, v163
v_cvt_pk_bf16_f32 v170, v164, v165
v_cvt_pk_bf16_f32 v171, v166, v167
s_cbranch_vccz LT_nors
v_accvgpr_read_b32 v180, a0
v_accvgpr_read_b32 v181, a1
v_accvgpr_read_b32 v182, a2
v_accvgpr_read_b32 v183, a3
v_accvgpr_read_b32 v184, a4
v_accvgpr_read_b32 v185, a5
v_accvgpr_read_b32 v186, a6
v_accvgpr_read_b32 v187, a7
v_mul_f32 v180, v180, v174
v_mul_f32 v181, v181, v174
v_mul_f32 v182, v182, v174
v_mul_f32 v183, v183, v174
v_mul_f32 v184, v184, v174
v_mul_f32 v185, v185, v174
v_mul_f32 v186, v186, v174
v_mul_f32 v187, v187, v174
v_accvgpr_write_b32 a0, v180
v_accvgpr_write_b32 a1, v181
v_accvgpr_write_b32 a2, v182
v_accvgpr_write_b32 a3, v183
v_accvgpr_write_b32 a4, v184
v_accvgpr_write_b32 a5, v185
v_accvgpr_write_b32 a6, v186
v_accvgpr_write_b32 a7, v187
v_accvgpr_read_b32 v180, a8
v_accvgpr_read_b32 v181, a9
v_accvgpr_read_b32 v182, a10
v_accvgpr_read_b32 v183, a11
v_accvgpr_read_b32 v184, a12
v_accvgpr_read_b32 v185, a13
v_accvgpr_read_b32 v186, a14
v_accvgpr_read_b32 v187, a15
v_mul_f32 v180, v180, v174
v_mul_f32 v181, v181, v174
v_mul_f32 v182, v182, v174
v_mul_f32 v183, v183, v174
v_mul_f32 v184, v184, v174
v_mul_f32 v185, v185, v174
v_mul_f32 v186, v186, v174
v_mul_f32 v187, v187, v174
v_accvgpr_write_b32 a8, v180
v_accvgpr_write_b32 a9, v181
v_accvgpr_write_b32 a10, v182
v_accvgpr_write_b32 a11, v183
v_accvgpr_write_b32 a12, v184
v_accvgpr_write_b32 a13, v185
v_accvgpr_write_b32 a14, v186
v_accvgpr_write_b32 a15, v187
v_accvgpr_read_b32 v180, a16
v_accvgpr_read_b32 v181, a17
v_accvgpr_read_b32 v182, a18
v_accvgpr_read_b32 v183, a19
v_accvgpr_read_b32 v184, a20
v_accvgpr_read_b32 v185, a21
v_accvgpr_read_b32 v186, a22
v_accvgpr_read_b32 v187, a23
v_mul_f32 v180, v180, v174
v_mul_f32 v181, v181, v174
v_mul_f32 v182, v182, v174
v_mul_f32 v183, v183, v174
v_mul_f32 v184, v184, v174
v_mul_f32 v185, v185, v174
v_mul_f32 v186, v186, v174
v_mul_f32 v187, v187, v174
v_accvgpr_write_b32 a16, v180
v_accvgpr_write_b32 a17, v181
v_accvgpr_write_b32 a18, v182
v_accvgpr_write_b32 a19, v183
v_accvgpr_write_b32 a20, v184
v_accvgpr_write_b32 a21, v185
v_accvgpr_write_b32 a22, v186
v_accvgpr_write_b32 a23, v187
v_accvgpr_read_b32 v180, a24
v_accvgpr_read_b32 v181, a25
v_accvgpr_read_b32 v182, a26
v_accvgpr_read_b32 v183, a27
v_accvgpr_read_b32 v184, a28
v_accvgpr_read_b32 v185, a29
v_accvgpr_read_b32 v186, a30
v_accvgpr_read_b32 v187, a31
v_mul_f32 v180, v180, v174
v_mul_f32 v181, v181, v174
v_mul_f32 v182, v182, v174
v_mul_f32 v183, v183, v174
v_mul_f32 v184, v184, v174
v_mul_f32 v185, v185, v174
v_mul_f32 v186, v186, v174
v_mul_f32 v187, v187, v174
v_accvgpr_write_b32 a24, v180
v_accvgpr_write_b32 a25, v181
v_accvgpr_write_b32 a26, v182
v_accvgpr_write_b32 a27, v183
v_accvgpr_write_b32 a28, v184
v_accvgpr_write_b32 a29, v185
v_accvgpr_write_b32 a30, v186
v_accvgpr_write_b32 a31, v187
v_accvgpr_read_b32 v180, a32
v_accvgpr_read_b32 v181, a33
v_accvgpr_read_b32 v182, a34
v_accvgpr_read_b32 v183, a35
v_accvgpr_read_b32 v184, a36
v_accvgpr_read_b32 v185, a37
v_accvgpr_read_b32 v186, a38
v_accvgpr_read_b32 v187, a39
v_mul_f32 v180, v180, v174
v_mul_f32 v181, v181, v174
v_mul_f32 v182, v182, v174
v_mul_f32 v183, v183, v174
v_mul_f32 v184, v184, v174
v_mul_f32 v185, v185, v174
v_mul_f32 v186, v186, v174
v_mul_f32 v187, v187, v174
v_accvgpr_write_b32 a32, v180
v_accvgpr_write_b32 a33, v181
v_accvgpr_write_b32 a34, v182
v_accvgpr_write_b32 a35, v183
v_accvgpr_write_b32 a36, v184
v_accvgpr_write_b32 a37, v185
v_accvgpr_write_b32 a38, v186
v_accvgpr_write_b32 a39, v187
v_accvgpr_read_b32 v180, a40
v_accvgpr_read_b32 v181, a41
v_accvgpr_read_b32 v182, a42
v_accvgpr_read_b32 v183, a43
v_accvgpr_read_b32 v184, a44
v_accvgpr_read_b32 v185, a45
v_accvgpr_read_b32 v186, a46
v_accvgpr_read_b32 v187, a47
v_mul_f32 v180, v180, v174
v_mul_f32 v181, v181, v174
v_mul_f32 v182, v182, v174
v_mul_f32 v183, v183, v174
v_mul_f32 v184, v184, v174
v_mul_f32 v185, v185, v174
v_mul_f32 v186, v186, v174
v_mul_f32 v187, v187, v174
v_accvgpr_write_b32 a40, v180
v_accvgpr_write_b32 a41, v181
v_accvgpr_write_b32 a42, v182
v_accvgpr_write_b32 a43, v183
v_accvgpr_write_b32 a44, v184
v_accvgpr_write_b32 a45, v185
v_accvgpr_write_b32 a46, v186
v_accvgpr_write_b32 a47, v187
v_accvgpr_read_b32 v180, a48
v_accvgpr_read_b32 v181, a49
v_accvgpr_read_b32 v182, a50
v_accvgpr_read_b32 v183, a51
v_accvgpr_read_b32 v184, a52
v_accvgpr_read_b32 v185, a53
v_accvgpr_read_b32 v186, a54
v_accvgpr_read_b32 v187, a55
v_mul_f32 v180, v180, v174
v_mul_f32 v181, v181, v174
v_mul_f32 v182, v182, v174
v_mul_f32 v183, v183, v174
v_mul_f32 v184, v184, v174
v_mul_f32 v185, v185, v174
v_mul_f32 v186, v186, v174
v_mul_f32 v187, v187, v174
v_accvgpr_write_b32 a48, v180
v_accvgpr_write_b32 a49, v181
v_accvgpr_write_b32 a50, v182
v_accvgpr_write_b32 a51, v183
v_accvgpr_write_b32 a52, v184
v_accvgpr_write_b32 a53, v185
v_accvgpr_write_b32 a54, v186
v_accvgpr_write_b32 a55, v187
v_accvgpr_read_b32 v180, a56
v_accvgpr_read_b32 v181, a57
v_accvgpr_read_b32 v182, a58
v_accvgpr_read_b32 v183, a59
v_accvgpr_read_b32 v184, a60
v_accvgpr_read_b32 v185, a61
v_accvgpr_read_b32 v186, a62
v_accvgpr_read_b32 v187, a63
v_mul_f32 v180, v180, v174
v_mul_f32 v181, v181, v174
v_mul_f32 v182, v182, v174
v_mul_f32 v183, v183, v174
v_mul_f32 v184, v184, v174
v_mul_f32 v185, v185, v174
v_mul_f32 v186, v186, v174
v_mul_f32 v187, v187, v174
v_accvgpr_write_b32 a56, v180
v_accvgpr_write_b32 a57, v181
v_accvgpr_write_b32 a58, v182
v_accvgpr_write_b32 a59, v183
v_accvgpr_write_b32 a60, v184
v_accvgpr_write_b32 a61, v185
v_accvgpr_write_b32 a62, v186
v_accvgpr_write_b32 a63, v187
LT_nors:
s_waitcnt lgkmcnt(0)
s_nop 1
v_mfma_f32_16x16x32_bf16 a[0:3], v[96:99], v[168:171], a[0:3]
v_mfma_f32_16x16x32_bf16 a[4:7], v[100:103], v[168:171], a[4:7]
v_mfma_f32_16x16x32_bf16 a[8:11], v[104:107], v[168:171], a[8:11]
v_mfma_f32_16x16x32_bf16 a[12:15], v[108:111], v[168:171], a[12:15]
v_mfma_f32_16x16x32_bf16 a[16:19], v[112:115], v[168:171], a[16:19]
v_mfma_f32_16x16x32_bf16 a[20:23], v[116:119], v[168:171], a[20:23]
v_mfma_f32_16x16x32_bf16 a[24:27], v[120:123], v[168:171], a[24:27]
v_mfma_f32_16x16x32_bf16 a[28:31], v[124:127], v[168:171], a[28:31]
v_mfma_f32_16x16x32_bf16 a[32:35], v[128:131], v[168:171], a[32:35]
v_mfma_f32_16x16x32_bf16 a[36:39], v[132:135], v[168:171], a[36:39]
v_mfma_f32_16x16x32_bf16 a[40:43], v[136:139], v[168:171], a[40:43]
v_mfma_f32_16x16x32_bf16 a[44:47], v[140:143], v[168:171], a[44:47]
v_mfma_f32_16x16x32_bf16 a[48:51], v[144:147], v[168:171], a[48:51]
v_mfma_f32_16x16x32_bf16 a[52:55], v[148:151], v[168:171], a[52:55]
v_mfma_f32_16x16x32_bf16 a[56:59], v[152:155], v[168:171], a[56:59]
v_mfma_f32_16x16x32_bf16 a[60:63], v[156:159], v[168:171], a[60:63]
s_sub_u32 s51, s51, 1
s_cmp_lg_u32 s51, 0
s_cbranch_scc1 LT_loop
s_nop 15
v_accvgpr_read_b32 v173, a0
v_accvgpr_read_b32 v180, a0
v_accvgpr_read_b32 v181, a1
v_accvgpr_read_b32 v182, a2
v_accvgpr_read_b32 v183, a3
v_accvgpr_read_b32 v184, a4
v_accvgpr_read_b32 v185, a5
v_accvgpr_read_b32 v186, a6
v_accvgpr_read_b32 v187, a7
v_cvt_pk_bf16_f32 v32, v180, v181
v_cvt_pk_bf16_f32 v33, v182, v183
v_cvt_pk_bf16_f32 v34, v184, v185
v_cvt_pk_bf16_f32 v35, v186, v187
buffer_store_dwordx4 v[32:35], v252, s[20:23], s40 offen offset:0 sc1
v_accvgpr_read_b32 v180, a8
v_accvgpr_read_b32 v181, a9
v_accvgpr_read_b32 v182, a10
v_accvgpr_read_b32 v183, a11
v_accvgpr_read_b32 v184, a12
v_accvgpr_read_b32 v185, a13
v_accvgpr_read_b32 v186, a14
v_accvgpr_read_b32 v187, a15
v_cvt_pk_bf16_f32 v36, v180, v181
v_cvt_pk_bf16_f32 v37, v182, v183
v_cvt_pk_bf16_f32 v38, v184, v185
v_cvt_pk_bf16_f32 v39, v186, v187
buffer_store_dwordx4 v[36:39], v252, s[20:23], s40 offen offset:1024 sc1
v_accvgpr_read_b32 v180, a16
v_accvgpr_read_b32 v181, a17
v_accvgpr_read_b32 v182, a18
v_accvgpr_read_b32 v183, a19
v_accvgpr_read_b32 v184, a20
v_accvgpr_read_b32 v185, a21
v_accvgpr_read_b32 v186, a22
v_accvgpr_read_b32 v187, a23
v_cvt_pk_bf16_f32 v40, v180, v181
v_cvt_pk_bf16_f32 v41, v182, v183
v_cvt_pk_bf16_f32 v42, v184, v185
v_cvt_pk_bf16_f32 v43, v186, v187
buffer_store_dwordx4 v[40:43], v252, s[20:23], s40 offen offset:2048 sc1
v_accvgpr_read_b32 v180, a24
v_accvgpr_read_b32 v181, a25
v_accvgpr_read_b32 v182, a26
v_accvgpr_read_b32 v183, a27
v_accvgpr_read_b32 v184, a28
v_accvgpr_read_b32 v185, a29
v_accvgpr_read_b32 v186, a30
v_accvgpr_read_b32 v187, a31
v_cvt_pk_bf16_f32 v44, v180, v181
v_cvt_pk_bf16_f32 v45, v182, v183
v_cvt_pk_bf16_f32 v46, v184, v185
v_cvt_pk_bf16_f32 v47, v186, v187
buffer_store_dwordx4 v[44:47], v252, s[20:23], s40 offen offset:3072 sc1
v_accvgpr_read_b32 v180, a32
v_accvgpr_read_b32 v181, a33
v_accvgpr_read_b32 v182, a34
v_accvgpr_read_b32 v183, a35
v_accvgpr_read_b32 v184, a36
v_accvgpr_read_b32 v185, a37
v_accvgpr_read_b32 v186, a38
v_accvgpr_read_b32 v187, a39
v_cvt_pk_bf16_f32 v48, v180, v181
v_cvt_pk_bf16_f32 v49, v182, v183
v_cvt_pk_bf16_f32 v50, v184, v185
v_cvt_pk_bf16_f32 v51, v186, v187
buffer_store_dwordx4 v[48:51], v252, s[20:23], s44 offen offset:0 sc1
v_accvgpr_read_b32 v180, a40
v_accvgpr_read_b32 v181, a41
v_accvgpr_read_b32 v182, a42
v_accvgpr_read_b32 v183, a43
v_accvgpr_read_b32 v184, a44
v_accvgpr_read_b32 v185, a45
v_accvgpr_read_b32 v186, a46
v_accvgpr_read_b32 v187, a47
v_cvt_pk_bf16_f32 v52, v180, v181
v_cvt_pk_bf16_f32 v53, v182, v183
v_cvt_pk_bf16_f32 v54, v184, v185
v_cvt_pk_bf16_f32 v55, v186, v187
buffer_store_dwordx4 v[52:55], v252, s[20:23], s44 offen offset:1024 sc1
v_accvgpr_read_b32 v180, a48
v_accvgpr_read_b32 v181, a49
v_accvgpr_read_b32 v182, a50
v_accvgpr_read_b32 v183, a51
v_accvgpr_read_b32 v184, a52
v_accvgpr_read_b32 v185, a53
v_accvgpr_read_b32 v186, a54
v_accvgpr_read_b32 v187, a55
v_cvt_pk_bf16_f32 v56, v180, v181
v_cvt_pk_bf16_f32 v57, v182, v183
v_cvt_pk_bf16_f32 v58, v184, v185
v_cvt_pk_bf16_f32 v59, v186, v187
buffer_store_dwordx4 v[56:59], v252, s[20:23], s44 offen offset:2048 sc1
v_accvgpr_read_b32 v180, a56
v_accvgpr_read_b32 v181, a57
v_accvgpr_read_b32 v182, a58
v_accvgpr_read_b32 v183, a59
v_accvgpr_read_b32 v184, a60
v_accvgpr_read_b32 v185, a61
v_accvgpr_read_b32 v186, a62
v_accvgpr_read_b32 v187, a63
v_cvt_pk_bf16_f32 v60, v180, v181
v_cvt_pk_bf16_f32 v61, v182, v183
v_cvt_pk_bf16_f32 v62, v184, v185
v_cvt_pk_bf16_f32 v63, v186, v187
buffer_store_dwordx4 v[60:63], v252, s[20:23], s44 offen offset:3072 sc1
v_lshlrev_b32 v175, 2, v252
s_mov_b64 exec, 0xffff
buffer_store_dwordx2 v[172:173], v175, s[24:27], s48 offen sc1
s_mov_b64 exec, -1
s_waitcnt vmcnt(0)
s_add_u32 s40, s40, 8192
s_add_u32 s48, s48, 1024
s_sub_u32 s55, s55, 1
s_cmp_lg_u32 s55, 0
s_cbranch_scc1 LT_q
s_add_u32 s52, s4, 0x7c00000
s_addc_u32 s53, s5, 0
s_mov_b32 s54, 0x2000
s_mov_b32 s55, 0x00020000
v_mov_b32 v1, 4992
v_mov_b32 v2, 1
s_mov_b64 exec, 1
s_waitcnt vmcnt(0)
buffer_atomic_add v2, v1, s[52:55], 0 offen
s_mov_b64 exec, -1
s_branch L2_fin
LE_start:
s_cmp_ge_u32 s37, 32
s_cbranch_scc1 L2_end
v_lshrrev_b32 v1, 6, v0
s_sub_u32 s37, s37, 30
s_lshl_b32 s35, s35, 1
v_readfirstlane_b32 s41, v1
s_add_u32 s35, s35, s37
s_mul_i32 s35, s35, 3
s_add_u32 s40, s35, s41
s_cmp_ge_u32 s41, 3
s_cbranch_scc1 LC_help
LE_common:
v_and_b32 v1, 63, v0
s_load_dwordx2 s[58:59], s[0:1], 24
s_mov_b32 s42, 0
s_mov_b32 s49, 512
v_lshrrev_b32 v33, 1, v1
v_and_b32 v34, 1, v1
v_mul_u32_u24 v6, 0x5000, v33
v_lshl_add_u32 v6, v34, 4, v6
v_lshlrev_b32 v33, 2, v33
s_mul_i32 s50, s40, 655360
s_mul_i32 s48, s40, 128
s_waitcnt lgkmcnt(0)
s_add_u32 s8, s4, 0x7800000
s_addc_u32 s9, s5, 0
s_mov_b32 s10, 0x2000
s_mov_b32 s11, 0x00020000
s_add_u32 s12, s4, 0x8000000
s_addc_u32 s13, s5, 0
s_mov_b32 s14, 0x2800000
s_mov_b32 s15, 0x00020000
buffer_load_dword v4, v33, s[8:11], s48 offen
buffer_load_dwordx4 v[192:195], v6, s[12:15], s50 offen offset:0
buffer_load_dwordx4 v[196:199], v6, s[12:15], s50 offen offset:32
buffer_load_dwordx4 v[200:203], v6, s[12:15], s50 offen offset:64
buffer_load_dwordx4 v[204:207], v6, s[12:15], s50 offen offset:96
buffer_load_dwordx4 v[208:211], v6, s[12:15], s50 offen offset:128
buffer_load_dwordx4 v[212:215], v6, s[12:15], s50 offen offset:160
buffer_load_dwordx4 v[216:219], v6, s[12:15], s50 offen offset:192
buffer_load_dwordx4 v[220:223], v6, s[12:15], s50 offen offset:224
buffer_load_dwordx4 v[224:227], v6, s[12:15], s50 offen offset:256
buffer_load_dwordx4 v[228:231], v6, s[12:15], s50 offen offset:288
buffer_load_dwordx4 v[232:235], v6, s[12:15], s50 offen offset:320
buffer_load_dwordx4 v[236:239], v6, s[12:15], s50 offen offset:352
buffer_load_dwordx4 v[240:243], v6, s[12:15], s50 offen offset:384
buffer_load_dwordx4 v[244:247], v6, s[12:15], s50 offen offset:416
buffer_load_dwordx4 v[248:251], v6, s[12:15], s50 offen offset:448
buffer_load_dwordx4 v[252:255], v6, s[12:15], s50 offen offset:480
s_add_u32 s16, s58, 0x0
s_addc_u32 s17, s59, 0
s_mov_b32 s18, 0x4e20
s_mov_b32 s19, 0x00020000
v_lshlrev_b32 v35, 1, v1
s_mul_i32 s48, s40, 334
buffer_load_ushort v76, v35, s[16:19], s48 offen offset:0
buffer_load_ushort v77, v35, s[16:19], s48 offen offset:128
buffer_load_ushort v78, v35, s[16:19], s48 offen offset:256
s_add_u32 s16, s4, 0x6800000
s_addc_u32 s17, s5, 0
s_mov_b32 s18, 0x4e2000
s_mov_b32 s19, 0x00020000
s_add_u32 s20, s4, 0x7000000
s_addc_u32 s21, s5, 0
s_mov_b32 s22, 0x4e2000
s_mov_b32 s23, 0x00020000
v_lshlrev_b32 v5, 2, v34
v_and_b32 v2, 15, v1
v_lshrrev_b32 v3, 4, v1
v_mov_b32 v16, 1
v_mov_b32 v17, 4
v_and_b32 v33, 1, v2
v_lshlrev_b32 v33, 4, v33
v_lshlrev_b32 v33, v33, v16
v_mul_u32_u24 v33, 0x3f80, v33
v_lshrrev_b32 v34, 1, v2
v_cmp_eq_u32 vcc, 0, v34
s_nop 1
v_cndmask_b32 v40, 0, v33, vcc
v_cmp_eq_u32 vcc, 1, v34
s_nop 1
v_cndmask_b32 v41, 0, v33, vcc
v_cmp_eq_u32 vcc, 2, v34
s_nop 1
v_cndmask_b32 v42, 0, v33, vcc
v_cmp_eq_u32 vcc, 3, v34
s_nop 1
v_cndmask_b32 v43, 0, v33, vcc
v_cmp_eq_u32 vcc, 4, v34
s_nop 1
v_cndmask_b32 v44, 0, v33, vcc
v_cmp_eq_u32 vcc, 5, v34
s_nop 1
v_cndmask_b32 v45, 0, v33, vcc
v_cmp_eq_u32 vcc, 6, v34
s_nop 1
v_cndmask_b32 v46, 0, v33, vcc
v_cmp_eq_u32 vcc, 7, v34
s_nop 1
v_cndmask_b32 v47, 0, v33, vcc
v_lshlrev_b32 v39, 5, v2
v_lshl_add_u32 v39, v3, 3, v39
v_lshlrev_b32 v2, 4, v2
s_mul_i32 s48, s41, 21504
s_add_u32 s48, s48, 4096
v_mov_b32 v36, s48
v_lshl_add_u32 v38, v3, 2, v36
s_lshl_b32 s36, s41, 10
v_mov_b32 v7, s36
v_lshlrev_b32 v35, 4, v1
v_add_u32 v68, s48, v35
v_add_u32 v35, s36, v35
v_lshlrev_b32 v33, 2, v1
v_mov_b32 v72, 0xffff
v_mov_b32 v73, 0xffff
v_mov_b32 v74, 0xffff
v_mov_b32 v75, 0xffff
v_cmp_gt_u32 vcc, 167, v33
v_mov_b32 v48, 0
s_nop 0
v_cndmask_b32 v18, 0, v16, vcc
v_cmp_gt_u32 vcc, 166, v33
v_mov_b32 v49, 0
s_nop 0
v_cndmask_b32 v19, 0, v16, vcc
v_cmp_gt_u32 vcc, 165, v33
v_mov_b32 v50, 0
s_nop 0
v_cndmask_b32 v20, 0, v16, vcc
v_cmp_gt_u32 vcc, 164, v33
v_mov_b32 v51, 0
s_nop 0
v_cndmask_b32 v21, 0, v16, vcc
LE_pass:
ds_write_b128 v35, v[48:51]
ds_write_b128 v68, v[72:75] offset:0
ds_write_b128 v68, v[72:75] offset:1024
ds_write_b128 v68, v[72:75] offset:2048
ds_write_b128 v68, v[72:75] offset:3072
ds_write_b128 v68, v[72:75] offset:4096
ds_write_b128 v68, v[72:75] offset:5120
ds_write_b128 v68, v[72:75] offset:6144
ds_write_b128 v68, v[72:75] offset:7168
ds_write_b128 v68, v[72:75] offset:8192
ds_write_b128 v68, v[72:75] offset:9216
ds_write_b128 v68, v[72:75] offset:10240
ds_write_b128 v68, v[72:75] offset:11264
ds_write_b128 v68, v[72:75] offset:12288
ds_write_b128 v68, v[72:75] offset:13312
ds_write_b128 v68, v[72:75] offset:14336
ds_write_b128 v68, v[72:75] offset:15360
ds_write_b128 v68, v[72:75] offset:16384
ds_write_b128 v68, v[72:75] offset:17408
ds_write_b128 v68, v[72:75] offset:18432
ds_write_b128 v68, v[72:75] offset:19456
v_lshl_add_u32 v32, v1, 2, v36
ds_write_b32 v32, v48 offset:20480
s_waitcnt vmcnt(19)
v_sub_u32 v32, v4, v5
s_waitcnt vmcnt(15)
v_cmpx_lt_i32 vcc, 0, v32
s_cbranch_execz LE_c
v_mad_u32_u16 v128, v192, 1, v7 op_sel:[1,0,0,0]
ds_add_u32 v128, v16
v_cmpx_lt_i32 vcc, 1, v32
v_mad_u32_u16 v129, v193, 1, v7 op_sel:[1,0,0,0]
ds_add_u32 v129, v16
v_cmpx_lt_i32 vcc, 2, v32
v_mad_u32_u16 v130, v194, 1, v7 op_sel:[1,0,0,0]
ds_add_u32 v130, v16
v_cmpx_lt_i32 vcc, 3, v32
v_mad_u32_u16 v131, v195, 1, v7 op_sel:[1,0,0,0]
ds_add_u32 v131, v16
s_waitcnt vmcnt(14)
v_cmpx_lt_i32 vcc, 8, v32
s_cbranch_execz LE_c
v_mad_u32_u16 v132, v196, 1, v7 op_sel:[1,0,0,0]
ds_add_u32 v132, v16
v_cmpx_lt_i32 vcc, 9, v32
v_mad_u32_u16 v133, v197, 1, v7 op_sel:[1,0,0,0]
ds_add_u32 v133, v16
v_cmpx_lt_i32 vcc, 10, v32
v_mad_u32_u16 v134, v198, 1, v7 op_sel:[1,0,0,0]
ds_add_u32 v134, v16
v_cmpx_lt_i32 vcc, 11, v32
v_mad_u32_u16 v135, v199, 1, v7 op_sel:[1,0,0,0]
ds_add_u32 v135, v16
s_waitcnt vmcnt(13)
v_cmpx_lt_i32 vcc, 16, v32
s_cbranch_execz LE_c
v_mad_u32_u16 v136, v200, 1, v7 op_sel:[1,0,0,0]
ds_add_u32 v136, v16
v_cmpx_lt_i32 vcc, 17, v32
v_mad_u32_u16 v137, v201, 1, v7 op_sel:[1,0,0,0]
ds_add_u32 v137, v16
v_cmpx_lt_i32 vcc, 18, v32
v_mad_u32_u16 v138, v202, 1, v7 op_sel:[1,0,0,0]
ds_add_u32 v138, v16
v_cmpx_lt_i32 vcc, 19, v32
v_mad_u32_u16 v139, v203, 1, v7 op_sel:[1,0,0,0]
ds_add_u32 v139, v16
s_waitcnt vmcnt(12)
v_cmpx_lt_i32 vcc, 24, v32
s_cbranch_execz LE_c
v_mad_u32_u16 v140, v204, 1, v7 op_sel:[1,0,0,0]
ds_add_u32 v140, v16
v_cmpx_lt_i32 vcc, 25, v32
v_mad_u32_u16 v141, v205, 1, v7 op_sel:[1,0,0,0]
ds_add_u32 v141, v16
v_cmpx_lt_i32 vcc, 26, v32
v_mad_u32_u16 v142, v206, 1, v7 op_sel:[1,0,0,0]
ds_add_u32 v142, v16
v_cmpx_lt_i32 vcc, 27, v32
v_mad_u32_u16 v143, v207, 1, v7 op_sel:[1,0,0,0]
ds_add_u32 v143, v16
s_waitcnt vmcnt(11)
v_cmpx_lt_i32 vcc, 32, v32
s_cbranch_execz LE_c
v_mad_u32_u16 v144, v208, 1, v7 op_sel:[1,0,0,0]
ds_add_u32 v144, v16
v_cmpx_lt_i32 vcc, 33, v32
v_mad_u32_u16 v145, v209, 1, v7 op_sel:[1,0,0,0]
ds_add_u32 v145, v16
v_cmpx_lt_i32 vcc, 34, v32
v_mad_u32_u16 v146, v210, 1, v7 op_sel:[1,0,0,0]
ds_add_u32 v146, v16
v_cmpx_lt_i32 vcc, 35, v32
v_mad_u32_u16 v147, v211, 1, v7 op_sel:[1,0,0,0]
ds_add_u32 v147, v16
s_waitcnt vmcnt(10)
v_cmpx_lt_i32 vcc, 40, v32
s_cbranch_execz LE_c
v_mad_u32_u16 v148, v212, 1, v7 op_sel:[1,0,0,0]
ds_add_u32 v148, v16
v_cmpx_lt_i32 vcc, 41, v32
v_mad_u32_u16 v149, v213, 1, v7 op_sel:[1,0,0,0]
ds_add_u32 v149, v16
v_cmpx_lt_i32 vcc, 42, v32
v_mad_u32_u16 v150, v214, 1, v7 op_sel:[1,0,0,0]
ds_add_u32 v150, v16
v_cmpx_lt_i32 vcc, 43, v32
v_mad_u32_u16 v151, v215, 1, v7 op_sel:[1,0,0,0]
ds_add_u32 v151, v16
s_waitcnt vmcnt(9)
v_cmpx_lt_i32 vcc, 48, v32
s_cbranch_execz LE_c
v_mad_u32_u16 v152, v216, 1, v7 op_sel:[1,0,0,0]
ds_add_u32 v152, v16
v_cmpx_lt_i32 vcc, 49, v32
v_mad_u32_u16 v153, v217, 1, v7 op_sel:[1,0,0,0]
ds_add_u32 v153, v16
v_cmpx_lt_i32 vcc, 50, v32
v_mad_u32_u16 v154, v218, 1, v7 op_sel:[1,0,0,0]
ds_add_u32 v154, v16
v_cmpx_lt_i32 vcc, 51, v32
v_mad_u32_u16 v155, v219, 1, v7 op_sel:[1,0,0,0]
ds_add_u32 v155, v16
s_waitcnt vmcnt(8)
v_cmpx_lt_i32 vcc, 56, v32
s_cbranch_execz LE_c
v_mad_u32_u16 v156, v220, 1, v7 op_sel:[1,0,0,0]
ds_add_u32 v156, v16
v_cmpx_lt_i32 vcc, 57, v32
v_mad_u32_u16 v157, v221, 1, v7 op_sel:[1,0,0,0]
ds_add_u32 v157, v16
v_cmpx_lt_i32 vcc, 58, v32
v_mad_u32_u16 v158, v222, 1, v7 op_sel:[1,0,0,0]
ds_add_u32 v158, v16
v_cmpx_lt_i32 vcc, 59, v32
v_mad_u32_u16 v159, v223, 1, v7 op_sel:[1,0,0,0]
ds_add_u32 v159, v16
s_waitcnt vmcnt(7)
v_cmpx_lt_i32 vcc, 64, v32
s_cbranch_execz LE_c
v_mad_u32_u16 v160, v224, 1, v7 op_sel:[1,0,0,0]
ds_add_u32 v160, v16
v_cmpx_lt_i32 vcc, 65, v32
v_mad_u32_u16 v161, v225, 1, v7 op_sel:[1,0,0,0]
ds_add_u32 v161, v16
v_cmpx_lt_i32 vcc, 66, v32
v_mad_u32_u16 v162, v226, 1, v7 op_sel:[1,0,0,0]
ds_add_u32 v162, v16
v_cmpx_lt_i32 vcc, 67, v32
v_mad_u32_u16 v163, v227, 1, v7 op_sel:[1,0,0,0]
ds_add_u32 v163, v16
s_waitcnt vmcnt(6)
v_cmpx_lt_i32 vcc, 72, v32
s_cbranch_execz LE_c
v_mad_u32_u16 v164, v228, 1, v7 op_sel:[1,0,0,0]
ds_add_u32 v164, v16
v_cmpx_lt_i32 vcc, 73, v32
v_mad_u32_u16 v165, v229, 1, v7 op_sel:[1,0,0,0]
ds_add_u32 v165, v16
v_cmpx_lt_i32 vcc, 74, v32
v_mad_u32_u16 v166, v230, 1, v7 op_sel:[1,0,0,0]
ds_add_u32 v166, v16
v_cmpx_lt_i32 vcc, 75, v32
v_mad_u32_u16 v167, v231, 1, v7 op_sel:[1,0,0,0]
ds_add_u32 v167, v16
s_waitcnt vmcnt(5)
v_cmpx_lt_i32 vcc, 80, v32
s_cbranch_execz LE_c
v_mad_u32_u16 v168, v232, 1, v7 op_sel:[1,0,0,0]
ds_add_u32 v168, v16
v_cmpx_lt_i32 vcc, 81, v32
v_mad_u32_u16 v169, v233, 1, v7 op_sel:[1,0,0,0]
ds_add_u32 v169, v16
v_cmpx_lt_i32 vcc, 82, v32
v_mad_u32_u16 v170, v234, 1, v7 op_sel:[1,0,0,0]
ds_add_u32 v170, v16
v_cmpx_lt_i32 vcc, 83, v32
v_mad_u32_u16 v171, v235, 1, v7 op_sel:[1,0,0,0]
ds_add_u32 v171, v16
s_waitcnt vmcnt(4)
v_cmpx_lt_i32 vcc, 88, v32
s_cbranch_execz LE_c
v_mad_u32_u16 v172, v236, 1, v7 op_sel:[1,0,0,0]
ds_add_u32 v172, v16
v_cmpx_lt_i32 vcc, 89, v32
v_mad_u32_u16 v173, v237, 1, v7 op_sel:[1,0,0,0]
ds_add_u32 v173, v16
v_cmpx_lt_i32 vcc, 90, v32
v_mad_u32_u16 v174, v238, 1, v7 op_sel:[1,0,0,0]
ds_add_u32 v174, v16
v_cmpx_lt_i32 vcc, 91, v32
v_mad_u32_u16 v175, v239, 1, v7 op_sel:[1,0,0,0]
ds_add_u32 v175, v16
s_waitcnt vmcnt(3)
v_cmpx_lt_i32 vcc, 96, v32
s_cbranch_execz LE_c
v_mad_u32_u16 v176, v240, 1, v7 op_sel:[1,0,0,0]
ds_add_u32 v176, v16
v_cmpx_lt_i32 vcc, 97, v32
v_mad_u32_u16 v177, v241, 1, v7 op_sel:[1,0,0,0]
ds_add_u32 v177, v16
v_cmpx_lt_i32 vcc, 98, v32
v_mad_u32_u16 v178, v242, 1, v7 op_sel:[1,0,0,0]
ds_add_u32 v178, v16
v_cmpx_lt_i32 vcc, 99, v32
v_mad_u32_u16 v179, v243, 1, v7 op_sel:[1,0,0,0]
ds_add_u32 v179, v16
s_waitcnt vmcnt(2)
v_cmpx_lt_i32 vcc, 104, v32
s_cbranch_execz LE_c
v_mad_u32_u16 v180, v244, 1, v7 op_sel:[1,0,0,0]
ds_add_u32 v180, v16
v_cmpx_lt_i32 vcc, 105, v32
v_mad_u32_u16 v181, v245, 1, v7 op_sel:[1,0,0,0]
ds_add_u32 v181, v16
v_cmpx_lt_i32 vcc, 106, v32
v_mad_u32_u16 v182, v246, 1, v7 op_sel:[1,0,0,0]
ds_add_u32 v182, v16
v_cmpx_lt_i32 vcc, 107, v32
v_mad_u32_u16 v183, v247, 1, v7 op_sel:[1,0,0,0]
ds_add_u32 v183, v16
s_waitcnt vmcnt(1)
v_cmpx_lt_i32 vcc, 112, v32
s_cbranch_execz LE_c
v_mad_u32_u16 v184, v248, 1, v7 op_sel:[1,0,0,0]
ds_add_u32 v184, v16
v_cmpx_lt_i32 vcc, 113, v32
v_mad_u32_u16 v185, v249, 1, v7 op_sel:[1,0,0,0]
ds_add_u32 v185, v16
v_cmpx_lt_i32 vcc, 114, v32
v_mad_u32_u16 v186, v250, 1, v7 op_sel:[1,0,0,0]
ds_add_u32 v186, v16
v_cmpx_lt_i32 vcc, 115, v32
v_mad_u32_u16 v187, v251, 1, v7 op_sel:[1,0,0,0]
ds_add_u32 v187, v16
s_waitcnt vmcnt(0)
v_cmpx_lt_i32 vcc, 120, v32
s_cbranch_execz LE_c
v_mad_u32_u16 v188, v252, 1, v7 op_sel:[1,0,0,0]
ds_add_u32 v188, v16
v_cmpx_lt_i32 vcc, 121, v32
v_mad_u32_u16 v189, v253, 1, v7 op_sel:[1,0,0,0]
ds_add_u32 v189, v16
v_cmpx_lt_i32 vcc, 122, v32
v_mad_u32_u16 v190, v254, 1, v7 op_sel:[1,0,0,0]
ds_add_u32 v190, v16
v_cmpx_lt_i32 vcc, 123, v32
v_mad_u32_u16 v191, v255, 1, v7 op_sel:[1,0,0,0]
ds_add_u32 v191, v16
LE_c:
s_mov_b64 exec, -1
ds_read_b128 v[24:27], v35
s_waitcnt lgkmcnt(0)
v_add_u32 v24, 3, v24
v_lshrrev_b32 v24, 2, v24
v_max_u32 v24, v24, v18
v_add_u32 v25, 3, v25
v_lshrrev_b32 v25, 2, v25
v_max_u32 v25, v25, v19
v_add_u32 v26, 3, v26
v_lshrrev_b32 v26, 2, v26
v_max_u32 v26, v26, v20
v_add_u32 v27, 3, v27
v_lshrrev_b32 v27, 2, v27
v_max_u32 v27, v27, v21
v_add_u32 v33, v24, v25
v_add3_u32 v33, v33, v26, v27
v_mov_b32 v64, v33
s_nop 1
v_add_u32_dpp v64, v64, v64 row_shr:1 row_mask:0xf bank_mask:0xf
s_nop 1
v_add_u32_dpp v64, v64, v64 row_shr:2 row_mask:0xf bank_mask:0xf
s_nop 1
v_add_u32_dpp v64, v64, v64 row_shr:4 row_mask:0xf bank_mask:0xf
s_nop 1
v_add_u32_dpp v64, v64, v64 row_shr:8 row_mask:0xf bank_mask:0xf
s_nop 1
v_add_u32_dpp v64, v64, v64 row_bcast:15 row_mask:0xa bank_mask:0xf
s_nop 1
v_add_u32_dpp v64, v64, v64 row_bcast:31 row_mask:0xc bank_mask:0xf
s_nop 1
v_readlane_b32 s44, v64, 63
v_sub_u32 v28, v64, v33
v_add_u32 v29, v28, v24
v_add_u32 v30, v29, v25
v_add_u32 v31, v30, v26
v_add3_u32 v33, v28, v24, -1
v_lshlrev_b32 v34, v33, v18
v_lshrrev_b32 v33, 5, v33
v_lshl_add_u32 v33, v33, 2, v36
ds_or_b32 v33, v34 offset:20480
v_lshl_add_u32 v28, v28, 4, v36
v_add3_u32 v33, v29, v25, -1
v_lshlrev_b32 v34, v33, v19
v_lshrrev_b32 v33, 5, v33
v_lshl_add_u32 v33, v33, 2, v36
ds_or_b32 v33, v34 offset:20480
v_lshl_add_u32 v29, v29, 4, v36
v_add3_u32 v33, v30, v26, -1
v_lshlrev_b32 v34, v33, v20
v_lshrrev_b32 v33, 5, v33
v_lshl_add_u32 v33, v33, 2, v36
ds_or_b32 v33, v34 offset:20480
v_lshl_add_u32 v30, v30, 4, v36
v_add3_u32 v33, v31, v27, -1
v_lshlrev_b32 v34, v33, v21
v_lshrrev_b32 v33, 5, v33
v_lshl_add_u32 v33, v33, 2, v36
ds_or_b32 v33, v34 offset:20480
v_lshl_add_u32 v31, v31, 4, v36
ds_write_b128 v35, v[28:31]
s_add_u32 s44, s44, 31
s_lshr_b32 s44, s44, 5
v_cmpx_lt_i32 vcc, 0, v32
s_cbranch_execz LE_p
ds_add_rtn_u32 v128, v128, v17
v_cmpx_lt_i32 vcc, 1, v32
ds_add_rtn_u32 v129, v129, v17
v_cmpx_lt_i32 vcc, 2, v32
ds_add_rtn_u32 v130, v130, v17
v_cmpx_lt_i32 vcc, 3, v32
ds_add_rtn_u32 v131, v131, v17
v_cmpx_lt_i32 vcc, 8, v32
s_cbranch_execz LE_p
ds_add_rtn_u32 v132, v132, v17
v_cmpx_lt_i32 vcc, 9, v32
ds_add_rtn_u32 v133, v133, v17
v_cmpx_lt_i32 vcc, 10, v32
ds_add_rtn_u32 v134, v134, v17
v_cmpx_lt_i32 vcc, 11, v32
ds_add_rtn_u32 v135, v135, v17
v_cmpx_lt_i32 vcc, 16, v32
s_cbranch_execz LE_p
ds_add_rtn_u32 v136, v136, v17
v_cmpx_lt_i32 vcc, 17, v32
ds_add_rtn_u32 v137, v137, v17
v_cmpx_lt_i32 vcc, 18, v32
ds_add_rtn_u32 v138, v138, v17
v_cmpx_lt_i32 vcc, 19, v32
ds_add_rtn_u32 v139, v139, v17
v_cmpx_lt_i32 vcc, 24, v32
s_cbranch_execz LE_p
ds_add_rtn_u32 v140, v140, v17
v_cmpx_lt_i32 vcc, 25, v32
ds_add_rtn_u32 v141, v141, v17
v_cmpx_lt_i32 vcc, 26, v32
ds_add_rtn_u32 v142, v142, v17
v_cmpx_lt_i32 vcc, 27, v32
ds_add_rtn_u32 v143, v143, v17
v_cmpx_lt_i32 vcc, 32, v32
s_cbranch_execz LE_p
ds_add_rtn_u32 v144, v144, v17
v_cmpx_lt_i32 vcc, 33, v32
ds_add_rtn_u32 v145, v145, v17
v_cmpx_lt_i32 vcc, 34, v32
ds_add_rtn_u32 v146, v146, v17
v_cmpx_lt_i32 vcc, 35, v32
ds_add_rtn_u32 v147, v147, v17
v_cmpx_lt_i32 vcc, 40, v32
s_cbranch_execz LE_p
ds_add_rtn_u32 v148, v148, v17
v_cmpx_lt_i32 vcc, 41, v32
ds_add_rtn_u32 v149, v149, v17
v_cmpx_lt_i32 vcc, 42, v32
ds_add_rtn_u32 v150, v150, v17
v_cmpx_lt_i32 vcc, 43, v32
ds_add_rtn_u32 v151, v151, v17
v_cmpx_lt_i32 vcc, 48, v32
s_cbranch_execz LE_p
ds_add_rtn_u32 v152, v152, v17
v_cmpx_lt_i32 vcc, 49, v32
ds_add_rtn_u32 v153, v153, v17
v_cmpx_lt_i32 vcc, 50, v32
ds_add_rtn_u32 v154, v154, v17
v_cmpx_lt_i32 vcc, 51, v32
ds_add_rtn_u32 v155, v155, v17
v_cmpx_lt_i32 vcc, 56, v32
s_cbranch_execz LE_p
ds_add_rtn_u32 v156, v156, v17
v_cmpx_lt_i32 vcc, 57, v32
ds_add_rtn_u32 v157, v157, v17
v_cmpx_lt_i32 vcc, 58, v32
ds_add_rtn_u32 v158, v158, v17
v_cmpx_lt_i32 vcc, 59, v32
ds_add_rtn_u32 v159, v159, v17
v_cmpx_lt_i32 vcc, 64, v32
s_cbranch_execz LE_p
ds_add_rtn_u32 v160, v160, v17
v_cmpx_lt_i32 vcc, 65, v32
ds_add_rtn_u32 v161, v161, v17
v_cmpx_lt_i32 vcc, 66, v32
ds_add_rtn_u32 v162, v162, v17
v_cmpx_lt_i32 vcc, 67, v32
ds_add_rtn_u32 v163, v163, v17
v_cmpx_lt_i32 vcc, 72, v32
s_cbranch_execz LE_p
ds_add_rtn_u32 v164, v164, v17
v_cmpx_lt_i32 vcc, 73, v32
ds_add_rtn_u32 v165, v165, v17
v_cmpx_lt_i32 vcc, 74, v32
ds_add_rtn_u32 v166, v166, v17
v_cmpx_lt_i32 vcc, 75, v32
ds_add_rtn_u32 v167, v167, v17
v_cmpx_lt_i32 vcc, 80, v32
s_cbranch_execz LE_p
ds_add_rtn_u32 v168, v168, v17
v_cmpx_lt_i32 vcc, 81, v32
ds_add_rtn_u32 v169, v169, v17
v_cmpx_lt_i32 vcc, 82, v32
ds_add_rtn_u32 v170, v170, v17
v_cmpx_lt_i32 vcc, 83, v32
ds_add_rtn_u32 v171, v171, v17
v_cmpx_lt_i32 vcc, 88, v32
s_cbranch_execz LE_p
ds_add_rtn_u32 v172, v172, v17
v_cmpx_lt_i32 vcc, 89, v32
ds_add_rtn_u32 v173, v173, v17
v_cmpx_lt_i32 vcc, 90, v32
ds_add_rtn_u32 v174, v174, v17
v_cmpx_lt_i32 vcc, 91, v32
ds_add_rtn_u32 v175, v175, v17
v_cmpx_lt_i32 vcc, 96, v32
s_cbranch_execz LE_p
ds_add_rtn_u32 v176, v176, v17
v_cmpx_lt_i32 vcc, 97, v32
ds_add_rtn_u32 v177, v177, v17
v_cmpx_lt_i32 vcc, 98, v32
ds_add_rtn_u32 v178, v178, v17
v_cmpx_lt_i32 vcc, 99, v32
ds_add_rtn_u32 v179, v179, v17
v_cmpx_lt_i32 vcc, 104, v32
s_cbranch_execz LE_p
ds_add_rtn_u32 v180, v180, v17
v_cmpx_lt_i32 vcc, 105, v32
ds_add_rtn_u32 v181, v181, v17
v_cmpx_lt_i32 vcc, 106, v32
ds_add_rtn_u32 v182, v182, v17
v_cmpx_lt_i32 vcc, 107, v32
ds_add_rtn_u32 v183, v183, v17
v_cmpx_lt_i32 vcc, 112, v32
s_cbranch_execz LE_p
ds_add_rtn_u32 v184, v184, v17
v_cmpx_lt_i32 vcc, 113, v32
ds_add_rtn_u32 v185, v185, v17
v_cmpx_lt_i32 vcc, 114, v32
ds_add_rtn_u32 v186, v186, v17
v_cmpx_lt_i32 vcc, 115, v32
ds_add_rtn_u32 v187, v187, v17
v_cmpx_lt_i32 vcc, 120, v32
s_cbranch_execz LE_p
ds_add_rtn_u32 v188, v188, v17
v_cmpx_lt_i32 vcc, 121, v32
ds_add_rtn_u32 v189, v189, v17
v_cmpx_lt_i32 vcc, 122, v32
ds_add_rtn_u32 v190, v190, v17
v_cmpx_lt_i32 vcc, 123, v32
ds_add_rtn_u32 v191, v191, v17
LE_p:
s_mov_b64 exec, -1
v_lshl_add_u32 v33, v1, 2, v36
ds_read_b32 v37, v33 offset:20480
s_waitcnt lgkmcnt(0)
v_cmpx_lt_i32 vcc, 0, v32
s_cbranch_execz LE_w
ds_write_b32 v128, v192
v_cmpx_lt_i32 vcc, 1, v32
ds_write_b32 v129, v193
v_cmpx_lt_i32 vcc, 2, v32
ds_write_b32 v130, v194
v_cmpx_lt_i32 vcc, 3, v32
ds_write_b32 v131, v195
v_cmpx_lt_i32 vcc, 8, v32
s_cbranch_execz LE_w
ds_write_b32 v132, v196
v_cmpx_lt_i32 vcc, 9, v32
ds_write_b32 v133, v197
v_cmpx_lt_i32 vcc, 10, v32
ds_write_b32 v134, v198
v_cmpx_lt_i32 vcc, 11, v32
ds_write_b32 v135, v199
v_cmpx_lt_i32 vcc, 16, v32
s_cbranch_execz LE_w
ds_write_b32 v136, v200
v_cmpx_lt_i32 vcc, 17, v32
ds_write_b32 v137, v201
v_cmpx_lt_i32 vcc, 18, v32
ds_write_b32 v138, v202
v_cmpx_lt_i32 vcc, 19, v32
ds_write_b32 v139, v203
v_cmpx_lt_i32 vcc, 24, v32
s_cbranch_execz LE_w
ds_write_b32 v140, v204
v_cmpx_lt_i32 vcc, 25, v32
ds_write_b32 v141, v205
v_cmpx_lt_i32 vcc, 26, v32
ds_write_b32 v142, v206
v_cmpx_lt_i32 vcc, 27, v32
ds_write_b32 v143, v207
v_cmpx_lt_i32 vcc, 32, v32
s_cbranch_execz LE_w
ds_write_b32 v144, v208
v_cmpx_lt_i32 vcc, 33, v32
ds_write_b32 v145, v209
v_cmpx_lt_i32 vcc, 34, v32
ds_write_b32 v146, v210
v_cmpx_lt_i32 vcc, 35, v32
ds_write_b32 v147, v211
v_cmpx_lt_i32 vcc, 40, v32
s_cbranch_execz LE_w
ds_write_b32 v148, v212
v_cmpx_lt_i32 vcc, 41, v32
ds_write_b32 v149, v213
v_cmpx_lt_i32 vcc, 42, v32
ds_write_b32 v150, v214
v_cmpx_lt_i32 vcc, 43, v32
ds_write_b32 v151, v215
v_cmpx_lt_i32 vcc, 48, v32
s_cbranch_execz LE_w
ds_write_b32 v152, v216
v_cmpx_lt_i32 vcc, 49, v32
ds_write_b32 v153, v217
v_cmpx_lt_i32 vcc, 50, v32
ds_write_b32 v154, v218
v_cmpx_lt_i32 vcc, 51, v32
ds_write_b32 v155, v219
v_cmpx_lt_i32 vcc, 56, v32
s_cbranch_execz LE_w
ds_write_b32 v156, v220
v_cmpx_lt_i32 vcc, 57, v32
ds_write_b32 v157, v221
v_cmpx_lt_i32 vcc, 58, v32
ds_write_b32 v158, v222
v_cmpx_lt_i32 vcc, 59, v32
ds_write_b32 v159, v223
v_cmpx_lt_i32 vcc, 64, v32
s_cbranch_execz LE_w
ds_write_b32 v160, v224
v_cmpx_lt_i32 vcc, 65, v32
ds_write_b32 v161, v225
v_cmpx_lt_i32 vcc, 66, v32
ds_write_b32 v162, v226
v_cmpx_lt_i32 vcc, 67, v32
ds_write_b32 v163, v227
v_cmpx_lt_i32 vcc, 72, v32
s_cbranch_execz LE_w
ds_write_b32 v164, v228
v_cmpx_lt_i32 vcc, 73, v32
ds_write_b32 v165, v229
v_cmpx_lt_i32 vcc, 74, v32
ds_write_b32 v166, v230
v_cmpx_lt_i32 vcc, 75, v32
ds_write_b32 v167, v231
v_cmpx_lt_i32 vcc, 80, v32
s_cbranch_execz LE_w
ds_write_b32 v168, v232
v_cmpx_lt_i32 vcc, 81, v32
ds_write_b32 v169, v233
v_cmpx_lt_i32 vcc, 82, v32
ds_write_b32 v170, v234
v_cmpx_lt_i32 vcc, 83, v32
ds_write_b32 v171, v235
v_cmpx_lt_i32 vcc, 88, v32
s_cbranch_execz LE_w
ds_write_b32 v172, v236
v_cmpx_lt_i32 vcc, 89, v32
ds_write_b32 v173, v237
v_cmpx_lt_i32 vcc, 90, v32
ds_write_b32 v174, v238
v_cmpx_lt_i32 vcc, 91, v32
ds_write_b32 v175, v239
v_cmpx_lt_i32 vcc, 96, v32
s_cbranch_execz LE_w
ds_write_b32 v176, v240
v_cmpx_lt_i32 vcc, 97, v32
ds_write_b32 v177, v241
v_cmpx_lt_i32 vcc, 98, v32
ds_write_b32 v178, v242
v_cmpx_lt_i32 vcc, 99, v32
ds_write_b32 v179, v243
v_cmpx_lt_i32 vcc, 104, v32
s_cbranch_execz LE_w
ds_write_b32 v180, v244
v_cmpx_lt_i32 vcc, 105, v32
ds_write_b32 v181, v245
v_cmpx_lt_i32 vcc, 106, v32
ds_write_b32 v182, v246
v_cmpx_lt_i32 vcc, 107, v32
ds_write_b32 v183, v247
v_cmpx_lt_i32 vcc, 112, v32
s_cbranch_execz LE_w
ds_write_b32 v184, v248
v_cmpx_lt_i32 vcc, 113, v32
ds_write_b32 v185, v249
v_cmpx_lt_i32 vcc, 114, v32
ds_write_b32 v186, v250
v_cmpx_lt_i32 vcc, 115, v32
ds_write_b32 v187, v251
v_cmpx_lt_i32 vcc, 120, v32
s_cbranch_execz LE_w
ds_write_b32 v188, v252
v_cmpx_lt_i32 vcc, 121, v32
ds_write_b32 v189, v253
v_cmpx_lt_i32 vcc, 122, v32
ds_write_b32 v190, v254
v_cmpx_lt_i32 vcc, 123, v32
ds_write_b32 v191, v255
LE_w:
s_mov_b64 exec, -1
s_waitcnt vmcnt(0)
s_mov_b32 s51, 0
v_lshlrev_b32 v80, 16, v76
v_lshlrev_b32 v81, 16, v77
v_lshlrev_b32 v82, 16, v78
v_mov_b32 v34, v38
ds_read2_b32 v[52:53], v34 offset0:0 offset1:4
ds_read2_b32 v[54:55], v34 offset0:8 offset1:12
s_waitcnt lgkmcnt(0)
ds_read2_b32 v[56:57], v34 offset0:16 offset1:20
ds_read2_b32 v[58:59], v34 offset0:24 offset1:28
v_mad_u32_u16 v60, v52, s49, v2
v_mad_u32_u16 v61, v53, s49, v2
v_mad_u32_u16 v62, v54, s49, v2
v_mad_u32_u16 v63, v55, s49, v2
buffer_load_dwordx4 a[0:3], v60, s[16:19], 0 offen
buffer_load_dwordx4 a[4:7], v60, s[16:19], 0 offen offset:256
buffer_load_dwordx4 a[8:11], v61, s[16:19], 0 offen
buffer_load_dwordx4 a[12:15], v61, s[16:19], 0 offen offset:256
buffer_load_dwordx4 a[16:19], v62, s[16:19], 0 offen
buffer_load_dwordx4 a[20:23], v62, s[16:19], 0 offen offset:256
buffer_load_dwordx4 a[24:27], v63, s[16:19], 0 offen
buffer_load_dwordx4 a[28:31], v63, s[16:19], 0 offen offset:256
s_waitcnt lgkmcnt(0)
ds_read2_b32 v[52:53], v34 offset0:32 offset1:36
ds_read2_b32 v[54:55], v34 offset0:40 offset1:44
v_mad_u32_u16 v60, v56, s49, v2
v_mad_u32_u16 v61, v57, s49, v2
v_mad_u32_u16 v62, v58, s49, v2
v_mad_u32_u16 v63, v59, s49, v2
buffer_load_dwordx4 a[32:35], v60, s[16:19], 0 offen
buffer_load_dwordx4 a[36:39], v60, s[16:19], 0 offen offset:256
buffer_load_dwordx4 a[40:43], v61, s[16:19], 0 offen
buffer_load_dwordx4 a[44:47], v61, s[16:19], 0 offen offset:256
buffer_load_dwordx4 a[48:51], v62, s[16:19], 0 offen
buffer_load_dwordx4 a[52:55], v62, s[16:19], 0 offen offset:256
buffer_load_dwordx4 a[56:59], v63, s[16:19], 0 offen
buffer_load_dwordx4 a[60:63], v63, s[16:19], 0 offen offset:256
s_waitcnt lgkmcnt(0)
ds_read2_b32 v[56:57], v34 offset0:48 offset1:52
ds_read2_b32 v[58:59], v34 offset0:56 offset1:60
v_mad_u32_u16 v60, v52, s49, v2
v_mad_u32_u16 v61, v53, s49, v2
v_mad_u32_u16 v62, v54, s49, v2
v_mad_u32_u16 v63, v55, s49, v2
buffer_load_dwordx4 a[64:67], v60, s[16:19], 0 offen
buffer_load_dwordx4 a[68:71], v60, s[16:19], 0 offen offset:256
buffer_load_dwordx4 a[72:75], v61, s[16:19], 0 offen
buffer_load_dwordx4 a[76:79], v61, s[16:19], 0 offen offset:256
buffer_load_dwordx4 a[80:83], v62, s[16:19], 0 offen
buffer_load_dwordx4 a[84:87], v62, s[16:19], 0 offen offset:256
buffer_load_dwordx4 a[88:91], v63, s[16:19], 0 offen
buffer_load_dwordx4 a[92:95], v63, s[16:19], 0 offen offset:256
s_waitcnt lgkmcnt(0)
ds_read2_b32 v[52:53], v34 offset0:64 offset1:68
ds_read2_b32 v[54:55], v34 offset0:72 offset1:76
v_mad_u32_u16 v60, v56, s49, v2
v_mad_u32_u16 v61, v57, s49, v2
v_mad_u32_u16 v62, v58, s49, v2
v_mad_u32_u16 v63, v59, s49, v2
buffer_load_dwordx4 a[96:99], v60, s[16:19], 0 offen
buffer_load_dwordx4 a[100:103], v60, s[16:19], 0 offen offset:256
buffer_load_dwordx4 a[104:107], v61, s[16:19], 0 offen
buffer_load_dwordx4 a[108:111], v61, s[16:19], 0 offen offset:256
buffer_load_dwordx4 a[112:115], v62, s[16:19], 0 offen
buffer_load_dwordx4 a[116:119], v62, s[16:19], 0 offen offset:256
buffer_load_dwordx4 a[120:123], v63, s[16:19], 0 offen
buffer_load_dwordx4 a[124:127], v63, s[16:19], 0 offen offset:256
s_waitcnt lgkmcnt(0)
ds_read2_b32 v[56:57], v34 offset0:80 offset1:84
ds_read2_b32 v[58:59], v34 offset0:88 offset1:92
v_mad_u32_u16 v60, v52, s49, v2
v_mad_u32_u16 v61, v53, s49, v2
v_mad_u32_u16 v62, v54, s49, v2
v_mad_u32_u16 v63, v55, s49, v2
buffer_load_dwordx4 a[128:131], v60, s[16:19], 0 offen
buffer_load_dwordx4 a[132:135], v60, s[16:19], 0 offen offset:256
buffer_load_dwordx4 a[136:139], v61, s[16:19], 0 offen
buffer_load_dwordx4 a[140:143], v61, s[16:19], 0 offen offset:256
buffer_load_dwordx4 a[144:147], v62, s[16:19], 0 offen
buffer_load_dwordx4 a[148:151], v62, s[16:19], 0 offen offset:256
buffer_load_dwordx4 a[152:155], v63, s[16:19], 0 offen
buffer_load_dwordx4 a[156:159], v63, s[16:19], 0 offen offset:256
s_waitcnt lgkmcnt(0)
ds_read2_b32 v[52:53], v34 offset0:96 offset1:100
ds_read2_b32 v[54:55], v34 offset0:104 offset1:108
v_mad_u32_u16 v60, v56, s49, v2
v_mad_u32_u16 v61, v57, s49, v2
v_mad_u32_u16 v62, v58, s49, v2
v_mad_u32_u16 v63, v59, s49, v2
buffer_load_dwordx4 a[160:163], v60, s[16:19], 0 offen
buffer_load_dwordx4 a[164:167], v60, s[16:19], 0 offen offset:256
buffer_load_dwordx4 a[168:171], v61, s[16:19], 0 offen
buffer_load_dwordx4 a[172:175], v61, s[16:19], 0 offen offset:256
buffer_load_dwordx4 a[176:179], v62, s[16:19], 0 offen
buffer_load_dwordx4 a[180:183], v62, s[16:19], 0 offen offset:256
buffer_load_dwordx4 a[184:187], v63, s[16:19], 0 offen
buffer_load_dwordx4 a[188:191], v63, s[16:19], 0 offen offset:256
s_waitcnt lgkmcnt(0)
ds_read2_b32 v[56:57], v34 offset0:112 offset1:116
ds_read2_b32 v[58:59], v34 offset0:120 offset1:124
v_mad_u32_u16 v60, v52, s49, v2
v_mad_u32_u16 v61, v53, s49, v2
v_mad_u32_u16 v62, v54, s49, v2
v_mad_u32_u16 v63, v55, s49, v2
buffer_load_dwordx4 a[192:195], v60, s[16:19], 0 offen
buffer_load_dwordx4 a[196:199], v60, s[16:19], 0 offen offset:256
buffer_load_dwordx4 a[200:203], v61, s[16:19], 0 offen
buffer_load_dwordx4 a[204:207], v61, s[16:19], 0 offen offset:256
buffer_load_dwordx4 a[208:211], v62, s[16:19], 0 offen
buffer_load_dwordx4 a[212:215], v62, s[16:19], 0 offen offset:256
buffer_load_dwordx4 a[216:219], v63, s[16:19], 0 offen
buffer_load_dwordx4 a[220:223], v63, s[16:19], 0 offen offset:256
s_waitcnt lgkmcnt(0)
ds_read2_b32 v[52:53], v34 offset0:128 offset1:132
ds_read2_b32 v[54:55], v34 offset0:136 offset1:140
v_mad_u32_u16 v60, v56, s49, v2
v_mad_u32_u16 v61, v57, s49, v2
v_mad_u32_u16 v62, v58, s49, v2
v_mad_u32_u16 v63, v59, s49, v2
buffer_load_dwordx4 a[224:227], v60, s[16:19], 0 offen
buffer_load_dwordx4 a[228:231], v60, s[16:19], 0 offen offset:256
buffer_load_dwordx4 a[232:235], v61, s[16:19], 0 offen
buffer_load_dwordx4 a[236:239], v61, s[16:19], 0 offen offset:256
buffer_load_dwordx4 a[240:243], v62, s[16:19], 0 offen
buffer_load_dwordx4 a[244:247], v62, s[16:19], 0 offen offset:256
buffer_load_dwordx4 a[248:251], v63, s[16:19], 0 offen
buffer_load_dwordx4 a[252:255], v63, s[16:19], 0 offen offset:256
v_add_u32 v34, 512, v34
s_mov_b32 s45, 0
s_mul_i32 s47, s40, 85504
LE_loop:
v_readlane_b32 s46, v37, s45
s_add_u32 s45, s45, 1
s_waitcnt vmcnt(56)
v_mfma_f32_16x16x32_bf16 v[48:51], a[0:3], v[40:43], v[48:51]
v_mfma_f32_16x16x32_bf16 v[48:51], a[4:7], v[44:47], v[48:51]
s_bitcmp1_b32 s46, 0
s_cbranch_scc0 LE_nf0
v_readlane_b32 s57, v80, s51
s_add_u32 s51, s51, 1
s_and_b32 s51, s51, 63
s_cbranch_scc1 LE_dg0
v_mov_b32 v80, v81
v_mov_b32 v81, v82
LE_dg0:
s_nop 3
v_mul_f32 v48, s57, v48
v_mul_f32 v49, s57, v49
v_mul_f32 v50, s57, v50
v_mul_f32 v51, s57, v51
s_cmp_eq_u32 s42, 0
s_cbranch_scc1 LE_fl0
buffer_load_dwordx2 v[66:67], v39, s[20:23], s47 offen sc1
s_waitcnt vmcnt(0)
v_lshlrev_b32 v64, 16, v66
v_and_b32 v65, 0xffff0000, v66
v_add_f32 v48, v48, v64
v_add_f32 v49, v49, v65
v_lshlrev_b32 v64, 16, v67
v_and_b32 v65, 0xffff0000, v67
v_add_f32 v50, v50, v64
v_add_f32 v51, v51, v65
LE_fl0:
v_cvt_pk_bf16_f32 v64, v48, v49
v_cvt_pk_bf16_f32 v65, v50, v51
v_mov_b32 v48, 0
v_mov_b32 v49, 0
v_mov_b32 v50, 0
v_mov_b32 v51, 0
buffer_store_dwordx2 v[64:65], v39, s[20:23], s47 offen sc1
s_add_u32 s47, s47, 512
LE_nf0:
v_mfma_f32_16x16x32_bf16 v[48:51], a[8:11], v[40:43], v[48:51]
v_mfma_f32_16x16x32_bf16 v[48:51], a[12:15], v[44:47], v[48:51]
s_bitcmp1_b32 s46, 1
s_cbranch_scc0 LE_nf1
v_readlane_b32 s57, v80, s51
s_add_u32 s51, s51, 1
s_and_b32 s51, s51, 63
s_cbranch_scc1 LE_dg1
v_mov_b32 v80, v81
v_mov_b32 v81, v82
LE_dg1:
s_nop 3
v_mul_f32 v48, s57, v48
v_mul_f32 v49, s57, v49
v_mul_f32 v50, s57, v50
v_mul_f32 v51, s57, v51
s_cmp_eq_u32 s42, 0
s_cbranch_scc1 LE_fl1
buffer_load_dwordx2 v[66:67], v39, s[20:23], s47 offen sc1
s_waitcnt vmcnt(0)
v_lshlrev_b32 v64, 16, v66
v_and_b32 v65, 0xffff0000, v66
v_add_f32 v48, v48, v64
v_add_f32 v49, v49, v65
v_lshlrev_b32 v64, 16, v67
v_and_b32 v65, 0xffff0000, v67
v_add_f32 v50, v50, v64
v_add_f32 v51, v51, v65
LE_fl1:
v_cvt_pk_bf16_f32 v64, v48, v49
v_cvt_pk_bf16_f32 v65, v50, v51
v_mov_b32 v48, 0
v_mov_b32 v49, 0
v_mov_b32 v50, 0
v_mov_b32 v51, 0
buffer_store_dwordx2 v[64:65], v39, s[20:23], s47 offen sc1
s_add_u32 s47, s47, 512
LE_nf1:
v_mfma_f32_16x16x32_bf16 v[48:51], a[16:19], v[40:43], v[48:51]
v_mfma_f32_16x16x32_bf16 v[48:51], a[20:23], v[44:47], v[48:51]
s_bitcmp1_b32 s46, 2
s_cbranch_scc0 LE_nf2
v_readlane_b32 s57, v80, s51
s_add_u32 s51, s51, 1
s_and_b32 s51, s51, 63
s_cbranch_scc1 LE_dg2
v_mov_b32 v80, v81
v_mov_b32 v81, v82
LE_dg2:
s_nop 3
v_mul_f32 v48, s57, v48
v_mul_f32 v49, s57, v49
v_mul_f32 v50, s57, v50
v_mul_f32 v51, s57, v51
s_cmp_eq_u32 s42, 0
s_cbranch_scc1 LE_fl2
buffer_load_dwordx2 v[66:67], v39, s[20:23], s47 offen sc1
s_waitcnt vmcnt(0)
v_lshlrev_b32 v64, 16, v66
v_and_b32 v65, 0xffff0000, v66
v_add_f32 v48, v48, v64
v_add_f32 v49, v49, v65
v_lshlrev_b32 v64, 16, v67
v_and_b32 v65, 0xffff0000, v67
v_add_f32 v50, v50, v64
v_add_f32 v51, v51, v65
LE_fl2:
v_cvt_pk_bf16_f32 v64, v48, v49
v_cvt_pk_bf16_f32 v65, v50, v51
v_mov_b32 v48, 0
v_mov_b32 v49, 0
v_mov_b32 v50, 0
v_mov_b32 v51, 0
buffer_store_dwordx2 v[64:65], v39, s[20:23], s47 offen sc1
s_add_u32 s47, s47, 512
LE_nf2:
v_mfma_f32_16x16x32_bf16 v[48:51], a[24:27], v[40:43], v[48:51]
v_mfma_f32_16x16x32_bf16 v[48:51], a[28:31], v[44:47], v[48:51]
s_bitcmp1_b32 s46, 3
s_cbranch_scc0 LE_nf3
v_readlane_b32 s57, v80, s51
s_add_u32 s51, s51, 1
s_and_b32 s51, s51, 63
s_cbranch_scc1 LE_dg3
v_mov_b32 v80, v81
v_mov_b32 v81, v82
LE_dg3:
s_nop 3
v_mul_f32 v48, s57, v48
v_mul_f32 v49, s57, v49
v_mul_f32 v50, s57, v50
v_mul_f32 v51, s57, v51
s_cmp_eq_u32 s42, 0
s_cbranch_scc1 LE_fl3
buffer_load_dwordx2 v[66:67], v39, s[20:23], s47 offen sc1
s_waitcnt vmcnt(0)
v_lshlrev_b32 v64, 16, v66
v_and_b32 v65, 0xffff0000, v66
v_add_f32 v48, v48, v64
v_add_f32 v49, v49, v65
v_lshlrev_b32 v64, 16, v67
v_and_b32 v65, 0xffff0000, v67
v_add_f32 v50, v50, v64
v_add_f32 v51, v51, v65
LE_fl3:
v_cvt_pk_bf16_f32 v64, v48, v49
v_cvt_pk_bf16_f32 v65, v50, v51
v_mov_b32 v48, 0
v_mov_b32 v49, 0
v_mov_b32 v50, 0
v_mov_b32 v51, 0
buffer_store_dwordx2 v[64:65], v39, s[20:23], s47 offen sc1
s_add_u32 s47, s47, 512
LE_nf3:
s_waitcnt lgkmcnt(0)
ds_read2_b32 v[56:57], v34 offset0:16 offset1:20
ds_read2_b32 v[58:59], v34 offset0:24 offset1:28
v_mad_u32_u16 v60, v52, s49, v2
v_mad_u32_u16 v61, v53, s49, v2
v_mad_u32_u16 v62, v54, s49, v2
v_mad_u32_u16 v63, v55, s49, v2
buffer_load_dwordx4 a[0:3], v60, s[16:19], 0 offen
buffer_load_dwordx4 a[4:7], v60, s[16:19], 0 offen offset:256
buffer_load_dwordx4 a[8:11], v61, s[16:19], 0 offen
buffer_load_dwordx4 a[12:15], v61, s[16:19], 0 offen offset:256
buffer_load_dwordx4 a[16:19], v62, s[16:19], 0 offen
buffer_load_dwordx4 a[20:23], v62, s[16:19], 0 offen offset:256
buffer_load_dwordx4 a[24:27], v63, s[16:19], 0 offen
buffer_load_dwordx4 a[28:31], v63, s[16:19], 0 offen offset:256
s_waitcnt vmcnt(56)
v_mfma_f32_16x16x32_bf16 v[48:51], a[32:35], v[40:43], v[48:51]
v_mfma_f32_16x16x32_bf16 v[48:51], a[36:39], v[44:47], v[48:51]
s_bitcmp1_b32 s46, 4
s_cbranch_scc0 LE_nf4
v_readlane_b32 s57, v80, s51
s_add_u32 s51, s51, 1
s_and_b32 s51, s51, 63
s_cbranch_scc1 LE_dg4
v_mov_b32 v80, v81
v_mov_b32 v81, v82
LE_dg4:
s_nop 3
v_mul_f32 v48, s57, v48
v_mul_f32 v49, s57, v49
v_mul_f32 v50, s57, v50
v_mul_f32 v51, s57, v51
s_cmp_eq_u32 s42, 0
s_cbranch_scc1 LE_fl4
buffer_load_dwordx2 v[66:67], v39, s[20:23], s47 offen sc1
s_waitcnt vmcnt(0)
v_lshlrev_b32 v64, 16, v66
v_and_b32 v65, 0xffff0000, v66
v_add_f32 v48, v48, v64
v_add_f32 v49, v49, v65
v_lshlrev_b32 v64, 16, v67
v_and_b32 v65, 0xffff0000, v67
v_add_f32 v50, v50, v64
v_add_f32 v51, v51, v65
LE_fl4:
v_cvt_pk_bf16_f32 v64, v48, v49
v_cvt_pk_bf16_f32 v65, v50, v51
v_mov_b32 v48, 0
v_mov_b32 v49, 0
v_mov_b32 v50, 0
v_mov_b32 v51, 0
buffer_store_dwordx2 v[64:65], v39, s[20:23], s47 offen sc1
s_add_u32 s47, s47, 512
LE_nf4:
v_mfma_f32_16x16x32_bf16 v[48:51], a[40:43], v[40:43], v[48:51]
v_mfma_f32_16x16x32_bf16 v[48:51], a[44:47], v[44:47], v[48:51]
s_bitcmp1_b32 s46, 5
s_cbranch_scc0 LE_nf5
v_readlane_b32 s57, v80, s51
s_add_u32 s51, s51, 1
s_and_b32 s51, s51, 63
s_cbranch_scc1 LE_dg5
v_mov_b32 v80, v81
v_mov_b32 v81, v82
LE_dg5:
s_nop 3
v_mul_f32 v48, s57, v48
v_mul_f32 v49, s57, v49
v_mul_f32 v50, s57, v50
v_mul_f32 v51, s57, v51
s_cmp_eq_u32 s42, 0
s_cbranch_scc1 LE_fl5
buffer_load_dwordx2 v[66:67], v39, s[20:23], s47 offen sc1
s_waitcnt vmcnt(0)
v_lshlrev_b32 v64, 16, v66
v_and_b32 v65, 0xffff0000, v66
v_add_f32 v48, v48, v64
v_add_f32 v49, v49, v65
v_lshlrev_b32 v64, 16, v67
v_and_b32 v65, 0xffff0000, v67
v_add_f32 v50, v50, v64
v_add_f32 v51, v51, v65
LE_fl5:
v_cvt_pk_bf16_f32 v64, v48, v49
v_cvt_pk_bf16_f32 v65, v50, v51
v_mov_b32 v48, 0
v_mov_b32 v49, 0
v_mov_b32 v50, 0
v_mov_b32 v51, 0
buffer_store_dwordx2 v[64:65], v39, s[20:23], s47 offen sc1
s_add_u32 s47, s47, 512
LE_nf5:
v_mfma_f32_16x16x32_bf16 v[48:51], a[48:51], v[40:43], v[48:51]
v_mfma_f32_16x16x32_bf16 v[48:51], a[52:55], v[44:47], v[48:51]
s_bitcmp1_b32 s46, 6
s_cbranch_scc0 LE_nf6
v_readlane_b32 s57, v80, s51
s_add_u32 s51, s51, 1
s_and_b32 s51, s51, 63
s_cbranch_scc1 LE_dg6
v_mov_b32 v80, v81
v_mov_b32 v81, v82
LE_dg6:
s_nop 3
v_mul_f32 v48, s57, v48
v_mul_f32 v49, s57, v49
v_mul_f32 v50, s57, v50
v_mul_f32 v51, s57, v51
s_cmp_eq_u32 s42, 0
s_cbranch_scc1 LE_fl6
buffer_load_dwordx2 v[66:67], v39, s[20:23], s47 offen sc1
s_waitcnt vmcnt(0)
v_lshlrev_b32 v64, 16, v66
v_and_b32 v65, 0xffff0000, v66
v_add_f32 v48, v48, v64
v_add_f32 v49, v49, v65
v_lshlrev_b32 v64, 16, v67
v_and_b32 v65, 0xffff0000, v67
v_add_f32 v50, v50, v64
v_add_f32 v51, v51, v65
LE_fl6:
v_cvt_pk_bf16_f32 v64, v48, v49
v_cvt_pk_bf16_f32 v65, v50, v51
v_mov_b32 v48, 0
v_mov_b32 v49, 0
v_mov_b32 v50, 0
v_mov_b32 v51, 0
buffer_store_dwordx2 v[64:65], v39, s[20:23], s47 offen sc1
s_add_u32 s47, s47, 512
LE_nf6:
v_mfma_f32_16x16x32_bf16 v[48:51], a[56:59], v[40:43], v[48:51]
v_mfma_f32_16x16x32_bf16 v[48:51], a[60:63], v[44:47], v[48:51]
s_bitcmp1_b32 s46, 7
s_cbranch_scc0 LE_nf7
v_readlane_b32 s57, v80, s51
s_add_u32 s51, s51, 1
s_and_b32 s51, s51, 63
s_cbranch_scc1 LE_dg7
v_mov_b32 v80, v81
v_mov_b32 v81, v82
LE_dg7:
s_nop 3
v_mul_f32 v48, s57, v48
v_mul_f32 v49, s57, v49
v_mul_f32 v50, s57, v50
v_mul_f32 v51, s57, v51
s_cmp_eq_u32 s42, 0
s_cbranch_scc1 LE_fl7
buffer_load_dwordx2 v[66:67], v39, s[20:23], s47 offen sc1
s_waitcnt vmcnt(0)
v_lshlrev_b32 v64, 16, v66
v_and_b32 v65, 0xffff0000, v66
v_add_f32 v48, v48, v64
v_add_f32 v49, v49, v65
v_lshlrev_b32 v64, 16, v67
v_and_b32 v65, 0xffff0000, v67
v_add_f32 v50, v50, v64
v_add_f32 v51, v51, v65
LE_fl7:
v_cvt_pk_bf16_f32 v64, v48, v49
v_cvt_pk_bf16_f32 v65, v50, v51
v_mov_b32 v48, 0
v_mov_b32 v49, 0
v_mov_b32 v50, 0
v_mov_b32 v51, 0
buffer_store_dwordx2 v[64:65], v39, s[20:23], s47 offen sc1
s_add_u32 s47, s47, 512
LE_nf7:
s_waitcnt lgkmcnt(0)
ds_read2_b32 v[52:53], v34 offset0:32 offset1:36
ds_read2_b32 v[54:55], v34 offset0:40 offset1:44
v_mad_u32_u16 v60, v56, s49, v2
v_mad_u32_u16 v61, v57, s49, v2
v_mad_u32_u16 v62, v58, s49, v2
v_mad_u32_u16 v63, v59, s49, v2
buffer_load_dwordx4 a[32:35], v60, s[16:19], 0 offen
buffer_load_dwordx4 a[36:39], v60, s[16:19], 0 offen offset:256
buffer_load_dwordx4 a[40:43], v61, s[16:19], 0 offen
buffer_load_dwordx4 a[44:47], v61, s[16:19], 0 offen offset:256
buffer_load_dwordx4 a[48:51], v62, s[16:19], 0 offen
buffer_load_dwordx4 a[52:55], v62, s[16:19], 0 offen offset:256
buffer_load_dwordx4 a[56:59], v63, s[16:19], 0 offen
buffer_load_dwordx4 a[60:63], v63, s[16:19], 0 offen offset:256
s_waitcnt vmcnt(56)
v_mfma_f32_16x16x32_bf16 v[48:51], a[64:67], v[40:43], v[48:51]
v_mfma_f32_16x16x32_bf16 v[48:51], a[68:71], v[44:47], v[48:51]
s_bitcmp1_b32 s46, 8
s_cbranch_scc0 LE_nf8
v_readlane_b32 s57, v80, s51
s_add_u32 s51, s51, 1
s_and_b32 s51, s51, 63
s_cbranch_scc1 LE_dg8
v_mov_b32 v80, v81
v_mov_b32 v81, v82
LE_dg8:
s_nop 3
v_mul_f32 v48, s57, v48
v_mul_f32 v49, s57, v49
v_mul_f32 v50, s57, v50
v_mul_f32 v51, s57, v51
s_cmp_eq_u32 s42, 0
s_cbranch_scc1 LE_fl8
buffer_load_dwordx2 v[66:67], v39, s[20:23], s47 offen sc1
s_waitcnt vmcnt(0)
v_lshlrev_b32 v64, 16, v66
v_and_b32 v65, 0xffff0000, v66
v_add_f32 v48, v48, v64
v_add_f32 v49, v49, v65
v_lshlrev_b32 v64, 16, v67
v_and_b32 v65, 0xffff0000, v67
v_add_f32 v50, v50, v64
v_add_f32 v51, v51, v65
LE_fl8:
v_cvt_pk_bf16_f32 v64, v48, v49
v_cvt_pk_bf16_f32 v65, v50, v51
v_mov_b32 v48, 0
v_mov_b32 v49, 0
v_mov_b32 v50, 0
v_mov_b32 v51, 0
buffer_store_dwordx2 v[64:65], v39, s[20:23], s47 offen sc1
s_add_u32 s47, s47, 512
LE_nf8:
v_mfma_f32_16x16x32_bf16 v[48:51], a[72:75], v[40:43], v[48:51]
v_mfma_f32_16x16x32_bf16 v[48:51], a[76:79], v[44:47], v[48:51]
s_bitcmp1_b32 s46, 9
s_cbranch_scc0 LE_nf9
v_readlane_b32 s57, v80, s51
s_add_u32 s51, s51, 1
s_and_b32 s51, s51, 63
s_cbranch_scc1 LE_dg9
v_mov_b32 v80, v81
v_mov_b32 v81, v82
LE_dg9:
s_nop 3
v_mul_f32 v48, s57, v48
v_mul_f32 v49, s57, v49
v_mul_f32 v50, s57, v50
v_mul_f32 v51, s57, v51
s_cmp_eq_u32 s42, 0
s_cbranch_scc1 LE_fl9
buffer_load_dwordx2 v[66:67], v39, s[20:23], s47 offen sc1
s_waitcnt vmcnt(0)
v_lshlrev_b32 v64, 16, v66
v_and_b32 v65, 0xffff0000, v66
v_add_f32 v48, v48, v64
v_add_f32 v49, v49, v65
v_lshlrev_b32 v64, 16, v67
v_and_b32 v65, 0xffff0000, v67
v_add_f32 v50, v50, v64
v_add_f32 v51, v51, v65
LE_fl9:
v_cvt_pk_bf16_f32 v64, v48, v49
v_cvt_pk_bf16_f32 v65, v50, v51
v_mov_b32 v48, 0
v_mov_b32 v49, 0
v_mov_b32 v50, 0
v_mov_b32 v51, 0
buffer_store_dwordx2 v[64:65], v39, s[20:23], s47 offen sc1
s_add_u32 s47, s47, 512
LE_nf9:
v_mfma_f32_16x16x32_bf16 v[48:51], a[80:83], v[40:43], v[48:51]
v_mfma_f32_16x16x32_bf16 v[48:51], a[84:87], v[44:47], v[48:51]
s_bitcmp1_b32 s46, 10
s_cbranch_scc0 LE_nf10
v_readlane_b32 s57, v80, s51
s_add_u32 s51, s51, 1
s_and_b32 s51, s51, 63
s_cbranch_scc1 LE_dg10
v_mov_b32 v80, v81
v_mov_b32 v81, v82
LE_dg10:
s_nop 3
v_mul_f32 v48, s57, v48
v_mul_f32 v49, s57, v49
v_mul_f32 v50, s57, v50
v_mul_f32 v51, s57, v51
s_cmp_eq_u32 s42, 0
s_cbranch_scc1 LE_fl10
buffer_load_dwordx2 v[66:67], v39, s[20:23], s47 offen sc1
s_waitcnt vmcnt(0)
v_lshlrev_b32 v64, 16, v66
v_and_b32 v65, 0xffff0000, v66
v_add_f32 v48, v48, v64
v_add_f32 v49, v49, v65
v_lshlrev_b32 v64, 16, v67
v_and_b32 v65, 0xffff0000, v67
v_add_f32 v50, v50, v64
v_add_f32 v51, v51, v65
LE_fl10:
v_cvt_pk_bf16_f32 v64, v48, v49
v_cvt_pk_bf16_f32 v65, v50, v51
v_mov_b32 v48, 0
v_mov_b32 v49, 0
v_mov_b32 v50, 0
v_mov_b32 v51, 0
buffer_store_dwordx2 v[64:65], v39, s[20:23], s47 offen sc1
s_add_u32 s47, s47, 512
LE_nf10:
v_mfma_f32_16x16x32_bf16 v[48:51], a[88:91], v[40:43], v[48:51]
v_mfma_f32_16x16x32_bf16 v[48:51], a[92:95], v[44:47], v[48:51]
s_bitcmp1_b32 s46, 11
s_cbranch_scc0 LE_nf11
v_readlane_b32 s57, v80, s51
s_add_u32 s51, s51, 1
s_and_b32 s51, s51, 63
s_cbranch_scc1 LE_dg11
v_mov_b32 v80, v81
v_mov_b32 v81, v82
LE_dg11:
s_nop 3
v_mul_f32 v48, s57, v48
v_mul_f32 v49, s57, v49
v_mul_f32 v50, s57, v50
v_mul_f32 v51, s57, v51
s_cmp_eq_u32 s42, 0
s_cbranch_scc1 LE_fl11
buffer_load_dwordx2 v[66:67], v39, s[20:23], s47 offen sc1
s_waitcnt vmcnt(0)
v_lshlrev_b32 v64, 16, v66
v_and_b32 v65, 0xffff0000, v66
v_add_f32 v48, v48, v64
v_add_f32 v49, v49, v65
v_lshlrev_b32 v64, 16, v67
v_and_b32 v65, 0xffff0000, v67
v_add_f32 v50, v50, v64
v_add_f32 v51, v51, v65
LE_fl11:
v_cvt_pk_bf16_f32 v64, v48, v49
v_cvt_pk_bf16_f32 v65, v50, v51
v_mov_b32 v48, 0
v_mov_b32 v49, 0
v_mov_b32 v50, 0
v_mov_b32 v51, 0
buffer_store_dwordx2 v[64:65], v39, s[20:23], s47 offen sc1
s_add_u32 s47, s47, 512
LE_nf11:
s_waitcnt lgkmcnt(0)
ds_read2_b32 v[56:57], v34 offset0:48 offset1:52
ds_read2_b32 v[58:59], v34 offset0:56 offset1:60
v_mad_u32_u16 v60, v52, s49, v2
v_mad_u32_u16 v61, v53, s49, v2
v_mad_u32_u16 v62, v54, s49, v2
v_mad_u32_u16 v63, v55, s49, v2
buffer_load_dwordx4 a[64:67], v60, s[16:19], 0 offen
buffer_load_dwordx4 a[68:71], v60, s[16:19], 0 offen offset:256
buffer_load_dwordx4 a[72:75], v61, s[16:19], 0 offen
buffer_load_dwordx4 a[76:79], v61, s[16:19], 0 offen offset:256
buffer_load_dwordx4 a[80:83], v62, s[16:19], 0 offen
buffer_load_dwordx4 a[84:87], v62, s[16:19], 0 offen offset:256
buffer_load_dwordx4 a[88:91], v63, s[16:19], 0 offen
buffer_load_dwordx4 a[92:95], v63, s[16:19], 0 offen offset:256
s_waitcnt vmcnt(56)
v_mfma_f32_16x16x32_bf16 v[48:51], a[96:99], v[40:43], v[48:51]
v_mfma_f32_16x16x32_bf16 v[48:51], a[100:103], v[44:47], v[48:51]
s_bitcmp1_b32 s46, 12
s_cbranch_scc0 LE_nf12
v_readlane_b32 s57, v80, s51
s_add_u32 s51, s51, 1
s_and_b32 s51, s51, 63
s_cbranch_scc1 LE_dg12
v_mov_b32 v80, v81
v_mov_b32 v81, v82
LE_dg12:
s_nop 3
v_mul_f32 v48, s57, v48
v_mul_f32 v49, s57, v49
v_mul_f32 v50, s57, v50
v_mul_f32 v51, s57, v51
s_cmp_eq_u32 s42, 0
s_cbranch_scc1 LE_fl12
buffer_load_dwordx2 v[66:67], v39, s[20:23], s47 offen sc1
s_waitcnt vmcnt(0)
v_lshlrev_b32 v64, 16, v66
v_and_b32 v65, 0xffff0000, v66
v_add_f32 v48, v48, v64
v_add_f32 v49, v49, v65
v_lshlrev_b32 v64, 16, v67
v_and_b32 v65, 0xffff0000, v67
v_add_f32 v50, v50, v64
v_add_f32 v51, v51, v65
LE_fl12:
v_cvt_pk_bf16_f32 v64, v48, v49
v_cvt_pk_bf16_f32 v65, v50, v51
v_mov_b32 v48, 0
v_mov_b32 v49, 0
v_mov_b32 v50, 0
v_mov_b32 v51, 0
buffer_store_dwordx2 v[64:65], v39, s[20:23], s47 offen sc1
s_add_u32 s47, s47, 512
LE_nf12:
v_mfma_f32_16x16x32_bf16 v[48:51], a[104:107], v[40:43], v[48:51]
v_mfma_f32_16x16x32_bf16 v[48:51], a[108:111], v[44:47], v[48:51]
s_bitcmp1_b32 s46, 13
s_cbranch_scc0 LE_nf13
v_readlane_b32 s57, v80, s51
s_add_u32 s51, s51, 1
s_and_b32 s51, s51, 63
s_cbranch_scc1 LE_dg13
v_mov_b32 v80, v81
v_mov_b32 v81, v82
LE_dg13:
s_nop 3
v_mul_f32 v48, s57, v48
v_mul_f32 v49, s57, v49
v_mul_f32 v50, s57, v50
v_mul_f32 v51, s57, v51
s_cmp_eq_u32 s42, 0
s_cbranch_scc1 LE_fl13
buffer_load_dwordx2 v[66:67], v39, s[20:23], s47 offen sc1
s_waitcnt vmcnt(0)
v_lshlrev_b32 v64, 16, v66
v_and_b32 v65, 0xffff0000, v66
v_add_f32 v48, v48, v64
v_add_f32 v49, v49, v65
v_lshlrev_b32 v64, 16, v67
v_and_b32 v65, 0xffff0000, v67
v_add_f32 v50, v50, v64
v_add_f32 v51, v51, v65
LE_fl13:
v_cvt_pk_bf16_f32 v64, v48, v49
v_cvt_pk_bf16_f32 v65, v50, v51
v_mov_b32 v48, 0
v_mov_b32 v49, 0
v_mov_b32 v50, 0
v_mov_b32 v51, 0
buffer_store_dwordx2 v[64:65], v39, s[20:23], s47 offen sc1
s_add_u32 s47, s47, 512
LE_nf13:
v_mfma_f32_16x16x32_bf16 v[48:51], a[112:115], v[40:43], v[48:51]
v_mfma_f32_16x16x32_bf16 v[48:51], a[116:119], v[44:47], v[48:51]
s_bitcmp1_b32 s46, 14
s_cbranch_scc0 LE_nf14
v_readlane_b32 s57, v80, s51
s_add_u32 s51, s51, 1
s_and_b32 s51, s51, 63
s_cbranch_scc1 LE_dg14
v_mov_b32 v80, v81
v_mov_b32 v81, v82
LE_dg14:
s_nop 3
v_mul_f32 v48, s57, v48
v_mul_f32 v49, s57, v49
v_mul_f32 v50, s57, v50
v_mul_f32 v51, s57, v51
s_cmp_eq_u32 s42, 0
s_cbranch_scc1 LE_fl14
buffer_load_dwordx2 v[66:67], v39, s[20:23], s47 offen sc1
s_waitcnt vmcnt(0)
v_lshlrev_b32 v64, 16, v66
v_and_b32 v65, 0xffff0000, v66
v_add_f32 v48, v48, v64
v_add_f32 v49, v49, v65
v_lshlrev_b32 v64, 16, v67
v_and_b32 v65, 0xffff0000, v67
v_add_f32 v50, v50, v64
v_add_f32 v51, v51, v65
LE_fl14:
v_cvt_pk_bf16_f32 v64, v48, v49
v_cvt_pk_bf16_f32 v65, v50, v51
v_mov_b32 v48, 0
v_mov_b32 v49, 0
v_mov_b32 v50, 0
v_mov_b32 v51, 0
buffer_store_dwordx2 v[64:65], v39, s[20:23], s47 offen sc1
s_add_u32 s47, s47, 512
LE_nf14:
v_mfma_f32_16x16x32_bf16 v[48:51], a[120:123], v[40:43], v[48:51]
v_mfma_f32_16x16x32_bf16 v[48:51], a[124:127], v[44:47], v[48:51]
s_bitcmp1_b32 s46, 15
s_cbranch_scc0 LE_nf15
v_readlane_b32 s57, v80, s51
s_add_u32 s51, s51, 1
s_and_b32 s51, s51, 63
s_cbranch_scc1 LE_dg15
v_mov_b32 v80, v81
v_mov_b32 v81, v82
LE_dg15:
s_nop 3
v_mul_f32 v48, s57, v48
v_mul_f32 v49, s57, v49
v_mul_f32 v50, s57, v50
v_mul_f32 v51, s57, v51
s_cmp_eq_u32 s42, 0
s_cbranch_scc1 LE_fl15
buffer_load_dwordx2 v[66:67], v39, s[20:23], s47 offen sc1
s_waitcnt vmcnt(0)
v_lshlrev_b32 v64, 16, v66
v_and_b32 v65, 0xffff0000, v66
v_add_f32 v48, v48, v64
v_add_f32 v49, v49, v65
v_lshlrev_b32 v64, 16, v67
v_and_b32 v65, 0xffff0000, v67
v_add_f32 v50, v50, v64
v_add_f32 v51, v51, v65
LE_fl15:
v_cvt_pk_bf16_f32 v64, v48, v49
v_cvt_pk_bf16_f32 v65, v50, v51
v_mov_b32 v48, 0
v_mov_b32 v49, 0
v_mov_b32 v50, 0
v_mov_b32 v51, 0
buffer_store_dwordx2 v[64:65], v39, s[20:23], s47 offen sc1
s_add_u32 s47, s47, 512
LE_nf15:
s_waitcnt lgkmcnt(0)
ds_read2_b32 v[52:53], v34 offset0:64 offset1:68
ds_read2_b32 v[54:55], v34 offset0:72 offset1:76
v_mad_u32_u16 v60, v56, s49, v2
v_mad_u32_u16 v61, v57, s49, v2
v_mad_u32_u16 v62, v58, s49, v2
v_mad_u32_u16 v63, v59, s49, v2
buffer_load_dwordx4 a[96:99], v60, s[16:19], 0 offen
buffer_load_dwordx4 a[100:103], v60, s[16:19], 0 offen offset:256
buffer_load_dwordx4 a[104:107], v61, s[16:19], 0 offen
buffer_load_dwordx4 a[108:111], v61, s[16:19], 0 offen offset:256
buffer_load_dwordx4 a[112:115], v62, s[16:19], 0 offen
buffer_load_dwordx4 a[116:119], v62, s[16:19], 0 offen offset:256
buffer_load_dwordx4 a[120:123], v63, s[16:19], 0 offen
buffer_load_dwordx4 a[124:127], v63, s[16:19], 0 offen offset:256
s_waitcnt vmcnt(56)
v_mfma_f32_16x16x32_bf16 v[48:51], a[128:131], v[40:43], v[48:51]
v_mfma_f32_16x16x32_bf16 v[48:51], a[132:135], v[44:47], v[48:51]
s_bitcmp1_b32 s46, 16
s_cbranch_scc0 LE_nf16
v_readlane_b32 s57, v80, s51
s_add_u32 s51, s51, 1
s_and_b32 s51, s51, 63
s_cbranch_scc1 LE_dg16
v_mov_b32 v80, v81
v_mov_b32 v81, v82
LE_dg16:
s_nop 3
v_mul_f32 v48, s57, v48
v_mul_f32 v49, s57, v49
v_mul_f32 v50, s57, v50
v_mul_f32 v51, s57, v51
s_cmp_eq_u32 s42, 0
s_cbranch_scc1 LE_fl16
buffer_load_dwordx2 v[66:67], v39, s[20:23], s47 offen sc1
s_waitcnt vmcnt(0)
v_lshlrev_b32 v64, 16, v66
v_and_b32 v65, 0xffff0000, v66
v_add_f32 v48, v48, v64
v_add_f32 v49, v49, v65
v_lshlrev_b32 v64, 16, v67
v_and_b32 v65, 0xffff0000, v67
v_add_f32 v50, v50, v64
v_add_f32 v51, v51, v65
LE_fl16:
v_cvt_pk_bf16_f32 v64, v48, v49
v_cvt_pk_bf16_f32 v65, v50, v51
v_mov_b32 v48, 0
v_mov_b32 v49, 0
v_mov_b32 v50, 0
v_mov_b32 v51, 0
buffer_store_dwordx2 v[64:65], v39, s[20:23], s47 offen sc1
s_add_u32 s47, s47, 512
LE_nf16:
v_mfma_f32_16x16x32_bf16 v[48:51], a[136:139], v[40:43], v[48:51]
v_mfma_f32_16x16x32_bf16 v[48:51], a[140:143], v[44:47], v[48:51]
s_bitcmp1_b32 s46, 17
s_cbranch_scc0 LE_nf17
v_readlane_b32 s57, v80, s51
s_add_u32 s51, s51, 1
s_and_b32 s51, s51, 63
s_cbranch_scc1 LE_dg17
v_mov_b32 v80, v81
v_mov_b32 v81, v82
LE_dg17:
s_nop 3
v_mul_f32 v48, s57, v48
v_mul_f32 v49, s57, v49
v_mul_f32 v50, s57, v50
v_mul_f32 v51, s57, v51
s_cmp_eq_u32 s42, 0
s_cbranch_scc1 LE_fl17
buffer_load_dwordx2 v[66:67], v39, s[20:23], s47 offen sc1
s_waitcnt vmcnt(0)
v_lshlrev_b32 v64, 16, v66
v_and_b32 v65, 0xffff0000, v66
v_add_f32 v48, v48, v64
v_add_f32 v49, v49, v65
v_lshlrev_b32 v64, 16, v67
v_and_b32 v65, 0xffff0000, v67
v_add_f32 v50, v50, v64
v_add_f32 v51, v51, v65
LE_fl17:
v_cvt_pk_bf16_f32 v64, v48, v49
v_cvt_pk_bf16_f32 v65, v50, v51
v_mov_b32 v48, 0
v_mov_b32 v49, 0
v_mov_b32 v50, 0
v_mov_b32 v51, 0
buffer_store_dwordx2 v[64:65], v39, s[20:23], s47 offen sc1
s_add_u32 s47, s47, 512
LE_nf17:
v_mfma_f32_16x16x32_bf16 v[48:51], a[144:147], v[40:43], v[48:51]
v_mfma_f32_16x16x32_bf16 v[48:51], a[148:151], v[44:47], v[48:51]
s_bitcmp1_b32 s46, 18
s_cbranch_scc0 LE_nf18
v_readlane_b32 s57, v80, s51
s_add_u32 s51, s51, 1
s_and_b32 s51, s51, 63
s_cbranch_scc1 LE_dg18
v_mov_b32 v80, v81
v_mov_b32 v81, v82
LE_dg18:
s_nop 3
v_mul_f32 v48, s57, v48
v_mul_f32 v49, s57, v49
v_mul_f32 v50, s57, v50
v_mul_f32 v51, s57, v51
s_cmp_eq_u32 s42, 0
s_cbranch_scc1 LE_fl18
buffer_load_dwordx2 v[66:67], v39, s[20:23], s47 offen sc1
s_waitcnt vmcnt(0)
v_lshlrev_b32 v64, 16, v66
v_and_b32 v65, 0xffff0000, v66
v_add_f32 v48, v48, v64
v_add_f32 v49, v49, v65
v_lshlrev_b32 v64, 16, v67
v_and_b32 v65, 0xffff0000, v67
v_add_f32 v50, v50, v64
v_add_f32 v51, v51, v65
LE_fl18:
v_cvt_pk_bf16_f32 v64, v48, v49
v_cvt_pk_bf16_f32 v65, v50, v51
v_mov_b32 v48, 0
v_mov_b32 v49, 0
v_mov_b32 v50, 0
v_mov_b32 v51, 0
buffer_store_dwordx2 v[64:65], v39, s[20:23], s47 offen sc1
s_add_u32 s47, s47, 512
LE_nf18:
v_mfma_f32_16x16x32_bf16 v[48:51], a[152:155], v[40:43], v[48:51]
v_mfma_f32_16x16x32_bf16 v[48:51], a[156:159], v[44:47], v[48:51]
s_bitcmp1_b32 s46, 19
s_cbranch_scc0 LE_nf19
v_readlane_b32 s57, v80, s51
s_add_u32 s51, s51, 1
s_and_b32 s51, s51, 63
s_cbranch_scc1 LE_dg19
v_mov_b32 v80, v81
v_mov_b32 v81, v82
LE_dg19:
s_nop 3
v_mul_f32 v48, s57, v48
v_mul_f32 v49, s57, v49
v_mul_f32 v50, s57, v50
v_mul_f32 v51, s57, v51
s_cmp_eq_u32 s42, 0
s_cbranch_scc1 LE_fl19
buffer_load_dwordx2 v[66:67], v39, s[20:23], s47 offen sc1
s_waitcnt vmcnt(0)
v_lshlrev_b32 v64, 16, v66
v_and_b32 v65, 0xffff0000, v66
v_add_f32 v48, v48, v64
v_add_f32 v49, v49, v65
v_lshlrev_b32 v64, 16, v67
v_and_b32 v65, 0xffff0000, v67
v_add_f32 v50, v50, v64
v_add_f32 v51, v51, v65
LE_fl19:
v_cvt_pk_bf16_f32 v64, v48, v49
v_cvt_pk_bf16_f32 v65, v50, v51
v_mov_b32 v48, 0
v_mov_b32 v49, 0
v_mov_b32 v50, 0
v_mov_b32 v51, 0
buffer_store_dwordx2 v[64:65], v39, s[20:23], s47 offen sc1
s_add_u32 s47, s47, 512
LE_nf19:
s_waitcnt lgkmcnt(0)
ds_read2_b32 v[56:57], v34 offset0:80 offset1:84
ds_read2_b32 v[58:59], v34 offset0:88 offset1:92
v_mad_u32_u16 v60, v52, s49, v2
v_mad_u32_u16 v61, v53, s49, v2
v_mad_u32_u16 v62, v54, s49, v2
v_mad_u32_u16 v63, v55, s49, v2
buffer_load_dwordx4 a[128:131], v60, s[16:19], 0 offen
buffer_load_dwordx4 a[132:135], v60, s[16:19], 0 offen offset:256
buffer_load_dwordx4 a[136:139], v61, s[16:19], 0 offen
buffer_load_dwordx4 a[140:143], v61, s[16:19], 0 offen offset:256
buffer_load_dwordx4 a[144:147], v62, s[16:19], 0 offen
buffer_load_dwordx4 a[148:151], v62, s[16:19], 0 offen offset:256
buffer_load_dwordx4 a[152:155], v63, s[16:19], 0 offen
buffer_load_dwordx4 a[156:159], v63, s[16:19], 0 offen offset:256
s_waitcnt vmcnt(56)
v_mfma_f32_16x16x32_bf16 v[48:51], a[160:163], v[40:43], v[48:51]
v_mfma_f32_16x16x32_bf16 v[48:51], a[164:167], v[44:47], v[48:51]
s_bitcmp1_b32 s46, 20
s_cbranch_scc0 LE_nf20
v_readlane_b32 s57, v80, s51
s_add_u32 s51, s51, 1
s_and_b32 s51, s51, 63
s_cbranch_scc1 LE_dg20
v_mov_b32 v80, v81
v_mov_b32 v81, v82
LE_dg20:
s_nop 3
v_mul_f32 v48, s57, v48
v_mul_f32 v49, s57, v49
v_mul_f32 v50, s57, v50
v_mul_f32 v51, s57, v51
s_cmp_eq_u32 s42, 0
s_cbranch_scc1 LE_fl20
buffer_load_dwordx2 v[66:67], v39, s[20:23], s47 offen sc1
s_waitcnt vmcnt(0)
v_lshlrev_b32 v64, 16, v66
v_and_b32 v65, 0xffff0000, v66
v_add_f32 v48, v48, v64
v_add_f32 v49, v49, v65
v_lshlrev_b32 v64, 16, v67
v_and_b32 v65, 0xffff0000, v67
v_add_f32 v50, v50, v64
v_add_f32 v51, v51, v65
LE_fl20:
v_cvt_pk_bf16_f32 v64, v48, v49
v_cvt_pk_bf16_f32 v65, v50, v51
v_mov_b32 v48, 0
v_mov_b32 v49, 0
v_mov_b32 v50, 0
v_mov_b32 v51, 0
buffer_store_dwordx2 v[64:65], v39, s[20:23], s47 offen sc1
s_add_u32 s47, s47, 512
LE_nf20:
v_mfma_f32_16x16x32_bf16 v[48:51], a[168:171], v[40:43], v[48:51]
v_mfma_f32_16x16x32_bf16 v[48:51], a[172:175], v[44:47], v[48:51]
s_bitcmp1_b32 s46, 21
s_cbranch_scc0 LE_nf21
v_readlane_b32 s57, v80, s51
s_add_u32 s51, s51, 1
s_and_b32 s51, s51, 63
s_cbranch_scc1 LE_dg21
v_mov_b32 v80, v81
v_mov_b32 v81, v82
LE_dg21:
s_nop 3
v_mul_f32 v48, s57, v48
v_mul_f32 v49, s57, v49
v_mul_f32 v50, s57, v50
v_mul_f32 v51, s57, v51
s_cmp_eq_u32 s42, 0
s_cbranch_scc1 LE_fl21
buffer_load_dwordx2 v[66:67], v39, s[20:23], s47 offen sc1
s_waitcnt vmcnt(0)
v_lshlrev_b32 v64, 16, v66
v_and_b32 v65, 0xffff0000, v66
v_add_f32 v48, v48, v64
v_add_f32 v49, v49, v65
v_lshlrev_b32 v64, 16, v67
v_and_b32 v65, 0xffff0000, v67
v_add_f32 v50, v50, v64
v_add_f32 v51, v51, v65
LE_fl21:
v_cvt_pk_bf16_f32 v64, v48, v49
v_cvt_pk_bf16_f32 v65, v50, v51
v_mov_b32 v48, 0
v_mov_b32 v49, 0
v_mov_b32 v50, 0
v_mov_b32 v51, 0
buffer_store_dwordx2 v[64:65], v39, s[20:23], s47 offen sc1
s_add_u32 s47, s47, 512
LE_nf21:
v_mfma_f32_16x16x32_bf16 v[48:51], a[176:179], v[40:43], v[48:51]
v_mfma_f32_16x16x32_bf16 v[48:51], a[180:183], v[44:47], v[48:51]
s_bitcmp1_b32 s46, 22
s_cbranch_scc0 LE_nf22
v_readlane_b32 s57, v80, s51
s_add_u32 s51, s51, 1
s_and_b32 s51, s51, 63
s_cbranch_scc1 LE_dg22
v_mov_b32 v80, v81
v_mov_b32 v81, v82
LE_dg22:
s_nop 3
v_mul_f32 v48, s57, v48
v_mul_f32 v49, s57, v49
v_mul_f32 v50, s57, v50
v_mul_f32 v51, s57, v51
s_cmp_eq_u32 s42, 0
s_cbranch_scc1 LE_fl22
buffer_load_dwordx2 v[66:67], v39, s[20:23], s47 offen sc1
s_waitcnt vmcnt(0)
v_lshlrev_b32 v64, 16, v66
v_and_b32 v65, 0xffff0000, v66
v_add_f32 v48, v48, v64
v_add_f32 v49, v49, v65
v_lshlrev_b32 v64, 16, v67
v_and_b32 v65, 0xffff0000, v67
v_add_f32 v50, v50, v64
v_add_f32 v51, v51, v65
LE_fl22:
v_cvt_pk_bf16_f32 v64, v48, v49
v_cvt_pk_bf16_f32 v65, v50, v51
v_mov_b32 v48, 0
v_mov_b32 v49, 0
v_mov_b32 v50, 0
v_mov_b32 v51, 0
buffer_store_dwordx2 v[64:65], v39, s[20:23], s47 offen sc1
s_add_u32 s47, s47, 512
LE_nf22:
v_mfma_f32_16x16x32_bf16 v[48:51], a[184:187], v[40:43], v[48:51]
v_mfma_f32_16x16x32_bf16 v[48:51], a[188:191], v[44:47], v[48:51]
s_bitcmp1_b32 s46, 23
s_cbranch_scc0 LE_nf23
v_readlane_b32 s57, v80, s51
s_add_u32 s51, s51, 1
s_and_b32 s51, s51, 63
s_cbranch_scc1 LE_dg23
v_mov_b32 v80, v81
v_mov_b32 v81, v82
LE_dg23:
s_nop 3
v_mul_f32 v48, s57, v48
v_mul_f32 v49, s57, v49
v_mul_f32 v50, s57, v50
v_mul_f32 v51, s57, v51
s_cmp_eq_u32 s42, 0
s_cbranch_scc1 LE_fl23
buffer_load_dwordx2 v[66:67], v39, s[20:23], s47 offen sc1
s_waitcnt vmcnt(0)
v_lshlrev_b32 v64, 16, v66
v_and_b32 v65, 0xffff0000, v66
v_add_f32 v48, v48, v64
v_add_f32 v49, v49, v65
v_lshlrev_b32 v64, 16, v67
v_and_b32 v65, 0xffff0000, v67
v_add_f32 v50, v50, v64
v_add_f32 v51, v51, v65
LE_fl23:
v_cvt_pk_bf16_f32 v64, v48, v49
v_cvt_pk_bf16_f32 v65, v50, v51
v_mov_b32 v48, 0
v_mov_b32 v49, 0
v_mov_b32 v50, 0
v_mov_b32 v51, 0
buffer_store_dwordx2 v[64:65], v39, s[20:23], s47 offen sc1
s_add_u32 s47, s47, 512
LE_nf23:
s_waitcnt lgkmcnt(0)
ds_read2_b32 v[52:53], v34 offset0:96 offset1:100
ds_read2_b32 v[54:55], v34 offset0:104 offset1:108
v_mad_u32_u16 v60, v56, s49, v2
v_mad_u32_u16 v61, v57, s49, v2
v_mad_u32_u16 v62, v58, s49, v2
v_mad_u32_u16 v63, v59, s49, v2
buffer_load_dwordx4 a[160:163], v60, s[16:19], 0 offen
buffer_load_dwordx4 a[164:167], v60, s[16:19], 0 offen offset:256
buffer_load_dwordx4 a[168:171], v61, s[16:19], 0 offen
buffer_load_dwordx4 a[172:175], v61, s[16:19], 0 offen offset:256
buffer_load_dwordx4 a[176:179], v62, s[16:19], 0 offen
buffer_load_dwordx4 a[180:183], v62, s[16:19], 0 offen offset:256
buffer_load_dwordx4 a[184:187], v63, s[16:19], 0 offen
buffer_load_dwordx4 a[188:191], v63, s[16:19], 0 offen offset:256
s_waitcnt vmcnt(56)
v_mfma_f32_16x16x32_bf16 v[48:51], a[192:195], v[40:43], v[48:51]
v_mfma_f32_16x16x32_bf16 v[48:51], a[196:199], v[44:47], v[48:51]
s_bitcmp1_b32 s46, 24
s_cbranch_scc0 LE_nf24
v_readlane_b32 s57, v80, s51
s_add_u32 s51, s51, 1
s_and_b32 s51, s51, 63
s_cbranch_scc1 LE_dg24
v_mov_b32 v80, v81
v_mov_b32 v81, v82
LE_dg24:
s_nop 3
v_mul_f32 v48, s57, v48
v_mul_f32 v49, s57, v49
v_mul_f32 v50, s57, v50
v_mul_f32 v51, s57, v51
s_cmp_eq_u32 s42, 0
s_cbranch_scc1 LE_fl24
buffer_load_dwordx2 v[66:67], v39, s[20:23], s47 offen sc1
s_waitcnt vmcnt(0)
v_lshlrev_b32 v64, 16, v66
v_and_b32 v65, 0xffff0000, v66
v_add_f32 v48, v48, v64
v_add_f32 v49, v49, v65
v_lshlrev_b32 v64, 16, v67
v_and_b32 v65, 0xffff0000, v67
v_add_f32 v50, v50, v64
v_add_f32 v51, v51, v65
LE_fl24:
v_cvt_pk_bf16_f32 v64, v48, v49
v_cvt_pk_bf16_f32 v65, v50, v51
v_mov_b32 v48, 0
v_mov_b32 v49, 0
v_mov_b32 v50, 0
v_mov_b32 v51, 0
buffer_store_dwordx2 v[64:65], v39, s[20:23], s47 offen sc1
s_add_u32 s47, s47, 512
LE_nf24:
v_mfma_f32_16x16x32_bf16 v[48:51], a[200:203], v[40:43], v[48:51]
v_mfma_f32_16x16x32_bf16 v[48:51], a[204:207], v[44:47], v[48:51]
s_bitcmp1_b32 s46, 25
s_cbranch_scc0 LE_nf25
v_readlane_b32 s57, v80, s51
s_add_u32 s51, s51, 1
s_and_b32 s51, s51, 63
s_cbranch_scc1 LE_dg25
v_mov_b32 v80, v81
v_mov_b32 v81, v82
LE_dg25:
s_nop 3
v_mul_f32 v48, s57, v48
v_mul_f32 v49, s57, v49
v_mul_f32 v50, s57, v50
v_mul_f32 v51, s57, v51
s_cmp_eq_u32 s42, 0
s_cbranch_scc1 LE_fl25
buffer_load_dwordx2 v[66:67], v39, s[20:23], s47 offen sc1
s_waitcnt vmcnt(0)
v_lshlrev_b32 v64, 16, v66
v_and_b32 v65, 0xffff0000, v66
v_add_f32 v48, v48, v64
v_add_f32 v49, v49, v65
v_lshlrev_b32 v64, 16, v67
v_and_b32 v65, 0xffff0000, v67
v_add_f32 v50, v50, v64
v_add_f32 v51, v51, v65
LE_fl25:
v_cvt_pk_bf16_f32 v64, v48, v49
v_cvt_pk_bf16_f32 v65, v50, v51
v_mov_b32 v48, 0
v_mov_b32 v49, 0
v_mov_b32 v50, 0
v_mov_b32 v51, 0
buffer_store_dwordx2 v[64:65], v39, s[20:23], s47 offen sc1
s_add_u32 s47, s47, 512
LE_nf25:
v_mfma_f32_16x16x32_bf16 v[48:51], a[208:211], v[40:43], v[48:51]
v_mfma_f32_16x16x32_bf16 v[48:51], a[212:215], v[44:47], v[48:51]
s_bitcmp1_b32 s46, 26
s_cbranch_scc0 LE_nf26
v_readlane_b32 s57, v80, s51
s_add_u32 s51, s51, 1
s_and_b32 s51, s51, 63
s_cbranch_scc1 LE_dg26
v_mov_b32 v80, v81
v_mov_b32 v81, v82
LE_dg26:
s_nop 3
v_mul_f32 v48, s57, v48
v_mul_f32 v49, s57, v49
v_mul_f32 v50, s57, v50
v_mul_f32 v51, s57, v51
s_cmp_eq_u32 s42, 0
s_cbranch_scc1 LE_fl26
buffer_load_dwordx2 v[66:67], v39, s[20:23], s47 offen sc1
s_waitcnt vmcnt(0)
v_lshlrev_b32 v64, 16, v66
v_and_b32 v65, 0xffff0000, v66
v_add_f32 v48, v48, v64
v_add_f32 v49, v49, v65
v_lshlrev_b32 v64, 16, v67
v_and_b32 v65, 0xffff0000, v67
v_add_f32 v50, v50, v64
v_add_f32 v51, v51, v65
LE_fl26:
v_cvt_pk_bf16_f32 v64, v48, v49
v_cvt_pk_bf16_f32 v65, v50, v51
v_mov_b32 v48, 0
v_mov_b32 v49, 0
v_mov_b32 v50, 0
v_mov_b32 v51, 0
buffer_store_dwordx2 v[64:65], v39, s[20:23], s47 offen sc1
s_add_u32 s47, s47, 512
LE_nf26:
v_mfma_f32_16x16x32_bf16 v[48:51], a[216:219], v[40:43], v[48:51]
v_mfma_f32_16x16x32_bf16 v[48:51], a[220:223], v[44:47], v[48:51]
s_bitcmp1_b32 s46, 27
s_cbranch_scc0 LE_nf27
v_readlane_b32 s57, v80, s51
s_add_u32 s51, s51, 1
s_and_b32 s51, s51, 63
s_cbranch_scc1 LE_dg27
v_mov_b32 v80, v81
v_mov_b32 v81, v82
LE_dg27:
s_nop 3
v_mul_f32 v48, s57, v48
v_mul_f32 v49, s57, v49
v_mul_f32 v50, s57, v50
v_mul_f32 v51, s57, v51
s_cmp_eq_u32 s42, 0
s_cbranch_scc1 LE_fl27
buffer_load_dwordx2 v[66:67], v39, s[20:23], s47 offen sc1
s_waitcnt vmcnt(0)
v_lshlrev_b32 v64, 16, v66
v_and_b32 v65, 0xffff0000, v66
v_add_f32 v48, v48, v64
v_add_f32 v49, v49, v65
v_lshlrev_b32 v64, 16, v67
v_and_b32 v65, 0xffff0000, v67
v_add_f32 v50, v50, v64
v_add_f32 v51, v51, v65
LE_fl27:
v_cvt_pk_bf16_f32 v64, v48, v49
v_cvt_pk_bf16_f32 v65, v50, v51
v_mov_b32 v48, 0
v_mov_b32 v49, 0
v_mov_b32 v50, 0
v_mov_b32 v51, 0
buffer_store_dwordx2 v[64:65], v39, s[20:23], s47 offen sc1
s_add_u32 s47, s47, 512
LE_nf27:
s_waitcnt lgkmcnt(0)
ds_read2_b32 v[56:57], v34 offset0:112 offset1:116
ds_read2_b32 v[58:59], v34 offset0:120 offset1:124
v_mad_u32_u16 v60, v52, s49, v2
v_mad_u32_u16 v61, v53, s49, v2
v_mad_u32_u16 v62, v54, s49, v2
v_mad_u32_u16 v63, v55, s49, v2
buffer_load_dwordx4 a[192:195], v60, s[16:19], 0 offen
buffer_load_dwordx4 a[196:199], v60, s[16:19], 0 offen offset:256
buffer_load_dwordx4 a[200:203], v61, s[16:19], 0 offen
buffer_load_dwordx4 a[204:207], v61, s[16:19], 0 offen offset:256
buffer_load_dwordx4 a[208:211], v62, s[16:19], 0 offen
buffer_load_dwordx4 a[212:215], v62, s[16:19], 0 offen offset:256
buffer_load_dwordx4 a[216:219], v63, s[16:19], 0 offen
buffer_load_dwordx4 a[220:223], v63, s[16:19], 0 offen offset:256
s_waitcnt vmcnt(56)
v_mfma_f32_16x16x32_bf16 v[48:51], a[224:227], v[40:43], v[48:51]
v_mfma_f32_16x16x32_bf16 v[48:51], a[228:231], v[44:47], v[48:51]
s_bitcmp1_b32 s46, 28
s_cbranch_scc0 LE_nf28
v_readlane_b32 s57, v80, s51
s_add_u32 s51, s51, 1
s_and_b32 s51, s51, 63
s_cbranch_scc1 LE_dg28
v_mov_b32 v80, v81
v_mov_b32 v81, v82
LE_dg28:
s_nop 3
v_mul_f32 v48, s57, v48
v_mul_f32 v49, s57, v49
v_mul_f32 v50, s57, v50
v_mul_f32 v51, s57, v51
s_cmp_eq_u32 s42, 0
s_cbranch_scc1 LE_fl28
buffer_load_dwordx2 v[66:67], v39, s[20:23], s47 offen sc1
s_waitcnt vmcnt(0)
v_lshlrev_b32 v64, 16, v66
v_and_b32 v65, 0xffff0000, v66
v_add_f32 v48, v48, v64
v_add_f32 v49, v49, v65
v_lshlrev_b32 v64, 16, v67
v_and_b32 v65, 0xffff0000, v67
v_add_f32 v50, v50, v64
v_add_f32 v51, v51, v65
LE_fl28:
v_cvt_pk_bf16_f32 v64, v48, v49
v_cvt_pk_bf16_f32 v65, v50, v51
v_mov_b32 v48, 0
v_mov_b32 v49, 0
v_mov_b32 v50, 0
v_mov_b32 v51, 0
buffer_store_dwordx2 v[64:65], v39, s[20:23], s47 offen sc1
s_add_u32 s47, s47, 512
LE_nf28:
v_mfma_f32_16x16x32_bf16 v[48:51], a[232:235], v[40:43], v[48:51]
v_mfma_f32_16x16x32_bf16 v[48:51], a[236:239], v[44:47], v[48:51]
s_bitcmp1_b32 s46, 29
s_cbranch_scc0 LE_nf29
v_readlane_b32 s57, v80, s51
s_add_u32 s51, s51, 1
s_and_b32 s51, s51, 63
s_cbranch_scc1 LE_dg29
v_mov_b32 v80, v81
v_mov_b32 v81, v82
LE_dg29:
s_nop 3
v_mul_f32 v48, s57, v48
v_mul_f32 v49, s57, v49
v_mul_f32 v50, s57, v50
v_mul_f32 v51, s57, v51
s_cmp_eq_u32 s42, 0
s_cbranch_scc1 LE_fl29
buffer_load_dwordx2 v[66:67], v39, s[20:23], s47 offen sc1
s_waitcnt vmcnt(0)
v_lshlrev_b32 v64, 16, v66
v_and_b32 v65, 0xffff0000, v66
v_add_f32 v48, v48, v64
v_add_f32 v49, v49, v65
v_lshlrev_b32 v64, 16, v67
v_and_b32 v65, 0xffff0000, v67
v_add_f32 v50, v50, v64
v_add_f32 v51, v51, v65
LE_fl29:
v_cvt_pk_bf16_f32 v64, v48, v49
v_cvt_pk_bf16_f32 v65, v50, v51
v_mov_b32 v48, 0
v_mov_b32 v49, 0
v_mov_b32 v50, 0
v_mov_b32 v51, 0
buffer_store_dwordx2 v[64:65], v39, s[20:23], s47 offen sc1
s_add_u32 s47, s47, 512
LE_nf29:
v_mfma_f32_16x16x32_bf16 v[48:51], a[240:243], v[40:43], v[48:51]
v_mfma_f32_16x16x32_bf16 v[48:51], a[244:247], v[44:47], v[48:51]
s_bitcmp1_b32 s46, 30
s_cbranch_scc0 LE_nf30
v_readlane_b32 s57, v80, s51
s_add_u32 s51, s51, 1
s_and_b32 s51, s51, 63
s_cbranch_scc1 LE_dg30
v_mov_b32 v80, v81
v_mov_b32 v81, v82
LE_dg30:
s_nop 3
v_mul_f32 v48, s57, v48
v_mul_f32 v49, s57, v49
v_mul_f32 v50, s57, v50
v_mul_f32 v51, s57, v51
s_cmp_eq_u32 s42, 0
s_cbranch_scc1 LE_fl30
buffer_load_dwordx2 v[66:67], v39, s[20:23], s47 offen sc1
s_waitcnt vmcnt(0)
v_lshlrev_b32 v64, 16, v66
v_and_b32 v65, 0xffff0000, v66
v_add_f32 v48, v48, v64
v_add_f32 v49, v49, v65
v_lshlrev_b32 v64, 16, v67
v_and_b32 v65, 0xffff0000, v67
v_add_f32 v50, v50, v64
v_add_f32 v51, v51, v65
LE_fl30:
v_cvt_pk_bf16_f32 v64, v48, v49
v_cvt_pk_bf16_f32 v65, v50, v51
v_mov_b32 v48, 0
v_mov_b32 v49, 0
v_mov_b32 v50, 0
v_mov_b32 v51, 0
buffer_store_dwordx2 v[64:65], v39, s[20:23], s47 offen sc1
s_add_u32 s47, s47, 512
LE_nf30:
v_mfma_f32_16x16x32_bf16 v[48:51], a[248:251], v[40:43], v[48:51]
v_mfma_f32_16x16x32_bf16 v[48:51], a[252:255], v[44:47], v[48:51]
s_bitcmp1_b32 s46, 31
s_cbranch_scc0 LE_nf31
v_readlane_b32 s57, v80, s51
s_add_u32 s51, s51, 1
s_and_b32 s51, s51, 63
s_cbranch_scc1 LE_dg31
v_mov_b32 v80, v81
v_mov_b32 v81, v82
LE_dg31:
s_nop 3
v_mul_f32 v48, s57, v48
v_mul_f32 v49, s57, v49
v_mul_f32 v50, s57, v50
v_mul_f32 v51, s57, v51
s_cmp_eq_u32 s42, 0
s_cbranch_scc1 LE_fl31
buffer_load_dwordx2 v[66:67], v39, s[20:23], s47 offen sc1
s_waitcnt vmcnt(0)
v_lshlrev_b32 v64, 16, v66
v_and_b32 v65, 0xffff0000, v66
v_add_f32 v48, v48, v64
v_add_f32 v49, v49, v65
v_lshlrev_b32 v64, 16, v67
v_and_b32 v65, 0xffff0000, v67
v_add_f32 v50, v50, v64
v_add_f32 v51, v51, v65
LE_fl31:
v_cvt_pk_bf16_f32 v64, v48, v49
v_cvt_pk_bf16_f32 v65, v50, v51
v_mov_b32 v48, 0
v_mov_b32 v49, 0
v_mov_b32 v50, 0
v_mov_b32 v51, 0
buffer_store_dwordx2 v[64:65], v39, s[20:23], s47 offen sc1
s_add_u32 s47, s47, 512
LE_nf31:
s_waitcnt lgkmcnt(0)
ds_read2_b32 v[52:53], v34 offset0:128 offset1:132
ds_read2_b32 v[54:55], v34 offset0:136 offset1:140
v_mad_u32_u16 v60, v56, s49, v2
v_mad_u32_u16 v61, v57, s49, v2
v_mad_u32_u16 v62, v58, s49, v2
v_mad_u32_u16 v63, v59, s49, v2
buffer_load_dwordx4 a[224:227], v60, s[16:19], 0 offen
buffer_load_dwordx4 a[228:231], v60, s[16:19], 0 offen offset:256
buffer_load_dwordx4 a[232:235], v61, s[16:19], 0 offen
buffer_load_dwordx4 a[236:239], v61, s[16:19], 0 offen offset:256
buffer_load_dwordx4 a[240:243], v62, s[16:19], 0 offen
buffer_load_dwordx4 a[244:247], v62, s[16:19], 0 offen offset:256
buffer_load_dwordx4 a[248:251], v63, s[16:19], 0 offen
buffer_load_dwordx4 a[252:255], v63, s[16:19], 0 offen offset:256
v_add_u32 v34, 512, v34
s_cmp_lt_u32 s45, s44
s_cbranch_scc1 LE_loop
s_add_u32 s42, s42, 1
s_mul_i32 s43, s42, 128
v_cmp_lt_u32 vcc, s43, v4
s_cbranch_vccz LE_done
s_cmp_ge_u32 s42, 40
s_cbranch_scc1 LE_done
s_waitcnt vmcnt(0) lgkmcnt(0)
s_add_u32 s50, s50, 512
v_add_u32 v5, 0x80, v5
buffer_load_dwordx4 v[192:195], v6, s[12:15], s50 offen offset:0
buffer_load_dwordx4 v[196:199], v6, s[12:15], s50 offen offset:32
buffer_load_dwordx4 v[200:203], v6, s[12:15], s50 offen offset:64
buffer_load_dwordx4 v[204:207], v6, s[12:15], s50 offen offset:96
buffer_load_dwordx4 v[208:211], v6, s[12:15], s50 offen offset:128
buffer_load_dwordx4 v[212:215], v6, s[12:15], s50 offen offset:160
buffer_load_dwordx4 v[216:219], v6, s[12:15], s50 offen offset:192
buffer_load_dwordx4 v[220:223], v6, s[12:15], s50 offen offset:224
buffer_load_dwordx4 v[224:227], v6, s[12:15], s50 offen offset:256
buffer_load_dwordx4 v[228:231], v6, s[12:15], s50 offen offset:288
buffer_load_dwordx4 v[232:235], v6, s[12:15], s50 offen offset:320
buffer_load_dwordx4 v[236:239], v6, s[12:15], s50 offen offset:352
buffer_load_dwordx4 v[240:243], v6, s[12:15], s50 offen offset:384
buffer_load_dwordx4 v[244:247], v6, s[12:15], s50 offen offset:416
buffer_load_dwordx4 v[248:251], v6, s[12:15], s50 offen offset:448
buffer_load_dwordx4 v[252:255], v6, s[12:15], s50 offen offset:480
s_branch LE_pass
LE_done:
s_add_u32 s52, s4, 0x7c00000
s_addc_u32 s53, s5, 0
s_mov_b32 s54, 0x2000
s_mov_b32 s55, 0x00020000
v_mov_b32 v20, 5120
v_mov_b32 v21, 1
s_mov_b64 exec, 1
s_waitcnt vmcnt(0)
buffer_atomic_add v21, v20, s[52:55], 0 offen
s_mov_b64 exec, -1
s_getpc_b64 s[52:53]
LE_pc:
s_sub_u32 s52, s52, LE_pc-L2_tails
s_subb_u32 s53, s53, 0
s_mov_b32 s54, LT_disp-L2_tails
s_mov_b32 s55, 0x00020000
s_mov_b64 exec, -1
v_lshlrev_b32 v30, 7, v1
s_mov_b32 s56, 0x0
buffer_load_dword v32, v30, s[52:55], s56 offen
s_mov_b32 s56, 0x2000
buffer_load_dword v33, v30, s[52:55], s56 offen
s_mov_b32 s56, 0x4000
buffer_load_dword v34, v30, s[52:55], s56 offen
s_mov_b32 s56, 0x6000
buffer_load_dword v35, v30, s[52:55], s56 offen
s_mov_b32 s56, 0x8000
buffer_load_dword v36, v30, s[52:55], s56 offen
s_mov_b32 s56, 0xa000
buffer_load_dword v37, v30, s[52:55], s56 offen
s_mov_b32 s56, 0xc000
buffer_load_dword v38, v30, s[52:55], s56 offen
s_cmp_ge_u32 s2, 240
s_cbranch_scc1 LC_help
s_branch L2_end
LC_help:
s_waitcnt vmcnt(0)
s_mov_b32 s100, 0
s_load_dwordx2 s[6:7], s[0:1], 0
s_load_dwordx2 s[18:19], s[0:1], 72
s_mov_b32 s34, s41
v_mbcnt_lo_u32_b32 v252, -1, 0
v_mbcnt_hi_u32_b32 v252, -1, v252
v_lshlrev_b32 v252, 4, v252
s_and_b32 s32, s2, 7
s_mul_i32 s32, s32, 5
s_bfe_u32 s33, s2, 0x10003
s_mul_i32 s35, s33, 3
s_add_u32 s32, s32, s35
s_add_u32 s35, s32, 0
s_lshl_b32 s48, s35, 7
s_lshl_b32 s52, s35, 17
s_add_u32 s52, s52, 122880
s_add_u32 s35, s32, 1
s_lshl_b32 s49, s35, 7
s_lshl_b32 s53, s35, 17
s_add_u32 s53, s53, 122880
s_add_u32 s35, s32, 2
s_lshl_b32 s50, s35, 7
s_lshl_b32 s54, s35, 17
s_add_u32 s54, s54, 122880
s_cmp_eq_u32 s49, 4992
s_cselect_b32 s53, 5111808, s53
s_cmp_eq_u32 s33, 1
s_cselect_b32 s54, 0x7fff0000, s54
s_cselect_b32 s50, s48, s50
s_mov_b32 s15, 0x7fff0000
s_mov_b32 s14, 0
s_mov_b32 s99, 0
s_mov_b32 s51, 0
s_mov_b32 s98, 2
s_waitcnt lgkmcnt(0)
s_add_u32 s24, s4, 0x6000000
s_addc_u32 s25, s5, 0
s_mov_b32 s26, 0x9c800
s_mov_b32 s27, 0x00020000
s_add_u32 s56, s4, 0x1000000
s_addc_u32 s57, s5, 0
s_mov_b32 s58, 0x6c02000
s_mov_b32 s59, 0x00020000
s_branch LC_common
L2_fin:
L2_end:
s_endpgm
.section .rodata,"a"
.p2align 6
.amdhsa_kernel k1_kernel
  .amdhsa_next_free_vgpr 256
  .amdhsa_next_free_sgpr 102
  .amdhsa_accum_offset 256
  .amdhsa_group_segment_fixed_size 0
  .amdhsa_kernarg_size 96
  .amdhsa_user_sgpr_count 2
  .amdhsa_user_sgpr_kernarg_segment_ptr 1
  .amdhsa_system_sgpr_workgroup_id_x 1
.end_amdhsa_kernel
.p2align 6
.amdhsa_kernel k2_kernel
  .amdhsa_next_free_vgpr 512
  .amdhsa_next_free_sgpr 102
  .amdhsa_accum_offset 256
  .amdhsa_group_segment_fixed_size 0
  .amdhsa_kernarg_size 96
  .amdhsa_user_sgpr_count 2
  .amdhsa_user_sgpr_kernarg_segment_ptr 1
  .amdhsa_system_sgpr_workgroup_id_x 1
.end_amdhsa_kernel
```

```asm
; @launch kernel=k1_kernel grid=(249,1,1) block=(512,1,1) lds=163840
; @launch kernel=k2_kernel grid=(256,1,1) block=(256,1,1) lds=163840
.amdgcn_target "amdgcn-amd-amdhsa--gfx950"
.text
.globl k1_kernel
.p2align 8
.type k1_kernel,@function
k1_kernel:
s_getpc_b64 s[56:57]
s_load_dwordx16 s[16:31], s[0:1], 0
s_load_dwordx8 s[32:39], s[0:1], 64
s_cmp_ge_u32 s2, 249
s_cbranch_scc1 L1_end
v_lshrrev_b32 v1, 6, v0
v_and_b32 v2, 63, v0
s_lshr_b32 s3, s2, 3
v_readfirstlane_b32 s60, v1
s_mul_i32 s5, s3, 8
s_add_u32 s5, s5, s60
s_and_b32 s56, s56, 0xffffff00
s_mov_b32 s58, L2_end-k1_kernel
s_mov_b32 s59, 0x00020000
s_and_b32 s6, s5, 15
s_lshl_b32 s6, s6, 13
v_lshlrev_b32 v10, 7, v2
buffer_load_dword v255, v10, s[56:59], s6 offen
v_and_b32 v3, 15, v2
v_lshrrev_b32 v4, 4, v2
s_and_b32 s62, s3, 7
s_sub_u32 s4, s2, 40
s_cmp_lt_u32 s2, 40
s_cbranch_scc1 L1_notq
s_mov_b32 s61, 0
v_lshlrev_b32 v16, 4, v2
s_mul_i32 s63, s60, 6144
s_mul_i32 s6, s4, 24576
s_mul_i32 s7, s60, 3072
s_add_u32 s64, s6, s7
s_add_u32 s65, s64, 4096
s_lshl_b32 s7, s60, 6
v_lshrrev_b32 v5, 2, v2
v_and_b32 v6, 3, v2
v_lshrrev_b32 v7, 5, v2
v_lshlrev_b32 v7, 1, v7
v_xor_b32 v6, v6, v7
v_lshl_add_u32 v5, v5, 9, s7
v_lshl_add_u32 v17, v6, 4, v5
v_add_u32 v18, 0x1c00, v17
s_xor_b32 s6, s62, 0
s_lshl_b32 s66, s6, 14
s_xor_b32 s6, s62, 1
s_lshl_b32 s67, s6, 14
s_xor_b32 s6, s62, 2
s_lshl_b32 s68, s6, 14
s_xor_b32 s6, s62, 3
s_lshl_b32 s69, s6, 14
s_xor_b32 s6, s62, 4
s_lshl_b32 s70, s6, 14
s_xor_b32 s6, s62, 5
s_lshl_b32 s71, s6, 14
s_xor_b32 s6, s62, 6
s_lshl_b32 s72, s6, 14
s_xor_b32 s6, s62, 7
s_lshl_b32 s73, s6, 14
s_waitcnt lgkmcnt(0)
s_add_u32 s40, s16, 0x0
s_addc_u32 s41, s17, 0
s_mov_b32 s42, 0x4e2000
s_mov_b32 s43, 0x00020000
s_add_u32 s44, s26, 0x0
s_addc_u32 s45, s27, 0
s_mov_b32 s46, 0x20000
s_mov_b32 s47, 0x00020000
buffer_load_dwordx4 v[40:43], v16, s[40:43], s64 offen offset:0
buffer_load_dwordx4 v[44:47], v16, s[40:43], s64 offen offset:1024
buffer_load_dwordx4 v[48:51], v16, s[40:43], s64 offen offset:2048
s_add_u32 m0, s63, 0x0
s_nop 0
buffer_load_dwordx4 v17, s[44:47], s66 offen offset:0 lds
buffer_load_dwordx4 v18, s[44:47], s66 offen offset:1024 lds
s_add_u32 m0, s63, 0x800
s_nop 0
buffer_load_dwordx4 v17, s[44:47], s67 offen offset:0 lds
buffer_load_dwordx4 v18, s[44:47], s67 offen offset:1024 lds
v_bfe_u32 v5, v2, 2, 3
v_xor_b32 v5, s62, v5
v_and_b32 v6, 3, v2
v_lshlrev_b32 v7, 10, v5
v_lshl_add_u32 v7, v6, 8, v7
v_add_u32 v7, 0xc000, v7
v_and_b32 v5, 1, v5
v_lshl_or_b32 v6, v5, 2, v6
v_lshrrev_b32 v5, 5, v2
s_mul_i32 s6, s60, 6
v_add3_u32 v8, v5, s6, 0
v_lshrrev_b32 v9, 4, v8
v_lshl_add_u32 v9, v9, 13, v7
v_and_b32 v8, 15, v8
v_xor_b32 v8, v8, v6
v_lshl_add_u32 v36, v8, 4, v9
v_add3_u32 v8, v5, s6, 2
v_lshrrev_b32 v9, 4, v8
v_lshl_add_u32 v9, v9, 13, v7
v_and_b32 v8, 15, v8
v_xor_b32 v8, v8, v6
v_lshl_add_u32 v37, v8, 4, v9
v_add3_u32 v8, v5, s6, 4
v_lshrrev_b32 v9, 4, v8
v_lshl_add_u32 v9, v9, 13, v7
v_and_b32 v8, 15, v8
v_xor_b32 v8, v8, v6
v_lshl_add_u32 v38, v8, 4, v9
v_xor_b32 v5, v3, v4
v_lshlrev_b32 v5, 4, v5
v_lshl_add_u32 v5, v4, 8, v5
v_add_u32 v31, 0xc000, v5
v_xor_b32 v32, 64, v31
v_lshrrev_b32 v5, 2, v3
v_and_b32 v6, 3, v3
v_and_b32 v7, 1, v4
v_lshlrev_b32 v7, 1, v7
v_lshl_add_u32 v8, v4, 3, v5
v_lshlrev_b32 v8, 6, v8
v_add_u32 v8, s63, v8
v_and_b32 v9, 1, v6
v_lshl_add_u32 v8, v9, 3, v8
v_lshrrev_b32 v6, 1, v6
v_xor_b32 v6, v6, v7
v_xor_b32 v9, 0, v6
v_lshl_add_u32 v25, v9, 4, v8
v_xor_b32 v9, 2, v6
v_lshl_add_u32 v26, v9, 4, v8
v_lshrrev_b32 v5, 3, v2
v_and_b32 v6, 7, v2
v_lshrrev_b32 v7, 1, v5
v_xor_b32 v6, v6, v7
v_and_b32 v7, 4, v5
v_add_u32 v5, v5, v7
s_mul_i32 s6, s60, 16384
v_lshl_add_u32 v5, v5, 9, s6
v_lshl_add_u32 v21, v6, 4, v5
v_xor_b32 v6, 4, v6
v_lshl_add_u32 v22, v6, 4, v5
v_add_u32 v22, 0x1c00, v22
s_lshr_b32 s7, s62, 1
s_xor_b32 s6, s7, 0
s_lshl_b32 s74, s6, 7
s_add_u32 s75, s74, 2048
s_xor_b32 s6, s7, 1
s_lshl_b32 s76, s6, 7
s_add_u32 s77, s76, 2048
s_xor_b32 s6, s7, 2
s_lshl_b32 s78, s6, 7
s_add_u32 s79, s78, 2048
s_xor_b32 s6, s7, 3
s_lshl_b32 s80, s6, 7
s_add_u32 s81, s80, 2048
s_and_b32 s6, s62, 1
s_lshl_b32 s6, s6, 2
v_lshrrev_b32 v5, 1, v3
v_xor_b32 v5, v5, v4
v_xor_b32 v5, s6, v5
v_lshl_add_u32 v6, v3, 7, s63
v_lshl_add_u32 v29, v5, 4, v6
v_xor_b32 v30, 64, v29
s_mul_i32 s6, s60, 1
s_xor_b32 s6, s6, s62
s_lshl_b32 s6, s6, 10
s_add_u32 s6, s6, 0x12000
v_lshrrev_b32 v5, 1, v4
v_and_b32 v6, 1, v4
v_lshl_add_u32 v5, v5, 8, s6
v_lshl_add_u32 v5, v6, 3, v5
v_lshl_add_u32 v33, v3, 4, v5
v_xor_b32 v34, 0x400, v33
v_add_u32 v35, 0x12000, v16
s_mul_i32 s6, s4, 24576
s_mul_i32 s7, s60, 1024
s_add_u32 s82, s6, s7
s_add_u32 s83, s82, 8192
s_add_u32 s84, s82, 16384
s_mov_b32 s86, 0x3db8aa3b
s_mov_b32 s87, 0x3db8aa3b
s_mov_b32 s88, 0x3727c5ac
s_mov_b32 s89, 0x3b800000
s_mov_b32 s90, 0xffff0000
s_add_u32 s48, s28, 0x0
s_addc_u32 s49, s29, 0
s_mov_b32 s50, 0x20000
s_mov_b32 s51, 0x00020000
s_add_u32 s52, s38, 0x0
s_addc_u32 s53, s39, 0
s_mov_b32 s54, 0x4e4000
s_mov_b32 s55, 0x00020000
s_add_u32 s56, s38, 0x6800000
s_addc_u32 s57, s39, 0
s_mov_b32 s58, 0x4e4000
s_mov_b32 s59, 0x00020000
v_lshlrev_b32 v11, 4, v4
s_lshr_b32 s8, s66, 8
buffer_load_dwordx4 v[172:175], v11, s[48:51], s8 offen
s_lshr_b32 s8, s67, 8
buffer_load_dwordx4 v[176:179], v11, s[48:51], s8 offen
s_lshr_b32 s8, s68, 8
buffer_load_dwordx4 v[180:183], v11, s[48:51], s8 offen
s_lshr_b32 s8, s69, 8
buffer_load_dwordx4 v[184:187], v11, s[48:51], s8 offen
s_lshr_b32 s8, s70, 8
buffer_load_dwordx4 v[188:191], v11, s[48:51], s8 offen
s_lshr_b32 s8, s71, 8
buffer_load_dwordx4 v[192:195], v11, s[48:51], s8 offen
s_lshr_b32 s8, s72, 8
buffer_load_dwordx4 v[196:199], v11, s[48:51], s8 offen
s_lshr_b32 s8, s73, 8
buffer_load_dwordx4 v[200:203], v11, s[48:51], s8 offen
s_waitcnt vmcnt(14)
v_lshlrev_b32 v76, 16, v40
v_and_b32 v77, s90, v40
v_lshlrev_b32 v78, 16, v41
v_and_b32 v79, s90, v41
v_lshlrev_b32 v80, 16, v42
v_and_b32 v81, s90, v42
v_lshlrev_b32 v82, 16, v43
v_and_b32 v83, s90, v43
v_pk_add_f32 v[100:101], v[76:77], v[78:79]
v_pk_mul_f32 v[102:103], v[76:77], v[76:77]
v_pk_add_f32 v[40:41], v[80:81], v[82:83]
v_pk_fma_f32 v[102:103], v[78:79], v[78:79], v[102:103]
v_pk_add_f32 v[100:101], v[100:101], v[40:41]
v_pk_fma_f32 v[102:103], v[80:81], v[80:81], v[102:103]
v_add_f32 v100, v100, v101
v_pk_fma_f32 v[102:103], v[82:83], v[82:83], v[102:103]
v_add_f32 v102, v102, v103
s_waitcnt vmcnt(13)
v_lshlrev_b32 v84, 16, v44
v_and_b32 v85, s90, v44
v_lshlrev_b32 v86, 16, v45
v_and_b32 v87, s90, v45
v_lshlrev_b32 v88, 16, v46
v_and_b32 v89, s90, v46
v_lshlrev_b32 v90, 16, v47
v_and_b32 v91, s90, v47
v_pk_add_f32 v[104:105], v[84:85], v[86:87]
v_pk_mul_f32 v[106:107], v[84:85], v[84:85]
v_pk_add_f32 v[44:45], v[88:89], v[90:91]
v_pk_fma_f32 v[106:107], v[86:87], v[86:87], v[106:107]
v_pk_add_f32 v[104:105], v[104:105], v[44:45]
v_pk_fma_f32 v[106:107], v[88:89], v[88:89], v[106:107]
v_add_f32 v104, v104, v105
v_pk_fma_f32 v[106:107], v[90:91], v[90:91], v[106:107]
v_add_f32 v106, v106, v107
s_waitcnt vmcnt(12)
v_lshlrev_b32 v92, 16, v48
v_and_b32 v93, s90, v48
v_lshlrev_b32 v94, 16, v49
v_and_b32 v95, s90, v49
v_lshlrev_b32 v96, 16, v50
v_and_b32 v97, s90, v50
v_lshlrev_b32 v98, 16, v51
v_and_b32 v99, s90, v51
v_pk_add_f32 v[108:109], v[92:93], v[94:95]
v_pk_mul_f32 v[110:111], v[92:93], v[92:93]
v_pk_add_f32 v[48:49], v[96:97], v[98:99]
v_pk_fma_f32 v[110:111], v[94:95], v[94:95], v[110:111]
v_pk_add_f32 v[108:109], v[108:109], v[48:49]
v_pk_fma_f32 v[110:111], v[96:97], v[96:97], v[110:111]
v_add_f32 v108, v108, v109
v_pk_fma_f32 v[110:111], v[98:99], v[98:99], v[110:111]
v_add_f32 v110, v110, v111
v_permlane16_swap_b32 v100, v102
v_permlane16_swap_b32 v104, v106
v_permlane16_swap_b32 v108, v110
v_add_f32 v100, v100, v102
v_add_f32 v104, v104, v106
v_add_f32 v108, v108, v110
v_add_f32_dpp v101, v100, v100 row_ror:8 row_mask:0xf bank_mask:0x3
v_add_f32_dpp v101, v104, v104 row_ror:8 row_mask:0xf bank_mask:0xc
v_add_f32_dpp v109, v108, v108 row_ror:8 row_mask:0xf bank_mask:0xf
s_nop 0
v_add_f32_dpp v102, v101, v101 row_half_mirror row_mask:0xf bank_mask:0x5
v_add_f32_dpp v102, v109, v109 row_half_mirror row_mask:0xf bank_mask:0xa
s_nop 1
v_add_f32_dpp v102, v102, v102 quad_perm:[1,0,3,2] row_mask:0xf bank_mask:0xf
s_nop 1
v_add_f32_dpp v102, v102, v102 quad_perm:[2,3,0,1] row_mask:0xf bank_mask:0xf
v_mov_b32 v103, v102
s_nop 1
v_permlane16_swap_b32 v103, v102
v_mul_f32 v103, s89, v103
v_mul_f32 v102, s89, v102
v_fma_f32 v102, -v103, v103, v102
v_max_f32 v102, 0, v102
v_cvt_pk_bf16_f32 v102, v102, v102
v_and_b32 v102, s90, v102
v_add_f32 v102, s88, v102
v_cvt_pk_bf16_f32 v102, v102, v102
v_and_b32 v102, s90, v102
v_sqrt_f32 v102, v102
s_nop 0
v_cvt_pk_bf16_f32 v102, v102, v102
v_and_b32 v102, s90, v102
v_rcp_f32 v102, v102
s_nop 0
v_mul_f32 v103, -v103, v102
s_nop 1
v_mov_b64_dpp v[100:101], v[102:103] row_newbcast:0 row_mask:0xf bank_mask:0xf
v_mov_b64_dpp v[104:105], v[102:103] row_newbcast:8 row_mask:0xf bank_mask:0xf
v_mov_b64_dpp v[108:109], v[102:103] row_newbcast:4 row_mask:0xf bank_mask:0xf
v_fma_f32 v76, v76, v100, v101
v_fma_f32 v77, v77, v100, v101
v_fma_f32 v78, v78, v100, v101
v_fma_f32 v79, v79, v100, v101
v_fma_f32 v80, v80, v100, v101
v_fma_f32 v81, v81, v100, v101
v_fma_f32 v82, v82, v100, v101
v_fma_f32 v83, v83, v100, v101
v_cvt_pk_bf16_f32 v40, v76, v77
v_cvt_pk_bf16_f32 v41, v78, v79
v_cvt_pk_bf16_f32 v42, v80, v81
v_cvt_pk_bf16_f32 v43, v82, v83
ds_write_b128 v36, v[40:43]
v_fma_f32 v84, v84, v104, v105
v_fma_f32 v85, v85, v104, v105
v_fma_f32 v86, v86, v104, v105
v_fma_f32 v87, v87, v104, v105
v_fma_f32 v88, v88, v104, v105
v_fma_f32 v89, v89, v104, v105
v_fma_f32 v90, v90, v104, v105
v_fma_f32 v91, v91, v104, v105
v_cvt_pk_bf16_f32 v44, v84, v85
v_cvt_pk_bf16_f32 v45, v86, v87
v_cvt_pk_bf16_f32 v46, v88, v89
v_cvt_pk_bf16_f32 v47, v90, v91
ds_write_b128 v37, v[44:47]
v_fma_f32 v92, v92, v108, v109
v_fma_f32 v93, v93, v108, v109
v_fma_f32 v94, v94, v108, v109
v_fma_f32 v95, v95, v108, v109
v_fma_f32 v96, v96, v108, v109
v_fma_f32 v97, v97, v108, v109
v_fma_f32 v98, v98, v108, v109
v_fma_f32 v99, v99, v108, v109
v_cvt_pk_bf16_f32 v48, v92, v93
v_cvt_pk_bf16_f32 v49, v94, v95
v_cvt_pk_bf16_f32 v50, v96, v97
v_cvt_pk_bf16_f32 v51, v98, v99
ds_write_b128 v38, v[48:51]
s_add_u32 m0, s63, 0x1000
s_nop 0
buffer_load_dwordx4 v17, s[44:47], s68 offen offset:0 lds
buffer_load_dwordx4 v18, s[44:47], s68 offen offset:1024 lds
s_waitcnt vmcnt(12)
ds_read_b64_tr_b16 v[100:101], v25 offset:0
ds_read_b64_tr_b16 v[102:103], v25 offset:256
ds_read_b64_tr_b16 v[104:105], v26 offset:0
ds_read_b64_tr_b16 v[106:107], v26 offset:256
s_waitcnt lgkmcnt(4)
s_barrier
ds_read_b128 v[124:127], v31 offset:0
ds_read_b128 v[128:131], v31 offset:8192
ds_read_b128 v[132:135], v31 offset:16384
ds_read_b128 v[136:139], v32 offset:1024
s_waitcnt vmcnt(10)
ds_read_b64_tr_b16 v[108:109], v25 offset:2048
ds_read_b64_tr_b16 v[110:111], v25 offset:2304
s_waitcnt lgkmcnt(5)
v_mfma_f32_16x16x32_bf16 v[52:55], v[100:103], v[124:127], 0
ds_read_b128 v[140:143], v32 offset:9216
s_waitcnt lgkmcnt(5)
v_mfma_f32_16x16x32_bf16 v[56:59], v[100:103], v[128:131], 0
ds_read_b128 v[144:147], v32 offset:17408
s_waitcnt lgkmcnt(5)
v_mfma_f32_16x16x32_bf16 v[60:63], v[100:103], v[132:135], 0
ds_read_b64_tr_b16 v[112:113], v26 offset:2048
ds_read_b64_tr_b16 v[114:115], v26 offset:2304
v_mfma_f32_16x16x32_bf16 v[64:67], v[104:107], v[124:127], 0
s_add_u32 m0, s63, 0x0
s_nop 0
buffer_load_dwordx4 v17, s[44:47], s69 offen offset:0 lds
buffer_load_dwordx4 v18, s[44:47], s69 offen offset:1024 lds
v_mfma_f32_16x16x32_bf16 v[68:71], v[104:107], v[128:131], 0
v_and_b32 v5, 31, v2
v_lshrrev_b32 v6, 5, v2
v_mfma_f32_16x16x32_bf16 v[72:75], v[104:107], v[132:135], 0
ds_read_b128 v[148:151], v31 offset:2048
s_waitcnt vmcnt(2)
ds_read_b64_tr_b16 v[116:117], v25 offset:4096
ds_read_b64_tr_b16 v[118:119], v25 offset:4352
s_waitcnt lgkmcnt(7)
v_mfma_f32_16x16x32_bf16 v[52:55], v[108:111], v[136:139], v[52:55]
ds_read_b128 v[152:155], v31 offset:10240
s_lshr_b32 s6, s64, 9
s_waitcnt lgkmcnt(7)
v_mfma_f32_16x16x32_bf16 v[56:59], v[108:111], v[140:143], v[56:59]
ds_read_b128 v[156:159], v31 offset:18432
v_cmp_eq_u32 vcc, 0, v5
s_waitcnt lgkmcnt(7)
v_mfma_f32_16x16x32_bf16 v[60:63], v[108:111], v[144:147], v[60:63]
ds_read_b64_tr_b16 v[120:121], v26 offset:4096
ds_read_b64_tr_b16 v[122:123], v26 offset:4352
s_waitcnt lgkmcnt(7)
v_mfma_f32_16x16x32_bf16 v[64:67], v[112:115], v[136:139], v[64:67]
s_add_u32 m0, s63, 0x800
s_nop 0
buffer_load_dwordx4 v17, s[44:47], s70 offen offset:0 lds
buffer_load_dwordx4 v18, s[44:47], s70 offen offset:1024 lds
v_mfma_f32_16x16x32_bf16 v[68:71], v[112:115], v[140:143], v[68:71]
s_sub_u32 s6, 10000, s6
v_mov_b32 v7, 0x7fffffff
v_mfma_f32_16x16x32_bf16 v[72:75], v[112:115], v[144:147], v[72:75]
ds_read_b128 v[160:163], v32 offset:3072
s_waitcnt vmcnt(2)
ds_read_b64_tr_b16 v[100:101], v25 offset:0
ds_read_b64_tr_b16 v[102:103], v25 offset:256
s_waitcnt lgkmcnt(7)
v_mfma_f32_16x16x32_bf16 v[52:55], v[116:119], v[148:151], v[52:55]
ds_read_b128 v[164:167], v32 offset:11264
v_cndmask_b32 v6, v7, v6, vcc
s_waitcnt lgkmcnt(7)
v_mfma_f32_16x16x32_bf16 v[56:59], v[116:119], v[152:155], v[56:59]
ds_read_b128 v[168:171], v32 offset:19456
v_cmp_gt_i32 vcc, s6, v6
s_waitcnt lgkmcnt(7)
v_mfma_f32_16x16x32_bf16 v[60:63], v[116:119], v[156:159], v[60:63]
ds_read_b64_tr_b16 v[104:105], v26 offset:0
ds_read_b64_tr_b16 v[106:107], v26 offset:256
s_waitcnt lgkmcnt(7)
v_mfma_f32_16x16x32_bf16 v[64:67], v[120:123], v[148:151], v[64:67]
s_add_u32 m0, s63, 0x1000
s_nop 0
buffer_load_dwordx4 v17, s[44:47], s71 offen offset:0 lds
buffer_load_dwordx4 v18, s[44:47], s71 offen offset:1024 lds
v_mfma_f32_16x16x32_bf16 v[68:71], v[120:123], v[152:155], v[68:71]
v_and_b32 v5, s90, v40
v_or_b32 v5, 0x3f80, v5
v_mfma_f32_16x16x32_bf16 v[72:75], v[120:123], v[156:159], v[72:75]
ds_read_b128 v[124:127], v31 offset:4096
s_waitcnt vmcnt(2)
ds_read_b64_tr_b16 v[108:109], v25 offset:2048
ds_read_b64_tr_b16 v[110:111], v25 offset:2304
s_waitcnt lgkmcnt(7)
v_mfma_f32_16x16x32_bf16 v[52:55], v[100:103], v[160:163], v[52:55]
ds_read_b128 v[128:131], v31 offset:12288
s_sub_u32 s6, s6, 2
s_waitcnt lgkmcnt(7)
v_mfma_f32_16x16x32_bf16 v[56:59], v[100:103], v[164:167], v[56:59]
ds_read_b128 v[132:135], v31 offset:20480
v_cndmask_b32 v40, v40, v5, vcc
s_waitcnt lgkmcnt(7)
v_mfma_f32_16x16x32_bf16 v[60:63], v[100:103], v[168:171], v[60:63]
ds_read_b64_tr_b16 v[112:113], v26 offset:2048
ds_read_b64_tr_b16 v[114:115], v26 offset:2304
s_waitcnt lgkmcnt(7)
v_mfma_f32_16x16x32_bf16 v[64:67], v[104:107], v[160:163], v[64:67]
s_add_u32 m0, s63, 0x0
s_nop 0
buffer_load_dwordx4 v17, s[44:47], s72 offen offset:0 lds
buffer_load_dwordx4 v18, s[44:47], s72 offen offset:1024 lds
v_mfma_f32_16x16x32_bf16 v[68:71], v[104:107], v[164:167], v[68:71]
v_cmp_gt_i32 vcc, s6, v6
v_and_b32 v5, s90, v44
v_mfma_f32_16x16x32_bf16 v[72:75], v[104:107], v[168:171], v[72:75]
ds_read_b128 v[136:139], v32 offset:5120
s_waitcnt vmcnt(2)
ds_read_b64_tr_b16 v[116:117], v25 offset:4096
ds_read_b64_tr_b16 v[118:119], v25 offset:4352
s_waitcnt lgkmcnt(7)
v_mfma_f32_16x16x32_bf16 v[52:55], v[108:111], v[124:127], v[52:55]
ds_read_b128 v[140:143], v32 offset:13312
v_or_b32 v5, 0x3f80, v5
s_waitcnt lgkmcnt(7)
v_mfma_f32_16x16x32_bf16 v[56:59], v[108:111], v[128:131], v[56:59]
ds_read_b128 v[144:147], v32 offset:21504
s_sub_u32 s6, s6, 2
s_waitcnt lgkmcnt(7)
v_mfma_f32_16x16x32_bf16 v[60:63], v[108:111], v[132:135], v[60:63]
ds_read_b64_tr_b16 v[120:121], v26 offset:4096
ds_read_b64_tr_b16 v[122:123], v26 offset:4352
s_waitcnt lgkmcnt(7)
v_mfma_f32_16x16x32_bf16 v[64:67], v[112:115], v[124:127], v[64:67]
s_add_u32 m0, s63, 0x800
s_nop 0
buffer_load_dwordx4 v17, s[44:47], s73 offen offset:0 lds
buffer_load_dwordx4 v18, s[44:47], s73 offen offset:1024 lds
v_mfma_f32_16x16x32_bf16 v[68:71], v[112:115], v[128:131], v[68:71]
v_cndmask_b32 v44, v44, v5, vcc
v_cmp_gt_i32 vcc, s6, v6
v_mfma_f32_16x16x32_bf16 v[72:75], v[112:115], v[132:135], v[72:75]
ds_read_b128 v[148:151], v31 offset:6144
s_waitcnt vmcnt(2)
ds_read_b64_tr_b16 v[100:101], v25 offset:0
ds_read_b64_tr_b16 v[102:103], v25 offset:256
s_waitcnt lgkmcnt(7)
v_mfma_f32_16x16x32_bf16 v[52:55], v[116:119], v[136:139], v[52:55]
ds_read_b128 v[152:155], v31 offset:14336
v_and_b32 v5, s90, v48
s_waitcnt lgkmcnt(7)
v_mfma_f32_16x16x32_bf16 v[56:59], v[116:119], v[140:143], v[56:59]
ds_read_b128 v[156:159], v31 offset:22528
v_or_b32 v5, 0x3f80, v5
s_waitcnt lgkmcnt(7)
v_mfma_f32_16x16x32_bf16 v[60:63], v[116:119], v[144:147], v[60:63]
ds_read_b64_tr_b16 v[104:105], v26 offset:0
ds_read_b64_tr_b16 v[106:107], v26 offset:256
s_waitcnt lgkmcnt(7)
v_mfma_f32_16x16x32_bf16 v[64:67], v[120:123], v[136:139], v[64:67]
s_add_u32 m0, s63, 0x1000
s_nop 0
buffer_load_dwordx4 v21, s[48:51], s74 offen offset:0 lds
buffer_load_dwordx4 v22, s[48:51], s74 offen offset:1024 lds
v_mfma_f32_16x16x32_bf16 v[68:71], v[120:123], v[140:143], v[68:71]
s_sub_u32 s6, s6, 2
v_cndmask_b32 v48, v48, v5, vcc
v_mfma_f32_16x16x32_bf16 v[72:75], v[120:123], v[144:147], v[72:75]
ds_read_b128 v[160:163], v32 offset:7168
s_waitcnt vmcnt(2)
ds_read_b64_tr_b16 v[108:109], v25 offset:2048
ds_read_b64_tr_b16 v[110:111], v25 offset:2304
s_waitcnt lgkmcnt(7)
v_mfma_f32_16x16x32_bf16 v[52:55], v[100:103], v[148:151], v[52:55]
ds_read_b128 v[164:167], v32 offset:15360
s_waitcnt lgkmcnt(7)
v_mfma_f32_16x16x32_bf16 v[56:59], v[100:103], v[152:155], v[56:59]
ds_read_b128 v[168:171], v32 offset:23552
s_waitcnt lgkmcnt(7)
v_mfma_f32_16x16x32_bf16 v[60:63], v[100:103], v[156:159], v[60:63]
ds_read_b64_tr_b16 v[112:113], v26 offset:2048
ds_read_b64_tr_b16 v[114:115], v26 offset:2304
s_waitcnt lgkmcnt(7)
v_mfma_f32_16x16x32_bf16 v[64:67], v[104:107], v[148:151], v[64:67]
s_add_u32 m0, s63, 0x0
s_nop 0
buffer_load_dwordx4 v21, s[48:51], s75 offen offset:0 lds
buffer_load_dwordx4 v22, s[48:51], s75 offen offset:1024 lds
v_mfma_f32_16x16x32_bf16 v[68:71], v[104:107], v[152:155], v[68:71]
v_mfma_f32_16x16x32_bf16 v[72:75], v[104:107], v[156:159], v[72:75]
s_waitcnt lgkmcnt(4)
v_mfma_f32_16x16x32_bf16 v[52:55], v[108:111], v[160:163], v[52:55]
s_waitcnt lgkmcnt(3)
v_mfma_f32_16x16x32_bf16 v[56:59], v[108:111], v[164:167], v[56:59]
s_waitcnt lgkmcnt(2)
v_mfma_f32_16x16x32_bf16 v[60:63], v[108:111], v[168:171], v[60:63]
s_waitcnt lgkmcnt(0)
v_mfma_f32_16x16x32_bf16 v[64:67], v[112:115], v[160:163], v[64:67]
s_nop 1
v_cvt_pk_bf16_f32 v52, v52, v53
v_cvt_pk_bf16_f32 v53, v54, v55
ds_write_b64 v33, v[52:53] offset:0
s_add_u32 m0, s63, 0x800
s_nop 0
buffer_load_dwordx4 v21, s[48:51], s76 offen offset:0 lds
buffer_load_dwordx4 v22, s[48:51], s76 offen offset:1024 lds
v_mfma_f32_16x16x32_bf16 v[68:71], v[112:115], v[164:167], v[68:71]
v_cvt_pk_bf16_f32 v56, v56, v57
v_cvt_pk_bf16_f32 v57, v58, v59
ds_write_b64 v33, v[56:57] offset:8192
v_mfma_f32_16x16x32_bf16 v[72:75], v[112:115], v[168:171], v[72:75]
v_cvt_pk_bf16_f32 v60, v60, v61
v_cvt_pk_bf16_f32 v61, v62, v63
ds_write_b64 v33, v[60:61] offset:16384
v_cvt_pk_bf16_f32 v64, v64, v65
v_cvt_pk_bf16_f32 v65, v66, v67
ds_write_b64 v33, v[64:65] offset:512
v_cvt_pk_bf16_f32 v68, v68, v69
v_cvt_pk_bf16_f32 v69, v70, v71
ds_write_b64 v33, v[68:69] offset:8704
v_cvt_pk_bf16_f32 v72, v72, v73
v_cvt_pk_bf16_f32 v73, v74, v75
ds_write_b64 v33, v[72:73] offset:16896
s_waitcnt vmcnt(4)
ds_read_b128 v[116:119], v29 offset:4096
ds_read_b128 v[120:123], v30 offset:4096
s_waitcnt lgkmcnt(2)
s_barrier
ds_read_b128 v[124:127], v35 offset:0
ds_read_b128 v[128:131], v35 offset:8192
ds_read_b128 v[132:135], v35 offset:16384
ds_read_b128 v[136:139], v35 offset:1024
s_waitcnt lgkmcnt(3)
v_mfma_f32_16x16x32_bf16 v[76:79], v[116:119], v[124:127], 0
ds_read_b128 v[140:143], v35 offset:9216
s_waitcnt lgkmcnt(3)
v_mfma_f32_16x16x32_bf16 v[84:87], v[116:119], v[128:131], 0
ds_read_b128 v[144:147], v35 offset:17408
s_waitcnt lgkmcnt(3)
v_mfma_f32_16x16x32_bf16 v[92:95], v[116:119], v[132:135], 0
v_mfma_f32_16x16x32_bf16 v[204:207], v[172:175], v[124:127], 0
v_mfma_f32_16x16x32_bf16 v[208:211], v[172:175], v[128:131], 0
v_mfma_f32_16x16x32_bf16 v[212:215], v[172:175], v[132:135], 0
s_waitcnt vmcnt(2)
ds_read_b128 v[100:103], v29 offset:0
s_waitcnt lgkmcnt(3)
v_mfma_f32_16x16x32_bf16 v[76:79], v[120:123], v[136:139], v[76:79]
s_add_u32 m0, s63, 0x1000
s_nop 0
buffer_load_dwordx4 v21, s[48:51], s77 offen offset:0 lds
buffer_load_dwordx4 v22, s[48:51], s77 offen offset:1024 lds
s_waitcnt lgkmcnt(2)
v_mfma_f32_16x16x32_bf16 v[84:87], v[120:123], v[140:143], v[84:87]
s_waitcnt lgkmcnt(1)
v_mfma_f32_16x16x32_bf16 v[92:95], v[120:123], v[144:147], v[92:95]
ds_read_b128 v[104:107], v30 offset:0
v_mfma_f32_16x16x32_bf16 v[204:207], v[176:179], v[136:139], v[204:207]
v_mfma_f32_16x16x32_bf16 v[208:211], v[176:179], v[140:143], v[208:211]
v_mfma_f32_16x16x32_bf16 v[212:215], v[176:179], v[144:147], v[212:215]
ds_read_b128 v[148:151], v35 offset:2048
s_waitcnt vmcnt(2)
ds_read_b128 v[108:111], v29 offset:2048
s_waitcnt lgkmcnt(3)
v_mfma_f32_16x16x32_bf16 v[80:83], v[100:103], v[124:127], 0
ds_read_b128 v[152:155], v35 offset:10240
v_mfma_f32_16x16x32_bf16 v[88:91], v[100:103], v[128:131], 0
ds_read_b128 v[156:159], v35 offset:18432
v_mfma_f32_16x16x32_bf16 v[96:99], v[100:103], v[132:135], 0
s_waitcnt lgkmcnt(4)
v_mfma_f32_16x16x32_bf16 v[80:83], v[104:107], v[136:139], v[80:83]
s_add_u32 m0, s63, 0x0
s_nop 0
buffer_load_dwordx4 v21, s[48:51], s78 offen offset:0 lds
buffer_load_dwordx4 v22, s[48:51], s78 offen offset:1024 lds
v_mfma_f32_16x16x32_bf16 v[88:91], v[104:107], v[140:143], v[88:91]
v_mfma_f32_16x16x32_bf16 v[96:99], v[104:107], v[144:147], v[96:99]
ds_read_b128 v[160:163], v35 offset:3072
ds_read_b128 v[112:115], v30 offset:2048
s_waitcnt lgkmcnt(4)
v_mfma_f32_16x16x32_bf16 v[76:79], v[108:111], v[148:151], v[76:79]
ds_read_b128 v[164:167], v35 offset:11264
s_waitcnt lgkmcnt(4)
v_mfma_f32_16x16x32_bf16 v[84:87], v[108:111], v[152:155], v[84:87]
ds_read_b128 v[168:171], v35 offset:19456
s_waitcnt lgkmcnt(4)
v_mfma_f32_16x16x32_bf16 v[92:95], v[108:111], v[156:159], v[92:95]
v_mfma_f32_16x16x32_bf16 v[204:207], v[180:183], v[148:151], v[204:207]
v_mfma_f32_16x16x32_bf16 v[208:211], v[180:183], v[152:155], v[208:211]
v_mfma_f32_16x16x32_bf16 v[212:215], v[180:183], v[156:159], v[212:215]
s_waitcnt vmcnt(2)
ds_read_b128 v[116:119], v29 offset:4096
s_waitcnt lgkmcnt(3)
v_mfma_f32_16x16x32_bf16 v[76:79], v[112:115], v[160:163], v[76:79]
s_add_u32 m0, s63, 0x800
s_nop 0
buffer_load_dwordx4 v21, s[48:51], s79 offen offset:0 lds
buffer_load_dwordx4 v22, s[48:51], s79 offen offset:1024 lds
s_waitcnt lgkmcnt(2)
v_mfma_f32_16x16x32_bf16 v[84:87], v[112:115], v[164:167], v[84:87]
s_waitcnt lgkmcnt(1)
v_mfma_f32_16x16x32_bf16 v[92:95], v[112:115], v[168:171], v[92:95]
ds_read_b128 v[120:123], v30 offset:4096
v_mfma_f32_16x16x32_bf16 v[204:207], v[184:187], v[160:163], v[204:207]
v_mfma_f32_16x16x32_bf16 v[208:211], v[184:187], v[164:167], v[208:211]
v_mfma_f32_16x16x32_bf16 v[212:215], v[184:187], v[168:171], v[212:215]
ds_read_b128 v[124:127], v35 offset:4096
s_waitcnt vmcnt(2)
ds_read_b128 v[100:103], v29 offset:0
s_waitcnt lgkmcnt(3)
v_mfma_f32_16x16x32_bf16 v[80:83], v[116:119], v[148:151], v[80:83]
ds_read_b128 v[128:131], v35 offset:12288
v_mfma_f32_16x16x32_bf16 v[88:91], v[116:119], v[152:155], v[88:91]
ds_read_b128 v[132:135], v35 offset:20480
v_mfma_f32_16x16x32_bf16 v[96:99], v[116:119], v[156:159], v[96:99]
s_waitcnt lgkmcnt(4)
v_mfma_f32_16x16x32_bf16 v[80:83], v[120:123], v[160:163], v[80:83]
s_add_u32 m0, s63, 0x1000
s_nop 0
buffer_load_dwordx4 v21, s[48:51], s80 offen offset:0 lds
buffer_load_dwordx4 v22, s[48:51], s80 offen offset:1024 lds
v_mfma_f32_16x16x32_bf16 v[88:91], v[120:123], v[164:167], v[88:91]
v_mfma_f32_16x16x32_bf16 v[96:99], v[120:123], v[168:171], v[96:99]
ds_read_b128 v[136:139], v35 offset:5120
ds_read_b128 v[104:107], v30 offset:0
s_waitcnt lgkmcnt(4)
v_mfma_f32_16x16x32_bf16 v[76:79], v[100:103], v[124:127], v[76:79]
ds_read_b128 v[140:143], v35 offset:13312
s_waitcnt lgkmcnt(4)
v_mfma_f32_16x16x32_bf16 v[84:87], v[100:103], v[128:131], v[84:87]
ds_read_b128 v[144:147], v35 offset:21504
s_waitcnt lgkmcnt(4)
v_mfma_f32_16x16x32_bf16 v[92:95], v[100:103], v[132:135], v[92:95]
v_mfma_f32_16x16x32_bf16 v[204:207], v[188:191], v[124:127], v[204:207]
v_mfma_f32_16x16x32_bf16 v[208:211], v[188:191], v[128:131], v[208:211]
v_mfma_f32_16x16x32_bf16 v[212:215], v[188:191], v[132:135], v[212:215]
s_waitcnt vmcnt(2)
ds_read_b128 v[108:111], v29 offset:2048
s_waitcnt lgkmcnt(3)
v_mfma_f32_16x16x32_bf16 v[76:79], v[104:107], v[136:139], v[76:79]
s_add_u32 m0, s63, 0x0
s_nop 0
buffer_load_dwordx4 v21, s[48:51], s81 offen offset:0 lds
buffer_load_dwordx4 v22, s[48:51], s81 offen offset:1024 lds
s_waitcnt lgkmcnt(2)
v_mfma_f32_16x16x32_bf16 v[84:87], v[104:107], v[140:143], v[84:87]
buffer_store_dwordx4 v[40:43], v16, s[56:59], s64 offen offset:0 sc1
buffer_store_dwordx4 v[44:47], v16, s[56:59], s64 offen offset:1024 sc1
s_waitcnt lgkmcnt(1)
v_mfma_f32_16x16x32_bf16 v[92:95], v[104:107], v[144:147], v[92:95]
ds_read_b128 v[112:115], v30 offset:2048
buffer_store_dwordx4 v[48:51], v16, s[56:59], s64 offen offset:2048 sc1
v_mfma_f32_16x16x32_bf16 v[204:207], v[192:195], v[136:139], v[204:207]
v_mfma_f32_16x16x32_bf16 v[208:211], v[192:195], v[140:143], v[208:211]
v_mfma_f32_16x16x32_bf16 v[212:215], v[192:195], v[144:147], v[212:215]
ds_read_b128 v[148:151], v35 offset:6144
s_waitcnt vmcnt(5)
ds_read_b128 v[116:119], v29 offset:4096
s_waitcnt lgkmcnt(3)
v_mfma_f32_16x16x32_bf16 v[80:83], v[108:111], v[124:127], v[80:83]
ds_read_b128 v[152:155], v35 offset:14336
v_mfma_f32_16x16x32_bf16 v[88:91], v[108:111], v[128:131], v[88:91]
ds_read_b128 v[156:159], v35 offset:22528
v_mfma_f32_16x16x32_bf16 v[96:99], v[108:111], v[132:135], v[96:99]
s_waitcnt lgkmcnt(4)
v_mfma_f32_16x16x32_bf16 v[80:83], v[112:115], v[136:139], v[80:83]
v_mfma_f32_16x16x32_bf16 v[88:91], v[112:115], v[140:143], v[88:91]
v_mfma_f32_16x16x32_bf16 v[96:99], v[112:115], v[144:147], v[96:99]
ds_read_b128 v[160:163], v35 offset:7168
ds_read_b128 v[120:123], v30 offset:4096
s_waitcnt lgkmcnt(4)
v_mfma_f32_16x16x32_bf16 v[76:79], v[116:119], v[148:151], v[76:79]
ds_read_b128 v[164:167], v35 offset:15360
s_waitcnt lgkmcnt(4)
v_mfma_f32_16x16x32_bf16 v[84:87], v[116:119], v[152:155], v[84:87]
ds_read_b128 v[168:171], v35 offset:23552
s_waitcnt lgkmcnt(4)
v_mfma_f32_16x16x32_bf16 v[92:95], v[116:119], v[156:159], v[92:95]
v_mfma_f32_16x16x32_bf16 v[204:207], v[196:199], v[148:151], v[204:207]
v_mfma_f32_16x16x32_bf16 v[208:211], v[196:199], v[152:155], v[208:211]
v_mfma_f32_16x16x32_bf16 v[212:215], v[196:199], v[156:159], v[212:215]
s_waitcnt vmcnt(3)
ds_read_b128 v[100:103], v29 offset:0
s_waitcnt lgkmcnt(3)
v_mfma_f32_16x16x32_bf16 v[76:79], v[120:123], v[160:163], v[76:79]
s_waitcnt lgkmcnt(2)
v_mfma_f32_16x16x32_bf16 v[84:87], v[120:123], v[164:167], v[84:87]
s_waitcnt lgkmcnt(1)
v_mfma_f32_16x16x32_bf16 v[92:95], v[120:123], v[168:171], v[92:95]
ds_read_b128 v[104:107], v30 offset:0
v_mfma_f32_16x16x32_bf16 v[204:207], v[200:203], v[160:163], v[204:207]
v_mfma_f32_16x16x32_bf16 v[208:211], v[200:203], v[164:167], v[208:211]
v_mfma_f32_16x16x32_bf16 v[212:215], v[200:203], v[168:171], v[212:215]
s_waitcnt lgkmcnt(1)
v_mfma_f32_16x16x32_bf16 v[80:83], v[100:103], v[148:151], v[80:83]
s_nop 3
v_mul_f32 v204, -v204, s86
v_mfma_f32_16x16x32_bf16 v[88:91], v[100:103], v[152:155], v[88:91]
v_mul_f32 v208, -v208, s86
v_mfma_f32_16x16x32_bf16 v[96:99], v[100:103], v[156:159], v[96:99]
v_mul_f32 v212, -v212, s86
s_waitcnt lgkmcnt(0)
v_mfma_f32_16x16x32_bf16 v[80:83], v[104:107], v[160:163], v[80:83]
v_mfma_f32_16x16x32_bf16 v[88:91], v[104:107], v[164:167], v[88:91]
v_mfma_f32_16x16x32_bf16 v[96:99], v[104:107], v[168:171], v[96:99]
v_fma_f32 v76, v76, s86, v204
v_fma_f32 v77, v77, s86, v204
v_fma_f32 v78, v78, s86, v204
v_fma_f32 v79, v79, s86, v204
s_nop 1
v_fma_f32 v80, v80, s86, v204
v_fma_f32 v81, v81, s86, v204
v_fma_f32 v82, v82, s86, v204
v_fma_f32 v83, v83, s86, v204
v_cvt_pk_bf16_f32 v76, v76, v77
v_cvt_pk_bf16_f32 v77, v78, v79
v_cvt_pk_bf16_f32 v78, v80, v81
v_cvt_pk_bf16_f32 v79, v82, v83
buffer_store_dwordx4 v[76:79], v16, s[52:55], s82 offen offset:0 sc1
v_fma_f32 v84, v84, s86, v208
v_fma_f32 v85, v85, s86, v208
v_fma_f32 v86, v86, s86, v208
v_fma_f32 v87, v87, s86, v208
v_fma_f32 v88, v88, s86, v208
v_fma_f32 v89, v89, s86, v208
v_fma_f32 v90, v90, s86, v208
v_fma_f32 v91, v91, s86, v208
v_cvt_pk_bf16_f32 v84, v84, v85
v_cvt_pk_bf16_f32 v85, v86, v87
v_cvt_pk_bf16_f32 v86, v88, v89
v_cvt_pk_bf16_f32 v87, v90, v91
buffer_store_dwordx4 v[84:87], v16, s[52:55], s83 offen offset:0 sc1
v_fma_f32 v92, v92, s86, v212
v_fma_f32 v93, v93, s86, v212
v_fma_f32 v94, v94, s86, v212
v_fma_f32 v95, v95, s86, v212
v_fma_f32 v96, v96, s86, v212
v_fma_f32 v97, v97, s86, v212
v_fma_f32 v98, v98, s86, v212
v_fma_f32 v99, v99, s86, v212
v_cvt_pk_bf16_f32 v92, v92, v93
v_cvt_pk_bf16_f32 v93, v94, v95
v_cvt_pk_bf16_f32 v94, v96, v97
v_cvt_pk_bf16_f32 v95, v98, v99
buffer_store_dwordx4 v[92:95], v16, s[52:55], s84 offen offset:0 sc1
s_branch L1_fin
L1_notq:
s_sub_u32 s4, s2, 32
s_cmp_lt_u32 s2, 32
s_cbranch_scc1 L1_edge
s_mov_b32 s61, 1
v_lshlrev_b32 v16, 4, v2
s_mul_i32 s63, s60, 6144
s_and_b32 s6, s4, 3
s_lshl_b32 s6, s6, 6
s_mul_i32 s7, s60, 8
s_add_u32 s6, s6, s7
v_lshrrev_b32 v5, 5, v2
v_and_b32 v6, 31, v2
v_lshlrev_b32 v6, 4, v6
v_mov_b32 v176, v6
s_cmp_ge_u32 s4, 4
s_cselect_b64 vcc, -1, 0
v_add3_u32 v7, v5, s6, 0
v_and_b32 v8, 0x80, v7
v_bfe_u32 v9, v7, 2, 1
v_lshl_or_b32 v8, v9, 6, v8
v_bfe_u32 v9, v7, 4, 1
v_lshl_or_b32 v8, v9, 5, v8
v_and_b32 v9, 3, v7
v_lshl_or_b32 v8, v9, 3, v8
v_bfe_u32 v9, v7, 5, 2
v_lshl_or_b32 v8, v9, 1, v8
v_bfe_u32 v9, v7, 3, 1
v_or_b32 v8, v9, v8
v_cndmask_b32 v8, v8, v7, vcc
v_lshl_add_u32 v40, v8, 9, v6
v_add3_u32 v7, v5, s6, 2
v_and_b32 v8, 0x80, v7
v_bfe_u32 v9, v7, 2, 1
v_lshl_or_b32 v8, v9, 6, v8
v_bfe_u32 v9, v7, 4, 1
v_lshl_or_b32 v8, v9, 5, v8
v_and_b32 v9, 3, v7
v_lshl_or_b32 v8, v9, 3, v8
v_bfe_u32 v9, v7, 5, 2
v_lshl_or_b32 v8, v9, 1, v8
v_bfe_u32 v9, v7, 3, 1
v_or_b32 v8, v9, v8
v_cndmask_b32 v8, v8, v7, vcc
v_lshl_add_u32 v44, v8, 9, v6
v_add3_u32 v7, v5, s6, 4
v_and_b32 v8, 0x80, v7
v_bfe_u32 v9, v7, 2, 1
v_lshl_or_b32 v8, v9, 6, v8
v_bfe_u32 v9, v7, 4, 1
v_lshl_or_b32 v8, v9, 5, v8
v_and_b32 v9, 3, v7
v_lshl_or_b32 v8, v9, 3, v8
v_bfe_u32 v9, v7, 5, 2
v_lshl_or_b32 v8, v9, 1, v8
v_bfe_u32 v9, v7, 3, 1
v_or_b32 v8, v9, v8
v_cndmask_b32 v8, v8, v7, vcc
v_lshl_add_u32 v48, v8, 9, v6
v_add3_u32 v7, v5, s6, 6
v_and_b32 v8, 0x80, v7
v_bfe_u32 v9, v7, 2, 1
v_lshl_or_b32 v8, v9, 6, v8
v_bfe_u32 v9, v7, 4, 1
v_lshl_or_b32 v8, v9, 5, v8
v_and_b32 v9, 3, v7
v_lshl_or_b32 v8, v9, 3, v8
v_bfe_u32 v9, v7, 5, 2
v_lshl_or_b32 v8, v9, 1, v8
v_bfe_u32 v9, v7, 3, 1
v_or_b32 v8, v9, v8
v_cndmask_b32 v8, v8, v7, vcc
v_lshl_add_u32 v52, v8, 9, v6
s_lshl_b32 s7, s60, 6
v_lshrrev_b32 v5, 2, v2
v_and_b32 v6, 3, v2
v_lshrrev_b32 v7, 5, v2
v_lshlrev_b32 v7, 1, v7
v_xor_b32 v6, v6, v7
v_lshl_add_u32 v5, v5, 9, s7
v_lshl_add_u32 v17, v6, 4, v5
v_add_u32 v18, 0x1c00, v17
s_xor_b32 s6, s62, 0
s_lshl_b32 s66, s6, 14
s_xor_b32 s6, s62, 1
s_lshl_b32 s67, s6, 14
s_xor_b32 s6, s62, 2
s_lshl_b32 s68, s6, 14
s_xor_b32 s6, s62, 3
s_lshl_b32 s69, s6, 14
s_xor_b32 s6, s62, 4
s_lshl_b32 s70, s6, 14
s_xor_b32 s6, s62, 5
s_lshl_b32 s71, s6, 14
s_xor_b32 s6, s62, 6
s_lshl_b32 s72, s6, 14
s_xor_b32 s6, s62, 7
s_lshl_b32 s73, s6, 14
s_waitcnt lgkmcnt(0)
s_cmp_ge_u32 s4, 4
s_cselect_b32 s6, s30, s24
s_cselect_b32 s7, s31, s25
s_add_u32 s40, s6, 0x0
s_addc_u32 s41, s7, 0
s_mov_b32 s42, 0x20000
s_mov_b32 s43, 0x00020000
s_add_u32 s44, s32, 0x0
s_addc_u32 s45, s33, 0
s_mov_b32 s46, 0x20000
s_mov_b32 s47, 0x00020000
buffer_load_dwordx4 v[40:43], v40, s[40:43], 0 offen
buffer_load_dwordx4 v[44:47], v44, s[40:43], 0 offen
buffer_load_dwordx4 v[48:51], v48, s[40:43], 0 offen
buffer_load_dwordx4 v[52:55], v52, s[40:43], 0 offen
buffer_load_dwordx4 v[176:179], v176, s[40:43], 0 offen
s_add_u32 m0, s63, 0x0
s_nop 0
buffer_load_dwordx4 v17, s[44:47], s66 offen offset:0 lds
buffer_load_dwordx4 v18, s[44:47], s66 offen offset:1024 lds
s_add_u32 m0, s63, 0x800
s_nop 0
buffer_load_dwordx4 v17, s[44:47], s67 offen offset:0 lds
buffer_load_dwordx4 v18, s[44:47], s67 offen offset:1024 lds
v_bfe_u32 v5, v2, 2, 3
v_xor_b32 v5, s62, v5
v_and_b32 v6, 3, v2
v_lshlrev_b32 v7, 10, v5
v_lshl_add_u32 v7, v6, 8, v7
v_add_u32 v7, 0xc000, v7
v_and_b32 v5, 1, v5
v_lshl_or_b32 v6, v5, 2, v6
v_lshrrev_b32 v5, 5, v2
s_mul_i32 s6, s60, 8
v_add3_u32 v8, v5, s6, 0
v_lshrrev_b32 v9, 4, v8
v_lshl_add_u32 v9, v9, 13, v7
v_and_b32 v8, 15, v8
v_xor_b32 v8, v8, v6
v_lshl_add_u32 v36, v8, 4, v9
v_add3_u32 v8, v5, s6, 2
v_lshrrev_b32 v9, 4, v8
v_lshl_add_u32 v9, v9, 13, v7
v_and_b32 v8, 15, v8
v_xor_b32 v8, v8, v6
v_lshl_add_u32 v37, v8, 4, v9
v_add3_u32 v8, v5, s6, 4
v_lshrrev_b32 v9, 4, v8
v_lshl_add_u32 v9, v9, 13, v7
v_and_b32 v8, 15, v8
v_xor_b32 v8, v8, v6
v_lshl_add_u32 v38, v8, 4, v9
v_add3_u32 v8, v5, s6, 6
v_lshrrev_b32 v9, 4, v8
v_lshl_add_u32 v9, v9, 13, v7
v_and_b32 v8, 15, v8
v_xor_b32 v8, v8, v6
v_lshl_add_u32 v39, v8, 4, v9
v_xor_b32 v5, v3, v4
v_lshlrev_b32 v5, 4, v5
v_lshl_add_u32 v5, v4, 8, v5
v_add_u32 v31, 0xc000, v5
v_xor_b32 v32, 64, v31
v_lshrrev_b32 v5, 2, v3
v_and_b32 v6, 3, v3
v_and_b32 v7, 1, v4
v_lshlrev_b32 v7, 1, v7
v_lshl_add_u32 v8, v4, 3, v5
v_lshlrev_b32 v8, 6, v8
v_add_u32 v8, s63, v8
v_xor_b32 v6, v6, v7
v_xor_b32 v9, 0, v6
v_lshl_add_u32 v25, v9, 4, v8
v_add_u32 v26, 8, v25
s_lshr_b32 s6, s4, 2
s_lshl_b32 s6, s6, 17
s_and_b32 s7, s4, 3
s_lshl_b32 s7, s7, 12
s_add_u32 s6, s6, s7
s_mul_i32 s7, s60, 16384
s_add_u32 s82, s6, s7
s_add_u32 s83, s82, 16384
s_add_u32 s52, s38, 0x1000000
s_addc_u32 s53, s39, 0
s_mov_b32 s54, 0x40000
s_mov_b32 s55, 0x00020000
s_mov_b32 s90, 0xffff0000
s_waitcnt vmcnt(4)
v_lshlrev_b32 v180, 16, v176
v_and_b32 v181, s90, v176
v_lshlrev_b32 v182, 16, v177
v_and_b32 v183, s90, v177
v_lshlrev_b32 v184, 16, v178
v_and_b32 v185, s90, v178
v_lshlrev_b32 v186, 16, v179
v_and_b32 v187, s90, v179
v_lshlrev_b32 v176, 16, v40
v_and_b32 v177, s90, v40
v_sub_f32 v176, v176, v180
v_sub_f32 v177, v177, v181
v_cvt_pk_bf16_f32 v40, v176, v177
v_lshlrev_b32 v176, 16, v41
v_and_b32 v177, s90, v41
v_sub_f32 v176, v176, v182
v_sub_f32 v177, v177, v183
v_cvt_pk_bf16_f32 v41, v176, v177
v_lshlrev_b32 v176, 16, v42
v_and_b32 v177, s90, v42
v_sub_f32 v176, v176, v184
v_sub_f32 v177, v177, v185
v_cvt_pk_bf16_f32 v42, v176, v177
v_lshlrev_b32 v176, 16, v43
v_and_b32 v177, s90, v43
v_sub_f32 v176, v176, v186
v_sub_f32 v177, v177, v187
v_cvt_pk_bf16_f32 v43, v176, v177
v_lshlrev_b32 v176, 16, v44
v_and_b32 v177, s90, v44
v_sub_f32 v176, v176, v180
v_sub_f32 v177, v177, v181
v_cvt_pk_bf16_f32 v44, v176, v177
v_lshlrev_b32 v176, 16, v45
v_and_b32 v177, s90, v45
v_sub_f32 v176, v176, v182
v_sub_f32 v177, v177, v183
v_cvt_pk_bf16_f32 v45, v176, v177
v_lshlrev_b32 v176, 16, v46
v_and_b32 v177, s90, v46
v_sub_f32 v176, v176, v184
v_sub_f32 v177, v177, v185
v_cvt_pk_bf16_f32 v46, v176, v177
v_lshlrev_b32 v176, 16, v47
v_and_b32 v177, s90, v47
v_sub_f32 v176, v176, v186
v_sub_f32 v177, v177, v187
v_cvt_pk_bf16_f32 v47, v176, v177
v_lshlrev_b32 v176, 16, v48
v_and_b32 v177, s90, v48
v_sub_f32 v176, v176, v180
v_sub_f32 v177, v177, v181
v_cvt_pk_bf16_f32 v48, v176, v177
v_lshlrev_b32 v176, 16, v49
v_and_b32 v177, s90, v49
v_sub_f32 v176, v176, v182
v_sub_f32 v177, v177, v183
v_cvt_pk_bf16_f32 v49, v176, v177
v_lshlrev_b32 v176, 16, v50
v_and_b32 v177, s90, v50
v_sub_f32 v176, v176, v184
v_sub_f32 v177, v177, v185
v_cvt_pk_bf16_f32 v50, v176, v177
v_lshlrev_b32 v176, 16, v51
v_and_b32 v177, s90, v51
v_sub_f32 v176, v176, v186
v_sub_f32 v177, v177, v187
v_cvt_pk_bf16_f32 v51, v176, v177
v_lshlrev_b32 v176, 16, v52
v_and_b32 v177, s90, v52
v_sub_f32 v176, v176, v180
v_sub_f32 v177, v177, v181
v_cvt_pk_bf16_f32 v52, v176, v177
v_lshlrev_b32 v176, 16, v53
v_and_b32 v177, s90, v53
v_sub_f32 v176, v176, v182
v_sub_f32 v177, v177, v183
v_cvt_pk_bf16_f32 v53, v176, v177
v_lshlrev_b32 v176, 16, v54
v_and_b32 v177, s90, v54
v_sub_f32 v176, v176, v184
v_sub_f32 v177, v177, v185
v_cvt_pk_bf16_f32 v54, v176, v177
v_lshlrev_b32 v176, 16, v55
v_and_b32 v177, s90, v55
v_sub_f32 v176, v176, v186
v_sub_f32 v177, v177, v187
v_cvt_pk_bf16_f32 v55, v176, v177
ds_write_b128 v36, v[40:43]
ds_write_b128 v37, v[44:47]
ds_write_b128 v38, v[48:51]
ds_write_b128 v39, v[52:55]
s_add_u32 m0, s63, 0x1000
s_nop 0
buffer_load_dwordx4 v17, s[44:47], s68 offen offset:0 lds
buffer_load_dwordx4 v18, s[44:47], s68 offen offset:1024 lds
s_waitcnt vmcnt(4)
ds_read_b64_tr_b16 v[88:89], v25 offset:0
ds_read_b64_tr_b16 v[90:91], v25 offset:256
ds_read_b64_tr_b16 v[92:93], v26 offset:0
ds_read_b64_tr_b16 v[94:95], v26 offset:256
s_waitcnt lgkmcnt(4)
s_barrier
ds_read_b128 v[112:115], v31 offset:0
ds_read_b128 v[116:119], v31 offset:8192
ds_read_b128 v[120:123], v31 offset:16384
ds_read_b128 v[124:127], v31 offset:24576
ds_read_b128 v[128:131], v32 offset:1024
s_waitcnt vmcnt(2)
ds_read_b64_tr_b16 v[96:97], v25 offset:2048
ds_read_b64_tr_b16 v[98:99], v25 offset:2304
s_waitcnt lgkmcnt(6)
v_mfma_f32_16x16x32_bf16 v[56:59], v[112:115], v[88:91], 0
ds_read_b128 v[132:135], v32 offset:9216
s_waitcnt lgkmcnt(6)
v_mfma_f32_16x16x32_bf16 v[60:63], v[116:119], v[88:91], 0
ds_read_b128 v[136:139], v32 offset:17408
s_waitcnt lgkmcnt(6)
v_mfma_f32_16x16x32_bf16 v[64:67], v[120:123], v[88:91], 0
ds_read_b128 v[140:143], v32 offset:25600
s_waitcnt lgkmcnt(6)
v_mfma_f32_16x16x32_bf16 v[68:71], v[124:127], v[88:91], 0
ds_read_b64_tr_b16 v[100:101], v26 offset:2048
ds_read_b64_tr_b16 v[102:103], v26 offset:2304
v_mfma_f32_16x16x32_bf16 v[72:75], v[112:115], v[92:95], 0
s_add_u32 m0, s63, 0x0
s_nop 0
buffer_load_dwordx4 v17, s[44:47], s69 offen offset:0 lds
buffer_load_dwordx4 v18, s[44:47], s69 offen offset:1024 lds
v_mfma_f32_16x16x32_bf16 v[76:79], v[116:119], v[92:95], 0
v_mfma_f32_16x16x32_bf16 v[80:83], v[120:123], v[92:95], 0
v_mfma_f32_16x16x32_bf16 v[84:87], v[124:127], v[92:95], 0
ds_read_b128 v[144:147], v31 offset:2048
s_waitcnt vmcnt(2)
ds_read_b64_tr_b16 v[104:105], v25 offset:4096
ds_read_b64_tr_b16 v[106:107], v25 offset:4352
s_waitcnt lgkmcnt(8)
v_mfma_f32_16x16x32_bf16 v[56:59], v[128:131], v[96:99], v[56:59]
ds_read_b128 v[148:151], v31 offset:10240
s_waitcnt lgkmcnt(8)
v_mfma_f32_16x16x32_bf16 v[60:63], v[132:135], v[96:99], v[60:63]
ds_read_b128 v[152:155], v31 offset:18432
s_waitcnt lgkmcnt(8)
v_mfma_f32_16x16x32_bf16 v[64:67], v[136:139], v[96:99], v[64:67]
ds_read_b128 v[156:159], v31 offset:26624
s_waitcnt lgkmcnt(8)
v_mfma_f32_16x16x32_bf16 v[68:71], v[140:143], v[96:99], v[68:71]
ds_read_b64_tr_b16 v[108:109], v26 offset:4096
ds_read_b64_tr_b16 v[110:111], v26 offset:4352
s_waitcnt lgkmcnt(8)
v_mfma_f32_16x16x32_bf16 v[72:75], v[128:131], v[100:103], v[72:75]
s_add_u32 m0, s63, 0x800
s_nop 0
buffer_load_dwordx4 v17, s[44:47], s70 offen offset:0 lds
buffer_load_dwordx4 v18, s[44:47], s70 offen offset:1024 lds
v_mfma_f32_16x16x32_bf16 v[76:79], v[132:135], v[100:103], v[76:79]
v_mfma_f32_16x16x32_bf16 v[80:83], v[136:139], v[100:103], v[80:83]
v_mfma_f32_16x16x32_bf16 v[84:87], v[140:143], v[100:103], v[84:87]
ds_read_b128 v[160:163], v32 offset:3072
s_waitcnt vmcnt(2)
ds_read_b64_tr_b16 v[88:89], v25 offset:0
ds_read_b64_tr_b16 v[90:91], v25 offset:256
s_waitcnt lgkmcnt(8)
v_mfma_f32_16x16x32_bf16 v[56:59], v[144:147], v[104:107], v[56:59]
ds_read_b128 v[164:167], v32 offset:11264
s_waitcnt lgkmcnt(8)
v_mfma_f32_16x16x32_bf16 v[60:63], v[148:151], v[104:107], v[60:63]
ds_read_b128 v[168:171], v32 offset:19456
s_waitcnt lgkmcnt(8)
v_mfma_f32_16x16x32_bf16 v[64:67], v[152:155], v[104:107], v[64:67]
ds_read_b128 v[172:175], v32 offset:27648
s_waitcnt lgkmcnt(8)
v_mfma_f32_16x16x32_bf16 v[68:71], v[156:159], v[104:107], v[68:71]
ds_read_b64_tr_b16 v[92:93], v26 offset:0
ds_read_b64_tr_b16 v[94:95], v26 offset:256
s_waitcnt lgkmcnt(8)
v_mfma_f32_16x16x32_bf16 v[72:75], v[144:147], v[108:111], v[72:75]
s_add_u32 m0, s63, 0x1000
s_nop 0
buffer_load_dwordx4 v17, s[44:47], s71 offen offset:0 lds
buffer_load_dwordx4 v18, s[44:47], s71 offen offset:1024 lds
v_mfma_f32_16x16x32_bf16 v[76:79], v[148:151], v[108:111], v[76:79]
v_mfma_f32_16x16x32_bf16 v[80:83], v[152:155], v[108:111], v[80:83]
v_mfma_f32_16x16x32_bf16 v[84:87], v[156:159], v[108:111], v[84:87]
ds_read_b128 v[112:115], v31 offset:4096
s_waitcnt vmcnt(2)
ds_read_b64_tr_b16 v[96:97], v25 offset:2048
ds_read_b64_tr_b16 v[98:99], v25 offset:2304
s_waitcnt lgkmcnt(8)
v_mfma_f32_16x16x32_bf16 v[56:59], v[160:163], v[88:91], v[56:59]
ds_read_b128 v[116:119], v31 offset:12288
s_waitcnt lgkmcnt(8)
v_mfma_f32_16x16x32_bf16 v[60:63], v[164:167], v[88:91], v[60:63]
ds_read_b128 v[120:123], v31 offset:20480
s_waitcnt lgkmcnt(8)
v_mfma_f32_16x16x32_bf16 v[64:67], v[168:171], v[88:91], v[64:67]
ds_read_b128 v[124:127], v31 offset:28672
s_waitcnt lgkmcnt(8)
v_mfma_f32_16x16x32_bf16 v[68:71], v[172:175], v[88:91], v[68:71]
ds_read_b64_tr_b16 v[100:101], v26 offset:2048
ds_read_b64_tr_b16 v[102:103], v26 offset:2304
s_waitcnt lgkmcnt(8)
v_mfma_f32_16x16x32_bf16 v[72:75], v[160:163], v[92:95], v[72:75]
s_add_u32 m0, s63, 0x0
s_nop 0
buffer_load_dwordx4 v17, s[44:47], s72 offen offset:0 lds
buffer_load_dwordx4 v18, s[44:47], s72 offen offset:1024 lds
v_mfma_f32_16x16x32_bf16 v[76:79], v[164:167], v[92:95], v[76:79]
v_mfma_f32_16x16x32_bf16 v[80:83], v[168:171], v[92:95], v[80:83]
v_mfma_f32_16x16x32_bf16 v[84:87], v[172:175], v[92:95], v[84:87]
ds_read_b128 v[128:131], v32 offset:5120
s_waitcnt vmcnt(2)
ds_read_b64_tr_b16 v[104:105], v25 offset:4096
ds_read_b64_tr_b16 v[106:107], v25 offset:4352
s_waitcnt lgkmcnt(8)
v_mfma_f32_16x16x32_bf16 v[56:59], v[112:115], v[96:99], v[56:59]
ds_read_b128 v[132:135], v32 offset:13312
s_waitcnt lgkmcnt(8)
v_mfma_f32_16x16x32_bf16 v[60:63], v[116:119], v[96:99], v[60:63]
ds_read_b128 v[136:139], v32 offset:21504
s_waitcnt lgkmcnt(8)
v_mfma_f32_16x16x32_bf16 v[64:67], v[120:123], v[96:99], v[64:67]
ds_read_b128 v[140:143], v32 offset:29696
s_waitcnt lgkmcnt(8)
v_mfma_f32_16x16x32_bf16 v[68:71], v[124:127], v[96:99], v[68:71]
ds_read_b64_tr_b16 v[108:109], v26 offset:4096
ds_read_b64_tr_b16 v[110:111], v26 offset:4352
s_waitcnt lgkmcnt(8)
v_mfma_f32_16x16x32_bf16 v[72:75], v[112:115], v[100:103], v[72:75]
s_add_u32 m0, s63, 0x800
s_nop 0
buffer_load_dwordx4 v17, s[44:47], s73 offen offset:0 lds
buffer_load_dwordx4 v18, s[44:47], s73 offen offset:1024 lds
v_mfma_f32_16x16x32_bf16 v[76:79], v[116:119], v[100:103], v[76:79]
v_mfma_f32_16x16x32_bf16 v[80:83], v[120:123], v[100:103], v[80:83]
v_mfma_f32_16x16x32_bf16 v[84:87], v[124:127], v[100:103], v[84:87]
ds_read_b128 v[144:147], v31 offset:6144
s_waitcnt vmcnt(2)
ds_read_b64_tr_b16 v[88:89], v25 offset:0
ds_read_b64_tr_b16 v[90:91], v25 offset:256
s_waitcnt lgkmcnt(8)
v_mfma_f32_16x16x32_bf16 v[56:59], v[128:131], v[104:107], v[56:59]
ds_read_b128 v[148:151], v31 offset:14336
s_waitcnt lgkmcnt(8)
v_mfma_f32_16x16x32_bf16 v[60:63], v[132:135], v[104:107], v[60:63]
ds_read_b128 v[152:155], v31 offset:22528
s_waitcnt lgkmcnt(8)
v_mfma_f32_16x16x32_bf16 v[64:67], v[136:139], v[104:107], v[64:67]
ds_read_b128 v[156:159], v31 offset:30720
s_waitcnt lgkmcnt(8)
v_mfma_f32_16x16x32_bf16 v[68:71], v[140:143], v[104:107], v[68:71]
ds_read_b64_tr_b16 v[92:93], v26 offset:0
ds_read_b64_tr_b16 v[94:95], v26 offset:256
s_waitcnt lgkmcnt(8)
v_mfma_f32_16x16x32_bf16 v[72:75], v[128:131], v[108:111], v[72:75]
v_mfma_f32_16x16x32_bf16 v[76:79], v[132:135], v[108:111], v[76:79]
v_mfma_f32_16x16x32_bf16 v[80:83], v[136:139], v[108:111], v[80:83]
v_mfma_f32_16x16x32_bf16 v[84:87], v[140:143], v[108:111], v[84:87]
ds_read_b128 v[160:163], v32 offset:7168
s_waitcnt vmcnt(0)
ds_read_b64_tr_b16 v[96:97], v25 offset:2048
ds_read_b64_tr_b16 v[98:99], v25 offset:2304
s_waitcnt lgkmcnt(8)
v_mfma_f32_16x16x32_bf16 v[56:59], v[144:147], v[88:91], v[56:59]
ds_read_b128 v[164:167], v32 offset:15360
s_waitcnt lgkmcnt(8)
v_mfma_f32_16x16x32_bf16 v[60:63], v[148:151], v[88:91], v[60:63]
ds_read_b128 v[168:171], v32 offset:23552
s_waitcnt lgkmcnt(8)
v_mfma_f32_16x16x32_bf16 v[64:67], v[152:155], v[88:91], v[64:67]
ds_read_b128 v[172:175], v32 offset:31744
s_waitcnt lgkmcnt(8)
v_mfma_f32_16x16x32_bf16 v[68:71], v[156:159], v[88:91], v[68:71]
ds_read_b64_tr_b16 v[100:101], v26 offset:2048
ds_read_b64_tr_b16 v[102:103], v26 offset:2304
s_waitcnt lgkmcnt(8)
v_mfma_f32_16x16x32_bf16 v[72:75], v[144:147], v[92:95], v[72:75]
v_mfma_f32_16x16x32_bf16 v[76:79], v[148:151], v[92:95], v[76:79]
v_mfma_f32_16x16x32_bf16 v[80:83], v[152:155], v[92:95], v[80:83]
v_mfma_f32_16x16x32_bf16 v[84:87], v[156:159], v[92:95], v[84:87]
s_waitcnt lgkmcnt(5)
v_mfma_f32_16x16x32_bf16 v[56:59], v[160:163], v[96:99], v[56:59]
s_waitcnt lgkmcnt(4)
v_mfma_f32_16x16x32_bf16 v[60:63], v[164:167], v[96:99], v[60:63]
s_waitcnt lgkmcnt(3)
v_mfma_f32_16x16x32_bf16 v[64:67], v[168:171], v[96:99], v[64:67]
s_waitcnt lgkmcnt(2)
v_mfma_f32_16x16x32_bf16 v[68:71], v[172:175], v[96:99], v[68:71]
s_waitcnt lgkmcnt(0)
v_mfma_f32_16x16x32_bf16 v[72:75], v[160:163], v[100:103], v[72:75]
v_cvt_pk_bf16_f32 v56, v56, v57
v_cvt_pk_bf16_f32 v57, v58, v59
v_cvt_pk_bf16_f32 v58, v60, v61
v_cvt_pk_bf16_f32 v59, v62, v63
buffer_store_dwordx4 v[56:59], v16, s[52:55], s82 offen offset:0 sc1
v_mfma_f32_16x16x32_bf16 v[76:79], v[164:167], v[100:103], v[76:79]
v_mfma_f32_16x16x32_bf16 v[80:83], v[168:171], v[100:103], v[80:83]
v_cvt_pk_bf16_f32 v64, v64, v65
v_cvt_pk_bf16_f32 v65, v66, v67
v_cvt_pk_bf16_f32 v66, v68, v69
v_cvt_pk_bf16_f32 v67, v70, v71
buffer_store_dwordx4 v[64:67], v16, s[52:55], s82 offen offset:2048 sc1
v_mfma_f32_16x16x32_bf16 v[84:87], v[172:175], v[100:103], v[84:87]
v_cvt_pk_bf16_f32 v72, v72, v73
v_cvt_pk_bf16_f32 v73, v74, v75
v_cvt_pk_bf16_f32 v74, v76, v77
v_cvt_pk_bf16_f32 v75, v78, v79
buffer_store_dwordx4 v[72:75], v16, s[52:55], s82 offen offset:1024 sc1
v_cvt_pk_bf16_f32 v80, v80, v81
v_cvt_pk_bf16_f32 v81, v82, v83
s_nop 0
v_cvt_pk_bf16_f32 v82, v84, v85
v_cvt_pk_bf16_f32 v83, v86, v87
buffer_store_dwordx4 v[80:83], v16, s[52:55], s82 offen offset:3072 sc1
s_branch L1_fin
L1_edge:
s_mov_b32 s61, 4
s_mov_b32 s4, s2
s_mul_i32 s6, s4, 20000
v_lshlrev_b32 v5, 4, v0
v_lshlrev_b32 v6, 2, v2
v_add_u32 v6, 0x10000, v6
v_mov_b32 v7, 0
ds_write_b32 v6, v7
s_mov_b32 s66, 0
s_mov_b32 s67, 8192
s_mov_b32 s68, 16384
s_waitcnt lgkmcnt(0)
s_add_u32 s56, s38, 0x7c00000
s_addc_u32 s57, s39, 0
s_mov_b32 s58, 0x2000
s_mov_b32 s59, 0x00020000
s_cmp_eq_u32 s4, 0
s_cselect_b32 s9, 0, 0x7fff0000
v_mov_b32 v8, 0
v_mov_b32 v9, 0
v_mov_b32 v10, 0
v_mov_b32 v11, 0
buffer_store_dwordx4 v[8:11], v5, s[56:59], s9 offen
s_add_u32 s40, s20, 0x0
s_addc_u32 s41, s21, 0
s_add_u32 s40, s40, s6
s_addc_u32 s41, s41, 0
s_mov_b32 s42, 0x4e20
s_mov_b32 s43, 0x00020000
s_add_u32 s44, s18, 0x0
s_addc_u32 s45, s19, 0
s_add_u32 s44, s44, s6
s_addc_u32 s45, s45, 0
s_mov_b32 s46, 0x4e20
s_mov_b32 s47, 0x00020000
buffer_load_dwordx4 v[16:19], v5, s[40:43], s66 offen
buffer_load_dwordx4 v[20:23], v5, s[40:43], s67 offen
buffer_load_dwordx4 v[24:27], v5, s[40:43], s68 offen
buffer_load_dwordx4 v[28:31], v5, s[44:47], s66 offen
buffer_load_dwordx4 v[32:35], v5, s[44:47], s67 offen
buffer_load_dwordx4 v[36:39], v5, s[44:47], s68 offen
s_add_u32 s48, s38, 0x8000000
s_addc_u32 s49, s39, 0
s_mov_b32 s50, 0x2800000
s_mov_b32 s51, 0x00020000
s_add_u32 s52, s38, 0x7800000
s_addc_u32 s53, s39, 0
s_mov_b32 s54, 0x2000
s_mov_b32 s55, 0x00020000
s_mov_b32 s9, 6279
s_mov_b32 s10, 4294967129
s_mov_b32 s11, 0x10000
v_mov_b32 v7, 1
v_cmp_gt_u32 vcc, 0xe2, v0
s_mov_b64 s[12:13], vcc
s_barrier
s_waitcnt vmcnt(5)
v_mul_u32_u24 v40, s9, v16
v_lshrrev_b32 v40, 20, v40
v_lshl_add_u32 v52, v40, 2, s11
ds_add_rtn_u32 v52, v52, v7
v_mad_i32_i24 v16, v40, s10, v16
v_mul_u32_u24 v41, s9, v17
v_lshrrev_b32 v41, 20, v41
v_lshl_add_u32 v53, v41, 2, s11
ds_add_rtn_u32 v53, v53, v7
v_mad_i32_i24 v17, v41, s10, v17
v_mul_u32_u24 v42, s9, v18
v_lshrrev_b32 v42, 20, v42
v_lshl_add_u32 v54, v42, 2, s11
ds_add_rtn_u32 v54, v54, v7
v_mad_i32_i24 v18, v42, s10, v18
v_mul_u32_u24 v43, s9, v19
v_lshrrev_b32 v43, 20, v43
v_lshl_add_u32 v55, v43, 2, s11
ds_add_rtn_u32 v55, v55, v7
v_mad_i32_i24 v19, v43, s10, v19
s_waitcnt vmcnt(4)
v_mul_u32_u24 v44, s9, v20
v_lshrrev_b32 v44, 20, v44
v_lshl_add_u32 v56, v44, 2, s11
ds_add_rtn_u32 v56, v56, v7
v_mad_i32_i24 v20, v44, s10, v20
v_mul_u32_u24 v45, s9, v21
v_lshrrev_b32 v45, 20, v45
v_lshl_add_u32 v57, v45, 2, s11
ds_add_rtn_u32 v57, v57, v7
v_mad_i32_i24 v21, v45, s10, v21
v_mul_u32_u24 v46, s9, v22
v_lshrrev_b32 v46, 20, v46
v_lshl_add_u32 v58, v46, 2, s11
ds_add_rtn_u32 v58, v58, v7
v_mad_i32_i24 v22, v46, s10, v22
v_mul_u32_u24 v47, s9, v23
v_lshrrev_b32 v47, 20, v47
v_lshl_add_u32 v59, v47, 2, s11
ds_add_rtn_u32 v59, v59, v7
v_mad_i32_i24 v23, v47, s10, v23
s_waitcnt vmcnt(3)
s_mov_b64 exec, s[12:13]
v_mul_u32_u24 v48, s9, v24
v_lshrrev_b32 v48, 20, v48
v_lshl_add_u32 v60, v48, 2, s11
ds_add_rtn_u32 v60, v60, v7
v_mad_i32_i24 v24, v48, s10, v24
v_mul_u32_u24 v49, s9, v25
v_lshrrev_b32 v49, 20, v49
v_lshl_add_u32 v61, v49, 2, s11
ds_add_rtn_u32 v61, v61, v7
v_mad_i32_i24 v25, v49, s10, v25
v_mul_u32_u24 v50, s9, v26
v_lshrrev_b32 v50, 20, v50
v_lshl_add_u32 v62, v50, 2, s11
ds_add_rtn_u32 v62, v62, v7
v_mad_i32_i24 v26, v50, s10, v26
v_mul_u32_u24 v51, s9, v27
v_lshrrev_b32 v51, 20, v51
v_lshl_add_u32 v63, v51, 2, s11
ds_add_rtn_u32 v63, v63, v7
v_mad_i32_i24 v27, v51, s10, v27
s_mov_b64 exec, -1
s_waitcnt vmcnt(2) lgkmcnt(4)
v_and_b32 v8, 0x7f, v52
v_lshl_or_b32 v28, v16, 18, v28
v_lshlrev_b32 v8, 2, v8
v_lshl_add_u32 v8, v40, 9, v8
ds_write_b32 v8, v28
v_and_b32 v8, 0x7f, v53
v_lshl_or_b32 v29, v17, 18, v29
v_lshlrev_b32 v8, 2, v8
v_lshl_add_u32 v8, v41, 9, v8
ds_write_b32 v8, v29
v_and_b32 v8, 0x7f, v54
v_lshl_or_b32 v30, v18, 18, v30
v_lshlrev_b32 v8, 2, v8
v_lshl_add_u32 v8, v42, 9, v8
ds_write_b32 v8, v30
v_and_b32 v8, 0x7f, v55
v_lshl_or_b32 v31, v19, 18, v31
v_lshlrev_b32 v8, 2, v8
v_lshl_add_u32 v8, v43, 9, v8
ds_write_b32 v8, v31
s_waitcnt vmcnt(1) lgkmcnt(4)
v_and_b32 v8, 0x7f, v56
v_lshl_or_b32 v32, v20, 18, v32
v_lshlrev_b32 v8, 2, v8
v_lshl_add_u32 v8, v44, 9, v8
ds_write_b32 v8, v32
v_and_b32 v8, 0x7f, v57
v_lshl_or_b32 v33, v21, 18, v33
v_lshlrev_b32 v8, 2, v8
v_lshl_add_u32 v8, v45, 9, v8
ds_write_b32 v8, v33
v_and_b32 v8, 0x7f, v58
v_lshl_or_b32 v34, v22, 18, v34
v_lshlrev_b32 v8, 2, v8
v_lshl_add_u32 v8, v46, 9, v8
ds_write_b32 v8, v34
v_and_b32 v8, 0x7f, v59
v_lshl_or_b32 v35, v23, 18, v35
v_lshlrev_b32 v8, 2, v8
v_lshl_add_u32 v8, v47, 9, v8
ds_write_b32 v8, v35
s_waitcnt vmcnt(0) lgkmcnt(8)
s_mov_b64 exec, s[12:13]
v_and_b32 v8, 0x7f, v60
v_lshl_or_b32 v36, v24, 18, v36
v_lshlrev_b32 v8, 2, v8
v_lshl_add_u32 v8, v48, 9, v8
ds_write_b32 v8, v36
v_and_b32 v8, 0x7f, v61
v_lshl_or_b32 v37, v25, 18, v37
v_lshlrev_b32 v8, 2, v8
v_lshl_add_u32 v8, v49, 9, v8
ds_write_b32 v8, v37
v_and_b32 v8, 0x7f, v62
v_lshl_or_b32 v38, v26, 18, v38
v_lshlrev_b32 v8, 2, v8
v_lshl_add_u32 v8, v50, 9, v8
ds_write_b32 v8, v38
v_and_b32 v8, 0x7f, v63
v_lshl_or_b32 v39, v27, 18, v39
v_lshlrev_b32 v8, 2, v8
v_lshl_add_u32 v8, v51, 9, v8
ds_write_b32 v8, v39
s_mov_b64 exec, -1
s_waitcnt lgkmcnt(0)
s_barrier
ds_read_b32 v8, v6
s_mul_i32 s6, s60, 4096
v_lshlrev_b32 v10, 4, v2
v_add_u32 v9, s6, v10
ds_read_b128 v[64:67], v9 offset:0
ds_read_b128 v[68:71], v9 offset:1024
ds_read_b128 v[72:75], v9 offset:2048
ds_read_b128 v[76:79], v9 offset:3072
v_lshrrev_b32 v11, 5, v2
v_mul_u32_u24 v11, 0x9fe00, v11
v_add_u32 v10, v10, v11
s_mul_i32 s6, s60, 5242880
s_mul_i32 s7, s4, 20480
s_add_u32 s6, s6, s7
v_lshlrev_b32 v9, 7, v2
s_lshl_b32 s8, s4, 2
s_cmp_eq_u32 s60, 0
s_cselect_b32 s8, s8, 0x7fff0000
s_waitcnt lgkmcnt(4)
buffer_store_dword v8, v9, s[52:55], s8 offen sc1
v_cmp_lt_u32 vcc, 0x80, v8
s_cbranch_vccnz L1_eslow
s_waitcnt lgkmcnt(3)
buffer_store_dwordx4 v[64:67], v10, s[48:51], s6 offen sc1
s_add_u32 s6, s6, 1310720
s_waitcnt lgkmcnt(2)
buffer_store_dwordx4 v[68:71], v10, s[48:51], s6 offen sc1
s_add_u32 s6, s6, 1310720
s_waitcnt lgkmcnt(1)
buffer_store_dwordx4 v[72:75], v10, s[48:51], s6 offen sc1
s_add_u32 s6, s6, 1310720
s_waitcnt lgkmcnt(0)
buffer_store_dwordx4 v[76:79], v10, s[48:51], s6 offen sc1
s_add_u32 s6, s6, 1310720
s_branch L1_fin
L1_eslow:
s_mov_b32 s9, 655360
v_mul_u32_u24 v40, s9, v40
v_lshl_add_u32 v40, v52, 2, v40
v_mul_u32_u24 v41, s9, v41
v_lshl_add_u32 v41, v53, 2, v41
v_mul_u32_u24 v42, s9, v42
v_lshl_add_u32 v42, v54, 2, v42
v_mul_u32_u24 v43, s9, v43
v_lshl_add_u32 v43, v55, 2, v43
v_mul_u32_u24 v44, s9, v44
v_lshl_add_u32 v44, v56, 2, v44
v_mul_u32_u24 v45, s9, v45
v_lshl_add_u32 v45, v57, 2, v45
v_mul_u32_u24 v46, s9, v46
v_lshl_add_u32 v46, v58, 2, v46
v_mul_u32_u24 v47, s9, v47
v_lshl_add_u32 v47, v59, 2, v47
v_mul_u32_u24 v48, s9, v48
v_lshl_add_u32 v48, v60, 2, v48
v_mul_u32_u24 v49, s9, v49
v_lshl_add_u32 v49, v61, 2, v49
v_mul_u32_u24 v50, s9, v50
v_lshl_add_u32 v50, v62, 2, v50
v_mul_u32_u24 v51, s9, v51
v_lshl_add_u32 v51, v63, 2, v51
buffer_store_dword v28, v40, s[48:51], s7 offen
buffer_store_dword v29, v41, s[48:51], s7 offen
buffer_store_dword v30, v42, s[48:51], s7 offen
buffer_store_dword v31, v43, s[48:51], s7 offen
buffer_store_dword v32, v44, s[48:51], s7 offen
buffer_store_dword v33, v45, s[48:51], s7 offen
buffer_store_dword v34, v46, s[48:51], s7 offen
buffer_store_dword v35, v47, s[48:51], s7 offen
s_mov_b64 exec, s[12:13]
buffer_store_dword v36, v48, s[48:51], s7 offen
buffer_store_dword v37, v49, s[48:51], s7 offen
buffer_store_dword v38, v50, s[48:51], s7 offen
buffer_store_dword v39, v51, s[48:51], s7 offen
s_mov_b64 exec, -1
L1_fin:
L1_end:
s_endpgm
.globl k2_kernel
.p2align 8
.type k2_kernel,@function
k2_kernel:
s_load_dwordx2 s[4:5], s[0:1], 88
s_load_dwordx2 s[6:7], s[0:1], 0
s_load_dwordx2 s[18:19], s[0:1], 72
s_and_b32 s35, s2, 7
s_lshr_b32 s37, s2, 3
s_cmp_ge_u32 s37, 30
s_cbranch_scc1 LE_start
s_mul_i32 s38, s37, 52
s_lshr_b32 s38, s38, 8
s_mul_i32 s39, s38, 5
s_sub_u32 s39, s37, s39
s_mov_b32 s37, s38
s_mul_i32 s38, s35, 5
s_add_u32 s38, s38, s39
v_lshrrev_b32 v1, 6, v0
v_and_b32 v252, 63, v0
v_lshlrev_b32 v252, 4, v252
v_readfirstlane_b32 s34, v1
s_mov_b32 s50, 0xe1a06800
s_mov_b32 s51, 0x4e608d04
s_mul_i32 s39, s37, 9
s_lshr_b64 s[50:51], s[50:51], s39
s_and_b32 s39, s50, 0x1ff
s_bfe_u32 s49, s50, 0x90009
s_sub_u32 s29, s49, s39
s_lshl_b32 s50, s37, 2
s_lshr_b32 s59, 0x766666, s50
s_and_b32 s59, s59, 15
s_sub_u32 s31, s29, s59
s_lshr_b32 s31, s31, 1
s_sub_u32 s31, s31, 1
s_lshl_b32 s39, s39, 14
s_lshl_b32 s49, s49, 14
s_add_u32 s28, s39, 0x4000
s_cmp_eq_u32 s37, 5
s_cselect_b32 s33, 0xff800000, 0
s_mov_b32 s32, 0xffff
v_and_b32 v2, 63, v0
v_bfe_u32 v3, v2, 3, 2
v_bfe_u32 v4, v2, 2, 1
v_lshlrev_b32 v251, 12, v3
v_lshl_or_b32 v251, v4, 9, v251
v_lshl_or_b32 v251, v1, 7, v251
v_lshrrev_b32 v4, 5, v2
v_lshl_or_b32 v251, v4, 6, v251
v_and_b32 v3, 2, v3
v_and_b32 v4, 3, v2
v_xor_b32 v3, v3, v4
v_lshl_or_b32 v251, v3, 4, v251
s_cmp_eq_u32 s38, 39
s_cbranch_scc1 LT_disp
s_lshl_b32 s30, s34, 12
s_mov_b32 m0, s30
s_waitcnt lgkmcnt(0)
s_add_u32 s12, s4, 0x6800000
s_addc_u32 s13, s5, 0
s_mov_b32 s14, s49
s_mov_b32 s15, 0x00020000
buffer_load_dwordx4 v251, s[12:15], s39 offen offset:0 lds
buffer_load_dwordx4 v251, s[12:15], s39 offen offset:1024 lds
buffer_load_dwordx4 v251, s[12:15], s39 offen offset:2048 lds
buffer_load_dwordx4 v251, s[12:15], s39 offen offset:3072 lds
s_add_u32 m0, s30, 0x4000
s_nop 0
buffer_load_dwordx4 v251, s[12:15], s28 offen offset:0 lds
buffer_load_dwordx4 v251, s[12:15], s28 offen offset:1024 lds
s_add_u32 s8, s4, 0x0
s_addc_u32 s9, s5, 0
s_mov_b32 s10, 0x4e4000
s_mov_b32 s11, 0x00020000
s_mul_i32 s35, s37, 0x600000
s_add_u32 s20, s4, 0x2000000
s_addc_u32 s21, s5, 0
s_add_u32 s20, s20, s35
s_addc_u32 s21, s21, 0
s_mov_b32 s22, 0x4e4000
s_mov_b32 s23, 0x00020000
s_add_u32 s24, s4, 0x6000000
s_addc_u32 s25, s5, 0
s_mov_b32 s26, 0x9c800
s_mov_b32 s27, 0x00020000
s_lshl_b32 s35, s38, 4
s_lshl_b32 s41, s34, 2
s_add_u32 s35, s35, s41
s_mul_i32 s41, s37, 3
s_sub_u32 s42, s34, s41
s_and_b32 s42, s42, 3
s_add_u32 s41, s41, s42
s_lshr_b32 s41, s41, 2
s_cmp_eq_u32 s37, 5
s_cselect_b32 s42, 3, s42
s_cmp_lt_u32 s42, 3
s_cselect_b32 s41, s41, 0
s_cselect_b32 s50, 1, 0
s_add_u32 s35, s35, s41
s_lshl_b32 s40, s35, 13
s_lshl_b32 s48, s35, 10
s_lshl_b32 s35, s37, 3
s_add_u32 s48, s48, s35
s_xor_b32 s41, s40, 8192
s_xor_b32 s42, s40, 16384
s_xor_b32 s43, s40, 24576
s_add_u32 s44, s40, 4096
s_add_u32 s45, s41, 4096
s_add_u32 s46, s42, 4096
s_add_u32 s47, s43, 4096
s_mul_i32 s35, s37, 3
s_and_b32 s36, s35, 3
s_lshl_b32 s36, s36, 2
s_lshr_b32 s52, s35, 2
s_add_u32 s36, s36, s52
s_lshl_b32 s52, s38, 4
s_add_u32 s52, s52, s36
s_lshl_b32 s52, s52, 13
s_add_u32 s35, s35, 1
s_and_b32 s36, s35, 3
s_lshl_b32 s36, s36, 2
s_lshr_b32 s53, s35, 2
s_add_u32 s36, s36, s53
s_lshl_b32 s53, s38, 4
s_add_u32 s53, s53, s36
s_lshl_b32 s53, s53, 13
s_add_u32 s35, s35, 1
s_and_b32 s36, s35, 3
s_lshl_b32 s36, s36, 2
s_lshr_b32 s54, s35, 2
s_add_u32 s36, s36, s54
s_lshl_b32 s54, s38, 4
s_add_u32 s54, s54, s36
s_lshl_b32 s54, s54, 13
v_mov_b32 v208, 0
v_mov_b32 v209, 0
v_mov_b32 v210, 0
v_mov_b32 v211, 0
buffer_load_dwordx4 v[0:3], v252, s[8:11], s40 offen offset:0
buffer_load_dwordx4 v[32:35], v252, s[8:11], s41 offen offset:0
v_mfma_f32_32x32x16_bf16 a[0:15], v[208:211], v[208:211], 0
buffer_load_dwordx4 v[64:67], v252, s[8:11], s42 offen offset:0
v_mfma_f32_32x32x16_bf16 a[16:31], v[208:211], v[208:211], 0
buffer_load_dwordx4 v[96:99], v252, s[8:11], s43 offen offset:0
buffer_load_dwordx4 v[4:7], v252, s[8:11], s40 offen offset:1024
v_mfma_f32_32x32x16_bf16 a[32:47], v[208:211], v[208:211], 0
buffer_load_dwordx4 v[36:39], v252, s[8:11], s41 offen offset:1024
v_mfma_f32_32x32x16_bf16 a[48:63], v[208:211], v[208:211], 0
buffer_load_dwordx4 v[68:71], v252, s[8:11], s42 offen offset:1024
buffer_load_dwordx4 v[100:103], v252, s[8:11], s43 offen offset:1024
v_mfma_f32_32x32x16_bf16 a[64:79], v[208:211], v[208:211], 0
buffer_load_dwordx4 v[8:11], v252, s[8:11], s40 offen offset:2048
v_mfma_f32_32x32x16_bf16 a[80:95], v[208:211], v[208:211], 0
buffer_load_dwordx4 v[40:43], v252, s[8:11], s41 offen offset:2048
buffer_load_dwordx4 v[72:75], v252, s[8:11], s42 offen offset:2048
v_mfma_f32_32x32x16_bf16 a[96:111], v[208:211], v[208:211], 0
buffer_load_dwordx4 v[104:107], v252, s[8:11], s43 offen offset:2048
v_mfma_f32_32x32x16_bf16 a[112:127], v[208:211], v[208:211], 0
buffer_load_dwordx4 v[12:15], v252, s[8:11], s40 offen offset:3072
buffer_load_dwordx4 v[44:47], v252, s[8:11], s41 offen offset:3072
v_mfma_f32_32x32x16_bf16 a[128:143], v[208:211], v[208:211], 0
buffer_load_dwordx4 v[76:79], v252, s[8:11], s42 offen offset:3072
v_mfma_f32_32x32x16_bf16 a[144:159], v[208:211], v[208:211], 0
buffer_load_dwordx4 v[108:111], v252, s[8:11], s43 offen offset:3072
buffer_load_dwordx4 v[16:19], v252, s[8:11], s44 offen offset:0
v_mfma_f32_32x32x16_bf16 a[160:175], v[208:211], v[208:211], 0
buffer_load_dwordx4 v[48:51], v252, s[8:11], s45 offen offset:0
v_mfma_f32_32x32x16_bf16 a[176:191], v[208:211], v[208:211], 0
buffer_load_dwordx4 v[80:83], v252, s[8:11], s46 offen offset:0
buffer_load_dwordx4 v[112:115], v252, s[8:11], s47 offen offset:0
v_mfma_f32_32x32x16_bf16 a[192:207], v[208:211], v[208:211], 0
buffer_load_dwordx4 v[20:23], v252, s[8:11], s44 offen offset:1024
v_mfma_f32_32x32x16_bf16 a[208:223], v[208:211], v[208:211], 0
buffer_load_dwordx4 v[52:55], v252, s[8:11], s45 offen offset:1024
buffer_load_dwordx4 v[84:87], v252, s[8:11], s46 offen offset:1024
v_mfma_f32_32x32x16_bf16 a[224:239], v[208:211], v[208:211], 0
buffer_load_dwordx4 v[116:119], v252, s[8:11], s47 offen offset:1024
v_mfma_f32_32x32x16_bf16 a[240:255], v[208:211], v[208:211], 0
v_bfe_u32 v248, v252, 4, 3
v_lshlrev_b32 v248, 6, v248
v_bfe_u32 v253, v252, 7, 1
v_lshl_or_b32 v248, v253, 10, v248
v_bfe_u32 v253, v252, 8, 2
v_lshl_or_b32 v248, v253, 4, v248
v_bfe_u32 v253, v252, 6, 1
v_lshlrev_b32 v253, 5, v253
v_xor_b32 v248, v248, v253
v_and_b32 v249, 0x1c0, v252
v_bfe_u32 v253, v252, 9, 1
v_lshl_or_b32 v249, v253, 10, v249
v_bfe_u32 v253, v252, 8, 1
v_lshl_or_b32 v249, v253, 5, v249
v_bfe_u32 v253, v252, 4, 2
v_lshl_or_b32 v249, v253, 3, v249
v_xor_b32 v250, 32, v249
s_waitcnt vmcnt(24)
s_barrier
ds_read_b128 v[224:227], v248 offset:0
ds_read_b128 v[228:231], v248 offset:512
ds_read_b128 v[232:235], v248 offset:2048
ds_read_b128 v[236:239], v248 offset:2560
s_waitcnt lgkmcnt(2)
s_waitcnt vmcnt(16)
v_mfma_f32_16x16x32_bf16 v[160:163], v[224:227], v[0:3], 0
ds_read_b128 v[240:243], v248 offset:16384
v_mfma_f32_16x16x32_bf16 v[160:163], v[228:231], v[4:7], v[160:163]
buffer_load_dwordx4 v[24:27], v252, s[8:11], s44 offen offset:2048
v_mfma_f32_16x16x32_bf16 v[164:167], v[224:227], v[32:35], 0
v_mfma_f32_16x16x32_bf16 v[164:167], v[228:231], v[36:39], v[164:167]
buffer_load_dwordx4 v[56:59], v252, s[8:11], s45 offen offset:2048
v_mfma_f32_16x16x32_bf16 v[168:171], v[224:227], v[64:67], 0
ds_read_b128 v[244:247], v248 offset:16896
v_mfma_f32_16x16x32_bf16 v[168:171], v[228:231], v[68:71], v[168:171]
buffer_load_dwordx4 v[88:91], v252, s[8:11], s46 offen offset:2048
v_mfma_f32_16x16x32_bf16 v[172:175], v[224:227], v[96:99], 0
v_mfma_f32_16x16x32_bf16 v[172:175], v[228:231], v[100:103], v[172:175]
s_waitcnt lgkmcnt(2)
buffer_load_dwordx4 v[120:123], v252, s[8:11], s47 offen offset:2048
v_mfma_f32_16x16x32_bf16 v[176:179], v[232:235], v[0:3], 0
ds_read_b128 v[224:227], v248 offset:4096
v_mfma_f32_16x16x32_bf16 v[176:179], v[236:239], v[4:7], v[176:179]
buffer_load_dwordx4 v[28:31], v252, s[8:11], s44 offen offset:3072
v_mfma_f32_16x16x32_bf16 v[180:183], v[232:235], v[32:35], 0
v_mfma_f32_16x16x32_bf16 v[180:183], v[236:239], v[36:39], v[180:183]
buffer_load_dwordx4 v[60:63], v252, s[8:11], s45 offen offset:3072
v_mfma_f32_16x16x32_bf16 v[184:187], v[232:235], v[64:67], 0
ds_read_b128 v[228:231], v248 offset:4608
v_mfma_f32_16x16x32_bf16 v[184:187], v[236:239], v[68:71], v[184:187]
buffer_load_dwordx4 v[92:95], v252, s[8:11], s46 offen offset:3072
v_mfma_f32_16x16x32_bf16 v[188:191], v[232:235], v[96:99], 0
v_mfma_f32_16x16x32_bf16 v[188:191], v[236:239], v[100:103], v[188:191]
s_waitcnt lgkmcnt(2)
buffer_load_dwordx4 v[124:127], v252, s[8:11], s47 offen offset:3072
v_mfma_f32_16x16x32_bf16 v[192:195], v[240:243], v[0:3], 0
ds_read_b128 v[232:235], v248 offset:6144
v_mfma_f32_16x16x32_bf16 v[192:195], v[244:247], v[4:7], v[192:195]
v_mfma_f32_16x16x32_bf16 v[196:199], v[240:243], v[32:35], 0
v_mfma_f32_16x16x32_bf16 v[196:199], v[244:247], v[36:39], v[196:199]
v_mfma_f32_16x16x32_bf16 v[200:203], v[240:243], v[64:67], 0
ds_read_b128 v[236:239], v248 offset:6656
v_mfma_f32_16x16x32_bf16 v[200:203], v[244:247], v[68:71], v[200:203]
v_mfma_f32_16x16x32_bf16 v[204:207], v[240:243], v[96:99], 0
v_mfma_f32_16x16x32_bf16 v[204:207], v[244:247], v[100:103], v[204:207]
s_waitcnt lgkmcnt(2)
s_waitcnt vmcnt(16)
v_mfma_f32_16x16x32_bf16 v[160:163], v[224:227], v[8:11], v[160:163]
ds_read_b128 v[240:243], v248 offset:20480
v_mfma_f32_16x16x32_bf16 v[160:163], v[228:231], v[12:15], v[160:163]
buffer_load_dwordx4 v251, s[12:15], s28 offen offset:2048 lds
v_mfma_f32_16x16x32_bf16 v[164:167], v[224:227], v[40:43], v[164:167]
v_mfma_f32_16x16x32_bf16 v[164:167], v[228:231], v[44:47], v[164:167]
buffer_load_dwordx4 v251, s[12:15], s28 offen offset:3072 lds
v_mfma_f32_16x16x32_bf16 v[168:171], v[224:227], v[72:75], v[168:171]
ds_read_b128 v[244:247], v248 offset:20992
v_mfma_f32_16x16x32_bf16 v[168:171], v[228:231], v[76:79], v[168:171]
s_add_u32 s28, s28, 0x4000
s_add_u32 m0, s30, 0x8000
s_nop 0
v_mfma_f32_16x16x32_bf16 v[172:175], v[224:227], v[104:107], v[172:175]
v_mfma_f32_16x16x32_bf16 v[172:175], v[228:231], v[108:111], v[172:175]
s_waitcnt lgkmcnt(2)
buffer_load_dwordx4 v251, s[12:15], s28 offen offset:0 lds
v_mfma_f32_16x16x32_bf16 v[176:179], v[232:235], v[8:11], v[176:179]
ds_read_b128 v[224:227], v248 offset:8192
v_mfma_f32_16x16x32_bf16 v[176:179], v[236:239], v[12:15], v[176:179]
buffer_load_dwordx4 v251, s[12:15], s28 offen offset:1024 lds
v_mfma_f32_16x16x32_bf16 v[180:183], v[232:235], v[40:43], v[180:183]
v_mfma_f32_16x16x32_bf16 v[180:183], v[236:239], v[44:47], v[180:183]
buffer_load_dwordx4 v251, s[12:15], s28 offen offset:2048 lds
v_mfma_f32_16x16x32_bf16 v[184:187], v[232:235], v[72:75], v[184:187]
ds_read_b128 v[228:231], v248 offset:8704
v_mfma_f32_16x16x32_bf16 v[184:187], v[236:239], v[76:79], v[184:187]
buffer_load_dwordx4 v251, s[12:15], s28 offen offset:3072 lds
v_mfma_f32_16x16x32_bf16 v[188:191], v[232:235], v[104:107], v[188:191]
v_mfma_f32_16x16x32_bf16 v[188:191], v[236:239], v[108:111], v[188:191]
s_waitcnt lgkmcnt(2)
v_mfma_f32_16x16x32_bf16 v[192:195], v[240:243], v[8:11], v[192:195]
ds_read_b128 v[232:235], v248 offset:10240
v_mfma_f32_16x16x32_bf16 v[192:195], v[244:247], v[12:15], v[192:195]
v_mfma_f32_16x16x32_bf16 v[196:199], v[240:243], v[40:43], v[196:199]
v_mfma_f32_16x16x32_bf16 v[196:199], v[244:247], v[44:47], v[196:199]
v_mfma_f32_16x16x32_bf16 v[200:203], v[240:243], v[72:75], v[200:203]
ds_read_b128 v[236:239], v248 offset:10752
v_mfma_f32_16x16x32_bf16 v[200:203], v[244:247], v[76:79], v[200:203]
v_mfma_f32_16x16x32_bf16 v[204:207], v[240:243], v[104:107], v[204:207]
v_mfma_f32_16x16x32_bf16 v[204:207], v[244:247], v[108:111], v[204:207]
s_waitcnt lgkmcnt(2)
s_waitcnt vmcnt(14)
v_mfma_f32_16x16x32_bf16 v[160:163], v[224:227], v[16:19], v[160:163]
ds_read_b128 v[240:243], v248 offset:24576
v_mfma_f32_16x16x32_bf16 v[160:163], v[228:231], v[20:23], v[160:163]
s_add_u32 s28, s28, 0x4000
s_add_u32 m0, s30, 0xc000
s_nop 0
v_mfma_f32_16x16x32_bf16 v[164:167], v[224:227], v[48:51], v[164:167]
v_mfma_f32_16x16x32_bf16 v[164:167], v[228:231], v[52:55], v[164:167]
buffer_load_dwordx4 v251, s[12:15], s28 offen offset:0 lds
v_mfma_f32_16x16x32_bf16 v[168:171], v[224:227], v[80:83], v[168:171]
ds_read_b128 v[244:247], v248 offset:25088
v_mfma_f32_16x16x32_bf16 v[168:171], v[228:231], v[84:87], v[168:171]
buffer_load_dwordx4 v251, s[12:15], s28 offen offset:1024 lds
v_mfma_f32_16x16x32_bf16 v[172:175], v[224:227], v[112:115], v[172:175]
v_mfma_f32_16x16x32_bf16 v[172:175], v[228:231], v[116:119], v[172:175]
s_waitcnt lgkmcnt(2)
buffer_load_dwordx4 v251, s[12:15], s28 offen offset:2048 lds
v_mfma_f32_16x16x32_bf16 v[176:179], v[232:235], v[16:19], v[176:179]
ds_read_b128 v[224:227], v248 offset:12288
v_mfma_f32_16x16x32_bf16 v[176:179], v[236:239], v[20:23], v[176:179]
buffer_load_dwordx4 v251, s[12:15], s28 offen offset:3072 lds
v_mfma_f32_16x16x32_bf16 v[180:183], v[232:235], v[48:51], v[180:183]
v_mfma_f32_16x16x32_bf16 v[180:183], v[236:239], v[52:55], v[180:183]
v_mfma_f32_16x16x32_bf16 v[184:187], v[232:235], v[80:83], v[184:187]
ds_read_b128 v[228:231], v248 offset:12800
v_mfma_f32_16x16x32_bf16 v[184:187], v[236:239], v[84:87], v[184:187]
v_mfma_f32_16x16x32_bf16 v[188:191], v[232:235], v[112:115], v[188:191]
v_mfma_f32_16x16x32_bf16 v[188:191], v[236:239], v[116:119], v[188:191]
s_waitcnt lgkmcnt(2)
v_mfma_f32_16x16x32_bf16 v[192:195], v[240:243], v[16:19], v[192:195]
ds_read_b128 v[232:235], v248 offset:14336
v_mfma_f32_16x16x32_bf16 v[192:195], v[244:247], v[20:23], v[192:195]
v_mfma_f32_16x16x32_bf16 v[196:199], v[240:243], v[48:51], v[196:199]
v_mfma_f32_16x16x32_bf16 v[196:199], v[244:247], v[52:55], v[196:199]
v_mfma_f32_16x16x32_bf16 v[200:203], v[240:243], v[80:83], v[200:203]
ds_read_b128 v[236:239], v248 offset:14848
v_mfma_f32_16x16x32_bf16 v[200:203], v[244:247], v[84:87], v[200:203]
v_mfma_f32_16x16x32_bf16 v[204:207], v[240:243], v[112:115], v[204:207]
v_mfma_f32_16x16x32_bf16 v[204:207], v[244:247], v[116:119], v[204:207]
s_waitcnt lgkmcnt(2)
s_waitcnt vmcnt(10)
v_mfma_f32_16x16x32_bf16 v[160:163], v[224:227], v[24:27], v[160:163]
ds_read_b128 v[240:243], v248 offset:28672
v_mfma_f32_16x16x32_bf16 v[160:163], v[228:231], v[28:31], v[160:163]
s_add_u32 s28, s28, 0x4000
s_add_u32 m0, s30, 0x10000
s_nop 0
v_mfma_f32_16x16x32_bf16 v[164:167], v[224:227], v[56:59], v[164:167]
v_mfma_f32_16x16x32_bf16 v[164:167], v[228:231], v[60:63], v[164:167]
buffer_load_dwordx4 v251, s[12:15], s28 offen offset:0 lds
v_mfma_f32_16x16x32_bf16 v[168:171], v[224:227], v[88:91], v[168:171]
ds_read_b128 v[244:247], v248 offset:29184
v_mfma_f32_16x16x32_bf16 v[168:171], v[228:231], v[92:95], v[168:171]
buffer_load_dwordx4 v251, s[12:15], s28 offen offset:1024 lds
v_mfma_f32_16x16x32_bf16 v[172:175], v[224:227], v[120:123], v[172:175]
v_mfma_f32_16x16x32_bf16 v[172:175], v[228:231], v[124:127], v[172:175]
s_waitcnt lgkmcnt(2)
buffer_load_dwordx4 v251, s[12:15], s28 offen offset:2048 lds
v_mfma_f32_16x16x32_bf16 v[176:179], v[232:235], v[24:27], v[176:179]
v_mfma_f32_16x16x32_bf16 v[176:179], v[236:239], v[28:31], v[176:179]
buffer_load_dwordx4 v251, s[12:15], s28 offen offset:3072 lds
v_mfma_f32_16x16x32_bf16 v[180:183], v[232:235], v[56:59], v[180:183]
v_mfma_f32_16x16x32_bf16 v[180:183], v[236:239], v[60:63], v[180:183]
v_mfma_f32_16x16x32_bf16 v[184:187], v[232:235], v[88:91], v[184:187]
v_mfma_f32_16x16x32_bf16 v[184:187], v[236:239], v[92:95], v[184:187]
v_mfma_f32_16x16x32_bf16 v[188:191], v[232:235], v[120:123], v[188:191]
v_mfma_f32_16x16x32_bf16 v[188:191], v[236:239], v[124:127], v[188:191]
s_waitcnt lgkmcnt(0)
v_mfma_f32_16x16x32_bf16 v[192:195], v[240:243], v[24:27], v[192:195]
v_mfma_f32_16x16x32_bf16 v[192:195], v[244:247], v[28:31], v[192:195]
v_mfma_f32_16x16x32_bf16 v[196:199], v[240:243], v[56:59], v[196:199]
v_mfma_f32_16x16x32_bf16 v[196:199], v[244:247], v[60:63], v[196:199]
v_mfma_f32_16x16x32_bf16 v[200:203], v[240:243], v[88:91], v[200:203]
v_mfma_f32_16x16x32_bf16 v[200:203], v[244:247], v[92:95], v[200:203]
v_mfma_f32_16x16x32_bf16 v[204:207], v[240:243], v[120:123], v[204:207]
v_mfma_f32_16x16x32_bf16 v[204:207], v[244:247], v[124:127], v[204:207]
s_nop 3
v_max3_f32 v224, v160, v161, v162
v_max3_f32 v225, v164, v165, v166
v_max3_f32 v226, v168, v169, v170
v_max3_f32 v227, v172, v173, v174
v_max3_f32 v224, v224, v163, v176
v_max3_f32 v225, v225, v167, v180
v_max3_f32 v226, v226, v171, v184
v_max3_f32 v227, v227, v175, v188
v_max3_f32 v224, v224, v177, v178
v_max3_f32 v225, v225, v181, v182
v_max3_f32 v226, v226, v185, v186
v_max3_f32 v227, v227, v189, v190
v_max_f32 v224, v224, v179
v_max_f32 v225, v225, v183
v_max_f32 v226, v226, v187
v_max_f32 v227, v227, v191
s_add_u32 s28, s28, 0x4000
s_xor_b32 s30, s30, 0x10000
v_mov_b32 v228, v224
v_mov_b32 v229, v225
v_mov_b32 v230, v226
v_mov_b32 v231, v227
v_permlane32_swap_b32 v224, v228
v_permlane32_swap_b32 v225, v229
v_permlane32_swap_b32 v226, v230
v_permlane32_swap_b32 v227, v231
v_max_f32 v224, v224, v228
v_max_f32 v225, v225, v229
v_max_f32 v226, v226, v230
v_max_f32 v227, v227, v231
v_mov_b32 v228, v224
v_mov_b32 v229, v225
v_mov_b32 v230, v226
v_mov_b32 v231, v227
v_permlane16_swap_b32 v224, v228
v_permlane16_swap_b32 v225, v229
v_permlane16_swap_b32 v226, v230
v_permlane16_swap_b32 v227, v231
v_max_f32 v224, v224, v228
v_max_f32 v225, v225, v229
v_max_f32 v226, v226, v230
v_max_f32 v227, v227, v231
s_waitcnt vmcnt(8)
s_barrier
ds_read_b128 v[232:235], v248 offset:18432
ds_read_b128 v[236:239], v248 offset:18944
ds_read_b128 v[240:243], v248 offset:22528
ds_read_b128 v[244:247], v248 offset:23040
v_cvt_pk_bf16_f32 v228, -v224, -v224
v_cvt_pk_bf16_f32 v229, -v225, -v225
v_cvt_pk_bf16_f32 v230, -v226, -v226
v_cvt_pk_bf16_f32 v231, -v227, -v227
v_lshlrev_b32 v253, 2, v252
v_lshlrev_b32 v147, 16, v228
v_lshlrev_b32 v151, 16, v229
v_lshlrev_b32 v155, 16, v230
v_lshlrev_b32 v159, 16, v231
s_mov_b64 exec, 0xffff
v_bfi_b32 v0, s32, v228, v0
v_bfi_b32 v32, s32, v229, v32
v_bfi_b32 v64, s32, v230, v64
v_bfi_b32 v96, s32, v231, v96
v_xor_b32 v224, 0x80000000, v147
v_xor_b32 v225, 0x80000000, v151
v_xor_b32 v226, 0x80000000, v155
v_xor_b32 v227, 0x80000000, v159
s_xor_b32 s35, s48, 0
buffer_store_dword v224, v253, s[24:27], s35 offen offset:0 sc1
s_xor_b32 s35, s48, 1024
buffer_store_dword v225, v253, s[24:27], s35 offen offset:0 sc1
s_xor_b32 s35, s48, 2048
buffer_store_dword v226, v253, s[24:27], s35 offen offset:0 sc1
s_xor_b32 s35, s48, 3072
buffer_store_dword v227, v253, s[24:27], s35 offen offset:0 sc1
s_mov_b64 exec, -1
s_waitcnt lgkmcnt(2)
v_mfma_f32_16x16x32_bf16 v[208:211], v[232:235], v[0:3], 0
ds_read_b128 v[224:227], v248 offset:26624
v_add_f32 v192, v192, v147
v_add_f32 v193, v193, v147
v_add_f32 v194, v194, v147
v_mfma_f32_16x16x32_bf16 v[208:211], v[236:239], v[4:7], v[208:211]
v_add_f32 v195, v195, v147
v_exp_f32 v192, v192
v_mfma_f32_16x16x32_bf16 v[212:215], v[232:235], v[32:35], 0
v_exp_f32 v193, v193
v_exp_f32 v194, v194
v_mfma_f32_16x16x32_bf16 v[212:215], v[236:239], v[36:39], v[212:215]
v_exp_f32 v195, v195
v_add_f32 v196, v196, v151
v_add_f32 v197, v197, v151
v_mfma_f32_16x16x32_bf16 v[216:219], v[232:235], v[64:67], 0
ds_read_b128 v[228:231], v248 offset:27136
v_cvt_pk_bf16_f32 v144, v192, v193
v_cvt_pk_bf16_f32 v145, v194, v195
v_add_f32 v198, v198, v151
v_mfma_f32_16x16x32_bf16 v[216:219], v[236:239], v[68:71], v[216:219]
v_add_f32 v199, v199, v151
v_exp_f32 v196, v196
v_mfma_f32_16x16x32_bf16 v[220:223], v[232:235], v[96:99], 0
v_exp_f32 v197, v197
v_exp_f32 v198, v198
v_mfma_f32_16x16x32_bf16 v[220:223], v[236:239], v[100:103], v[220:223]
s_waitcnt lgkmcnt(2)
v_exp_f32 v199, v199
v_cvt_pk_bf16_f32 v148, v196, v197
v_mfma_f32_16x16x32_bf16 v[208:211], v[240:243], v[8:11], v[208:211]
ds_read_b128 v[232:235], v248 offset:30720
v_cvt_pk_bf16_f32 v149, v198, v199
v_add_f32 v200, v200, v155
v_add_f32 v201, v201, v155
v_mfma_f32_16x16x32_bf16 v[208:211], v[244:247], v[12:15], v[208:211]
v_add_f32 v202, v202, v155
v_add_f32 v203, v203, v155
v_exp_f32 v200, v200
v_mfma_f32_16x16x32_bf16 v[212:215], v[240:243], v[40:43], v[212:215]
v_exp_f32 v201, v201
v_exp_f32 v202, v202
v_mfma_f32_16x16x32_bf16 v[212:215], v[244:247], v[44:47], v[212:215]
v_exp_f32 v203, v203
v_add_f32 v204, v204, v159
v_add_f32 v205, v205, v159
v_mfma_f32_16x16x32_bf16 v[216:219], v[240:243], v[72:75], v[216:219]
ds_read_b128 v[236:239], v248 offset:31232
v_cvt_pk_bf16_f32 v152, v200, v201
v_cvt_pk_bf16_f32 v153, v202, v203
v_add_f32 v206, v206, v159
v_mfma_f32_16x16x32_bf16 v[216:219], v[244:247], v[76:79], v[216:219]
v_add_f32 v207, v207, v159
v_exp_f32 v204, v204
v_mfma_f32_16x16x32_bf16 v[220:223], v[240:243], v[104:107], v[220:223]
v_exp_f32 v205, v205
v_exp_f32 v206, v206
v_mfma_f32_16x16x32_bf16 v[220:223], v[244:247], v[108:111], v[220:223]
s_waitcnt lgkmcnt(2)
v_exp_f32 v207, v207
v_cvt_pk_bf16_f32 v156, v204, v205
v_mfma_f32_16x16x32_bf16 v[208:211], v[224:227], v[16:19], v[208:211]
ds_read_b128 v[240:243], v248 offset:32768
v_cvt_pk_bf16_f32 v157, v206, v207
v_add_f32 v160, v160, v147
v_add_f32 v161, v161, v147
v_mfma_f32_16x16x32_bf16 v[208:211], v[228:231], v[20:23], v[208:211]
v_add_f32 v162, v162, v147
v_add_f32 v163, v163, v147
v_exp_f32 v160, v160
v_mfma_f32_16x16x32_bf16 v[212:215], v[224:227], v[48:51], v[212:215]
v_exp_f32 v161, v161
v_exp_f32 v162, v162
v_mfma_f32_16x16x32_bf16 v[212:215], v[228:231], v[52:55], v[212:215]
v_exp_f32 v163, v163
v_add_f32 v164, v164, v151
v_add_f32 v165, v165, v151
v_mfma_f32_16x16x32_bf16 v[216:219], v[224:227], v[80:83], v[216:219]
ds_read_b128 v[244:247], v248 offset:33280
v_cvt_pk_bf16_f32 v128, v160, v161
v_cvt_pk_bf16_f32 v129, v162, v163
v_add_f32 v166, v166, v151
v_mfma_f32_16x16x32_bf16 v[216:219], v[228:231], v[84:87], v[216:219]
v_add_f32 v167, v167, v151
v_exp_f32 v164, v164
v_mfma_f32_16x16x32_bf16 v[220:223], v[224:227], v[112:115], v[220:223]
v_exp_f32 v165, v165
v_exp_f32 v166, v166
v_mfma_f32_16x16x32_bf16 v[220:223], v[228:231], v[116:119], v[220:223]
s_waitcnt lgkmcnt(2)
v_exp_f32 v167, v167
v_cvt_pk_bf16_f32 v132, v164, v165
v_mfma_f32_16x16x32_bf16 v[208:211], v[232:235], v[24:27], v[208:211]
ds_read_b128 v[224:227], v248 offset:36864
v_cvt_pk_bf16_f32 v133, v166, v167
v_add_f32 v168, v168, v155
v_add_f32 v169, v169, v155
v_mfma_f32_16x16x32_bf16 v[208:211], v[236:239], v[28:31], v[208:211]
v_add_f32 v170, v170, v155
v_add_f32 v171, v171, v155
v_exp_f32 v168, v168
v_mfma_f32_16x16x32_bf16 v[212:215], v[232:235], v[56:59], v[212:215]
v_exp_f32 v169, v169
v_exp_f32 v170, v170
v_mfma_f32_16x16x32_bf16 v[212:215], v[236:239], v[60:63], v[212:215]
v_exp_f32 v171, v171
v_add_f32 v172, v172, v159
v_add_f32 v173, v173, v159
v_mfma_f32_16x16x32_bf16 v[216:219], v[232:235], v[88:91], v[216:219]
ds_read_b128 v[228:231], v248 offset:37376
v_cvt_pk_bf16_f32 v136, v168, v169
v_cvt_pk_bf16_f32 v137, v170, v171
v_add_f32 v174, v174, v159
v_mfma_f32_16x16x32_bf16 v[216:219], v[236:239], v[92:95], v[216:219]
v_add_f32 v175, v175, v159
v_exp_f32 v172, v172
v_mfma_f32_16x16x32_bf16 v[220:223], v[232:235], v[120:123], v[220:223]
v_exp_f32 v173, v173
v_exp_f32 v174, v174
v_mfma_f32_16x16x32_bf16 v[220:223], v[236:239], v[124:127], v[220:223]
s_waitcnt lgkmcnt(2)
v_exp_f32 v175, v175
v_cvt_pk_bf16_f32 v140, v172, v173
v_mfma_f32_16x16x32_bf16 v[192:195], v[240:243], v[0:3], 0
ds_read_b128 v[232:235], v248 offset:40960
v_cvt_pk_bf16_f32 v141, v174, v175
v_add_f32 v176, v176, v147
v_add_f32 v177, v177, v147
v_mfma_f32_16x16x32_bf16 v[192:195], v[244:247], v[4:7], v[192:195]
v_add_f32 v178, v178, v147
v_add_f32 v179, v179, v147
v_exp_f32 v176, v176
v_mfma_f32_16x16x32_bf16 v[196:199], v[240:243], v[32:35], 0
v_exp_f32 v177, v177
v_exp_f32 v178, v178
v_mfma_f32_16x16x32_bf16 v[196:199], v[244:247], v[36:39], v[196:199]
v_exp_f32 v179, v179
v_add_f32 v180, v180, v151
v_add_f32 v181, v181, v151
v_mfma_f32_16x16x32_bf16 v[200:203], v[240:243], v[64:67], 0
ds_read_b128 v[236:239], v248 offset:41472
v_cvt_pk_bf16_f32 v130, v176, v177
v_cvt_pk_bf16_f32 v131, v178, v179
v_add_f32 v182, v182, v151
v_mfma_f32_16x16x32_bf16 v[200:203], v[244:247], v[68:71], v[200:203]
v_add_f32 v183, v183, v151
v_exp_f32 v180, v180
v_mfma_f32_16x16x32_bf16 v[204:207], v[240:243], v[96:99], 0
v_exp_f32 v181, v181
v_exp_f32 v182, v182
v_mfma_f32_16x16x32_bf16 v[204:207], v[244:247], v[100:103], v[204:207]
s_waitcnt lgkmcnt(2)
v_exp_f32 v183, v183
v_cvt_pk_bf16_f32 v134, v180, v181
v_mfma_f32_16x16x32_bf16 v[192:195], v[224:227], v[8:11], v[192:195]
ds_read_b128 v[240:243], v248 offset:45056
v_cvt_pk_bf16_f32 v135, v182, v183
v_add_f32 v184, v184, v155
v_add_f32 v185, v185, v155
v_mfma_f32_16x16x32_bf16 v[192:195], v[228:231], v[12:15], v[192:195]
v_add_f32 v186, v186, v155
v_add_f32 v187, v187, v155
v_exp_f32 v184, v184
v_mfma_f32_16x16x32_bf16 v[196:199], v[224:227], v[40:43], v[196:199]
v_exp_f32 v185, v185
v_exp_f32 v186, v186
v_mfma_f32_16x16x32_bf16 v[196:199], v[228:231], v[44:47], v[196:199]
v_exp_f32 v187, v187
v_add_f32 v188, v188, v159
v_add_f32 v189, v189, v159
v_mfma_f32_16x16x32_bf16 v[200:203], v[224:227], v[72:75], v[200:203]
ds_read_b128 v[244:247], v248 offset:45568
v_cvt_pk_bf16_f32 v138, v184, v185
v_cvt_pk_bf16_f32 v139, v186, v187
v_add_f32 v190, v190, v159
v_mfma_f32_16x16x32_bf16 v[200:203], v[228:231], v[76:79], v[200:203]
v_add_f32 v191, v191, v159
v_exp_f32 v188, v188
v_mfma_f32_16x16x32_bf16 v[204:207], v[224:227], v[104:107], v[204:207]
v_exp_f32 v189, v189
v_exp_f32 v190, v190
v_mfma_f32_16x16x32_bf16 v[204:207], v[228:231], v[108:111], v[204:207]
s_waitcnt lgkmcnt(2)
v_exp_f32 v191, v191
v_cvt_pk_bf16_f32 v142, v188, v189
v_mfma_f32_16x16x32_bf16 v[192:195], v[232:235], v[16:19], v[192:195]
ds_read_b64_tr_b16 v[224:225], v249 offset:0
v_cvt_pk_bf16_f32 v143, v190, v191
v_exp_f32 v208, v208
v_mfma_f32_16x16x32_bf16 v[192:195], v[236:239], v[20:23], v[192:195]
v_exp_f32 v209, v209
v_exp_f32 v210, v210
v_mfma_f32_16x16x32_bf16 v[196:199], v[232:235], v[48:51], v[196:199]
ds_read_b64_tr_b16 v[226:227], v249 offset:2048
v_exp_f32 v211, v211
v_cvt_pk_bf16_f32 v146, v208, v209
v_mfma_f32_16x16x32_bf16 v[196:199], v[236:239], v[52:55], v[196:199]
v_cvt_pk_bf16_f32 v147, v210, v211
v_exp_f32 v212, v212
v_mfma_f32_16x16x32_bf16 v[200:203], v[232:235], v[80:83], v[200:203]
ds_read_b64_tr_b16 v[228:229], v249 offset:16384
v_exp_f32 v213, v213
v_mfma_f32_16x16x32_bf16 v[200:203], v[236:239], v[84:87], v[200:203]
v_exp_f32 v214, v214
v_exp_f32 v215, v215
v_mfma_f32_16x16x32_bf16 v[204:207], v[232:235], v[112:115], v[204:207]
ds_read_b64_tr_b16 v[230:231], v249 offset:18432
v_cvt_pk_bf16_f32 v150, v212, v213
v_cvt_pk_bf16_f32 v151, v214, v215
v_mfma_f32_16x16x32_bf16 v[204:207], v[236:239], v[116:119], v[204:207]
s_waitcnt lgkmcnt(4)
v_exp_f32 v216, v216
v_mfma_f32_16x16x32_bf16 v[192:195], v[240:243], v[24:27], v[192:195]
ds_read_b64_tr_b16 v[232:233], v250 offset:0
v_exp_f32 v217, v217
v_mfma_f32_16x16x32_bf16 v[192:195], v[244:247], v[28:31], v[192:195]
v_exp_f32 v218, v218
v_exp_f32 v219, v219
v_mfma_f32_16x16x32_bf16 v[196:199], v[240:243], v[56:59], v[196:199]
ds_read_b64_tr_b16 v[234:235], v250 offset:2048
v_cvt_pk_bf16_f32 v154, v216, v217
v_cvt_pk_bf16_f32 v155, v218, v219
v_mfma_f32_16x16x32_bf16 v[196:199], v[244:247], v[60:63], v[196:199]
v_exp_f32 v220, v220
v_exp_f32 v221, v221
v_mfma_f32_16x16x32_bf16 v[200:203], v[240:243], v[88:91], v[200:203]
ds_read_b64_tr_b16 v[236:237], v250 offset:16384
v_exp_f32 v222, v222
v_cvt_pk_bf16_f32 v158, v220, v221
v_mfma_f32_16x16x32_bf16 v[200:203], v[244:247], v[92:95], v[200:203]
v_exp_f32 v223, v223
v_mfma_f32_16x16x32_bf16 v[204:207], v[240:243], v[120:123], v[204:207]
ds_read_b64_tr_b16 v[238:239], v250 offset:18432
v_cvt_pk_bf16_f32 v159, v222, v223
v_mfma_f32_16x16x32_bf16 v[204:207], v[244:247], v[124:127], v[204:207]
s_cmp_eq_u32 s50, 1
s_cselect_b32 s40, 0x7fff0000, s40
s_cselect_b32 s44, 0x7fff0000, s44
.p2align 6
L2_loop:
s_waitcnt lgkmcnt(4)
v_mfma_f32_16x16x32_bf16 a[0:3], v[224:227], v[128:131], a[0:3]
ds_read_b64_tr_b16 v[240:241], v249 offset:512
v_mfma_f32_16x16x32_bf16 a[0:3], v[228:231], v[144:147], a[0:3]
v_mfma_f32_16x16x32_bf16 a[4:7], v[224:227], v[132:135], a[4:7]
ds_read_b64_tr_b16 v[242:243], v249 offset:2560
v_mfma_f32_16x16x32_bf16 a[4:7], v[228:231], v[148:151], a[4:7]
v_exp_f32 v192, v192
v_mfma_f32_16x16x32_bf16 a[8:11], v[224:227], v[136:139], a[8:11]
ds_read_b64_tr_b16 v[244:245], v249 offset:16896
v_mfma_f32_16x16x32_bf16 a[8:11], v[228:231], v[152:155], a[8:11]
v_exp_f32 v193, v193
v_mfma_f32_16x16x32_bf16 a[12:15], v[224:227], v[140:143], a[12:15]
ds_read_b64_tr_b16 v[246:247], v249 offset:18944
v_cvt_pk_bf16_f32 v160, v192, v193
v_mfma_f32_16x16x32_bf16 a[12:15], v[228:231], v[156:159], a[12:15]
s_waitcnt lgkmcnt(4)
v_mfma_f32_16x16x32_bf16 a[16:19], v[232:235], v[128:131], a[16:19]
ds_read_b64_tr_b16 v[176:177], v250 offset:512
v_mfma_f32_16x16x32_bf16 a[16:19], v[236:239], v[144:147], a[16:19]
v_exp_f32 v194, v194
v_mfma_f32_16x16x32_bf16 a[20:23], v[232:235], v[132:135], a[20:23]
ds_read_b64_tr_b16 v[178:179], v250 offset:2560
v_mfma_f32_16x16x32_bf16 a[20:23], v[236:239], v[148:151], a[20:23]
v_exp_f32 v195, v195
v_mfma_f32_16x16x32_bf16 a[24:27], v[232:235], v[136:139], a[24:27]
ds_read_b64_tr_b16 v[180:181], v250 offset:16896
v_cvt_pk_bf16_f32 v161, v194, v195
v_mfma_f32_16x16x32_bf16 a[24:27], v[236:239], v[152:155], a[24:27]
v_exp_f32 v196, v196
v_mfma_f32_16x16x32_bf16 a[28:31], v[232:235], v[140:143], a[28:31]
ds_read_b64_tr_b16 v[182:183], v250 offset:18944
v_mfma_f32_16x16x32_bf16 a[28:31], v[236:239], v[156:159], a[28:31]
s_waitcnt lgkmcnt(4)
v_mfma_f32_16x16x32_bf16 a[32:35], v[240:243], v[128:131], a[32:35]
ds_read_b128 v[224:227], v248 offset:34816
v_mfma_f32_16x16x32_bf16 a[32:35], v[244:247], v[144:147], a[32:35]
v_exp_f32 v197, v197
v_mfma_f32_16x16x32_bf16 a[36:39], v[240:243], v[132:135], a[36:39]
v_exp_f32 v198, v198
v_mfma_f32_16x16x32_bf16 a[36:39], v[244:247], v[148:151], a[36:39]
v_exp_f32 v199, v199
v_mfma_f32_16x16x32_bf16 a[40:43], v[240:243], v[136:139], a[40:43]
ds_read_b128 v[228:231], v248 offset:35328
v_cvt_pk_bf16_f32 v164, v196, v197
v_mfma_f32_16x16x32_bf16 a[40:43], v[244:247], v[152:155], a[40:43]
v_cvt_pk_bf16_f32 v165, v198, v199
v_mfma_f32_16x16x32_bf16 a[44:47], v[240:243], v[140:143], a[44:47]
v_exp_f32 v200, v200
v_mfma_f32_16x16x32_bf16 a[44:47], v[244:247], v[156:159], a[44:47]
s_waitcnt lgkmcnt(2)
v_mfma_f32_16x16x32_bf16 a[48:51], v[176:179], v[128:131], a[48:51]
ds_read_b128 v[232:235], v248 offset:38912
v_mfma_f32_16x16x32_bf16 a[48:51], v[180:183], v[144:147], a[48:51]
v_exp_f32 v201, v201
v_mfma_f32_16x16x32_bf16 a[52:55], v[176:179], v[132:135], a[52:55]
v_exp_f32 v202, v202
v_mfma_f32_16x16x32_bf16 a[52:55], v[180:183], v[148:151], a[52:55]
v_exp_f32 v203, v203
v_mfma_f32_16x16x32_bf16 a[56:59], v[176:179], v[136:139], a[56:59]
ds_read_b128 v[236:239], v248 offset:39424
v_cvt_pk_bf16_f32 v168, v200, v201
v_mfma_f32_16x16x32_bf16 a[56:59], v[180:183], v[152:155], a[56:59]
v_cvt_pk_bf16_f32 v169, v202, v203
v_mfma_f32_16x16x32_bf16 a[60:63], v[176:179], v[140:143], a[60:63]
v_exp_f32 v204, v204
v_mfma_f32_16x16x32_bf16 a[60:63], v[180:183], v[156:159], a[60:63]
s_waitcnt lgkmcnt(2)
v_mfma_f32_16x16x32_bf16 v[208:211], v[224:227], v[0:3], 0
ds_read_b128 v[240:243], v248 offset:43008
v_mfma_f32_16x16x32_bf16 v[208:211], v[228:231], v[4:7], v[208:211]
v_exp_f32 v205, v205
v_mfma_f32_16x16x32_bf16 v[212:215], v[224:227], v[32:35], 0
v_exp_f32 v206, v206
v_mfma_f32_16x16x32_bf16 v[212:215], v[228:231], v[36:39], v[212:215]
v_exp_f32 v207, v207
v_mfma_f32_16x16x32_bf16 v[216:219], v[224:227], v[64:67], 0
ds_read_b128 v[244:247], v248 offset:43520
v_cvt_pk_bf16_f32 v172, v204, v205
v_mfma_f32_16x16x32_bf16 v[216:219], v[228:231], v[68:71], v[216:219]
v_cvt_pk_bf16_f32 v173, v206, v207
v_mfma_f32_16x16x32_bf16 v[220:223], v[224:227], v[96:99], 0
v_mfma_f32_16x16x32_bf16 v[220:223], v[228:231], v[100:103], v[220:223]
s_waitcnt lgkmcnt(2)
v_mfma_f32_16x16x32_bf16 v[208:211], v[232:235], v[8:11], v[208:211]
ds_read_b128 v[176:179], v248 offset:47104
v_mfma_f32_16x16x32_bf16 v[208:211], v[236:239], v[12:15], v[208:211]
v_mfma_f32_16x16x32_bf16 v[212:215], v[232:235], v[40:43], v[212:215]
v_mfma_f32_16x16x32_bf16 v[212:215], v[236:239], v[44:47], v[212:215]
v_mfma_f32_16x16x32_bf16 v[216:219], v[232:235], v[72:75], v[216:219]
ds_read_b128 v[180:183], v248 offset:47616
v_mfma_f32_16x16x32_bf16 v[216:219], v[236:239], v[76:79], v[216:219]
v_mfma_f32_16x16x32_bf16 v[220:223], v[232:235], v[104:107], v[220:223]
v_mfma_f32_16x16x32_bf16 v[220:223], v[236:239], v[108:111], v[220:223]
s_waitcnt lgkmcnt(2)
v_mfma_f32_16x16x32_bf16 v[208:211], v[240:243], v[16:19], v[208:211]
ds_read_b64_tr_b16 v[224:225], v249 offset:4096
v_mfma_f32_16x16x32_bf16 v[208:211], v[244:247], v[20:23], v[208:211]
v_mfma_f32_16x16x32_bf16 v[212:215], v[240:243], v[48:51], v[212:215]
ds_read_b64_tr_b16 v[226:227], v249 offset:6144
v_mfma_f32_16x16x32_bf16 v[212:215], v[244:247], v[52:55], v[212:215]
v_mfma_f32_16x16x32_bf16 v[216:219], v[240:243], v[80:83], v[216:219]
ds_read_b64_tr_b16 v[228:229], v249 offset:20480
v_mfma_f32_16x16x32_bf16 v[216:219], v[244:247], v[84:87], v[216:219]
v_mfma_f32_16x16x32_bf16 v[220:223], v[240:243], v[112:115], v[220:223]
ds_read_b64_tr_b16 v[230:231], v249 offset:22528
v_mfma_f32_16x16x32_bf16 v[220:223], v[244:247], v[116:119], v[220:223]
s_waitcnt lgkmcnt(4)
v_mfma_f32_16x16x32_bf16 v[208:211], v[176:179], v[24:27], v[208:211]
ds_read_b64_tr_b16 v[232:233], v250 offset:4096
v_mfma_f32_16x16x32_bf16 v[208:211], v[180:183], v[28:31], v[208:211]
v_mfma_f32_16x16x32_bf16 v[212:215], v[176:179], v[56:59], v[212:215]
ds_read_b64_tr_b16 v[234:235], v250 offset:6144
v_mfma_f32_16x16x32_bf16 v[212:215], v[180:183], v[60:63], v[212:215]
v_mfma_f32_16x16x32_bf16 v[216:219], v[176:179], v[88:91], v[216:219]
ds_read_b64_tr_b16 v[236:237], v250 offset:20480
v_mfma_f32_16x16x32_bf16 v[216:219], v[180:183], v[92:95], v[216:219]
v_mfma_f32_16x16x32_bf16 v[220:223], v[176:179], v[120:123], v[220:223]
ds_read_b64_tr_b16 v[238:239], v250 offset:22528
v_mfma_f32_16x16x32_bf16 v[220:223], v[180:183], v[124:127], v[220:223]
s_waitcnt lgkmcnt(4)
v_mfma_f32_16x16x32_bf16 a[64:67], v[224:227], v[128:131], a[64:67]
ds_read_b64_tr_b16 v[240:241], v249 offset:4608
v_mfma_f32_16x16x32_bf16 a[64:67], v[228:231], v[144:147], a[64:67]
v_mfma_f32_16x16x32_bf16 a[68:71], v[224:227], v[132:135], a[68:71]
ds_read_b64_tr_b16 v[242:243], v249 offset:6656
v_mfma_f32_16x16x32_bf16 a[68:71], v[228:231], v[148:151], a[68:71]
v_exp_f32 v208, v208
v_mfma_f32_16x16x32_bf16 a[72:75], v[224:227], v[136:139], a[72:75]
ds_read_b64_tr_b16 v[244:245], v249 offset:20992
v_mfma_f32_16x16x32_bf16 a[72:75], v[228:231], v[152:155], a[72:75]
v_exp_f32 v209, v209
v_mfma_f32_16x16x32_bf16 a[76:79], v[224:227], v[140:143], a[76:79]
ds_read_b64_tr_b16 v[246:247], v249 offset:23040
v_cvt_pk_bf16_f32 v162, v208, v209
v_mfma_f32_16x16x32_bf16 a[76:79], v[228:231], v[156:159], a[76:79]
s_waitcnt lgkmcnt(4)
s_waitcnt vmcnt(0)
s_barrier
s_add_u32 m0, s30, 0x4000
v_mfma_f32_16x16x32_bf16 a[80:83], v[232:235], v[128:131], a[80:83]
ds_read_b64_tr_b16 v[224:225], v250 offset:4608
v_mfma_f32_16x16x32_bf16 a[80:83], v[236:239], v[144:147], a[80:83]
buffer_load_dwordx4 v251, s[12:15], s28 offen offset:0 lds
v_mfma_f32_16x16x32_bf16 a[84:87], v[232:235], v[132:135], a[84:87]
ds_read_b64_tr_b16 v[226:227], v250 offset:6656
v_mfma_f32_16x16x32_bf16 a[84:87], v[236:239], v[148:151], a[84:87]
v_exp_f32 v210, v210
v_mfma_f32_16x16x32_bf16 a[88:91], v[232:235], v[136:139], a[88:91]
ds_read_b64_tr_b16 v[228:229], v250 offset:20992
v_mfma_f32_16x16x32_bf16 a[88:91], v[236:239], v[152:155], a[88:91]
v_exp_f32 v211, v211
v_mfma_f32_16x16x32_bf16 a[92:95], v[232:235], v[140:143], a[92:95]
ds_read_b64_tr_b16 v[230:231], v250 offset:23040
v_cvt_pk_bf16_f32 v163, v210, v211
v_mfma_f32_16x16x32_bf16 a[92:95], v[236:239], v[156:159], a[92:95]
s_waitcnt lgkmcnt(4)
v_mfma_f32_16x16x32_bf16 a[96:99], v[240:243], v[128:131], a[96:99]
ds_read_b128 v[232:235], v248 offset:49152
v_mfma_f32_16x16x32_bf16 a[96:99], v[244:247], v[144:147], a[96:99]
buffer_load_dwordx4 v251, s[12:15], s28 offen offset:1024 lds
v_mfma_f32_16x16x32_bf16 a[100:103], v[240:243], v[132:135], a[100:103]
v_exp_f32 v212, v212
v_mfma_f32_16x16x32_bf16 a[100:103], v[244:247], v[148:151], a[100:103]
v_exp_f32 v213, v213
v_mfma_f32_16x16x32_bf16 a[104:107], v[240:243], v[136:139], a[104:107]
ds_read_b128 v[236:239], v248 offset:49664
v_cvt_pk_bf16_f32 v166, v212, v213
v_mfma_f32_16x16x32_bf16 a[104:107], v[244:247], v[152:155], a[104:107]
v_exp_f32 v214, v214
v_mfma_f32_16x16x32_bf16 a[108:111], v[240:243], v[140:143], a[108:111]
v_exp_f32 v215, v215
v_mfma_f32_16x16x32_bf16 a[108:111], v[244:247], v[156:159], a[108:111]
s_waitcnt lgkmcnt(2)
v_cvt_pk_bf16_f32 v167, v214, v215
v_mfma_f32_16x16x32_bf16 a[112:115], v[224:227], v[128:131], a[112:115]
ds_read_b128 v[240:243], v248 offset:53248
v_mfma_f32_16x16x32_bf16 a[112:115], v[228:231], v[144:147], a[112:115]
buffer_load_dwordx4 v251, s[12:15], s28 offen offset:2048 lds
v_mfma_f32_16x16x32_bf16 a[116:119], v[224:227], v[132:135], a[116:119]
v_exp_f32 v216, v216
v_mfma_f32_16x16x32_bf16 a[116:119], v[228:231], v[148:151], a[116:119]
v_exp_f32 v217, v217
v_mfma_f32_16x16x32_bf16 a[120:123], v[224:227], v[136:139], a[120:123]
ds_read_b128 v[244:247], v248 offset:53760
v_cvt_pk_bf16_f32 v170, v216, v217
v_mfma_f32_16x16x32_bf16 a[120:123], v[228:231], v[152:155], a[120:123]
v_exp_f32 v218, v218
v_mfma_f32_16x16x32_bf16 a[124:127], v[224:227], v[140:143], a[124:127]
v_exp_f32 v219, v219
v_mfma_f32_16x16x32_bf16 a[124:127], v[228:231], v[156:159], a[124:127]
s_waitcnt lgkmcnt(2)
v_cvt_pk_bf16_f32 v171, v218, v219
v_mfma_f32_16x16x32_bf16 v[192:195], v[232:235], v[0:3], 0
ds_read_b128 v[224:227], v248 offset:57344
v_mfma_f32_16x16x32_bf16 v[192:195], v[236:239], v[4:7], v[192:195]
buffer_load_dwordx4 v251, s[12:15], s28 offen offset:3072 lds
v_mfma_f32_16x16x32_bf16 v[196:199], v[232:235], v[32:35], 0
v_exp_f32 v220, v220
v_mfma_f32_16x16x32_bf16 v[196:199], v[236:239], v[36:39], v[196:199]
s_add_u32 s28, s28, 0x4000
v_mfma_f32_16x16x32_bf16 v[200:203], v[232:235], v[64:67], 0
ds_read_b128 v[228:231], v248 offset:57856
v_mfma_f32_16x16x32_bf16 v[200:203], v[236:239], v[68:71], v[200:203]
v_exp_f32 v221, v221
v_mfma_f32_16x16x32_bf16 v[204:207], v[232:235], v[96:99], 0
v_exp_f32 v222, v222
v_mfma_f32_16x16x32_bf16 v[204:207], v[236:239], v[100:103], v[204:207]
s_waitcnt lgkmcnt(2)
s_add_u32 m0, s30, 0x8000
v_mfma_f32_16x16x32_bf16 v[192:195], v[240:243], v[8:11], v[192:195]
ds_read_b128 v[232:235], v248 offset:61440
v_cvt_pk_bf16_f32 v174, v220, v221
v_mfma_f32_16x16x32_bf16 v[192:195], v[244:247], v[12:15], v[192:195]
buffer_load_dwordx4 v251, s[12:15], s28 offen offset:0 lds
v_mfma_f32_16x16x32_bf16 v[196:199], v[240:243], v[40:43], v[196:199]
v_exp_f32 v223, v223
v_mfma_f32_16x16x32_bf16 v[196:199], v[244:247], v[44:47], v[196:199]
v_mfma_f32_16x16x32_bf16 v[200:203], v[240:243], v[72:75], v[200:203]
ds_read_b128 v[236:239], v248 offset:61952
v_cvt_pk_bf16_f32 v175, v222, v223
v_mfma_f32_16x16x32_bf16 v[200:203], v[244:247], v[76:79], v[200:203]
v_mfma_f32_16x16x32_bf16 v[204:207], v[240:243], v[104:107], v[204:207]
v_mfma_f32_16x16x32_bf16 v[204:207], v[244:247], v[108:111], v[204:207]
s_waitcnt lgkmcnt(2)
v_mfma_f32_16x16x32_bf16 v[192:195], v[224:227], v[16:19], v[192:195]
ds_read_b64_tr_b16 v[240:241], v249 offset:8192
v_mfma_f32_16x16x32_bf16 v[192:195], v[228:231], v[20:23], v[192:195]
buffer_load_dwordx4 v251, s[12:15], s28 offen offset:1024 lds
v_mfma_f32_16x16x32_bf16 v[196:199], v[224:227], v[48:51], v[196:199]
ds_read_b64_tr_b16 v[242:243], v249 offset:10240
v_mfma_f32_16x16x32_bf16 v[196:199], v[228:231], v[52:55], v[196:199]
v_mfma_f32_16x16x32_bf16 v[200:203], v[224:227], v[80:83], v[200:203]
ds_read_b64_tr_b16 v[244:245], v249 offset:24576
v_mfma_f32_16x16x32_bf16 v[200:203], v[228:231], v[84:87], v[200:203]
v_mfma_f32_16x16x32_bf16 v[204:207], v[224:227], v[112:115], v[204:207]
ds_read_b64_tr_b16 v[246:247], v249 offset:26624
v_mfma_f32_16x16x32_bf16 v[204:207], v[228:231], v[116:119], v[204:207]
s_waitcnt lgkmcnt(4)
v_mfma_f32_16x16x32_bf16 v[192:195], v[232:235], v[24:27], v[192:195]
ds_read_b64_tr_b16 v[224:225], v250 offset:8192
v_mfma_f32_16x16x32_bf16 v[192:195], v[236:239], v[28:31], v[192:195]
buffer_load_dwordx4 v251, s[12:15], s28 offen offset:2048 lds
v_mfma_f32_16x16x32_bf16 v[196:199], v[232:235], v[56:59], v[196:199]
ds_read_b64_tr_b16 v[226:227], v250 offset:10240
v_mfma_f32_16x16x32_bf16 v[196:199], v[236:239], v[60:63], v[196:199]
v_mfma_f32_16x16x32_bf16 v[200:203], v[232:235], v[88:91], v[200:203]
ds_read_b64_tr_b16 v[228:229], v250 offset:24576
v_mfma_f32_16x16x32_bf16 v[200:203], v[236:239], v[92:95], v[200:203]
v_mfma_f32_16x16x32_bf16 v[204:207], v[232:235], v[120:123], v[204:207]
ds_read_b64_tr_b16 v[230:231], v250 offset:26624
v_mfma_f32_16x16x32_bf16 v[204:207], v[236:239], v[124:127], v[204:207]
s_waitcnt lgkmcnt(4)
v_mfma_f32_16x16x32_bf16 a[128:131], v[240:243], v[128:131], a[128:131]
ds_read_b64_tr_b16 v[232:233], v249 offset:8704
v_mfma_f32_16x16x32_bf16 a[128:131], v[244:247], v[144:147], a[128:131]
buffer_load_dwordx4 v251, s[12:15], s28 offen offset:3072 lds
v_mfma_f32_16x16x32_bf16 a[132:135], v[240:243], v[132:135], a[132:135]
ds_read_b64_tr_b16 v[234:235], v249 offset:10752
v_mfma_f32_16x16x32_bf16 a[132:135], v[244:247], v[148:151], a[132:135]
s_add_u32 s28, s28, 0x4000
v_mfma_f32_16x16x32_bf16 a[136:139], v[240:243], v[136:139], a[136:139]
ds_read_b64_tr_b16 v[236:237], v249 offset:25088
v_mfma_f32_16x16x32_bf16 a[136:139], v[244:247], v[152:155], a[136:139]
v_exp_f32 v192, v192
v_mfma_f32_16x16x32_bf16 a[140:143], v[240:243], v[140:143], a[140:143]
ds_read_b64_tr_b16 v[238:239], v249 offset:27136
v_mfma_f32_16x16x32_bf16 a[140:143], v[244:247], v[156:159], a[140:143]
s_waitcnt lgkmcnt(4)
v_mfma_f32_16x16x32_bf16 a[144:147], v[224:227], v[128:131], a[144:147]
ds_read_b64_tr_b16 v[240:241], v250 offset:8704
v_mfma_f32_16x16x32_bf16 a[144:147], v[228:231], v[144:147], a[144:147]
v_exp_f32 v193, v193
v_mfma_f32_16x16x32_bf16 a[148:151], v[224:227], v[132:135], a[148:151]
ds_read_b64_tr_b16 v[242:243], v250 offset:10752
v_cvt_pk_bf16_f32 v176, v192, v193
v_mfma_f32_16x16x32_bf16 a[148:151], v[228:231], v[148:151], a[148:151]
v_exp_f32 v194, v194
v_mfma_f32_16x16x32_bf16 a[152:155], v[224:227], v[136:139], a[152:155]
ds_read_b64_tr_b16 v[244:245], v250 offset:25088
v_mfma_f32_16x16x32_bf16 a[152:155], v[228:231], v[152:155], a[152:155]
v_exp_f32 v195, v195
v_mfma_f32_16x16x32_bf16 a[156:159], v[224:227], v[140:143], a[156:159]
ds_read_b64_tr_b16 v[246:247], v250 offset:27136
v_cvt_pk_bf16_f32 v177, v194, v195
v_mfma_f32_16x16x32_bf16 a[156:159], v[228:231], v[156:159], a[156:159]
s_waitcnt lgkmcnt(4)
v_mfma_f32_16x16x32_bf16 a[160:163], v[232:235], v[128:131], a[160:163]
ds_read_b128 v[224:227], v248 offset:51200
v_mfma_f32_16x16x32_bf16 a[160:163], v[236:239], v[144:147], a[160:163]
v_exp_f32 v196, v196
v_mfma_f32_16x16x32_bf16 a[164:167], v[232:235], v[132:135], a[164:167]
v_exp_f32 v197, v197
v_mfma_f32_16x16x32_bf16 a[164:167], v[236:239], v[148:151], a[164:167]
v_exp_f32 v198, v198
v_mfma_f32_16x16x32_bf16 a[168:171], v[232:235], v[136:139], a[168:171]
ds_read_b128 v[228:231], v248 offset:51712
v_cvt_pk_bf16_f32 v180, v196, v197
v_mfma_f32_16x16x32_bf16 a[168:171], v[236:239], v[152:155], a[168:171]
v_exp_f32 v199, v199
v_mfma_f32_16x16x32_bf16 a[172:175], v[232:235], v[140:143], a[172:175]
v_exp_f32 v200, v200
v_mfma_f32_16x16x32_bf16 a[172:175], v[236:239], v[156:159], a[172:175]
s_waitcnt lgkmcnt(2)
v_cvt_pk_bf16_f32 v181, v198, v199
v_mfma_f32_16x16x32_bf16 a[176:179], v[240:243], v[128:131], a[176:179]
ds_read_b128 v[232:235], v248 offset:55296
v_mfma_f32_16x16x32_bf16 a[176:179], v[244:247], v[144:147], a[176:179]
v_exp_f32 v201, v201
v_mfma_f32_16x16x32_bf16 a[180:183], v[240:243], v[132:135], a[180:183]
v_exp_f32 v202, v202
v_mfma_f32_16x16x32_bf16 a[180:183], v[244:247], v[148:151], a[180:183]
v_exp_f32 v203, v203
v_mfma_f32_16x16x32_bf16 a[184:187], v[240:243], v[136:139], a[184:187]
ds_read_b128 v[236:239], v248 offset:55808
v_cvt_pk_bf16_f32 v184, v200, v201
v_mfma_f32_16x16x32_bf16 a[184:187], v[244:247], v[152:155], a[184:187]
v_cvt_pk_bf16_f32 v185, v202, v203
v_mfma_f32_16x16x32_bf16 a[188:191], v[240:243], v[140:143], a[188:191]
v_exp_f32 v204, v204
v_mfma_f32_16x16x32_bf16 a[188:191], v[244:247], v[156:159], a[188:191]
s_waitcnt lgkmcnt(2)
v_mfma_f32_16x16x32_bf16 v[208:211], v[224:227], v[0:3], 0
ds_read_b128 v[240:243], v248 offset:59392
v_mfma_f32_16x16x32_bf16 v[208:211], v[228:231], v[4:7], v[208:211]
v_exp_f32 v205, v205
v_mfma_f32_16x16x32_bf16 v[212:215], v[224:227], v[32:35], 0
v_exp_f32 v206, v206
v_mfma_f32_16x16x32_bf16 v[212:215], v[228:231], v[36:39], v[212:215]
v_exp_f32 v207, v207
v_mfma_f32_16x16x32_bf16 v[216:219], v[224:227], v[64:67], 0
ds_read_b128 v[244:247], v248 offset:59904
v_cvt_pk_bf16_f32 v188, v204, v205
v_mfma_f32_16x16x32_bf16 v[216:219], v[228:231], v[68:71], v[216:219]
v_cvt_pk_bf16_f32 v189, v206, v207
v_mfma_f32_16x16x32_bf16 v[220:223], v[224:227], v[96:99], 0
v_mfma_f32_16x16x32_bf16 v[220:223], v[228:231], v[100:103], v[220:223]
s_waitcnt lgkmcnt(2)
v_mfma_f32_16x16x32_bf16 v[208:211], v[232:235], v[8:11], v[208:211]
ds_read_b128 v[224:227], v248 offset:63488
v_mfma_f32_16x16x32_bf16 v[208:211], v[236:239], v[12:15], v[208:211]
v_mfma_f32_16x16x32_bf16 v[212:215], v[232:235], v[40:43], v[212:215]
v_mfma_f32_16x16x32_bf16 v[212:215], v[236:239], v[44:47], v[212:215]
v_mfma_f32_16x16x32_bf16 v[216:219], v[232:235], v[72:75], v[216:219]
ds_read_b128 v[228:231], v248 offset:64000
v_mfma_f32_16x16x32_bf16 v[216:219], v[236:239], v[76:79], v[216:219]
v_mfma_f32_16x16x32_bf16 v[220:223], v[232:235], v[104:107], v[220:223]
v_mfma_f32_16x16x32_bf16 v[220:223], v[236:239], v[108:111], v[220:223]
s_waitcnt lgkmcnt(2)
v_mfma_f32_16x16x32_bf16 v[208:211], v[240:243], v[16:19], v[208:211]
ds_read_b64_tr_b16 v[232:233], v249 offset:12288
v_mfma_f32_16x16x32_bf16 v[208:211], v[244:247], v[20:23], v[208:211]
v_mfma_f32_16x16x32_bf16 v[212:215], v[240:243], v[48:51], v[212:215]
ds_read_b64_tr_b16 v[234:235], v249 offset:14336
v_mfma_f32_16x16x32_bf16 v[212:215], v[244:247], v[52:55], v[212:215]
v_mfma_f32_16x16x32_bf16 v[216:219], v[240:243], v[80:83], v[216:219]
ds_read_b64_tr_b16 v[236:237], v249 offset:28672
v_mfma_f32_16x16x32_bf16 v[216:219], v[244:247], v[84:87], v[216:219]
v_mfma_f32_16x16x32_bf16 v[220:223], v[240:243], v[112:115], v[220:223]
ds_read_b64_tr_b16 v[238:239], v249 offset:30720
v_mfma_f32_16x16x32_bf16 v[220:223], v[244:247], v[116:119], v[220:223]
s_waitcnt lgkmcnt(4)
v_mfma_f32_16x16x32_bf16 v[208:211], v[224:227], v[24:27], v[208:211]
ds_read_b64_tr_b16 v[240:241], v250 offset:12288
v_mfma_f32_16x16x32_bf16 v[208:211], v[228:231], v[28:31], v[208:211]
v_mfma_f32_16x16x32_bf16 v[212:215], v[224:227], v[56:59], v[212:215]
ds_read_b64_tr_b16 v[242:243], v250 offset:14336
v_mfma_f32_16x16x32_bf16 v[212:215], v[228:231], v[60:63], v[212:215]
v_mfma_f32_16x16x32_bf16 v[216:219], v[224:227], v[88:91], v[216:219]
ds_read_b64_tr_b16 v[244:245], v250 offset:28672
v_mfma_f32_16x16x32_bf16 v[216:219], v[228:231], v[92:95], v[216:219]
v_mfma_f32_16x16x32_bf16 v[220:223], v[224:227], v[120:123], v[220:223]
ds_read_b64_tr_b16 v[246:247], v250 offset:30720
v_xor_b32 v248, 0x10000, v248
v_mfma_f32_16x16x32_bf16 v[220:223], v[228:231], v[124:127], v[220:223]
s_waitcnt lgkmcnt(4)
v_mfma_f32_16x16x32_bf16 a[192:195], v[232:235], v[128:131], a[192:195]
ds_read_b64_tr_b16 v[224:225], v249 offset:12800
v_mfma_f32_16x16x32_bf16 a[192:195], v[236:239], v[144:147], a[192:195]
v_mfma_f32_16x16x32_bf16 a[196:199], v[232:235], v[132:135], a[196:199]
ds_read_b64_tr_b16 v[226:227], v249 offset:14848
v_mfma_f32_16x16x32_bf16 a[196:199], v[236:239], v[148:151], a[196:199]
v_exp_f32 v208, v208
v_mfma_f32_16x16x32_bf16 a[200:203], v[232:235], v[136:139], a[200:203]
ds_read_b64_tr_b16 v[228:229], v249 offset:29184
v_mfma_f32_16x16x32_bf16 a[200:203], v[236:239], v[152:155], a[200:203]
v_exp_f32 v209, v209
v_mfma_f32_16x16x32_bf16 a[204:207], v[232:235], v[140:143], a[204:207]
ds_read_b64_tr_b16 v[230:231], v249 offset:31232
v_cvt_pk_bf16_f32 v178, v208, v209
v_mfma_f32_16x16x32_bf16 a[204:207], v[236:239], v[156:159], a[204:207]
s_waitcnt lgkmcnt(4)
v_mfma_f32_16x16x32_bf16 a[208:211], v[240:243], v[128:131], a[208:211]
ds_read_b64_tr_b16 v[232:233], v250 offset:12800
v_mfma_f32_16x16x32_bf16 a[208:211], v[244:247], v[144:147], a[208:211]
v_exp_f32 v210, v210
v_mfma_f32_16x16x32_bf16 a[212:215], v[240:243], v[132:135], a[212:215]
ds_read_b64_tr_b16 v[234:235], v250 offset:14848
v_mfma_f32_16x16x32_bf16 a[212:215], v[244:247], v[148:151], a[212:215]
v_exp_f32 v211, v211
v_mfma_f32_16x16x32_bf16 a[216:219], v[240:243], v[136:139], a[216:219]
ds_read_b64_tr_b16 v[236:237], v250 offset:29184
v_cvt_pk_bf16_f32 v179, v210, v211
v_mfma_f32_16x16x32_bf16 a[216:219], v[244:247], v[152:155], a[216:219]
v_exp_f32 v212, v212
v_mfma_f32_16x16x32_bf16 a[220:223], v[240:243], v[140:143], a[220:223]
ds_read_b64_tr_b16 v[238:239], v250 offset:31232
v_mfma_f32_16x16x32_bf16 a[220:223], v[244:247], v[156:159], a[220:223]
s_waitcnt lgkmcnt(4)
v_mfma_f32_16x16x32_bf16 a[224:227], v[224:227], v[128:131], a[224:227]
ds_read_b128 v[240:243], v248 offset:0
v_mfma_f32_16x16x32_bf16 a[224:227], v[228:231], v[144:147], a[224:227]
v_exp_f32 v213, v213
v_mfma_f32_16x16x32_bf16 a[228:231], v[224:227], v[132:135], a[228:231]
v_exp_f32 v214, v214
v_mfma_f32_16x16x32_bf16 a[228:231], v[228:231], v[148:151], a[228:231]
v_exp_f32 v215, v215
v_mfma_f32_16x16x32_bf16 a[232:235], v[224:227], v[136:139], a[232:235]
ds_read_b128 v[244:247], v248 offset:512
v_cvt_pk_bf16_f32 v182, v212, v213
v_mfma_f32_16x16x32_bf16 a[232:235], v[228:231], v[152:155], a[232:235]
v_cvt_pk_bf16_f32 v183, v214, v215
v_mfma_f32_16x16x32_bf16 a[236:239], v[224:227], v[140:143], a[236:239]
v_exp_f32 v216, v216
v_mfma_f32_16x16x32_bf16 a[236:239], v[228:231], v[156:159], a[236:239]
s_waitcnt lgkmcnt(2)
v_mfma_f32_16x16x32_bf16 a[240:243], v[232:235], v[128:131], a[240:243]
ds_read_b128 v[224:227], v248 offset:4096
v_mfma_f32_16x16x32_bf16 a[240:243], v[236:239], v[144:147], a[240:243]
v_exp_f32 v217, v217
v_mfma_f32_16x16x32_bf16 a[244:247], v[232:235], v[132:135], a[244:247]
v_exp_f32 v218, v218
v_mfma_f32_16x16x32_bf16 a[244:247], v[236:239], v[148:151], a[244:247]
v_exp_f32 v219, v219
v_mfma_f32_16x16x32_bf16 a[248:251], v[232:235], v[136:139], a[248:251]
ds_read_b128 v[228:231], v248 offset:4608
v_cvt_pk_bf16_f32 v186, v216, v217
v_mfma_f32_16x16x32_bf16 a[248:251], v[236:239], v[152:155], a[248:251]
v_cvt_pk_bf16_f32 v187, v218, v219
v_mfma_f32_16x16x32_bf16 a[252:255], v[232:235], v[140:143], a[252:255]
v_exp_f32 v220, v220
v_mfma_f32_16x16x32_bf16 a[252:255], v[236:239], v[156:159], a[252:255]
s_waitcnt lgkmcnt(2)
v_mfma_f32_16x16x32_bf16 v[192:195], v[240:243], v[0:3], 0
ds_read_b128 v[232:235], v248 offset:8192
v_mfma_f32_16x16x32_bf16 v[192:195], v[244:247], v[4:7], v[192:195]
v_exp_f32 v221, v221
v_mfma_f32_16x16x32_bf16 v[196:199], v[240:243], v[32:35], 0
v_exp_f32 v222, v222
v_mfma_f32_16x16x32_bf16 v[196:199], v[244:247], v[36:39], v[196:199]
v_exp_f32 v223, v223
v_mfma_f32_16x16x32_bf16 v[200:203], v[240:243], v[64:67], 0
ds_read_b128 v[236:239], v248 offset:8704
v_cvt_pk_bf16_f32 v190, v220, v221
v_mfma_f32_16x16x32_bf16 v[200:203], v[244:247], v[68:71], v[200:203]
v_cvt_pk_bf16_f32 v191, v222, v223
v_mfma_f32_16x16x32_bf16 v[204:207], v[240:243], v[96:99], 0
v_mfma_f32_16x16x32_bf16 v[204:207], v[244:247], v[100:103], v[204:207]
s_waitcnt lgkmcnt(2)
v_mfma_f32_16x16x32_bf16 v[192:195], v[224:227], v[8:11], v[192:195]
ds_read_b128 v[240:243], v248 offset:12288
v_mfma_f32_16x16x32_bf16 v[192:195], v[228:231], v[12:15], v[192:195]
v_mfma_f32_16x16x32_bf16 v[196:199], v[224:227], v[40:43], v[196:199]
v_mfma_f32_16x16x32_bf16 v[196:199], v[228:231], v[44:47], v[196:199]
v_mfma_f32_16x16x32_bf16 v[200:203], v[224:227], v[72:75], v[200:203]
ds_read_b128 v[244:247], v248 offset:12800
v_mfma_f32_16x16x32_bf16 v[200:203], v[228:231], v[76:79], v[200:203]
v_mfma_f32_16x16x32_bf16 v[204:207], v[224:227], v[104:107], v[204:207]
v_mfma_f32_16x16x32_bf16 v[204:207], v[228:231], v[108:111], v[204:207]
s_waitcnt lgkmcnt(2)
v_mfma_f32_16x16x32_bf16 v[192:195], v[232:235], v[16:19], v[192:195]
ds_read_b64_tr_b16 v[224:225], v249 offset:32768
v_mfma_f32_16x16x32_bf16 v[192:195], v[236:239], v[20:23], v[192:195]
v_mfma_f32_16x16x32_bf16 v[196:199], v[232:235], v[48:51], v[196:199]
ds_read_b64_tr_b16 v[226:227], v249 offset:34816
v_mfma_f32_16x16x32_bf16 v[196:199], v[236:239], v[52:55], v[196:199]
v_mfma_f32_16x16x32_bf16 v[200:203], v[232:235], v[80:83], v[200:203]
ds_read_b64_tr_b16 v[228:229], v249 offset:49152
v_mfma_f32_16x16x32_bf16 v[200:203], v[236:239], v[84:87], v[200:203]
v_mfma_f32_16x16x32_bf16 v[204:207], v[232:235], v[112:115], v[204:207]
ds_read_b64_tr_b16 v[230:231], v249 offset:51200
v_mfma_f32_16x16x32_bf16 v[204:207], v[236:239], v[116:119], v[204:207]
s_waitcnt lgkmcnt(4)
v_mfma_f32_16x16x32_bf16 v[192:195], v[240:243], v[24:27], v[192:195]
ds_read_b64_tr_b16 v[232:233], v250 offset:32768
v_mfma_f32_16x16x32_bf16 v[192:195], v[244:247], v[28:31], v[192:195]
v_mfma_f32_16x16x32_bf16 v[196:199], v[240:243], v[56:59], v[196:199]
ds_read_b64_tr_b16 v[234:235], v250 offset:34816
v_mfma_f32_16x16x32_bf16 v[196:199], v[244:247], v[60:63], v[196:199]
v_mfma_f32_16x16x32_bf16 v[200:203], v[240:243], v[88:91], v[200:203]
ds_read_b64_tr_b16 v[236:237], v250 offset:49152
v_mfma_f32_16x16x32_bf16 v[200:203], v[244:247], v[92:95], v[200:203]
s_sub_u32 s31, s31, 1
v_mfma_f32_16x16x32_bf16 v[204:207], v[240:243], v[120:123], v[204:207]
ds_read_b64_tr_b16 v[238:239], v250 offset:51200
v_mfma_f32_16x16x32_bf16 v[204:207], v[244:247], v[124:127], v[204:207]
s_cbranch_scc1 L2_tail_1
s_waitcnt lgkmcnt(4)
v_mfma_f32_16x16x32_bf16 a[0:3], v[224:227], v[160:163], a[0:3]
ds_read_b64_tr_b16 v[240:241], v249 offset:33280
v_mfma_f32_16x16x32_bf16 a[0:3], v[228:231], v[176:179], a[0:3]
v_mfma_f32_16x16x32_bf16 a[4:7], v[224:227], v[164:167], a[4:7]
ds_read_b64_tr_b16 v[242:243], v249 offset:35328
v_mfma_f32_16x16x32_bf16 a[4:7], v[228:231], v[180:183], a[4:7]
v_exp_f32 v192, v192
v_mfma_f32_16x16x32_bf16 a[8:11], v[224:227], v[168:171], a[8:11]
ds_read_b64_tr_b16 v[244:245], v249 offset:49664
v_mfma_f32_16x16x32_bf16 a[8:11], v[228:231], v[184:187], a[8:11]
v_exp_f32 v193, v193
v_mfma_f32_16x16x32_bf16 a[12:15], v[224:227], v[172:175], a[12:15]
ds_read_b64_tr_b16 v[246:247], v249 offset:51712
v_cvt_pk_bf16_f32 v128, v192, v193
v_mfma_f32_16x16x32_bf16 a[12:15], v[228:231], v[188:191], a[12:15]
s_waitcnt lgkmcnt(4)
v_mfma_f32_16x16x32_bf16 a[16:19], v[232:235], v[160:163], a[16:19]
ds_read_b64_tr_b16 v[144:145], v250 offset:33280
v_mfma_f32_16x16x32_bf16 a[16:19], v[236:239], v[176:179], a[16:19]
v_exp_f32 v194, v194
v_mfma_f32_16x16x32_bf16 a[20:23], v[232:235], v[164:167], a[20:23]
ds_read_b64_tr_b16 v[146:147], v250 offset:35328
v_mfma_f32_16x16x32_bf16 a[20:23], v[236:239], v[180:183], a[20:23]
v_exp_f32 v195, v195
v_mfma_f32_16x16x32_bf16 a[24:27], v[232:235], v[168:171], a[24:27]
ds_read_b64_tr_b16 v[148:149], v250 offset:49664
v_cvt_pk_bf16_f32 v129, v194, v195
v_mfma_f32_16x16x32_bf16 a[24:27], v[236:239], v[184:187], a[24:27]
v_exp_f32 v196, v196
v_mfma_f32_16x16x32_bf16 a[28:31], v[232:235], v[172:175], a[28:31]
ds_read_b64_tr_b16 v[150:151], v250 offset:51712
v_mfma_f32_16x16x32_bf16 a[28:31], v[236:239], v[188:191], a[28:31]
s_waitcnt lgkmcnt(4)
v_mfma_f32_16x16x32_bf16 a[32:35], v[240:243], v[160:163], a[32:35]
ds_read_b128 v[224:227], v248 offset:2048
v_mfma_f32_16x16x32_bf16 a[32:35], v[244:247], v[176:179], a[32:35]
v_exp_f32 v197, v197
v_mfma_f32_16x16x32_bf16 a[36:39], v[240:243], v[164:167], a[36:39]
v_exp_f32 v198, v198
v_mfma_f32_16x16x32_bf16 a[36:39], v[244:247], v[180:183], a[36:39]
v_exp_f32 v199, v199
v_mfma_f32_16x16x32_bf16 a[40:43], v[240:243], v[168:171], a[40:43]
ds_read_b128 v[228:231], v248 offset:2560
v_cvt_pk_bf16_f32 v132, v196, v197
v_mfma_f32_16x16x32_bf16 a[40:43], v[244:247], v[184:187], a[40:43]
v_cvt_pk_bf16_f32 v133, v198, v199
v_mfma_f32_16x16x32_bf16 a[44:47], v[240:243], v[172:175], a[44:47]
v_exp_f32 v200, v200
v_mfma_f32_16x16x32_bf16 a[44:47], v[244:247], v[188:191], a[44:47]
s_waitcnt lgkmcnt(2)
v_mfma_f32_16x16x32_bf16 a[48:51], v[144:147], v[160:163], a[48:51]
ds_read_b128 v[232:235], v248 offset:6144
v_mfma_f32_16x16x32_bf16 a[48:51], v[148:151], v[176:179], a[48:51]
v_exp_f32 v201, v201
v_mfma_f32_16x16x32_bf16 a[52:55], v[144:147], v[164:167], a[52:55]
v_exp_f32 v202, v202
v_mfma_f32_16x16x32_bf16 a[52:55], v[148:151], v[180:183], a[52:55]
v_exp_f32 v203, v203
v_mfma_f32_16x16x32_bf16 a[56:59], v[144:147], v[168:171], a[56:59]
ds_read_b128 v[236:239], v248 offset:6656
v_cvt_pk_bf16_f32 v136, v200, v201
v_mfma_f32_16x16x32_bf16 a[56:59], v[148:151], v[184:187], a[56:59]
v_cvt_pk_bf16_f32 v137, v202, v203
v_mfma_f32_16x16x32_bf16 a[60:63], v[144:147], v[172:175], a[60:63]
v_exp_f32 v204, v204
v_mfma_f32_16x16x32_bf16 a[60:63], v[148:151], v[188:191], a[60:63]
s_waitcnt lgkmcnt(2)
v_mfma_f32_16x16x32_bf16 v[208:211], v[224:227], v[0:3], 0
ds_read_b128 v[240:243], v248 offset:10240
v_mfma_f32_16x16x32_bf16 v[208:211], v[228:231], v[4:7], v[208:211]
v_exp_f32 v205, v205
v_mfma_f32_16x16x32_bf16 v[212:215], v[224:227], v[32:35], 0
v_exp_f32 v206, v206
v_mfma_f32_16x16x32_bf16 v[212:215], v[228:231], v[36:39], v[212:215]
v_exp_f32 v207, v207
v_mfma_f32_16x16x32_bf16 v[216:219], v[224:227], v[64:67], 0
ds_read_b128 v[244:247], v248 offset:10752
v_cvt_pk_bf16_f32 v140, v204, v205
v_mfma_f32_16x16x32_bf16 v[216:219], v[228:231], v[68:71], v[216:219]
v_cvt_pk_bf16_f32 v141, v206, v207
v_mfma_f32_16x16x32_bf16 v[220:223], v[224:227], v[96:99], 0
v_mfma_f32_16x16x32_bf16 v[220:223], v[228:231], v[100:103], v[220:223]
s_waitcnt lgkmcnt(2)
v_mfma_f32_16x16x32_bf16 v[208:211], v[232:235], v[8:11], v[208:211]
ds_read_b128 v[144:147], v248 offset:14336
v_mfma_f32_16x16x32_bf16 v[208:211], v[236:239], v[12:15], v[208:211]
v_mfma_f32_16x16x32_bf16 v[212:215], v[232:235], v[40:43], v[212:215]
v_mfma_f32_16x16x32_bf16 v[212:215], v[236:239], v[44:47], v[212:215]
v_mfma_f32_16x16x32_bf16 v[216:219], v[232:235], v[72:75], v[216:219]
ds_read_b128 v[148:151], v248 offset:14848
v_mfma_f32_16x16x32_bf16 v[216:219], v[236:239], v[76:79], v[216:219]
v_mfma_f32_16x16x32_bf16 v[220:223], v[232:235], v[104:107], v[220:223]
v_mfma_f32_16x16x32_bf16 v[220:223], v[236:239], v[108:111], v[220:223]
s_waitcnt lgkmcnt(2)
v_mfma_f32_16x16x32_bf16 v[208:211], v[240:243], v[16:19], v[208:211]
ds_read_b64_tr_b16 v[224:225], v249 offset:36864
v_mfma_f32_16x16x32_bf16 v[208:211], v[244:247], v[20:23], v[208:211]
v_mfma_f32_16x16x32_bf16 v[212:215], v[240:243], v[48:51], v[212:215]
ds_read_b64_tr_b16 v[226:227], v249 offset:38912
v_mfma_f32_16x16x32_bf16 v[212:215], v[244:247], v[52:55], v[212:215]
v_mfma_f32_16x16x32_bf16 v[216:219], v[240:243], v[80:83], v[216:219]
ds_read_b64_tr_b16 v[228:229], v249 offset:53248
v_mfma_f32_16x16x32_bf16 v[216:219], v[244:247], v[84:87], v[216:219]
v_mfma_f32_16x16x32_bf16 v[220:223], v[240:243], v[112:115], v[220:223]
ds_read_b64_tr_b16 v[230:231], v249 offset:55296
v_mfma_f32_16x16x32_bf16 v[220:223], v[244:247], v[116:119], v[220:223]
s_waitcnt lgkmcnt(4)
v_mfma_f32_16x16x32_bf16 v[208:211], v[144:147], v[24:27], v[208:211]
ds_read_b64_tr_b16 v[232:233], v250 offset:36864
v_mfma_f32_16x16x32_bf16 v[208:211], v[148:151], v[28:31], v[208:211]
v_mfma_f32_16x16x32_bf16 v[212:215], v[144:147], v[56:59], v[212:215]
ds_read_b64_tr_b16 v[234:235], v250 offset:38912
v_mfma_f32_16x16x32_bf16 v[212:215], v[148:151], v[60:63], v[212:215]
v_mfma_f32_16x16x32_bf16 v[216:219], v[144:147], v[88:91], v[216:219]
ds_read_b64_tr_b16 v[236:237], v250 offset:53248
v_mfma_f32_16x16x32_bf16 v[216:219], v[148:151], v[92:95], v[216:219]
v_mfma_f32_16x16x32_bf16 v[220:223], v[144:147], v[120:123], v[220:223]
ds_read_b64_tr_b16 v[238:239], v250 offset:55296
v_mfma_f32_16x16x32_bf16 v[220:223], v[148:151], v[124:127], v[220:223]
s_waitcnt lgkmcnt(4)
v_mfma_f32_16x16x32_bf16 a[64:67], v[224:227], v[160:163], a[64:67]
ds_read_b64_tr_b16 v[240:241], v249 offset:37376
v_mfma_f32_16x16x32_bf16 a[64:67], v[228:231], v[176:179], a[64:67]
v_mfma_f32_16x16x32_bf16 a[68:71], v[224:227], v[164:167], a[68:71]
ds_read_b64_tr_b16 v[242:243], v249 offset:39424
v_mfma_f32_16x16x32_bf16 a[68:71], v[228:231], v[180:183], a[68:71]
v_exp_f32 v208, v208
v_mfma_f32_16x16x32_bf16 a[72:75], v[224:227], v[168:171], a[72:75]
ds_read_b64_tr_b16 v[244:245], v249 offset:53760
v_mfma_f32_16x16x32_bf16 a[72:75], v[228:231], v[184:187], a[72:75]
v_exp_f32 v209, v209
v_mfma_f32_16x16x32_bf16 a[76:79], v[224:227], v[172:175], a[76:79]
ds_read_b64_tr_b16 v[246:247], v249 offset:55808
v_cvt_pk_bf16_f32 v130, v208, v209
v_mfma_f32_16x16x32_bf16 a[76:79], v[228:231], v[188:191], a[76:79]
s_waitcnt lgkmcnt(4)
s_waitcnt vmcnt(0)
s_barrier
s_add_u32 m0, s30, 0xc000
v_mfma_f32_16x16x32_bf16 a[80:83], v[232:235], v[160:163], a[80:83]
ds_read_b64_tr_b16 v[224:225], v250 offset:37376
v_mfma_f32_16x16x32_bf16 a[80:83], v[236:239], v[176:179], a[80:83]
buffer_load_dwordx4 v251, s[12:15], s28 offen offset:0 lds
v_mfma_f32_16x16x32_bf16 a[84:87], v[232:235], v[164:167], a[84:87]
ds_read_b64_tr_b16 v[226:227], v250 offset:39424
v_mfma_f32_16x16x32_bf16 a[84:87], v[236:239], v[180:183], a[84:87]
v_exp_f32 v210, v210
v_mfma_f32_16x16x32_bf16 a[88:91], v[232:235], v[168:171], a[88:91]
ds_read_b64_tr_b16 v[228:229], v250 offset:53760
v_mfma_f32_16x16x32_bf16 a[88:91], v[236:239], v[184:187], a[88:91]
v_exp_f32 v211, v211
v_mfma_f32_16x16x32_bf16 a[92:95], v[232:235], v[172:175], a[92:95]
ds_read_b64_tr_b16 v[230:231], v250 offset:55808
v_cvt_pk_bf16_f32 v131, v210, v211
v_mfma_f32_16x16x32_bf16 a[92:95], v[236:239], v[188:191], a[92:95]
s_waitcnt lgkmcnt(4)
v_mfma_f32_16x16x32_bf16 a[96:99], v[240:243], v[160:163], a[96:99]
ds_read_b128 v[232:235], v248 offset:16384
v_mfma_f32_16x16x32_bf16 a[96:99], v[244:247], v[176:179], a[96:99]
buffer_load_dwordx4 v251, s[12:15], s28 offen offset:1024 lds
v_mfma_f32_16x16x32_bf16 a[100:103], v[240:243], v[164:167], a[100:103]
v_exp_f32 v212, v212
v_mfma_f32_16x16x32_bf16 a[100:103], v[244:247], v[180:183], a[100:103]
v_exp_f32 v213, v213
v_mfma_f32_16x16x32_bf16 a[104:107], v[240:243], v[168:171], a[104:107]
ds_read_b128 v[236:239], v248 offset:16896
v_cvt_pk_bf16_f32 v134, v212, v213
v_mfma_f32_16x16x32_bf16 a[104:107], v[244:247], v[184:187], a[104:107]
v_exp_f32 v214, v214
v_mfma_f32_16x16x32_bf16 a[108:111], v[240:243], v[172:175], a[108:111]
v_exp_f32 v215, v215
v_mfma_f32_16x16x32_bf16 a[108:111], v[244:247], v[188:191], a[108:111]
s_waitcnt lgkmcnt(2)
v_cvt_pk_bf16_f32 v135, v214, v215
v_mfma_f32_16x16x32_bf16 a[112:115], v[224:227], v[160:163], a[112:115]
ds_read_b128 v[240:243], v248 offset:20480
v_mfma_f32_16x16x32_bf16 a[112:115], v[228:231], v[176:179], a[112:115]
buffer_load_dwordx4 v251, s[12:15], s28 offen offset:2048 lds
v_mfma_f32_16x16x32_bf16 a[116:119], v[224:227], v[164:167], a[116:119]
v_exp_f32 v216, v216
v_mfma_f32_16x16x32_bf16 a[116:119], v[228:231], v[180:183], a[116:119]
v_exp_f32 v217, v217
v_mfma_f32_16x16x32_bf16 a[120:123], v[224:227], v[168:171], a[120:123]
ds_read_b128 v[244:247], v248 offset:20992
v_cvt_pk_bf16_f32 v138, v216, v217
v_mfma_f32_16x16x32_bf16 a[120:123], v[228:231], v[184:187], a[120:123]
v_exp_f32 v218, v218
v_mfma_f32_16x16x32_bf16 a[124:127], v[224:227], v[172:175], a[124:127]
v_exp_f32 v219, v219
v_mfma_f32_16x16x32_bf16 a[124:127], v[228:231], v[188:191], a[124:127]
s_waitcnt lgkmcnt(2)
v_cvt_pk_bf16_f32 v139, v218, v219
v_mfma_f32_16x16x32_bf16 v[192:195], v[232:235], v[0:3], 0
ds_read_b128 v[224:227], v248 offset:24576
v_mfma_f32_16x16x32_bf16 v[192:195], v[236:239], v[4:7], v[192:195]
buffer_load_dwordx4 v251, s[12:15], s28 offen offset:3072 lds
v_mfma_f32_16x16x32_bf16 v[196:199], v[232:235], v[32:35], 0
s_xor_b32 s30, s30, 0x10000
v_mfma_f32_16x16x32_bf16 v[196:199], v[236:239], v[36:39], v[196:199]
s_add_u32 s28, s28, 0x4000
v_mfma_f32_16x16x32_bf16 v[200:203], v[232:235], v[64:67], 0
ds_read_b128 v[228:231], v248 offset:25088
v_mfma_f32_16x16x32_bf16 v[200:203], v[236:239], v[68:71], v[200:203]
v_exp_f32 v220, v220
v_mfma_f32_16x16x32_bf16 v[204:207], v[232:235], v[96:99], 0
v_exp_f32 v221, v221
v_mfma_f32_16x16x32_bf16 v[204:207], v[236:239], v[100:103], v[204:207]
s_waitcnt lgkmcnt(2)
s_add_u32 m0, s30, 0x0
v_mfma_f32_16x16x32_bf16 v[192:195], v[240:243], v[8:11], v[192:195]
ds_read_b128 v[232:235], v248 offset:28672
v_cvt_pk_bf16_f32 v142, v220, v221
v_mfma_f32_16x16x32_bf16 v[192:195], v[244:247], v[12:15], v[192:195]
buffer_load_dwordx4 v251, s[12:15], s28 offen offset:0 lds
v_mfma_f32_16x16x32_bf16 v[196:199], v[240:243], v[40:43], v[196:199]
v_exp_f32 v222, v222
v_mfma_f32_16x16x32_bf16 v[196:199], v[244:247], v[44:47], v[196:199]
v_exp_f32 v223, v223
v_mfma_f32_16x16x32_bf16 v[200:203], v[240:243], v[72:75], v[200:203]
ds_read_b128 v[236:239], v248 offset:29184
v_cvt_pk_bf16_f32 v143, v222, v223
v_mfma_f32_16x16x32_bf16 v[200:203], v[244:247], v[76:79], v[200:203]
v_mfma_f32_16x16x32_bf16 v[204:207], v[240:243], v[104:107], v[204:207]
v_mfma_f32_16x16x32_bf16 v[204:207], v[244:247], v[108:111], v[204:207]
s_waitcnt lgkmcnt(2)
v_mfma_f32_16x16x32_bf16 v[192:195], v[224:227], v[16:19], v[192:195]
ds_read_b64_tr_b16 v[240:241], v249 offset:40960
v_mfma_f32_16x16x32_bf16 v[192:195], v[228:231], v[20:23], v[192:195]
buffer_load_dwordx4 v251, s[12:15], s28 offen offset:1024 lds
v_mfma_f32_16x16x32_bf16 v[196:199], v[224:227], v[48:51], v[196:199]
ds_read_b64_tr_b16 v[242:243], v249 offset:43008
v_mfma_f32_16x16x32_bf16 v[196:199], v[228:231], v[52:55], v[196:199]
v_mfma_f32_16x16x32_bf16 v[200:203], v[224:227], v[80:83], v[200:203]
ds_read_b64_tr_b16 v[244:245], v249 offset:57344
v_mfma_f32_16x16x32_bf16 v[200:203], v[228:231], v[84:87], v[200:203]
v_mfma_f32_16x16x32_bf16 v[204:207], v[224:227], v[112:115], v[204:207]
ds_read_b64_tr_b16 v[246:247], v249 offset:59392
v_mfma_f32_16x16x32_bf16 v[204:207], v[228:231], v[116:119], v[204:207]
s_waitcnt lgkmcnt(4)
v_mfma_f32_16x16x32_bf16 v[192:195], v[232:235], v[24:27], v[192:195]
ds_read_b64_tr_b16 v[224:225], v250 offset:40960
v_mfma_f32_16x16x32_bf16 v[192:195], v[236:239], v[28:31], v[192:195]
buffer_load_dwordx4 v251, s[12:15], s28 offen offset:2048 lds
v_mfma_f32_16x16x32_bf16 v[196:199], v[232:235], v[56:59], v[196:199]
ds_read_b64_tr_b16 v[226:227], v250 offset:43008
v_mfma_f32_16x16x32_bf16 v[196:199], v[236:239], v[60:63], v[196:199]
v_mfma_f32_16x16x32_bf16 v[200:203], v[232:235], v[88:91], v[200:203]
ds_read_b64_tr_b16 v[228:229], v250 offset:57344
v_mfma_f32_16x16x32_bf16 v[200:203], v[236:239], v[92:95], v[200:203]
v_mfma_f32_16x16x32_bf16 v[204:207], v[232:235], v[120:123], v[204:207]
ds_read_b64_tr_b16 v[230:231], v250 offset:59392
v_mfma_f32_16x16x32_bf16 v[204:207], v[236:239], v[124:127], v[204:207]
s_waitcnt lgkmcnt(4)
v_mfma_f32_16x16x32_bf16 a[128:131], v[240:243], v[160:163], a[128:131]
ds_read_b64_tr_b16 v[232:233], v249 offset:41472
v_mfma_f32_16x16x32_bf16 a[128:131], v[244:247], v[176:179], a[128:131]
buffer_load_dwordx4 v251, s[12:15], s28 offen offset:3072 lds
v_mfma_f32_16x16x32_bf16 a[132:135], v[240:243], v[164:167], a[132:135]
ds_read_b64_tr_b16 v[234:235], v249 offset:43520
v_mfma_f32_16x16x32_bf16 a[132:135], v[244:247], v[180:183], a[132:135]
s_add_u32 s28, s28, 0x4000
v_mfma_f32_16x16x32_bf16 a[136:139], v[240:243], v[168:171], a[136:139]
ds_read_b64_tr_b16 v[236:237], v249 offset:57856
v_mfma_f32_16x16x32_bf16 a[136:139], v[244:247], v[184:187], a[136:139]
v_exp_f32 v192, v192
v_mfma_f32_16x16x32_bf16 a[140:143], v[240:243], v[172:175], a[140:143]
ds_read_b64_tr_b16 v[238:239], v249 offset:59904
v_mfma_f32_16x16x32_bf16 a[140:143], v[244:247], v[188:191], a[140:143]
s_waitcnt lgkmcnt(4)
v_mfma_f32_16x16x32_bf16 a[144:147], v[224:227], v[160:163], a[144:147]
ds_read_b64_tr_b16 v[240:241], v250 offset:41472
v_mfma_f32_16x16x32_bf16 a[144:147], v[228:231], v[176:179], a[144:147]
v_exp_f32 v193, v193
v_mfma_f32_16x16x32_bf16 a[148:151], v[224:227], v[164:167], a[148:151]
ds_read_b64_tr_b16 v[242:243], v250 offset:43520
v_cvt_pk_bf16_f32 v144, v192, v193
v_mfma_f32_16x16x32_bf16 a[148:151], v[228:231], v[180:183], a[148:151]
v_exp_f32 v194, v194
v_mfma_f32_16x16x32_bf16 a[152:155], v[224:227], v[168:171], a[152:155]
ds_read_b64_tr_b16 v[244:245], v250 offset:57856
v_mfma_f32_16x16x32_bf16 a[152:155], v[228:231], v[184:187], a[152:155]
v_exp_f32 v195, v195
v_mfma_f32_16x16x32_bf16 a[156:159], v[224:227], v[172:175], a[156:159]
ds_read_b64_tr_b16 v[246:247], v250 offset:59904
v_cvt_pk_bf16_f32 v145, v194, v195
v_mfma_f32_16x16x32_bf16 a[156:159], v[228:231], v[188:191], a[156:159]
s_waitcnt lgkmcnt(4)
v_mfma_f32_16x16x32_bf16 a[160:163], v[232:235], v[160:163], a[160:163]
ds_read_b128 v[224:227], v248 offset:18432
v_mfma_f32_16x16x32_bf16 a[160:163], v[236:239], v[176:179], a[160:163]
v_exp_f32 v196, v196
v_mfma_f32_16x16x32_bf16 a[164:167], v[232:235], v[164:167], a[164:167]
v_exp_f32 v197, v197
v_mfma_f32_16x16x32_bf16 a[164:167], v[236:239], v[180:183], a[164:167]
v_exp_f32 v198, v198
v_mfma_f32_16x16x32_bf16 a[168:171], v[232:235], v[168:171], a[168:171]
ds_read_b128 v[228:231], v248 offset:18944
v_cvt_pk_bf16_f32 v148, v196, v197
v_mfma_f32_16x16x32_bf16 a[168:171], v[236:239], v[184:187], a[168:171]
v_exp_f32 v199, v199
v_mfma_f32_16x16x32_bf16 a[172:175], v[232:235], v[172:175], a[172:175]
v_exp_f32 v200, v200
v_mfma_f32_16x16x32_bf16 a[172:175], v[236:239], v[188:191], a[172:175]
s_waitcnt lgkmcnt(2)
v_cvt_pk_bf16_f32 v149, v198, v199
v_mfma_f32_16x16x32_bf16 a[176:179], v[240:243], v[160:163], a[176:179]
ds_read_b128 v[232:235], v248 offset:22528
v_mfma_f32_16x16x32_bf16 a[176:179], v[244:247], v[176:179], a[176:179]
v_exp_f32 v201, v201
v_mfma_f32_16x16x32_bf16 a[180:183], v[240:243], v[164:167], a[180:183]
v_exp_f32 v202, v202
v_mfma_f32_16x16x32_bf16 a[180:183], v[244:247], v[180:183], a[180:183]
v_exp_f32 v203, v203
v_mfma_f32_16x16x32_bf16 a[184:187], v[240:243], v[168:171], a[184:187]
ds_read_b128 v[236:239], v248 offset:23040
v_cvt_pk_bf16_f32 v152, v200, v201
v_mfma_f32_16x16x32_bf16 a[184:187], v[244:247], v[184:187], a[184:187]
v_cvt_pk_bf16_f32 v153, v202, v203
v_mfma_f32_16x16x32_bf16 a[188:191], v[240:243], v[172:175], a[188:191]
v_exp_f32 v204, v204
v_mfma_f32_16x16x32_bf16 a[188:191], v[244:247], v[188:191], a[188:191]
s_waitcnt lgkmcnt(2)
v_mfma_f32_16x16x32_bf16 v[208:211], v[224:227], v[0:3], 0
ds_read_b128 v[240:243], v248 offset:26624
v_mfma_f32_16x16x32_bf16 v[208:211], v[228:231], v[4:7], v[208:211]
v_exp_f32 v205, v205
v_mfma_f32_16x16x32_bf16 v[212:215], v[224:227], v[32:35], 0
v_exp_f32 v206, v206
v_mfma_f32_16x16x32_bf16 v[212:215], v[228:231], v[36:39], v[212:215]
v_exp_f32 v207, v207
v_mfma_f32_16x16x32_bf16 v[216:219], v[224:227], v[64:67], 0
ds_read_b128 v[244:247], v248 offset:27136
v_cvt_pk_bf16_f32 v156, v204, v205
v_mfma_f32_16x16x32_bf16 v[216:219], v[228:231], v[68:71], v[216:219]
v_cvt_pk_bf16_f32 v157, v206, v207
v_mfma_f32_16x16x32_bf16 v[220:223], v[224:227], v[96:99], 0
v_mfma_f32_16x16x32_bf16 v[220:223], v[228:231], v[100:103], v[220:223]
s_waitcnt lgkmcnt(2)
v_mfma_f32_16x16x32_bf16 v[208:211], v[232:235], v[8:11], v[208:211]
ds_read_b128 v[224:227], v248 offset:30720
v_mfma_f32_16x16x32_bf16 v[208:211], v[236:239], v[12:15], v[208:211]
v_mfma_f32_16x16x32_bf16 v[212:215], v[232:235], v[40:43], v[212:215]
v_mfma_f32_16x16x32_bf16 v[212:215], v[236:239], v[44:47], v[212:215]
v_mfma_f32_16x16x32_bf16 v[216:219], v[232:235], v[72:75], v[216:219]
ds_read_b128 v[228:231], v248 offset:31232
v_mfma_f32_16x16x32_bf16 v[216:219], v[236:239], v[76:79], v[216:219]
v_mfma_f32_16x16x32_bf16 v[220:223], v[232:235], v[104:107], v[220:223]
v_mfma_f32_16x16x32_bf16 v[220:223], v[236:239], v[108:111], v[220:223]
s_waitcnt lgkmcnt(2)
v_mfma_f32_16x16x32_bf16 v[208:211], v[240:243], v[16:19], v[208:211]
ds_read_b64_tr_b16 v[232:233], v249 offset:45056
v_mfma_f32_16x16x32_bf16 v[208:211], v[244:247], v[20:23], v[208:211]
v_mfma_f32_16x16x32_bf16 v[212:215], v[240:243], v[48:51], v[212:215]
ds_read_b64_tr_b16 v[234:235], v249 offset:47104
v_mfma_f32_16x16x32_bf16 v[212:215], v[244:247], v[52:55], v[212:215]
v_mfma_f32_16x16x32_bf16 v[216:219], v[240:243], v[80:83], v[216:219]
ds_read_b64_tr_b16 v[236:237], v249 offset:61440
v_mfma_f32_16x16x32_bf16 v[216:219], v[244:247], v[84:87], v[216:219]
v_mfma_f32_16x16x32_bf16 v[220:223], v[240:243], v[112:115], v[220:223]
ds_read_b64_tr_b16 v[238:239], v249 offset:63488
v_mfma_f32_16x16x32_bf16 v[220:223], v[244:247], v[116:119], v[220:223]
s_waitcnt lgkmcnt(4)
v_mfma_f32_16x16x32_bf16 v[208:211], v[224:227], v[24:27], v[208:211]
ds_read_b64_tr_b16 v[240:241], v250 offset:45056
v_mfma_f32_16x16x32_bf16 v[208:211], v[228:231], v[28:31], v[208:211]
v_mfma_f32_16x16x32_bf16 v[212:215], v[224:227], v[56:59], v[212:215]
ds_read_b64_tr_b16 v[242:243], v250 offset:47104
v_mfma_f32_16x16x32_bf16 v[212:215], v[228:231], v[60:63], v[212:215]
v_mfma_f32_16x16x32_bf16 v[216:219], v[224:227], v[88:91], v[216:219]
ds_read_b64_tr_b16 v[244:245], v250 offset:61440
v_mfma_f32_16x16x32_bf16 v[216:219], v[228:231], v[92:95], v[216:219]
v_mfma_f32_16x16x32_bf16 v[220:223], v[224:227], v[120:123], v[220:223]
ds_read_b64_tr_b16 v[246:247], v250 offset:63488
v_mfma_f32_16x16x32_bf16 v[220:223], v[228:231], v[124:127], v[220:223]
s_waitcnt lgkmcnt(4)
v_mfma_f32_16x16x32_bf16 a[192:195], v[232:235], v[160:163], a[192:195]
ds_read_b64_tr_b16 v[224:225], v249 offset:45568
v_mfma_f32_16x16x32_bf16 a[192:195], v[236:239], v[176:179], a[192:195]
v_mfma_f32_16x16x32_bf16 a[196:199], v[232:235], v[164:167], a[196:199]
ds_read_b64_tr_b16 v[226:227], v249 offset:47616
v_mfma_f32_16x16x32_bf16 a[196:199], v[236:239], v[180:183], a[196:199]
v_exp_f32 v208, v208
v_mfma_f32_16x16x32_bf16 a[200:203], v[232:235], v[168:171], a[200:203]
ds_read_b64_tr_b16 v[228:229], v249 offset:61952
v_mfma_f32_16x16x32_bf16 a[200:203], v[236:239], v[184:187], a[200:203]
v_exp_f32 v209, v209
v_mfma_f32_16x16x32_bf16 a[204:207], v[232:235], v[172:175], a[204:207]
ds_read_b64_tr_b16 v[230:231], v249 offset:64000
v_cvt_pk_bf16_f32 v146, v208, v209
v_mfma_f32_16x16x32_bf16 a[204:207], v[236:239], v[188:191], a[204:207]
s_waitcnt lgkmcnt(4)
v_mfma_f32_16x16x32_bf16 a[208:211], v[240:243], v[160:163], a[208:211]
ds_read_b64_tr_b16 v[232:233], v250 offset:45568
v_mfma_f32_16x16x32_bf16 a[208:211], v[244:247], v[176:179], a[208:211]
v_exp_f32 v210, v210
v_mfma_f32_16x16x32_bf16 a[212:215], v[240:243], v[164:167], a[212:215]
ds_read_b64_tr_b16 v[234:235], v250 offset:47616
v_mfma_f32_16x16x32_bf16 a[212:215], v[244:247], v[180:183], a[212:215]
v_exp_f32 v211, v211
v_mfma_f32_16x16x32_bf16 a[216:219], v[240:243], v[168:171], a[216:219]
ds_read_b64_tr_b16 v[236:237], v250 offset:61952
v_cvt_pk_bf16_f32 v147, v210, v211
v_mfma_f32_16x16x32_bf16 a[216:219], v[244:247], v[184:187], a[216:219]
v_exp_f32 v212, v212
v_mfma_f32_16x16x32_bf16 a[220:223], v[240:243], v[172:175], a[220:223]
ds_read_b64_tr_b16 v[238:239], v250 offset:64000
v_mfma_f32_16x16x32_bf16 a[220:223], v[244:247], v[188:191], a[220:223]
s_waitcnt lgkmcnt(4)
v_mfma_f32_16x16x32_bf16 a[224:227], v[224:227], v[160:163], a[224:227]
ds_read_b128 v[240:243], v248 offset:32768
v_mfma_f32_16x16x32_bf16 a[224:227], v[228:231], v[176:179], a[224:227]
v_exp_f32 v213, v213
v_mfma_f32_16x16x32_bf16 a[228:231], v[224:227], v[164:167], a[228:231]
v_exp_f32 v214, v214
v_mfma_f32_16x16x32_bf16 a[228:231], v[228:231], v[180:183], a[228:231]
v_exp_f32 v215, v215
v_mfma_f32_16x16x32_bf16 a[232:235], v[224:227], v[168:171], a[232:235]
ds_read_b128 v[244:247], v248 offset:33280
v_cvt_pk_bf16_f32 v150, v212, v213
v_mfma_f32_16x16x32_bf16 a[232:235], v[228:231], v[184:187], a[232:235]
v_cvt_pk_bf16_f32 v151, v214, v215
v_mfma_f32_16x16x32_bf16 a[236:239], v[224:227], v[172:175], a[236:239]
v_exp_f32 v216, v216
v_mfma_f32_16x16x32_bf16 a[236:239], v[228:231], v[188:191], a[236:239]
s_waitcnt lgkmcnt(2)
v_mfma_f32_16x16x32_bf16 a[240:243], v[232:235], v[160:163], a[240:243]
ds_read_b128 v[224:227], v248 offset:36864
v_mfma_f32_16x16x32_bf16 a[240:243], v[236:239], v[176:179], a[240:243]
v_exp_f32 v217, v217
v_mfma_f32_16x16x32_bf16 a[244:247], v[232:235], v[164:167], a[244:247]
v_exp_f32 v218, v218
v_mfma_f32_16x16x32_bf16 a[244:247], v[236:239], v[180:183], a[244:247]
v_exp_f32 v219, v219
v_mfma_f32_16x16x32_bf16 a[248:251], v[232:235], v[168:171], a[248:251]
ds_read_b128 v[228:231], v248 offset:37376
v_cvt_pk_bf16_f32 v154, v216, v217
v_mfma_f32_16x16x32_bf16 a[248:251], v[236:239], v[184:187], a[248:251]
v_cvt_pk_bf16_f32 v155, v218, v219
v_mfma_f32_16x16x32_bf16 a[252:255], v[232:235], v[172:175], a[252:255]
v_exp_f32 v220, v220
v_mfma_f32_16x16x32_bf16 a[252:255], v[236:239], v[188:191], a[252:255]
s_waitcnt lgkmcnt(2)
v_mfma_f32_16x16x32_bf16 v[192:195], v[240:243], v[0:3], 0
ds_read_b128 v[232:235], v248 offset:40960
v_mfma_f32_16x16x32_bf16 v[192:195], v[244:247], v[4:7], v[192:195]
v_xor_b32 v249, 0x10000, v249
v_mfma_f32_16x16x32_bf16 v[196:199], v[240:243], v[32:35], 0
v_exp_f32 v221, v221
v_mfma_f32_16x16x32_bf16 v[196:199], v[244:247], v[36:39], v[196:199]
v_xor_b32 v250, 0x10000, v250
v_cvt_pk_bf16_f32 v158, v220, v221
v_mfma_f32_16x16x32_bf16 v[200:203], v[240:243], v[64:67], 0
ds_read_b128 v[236:239], v248 offset:41472
v_mfma_f32_16x16x32_bf16 v[200:203], v[244:247], v[68:71], v[200:203]
v_exp_f32 v222, v222
v_mfma_f32_16x16x32_bf16 v[204:207], v[240:243], v[96:99], 0
v_exp_f32 v223, v223
v_mfma_f32_16x16x32_bf16 v[204:207], v[244:247], v[100:103], v[204:207]
s_waitcnt lgkmcnt(2)
v_cvt_pk_bf16_f32 v159, v222, v223
v_mfma_f32_16x16x32_bf16 v[192:195], v[224:227], v[8:11], v[192:195]
ds_read_b128 v[240:243], v248 offset:45056
v_mfma_f32_16x16x32_bf16 v[192:195], v[228:231], v[12:15], v[192:195]
v_mfma_f32_16x16x32_bf16 v[196:199], v[224:227], v[40:43], v[196:199]
v_mfma_f32_16x16x32_bf16 v[196:199], v[228:231], v[44:47], v[196:199]
v_mfma_f32_16x16x32_bf16 v[200:203], v[224:227], v[72:75], v[200:203]
ds_read_b128 v[244:247], v248 offset:45568
v_mfma_f32_16x16x32_bf16 v[200:203], v[228:231], v[76:79], v[200:203]
v_mfma_f32_16x16x32_bf16 v[204:207], v[224:227], v[104:107], v[204:207]
v_mfma_f32_16x16x32_bf16 v[204:207], v[228:231], v[108:111], v[204:207]
s_waitcnt lgkmcnt(2)
v_mfma_f32_16x16x32_bf16 v[192:195], v[232:235], v[16:19], v[192:195]
ds_read_b64_tr_b16 v[224:225], v249 offset:0
v_mfma_f32_16x16x32_bf16 v[192:195], v[236:239], v[20:23], v[192:195]
v_mfma_f32_16x16x32_bf16 v[196:199], v[232:235], v[48:51], v[196:199]
ds_read_b64_tr_b16 v[226:227], v249 offset:2048
v_mfma_f32_16x16x32_bf16 v[196:199], v[236:239], v[52:55], v[196:199]
v_mfma_f32_16x16x32_bf16 v[200:203], v[232:235], v[80:83], v[200:203]
ds_read_b64_tr_b16 v[228:229], v249 offset:16384
v_mfma_f32_16x16x32_bf16 v[200:203], v[236:239], v[84:87], v[200:203]
v_mfma_f32_16x16x32_bf16 v[204:207], v[232:235], v[112:115], v[204:207]
ds_read_b64_tr_b16 v[230:231], v249 offset:18432
v_mfma_f32_16x16x32_bf16 v[204:207], v[236:239], v[116:119], v[204:207]
s_waitcnt lgkmcnt(4)
v_mfma_f32_16x16x32_bf16 v[192:195], v[240:243], v[24:27], v[192:195]
ds_read_b64_tr_b16 v[232:233], v250 offset:0
v_mfma_f32_16x16x32_bf16 v[192:195], v[244:247], v[28:31], v[192:195]
v_mfma_f32_16x16x32_bf16 v[196:199], v[240:243], v[56:59], v[196:199]
ds_read_b64_tr_b16 v[234:235], v250 offset:2048
v_mfma_f32_16x16x32_bf16 v[196:199], v[244:247], v[60:63], v[196:199]
v_mfma_f32_16x16x32_bf16 v[200:203], v[240:243], v[88:91], v[200:203]
ds_read_b64_tr_b16 v[236:237], v250 offset:16384
v_mfma_f32_16x16x32_bf16 v[200:203], v[244:247], v[92:95], v[200:203]
s_sub_u32 s31, s31, 1
v_mfma_f32_16x16x32_bf16 v[204:207], v[240:243], v[120:123], v[204:207]
ds_read_b64_tr_b16 v[238:239], v250 offset:18432
v_mfma_f32_16x16x32_bf16 v[204:207], v[244:247], v[124:127], v[204:207]
s_cbranch_scc0 L2_loop
L2_tails:
L2_tail_1:
s_cmp_eq_u32 s59, 7
s_cbranch_scc1 L2_tail_1_7
L2_tail_1_6:
s_waitcnt lgkmcnt(4)
v_mfma_f32_16x16x32_bf16 a[0:3], v[224:227], v[160:163], a[0:3]
ds_read_b128 v[240:243], v248 offset:2048
v_mfma_f32_16x16x32_bf16 a[0:3], v[228:231], v[176:179], a[0:3]
s_lshl_b32 s36, s34, 13
v_mfma_f32_16x16x32_bf16 a[4:7], v[224:227], v[164:167], a[4:7]
s_add_u32 s56, s4, 0x1000000
s_addc_u32 s57, s5, 0
v_mfma_f32_16x16x32_bf16 a[4:7], v[228:231], v[180:183], a[4:7]
s_add_u32 s36, s36, 0x20000
s_mov_b32 s58, 0x6c02000
v_mfma_f32_16x16x32_bf16 a[8:11], v[224:227], v[168:171], a[8:11]
ds_read_b128 v[244:247], v248 offset:2560
s_mov_b32 s59, 0x00020000
v_mfma_f32_16x16x32_bf16 a[8:11], v[228:231], v[184:187], a[8:11]
v_add_u32 v255, s36, v252
s_lshr_b32 s35, s2, 1
v_mfma_f32_16x16x32_bf16 a[12:15], v[224:227], v[172:175], a[12:15]
s_and_b32 s35, s35, 28
s_add_u32 s35, s35, s34
v_mfma_f32_16x16x32_bf16 a[12:15], v[228:231], v[188:191], a[12:15]
s_waitcnt lgkmcnt(2)
s_lshl_b32 s35, s35, 13
v_mfma_f32_16x16x32_bf16 a[16:19], v[232:235], v[160:163], a[16:19]
ds_read_b128 v[224:227], v248 offset:6144
v_lshlrev_b32 v253, 3, v252
v_mfma_f32_16x16x32_bf16 a[16:19], v[236:239], v[176:179], a[16:19]
buffer_load_dword v253, v253, s[56:59], s35 offen
ds_write_b128 v255, v[160:163] offset:0
v_mfma_f32_16x16x32_bf16 a[20:23], v[232:235], v[164:167], a[20:23]
v_exp_f32 v192, v192
v_mfma_f32_16x16x32_bf16 a[20:23], v[236:239], v[180:183], a[20:23]
v_exp_f32 v193, v193
v_mfma_f32_16x16x32_bf16 a[24:27], v[232:235], v[168:171], a[24:27]
ds_read_b128 v[228:231], v248 offset:6656
v_cvt_pk_bf16_f32 v128, v192, v193
v_mfma_f32_16x16x32_bf16 a[24:27], v[236:239], v[184:187], a[24:27]
v_exp_f32 v194, v194
v_mfma_f32_16x16x32_bf16 a[28:31], v[232:235], v[172:175], a[28:31]
v_exp_f32 v195, v195
v_mfma_f32_16x16x32_bf16 a[28:31], v[236:239], v[188:191], a[28:31]
s_waitcnt lgkmcnt(3)
v_cvt_pk_bf16_f32 v129, v194, v195
v_mfma_f32_16x16x32_bf16 v[208:211], v[240:243], v[0:3], 0
ds_read_b128 v[232:235], v248 offset:10240
ds_write_b128 v255, v[164:167] offset:1024
v_mfma_f32_16x16x32_bf16 v[208:211], v[244:247], v[4:7], v[208:211]
v_exp_f32 v196, v196
v_mfma_f32_16x16x32_bf16 v[212:215], v[240:243], v[32:35], 0
v_exp_f32 v197, v197
v_mfma_f32_16x16x32_bf16 v[212:215], v[244:247], v[36:39], v[212:215]
v_exp_f32 v198, v198
v_mfma_f32_16x16x32_bf16 v[216:219], v[240:243], v[64:67], 0
ds_read_b128 v[236:239], v248 offset:10752
v_cvt_pk_bf16_f32 v132, v196, v197
v_mfma_f32_16x16x32_bf16 v[216:219], v[244:247], v[68:71], v[216:219]
v_exp_f32 v199, v199
v_mfma_f32_16x16x32_bf16 v[220:223], v[240:243], v[96:99], 0
v_exp_f32 v200, v200
v_mfma_f32_16x16x32_bf16 v[220:223], v[244:247], v[100:103], v[220:223]
s_waitcnt lgkmcnt(3)
v_cvt_pk_bf16_f32 v133, v198, v199
v_mfma_f32_16x16x32_bf16 v[208:211], v[224:227], v[8:11], v[208:211]
ds_read_b128 v[240:243], v248 offset:14336
ds_write_b128 v255, v[168:171] offset:2048
v_mfma_f32_16x16x32_bf16 v[208:211], v[228:231], v[12:15], v[208:211]
v_exp_f32 v201, v201
v_mfma_f32_16x16x32_bf16 v[212:215], v[224:227], v[40:43], v[212:215]
v_exp_f32 v202, v202
v_mfma_f32_16x16x32_bf16 v[212:215], v[228:231], v[44:47], v[212:215]
v_exp_f32 v203, v203
v_mfma_f32_16x16x32_bf16 v[216:219], v[224:227], v[72:75], v[216:219]
ds_read_b128 v[244:247], v248 offset:14848
v_cvt_pk_bf16_f32 v136, v200, v201
v_mfma_f32_16x16x32_bf16 v[216:219], v[228:231], v[76:79], v[216:219]
v_cvt_pk_bf16_f32 v137, v202, v203
ds_write_b128 v255, v[172:175] offset:3072
v_mfma_f32_16x16x32_bf16 v[220:223], v[224:227], v[104:107], v[220:223]
v_exp_f32 v204, v204
v_mfma_f32_16x16x32_bf16 v[220:223], v[228:231], v[108:111], v[220:223]
s_waitcnt lgkmcnt(4)
s_waitcnt vmcnt(1)
s_barrier
v_mfma_f32_16x16x32_bf16 v[208:211], v[232:235], v[16:19], v[208:211]
ds_read_b128 v[224:227], v248 offset:16384
s_add_u32 m0, s30, 0xc000
v_mfma_f32_16x16x32_bf16 v[208:211], v[236:239], v[20:23], v[208:211]
s_and_b32 s100, s30, 0x10000
buffer_load_dwordx4 v251, s[12:15], s28 offen offset:0 lds
v_mfma_f32_16x16x32_bf16 v[212:215], v[232:235], v[48:51], v[212:215]
s_xor_b32 s100, s100, 0x10000
v_mfma_f32_16x16x32_bf16 v[212:215], v[236:239], v[52:55], v[212:215]
v_exp_f32 v205, v205
v_mfma_f32_16x16x32_bf16 v[216:219], v[232:235], v[80:83], v[216:219]
ds_read_b128 v[228:231], v248 offset:16896
v_cvt_pk_bf16_f32 v140, v204, v205
v_mfma_f32_16x16x32_bf16 v[216:219], v[236:239], v[84:87], v[216:219]
v_exp_f32 v206, v206
v_mfma_f32_16x16x32_bf16 v[220:223], v[232:235], v[112:115], v[220:223]
v_exp_f32 v207, v207
v_mfma_f32_16x16x32_bf16 v[220:223], v[236:239], v[116:119], v[220:223]
s_waitcnt lgkmcnt(3)
v_cvt_pk_bf16_f32 v141, v206, v207
v_mfma_f32_16x16x32_bf16 v[208:211], v[240:243], v[24:27], v[208:211]
ds_read_b128 v[232:235], v248 offset:20480
buffer_load_dwordx4 v251, s[12:15], s28 offen offset:1024 lds
v_mfma_f32_16x16x32_bf16 v[208:211], v[244:247], v[28:31], v[208:211]
v_mfma_f32_16x16x32_bf16 v[212:215], v[240:243], v[56:59], v[212:215]
buffer_load_dwordx4 v251, s[12:15], s28 offen offset:2048 lds
v_mfma_f32_16x16x32_bf16 v[212:215], v[244:247], v[60:63], v[212:215]
v_mfma_f32_16x16x32_bf16 v[216:219], v[240:243], v[88:91], v[216:219]
ds_read_b128 v[236:239], v248 offset:20992
buffer_load_dwordx4 v251, s[12:15], s28 offen offset:3072 lds
v_mfma_f32_16x16x32_bf16 v[216:219], v[244:247], v[92:95], v[216:219]
v_mfma_f32_16x16x32_bf16 v[220:223], v[240:243], v[120:123], v[220:223]
s_add_u32 s28, s28, 0x4000
v_mfma_f32_16x16x32_bf16 v[220:223], v[244:247], v[124:127], v[220:223]
s_waitcnt lgkmcnt(2)
v_mfma_f32_16x16x32_bf16 v[192:195], v[224:227], v[0:3], 0
ds_read_b128 v[240:243], v248 offset:24576
v_mfma_f32_16x16x32_bf16 v[192:195], v[228:231], v[4:7], v[192:195]
v_exp_f32 v208, v208
v_mfma_f32_16x16x32_bf16 v[196:199], v[224:227], v[32:35], 0
v_exp_f32 v209, v209
v_mfma_f32_16x16x32_bf16 v[196:199], v[228:231], v[36:39], v[196:199]
v_exp_f32 v210, v210
v_mfma_f32_16x16x32_bf16 v[200:203], v[224:227], v[64:67], 0
ds_read_b128 v[244:247], v248 offset:25088
v_cvt_pk_bf16_f32 v130, v208, v209
v_mfma_f32_16x16x32_bf16 v[200:203], v[228:231], v[68:71], v[200:203]
v_exp_f32 v211, v211
v_mfma_f32_16x16x32_bf16 v[204:207], v[224:227], v[96:99], 0
v_exp_f32 v212, v212
v_mfma_f32_16x16x32_bf16 v[204:207], v[228:231], v[100:103], v[204:207]
s_waitcnt lgkmcnt(2)
v_cvt_pk_bf16_f32 v131, v210, v211
v_mfma_f32_16x16x32_bf16 v[192:195], v[232:235], v[8:11], v[192:195]
ds_read_b128 v[224:227], v248 offset:28672
v_mfma_f32_16x16x32_bf16 v[192:195], v[236:239], v[12:15], v[192:195]
v_exp_f32 v213, v213
v_mfma_f32_16x16x32_bf16 v[196:199], v[232:235], v[40:43], v[196:199]
v_exp_f32 v214, v214
v_mfma_f32_16x16x32_bf16 v[196:199], v[236:239], v[44:47], v[196:199]
v_exp_f32 v215, v215
v_mfma_f32_16x16x32_bf16 v[200:203], v[232:235], v[72:75], v[200:203]
ds_read_b128 v[228:231], v248 offset:29184
v_cvt_pk_bf16_f32 v134, v212, v213
v_mfma_f32_16x16x32_bf16 v[200:203], v[236:239], v[76:79], v[200:203]
v_cvt_pk_bf16_f32 v135, v214, v215
v_mfma_f32_16x16x32_bf16 v[204:207], v[232:235], v[104:107], v[204:207]
v_exp_f32 v216, v216
v_mfma_f32_16x16x32_bf16 v[204:207], v[236:239], v[108:111], v[204:207]
s_waitcnt lgkmcnt(2)
v_mfma_f32_16x16x32_bf16 v[192:195], v[240:243], v[16:19], v[192:195]
ds_read_b128 v[232:235], v248 offset:18432
v_mfma_f32_16x16x32_bf16 v[192:195], v[244:247], v[20:23], v[192:195]
v_exp_f32 v217, v217
v_mfma_f32_16x16x32_bf16 v[196:199], v[240:243], v[48:51], v[196:199]
v_exp_f32 v218, v218
v_mfma_f32_16x16x32_bf16 v[196:199], v[244:247], v[52:55], v[196:199]
v_exp_f32 v219, v219
v_mfma_f32_16x16x32_bf16 v[200:203], v[240:243], v[80:83], v[200:203]
ds_read_b128 v[236:239], v248 offset:18944
v_cvt_pk_bf16_f32 v138, v216, v217
v_mfma_f32_16x16x32_bf16 v[200:203], v[244:247], v[84:87], v[200:203]
v_cvt_pk_bf16_f32 v139, v218, v219
v_mfma_f32_16x16x32_bf16 v[204:207], v[240:243], v[112:115], v[204:207]
v_exp_f32 v220, v220
v_mfma_f32_16x16x32_bf16 v[204:207], v[244:247], v[116:119], v[204:207]
s_waitcnt lgkmcnt(2)
v_mfma_f32_16x16x32_bf16 v[192:195], v[224:227], v[24:27], v[192:195]
ds_read_b128 v[240:243], v248 offset:22528
v_mfma_f32_16x16x32_bf16 v[192:195], v[228:231], v[28:31], v[192:195]
v_exp_f32 v221, v221
v_mfma_f32_16x16x32_bf16 v[196:199], v[224:227], v[56:59], v[196:199]
v_exp_f32 v222, v222
v_mfma_f32_16x16x32_bf16 v[196:199], v[228:231], v[60:63], v[196:199]
v_exp_f32 v223, v223
v_mfma_f32_16x16x32_bf16 v[200:203], v[224:227], v[88:91], v[200:203]
ds_read_b128 v[244:247], v248 offset:23040
v_cvt_pk_bf16_f32 v142, v220, v221
v_mfma_f32_16x16x32_bf16 v[200:203], v[228:231], v[92:95], v[200:203]
v_cvt_pk_bf16_f32 v143, v222, v223
v_mfma_f32_16x16x32_bf16 v[204:207], v[224:227], v[120:123], v[204:207]
v_mfma_f32_16x16x32_bf16 v[204:207], v[228:231], v[124:127], v[204:207]
s_waitcnt lgkmcnt(2)
v_mfma_f32_16x16x32_bf16 v[208:211], v[232:235], v[0:3], 0
ds_read_b128 v[224:227], v248 offset:26624
v_mfma_f32_16x16x32_bf16 v[208:211], v[236:239], v[4:7], v[208:211]
v_exp_f32 v192, v192
v_mfma_f32_16x16x32_bf16 v[212:215], v[232:235], v[32:35], 0
v_exp_f32 v193, v193
v_mfma_f32_16x16x32_bf16 v[212:215], v[236:239], v[36:39], v[212:215]
v_exp_f32 v194, v194
v_mfma_f32_16x16x32_bf16 v[216:219], v[232:235], v[64:67], 0
ds_read_b128 v[228:231], v248 offset:27136
v_cvt_pk_bf16_f32 v144, v192, v193
v_mfma_f32_16x16x32_bf16 v[216:219], v[236:239], v[68:71], v[216:219]
v_exp_f32 v195, v195
v_mfma_f32_16x16x32_bf16 v[220:223], v[232:235], v[96:99], 0
v_exp_f32 v196, v196
v_mfma_f32_16x16x32_bf16 v[220:223], v[236:239], v[100:103], v[220:223]
s_waitcnt lgkmcnt(2)
v_cvt_pk_bf16_f32 v145, v194, v195
v_mfma_f32_16x16x32_bf16 v[208:211], v[240:243], v[8:11], v[208:211]
ds_read_b128 v[232:235], v248 offset:30720
v_mfma_f32_16x16x32_bf16 v[208:211], v[244:247], v[12:15], v[208:211]
v_exp_f32 v197, v197
v_mfma_f32_16x16x32_bf16 v[212:215], v[240:243], v[40:43], v[212:215]
v_exp_f32 v198, v198
v_mfma_f32_16x16x32_bf16 v[212:215], v[244:247], v[44:47], v[212:215]
v_exp_f32 v199, v199
v_mfma_f32_16x16x32_bf16 v[216:219], v[240:243], v[72:75], v[216:219]
ds_read_b128 v[236:239], v248 offset:31232
v_cvt_pk_bf16_f32 v148, v196, v197
v_mfma_f32_16x16x32_bf16 v[216:219], v[244:247], v[76:79], v[216:219]
v_cvt_pk_bf16_f32 v149, v198, v199
v_mfma_f32_16x16x32_bf16 v[220:223], v[240:243], v[104:107], v[220:223]
v_exp_f32 v200, v200
v_mfma_f32_16x16x32_bf16 v[220:223], v[244:247], v[108:111], v[220:223]
s_waitcnt lgkmcnt(2)
v_mfma_f32_16x16x32_bf16 v[208:211], v[224:227], v[16:19], v[208:211]
ds_read_b128 v[240:243], v248 offset:32768
v_mfma_f32_16x16x32_bf16 v[208:211], v[228:231], v[20:23], v[208:211]
v_exp_f32 v201, v201
v_mfma_f32_16x16x32_bf16 v[212:215], v[224:227], v[48:51], v[212:215]
v_exp_f32 v202, v202
v_mfma_f32_16x16x32_bf16 v[212:215], v[228:231], v[52:55], v[212:215]
v_exp_f32 v203, v203
v_mfma_f32_16x16x32_bf16 v[216:219], v[224:227], v[80:83], v[216:219]
ds_read_b128 v[244:247], v248 offset:33280
v_cvt_pk_bf16_f32 v152, v200, v201
v_mfma_f32_16x16x32_bf16 v[216:219], v[228:231], v[84:87], v[216:219]
v_cvt_pk_bf16_f32 v153, v202, v203
v_mfma_f32_16x16x32_bf16 v[220:223], v[224:227], v[112:115], v[220:223]
v_exp_f32 v204, v204
v_mfma_f32_16x16x32_bf16 v[220:223], v[228:231], v[116:119], v[220:223]
s_waitcnt lgkmcnt(2)
v_mfma_f32_16x16x32_bf16 v[208:211], v[232:235], v[24:27], v[208:211]
ds_read_b128 v[224:227], v248 offset:36864
v_mfma_f32_16x16x32_bf16 v[208:211], v[236:239], v[28:31], v[208:211]
v_exp_f32 v205, v205
v_mfma_f32_16x16x32_bf16 v[212:215], v[232:235], v[56:59], v[212:215]
v_exp_f32 v206, v206
v_mfma_f32_16x16x32_bf16 v[212:215], v[236:239], v[60:63], v[212:215]
v_exp_f32 v207, v207
v_mfma_f32_16x16x32_bf16 v[216:219], v[232:235], v[88:91], v[216:219]
ds_read_b128 v[228:231], v248 offset:37376
v_cvt_pk_bf16_f32 v156, v204, v205
v_mfma_f32_16x16x32_bf16 v[216:219], v[236:239], v[92:95], v[216:219]
v_cvt_pk_bf16_f32 v157, v206, v207
v_mfma_f32_16x16x32_bf16 v[220:223], v[232:235], v[120:123], v[220:223]
v_mfma_f32_16x16x32_bf16 v[220:223], v[236:239], v[124:127], v[220:223]
s_waitcnt lgkmcnt(2)
v_mfma_f32_16x16x32_bf16 v[192:195], v[240:243], v[0:3], 0
ds_read_b128 v[232:235], v248 offset:40960
v_mfma_f32_16x16x32_bf16 v[192:195], v[244:247], v[4:7], v[192:195]
v_exp_f32 v208, v208
v_mfma_f32_16x16x32_bf16 v[196:199], v[240:243], v[32:35], 0
v_exp_f32 v209, v209
v_mfma_f32_16x16x32_bf16 v[196:199], v[244:247], v[36:39], v[196:199]
v_exp_f32 v210, v210
v_mfma_f32_16x16x32_bf16 v[200:203], v[240:243], v[64:67], 0
ds_read_b128 v[236:239], v248 offset:41472
v_cvt_pk_bf16_f32 v146, v208, v209
v_mfma_f32_16x16x32_bf16 v[200:203], v[244:247], v[68:71], v[200:203]
v_exp_f32 v211, v211
v_mfma_f32_16x16x32_bf16 v[204:207], v[240:243], v[96:99], 0
v_exp_f32 v212, v212
v_mfma_f32_16x16x32_bf16 v[204:207], v[244:247], v[100:103], v[204:207]
s_waitcnt lgkmcnt(2)
v_cvt_pk_bf16_f32 v147, v210, v211
v_mfma_f32_16x16x32_bf16 v[192:195], v[224:227], v[8:11], v[192:195]
ds_read_b128 v[240:243], v248 offset:45056
v_mfma_f32_16x16x32_bf16 v[192:195], v[228:231], v[12:15], v[192:195]
v_exp_f32 v213, v213
v_mfma_f32_16x16x32_bf16 v[196:199], v[224:227], v[40:43], v[196:199]
v_exp_f32 v214, v214
v_mfma_f32_16x16x32_bf16 v[196:199], v[228:231], v[44:47], v[196:199]
v_exp_f32 v215, v215
v_mfma_f32_16x16x32_bf16 v[200:203], v[224:227], v[72:75], v[200:203]
ds_read_b128 v[244:247], v248 offset:45568
v_cvt_pk_bf16_f32 v150, v212, v213
v_mfma_f32_16x16x32_bf16 v[200:203], v[228:231], v[76:79], v[200:203]
v_cvt_pk_bf16_f32 v151, v214, v215
v_mfma_f32_16x16x32_bf16 v[204:207], v[224:227], v[104:107], v[204:207]
v_exp_f32 v216, v216
v_mfma_f32_16x16x32_bf16 v[204:207], v[228:231], v[108:111], v[204:207]
s_waitcnt lgkmcnt(2)
v_mfma_f32_16x16x32_bf16 v[192:195], v[232:235], v[16:19], v[192:195]
ds_read_b128 v[224:227], v248 offset:34816
v_mfma_f32_16x16x32_bf16 v[192:195], v[236:239], v[20:23], v[192:195]
v_exp_f32 v217, v217
v_mfma_f32_16x16x32_bf16 v[196:199], v[232:235], v[48:51], v[196:199]
v_exp_f32 v218, v218
v_mfma_f32_16x16x32_bf16 v[196:199], v[236:239], v[52:55], v[196:199]
v_exp_f32 v219, v219
v_mfma_f32_16x16x32_bf16 v[200:203], v[232:235], v[80:83], v[200:203]
ds_read_b128 v[228:231], v248 offset:35328
v_cvt_pk_bf16_f32 v154, v216, v217
v_mfma_f32_16x16x32_bf16 v[200:203], v[236:239], v[84:87], v[200:203]
v_cvt_pk_bf16_f32 v155, v218, v219
v_mfma_f32_16x16x32_bf16 v[204:207], v[232:235], v[112:115], v[204:207]
v_exp_f32 v220, v220
v_mfma_f32_16x16x32_bf16 v[204:207], v[236:239], v[116:119], v[204:207]
s_waitcnt lgkmcnt(2)
v_mfma_f32_16x16x32_bf16 v[192:195], v[240:243], v[24:27], v[192:195]
ds_read_b128 v[232:235], v248 offset:38912
v_mfma_f32_16x16x32_bf16 v[192:195], v[244:247], v[28:31], v[192:195]
v_exp_f32 v221, v221
v_mfma_f32_16x16x32_bf16 v[196:199], v[240:243], v[56:59], v[196:199]
v_exp_f32 v222, v222
v_mfma_f32_16x16x32_bf16 v[196:199], v[244:247], v[60:63], v[196:199]
v_exp_f32 v223, v223
v_mfma_f32_16x16x32_bf16 v[200:203], v[240:243], v[88:91], v[200:203]
ds_read_b128 v[236:239], v248 offset:39424
v_cvt_pk_bf16_f32 v158, v220, v221
v_mfma_f32_16x16x32_bf16 v[200:203], v[244:247], v[92:95], v[200:203]
v_cvt_pk_bf16_f32 v159, v222, v223
v_mfma_f32_16x16x32_bf16 v[204:207], v[240:243], v[120:123], v[204:207]
v_mfma_f32_16x16x32_bf16 v[204:207], v[244:247], v[124:127], v[204:207]
s_waitcnt lgkmcnt(2)
v_mfma_f32_16x16x32_bf16 v[208:211], v[224:227], v[0:3], 0
ds_read_b128 v[240:243], v248 offset:43008
v_mfma_f32_16x16x32_bf16 v[208:211], v[228:231], v[4:7], v[208:211]
v_exp_f32 v192, v192
v_mfma_f32_16x16x32_bf16 v[212:215], v[224:227], v[32:35], 0
v_exp_f32 v193, v193
v_mfma_f32_16x16x32_bf16 v[212:215], v[228:231], v[36:39], v[212:215]
v_exp_f32 v194, v194
v_mfma_f32_16x16x32_bf16 v[216:219], v[224:227], v[64:67], 0
ds_read_b128 v[244:247], v248 offset:43520
v_cvt_pk_bf16_f32 v160, v192, v193
v_mfma_f32_16x16x32_bf16 v[216:219], v[228:231], v[68:71], v[216:219]
v_exp_f32 v195, v195
v_mfma_f32_16x16x32_bf16 v[220:223], v[224:227], v[96:99], 0
v_exp_f32 v196, v196
v_mfma_f32_16x16x32_bf16 v[220:223], v[228:231], v[100:103], v[220:223]
s_waitcnt lgkmcnt(2)
v_cvt_pk_bf16_f32 v161, v194, v195
v_mfma_f32_16x16x32_bf16 v[208:211], v[232:235], v[8:11], v[208:211]
ds_read_b128 v[224:227], v248 offset:47104
v_mfma_f32_16x16x32_bf16 v[208:211], v[236:239], v[12:15], v[208:211]
v_exp_f32 v197, v197
v_mfma_f32_16x16x32_bf16 v[212:215], v[232:235], v[40:43], v[212:215]
v_exp_f32 v198, v198
v_mfma_f32_16x16x32_bf16 v[212:215], v[236:239], v[44:47], v[212:215]
v_exp_f32 v199, v199
v_mfma_f32_16x16x32_bf16 v[216:219], v[232:235], v[72:75], v[216:219]
ds_read_b128 v[228:231], v248 offset:47616
v_cvt_pk_bf16_f32 v164, v196, v197
v_mfma_f32_16x16x32_bf16 v[216:219], v[236:239], v[76:79], v[216:219]
v_cvt_pk_bf16_f32 v165, v198, v199
v_mfma_f32_16x16x32_bf16 v[220:223], v[232:235], v[104:107], v[220:223]
v_exp_f32 v200, v200
v_mfma_f32_16x16x32_bf16 v[220:223], v[236:239], v[108:111], v[220:223]
s_waitcnt lgkmcnt(2)
s_waitcnt vmcnt(0)
s_barrier
v_mfma_f32_16x16x32_bf16 v[208:211], v[240:243], v[16:19], v[208:211]
ds_read_b128 v[232:235], v248 offset:49152
s_add_u32 s8, s6, 0x0
s_addc_u32 s9, s7, 0
v_mfma_f32_16x16x32_bf16 v[208:211], v[244:247], v[20:23], v[208:211]
v_exp_f32 v201, v201
s_mov_b32 s10, 0x4e2000
v_mfma_f32_16x16x32_bf16 v[212:215], v[240:243], v[48:51], v[212:215]
v_exp_f32 v202, v202
s_mov_b32 s11, 0x00020000
v_mfma_f32_16x16x32_bf16 v[212:215], v[244:247], v[52:55], v[212:215]
v_exp_f32 v203, v203
s_lshl_b32 s55, s34, 13
v_mfma_f32_16x16x32_bf16 v[216:219], v[240:243], v[80:83], v[216:219]
ds_read_b128 v[236:239], v248 offset:49664
v_cvt_pk_bf16_f32 v168, v200, v201
s_add_u32 s55, s55, 0x21000
v_mfma_f32_16x16x32_bf16 v[216:219], v[244:247], v[84:87], v[216:219]
v_cvt_pk_bf16_f32 v169, v202, v203
s_lshl_b32 s36, s34, 7
v_bfe_u32 v253, v252, 4, 3
v_mfma_f32_16x16x32_bf16 v[220:223], v[240:243], v[112:115], v[220:223]
v_exp_f32 v204, v204
v_lshrrev_b32 v254, 7, v252
v_mfma_f32_16x16x32_bf16 v[220:223], v[244:247], v[116:119], v[220:223]
s_waitcnt lgkmcnt(2)
v_xor_b32 v253, v253, v254
v_lshl_add_u32 v254, v254, 9, s36
v_mfma_f32_16x16x32_bf16 v[208:211], v[224:227], v[24:27], v[208:211]
ds_read_b128 v[240:243], v248 offset:53248
v_lshl_add_u32 v253, v253, 4, v254
s_add_u32 m0, s55, 0
v_mfma_f32_16x16x32_bf16 v[208:211], v[228:231], v[28:31], v[208:211]
v_exp_f32 v205, v205
s_add_u32 s35, s52, 0
v_mfma_f32_16x16x32_bf16 v[212:215], v[224:227], v[56:59], v[212:215]
v_exp_f32 v206, v206
buffer_load_dwordx4 v253, s[8:11], s35 offen lds
v_mfma_f32_16x16x32_bf16 v[212:215], v[228:231], v[60:63], v[212:215]
v_exp_f32 v207, v207
s_add_u32 m0, s55, 1024
v_mfma_f32_16x16x32_bf16 v[216:219], v[224:227], v[88:91], v[216:219]
ds_read_b128 v[244:247], v248 offset:53760
v_cvt_pk_bf16_f32 v172, v204, v205
s_add_u32 s35, s52, 4096
v_mfma_f32_16x16x32_bf16 v[216:219], v[228:231], v[92:95], v[216:219]
v_cvt_pk_bf16_f32 v173, v206, v207
buffer_load_dwordx4 v253, s[8:11], s35 offen lds
s_add_u32 m0, s55, 2048
v_mfma_f32_16x16x32_bf16 v[220:223], v[224:227], v[120:123], v[220:223]
s_add_u32 s35, s53, 0
buffer_load_dwordx4 v253, s[8:11], s35 offen lds
s_add_u32 m0, s55, 3072
v_mfma_f32_16x16x32_bf16 v[220:223], v[228:231], v[124:127], v[220:223]
s_waitcnt lgkmcnt(2)
s_add_u32 s35, s53, 4096
buffer_load_dwordx4 v253, s[8:11], s35 offen lds
v_mfma_f32_16x16x32_bf16 v[192:195], v[232:235], v[0:3], 0
ds_read_b128 v[224:227], v248 offset:57344
v_mfma_f32_16x16x32_bf16 v[192:195], v[236:239], v[4:7], v[192:195]
v_exp_f32 v208, v208
v_mfma_f32_16x16x32_bf16 v[196:199], v[232:235], v[32:35], 0
v_exp_f32 v209, v209
v_mfma_f32_16x16x32_bf16 v[196:199], v[236:239], v[36:39], v[196:199]
v_exp_f32 v210, v210
v_mfma_f32_16x16x32_bf16 v[200:203], v[232:235], v[64:67], 0
ds_read_b128 v[228:231], v248 offset:57856
v_cvt_pk_bf16_f32 v162, v208, v209
v_mfma_f32_16x16x32_bf16 v[200:203], v[236:239], v[68:71], v[200:203]
v_exp_f32 v211, v211
v_mfma_f32_16x16x32_bf16 v[204:207], v[232:235], v[96:99], 0
v_exp_f32 v212, v212
v_mfma_f32_16x16x32_bf16 v[204:207], v[236:239], v[100:103], v[204:207]
s_waitcnt lgkmcnt(2)
v_cvt_pk_bf16_f32 v163, v210, v211
v_mfma_f32_16x16x32_bf16 v[192:195], v[240:243], v[8:11], v[192:195]
ds_read_b128 v[232:235], v248 offset:61440
v_mfma_f32_16x16x32_bf16 v[192:195], v[244:247], v[12:15], v[192:195]
v_exp_f32 v213, v213
v_mfma_f32_16x16x32_bf16 v[196:199], v[240:243], v[40:43], v[196:199]
v_exp_f32 v214, v214
v_mfma_f32_16x16x32_bf16 v[196:199], v[244:247], v[44:47], v[196:199]
v_exp_f32 v215, v215
v_mfma_f32_16x16x32_bf16 v[200:203], v[240:243], v[72:75], v[200:203]
ds_read_b128 v[236:239], v248 offset:61952
v_cvt_pk_bf16_f32 v166, v212, v213
v_mfma_f32_16x16x32_bf16 v[200:203], v[244:247], v[76:79], v[200:203]
v_cvt_pk_bf16_f32 v167, v214, v215
v_mfma_f32_16x16x32_bf16 v[204:207], v[240:243], v[104:107], v[204:207]
v_exp_f32 v216, v216
v_mfma_f32_16x16x32_bf16 v[204:207], v[244:247], v[108:111], v[204:207]
s_waitcnt lgkmcnt(2)
v_mfma_f32_16x16x32_bf16 v[192:195], v[224:227], v[16:19], v[192:195]
ds_read_b128 v[240:243], v248 offset:51200
v_mfma_f32_16x16x32_bf16 v[192:195], v[228:231], v[20:23], v[192:195]
v_exp_f32 v217, v217
v_mfma_f32_16x16x32_bf16 v[196:199], v[224:227], v[48:51], v[196:199]
v_exp_f32 v218, v218
v_mfma_f32_16x16x32_bf16 v[196:199], v[228:231], v[52:55], v[196:199]
v_exp_f32 v219, v219
v_mfma_f32_16x16x32_bf16 v[200:203], v[224:227], v[80:83], v[200:203]
ds_read_b128 v[244:247], v248 offset:51712
v_cvt_pk_bf16_f32 v170, v216, v217
v_mfma_f32_16x16x32_bf16 v[200:203], v[228:231], v[84:87], v[200:203]
v_cvt_pk_bf16_f32 v171, v218, v219
v_mfma_f32_16x16x32_bf16 v[204:207], v[224:227], v[112:115], v[204:207]
v_exp_f32 v220, v220
v_mfma_f32_16x16x32_bf16 v[204:207], v[228:231], v[116:119], v[204:207]
s_waitcnt lgkmcnt(2)
v_mfma_f32_16x16x32_bf16 v[192:195], v[232:235], v[24:27], v[192:195]
ds_read_b128 v[224:227], v248 offset:55296
v_mfma_f32_16x16x32_bf16 v[192:195], v[236:239], v[28:31], v[192:195]
v_exp_f32 v221, v221
v_mfma_f32_16x16x32_bf16 v[196:199], v[232:235], v[56:59], v[196:199]
v_exp_f32 v222, v222
v_mfma_f32_16x16x32_bf16 v[196:199], v[236:239], v[60:63], v[196:199]
v_exp_f32 v223, v223
v_mfma_f32_16x16x32_bf16 v[200:203], v[232:235], v[88:91], v[200:203]
ds_read_b128 v[228:231], v248 offset:55808
v_cvt_pk_bf16_f32 v174, v220, v221
v_mfma_f32_16x16x32_bf16 v[200:203], v[236:239], v[92:95], v[200:203]
v_cvt_pk_bf16_f32 v175, v222, v223
v_mfma_f32_16x16x32_bf16 v[204:207], v[232:235], v[120:123], v[204:207]
v_mfma_f32_16x16x32_bf16 v[204:207], v[236:239], v[124:127], v[204:207]
s_waitcnt lgkmcnt(2)
v_mfma_f32_16x16x32_bf16 v[208:211], v[240:243], v[0:3], 0
ds_read_b128 v[232:235], v248 offset:59392
v_mfma_f32_16x16x32_bf16 v[208:211], v[244:247], v[4:7], v[208:211]
v_exp_f32 v192, v192
v_mfma_f32_16x16x32_bf16 v[212:215], v[240:243], v[32:35], 0
v_exp_f32 v193, v193
v_mfma_f32_16x16x32_bf16 v[212:215], v[244:247], v[36:39], v[212:215]
v_exp_f32 v194, v194
v_mfma_f32_16x16x32_bf16 v[216:219], v[240:243], v[64:67], 0
ds_read_b128 v[236:239], v248 offset:59904
v_cvt_pk_bf16_f32 v0, v192, v193
v_mfma_f32_16x16x32_bf16 v[216:219], v[244:247], v[68:71], v[216:219]
v_exp_f32 v195, v195
v_mfma_f32_16x16x32_bf16 v[220:223], v[240:243], v[96:99], 0
v_exp_f32 v196, v196
v_mfma_f32_16x16x32_bf16 v[220:223], v[244:247], v[100:103], v[220:223]
s_waitcnt lgkmcnt(2)
v_cvt_pk_bf16_f32 v1, v194, v195
v_mfma_f32_16x16x32_bf16 v[208:211], v[224:227], v[8:11], v[208:211]
ds_read_b128 v[240:243], v248 offset:63488
v_mfma_f32_16x16x32_bf16 v[208:211], v[228:231], v[12:15], v[208:211]
v_exp_f32 v197, v197
v_mfma_f32_16x16x32_bf16 v[212:215], v[224:227], v[40:43], v[212:215]
ds_read_b128 v[4:7], v255 offset:0
ds_read_b128 v[36:39], v255 offset:1024
v_mfma_f32_16x16x32_bf16 v[212:215], v[228:231], v[44:47], v[212:215]
v_exp_f32 v198, v198
v_mfma_f32_16x16x32_bf16 v[216:219], v[224:227], v[72:75], v[216:219]
ds_read_b128 v[244:247], v248 offset:64000
v_xor_b32 v12, 0x10000, v249
v_mfma_f32_16x16x32_bf16 v[216:219], v[228:231], v[76:79], v[216:219]
v_xor_b32 v13, 0x10000, v250
v_cvt_pk_bf16_f32 v32, v196, v197
v_mfma_f32_16x16x32_bf16 v[220:223], v[224:227], v[104:107], v[220:223]
ds_read_b128 v[68:71], v255 offset:2048
ds_read_b128 v[100:103], v255 offset:3072
v_mfma_f32_16x16x32_bf16 v[220:223], v[228:231], v[108:111], v[220:223]
s_waitcnt lgkmcnt(6)
v_mfma_f32_16x16x32_bf16 v[208:211], v[232:235], v[16:19], v[208:211]
ds_read_b64_tr_b16 v[224:225], v12 offset:0
ds_read_b64_tr_b16 v[226:227], v12 offset:2048
v_mfma_f32_16x16x32_bf16 v[208:211], v[236:239], v[20:23], v[208:211]
v_exp_f32 v199, v199
v_mfma_f32_16x16x32_bf16 v[212:215], v[232:235], v[48:51], v[212:215]
v_cvt_pk_bf16_f32 v33, v198, v199
v_mfma_f32_16x16x32_bf16 v[212:215], v[236:239], v[52:55], v[212:215]
v_exp_f32 v200, v200
v_mfma_f32_16x16x32_bf16 v[216:219], v[232:235], v[80:83], v[216:219]
ds_read_b64_tr_b16 v[228:229], v12 offset:16384
ds_read_b64_tr_b16 v[230:231], v12 offset:18432
v_mfma_f32_16x16x32_bf16 v[216:219], v[236:239], v[84:87], v[216:219]
v_exp_f32 v201, v201
v_mfma_f32_16x16x32_bf16 v[220:223], v[232:235], v[112:115], v[220:223]
v_exp_f32 v202, v202
v_mfma_f32_16x16x32_bf16 v[220:223], v[236:239], v[116:119], v[220:223]
s_waitcnt lgkmcnt(6)
v_cvt_pk_bf16_f32 v64, v200, v201
v_mfma_f32_16x16x32_bf16 v[208:211], v[240:243], v[24:27], v[208:211]
ds_read_b64_tr_b16 v[232:233], v13 offset:0
ds_read_b64_tr_b16 v[234:235], v13 offset:2048
v_mfma_f32_16x16x32_bf16 v[208:211], v[244:247], v[28:31], v[208:211]
v_exp_f32 v203, v203
v_mfma_f32_16x16x32_bf16 v[212:215], v[240:243], v[56:59], v[212:215]
v_cvt_pk_bf16_f32 v65, v202, v203
v_mfma_f32_16x16x32_bf16 v[212:215], v[244:247], v[60:63], v[212:215]
v_exp_f32 v204, v204
v_mfma_f32_16x16x32_bf16 v[216:219], v[240:243], v[88:91], v[216:219]
ds_read_b64_tr_b16 v[236:237], v13 offset:16384
ds_read_b64_tr_b16 v[238:239], v13 offset:18432
v_mfma_f32_16x16x32_bf16 v[216:219], v[244:247], v[92:95], v[216:219]
v_exp_f32 v205, v205
v_mfma_f32_16x16x32_bf16 v[220:223], v[240:243], v[120:123], v[220:223]
v_exp_f32 v206, v206
v_mfma_f32_16x16x32_bf16 v[220:223], v[244:247], v[124:127], v[220:223]
s_waitcnt lgkmcnt(4)
v_mfma_f32_16x16x32_bf16 a[0:3], v[224:227], v[128:131], a[0:3]
ds_read_b64_tr_b16 v[240:241], v249 offset:33280
ds_read_b64_tr_b16 v[242:243], v249 offset:35328
v_mfma_f32_16x16x32_bf16 a[0:3], v[228:231], v[144:147], a[0:3]
v_exp_f32 v207, v207
v_mfma_f32_16x16x32_bf16 a[4:7], v[224:227], v[132:135], a[4:7]
v_cvt_pk_bf16_f32 v96, v204, v205
v_cvt_pk_bf16_f32 v97, v206, v207
v_mfma_f32_16x16x32_bf16 a[4:7], v[228:231], v[148:151], a[4:7]
v_exp_f32 v208, v208
v_mfma_f32_16x16x32_bf16 a[8:11], v[224:227], v[136:139], a[8:11]
ds_read_b64_tr_b16 v[244:245], v249 offset:49664
ds_read_b64_tr_b16 v[246:247], v249 offset:51712
v_mfma_f32_16x16x32_bf16 a[8:11], v[228:231], v[152:155], a[8:11]
v_exp_f32 v209, v209
v_mfma_f32_16x16x32_bf16 a[12:15], v[224:227], v[140:143], a[12:15]
v_exp_f32 v210, v210
v_mfma_f32_16x16x32_bf16 a[12:15], v[228:231], v[156:159], a[12:15]
s_waitcnt lgkmcnt(4)
v_cvt_pk_bf16_f32 v2, v208, v209
v_mfma_f32_16x16x32_bf16 a[16:19], v[232:235], v[128:131], a[16:19]
ds_read_b64_tr_b16 v[224:225], v12 offset:512
ds_read_b64_tr_b16 v[226:227], v12 offset:2560
v_mfma_f32_16x16x32_bf16 a[16:19], v[236:239], v[144:147], a[16:19]
v_exp_f32 v211, v211
v_mfma_f32_16x16x32_bf16 a[20:23], v[232:235], v[132:135], a[20:23]
v_cvt_pk_bf16_f32 v3, v210, v211
v_mfma_f32_16x16x32_bf16 a[20:23], v[236:239], v[148:151], a[20:23]
v_exp_f32 v212, v212
v_mfma_f32_16x16x32_bf16 a[24:27], v[232:235], v[136:139], a[24:27]
ds_read_b64_tr_b16 v[228:229], v12 offset:16896
ds_read_b64_tr_b16 v[230:231], v12 offset:18944
v_mfma_f32_16x16x32_bf16 a[24:27], v[236:239], v[152:155], a[24:27]
v_exp_f32 v213, v213
v_mfma_f32_16x16x32_bf16 a[28:31], v[232:235], v[140:143], a[28:31]
v_exp_f32 v214, v214
v_mfma_f32_16x16x32_bf16 a[28:31], v[236:239], v[156:159], a[28:31]
s_waitcnt lgkmcnt(4)
v_cvt_pk_bf16_f32 v34, v212, v213
v_mfma_f32_16x16x32_bf16 a[32:35], v[240:243], v[4:7], a[32:35]
ds_read_b64_tr_b16 v[232:233], v250 offset:33280
ds_read_b64_tr_b16 v[234:235], v250 offset:35328
v_mfma_f32_16x16x32_bf16 a[32:35], v[244:247], v[176:179], a[32:35]
v_exp_f32 v215, v215
v_mfma_f32_16x16x32_bf16 a[36:39], v[240:243], v[36:39], a[36:39]
v_cvt_pk_bf16_f32 v35, v214, v215
v_mfma_f32_16x16x32_bf16 a[36:39], v[244:247], v[180:183], a[36:39]
v_exp_f32 v216, v216
v_mfma_f32_16x16x32_bf16 a[40:43], v[240:243], v[68:71], a[40:43]
ds_read_b64_tr_b16 v[236:237], v250 offset:49664
ds_read_b64_tr_b16 v[238:239], v250 offset:51712
v_mfma_f32_16x16x32_bf16 a[40:43], v[244:247], v[184:187], a[40:43]
v_exp_f32 v217, v217
v_mfma_f32_16x16x32_bf16 a[44:47], v[240:243], v[100:103], a[44:47]
v_exp_f32 v218, v218
v_mfma_f32_16x16x32_bf16 a[44:47], v[244:247], v[188:191], a[44:47]
s_waitcnt lgkmcnt(4)
v_cvt_pk_bf16_f32 v66, v216, v217
v_mfma_f32_16x16x32_bf16 a[32:35], v[224:227], v[128:131], a[32:35]
ds_read_b64_tr_b16 v[240:241], v12 offset:32768
ds_read_b64_tr_b16 v[242:243], v12 offset:34816
v_mfma_f32_16x16x32_bf16 a[32:35], v[228:231], v[144:147], a[32:35]
v_exp_f32 v219, v219
v_mfma_f32_16x16x32_bf16 a[36:39], v[224:227], v[132:135], a[36:39]
v_cvt_pk_bf16_f32 v67, v218, v219
v_mfma_f32_16x16x32_bf16 a[36:39], v[228:231], v[148:151], a[36:39]
v_exp_f32 v220, v220
v_mfma_f32_16x16x32_bf16 a[40:43], v[224:227], v[136:139], a[40:43]
ds_read_b64_tr_b16 v[244:245], v12 offset:49152
ds_read_b64_tr_b16 v[246:247], v12 offset:51200
v_mfma_f32_16x16x32_bf16 a[40:43], v[228:231], v[152:155], a[40:43]
v_exp_f32 v221, v221
v_mfma_f32_16x16x32_bf16 a[44:47], v[224:227], v[140:143], a[44:47]
v_exp_f32 v222, v222
v_mfma_f32_16x16x32_bf16 a[44:47], v[228:231], v[156:159], a[44:47]
s_waitcnt lgkmcnt(4)
v_cvt_pk_bf16_f32 v98, v220, v221
v_mfma_f32_16x16x32_bf16 a[48:51], v[232:235], v[4:7], a[48:51]
ds_read_b64_tr_b16 v[224:225], v13 offset:32768
ds_read_b64_tr_b16 v[226:227], v13 offset:34816
v_mfma_f32_16x16x32_bf16 a[48:51], v[236:239], v[176:179], a[48:51]
v_exp_f32 v223, v223
v_mfma_f32_16x16x32_bf16 a[52:55], v[232:235], v[36:39], a[52:55]
v_cvt_pk_bf16_f32 v99, v222, v223
v_mfma_f32_16x16x32_bf16 a[52:55], v[236:239], v[180:183], a[52:55]
v_mfma_f32_16x16x32_bf16 a[56:59], v[232:235], v[68:71], a[56:59]
ds_read_b64_tr_b16 v[228:229], v13 offset:49152
ds_read_b64_tr_b16 v[230:231], v13 offset:51200
v_mfma_f32_16x16x32_bf16 a[56:59], v[236:239], v[184:187], a[56:59]
v_mfma_f32_16x16x32_bf16 a[60:63], v[232:235], v[100:103], a[60:63]
v_mfma_f32_16x16x32_bf16 a[60:63], v[236:239], v[188:191], a[60:63]
s_waitcnt lgkmcnt(4)
v_mfma_f32_16x16x32_bf16 a[0:3], v[240:243], v[160:163], a[0:3]
ds_read_b64_tr_b16 v[232:233], v12 offset:33280
ds_read_b64_tr_b16 v[234:235], v12 offset:35328
v_mfma_f32_16x16x32_bf16 a[0:3], v[244:247], v[0:3], a[0:3]
v_mfma_f32_16x16x32_bf16 a[4:7], v[240:243], v[164:167], a[4:7]
v_mfma_f32_16x16x32_bf16 a[4:7], v[244:247], v[32:35], a[4:7]
v_mfma_f32_16x16x32_bf16 a[8:11], v[240:243], v[168:171], a[8:11]
ds_read_b64_tr_b16 v[236:237], v12 offset:49664
ds_read_b64_tr_b16 v[238:239], v12 offset:51712
v_mfma_f32_16x16x32_bf16 a[8:11], v[244:247], v[64:67], a[8:11]
v_mfma_f32_16x16x32_bf16 a[12:15], v[240:243], v[172:175], a[12:15]
v_mfma_f32_16x16x32_bf16 a[12:15], v[244:247], v[96:99], a[12:15]
s_waitcnt lgkmcnt(4)
v_mfma_f32_16x16x32_bf16 a[16:19], v[224:227], v[160:163], a[16:19]
ds_read_b64_tr_b16 v[240:241], v13 offset:512
ds_read_b64_tr_b16 v[242:243], v13 offset:2560
v_mfma_f32_16x16x32_bf16 a[16:19], v[228:231], v[0:3], a[16:19]
v_mfma_f32_16x16x32_bf16 a[20:23], v[224:227], v[164:167], a[20:23]
v_mfma_f32_16x16x32_bf16 a[20:23], v[228:231], v[32:35], a[20:23]
v_mfma_f32_16x16x32_bf16 a[24:27], v[224:227], v[168:171], a[24:27]
ds_read_b64_tr_b16 v[244:245], v13 offset:16896
ds_read_b64_tr_b16 v[246:247], v13 offset:18944
v_accvgpr_read_b32 v192, a0
v_mfma_f32_16x16x32_bf16 a[24:27], v[228:231], v[64:67], a[24:27]
v_accvgpr_read_b32 v193, a4
v_accvgpr_read_b32 v194, a8
v_accvgpr_read_b32 v195, a12
v_mfma_f32_16x16x32_bf16 a[28:31], v[224:227], v[172:175], a[28:31]
v_lshlrev_b32 v253, 2, v252
v_subrev_u32 v196, 0x0d800000, v192
v_subrev_u32 v197, 0x0d800000, v193
v_mfma_f32_16x16x32_bf16 a[28:31], v[228:231], v[96:99], a[28:31]
s_waitcnt lgkmcnt(4)
v_subrev_u32 v198, 0x0d800000, v194
v_subrev_u32 v199, 0x0d800000, v195
v_mfma_f32_16x16x32_bf16 a[32:35], v[232:235], v[160:163], a[32:35]
ds_read_b64_tr_b16 v[224:225], v13 offset:33280
ds_read_b64_tr_b16 v[226:227], v13 offset:35328
v_max3_u32 v254, v196, v197, v198
v_mfma_f32_16x16x32_bf16 a[32:35], v[236:239], v[0:3], a[32:35]
v_max_u32 v254, v254, v199
v_mfma_f32_16x16x32_bf16 a[36:39], v[232:235], v[164:167], a[36:39]
s_mov_b64 exec, 0xffff
s_xor_b32 s35, s48, 0
buffer_store_dword v192, v253, s[24:27], s35 offen offset:4 sc1
s_xor_b32 s35, s48, 1024
buffer_store_dword v193, v253, s[24:27], s35 offen offset:4 sc1
s_xor_b32 s35, s48, 2048
buffer_store_dword v194, v253, s[24:27], s35 offen offset:4 sc1
s_xor_b32 s35, s48, 3072
buffer_store_dword v195, v253, s[24:27], s35 offen offset:4 sc1
v_cmp_le_u32 vcc, 0x64000000, v254
s_mov_b64 exec, -1
v_mfma_f32_16x16x32_bf16 a[36:39], v[236:239], v[32:35], a[36:39]
v_accvgpr_read_b32 v192, a0
v_accvgpr_read_b32 v193, a1
v_mfma_f32_16x16x32_bf16 a[40:43], v[232:235], v[168:171], a[40:43]
ds_read_b64_tr_b16 v[228:229], v13 offset:49664
ds_read_b64_tr_b16 v[230:231], v13 offset:51712
v_mfma_f32_16x16x32_bf16 a[40:43], v[236:239], v[64:67], a[40:43]
v_accvgpr_read_b32 v194, a2
v_accvgpr_read_b32 v195, a3
v_mfma_f32_16x16x32_bf16 a[44:47], v[232:235], v[172:175], a[44:47]
v_cvt_pk_bf16_f32 v16, v192, v193
v_cvt_pk_bf16_f32 v17, v194, v195
v_mfma_f32_16x16x32_bf16 a[44:47], v[236:239], v[96:99], a[44:47]
s_waitcnt lgkmcnt(4)
v_accvgpr_read_b32 v200, a4
v_mfma_f32_16x16x32_bf16 a[48:51], v[240:243], v[128:131], a[48:51]
ds_read_b64_tr_b16 v[232:233], v249 offset:36864
ds_read_b64_tr_b16 v[234:235], v249 offset:38912
v_mfma_f32_16x16x32_bf16 a[48:51], v[244:247], v[144:147], a[48:51]
v_accvgpr_read_b32 v201, a5
v_accvgpr_read_b32 v202, a6
v_mfma_f32_16x16x32_bf16 a[52:55], v[240:243], v[132:135], a[52:55]
v_accvgpr_read_b32 v203, a7
v_cvt_pk_bf16_f32 v48, v200, v201
v_mfma_f32_16x16x32_bf16 a[52:55], v[244:247], v[148:151], a[52:55]
v_cvt_pk_bf16_f32 v49, v202, v203
v_accvgpr_read_b32 v208, a8
v_mfma_f32_16x16x32_bf16 a[56:59], v[240:243], v[136:139], a[56:59]
ds_read_b64_tr_b16 v[236:237], v249 offset:53248
ds_read_b64_tr_b16 v[238:239], v249 offset:55296
v_mfma_f32_16x16x32_bf16 a[56:59], v[244:247], v[152:155], a[56:59]
v_accvgpr_read_b32 v209, a9
v_accvgpr_read_b32 v210, a10
v_mfma_f32_16x16x32_bf16 a[60:63], v[240:243], v[140:143], a[60:63]
v_accvgpr_read_b32 v211, a11
v_cvt_pk_bf16_f32 v80, v208, v209
v_mfma_f32_16x16x32_bf16 a[60:63], v[244:247], v[156:159], a[60:63]
s_waitcnt lgkmcnt(4)
v_cvt_pk_bf16_f32 v81, v210, v211
v_mfma_f32_16x16x32_bf16 a[48:51], v[224:227], v[160:163], a[48:51]
ds_read_b64_tr_b16 v[240:241], v12 offset:4096
ds_read_b64_tr_b16 v[242:243], v12 offset:6144
v_mfma_f32_16x16x32_bf16 a[48:51], v[228:231], v[0:3], a[48:51]
v_accvgpr_read_b32 v216, a12
v_accvgpr_read_b32 v217, a13
v_mfma_f32_16x16x32_bf16 a[52:55], v[224:227], v[164:167], a[52:55]
v_accvgpr_read_b32 v218, a14
v_accvgpr_read_b32 v219, a15
v_mfma_f32_16x16x32_bf16 a[52:55], v[228:231], v[32:35], a[52:55]
v_cvt_pk_bf16_f32 v112, v216, v217
v_cvt_pk_bf16_f32 v113, v218, v219
v_mfma_f32_16x16x32_bf16 a[56:59], v[224:227], v[168:171], a[56:59]
ds_read_b64_tr_b16 v[244:245], v12 offset:20480
ds_read_b64_tr_b16 v[246:247], v12 offset:22528
v_mfma_f32_16x16x32_bf16 a[56:59], v[228:231], v[64:67], a[56:59]
v_accvgpr_read_b32 v196, a16
v_accvgpr_read_b32 v197, a17
v_mfma_f32_16x16x32_bf16 a[60:63], v[224:227], v[172:175], a[60:63]
v_accvgpr_read_b32 v198, a18
v_accvgpr_read_b32 v199, a19
v_mfma_f32_16x16x32_bf16 a[60:63], v[228:231], v[96:99], a[60:63]
s_waitcnt lgkmcnt(4)
v_cvt_pk_bf16_f32 v18, v196, v197
v_mfma_f32_16x16x32_bf16 a[64:67], v[232:235], v[4:7], a[64:67]
ds_read_b64_tr_b16 v[224:225], v12 offset:36864
ds_read_b64_tr_b16 v[226:227], v12 offset:38912
v_mfma_f32_16x16x32_bf16 a[64:67], v[236:239], v[176:179], a[64:67]
v_cvt_pk_bf16_f32 v19, v198, v199
buffer_store_dwordx4 v[16:19], v252, s[20:23], s40 offen offset:0 sc1
v_mfma_f32_16x16x32_bf16 a[68:71], v[232:235], v[36:39], a[68:71]
ds_write_b128 v255, v[16:19] offset:0
v_accvgpr_read_b32 v204, a20
v_mfma_f32_16x16x32_bf16 a[68:71], v[236:239], v[180:183], a[68:71]
v_accvgpr_read_b32 v205, a21
v_accvgpr_read_b32 v206, a22
v_mfma_f32_16x16x32_bf16 a[72:75], v[232:235], v[68:71], a[72:75]
ds_read_b64_tr_b16 v[228:229], v12 offset:53248
ds_read_b64_tr_b16 v[230:231], v12 offset:55296
v_mfma_f32_16x16x32_bf16 a[72:75], v[236:239], v[184:187], a[72:75]
v_accvgpr_read_b32 v207, a23
v_cvt_pk_bf16_f32 v50, v204, v205
v_mfma_f32_16x16x32_bf16 a[76:79], v[232:235], v[100:103], a[76:79]
v_cvt_pk_bf16_f32 v51, v206, v207
buffer_store_dwordx4 v[48:51], v252, s[20:23], s41 offen offset:0 sc1
v_mfma_f32_16x16x32_bf16 a[76:79], v[236:239], v[188:191], a[76:79]
s_waitcnt lgkmcnt(5)
v_accvgpr_read_b32 v212, a24
v_mfma_f32_16x16x32_bf16 a[64:67], v[240:243], v[128:131], a[64:67]
ds_read_b64_tr_b16 v[232:233], v250 offset:36864
ds_read_b64_tr_b16 v[234:235], v250 offset:38912
v_mfma_f32_16x16x32_bf16 a[64:67], v[244:247], v[144:147], a[64:67]
v_accvgpr_read_b32 v213, a25
v_accvgpr_read_b32 v214, a26
v_mfma_f32_16x16x32_bf16 a[68:71], v[240:243], v[132:135], a[68:71]
v_accvgpr_read_b32 v215, a27
v_cvt_pk_bf16_f32 v82, v212, v213
v_mfma_f32_16x16x32_bf16 a[68:71], v[244:247], v[148:151], a[68:71]
v_cvt_pk_bf16_f32 v83, v214, v215
buffer_store_dwordx4 v[80:83], v252, s[20:23], s42 offen offset:0 sc1
v_mfma_f32_16x16x32_bf16 a[72:75], v[240:243], v[136:139], a[72:75]
ds_read_b64_tr_b16 v[236:237], v250 offset:53248
ds_read_b64_tr_b16 v[238:239], v250 offset:55296
v_mfma_f32_16x16x32_bf16 a[72:75], v[244:247], v[152:155], a[72:75]
v_accvgpr_read_b32 v220, a28
v_accvgpr_read_b32 v221, a29
v_mfma_f32_16x16x32_bf16 a[76:79], v[240:243], v[140:143], a[76:79]
v_accvgpr_read_b32 v222, a30
v_accvgpr_read_b32 v223, a31
v_mfma_f32_16x16x32_bf16 a[76:79], v[244:247], v[156:159], a[76:79]
s_waitcnt lgkmcnt(4)
v_cvt_pk_bf16_f32 v114, v220, v221
v_mfma_f32_16x16x32_bf16 a[64:67], v[224:227], v[160:163], a[64:67]
ds_read_b64_tr_b16 v[240:241], v13 offset:4096
ds_read_b64_tr_b16 v[242:243], v13 offset:6144
v_mfma_f32_16x16x32_bf16 a[64:67], v[228:231], v[0:3], a[64:67]
v_cvt_pk_bf16_f32 v115, v222, v223
buffer_store_dwordx4 v[112:115], v252, s[20:23], s43 offen offset:0 sc1
v_mfma_f32_16x16x32_bf16 a[68:71], v[224:227], v[164:167], a[68:71]
v_accvgpr_read_b32 v192, a32
v_accvgpr_read_b32 v193, a33
v_mfma_f32_16x16x32_bf16 a[68:71], v[228:231], v[32:35], a[68:71]
v_accvgpr_read_b32 v194, a34
v_accvgpr_read_b32 v195, a35
v_mfma_f32_16x16x32_bf16 a[72:75], v[224:227], v[168:171], a[72:75]
ds_read_b64_tr_b16 v[244:245], v13 offset:20480
ds_read_b64_tr_b16 v[246:247], v13 offset:22528
v_mfma_f32_16x16x32_bf16 a[72:75], v[228:231], v[64:67], a[72:75]
v_cvt_pk_bf16_f32 v20, v192, v193
v_cvt_pk_bf16_f32 v21, v194, v195
v_mfma_f32_16x16x32_bf16 a[76:79], v[224:227], v[172:175], a[76:79]
v_accvgpr_read_b32 v200, a36
v_accvgpr_read_b32 v201, a37
v_mfma_f32_16x16x32_bf16 a[76:79], v[228:231], v[96:99], a[76:79]
s_waitcnt lgkmcnt(4)
v_accvgpr_read_b32 v202, a38
v_mfma_f32_16x16x32_bf16 a[80:83], v[232:235], v[4:7], a[80:83]
ds_read_b64_tr_b16 v[224:225], v13 offset:36864
ds_read_b64_tr_b16 v[226:227], v13 offset:38912
v_mfma_f32_16x16x32_bf16 a[80:83], v[236:239], v[176:179], a[80:83]
v_accvgpr_read_b32 v203, a39
v_cvt_pk_bf16_f32 v52, v200, v201
v_mfma_f32_16x16x32_bf16 a[84:87], v[232:235], v[36:39], a[84:87]
v_cvt_pk_bf16_f32 v53, v202, v203
v_accvgpr_read_b32 v208, a40
v_mfma_f32_16x16x32_bf16 a[84:87], v[236:239], v[180:183], a[84:87]
v_accvgpr_read_b32 v209, a41
v_accvgpr_read_b32 v210, a42
v_mfma_f32_16x16x32_bf16 a[88:91], v[232:235], v[68:71], a[88:91]
ds_read_b64_tr_b16 v[228:229], v13 offset:53248
ds_read_b64_tr_b16 v[230:231], v13 offset:55296
v_mfma_f32_16x16x32_bf16 a[88:91], v[236:239], v[184:187], a[88:91]
v_accvgpr_read_b32 v211, a43
v_cvt_pk_bf16_f32 v84, v208, v209
v_mfma_f32_16x16x32_bf16 a[92:95], v[232:235], v[100:103], a[92:95]
v_cvt_pk_bf16_f32 v85, v210, v211
v_accvgpr_read_b32 v216, a44
v_mfma_f32_16x16x32_bf16 a[92:95], v[236:239], v[188:191], a[92:95]
s_waitcnt lgkmcnt(4)
v_accvgpr_read_b32 v217, a45
v_mfma_f32_16x16x32_bf16 a[80:83], v[240:243], v[128:131], a[80:83]
ds_read_b64_tr_b16 v[232:233], v249 offset:37376
ds_read_b64_tr_b16 v[234:235], v249 offset:39424
v_mfma_f32_16x16x32_bf16 a[80:83], v[244:247], v[144:147], a[80:83]
v_accvgpr_read_b32 v218, a46
v_accvgpr_read_b32 v219, a47
v_mfma_f32_16x16x32_bf16 a[84:87], v[240:243], v[132:135], a[84:87]
v_cvt_pk_bf16_f32 v116, v216, v217
v_cvt_pk_bf16_f32 v117, v218, v219
v_mfma_f32_16x16x32_bf16 a[84:87], v[244:247], v[148:151], a[84:87]
v_accvgpr_read_b32 v196, a48
v_accvgpr_read_b32 v197, a49
v_mfma_f32_16x16x32_bf16 a[88:91], v[240:243], v[136:139], a[88:91]
ds_read_b64_tr_b16 v[236:237], v249 offset:53760
ds_read_b64_tr_b16 v[238:239], v249 offset:55808
v_mfma_f32_16x16x32_bf16 a[88:91], v[244:247], v[152:155], a[88:91]
v_accvgpr_read_b32 v198, a50
v_accvgpr_read_b32 v199, a51
v_mfma_f32_16x16x32_bf16 a[92:95], v[240:243], v[140:143], a[92:95]
v_cvt_pk_bf16_f32 v22, v196, v197
v_cvt_pk_bf16_f32 v23, v198, v199
v_mfma_f32_16x16x32_bf16 a[92:95], v[244:247], v[156:159], a[92:95]
s_waitcnt lgkmcnt(4)
buffer_store_dwordx4 v[20:23], v252, s[20:23], s40 offen offset:1024 sc1
v_mfma_f32_16x16x32_bf16 a[80:83], v[224:227], v[160:163], a[80:83]
ds_read_b64_tr_b16 v[240:241], v12 offset:4608
ds_read_b64_tr_b16 v[242:243], v12 offset:6656
v_mfma_f32_16x16x32_bf16 a[80:83], v[228:231], v[0:3], a[80:83]
ds_write_b128 v255, v[20:23] offset:1024
v_accvgpr_read_b32 v204, a52
v_mfma_f32_16x16x32_bf16 a[84:87], v[224:227], v[164:167], a[84:87]
v_accvgpr_read_b32 v205, a53
v_accvgpr_read_b32 v206, a54
v_mfma_f32_16x16x32_bf16 a[84:87], v[228:231], v[32:35], a[84:87]
v_accvgpr_read_b32 v207, a55
v_cvt_pk_bf16_f32 v54, v204, v205
v_mfma_f32_16x16x32_bf16 a[88:91], v[224:227], v[168:171], a[88:91]
ds_read_b64_tr_b16 v[244:245], v12 offset:20992
ds_read_b64_tr_b16 v[246:247], v12 offset:23040
v_mfma_f32_16x16x32_bf16 a[88:91], v[228:231], v[64:67], a[88:91]
v_cvt_pk_bf16_f32 v55, v206, v207
buffer_store_dwordx4 v[52:55], v252, s[20:23], s41 offen offset:1024 sc1
v_mfma_f32_16x16x32_bf16 a[92:95], v[224:227], v[172:175], a[92:95]
v_accvgpr_read_b32 v212, a56
v_accvgpr_read_b32 v213, a57
v_mfma_f32_16x16x32_bf16 a[92:95], v[228:231], v[96:99], a[92:95]
s_waitcnt lgkmcnt(5)
v_accvgpr_read_b32 v214, a58
v_mfma_f32_16x16x32_bf16 a[96:99], v[232:235], v[4:7], a[96:99]
ds_read_b64_tr_b16 v[224:225], v12 offset:37376
ds_read_b64_tr_b16 v[226:227], v12 offset:39424
v_mfma_f32_16x16x32_bf16 a[96:99], v[236:239], v[176:179], a[96:99]
v_accvgpr_read_b32 v215, a59
v_cvt_pk_bf16_f32 v86, v212, v213
v_mfma_f32_16x16x32_bf16 a[100:103], v[232:235], v[36:39], a[100:103]
v_cvt_pk_bf16_f32 v87, v214, v215
buffer_store_dwordx4 v[84:87], v252, s[20:23], s42 offen offset:1024 sc1
v_mfma_f32_16x16x32_bf16 a[100:103], v[236:239], v[180:183], a[100:103]
v_accvgpr_read_b32 v220, a60
v_accvgpr_read_b32 v221, a61
v_mfma_f32_16x16x32_bf16 a[104:107], v[232:235], v[68:71], a[104:107]
ds_read_b64_tr_b16 v[228:229], v12 offset:53760
ds_read_b64_tr_b16 v[230:231], v12 offset:55808
v_mfma_f32_16x16x32_bf16 a[104:107], v[236:239], v[184:187], a[104:107]
v_accvgpr_read_b32 v222, a62
v_accvgpr_read_b32 v223, a63
v_mfma_f32_16x16x32_bf16 a[108:111], v[232:235], v[100:103], a[108:111]
v_cvt_pk_bf16_f32 v118, v220, v221
v_cvt_pk_bf16_f32 v119, v222, v223
v_mfma_f32_16x16x32_bf16 a[108:111], v[236:239], v[188:191], a[108:111]
s_waitcnt lgkmcnt(4)
buffer_store_dwordx4 v[116:119], v252, s[20:23], s43 offen offset:1024 sc1
v_mfma_f32_16x16x32_bf16 a[96:99], v[240:243], v[128:131], a[96:99]
ds_read_b64_tr_b16 v[232:233], v250 offset:37376
ds_read_b64_tr_b16 v[234:235], v250 offset:39424
v_mfma_f32_16x16x32_bf16 a[96:99], v[244:247], v[144:147], a[96:99]
v_accvgpr_read_b32 v192, a64
v_accvgpr_read_b32 v193, a65
v_mfma_f32_16x16x32_bf16 a[100:103], v[240:243], v[132:135], a[100:103]
v_accvgpr_read_b32 v194, a66
v_accvgpr_read_b32 v195, a67
v_mfma_f32_16x16x32_bf16 a[100:103], v[244:247], v[148:151], a[100:103]
v_cvt_pk_bf16_f32 v24, v192, v193
v_cvt_pk_bf16_f32 v25, v194, v195
v_mfma_f32_16x16x32_bf16 a[104:107], v[240:243], v[136:139], a[104:107]
ds_read_b64_tr_b16 v[236:237], v250 offset:53760
ds_read_b64_tr_b16 v[238:239], v250 offset:55808
v_mfma_f32_16x16x32_bf16 a[104:107], v[244:247], v[152:155], a[104:107]
v_accvgpr_read_b32 v200, a68
v_accvgpr_read_b32 v201, a69
v_mfma_f32_16x16x32_bf16 a[108:111], v[240:243], v[140:143], a[108:111]
v_accvgpr_read_b32 v202, a70
v_accvgpr_read_b32 v203, a71
v_mfma_f32_16x16x32_bf16 a[108:111], v[244:247], v[156:159], a[108:111]
s_waitcnt lgkmcnt(4)
v_cvt_pk_bf16_f32 v56, v200, v201
v_mfma_f32_16x16x32_bf16 a[96:99], v[224:227], v[160:163], a[96:99]
ds_read_b64_tr_b16 v[240:241], v13 offset:4608
ds_read_b64_tr_b16 v[242:243], v13 offset:6656
v_mfma_f32_16x16x32_bf16 a[96:99], v[228:231], v[0:3], a[96:99]
v_cvt_pk_bf16_f32 v57, v202, v203
v_accvgpr_read_b32 v208, a72
v_mfma_f32_16x16x32_bf16 a[100:103], v[224:227], v[164:167], a[100:103]
v_accvgpr_read_b32 v209, a73
v_accvgpr_read_b32 v210, a74
v_mfma_f32_16x16x32_bf16 a[100:103], v[228:231], v[32:35], a[100:103]
v_accvgpr_read_b32 v211, a75
v_cvt_pk_bf16_f32 v88, v208, v209
v_mfma_f32_16x16x32_bf16 a[104:107], v[224:227], v[168:171], a[104:107]
ds_read_b64_tr_b16 v[244:245], v13 offset:20992
ds_read_b64_tr_b16 v[246:247], v13 offset:23040
v_mfma_f32_16x16x32_bf16 a[104:107], v[228:231], v[64:67], a[104:107]
v_cvt_pk_bf16_f32 v89, v210, v211
v_accvgpr_read_b32 v216, a76
v_mfma_f32_16x16x32_bf16 a[108:111], v[224:227], v[172:175], a[108:111]
v_accvgpr_read_b32 v217, a77
v_accvgpr_read_b32 v218, a78
v_mfma_f32_16x16x32_bf16 a[108:111], v[228:231], v[96:99], a[108:111]
s_waitcnt lgkmcnt(4)
v_accvgpr_read_b32 v219, a79
v_mfma_f32_16x16x32_bf16 a[112:115], v[232:235], v[4:7], a[112:115]
ds_read_b64_tr_b16 v[224:225], v13 offset:37376
ds_read_b64_tr_b16 v[226:227], v13 offset:39424
v_mfma_f32_16x16x32_bf16 a[112:115], v[236:239], v[176:179], a[112:115]
v_cvt_pk_bf16_f32 v120, v216, v217
v_cvt_pk_bf16_f32 v121, v218, v219
v_mfma_f32_16x16x32_bf16 a[116:119], v[232:235], v[36:39], a[116:119]
v_accvgpr_read_b32 v196, a80
v_accvgpr_read_b32 v197, a81
v_mfma_f32_16x16x32_bf16 a[116:119], v[236:239], v[180:183], a[116:119]
v_accvgpr_read_b32 v198, a82
v_accvgpr_read_b32 v199, a83
v_mfma_f32_16x16x32_bf16 a[120:123], v[232:235], v[68:71], a[120:123]
ds_read_b64_tr_b16 v[228:229], v13 offset:53760
ds_read_b64_tr_b16 v[230:231], v13 offset:55808
v_mfma_f32_16x16x32_bf16 a[120:123], v[236:239], v[184:187], a[120:123]
v_cvt_pk_bf16_f32 v26, v196, v197
v_cvt_pk_bf16_f32 v27, v198, v199
v_mfma_f32_16x16x32_bf16 a[124:127], v[232:235], v[100:103], a[124:127]
buffer_store_dwordx4 v[24:27], v252, s[20:23], s40 offen offset:2048 sc1
ds_write_b128 v255, v[24:27] offset:2048
v_mfma_f32_16x16x32_bf16 a[124:127], v[236:239], v[188:191], a[124:127]
s_waitcnt lgkmcnt(5)
v_accvgpr_read_b32 v204, a84
v_mfma_f32_16x16x32_bf16 a[112:115], v[240:243], v[128:131], a[112:115]
ds_read_b64_tr_b16 v[232:233], v249 offset:40960
ds_read_b64_tr_b16 v[234:235], v249 offset:43008
v_mfma_f32_16x16x32_bf16 a[112:115], v[244:247], v[144:147], a[112:115]
v_accvgpr_read_b32 v205, a85
v_accvgpr_read_b32 v206, a86
v_mfma_f32_16x16x32_bf16 a[116:119], v[240:243], v[132:135], a[116:119]
v_accvgpr_read_b32 v207, a87
v_cvt_pk_bf16_f32 v58, v204, v205
v_mfma_f32_16x16x32_bf16 a[116:119], v[244:247], v[148:151], a[116:119]
v_cvt_pk_bf16_f32 v59, v206, v207
buffer_store_dwordx4 v[56:59], v252, s[20:23], s41 offen offset:2048 sc1
v_mfma_f32_16x16x32_bf16 a[120:123], v[240:243], v[136:139], a[120:123]
ds_read_b64_tr_b16 v[236:237], v249 offset:57344
ds_read_b64_tr_b16 v[238:239], v249 offset:59392
v_mfma_f32_16x16x32_bf16 a[120:123], v[244:247], v[152:155], a[120:123]
v_accvgpr_read_b32 v212, a88
v_accvgpr_read_b32 v213, a89
v_mfma_f32_16x16x32_bf16 a[124:127], v[240:243], v[140:143], a[124:127]
v_accvgpr_read_b32 v214, a90
v_accvgpr_read_b32 v215, a91
v_mfma_f32_16x16x32_bf16 a[124:127], v[244:247], v[156:159], a[124:127]
s_waitcnt lgkmcnt(5)
v_cvt_pk_bf16_f32 v90, v212, v213
v_mfma_f32_16x16x32_bf16 a[112:115], v[224:227], v[160:163], a[112:115]
ds_read_b64_tr_b16 v[240:241], v12 offset:8192
ds_read_b64_tr_b16 v[242:243], v12 offset:10240
v_mfma_f32_16x16x32_bf16 a[112:115], v[228:231], v[0:3], a[112:115]
v_cvt_pk_bf16_f32 v91, v214, v215
buffer_store_dwordx4 v[88:91], v252, s[20:23], s42 offen offset:2048 sc1
v_mfma_f32_16x16x32_bf16 a[116:119], v[224:227], v[164:167], a[116:119]
v_accvgpr_read_b32 v220, a92
v_accvgpr_read_b32 v221, a93
v_mfma_f32_16x16x32_bf16 a[116:119], v[228:231], v[32:35], a[116:119]
v_accvgpr_read_b32 v222, a94
v_accvgpr_read_b32 v223, a95
v_mfma_f32_16x16x32_bf16 a[120:123], v[224:227], v[168:171], a[120:123]
ds_read_b64_tr_b16 v[244:245], v12 offset:24576
ds_read_b64_tr_b16 v[246:247], v12 offset:26624
v_mfma_f32_16x16x32_bf16 a[120:123], v[228:231], v[64:67], a[120:123]
v_cvt_pk_bf16_f32 v122, v220, v221
v_cvt_pk_bf16_f32 v123, v222, v223
v_mfma_f32_16x16x32_bf16 a[124:127], v[224:227], v[172:175], a[124:127]
buffer_store_dwordx4 v[120:123], v252, s[20:23], s43 offen offset:2048 sc1
v_accvgpr_read_b32 v192, a96
v_mfma_f32_16x16x32_bf16 a[124:127], v[228:231], v[96:99], a[124:127]
s_waitcnt lgkmcnt(4)
v_accvgpr_read_b32 v193, a97
v_mfma_f32_16x16x32_bf16 a[128:131], v[232:235], v[4:7], a[128:131]
ds_read_b64_tr_b16 v[224:225], v12 offset:40960
ds_read_b64_tr_b16 v[226:227], v12 offset:43008
v_mfma_f32_16x16x32_bf16 a[128:131], v[236:239], v[176:179], a[128:131]
v_accvgpr_read_b32 v194, a98
v_accvgpr_read_b32 v195, a99
v_mfma_f32_16x16x32_bf16 a[132:135], v[232:235], v[36:39], a[132:135]
v_cvt_pk_bf16_f32 v28, v192, v193
v_cvt_pk_bf16_f32 v29, v194, v195
v_mfma_f32_16x16x32_bf16 a[132:135], v[236:239], v[180:183], a[132:135]
v_accvgpr_read_b32 v200, a100
v_accvgpr_read_b32 v201, a101
v_mfma_f32_16x16x32_bf16 a[136:139], v[232:235], v[68:71], a[136:139]
ds_read_b64_tr_b16 v[228:229], v12 offset:57344
ds_read_b64_tr_b16 v[230:231], v12 offset:59392
v_mfma_f32_16x16x32_bf16 a[136:139], v[236:239], v[184:187], a[136:139]
v_accvgpr_read_b32 v202, a102
v_accvgpr_read_b32 v203, a103
v_mfma_f32_16x16x32_bf16 a[140:143], v[232:235], v[100:103], a[140:143]
v_cvt_pk_bf16_f32 v60, v200, v201
v_cvt_pk_bf16_f32 v61, v202, v203
v_mfma_f32_16x16x32_bf16 a[140:143], v[236:239], v[188:191], a[140:143]
s_waitcnt lgkmcnt(4)
v_accvgpr_read_b32 v208, a104
v_mfma_f32_16x16x32_bf16 a[128:131], v[240:243], v[128:131], a[128:131]
ds_read_b64_tr_b16 v[232:233], v250 offset:40960
ds_read_b64_tr_b16 v[234:235], v250 offset:43008
v_mfma_f32_16x16x32_bf16 a[128:131], v[244:247], v[144:147], a[128:131]
v_accvgpr_read_b32 v209, a105
v_accvgpr_read_b32 v210, a106
v_mfma_f32_16x16x32_bf16 a[132:135], v[240:243], v[132:135], a[132:135]
v_accvgpr_read_b32 v211, a107
v_cvt_pk_bf16_f32 v92, v208, v209
v_mfma_f32_16x16x32_bf16 a[132:135], v[244:247], v[148:151], a[132:135]
v_cvt_pk_bf16_f32 v93, v210, v211
v_accvgpr_read_b32 v216, a108
v_mfma_f32_16x16x32_bf16 a[136:139], v[240:243], v[136:139], a[136:139]
ds_read_b64_tr_b16 v[236:237], v250 offset:57344
ds_read_b64_tr_b16 v[238:239], v250 offset:59392
v_mfma_f32_16x16x32_bf16 a[136:139], v[244:247], v[152:155], a[136:139]
v_accvgpr_read_b32 v217, a109
v_accvgpr_read_b32 v218, a110
v_mfma_f32_16x16x32_bf16 a[140:143], v[240:243], v[140:143], a[140:143]
v_accvgpr_read_b32 v219, a111
v_cvt_pk_bf16_f32 v124, v216, v217
v_mfma_f32_16x16x32_bf16 a[140:143], v[244:247], v[156:159], a[140:143]
s_waitcnt lgkmcnt(4)
v_cvt_pk_bf16_f32 v125, v218, v219
v_mfma_f32_16x16x32_bf16 a[128:131], v[224:227], v[160:163], a[128:131]
ds_read_b64_tr_b16 v[240:241], v13 offset:8192
ds_read_b64_tr_b16 v[242:243], v13 offset:10240
v_mfma_f32_16x16x32_bf16 a[128:131], v[228:231], v[0:3], a[128:131]
v_accvgpr_read_b32 v196, a112
v_accvgpr_read_b32 v197, a113
v_mfma_f32_16x16x32_bf16 a[132:135], v[224:227], v[164:167], a[132:135]
v_accvgpr_read_b32 v198, a114
v_accvgpr_read_b32 v199, a115
v_mfma_f32_16x16x32_bf16 a[132:135], v[228:231], v[32:35], a[132:135]
v_cvt_pk_bf16_f32 v30, v196, v197
v_cvt_pk_bf16_f32 v31, v198, v199
v_mfma_f32_16x16x32_bf16 a[136:139], v[224:227], v[168:171], a[136:139]
ds_read_b64_tr_b16 v[244:245], v13 offset:24576
ds_read_b64_tr_b16 v[246:247], v13 offset:26624
v_mfma_f32_16x16x32_bf16 a[136:139], v[228:231], v[64:67], a[136:139]
buffer_store_dwordx4 v[28:31], v252, s[20:23], s40 offen offset:3072 sc1
ds_write_b128 v255, v[28:31] offset:3072
v_mfma_f32_16x16x32_bf16 a[140:143], v[224:227], v[172:175], a[140:143]
v_accvgpr_read_b32 v204, a116
v_accvgpr_read_b32 v205, a117
v_mfma_f32_16x16x32_bf16 a[140:143], v[228:231], v[96:99], a[140:143]
s_waitcnt lgkmcnt(5)
v_accvgpr_read_b32 v206, a118
v_mfma_f32_16x16x32_bf16 a[144:147], v[232:235], v[4:7], a[144:147]
ds_read_b64_tr_b16 v[224:225], v13 offset:40960
ds_read_b64_tr_b16 v[226:227], v13 offset:43008
v_mfma_f32_16x16x32_bf16 a[144:147], v[236:239], v[176:179], a[144:147]
v_accvgpr_read_b32 v207, a119
v_cvt_pk_bf16_f32 v62, v204, v205
v_mfma_f32_16x16x32_bf16 a[148:151], v[232:235], v[36:39], a[148:151]
v_cvt_pk_bf16_f32 v63, v206, v207
buffer_store_dwordx4 v[60:63], v252, s[20:23], s41 offen offset:3072 sc1
v_mfma_f32_16x16x32_bf16 a[148:151], v[236:239], v[180:183], a[148:151]
v_accvgpr_read_b32 v212, a120
v_accvgpr_read_b32 v213, a121
v_mfma_f32_16x16x32_bf16 a[152:155], v[232:235], v[68:71], a[152:155]
ds_read_b64_tr_b16 v[228:229], v13 offset:57344
ds_read_b64_tr_b16 v[230:231], v13 offset:59392
v_mfma_f32_16x16x32_bf16 a[152:155], v[236:239], v[184:187], a[152:155]
v_accvgpr_read_b32 v214, a122
v_accvgpr_read_b32 v215, a123
v_mfma_f32_16x16x32_bf16 a[156:159], v[232:235], v[100:103], a[156:159]
v_cvt_pk_bf16_f32 v94, v212, v213
v_cvt_pk_bf16_f32 v95, v214, v215
v_mfma_f32_16x16x32_bf16 a[156:159], v[236:239], v[188:191], a[156:159]
s_waitcnt lgkmcnt(5)
buffer_store_dwordx4 v[92:95], v252, s[20:23], s42 offen offset:3072 sc1
v_mfma_f32_16x16x32_bf16 a[144:147], v[240:243], v[128:131], a[144:147]
ds_read_b64_tr_b16 v[232:233], v249 offset:41472
ds_read_b64_tr_b16 v[234:235], v249 offset:43520
v_mfma_f32_16x16x32_bf16 a[144:147], v[244:247], v[144:147], a[144:147]
v_accvgpr_read_b32 v220, a124
v_accvgpr_read_b32 v221, a125
v_mfma_f32_16x16x32_bf16 a[148:151], v[240:243], v[132:135], a[148:151]
v_accvgpr_read_b32 v222, a126
v_accvgpr_read_b32 v223, a127
v_mfma_f32_16x16x32_bf16 a[148:151], v[244:247], v[148:151], a[148:151]
v_cvt_pk_bf16_f32 v126, v220, v221
v_cvt_pk_bf16_f32 v127, v222, v223
v_mfma_f32_16x16x32_bf16 a[152:155], v[240:243], v[136:139], a[152:155]
ds_read_b64_tr_b16 v[236:237], v249 offset:57856
ds_read_b64_tr_b16 v[238:239], v249 offset:59904
v_mfma_f32_16x16x32_bf16 a[152:155], v[244:247], v[152:155], a[152:155]
buffer_store_dwordx4 v[124:127], v252, s[20:23], s43 offen offset:3072 sc1
v_accvgpr_read_b32 v192, a128
v_mfma_f32_16x16x32_bf16 a[156:159], v[240:243], v[140:143], a[156:159]
v_accvgpr_read_b32 v193, a129
v_accvgpr_read_b32 v194, a130
v_mfma_f32_16x16x32_bf16 a[156:159], v[244:247], v[156:159], a[156:159]
s_waitcnt lgkmcnt(4)
v_accvgpr_read_b32 v195, a131
v_mfma_f32_16x16x32_bf16 a[144:147], v[224:227], v[160:163], a[144:147]
ds_read_b64_tr_b16 v[240:241], v12 offset:8704
ds_read_b64_tr_b16 v[242:243], v12 offset:10752
v_mfma_f32_16x16x32_bf16 a[144:147], v[228:231], v[0:3], a[144:147]
v_cvt_pk_bf16_f32 v16, v192, v193
v_cvt_pk_bf16_f32 v17, v194, v195
v_mfma_f32_16x16x32_bf16 a[148:151], v[224:227], v[164:167], a[148:151]
v_accvgpr_read_b32 v200, a132
v_accvgpr_read_b32 v201, a133
v_mfma_f32_16x16x32_bf16 a[148:151], v[228:231], v[32:35], a[148:151]
v_accvgpr_read_b32 v202, a134
v_accvgpr_read_b32 v203, a135
v_mfma_f32_16x16x32_bf16 a[152:155], v[224:227], v[168:171], a[152:155]
ds_read_b64_tr_b16 v[244:245], v12 offset:25088
ds_read_b64_tr_b16 v[246:247], v12 offset:27136
v_mfma_f32_16x16x32_bf16 a[152:155], v[228:231], v[64:67], a[152:155]
v_cvt_pk_bf16_f32 v48, v200, v201
v_cvt_pk_bf16_f32 v49, v202, v203
v_mfma_f32_16x16x32_bf16 a[156:159], v[224:227], v[172:175], a[156:159]
v_accvgpr_read_b32 v208, a136
v_accvgpr_read_b32 v209, a137
v_mfma_f32_16x16x32_bf16 a[156:159], v[228:231], v[96:99], a[156:159]
s_waitcnt lgkmcnt(4)
v_accvgpr_read_b32 v210, a138
v_mfma_f32_16x16x32_bf16 a[160:163], v[232:235], v[4:7], a[160:163]
ds_read_b64_tr_b16 v[224:225], v12 offset:41472
ds_read_b64_tr_b16 v[226:227], v12 offset:43520
v_mfma_f32_16x16x32_bf16 a[160:163], v[236:239], v[176:179], a[160:163]
v_accvgpr_read_b32 v211, a139
v_cvt_pk_bf16_f32 v80, v208, v209
v_mfma_f32_16x16x32_bf16 a[164:167], v[232:235], v[36:39], a[164:167]
v_cvt_pk_bf16_f32 v81, v210, v211
v_accvgpr_read_b32 v216, a140
v_mfma_f32_16x16x32_bf16 a[164:167], v[236:239], v[180:183], a[164:167]
v_accvgpr_read_b32 v217, a141
v_accvgpr_read_b32 v218, a142
v_mfma_f32_16x16x32_bf16 a[168:171], v[232:235], v[68:71], a[168:171]
ds_read_b64_tr_b16 v[228:229], v12 offset:57856
ds_read_b64_tr_b16 v[230:231], v12 offset:59904
v_mfma_f32_16x16x32_bf16 a[168:171], v[236:239], v[184:187], a[168:171]
v_accvgpr_read_b32 v219, a143
v_cvt_pk_bf16_f32 v112, v216, v217
v_mfma_f32_16x16x32_bf16 a[172:175], v[232:235], v[100:103], a[172:175]
v_cvt_pk_bf16_f32 v113, v218, v219
v_accvgpr_read_b32 v196, a144
v_mfma_f32_16x16x32_bf16 a[172:175], v[236:239], v[188:191], a[172:175]
s_waitcnt lgkmcnt(4)
v_accvgpr_read_b32 v197, a145
v_mfma_f32_16x16x32_bf16 a[160:163], v[240:243], v[128:131], a[160:163]
ds_read_b64_tr_b16 v[232:233], v250 offset:41472
ds_read_b64_tr_b16 v[234:235], v250 offset:43520
v_mfma_f32_16x16x32_bf16 a[160:163], v[244:247], v[144:147], a[160:163]
v_accvgpr_read_b32 v198, a146
v_accvgpr_read_b32 v199, a147
v_mfma_f32_16x16x32_bf16 a[164:167], v[240:243], v[132:135], a[164:167]
v_cvt_pk_bf16_f32 v18, v196, v197
v_cvt_pk_bf16_f32 v19, v198, v199
v_mfma_f32_16x16x32_bf16 a[164:167], v[244:247], v[148:151], a[164:167]
buffer_store_dwordx4 v[16:19], v252, s[20:23], s44 offen offset:0 sc1
v_accvgpr_read_b32 v204, a148
v_mfma_f32_16x16x32_bf16 a[168:171], v[240:243], v[136:139], a[168:171]
ds_read_b64_tr_b16 v[236:237], v250 offset:57856
ds_read_b64_tr_b16 v[238:239], v250 offset:59904
v_mfma_f32_16x16x32_bf16 a[168:171], v[244:247], v[152:155], a[168:171]
v_accvgpr_read_b32 v205, a149
v_accvgpr_read_b32 v206, a150
v_mfma_f32_16x16x32_bf16 a[172:175], v[240:243], v[140:143], a[172:175]
v_accvgpr_read_b32 v207, a151
v_cvt_pk_bf16_f32 v50, v204, v205
s_mov_b32 s33, 0x6c01400
v_mfma_f32_16x16x32_bf16 a[172:175], v[244:247], v[156:159], a[172:175]
s_waitcnt lgkmcnt(4)
v_cvt_pk_bf16_f32 v51, v206, v207
buffer_load_dword v254, off, s[56:59], s33 sc1
v_mfma_f32_16x16x32_bf16 a[160:163], v[224:227], v[160:163], a[160:163]
ds_read_b64_tr_b16 v[240:241], v13 offset:8704
ds_read_b64_tr_b16 v[242:243], v13 offset:10752
v_mfma_f32_16x16x32_bf16 a[160:163], v[228:231], v[0:3], a[160:163]
buffer_store_dwordx4 v[48:51], v252, s[20:23], s45 offen offset:0 sc1
v_accvgpr_read_b32 v212, a152
v_mfma_f32_16x16x32_bf16 a[164:167], v[224:227], v[164:167], a[164:167]
v_accvgpr_read_b32 v213, a153
v_accvgpr_read_b32 v214, a154
v_mfma_f32_16x16x32_bf16 a[164:167], v[228:231], v[32:35], a[164:167]
v_accvgpr_read_b32 v215, a155
v_cvt_pk_bf16_f32 v82, v212, v213
v_mfma_f32_16x16x32_bf16 a[168:171], v[224:227], v[168:171], a[168:171]
ds_read_b64_tr_b16 v[244:245], v13 offset:25088
ds_read_b64_tr_b16 v[246:247], v13 offset:27136
v_mfma_f32_16x16x32_bf16 a[168:171], v[228:231], v[64:67], a[168:171]
v_cvt_pk_bf16_f32 v83, v214, v215
buffer_store_dwordx4 v[80:83], v252, s[20:23], s46 offen offset:0 sc1
v_mfma_f32_16x16x32_bf16 a[172:175], v[224:227], v[172:175], a[172:175]
v_accvgpr_read_b32 v220, a156
v_accvgpr_read_b32 v221, a157
v_mfma_f32_16x16x32_bf16 a[172:175], v[228:231], v[96:99], a[172:175]
s_waitcnt lgkmcnt(4)
v_accvgpr_read_b32 v222, a158
v_mfma_f32_16x16x32_bf16 a[176:179], v[232:235], v[4:7], a[176:179]
ds_read_b64_tr_b16 v[224:225], v13 offset:41472
ds_read_b64_tr_b16 v[226:227], v13 offset:43520
v_mfma_f32_16x16x32_bf16 a[176:179], v[236:239], v[176:179], a[176:179]
v_accvgpr_read_b32 v223, a159
v_cvt_pk_bf16_f32 v114, v220, v221
v_mfma_f32_16x16x32_bf16 a[180:183], v[232:235], v[36:39], a[180:183]
v_cvt_pk_bf16_f32 v115, v222, v223
buffer_store_dwordx4 v[112:115], v252, s[20:23], s47 offen offset:0 sc1
v_mfma_f32_16x16x32_bf16 a[180:183], v[236:239], v[180:183], a[180:183]
v_accvgpr_read_b32 v192, a160
v_accvgpr_read_b32 v193, a161
v_mfma_f32_16x16x32_bf16 a[184:187], v[232:235], v[68:71], a[184:187]
ds_read_b64_tr_b16 v[228:229], v13 offset:57856
ds_read_b64_tr_b16 v[230:231], v13 offset:59904
v_mfma_f32_16x16x32_bf16 a[184:187], v[236:239], v[184:187], a[184:187]
v_accvgpr_read_b32 v194, a162
v_accvgpr_read_b32 v195, a163
v_mfma_f32_16x16x32_bf16 a[188:191], v[232:235], v[100:103], a[188:191]
v_cvt_pk_bf16_f32 v20, v192, v193
v_cvt_pk_bf16_f32 v21, v194, v195
v_mfma_f32_16x16x32_bf16 a[188:191], v[236:239], v[188:191], a[188:191]
s_waitcnt lgkmcnt(4)
v_accvgpr_read_b32 v200, a164
v_mfma_f32_16x16x32_bf16 a[176:179], v[240:243], v[128:131], a[176:179]
ds_read_b64_tr_b16 v[232:233], v249 offset:45056
ds_read_b64_tr_b16 v[234:235], v249 offset:47104
v_mfma_f32_16x16x32_bf16 a[176:179], v[244:247], v[144:147], a[176:179]
v_accvgpr_read_b32 v201, a165
v_accvgpr_read_b32 v202, a166
v_mfma_f32_16x16x32_bf16 a[180:183], v[240:243], v[132:135], a[180:183]
v_accvgpr_read_b32 v203, a167
v_cvt_pk_bf16_f32 v52, v200, v201
v_mfma_f32_16x16x32_bf16 a[180:183], v[244:247], v[148:151], a[180:183]
v_cvt_pk_bf16_f32 v53, v202, v203
v_accvgpr_read_b32 v208, a168
v_mfma_f32_16x16x32_bf16 a[184:187], v[240:243], v[136:139], a[184:187]
ds_read_b64_tr_b16 v[236:237], v249 offset:61440
ds_read_b64_tr_b16 v[238:239], v249 offset:63488
v_mfma_f32_16x16x32_bf16 a[184:187], v[244:247], v[152:155], a[184:187]
v_accvgpr_read_b32 v209, a169
v_accvgpr_read_b32 v210, a170
v_mfma_f32_16x16x32_bf16 a[188:191], v[240:243], v[140:143], a[188:191]
v_accvgpr_read_b32 v211, a171
v_cvt_pk_bf16_f32 v84, v208, v209
v_mfma_f32_16x16x32_bf16 a[188:191], v[244:247], v[156:159], a[188:191]
s_waitcnt lgkmcnt(4)
v_cvt_pk_bf16_f32 v85, v210, v211
v_mfma_f32_16x16x32_bf16 a[176:179], v[224:227], v[160:163], a[176:179]
ds_read_b64_tr_b16 v[240:241], v12 offset:12288
ds_read_b64_tr_b16 v[242:243], v12 offset:14336
v_mfma_f32_16x16x32_bf16 a[176:179], v[228:231], v[0:3], a[176:179]
v_accvgpr_read_b32 v216, a172
v_accvgpr_read_b32 v217, a173
v_mfma_f32_16x16x32_bf16 a[180:183], v[224:227], v[164:167], a[180:183]
v_accvgpr_read_b32 v218, a174
v_accvgpr_read_b32 v219, a175
v_mfma_f32_16x16x32_bf16 a[180:183], v[228:231], v[32:35], a[180:183]
v_cvt_pk_bf16_f32 v116, v216, v217
v_cvt_pk_bf16_f32 v117, v218, v219
v_mfma_f32_16x16x32_bf16 a[184:187], v[224:227], v[168:171], a[184:187]
ds_read_b64_tr_b16 v[244:245], v12 offset:28672
ds_read_b64_tr_b16 v[246:247], v12 offset:30720
v_mfma_f32_16x16x32_bf16 a[184:187], v[228:231], v[64:67], a[184:187]
v_mfma_f32_16x16x32_bf16 a[188:191], v[224:227], v[172:175], a[188:191]
v_accvgpr_read_b32 v196, a176
v_accvgpr_read_b32 v197, a177
v_mfma_f32_16x16x32_bf16 a[188:191], v[228:231], v[96:99], a[188:191]
s_waitcnt lgkmcnt(4)
v_accvgpr_read_b32 v198, a178
v_mfma_f32_16x16x32_bf16 a[192:195], v[232:235], v[4:7], a[192:195]
ds_read_b64_tr_b16 v[224:225], v12 offset:45056
ds_read_b64_tr_b16 v[226:227], v12 offset:47104
v_mfma_f32_16x16x32_bf16 a[192:195], v[236:239], v[176:179], a[192:195]
v_accvgpr_read_b32 v199, a179
v_cvt_pk_bf16_f32 v22, v196, v197
v_mfma_f32_16x16x32_bf16 a[196:199], v[232:235], v[36:39], a[196:199]
v_cvt_pk_bf16_f32 v23, v198, v199
buffer_store_dwordx4 v[20:23], v252, s[20:23], s44 offen offset:1024 sc1
v_mfma_f32_16x16x32_bf16 a[196:199], v[236:239], v[180:183], a[196:199]
v_accvgpr_read_b32 v204, a180
v_accvgpr_read_b32 v205, a181
v_mfma_f32_16x16x32_bf16 a[200:203], v[232:235], v[68:71], a[200:203]
ds_read_b64_tr_b16 v[228:229], v12 offset:61440
ds_read_b64_tr_b16 v[230:231], v12 offset:63488
v_mfma_f32_16x16x32_bf16 a[200:203], v[236:239], v[184:187], a[200:203]
v_accvgpr_read_b32 v206, a182
v_accvgpr_read_b32 v207, a183
v_mfma_f32_16x16x32_bf16 a[204:207], v[232:235], v[100:103], a[204:207]
v_cvt_pk_bf16_f32 v54, v204, v205
v_cvt_pk_bf16_f32 v55, v206, v207
v_mfma_f32_16x16x32_bf16 a[204:207], v[236:239], v[188:191], a[204:207]
s_waitcnt lgkmcnt(4)
buffer_store_dwordx4 v[52:55], v252, s[20:23], s45 offen offset:1024 sc1
v_mfma_f32_16x16x32_bf16 a[192:195], v[240:243], v[128:131], a[192:195]
ds_read_b64_tr_b16 v[232:233], v250 offset:45056
ds_read_b64_tr_b16 v[234:235], v250 offset:47104
v_mfma_f32_16x16x32_bf16 a[192:195], v[244:247], v[144:147], a[192:195]
v_accvgpr_read_b32 v212, a184
v_accvgpr_read_b32 v213, a185
v_mfma_f32_16x16x32_bf16 a[196:199], v[240:243], v[132:135], a[196:199]
v_accvgpr_read_b32 v214, a186
v_accvgpr_read_b32 v215, a187
v_mfma_f32_16x16x32_bf16 a[196:199], v[244:247], v[148:151], a[196:199]
v_cvt_pk_bf16_f32 v86, v212, v213
v_cvt_pk_bf16_f32 v87, v214, v215
v_mfma_f32_16x16x32_bf16 a[200:203], v[240:243], v[136:139], a[200:203]
ds_read_b64_tr_b16 v[236:237], v250 offset:61440
ds_read_b64_tr_b16 v[238:239], v250 offset:63488
v_mfma_f32_16x16x32_bf16 a[200:203], v[244:247], v[152:155], a[200:203]
buffer_store_dwordx4 v[84:87], v252, s[20:23], s46 offen offset:1024 sc1
v_accvgpr_read_b32 v220, a188
v_mfma_f32_16x16x32_bf16 a[204:207], v[240:243], v[140:143], a[204:207]
v_accvgpr_read_b32 v221, a189
v_accvgpr_read_b32 v222, a190
v_mfma_f32_16x16x32_bf16 a[204:207], v[244:247], v[156:159], a[204:207]
s_waitcnt lgkmcnt(4)
v_accvgpr_read_b32 v223, a191
v_mfma_f32_16x16x32_bf16 a[192:195], v[224:227], v[160:163], a[192:195]
ds_read_b64_tr_b16 v[240:241], v13 offset:12288
ds_read_b64_tr_b16 v[242:243], v13 offset:14336
v_mfma_f32_16x16x32_bf16 a[192:195], v[228:231], v[0:3], a[192:195]
v_cvt_pk_bf16_f32 v118, v220, v221
v_cvt_pk_bf16_f32 v119, v222, v223
v_mfma_f32_16x16x32_bf16 a[196:199], v[224:227], v[164:167], a[196:199]
buffer_store_dwordx4 v[116:119], v252, s[20:23], s47 offen offset:1024 sc1
v_mfma_f32_16x16x32_bf16 a[196:199], v[228:231], v[32:35], a[196:199]
v_mfma_f32_16x16x32_bf16 a[200:203], v[224:227], v[168:171], a[200:203]
ds_read_b64_tr_b16 v[244:245], v13 offset:28672
ds_read_b64_tr_b16 v[246:247], v13 offset:30720
v_mfma_f32_16x16x32_bf16 a[200:203], v[228:231], v[64:67], a[200:203]
v_mfma_f32_16x16x32_bf16 a[204:207], v[224:227], v[172:175], a[204:207]
v_accvgpr_read_b32 v192, a192
v_accvgpr_read_b32 v193, a193
v_mfma_f32_16x16x32_bf16 a[204:207], v[228:231], v[96:99], a[204:207]
s_waitcnt lgkmcnt(4)
v_accvgpr_read_b32 v194, a194
v_mfma_f32_16x16x32_bf16 a[208:211], v[232:235], v[4:7], a[208:211]
ds_read_b64_tr_b16 v[224:225], v13 offset:45056
ds_read_b64_tr_b16 v[226:227], v13 offset:47104
v_mfma_f32_16x16x32_bf16 a[208:211], v[236:239], v[176:179], a[208:211]
v_accvgpr_read_b32 v195, a195
v_cvt_pk_bf16_f32 v24, v192, v193
v_mfma_f32_16x16x32_bf16 a[212:215], v[232:235], v[36:39], a[212:215]
v_cvt_pk_bf16_f32 v25, v194, v195
v_accvgpr_read_b32 v200, a196
v_mfma_f32_16x16x32_bf16 a[212:215], v[236:239], v[180:183], a[212:215]
v_accvgpr_read_b32 v201, a197
v_accvgpr_read_b32 v202, a198
v_mfma_f32_16x16x32_bf16 a[216:219], v[232:235], v[68:71], a[216:219]
ds_read_b64_tr_b16 v[228:229], v13 offset:61440
ds_read_b64_tr_b16 v[230:231], v13 offset:63488
v_mfma_f32_16x16x32_bf16 a[216:219], v[236:239], v[184:187], a[216:219]
v_accvgpr_read_b32 v203, a199
v_cvt_pk_bf16_f32 v56, v200, v201
v_mfma_f32_16x16x32_bf16 a[220:223], v[232:235], v[100:103], a[220:223]
v_cvt_pk_bf16_f32 v57, v202, v203
v_accvgpr_read_b32 v208, a200
v_mfma_f32_16x16x32_bf16 a[220:223], v[236:239], v[188:191], a[220:223]
s_waitcnt lgkmcnt(4)
v_accvgpr_read_b32 v209, a201
v_mfma_f32_16x16x32_bf16 a[208:211], v[240:243], v[128:131], a[208:211]
ds_read_b64_tr_b16 v[232:233], v249 offset:45568
ds_read_b64_tr_b16 v[234:235], v249 offset:47616
v_mfma_f32_16x16x32_bf16 a[208:211], v[244:247], v[144:147], a[208:211]
v_accvgpr_read_b32 v210, a202
v_accvgpr_read_b32 v211, a203
v_mfma_f32_16x16x32_bf16 a[212:215], v[240:243], v[132:135], a[212:215]
v_cvt_pk_bf16_f32 v88, v208, v209
v_cvt_pk_bf16_f32 v89, v210, v211
v_mfma_f32_16x16x32_bf16 a[212:215], v[244:247], v[148:151], a[212:215]
v_accvgpr_read_b32 v216, a204
v_accvgpr_read_b32 v217, a205
v_mfma_f32_16x16x32_bf16 a[216:219], v[240:243], v[136:139], a[216:219]
ds_read_b64_tr_b16 v[236:237], v249 offset:61952
ds_read_b64_tr_b16 v[238:239], v249 offset:64000
v_mfma_f32_16x16x32_bf16 a[216:219], v[244:247], v[152:155], a[216:219]
v_accvgpr_read_b32 v218, a206
v_accvgpr_read_b32 v219, a207
v_mfma_f32_16x16x32_bf16 a[220:223], v[240:243], v[140:143], a[220:223]
v_cvt_pk_bf16_f32 v120, v216, v217
v_cvt_pk_bf16_f32 v121, v218, v219
v_mfma_f32_16x16x32_bf16 a[220:223], v[244:247], v[156:159], a[220:223]
s_waitcnt lgkmcnt(4)
v_mfma_f32_16x16x32_bf16 a[208:211], v[224:227], v[160:163], a[208:211]
ds_read_b64_tr_b16 v[240:241], v12 offset:12800
ds_read_b64_tr_b16 v[242:243], v12 offset:14848
v_mfma_f32_16x16x32_bf16 a[208:211], v[228:231], v[0:3], a[208:211]
v_mfma_f32_16x16x32_bf16 a[212:215], v[224:227], v[164:167], a[212:215]
v_mfma_f32_16x16x32_bf16 a[212:215], v[228:231], v[32:35], a[212:215]
v_mfma_f32_16x16x32_bf16 a[216:219], v[224:227], v[168:171], a[216:219]
ds_read_b64_tr_b16 v[244:245], v12 offset:29184
ds_read_b64_tr_b16 v[246:247], v12 offset:31232
v_mfma_f32_16x16x32_bf16 a[216:219], v[228:231], v[64:67], a[216:219]
v_mfma_f32_16x16x32_bf16 a[220:223], v[224:227], v[172:175], a[220:223]
s_nop 0
v_accvgpr_read_b32 v196, a208
v_accvgpr_read_b32 v197, a209
v_mfma_f32_16x16x32_bf16 a[220:223], v[228:231], v[96:99], a[220:223]
s_waitcnt lgkmcnt(4)
v_accvgpr_read_b32 v198, a210
v_mfma_f32_16x16x32_bf16 a[224:227], v[232:235], v[4:7], a[224:227]
ds_read_b64_tr_b16 v[224:225], v12 offset:45568
ds_read_b64_tr_b16 v[226:227], v12 offset:47616
v_mfma_f32_16x16x32_bf16 a[224:227], v[236:239], v[176:179], a[224:227]
v_accvgpr_read_b32 v199, a211
v_cvt_pk_bf16_f32 v26, v196, v197
v_mfma_f32_16x16x32_bf16 a[228:231], v[232:235], v[36:39], a[228:231]
v_cvt_pk_bf16_f32 v27, v198, v199
buffer_store_dwordx4 v[24:27], v252, s[20:23], s44 offen offset:2048 sc1
v_mfma_f32_16x16x32_bf16 a[228:231], v[236:239], v[180:183], a[228:231]
v_accvgpr_read_b32 v204, a212
v_accvgpr_read_b32 v205, a213
v_mfma_f32_16x16x32_bf16 a[232:235], v[232:235], v[68:71], a[232:235]
ds_read_b64_tr_b16 v[228:229], v12 offset:61952
ds_read_b64_tr_b16 v[230:231], v12 offset:64000
v_mfma_f32_16x16x32_bf16 a[232:235], v[236:239], v[184:187], a[232:235]
v_accvgpr_read_b32 v206, a214
v_accvgpr_read_b32 v207, a215
v_mfma_f32_16x16x32_bf16 a[236:239], v[232:235], v[100:103], a[236:239]
v_cvt_pk_bf16_f32 v58, v204, v205
v_cvt_pk_bf16_f32 v59, v206, v207
v_mfma_f32_16x16x32_bf16 a[236:239], v[236:239], v[188:191], a[236:239]
s_waitcnt lgkmcnt(4)
buffer_store_dwordx4 v[56:59], v252, s[20:23], s45 offen offset:2048 sc1
v_mfma_f32_16x16x32_bf16 a[224:227], v[240:243], v[128:131], a[224:227]
ds_read_b64_tr_b16 v[232:233], v250 offset:45568
ds_read_b64_tr_b16 v[234:235], v250 offset:47616
v_mfma_f32_16x16x32_bf16 a[224:227], v[244:247], v[144:147], a[224:227]
v_accvgpr_read_b32 v212, a216
v_accvgpr_read_b32 v213, a217
v_mfma_f32_16x16x32_bf16 a[228:231], v[240:243], v[132:135], a[228:231]
v_accvgpr_read_b32 v214, a218
v_accvgpr_read_b32 v215, a219
v_mfma_f32_16x16x32_bf16 a[228:231], v[244:247], v[148:151], a[228:231]
v_cvt_pk_bf16_f32 v90, v212, v213
v_cvt_pk_bf16_f32 v91, v214, v215
v_mfma_f32_16x16x32_bf16 a[232:235], v[240:243], v[136:139], a[232:235]
ds_read_b64_tr_b16 v[236:237], v250 offset:61952
ds_read_b64_tr_b16 v[238:239], v250 offset:64000
v_mfma_f32_16x16x32_bf16 a[232:235], v[244:247], v[152:155], a[232:235]
buffer_store_dwordx4 v[88:91], v252, s[20:23], s46 offen offset:2048 sc1
v_accvgpr_read_b32 v220, a220
v_mfma_f32_16x16x32_bf16 a[236:239], v[240:243], v[140:143], a[236:239]
v_accvgpr_read_b32 v221, a221
v_accvgpr_read_b32 v222, a222
v_mfma_f32_16x16x32_bf16 a[236:239], v[244:247], v[156:159], a[236:239]
s_waitcnt lgkmcnt(4)
v_accvgpr_read_b32 v223, a223
v_mfma_f32_16x16x32_bf16 a[224:227], v[224:227], v[160:163], a[224:227]
ds_read_b64_tr_b16 v[240:241], v13 offset:12800
ds_read_b64_tr_b16 v[242:243], v13 offset:14848
v_mfma_f32_16x16x32_bf16 a[224:227], v[228:231], v[0:3], a[224:227]
v_cvt_pk_bf16_f32 v122, v220, v221
v_cvt_pk_bf16_f32 v123, v222, v223
v_mfma_f32_16x16x32_bf16 a[228:231], v[224:227], v[164:167], a[228:231]
buffer_store_dwordx4 v[120:123], v252, s[20:23], s47 offen offset:2048 sc1
v_mfma_f32_16x16x32_bf16 a[228:231], v[228:231], v[32:35], a[228:231]
v_mfma_f32_16x16x32_bf16 a[232:235], v[224:227], v[168:171], a[232:235]
ds_read_b64_tr_b16 v[244:245], v13 offset:29184
ds_read_b64_tr_b16 v[246:247], v13 offset:31232
v_mfma_f32_16x16x32_bf16 a[232:235], v[228:231], v[64:67], a[232:235]
v_mfma_f32_16x16x32_bf16 a[236:239], v[224:227], v[172:175], a[236:239]
v_accvgpr_read_b32 v192, a224
v_accvgpr_read_b32 v193, a225
v_mfma_f32_16x16x32_bf16 a[236:239], v[228:231], v[96:99], a[236:239]
s_waitcnt lgkmcnt(4)
v_accvgpr_read_b32 v194, a226
v_mfma_f32_16x16x32_bf16 a[240:243], v[232:235], v[4:7], a[240:243]
ds_read_b64_tr_b16 v[224:225], v13 offset:45568
ds_read_b64_tr_b16 v[226:227], v13 offset:47616
v_mfma_f32_16x16x32_bf16 a[240:243], v[236:239], v[176:179], a[240:243]
v_accvgpr_read_b32 v195, a227
v_cvt_pk_bf16_f32 v28, v192, v193
v_mfma_f32_16x16x32_bf16 a[244:247], v[232:235], v[36:39], a[244:247]
v_cvt_pk_bf16_f32 v29, v194, v195
v_accvgpr_read_b32 v200, a228
v_mfma_f32_16x16x32_bf16 a[244:247], v[236:239], v[180:183], a[244:247]
v_accvgpr_read_b32 v201, a229
v_accvgpr_read_b32 v202, a230
v_mfma_f32_16x16x32_bf16 a[248:251], v[232:235], v[68:71], a[248:251]
ds_read_b64_tr_b16 v[228:229], v13 offset:61952
ds_read_b64_tr_b16 v[230:231], v13 offset:64000
v_mfma_f32_16x16x32_bf16 a[248:251], v[236:239], v[184:187], a[248:251]
v_accvgpr_read_b32 v203, a231
v_cvt_pk_bf16_f32 v60, v200, v201
v_mfma_f32_16x16x32_bf16 a[252:255], v[232:235], v[100:103], a[252:255]
v_cvt_pk_bf16_f32 v61, v202, v203
v_accvgpr_read_b32 v208, a232
v_mfma_f32_16x16x32_bf16 a[252:255], v[236:239], v[188:191], a[252:255]
s_waitcnt lgkmcnt(4)
v_accvgpr_read_b32 v209, a233
v_mfma_f32_16x16x32_bf16 a[240:243], v[240:243], v[128:131], a[240:243]
v_accvgpr_read_b32 v210, a234
v_accvgpr_read_b32 v211, a235
v_mfma_f32_16x16x32_bf16 a[240:243], v[244:247], v[144:147], a[240:243]
v_cvt_pk_bf16_f32 v92, v208, v209
v_cvt_pk_bf16_f32 v93, v210, v211
v_mfma_f32_16x16x32_bf16 a[244:247], v[240:243], v[132:135], a[244:247]
v_accvgpr_read_b32 v216, a236
v_accvgpr_read_b32 v217, a237
v_mfma_f32_16x16x32_bf16 a[244:247], v[244:247], v[148:151], a[244:247]
v_accvgpr_read_b32 v218, a238
v_accvgpr_read_b32 v219, a239
v_mfma_f32_16x16x32_bf16 a[248:251], v[240:243], v[136:139], a[248:251]
v_cvt_pk_bf16_f32 v124, v216, v217
v_cvt_pk_bf16_f32 v125, v218, v219
v_mfma_f32_16x16x32_bf16 a[248:251], v[244:247], v[152:155], a[248:251]
v_mfma_f32_16x16x32_bf16 a[252:255], v[240:243], v[140:143], a[252:255]
v_mfma_f32_16x16x32_bf16 a[252:255], v[244:247], v[156:159], a[252:255]
s_waitcnt lgkmcnt(0)
v_mfma_f32_16x16x32_bf16 a[240:243], v[224:227], v[160:163], a[240:243]
v_mfma_f32_16x16x32_bf16 a[240:243], v[228:231], v[0:3], a[240:243]
v_mfma_f32_16x16x32_bf16 a[244:247], v[224:227], v[164:167], a[244:247]
v_mfma_f32_16x16x32_bf16 a[244:247], v[228:231], v[32:35], a[244:247]
v_mfma_f32_16x16x32_bf16 a[248:251], v[224:227], v[168:171], a[248:251]
v_mfma_f32_16x16x32_bf16 a[248:251], v[228:231], v[64:67], a[248:251]
v_mfma_f32_16x16x32_bf16 a[252:255], v[224:227], v[172:175], a[252:255]
s_nop 2
v_accvgpr_read_b32 v196, a240
v_accvgpr_read_b32 v197, a241
v_accvgpr_read_b32 v198, a242
v_accvgpr_read_b32 v199, a243
v_mfma_f32_16x16x32_bf16 a[252:255], v[228:231], v[96:99], a[252:255]
v_cvt_pk_bf16_f32 v30, v196, v197
v_cvt_pk_bf16_f32 v31, v198, v199
buffer_store_dwordx4 v[28:31], v252, s[20:23], s44 offen offset:3072 sc1
v_accvgpr_read_b32 v204, a244
v_accvgpr_read_b32 v205, a245
v_accvgpr_read_b32 v206, a246
v_accvgpr_read_b32 v207, a247
v_cvt_pk_bf16_f32 v62, v204, v205
v_cvt_pk_bf16_f32 v63, v206, v207
buffer_store_dwordx4 v[60:63], v252, s[20:23], s45 offen offset:3072 sc1
v_accvgpr_read_b32 v212, a248
v_accvgpr_read_b32 v213, a249
v_accvgpr_read_b32 v214, a250
v_accvgpr_read_b32 v215, a251
v_cvt_pk_bf16_f32 v94, v212, v213
v_cvt_pk_bf16_f32 v95, v214, v215
buffer_store_dwordx4 v[92:95], v252, s[20:23], s46 offen offset:3072 sc1
v_accvgpr_read_b32 v220, a252
v_accvgpr_read_b32 v221, a253
v_accvgpr_read_b32 v222, a254
v_accvgpr_read_b32 v223, a255
v_cvt_pk_bf16_f32 v126, v220, v221
v_cvt_pk_bf16_f32 v127, v222, v223
buffer_store_dwordx4 v[124:127], v252, s[20:23], s47 offen offset:3072 sc1
s_waitcnt vmcnt(15)
v_readfirstlane_b32 s99, v254
s_branch L2_chk
L2_tail_1_7:
s_waitcnt lgkmcnt(4)
v_mfma_f32_16x16x32_bf16 a[0:3], v[224:227], v[160:163], a[0:3]
ds_read_b128 v[240:243], v248 offset:2048
v_mfma_f32_16x16x32_bf16 a[0:3], v[228:231], v[176:179], a[0:3]
s_lshl_b32 s36, s34, 13
v_mfma_f32_16x16x32_bf16 a[4:7], v[224:227], v[164:167], a[4:7]
s_add_u32 s56, s4, 0x1000000
s_addc_u32 s57, s5, 0
v_mfma_f32_16x16x32_bf16 a[4:7], v[228:231], v[180:183], a[4:7]
s_add_u32 s36, s36, 0x20000
s_mov_b32 s58, 0x6c02000
v_mfma_f32_16x16x32_bf16 a[8:11], v[224:227], v[168:171], a[8:11]
ds_read_b128 v[244:247], v248 offset:2560
s_mov_b32 s59, 0x00020000
v_mfma_f32_16x16x32_bf16 a[8:11], v[228:231], v[184:187], a[8:11]
v_add_u32 v255, s36, v252
s_lshr_b32 s35, s2, 1
v_mfma_f32_16x16x32_bf16 a[12:15], v[224:227], v[172:175], a[12:15]
s_and_b32 s35, s35, 28
s_add_u32 s35, s35, s34
v_mfma_f32_16x16x32_bf16 a[12:15], v[228:231], v[188:191], a[12:15]
s_waitcnt lgkmcnt(2)
s_lshl_b32 s35, s35, 13
v_mfma_f32_16x16x32_bf16 a[16:19], v[232:235], v[160:163], a[16:19]
ds_read_b128 v[224:227], v248 offset:6144
v_lshlrev_b32 v253, 3, v252
v_mfma_f32_16x16x32_bf16 a[16:19], v[236:239], v[176:179], a[16:19]
buffer_load_dword v253, v253, s[56:59], s35 offen
ds_write_b128 v255, v[160:163] offset:0
v_mfma_f32_16x16x32_bf16 a[20:23], v[232:235], v[164:167], a[20:23]
v_exp_f32 v192, v192
v_mfma_f32_16x16x32_bf16 a[20:23], v[236:239], v[180:183], a[20:23]
v_exp_f32 v193, v193
v_mfma_f32_16x16x32_bf16 a[24:27], v[232:235], v[168:171], a[24:27]
ds_read_b128 v[228:231], v248 offset:6656
v_cvt_pk_bf16_f32 v128, v192, v193
v_mfma_f32_16x16x32_bf16 a[24:27], v[236:239], v[184:187], a[24:27]
v_exp_f32 v194, v194
v_mfma_f32_16x16x32_bf16 a[28:31], v[232:235], v[172:175], a[28:31]
v_exp_f32 v195, v195
v_mfma_f32_16x16x32_bf16 a[28:31], v[236:239], v[188:191], a[28:31]
s_waitcnt lgkmcnt(3)
v_cvt_pk_bf16_f32 v129, v194, v195
v_mfma_f32_16x16x32_bf16 v[208:211], v[240:243], v[0:3], 0
ds_read_b128 v[232:235], v248 offset:10240
ds_write_b128 v255, v[164:167] offset:1024
v_mfma_f32_16x16x32_bf16 v[208:211], v[244:247], v[4:7], v[208:211]
v_exp_f32 v196, v196
v_mfma_f32_16x16x32_bf16 v[212:215], v[240:243], v[32:35], 0
v_exp_f32 v197, v197
v_mfma_f32_16x16x32_bf16 v[212:215], v[244:247], v[36:39], v[212:215]
v_exp_f32 v198, v198
v_mfma_f32_16x16x32_bf16 v[216:219], v[240:243], v[64:67], 0
ds_read_b128 v[236:239], v248 offset:10752
v_cvt_pk_bf16_f32 v132, v196, v197
v_mfma_f32_16x16x32_bf16 v[216:219], v[244:247], v[68:71], v[216:219]
v_exp_f32 v199, v199
v_mfma_f32_16x16x32_bf16 v[220:223], v[240:243], v[96:99], 0
v_exp_f32 v200, v200
v_mfma_f32_16x16x32_bf16 v[220:223], v[244:247], v[100:103], v[220:223]
s_waitcnt lgkmcnt(3)
v_cvt_pk_bf16_f32 v133, v198, v199
v_mfma_f32_16x16x32_bf16 v[208:211], v[224:227], v[8:11], v[208:211]
ds_read_b128 v[240:243], v248 offset:14336
ds_write_b128 v255, v[168:171] offset:2048
v_mfma_f32_16x16x32_bf16 v[208:211], v[228:231], v[12:15], v[208:211]
v_exp_f32 v201, v201
v_mfma_f32_16x16x32_bf16 v[212:215], v[224:227], v[40:43], v[212:215]
v_exp_f32 v202, v202
v_mfma_f32_16x16x32_bf16 v[212:215], v[228:231], v[44:47], v[212:215]
v_exp_f32 v203, v203
v_mfma_f32_16x16x32_bf16 v[216:219], v[224:227], v[72:75], v[216:219]
ds_read_b128 v[244:247], v248 offset:14848
v_cvt_pk_bf16_f32 v136, v200, v201
v_mfma_f32_16x16x32_bf16 v[216:219], v[228:231], v[76:79], v[216:219]
v_cvt_pk_bf16_f32 v137, v202, v203
ds_write_b128 v255, v[172:175] offset:3072
v_mfma_f32_16x16x32_bf16 v[220:223], v[224:227], v[104:107], v[220:223]
v_exp_f32 v204, v204
v_mfma_f32_16x16x32_bf16 v[220:223], v[228:231], v[108:111], v[220:223]
s_waitcnt lgkmcnt(4)
s_waitcnt vmcnt(1)
s_barrier
v_mfma_f32_16x16x32_bf16 v[208:211], v[232:235], v[16:19], v[208:211]
ds_read_b128 v[224:227], v248 offset:16384
s_add_u32 m0, s30, 0xc000
v_mfma_f32_16x16x32_bf16 v[208:211], v[236:239], v[20:23], v[208:211]
s_and_b32 s100, s30, 0x10000
buffer_load_dwordx4 v251, s[12:15], s28 offen offset:0 lds
v_mfma_f32_16x16x32_bf16 v[212:215], v[232:235], v[48:51], v[212:215]
s_xor_b32 s100, s100, 0x10000
ds_write_b128 v255, v[176:179] offset:4096
v_mfma_f32_16x16x32_bf16 v[212:215], v[236:239], v[52:55], v[212:215]
s_mov_b32 s99, 0
buffer_load_dwordx4 v251, s[12:15], s28 offen offset:1024 lds
v_mfma_f32_16x16x32_bf16 v[216:219], v[232:235], v[80:83], v[216:219]
ds_read_b128 v[228:231], v248 offset:16896
ds_write_b128 v255, v[180:183] offset:5120
v_mfma_f32_16x16x32_bf16 v[216:219], v[236:239], v[84:87], v[216:219]
v_exp_f32 v205, v205
v_mfma_f32_16x16x32_bf16 v[220:223], v[232:235], v[112:115], v[220:223]
v_exp_f32 v206, v206
v_mfma_f32_16x16x32_bf16 v[220:223], v[236:239], v[116:119], v[220:223]
s_waitcnt lgkmcnt(5)
v_cvt_pk_bf16_f32 v140, v204, v205
v_mfma_f32_16x16x32_bf16 v[208:211], v[240:243], v[24:27], v[208:211]
ds_read_b128 v[232:235], v248 offset:20480
buffer_load_dwordx4 v251, s[12:15], s28 offen offset:2048 lds
v_mfma_f32_16x16x32_bf16 v[208:211], v[244:247], v[28:31], v[208:211]
v_exp_f32 v207, v207
v_mfma_f32_16x16x32_bf16 v[212:215], v[240:243], v[56:59], v[212:215]
buffer_load_dwordx4 v251, s[12:15], s28 offen offset:3072 lds
ds_write_b128 v255, v[184:187] offset:6144
v_mfma_f32_16x16x32_bf16 v[212:215], v[244:247], v[60:63], v[212:215]
ds_write_b128 v255, v[188:191] offset:7168
v_mfma_f32_16x16x32_bf16 v[216:219], v[240:243], v[88:91], v[216:219]
ds_read_b128 v[236:239], v248 offset:20992
v_cvt_pk_bf16_f32 v141, v206, v207
v_mfma_f32_16x16x32_bf16 v[216:219], v[244:247], v[92:95], v[216:219]
s_add_u32 s28, s28, 0x4000
s_xor_b32 s30, s30, 0x10000
v_mfma_f32_16x16x32_bf16 v[220:223], v[240:243], v[120:123], v[220:223]
s_add_u32 m0, s30, 0x0
v_mfma_f32_16x16x32_bf16 v[220:223], v[244:247], v[124:127], v[220:223]
s_waitcnt lgkmcnt(5)
buffer_load_dwordx4 v251, s[12:15], s28 offen offset:0 lds
v_mfma_f32_16x16x32_bf16 v[192:195], v[224:227], v[0:3], 0
ds_read_b128 v[240:243], v248 offset:24576
v_mfma_f32_16x16x32_bf16 v[192:195], v[228:231], v[4:7], v[192:195]
v_exp_f32 v208, v208
v_mfma_f32_16x16x32_bf16 v[196:199], v[224:227], v[32:35], 0
v_exp_f32 v209, v209
v_mfma_f32_16x16x32_bf16 v[196:199], v[228:231], v[36:39], v[196:199]
v_exp_f32 v210, v210
v_mfma_f32_16x16x32_bf16 v[200:203], v[224:227], v[64:67], 0
ds_read_b128 v[244:247], v248 offset:25088
v_cvt_pk_bf16_f32 v130, v208, v209
v_mfma_f32_16x16x32_bf16 v[200:203], v[228:231], v[68:71], v[200:203]
v_exp_f32 v211, v211
v_mfma_f32_16x16x32_bf16 v[204:207], v[224:227], v[96:99], 0
v_exp_f32 v212, v212
v_mfma_f32_16x16x32_bf16 v[204:207], v[228:231], v[100:103], v[204:207]
s_waitcnt lgkmcnt(2)
v_cvt_pk_bf16_f32 v131, v210, v211
v_mfma_f32_16x16x32_bf16 v[192:195], v[232:235], v[8:11], v[192:195]
ds_read_b128 v[224:227], v248 offset:28672
buffer_load_dwordx4 v251, s[12:15], s28 offen offset:1024 lds
v_mfma_f32_16x16x32_bf16 v[192:195], v[236:239], v[12:15], v[192:195]
v_exp_f32 v213, v213
v_mfma_f32_16x16x32_bf16 v[196:199], v[232:235], v[40:43], v[196:199]
v_exp_f32 v214, v214
v_mfma_f32_16x16x32_bf16 v[196:199], v[236:239], v[44:47], v[196:199]
v_exp_f32 v215, v215
v_mfma_f32_16x16x32_bf16 v[200:203], v[232:235], v[72:75], v[200:203]
ds_read_b128 v[228:231], v248 offset:29184
v_cvt_pk_bf16_f32 v134, v212, v213
v_mfma_f32_16x16x32_bf16 v[200:203], v[236:239], v[76:79], v[200:203]
v_cvt_pk_bf16_f32 v135, v214, v215
buffer_load_dwordx4 v251, s[12:15], s28 offen offset:2048 lds
v_mfma_f32_16x16x32_bf16 v[204:207], v[232:235], v[104:107], v[204:207]
v_exp_f32 v216, v216
v_mfma_f32_16x16x32_bf16 v[204:207], v[236:239], v[108:111], v[204:207]
s_waitcnt lgkmcnt(2)
buffer_load_dwordx4 v251, s[12:15], s28 offen offset:3072 lds
v_mfma_f32_16x16x32_bf16 v[192:195], v[240:243], v[16:19], v[192:195]
ds_read_b128 v[232:235], v248 offset:18432
v_mfma_f32_16x16x32_bf16 v[192:195], v[244:247], v[20:23], v[192:195]
v_exp_f32 v217, v217
v_mfma_f32_16x16x32_bf16 v[196:199], v[240:243], v[48:51], v[196:199]
v_exp_f32 v218, v218
v_mfma_f32_16x16x32_bf16 v[196:199], v[244:247], v[52:55], v[196:199]
v_exp_f32 v219, v219
v_mfma_f32_16x16x32_bf16 v[200:203], v[240:243], v[80:83], v[200:203]
ds_read_b128 v[236:239], v248 offset:18944
v_cvt_pk_bf16_f32 v138, v216, v217
v_mfma_f32_16x16x32_bf16 v[200:203], v[244:247], v[84:87], v[200:203]
v_cvt_pk_bf16_f32 v139, v218, v219
s_add_u32 s28, s28, 0x4000
v_mfma_f32_16x16x32_bf16 v[204:207], v[240:243], v[112:115], v[204:207]
v_exp_f32 v220, v220
v_mfma_f32_16x16x32_bf16 v[204:207], v[244:247], v[116:119], v[204:207]
s_waitcnt lgkmcnt(2)
v_mfma_f32_16x16x32_bf16 v[192:195], v[224:227], v[24:27], v[192:195]
ds_read_b128 v[240:243], v248 offset:22528
v_mfma_f32_16x16x32_bf16 v[192:195], v[228:231], v[28:31], v[192:195]
v_exp_f32 v221, v221
v_mfma_f32_16x16x32_bf16 v[196:199], v[224:227], v[56:59], v[196:199]
v_exp_f32 v222, v222
v_mfma_f32_16x16x32_bf16 v[196:199], v[228:231], v[60:63], v[196:199]
v_exp_f32 v223, v223
v_mfma_f32_16x16x32_bf16 v[200:203], v[224:227], v[88:91], v[200:203]
ds_read_b128 v[244:247], v248 offset:23040
v_cvt_pk_bf16_f32 v142, v220, v221
v_mfma_f32_16x16x32_bf16 v[200:203], v[228:231], v[92:95], v[200:203]
v_cvt_pk_bf16_f32 v143, v222, v223
v_mfma_f32_16x16x32_bf16 v[204:207], v[224:227], v[120:123], v[204:207]
v_mfma_f32_16x16x32_bf16 v[204:207], v[228:231], v[124:127], v[204:207]
s_waitcnt lgkmcnt(2)
v_mfma_f32_16x16x32_bf16 v[208:211], v[232:235], v[0:3], 0
ds_read_b128 v[224:227], v248 offset:26624
v_mfma_f32_16x16x32_bf16 v[208:211], v[236:239], v[4:7], v[208:211]
v_exp_f32 v192, v192
v_mfma_f32_16x16x32_bf16 v[212:215], v[232:235], v[32:35], 0
v_exp_f32 v193, v193
v_mfma_f32_16x16x32_bf16 v[212:215], v[236:239], v[36:39], v[212:215]
v_exp_f32 v194, v194
v_mfma_f32_16x16x32_bf16 v[216:219], v[232:235], v[64:67], 0
ds_read_b128 v[228:231], v248 offset:27136
v_cvt_pk_bf16_f32 v144, v192, v193
v_mfma_f32_16x16x32_bf16 v[216:219], v[236:239], v[68:71], v[216:219]
v_exp_f32 v195, v195
v_mfma_f32_16x16x32_bf16 v[220:223], v[232:235], v[96:99], 0
v_exp_f32 v196, v196
v_mfma_f32_16x16x32_bf16 v[220:223], v[236:239], v[100:103], v[220:223]
s_waitcnt lgkmcnt(2)
v_cvt_pk_bf16_f32 v145, v194, v195
v_mfma_f32_16x16x32_bf16 v[208:211], v[240:243], v[8:11], v[208:211]
ds_read_b128 v[232:235], v248 offset:30720
v_mfma_f32_16x16x32_bf16 v[208:211], v[244:247], v[12:15], v[208:211]
v_exp_f32 v197, v197
v_mfma_f32_16x16x32_bf16 v[212:215], v[240:243], v[40:43], v[212:215]
v_exp_f32 v198, v198
v_mfma_f32_16x16x32_bf16 v[212:215], v[244:247], v[44:47], v[212:215]
v_exp_f32 v199, v199
v_mfma_f32_16x16x32_bf16 v[216:219], v[240:243], v[72:75], v[216:219]
ds_read_b128 v[236:239], v248 offset:31232
v_cvt_pk_bf16_f32 v148, v196, v197
v_mfma_f32_16x16x32_bf16 v[216:219], v[244:247], v[76:79], v[216:219]
v_cvt_pk_bf16_f32 v149, v198, v199
v_mfma_f32_16x16x32_bf16 v[220:223], v[240:243], v[104:107], v[220:223]
v_exp_f32 v200, v200
v_mfma_f32_16x16x32_bf16 v[220:223], v[244:247], v[108:111], v[220:223]
s_waitcnt lgkmcnt(2)
v_mfma_f32_16x16x32_bf16 v[208:211], v[224:227], v[16:19], v[208:211]
ds_read_b128 v[240:243], v248 offset:32768
v_mfma_f32_16x16x32_bf16 v[208:211], v[228:231], v[20:23], v[208:211]
v_exp_f32 v201, v201
v_mfma_f32_16x16x32_bf16 v[212:215], v[224:227], v[48:51], v[212:215]
v_exp_f32 v202, v202
v_mfma_f32_16x16x32_bf16 v[212:215], v[228:231], v[52:55], v[212:215]
v_exp_f32 v203, v203
v_mfma_f32_16x16x32_bf16 v[216:219], v[224:227], v[80:83], v[216:219]
ds_read_b128 v[244:247], v248 offset:33280
v_cvt_pk_bf16_f32 v152, v200, v201
v_mfma_f32_16x16x32_bf16 v[216:219], v[228:231], v[84:87], v[216:219]
v_cvt_pk_bf16_f32 v153, v202, v203
v_mfma_f32_16x16x32_bf16 v[220:223], v[224:227], v[112:115], v[220:223]
v_exp_f32 v204, v204
v_mfma_f32_16x16x32_bf16 v[220:223], v[228:231], v[116:119], v[220:223]
s_waitcnt lgkmcnt(2)
v_mfma_f32_16x16x32_bf16 v[208:211], v[232:235], v[24:27], v[208:211]
ds_read_b128 v[224:227], v248 offset:36864
v_mfma_f32_16x16x32_bf16 v[208:211], v[236:239], v[28:31], v[208:211]
v_exp_f32 v205, v205
v_mfma_f32_16x16x32_bf16 v[212:215], v[232:235], v[56:59], v[212:215]
v_exp_f32 v206, v206
v_mfma_f32_16x16x32_bf16 v[212:215], v[236:239], v[60:63], v[212:215]
v_exp_f32 v207, v207
v_mfma_f32_16x16x32_bf16 v[216:219], v[232:235], v[88:91], v[216:219]
ds_read_b128 v[228:231], v248 offset:37376
v_cvt_pk_bf16_f32 v156, v204, v205
v_mfma_f32_16x16x32_bf16 v[216:219], v[236:239], v[92:95], v[216:219]
v_cvt_pk_bf16_f32 v157, v206, v207
v_mfma_f32_16x16x32_bf16 v[220:223], v[232:235], v[120:123], v[220:223]
v_mfma_f32_16x16x32_bf16 v[220:223], v[236:239], v[124:127], v[220:223]
s_waitcnt lgkmcnt(2)
v_mfma_f32_16x16x32_bf16 v[192:195], v[240:243], v[0:3], 0
ds_read_b128 v[232:235], v248 offset:40960
v_mfma_f32_16x16x32_bf16 v[192:195], v[244:247], v[4:7], v[192:195]
v_exp_f32 v208, v208
v_mfma_f32_16x16x32_bf16 v[196:199], v[240:243], v[32:35], 0
v_exp_f32 v209, v209
v_mfma_f32_16x16x32_bf16 v[196:199], v[244:247], v[36:39], v[196:199]
v_exp_f32 v210, v210
v_mfma_f32_16x16x32_bf16 v[200:203], v[240:243], v[64:67], 0
ds_read_b128 v[236:239], v248 offset:41472
v_cvt_pk_bf16_f32 v146, v208, v209
v_mfma_f32_16x16x32_bf16 v[200:203], v[244:247], v[68:71], v[200:203]
v_exp_f32 v211, v211
v_mfma_f32_16x16x32_bf16 v[204:207], v[240:243], v[96:99], 0
v_exp_f32 v212, v212
v_mfma_f32_16x16x32_bf16 v[204:207], v[244:247], v[100:103], v[204:207]
s_waitcnt lgkmcnt(2)
v_cvt_pk_bf16_f32 v147, v210, v211
v_mfma_f32_16x16x32_bf16 v[192:195], v[224:227], v[8:11], v[192:195]
ds_read_b128 v[240:243], v248 offset:45056
v_mfma_f32_16x16x32_bf16 v[192:195], v[228:231], v[12:15], v[192:195]
v_exp_f32 v213, v213
v_mfma_f32_16x16x32_bf16 v[196:199], v[224:227], v[40:43], v[196:199]
v_exp_f32 v214, v214
v_mfma_f32_16x16x32_bf16 v[196:199], v[228:231], v[44:47], v[196:199]
v_exp_f32 v215, v215
v_mfma_f32_16x16x32_bf16 v[200:203], v[224:227], v[72:75], v[200:203]
ds_read_b128 v[244:247], v248 offset:45568
v_cvt_pk_bf16_f32 v150, v212, v213
v_mfma_f32_16x16x32_bf16 v[200:203], v[228:231], v[76:79], v[200:203]
v_cvt_pk_bf16_f32 v151, v214, v215
v_mfma_f32_16x16x32_bf16 v[204:207], v[224:227], v[104:107], v[204:207]
v_exp_f32 v216, v216
v_mfma_f32_16x16x32_bf16 v[204:207], v[228:231], v[108:111], v[204:207]
s_waitcnt lgkmcnt(2)
v_mfma_f32_16x16x32_bf16 v[192:195], v[232:235], v[16:19], v[192:195]
ds_read_b128 v[224:227], v248 offset:34816
v_mfma_f32_16x16x32_bf16 v[192:195], v[236:239], v[20:23], v[192:195]
v_exp_f32 v217, v217
v_mfma_f32_16x16x32_bf16 v[196:199], v[232:235], v[48:51], v[196:199]
v_exp_f32 v218, v218
v_mfma_f32_16x16x32_bf16 v[196:199], v[236:239], v[52:55], v[196:199]
v_exp_f32 v219, v219
v_mfma_f32_16x16x32_bf16 v[200:203], v[232:235], v[80:83], v[200:203]
ds_read_b128 v[228:231], v248 offset:35328
v_cvt_pk_bf16_f32 v154, v216, v217
v_mfma_f32_16x16x32_bf16 v[200:203], v[236:239], v[84:87], v[200:203]
v_cvt_pk_bf16_f32 v155, v218, v219
v_mfma_f32_16x16x32_bf16 v[204:207], v[232:235], v[112:115], v[204:207]
v_exp_f32 v220, v220
v_mfma_f32_16x16x32_bf16 v[204:207], v[236:239], v[116:119], v[204:207]
s_waitcnt lgkmcnt(2)
v_mfma_f32_16x16x32_bf16 v[192:195], v[240:243], v[24:27], v[192:195]
ds_read_b128 v[232:235], v248 offset:38912
v_mfma_f32_16x16x32_bf16 v[192:195], v[244:247], v[28:31], v[192:195]
v_exp_f32 v221, v221
v_mfma_f32_16x16x32_bf16 v[196:199], v[240:243], v[56:59], v[196:199]
v_exp_f32 v222, v222
v_mfma_f32_16x16x32_bf16 v[196:199], v[244:247], v[60:63], v[196:199]
v_exp_f32 v223, v223
v_mfma_f32_16x16x32_bf16 v[200:203], v[240:243], v[88:91], v[200:203]
ds_read_b128 v[236:239], v248 offset:39424
v_cvt_pk_bf16_f32 v158, v220, v221
v_mfma_f32_16x16x32_bf16 v[200:203], v[244:247], v[92:95], v[200:203]
v_cvt_pk_bf16_f32 v159, v222, v223
v_mfma_f32_16x16x32_bf16 v[204:207], v[240:243], v[120:123], v[204:207]
v_mfma_f32_16x16x32_bf16 v[204:207], v[244:247], v[124:127], v[204:207]
s_waitcnt lgkmcnt(2)
v_mfma_f32_16x16x32_bf16 v[208:211], v[224:227], v[0:3], 0
ds_read_b128 v[240:243], v248 offset:43008
v_mfma_f32_16x16x32_bf16 v[208:211], v[228:231], v[4:7], v[208:211]
v_exp_f32 v192, v192
v_mfma_f32_16x16x32_bf16 v[212:215], v[224:227], v[32:35], 0
v_exp_f32 v193, v193
v_mfma_f32_16x16x32_bf16 v[212:215], v[228:231], v[36:39], v[212:215]
v_exp_f32 v194, v194
v_mfma_f32_16x16x32_bf16 v[216:219], v[224:227], v[64:67], 0
ds_read_b128 v[244:247], v248 offset:43520
v_cvt_pk_bf16_f32 v160, v192, v193
v_mfma_f32_16x16x32_bf16 v[216:219], v[228:231], v[68:71], v[216:219]
v_exp_f32 v195, v195
v_mfma_f32_16x16x32_bf16 v[220:223], v[224:227], v[96:99], 0
v_exp_f32 v196, v196
v_mfma_f32_16x16x32_bf16 v[220:223], v[228:231], v[100:103], v[220:223]
s_waitcnt lgkmcnt(2)
v_cvt_pk_bf16_f32 v161, v194, v195
v_mfma_f32_16x16x32_bf16 v[208:211], v[232:235], v[8:11], v[208:211]
ds_read_b128 v[224:227], v248 offset:47104
v_mfma_f32_16x16x32_bf16 v[208:211], v[236:239], v[12:15], v[208:211]
v_exp_f32 v197, v197
v_mfma_f32_16x16x32_bf16 v[212:215], v[232:235], v[40:43], v[212:215]
v_exp_f32 v198, v198
v_mfma_f32_16x16x32_bf16 v[212:215], v[236:239], v[44:47], v[212:215]
v_exp_f32 v199, v199
v_mfma_f32_16x16x32_bf16 v[216:219], v[232:235], v[72:75], v[216:219]
ds_read_b128 v[228:231], v248 offset:47616
v_cvt_pk_bf16_f32 v164, v196, v197
v_mfma_f32_16x16x32_bf16 v[216:219], v[236:239], v[76:79], v[216:219]
v_cvt_pk_bf16_f32 v165, v198, v199
v_mfma_f32_16x16x32_bf16 v[220:223], v[232:235], v[104:107], v[220:223]
v_exp_f32 v200, v200
v_mfma_f32_16x16x32_bf16 v[220:223], v[236:239], v[108:111], v[220:223]
s_waitcnt lgkmcnt(2)
s_waitcnt vmcnt(0)
s_barrier
v_mfma_f32_16x16x32_bf16 v[208:211], v[240:243], v[16:19], v[208:211]
ds_read_b128 v[232:235], v248 offset:49152
v_mfma_f32_16x16x32_bf16 v[208:211], v[244:247], v[20:23], v[208:211]
v_exp_f32 v201, v201
v_mfma_f32_16x16x32_bf16 v[212:215], v[240:243], v[48:51], v[212:215]
v_exp_f32 v202, v202
v_mfma_f32_16x16x32_bf16 v[212:215], v[244:247], v[52:55], v[212:215]
v_exp_f32 v203, v203
v_mfma_f32_16x16x32_bf16 v[216:219], v[240:243], v[80:83], v[216:219]
ds_read_b128 v[236:239], v248 offset:49664
v_cvt_pk_bf16_f32 v168, v200, v201
v_mfma_f32_16x16x32_bf16 v[216:219], v[244:247], v[84:87], v[216:219]
v_cvt_pk_bf16_f32 v169, v202, v203
v_mfma_f32_16x16x32_bf16 v[220:223], v[240:243], v[112:115], v[220:223]
v_exp_f32 v204, v204
v_mfma_f32_16x16x32_bf16 v[220:223], v[244:247], v[116:119], v[220:223]
s_waitcnt lgkmcnt(2)
v_mfma_f32_16x16x32_bf16 v[208:211], v[224:227], v[24:27], v[208:211]
ds_read_b128 v[240:243], v248 offset:53248
v_mfma_f32_16x16x32_bf16 v[208:211], v[228:231], v[28:31], v[208:211]
v_exp_f32 v205, v205
v_mfma_f32_16x16x32_bf16 v[212:215], v[224:227], v[56:59], v[212:215]
v_exp_f32 v206, v206
v_mfma_f32_16x16x32_bf16 v[212:215], v[228:231], v[60:63], v[212:215]
v_exp_f32 v207, v207
v_mfma_f32_16x16x32_bf16 v[216:219], v[224:227], v[88:91], v[216:219]
ds_read_b128 v[244:247], v248 offset:53760
v_cvt_pk_bf16_f32 v172, v204, v205
v_mfma_f32_16x16x32_bf16 v[216:219], v[228:231], v[92:95], v[216:219]
v_cvt_pk_bf16_f32 v173, v206, v207
v_mfma_f32_16x16x32_bf16 v[220:223], v[224:227], v[120:123], v[220:223]
v_mfma_f32_16x16x32_bf16 v[220:223], v[228:231], v[124:127], v[220:223]
s_waitcnt lgkmcnt(2)
v_mfma_f32_16x16x32_bf16 v[192:195], v[232:235], v[0:3], 0
ds_read_b128 v[224:227], v248 offset:57344
v_mfma_f32_16x16x32_bf16 v[192:195], v[236:239], v[4:7], v[192:195]
v_exp_f32 v208, v208
v_mfma_f32_16x16x32_bf16 v[196:199], v[232:235], v[32:35], 0
v_exp_f32 v209, v209
v_mfma_f32_16x16x32_bf16 v[196:199], v[236:239], v[36:39], v[196:199]
v_exp_f32 v210, v210
v_mfma_f32_16x16x32_bf16 v[200:203], v[232:235], v[64:67], 0
ds_read_b128 v[228:231], v248 offset:57856
v_cvt_pk_bf16_f32 v162, v208, v209
v_mfma_f32_16x16x32_bf16 v[200:203], v[236:239], v[68:71], v[200:203]
v_exp_f32 v211, v211
v_mfma_f32_16x16x32_bf16 v[204:207], v[232:235], v[96:99], 0
v_exp_f32 v212, v212
v_mfma_f32_16x16x32_bf16 v[204:207], v[236:239], v[100:103], v[204:207]
s_waitcnt lgkmcnt(2)
v_cvt_pk_bf16_f32 v163, v210, v211
v_mfma_f32_16x16x32_bf16 v[192:195], v[240:243], v[8:11], v[192:195]
ds_read_b128 v[232:235], v248 offset:61440
v_mfma_f32_16x16x32_bf16 v[192:195], v[244:247], v[12:15], v[192:195]
v_exp_f32 v213, v213
v_mfma_f32_16x16x32_bf16 v[196:199], v[240:243], v[40:43], v[196:199]
v_exp_f32 v214, v214
v_mfma_f32_16x16x32_bf16 v[196:199], v[244:247], v[44:47], v[196:199]
v_exp_f32 v215, v215
v_mfma_f32_16x16x32_bf16 v[200:203], v[240:243], v[72:75], v[200:203]
ds_read_b128 v[236:239], v248 offset:61952
v_cvt_pk_bf16_f32 v166, v212, v213
v_mfma_f32_16x16x32_bf16 v[200:203], v[244:247], v[76:79], v[200:203]
v_cvt_pk_bf16_f32 v167, v214, v215
v_mfma_f32_16x16x32_bf16 v[204:207], v[240:243], v[104:107], v[204:207]
v_exp_f32 v216, v216
v_mfma_f32_16x16x32_bf16 v[204:207], v[244:247], v[108:111], v[204:207]
s_waitcnt lgkmcnt(2)
v_mfma_f32_16x16x32_bf16 v[192:195], v[224:227], v[16:19], v[192:195]
ds_read_b128 v[240:243], v248 offset:51200
v_mfma_f32_16x16x32_bf16 v[192:195], v[228:231], v[20:23], v[192:195]
v_exp_f32 v217, v217
v_mfma_f32_16x16x32_bf16 v[196:199], v[224:227], v[48:51], v[196:199]
v_exp_f32 v218, v218
v_mfma_f32_16x16x32_bf16 v[196:199], v[228:231], v[52:55], v[196:199]
v_exp_f32 v219, v219
v_mfma_f32_16x16x32_bf16 v[200:203], v[224:227], v[80:83], v[200:203]
ds_read_b128 v[244:247], v248 offset:51712
v_cvt_pk_bf16_f32 v170, v216, v217
v_mfma_f32_16x16x32_bf16 v[200:203], v[228:231], v[84:87], v[200:203]
v_cvt_pk_bf16_f32 v171, v218, v219
v_mfma_f32_16x16x32_bf16 v[204:207], v[224:227], v[112:115], v[204:207]
v_exp_f32 v220, v220
v_mfma_f32_16x16x32_bf16 v[204:207], v[228:231], v[116:119], v[204:207]
s_waitcnt lgkmcnt(2)
v_mfma_f32_16x16x32_bf16 v[192:195], v[232:235], v[24:27], v[192:195]
ds_read_b128 v[224:227], v248 offset:55296
v_mfma_f32_16x16x32_bf16 v[192:195], v[236:239], v[28:31], v[192:195]
v_exp_f32 v221, v221
v_mfma_f32_16x16x32_bf16 v[196:199], v[232:235], v[56:59], v[196:199]
v_exp_f32 v222, v222
v_mfma_f32_16x16x32_bf16 v[196:199], v[236:239], v[60:63], v[196:199]
v_exp_f32 v223, v223
v_mfma_f32_16x16x32_bf16 v[200:203], v[232:235], v[88:91], v[200:203]
ds_read_b128 v[228:231], v248 offset:55808
v_cvt_pk_bf16_f32 v174, v220, v221
v_mfma_f32_16x16x32_bf16 v[200:203], v[236:239], v[92:95], v[200:203]
v_cvt_pk_bf16_f32 v175, v222, v223
v_mfma_f32_16x16x32_bf16 v[204:207], v[232:235], v[120:123], v[204:207]
v_mfma_f32_16x16x32_bf16 v[204:207], v[236:239], v[124:127], v[204:207]
s_waitcnt lgkmcnt(2)
v_mfma_f32_16x16x32_bf16 v[208:211], v[240:243], v[0:3], 0
ds_read_b128 v[232:235], v248 offset:59392
v_mfma_f32_16x16x32_bf16 v[208:211], v[244:247], v[4:7], v[208:211]
v_exp_f32 v192, v192
v_mfma_f32_16x16x32_bf16 v[212:215], v[240:243], v[32:35], 0
v_exp_f32 v193, v193
v_mfma_f32_16x16x32_bf16 v[212:215], v[244:247], v[36:39], v[212:215]
v_exp_f32 v194, v194
v_mfma_f32_16x16x32_bf16 v[216:219], v[240:243], v[64:67], 0
ds_read_b128 v[236:239], v248 offset:59904
v_cvt_pk_bf16_f32 v176, v192, v193
v_mfma_f32_16x16x32_bf16 v[216:219], v[244:247], v[68:71], v[216:219]
v_exp_f32 v195, v195
v_mfma_f32_16x16x32_bf16 v[220:223], v[240:243], v[96:99], 0
v_exp_f32 v196, v196
v_mfma_f32_16x16x32_bf16 v[220:223], v[244:247], v[100:103], v[220:223]
s_waitcnt lgkmcnt(2)
v_cvt_pk_bf16_f32 v177, v194, v195
v_mfma_f32_16x16x32_bf16 v[208:211], v[224:227], v[8:11], v[208:211]
ds_read_b128 v[240:243], v248 offset:63488
v_mfma_f32_16x16x32_bf16 v[208:211], v[228:231], v[12:15], v[208:211]
v_exp_f32 v197, v197
v_mfma_f32_16x16x32_bf16 v[212:215], v[224:227], v[40:43], v[212:215]
v_exp_f32 v198, v198
v_mfma_f32_16x16x32_bf16 v[212:215], v[228:231], v[44:47], v[212:215]
v_exp_f32 v199, v199
v_mfma_f32_16x16x32_bf16 v[216:219], v[224:227], v[72:75], v[216:219]
ds_read_b128 v[244:247], v248 offset:64000
v_cvt_pk_bf16_f32 v180, v196, v197
v_mfma_f32_16x16x32_bf16 v[216:219], v[228:231], v[76:79], v[216:219]
v_cvt_pk_bf16_f32 v181, v198, v199
v_mfma_f32_16x16x32_bf16 v[220:223], v[224:227], v[104:107], v[220:223]
v_exp_f32 v200, v200
v_mfma_f32_16x16x32_bf16 v[220:223], v[228:231], v[108:111], v[220:223]
s_waitcnt lgkmcnt(2)
v_xor_b32 v248, 0x10000, v248
v_mfma_f32_16x16x32_bf16 v[208:211], v[232:235], v[16:19], v[208:211]
ds_read_b128 v[224:227], v248 offset:0
v_mfma_f32_16x16x32_bf16 v[208:211], v[236:239], v[20:23], v[208:211]
v_exp_f32 v201, v201
v_mfma_f32_16x16x32_bf16 v[212:215], v[232:235], v[48:51], v[212:215]
v_exp_f32 v202, v202
v_mfma_f32_16x16x32_bf16 v[212:215], v[236:239], v[52:55], v[212:215]
v_exp_f32 v203, v203
v_mfma_f32_16x16x32_bf16 v[216:219], v[232:235], v[80:83], v[216:219]
ds_read_b128 v[228:231], v248 offset:512
v_cvt_pk_bf16_f32 v184, v200, v201
v_mfma_f32_16x16x32_bf16 v[216:219], v[236:239], v[84:87], v[216:219]
v_cvt_pk_bf16_f32 v185, v202, v203
v_mfma_f32_16x16x32_bf16 v[220:223], v[232:235], v[112:115], v[220:223]
v_exp_f32 v204, v204
v_mfma_f32_16x16x32_bf16 v[220:223], v[236:239], v[116:119], v[220:223]
s_waitcnt lgkmcnt(2)
v_mfma_f32_16x16x32_bf16 v[208:211], v[240:243], v[24:27], v[208:211]
ds_read_b128 v[232:235], v248 offset:4096
v_mfma_f32_16x16x32_bf16 v[208:211], v[244:247], v[28:31], v[208:211]
v_exp_f32 v205, v205
v_mfma_f32_16x16x32_bf16 v[212:215], v[240:243], v[56:59], v[212:215]
v_exp_f32 v206, v206
v_mfma_f32_16x16x32_bf16 v[212:215], v[244:247], v[60:63], v[212:215]
v_exp_f32 v207, v207
v_mfma_f32_16x16x32_bf16 v[216:219], v[240:243], v[88:91], v[216:219]
ds_read_b128 v[236:239], v248 offset:4608
v_cvt_pk_bf16_f32 v188, v204, v205
v_mfma_f32_16x16x32_bf16 v[216:219], v[244:247], v[92:95], v[216:219]
v_cvt_pk_bf16_f32 v189, v206, v207
v_mfma_f32_16x16x32_bf16 v[220:223], v[240:243], v[120:123], v[220:223]
v_mfma_f32_16x16x32_bf16 v[220:223], v[244:247], v[124:127], v[220:223]
s_waitcnt lgkmcnt(2)
v_mfma_f32_16x16x32_bf16 v[192:195], v[224:227], v[0:3], 0
ds_read_b128 v[240:243], v248 offset:8192
v_mfma_f32_16x16x32_bf16 v[192:195], v[228:231], v[4:7], v[192:195]
v_exp_f32 v208, v208
v_mfma_f32_16x16x32_bf16 v[196:199], v[224:227], v[32:35], 0
v_exp_f32 v209, v209
v_mfma_f32_16x16x32_bf16 v[196:199], v[228:231], v[36:39], v[196:199]
v_exp_f32 v210, v210
v_mfma_f32_16x16x32_bf16 v[200:203], v[224:227], v[64:67], 0
ds_read_b128 v[244:247], v248 offset:8704
v_cvt_pk_bf16_f32 v178, v208, v209
v_mfma_f32_16x16x32_bf16 v[200:203], v[228:231], v[68:71], v[200:203]
v_exp_f32 v211, v211
v_mfma_f32_16x16x32_bf16 v[204:207], v[224:227], v[96:99], 0
v_exp_f32 v212, v212
v_mfma_f32_16x16x32_bf16 v[204:207], v[228:231], v[100:103], v[204:207]
s_waitcnt lgkmcnt(2)
v_cvt_pk_bf16_f32 v179, v210, v211
v_mfma_f32_16x16x32_bf16 v[192:195], v[232:235], v[8:11], v[192:195]
ds_read_b128 v[224:227], v248 offset:12288
v_mfma_f32_16x16x32_bf16 v[192:195], v[236:239], v[12:15], v[192:195]
v_exp_f32 v213, v213
v_mfma_f32_16x16x32_bf16 v[196:199], v[232:235], v[40:43], v[196:199]
v_exp_f32 v214, v214
v_mfma_f32_16x16x32_bf16 v[196:199], v[236:239], v[44:47], v[196:199]
v_exp_f32 v215, v215
v_mfma_f32_16x16x32_bf16 v[200:203], v[232:235], v[72:75], v[200:203]
ds_read_b128 v[228:231], v248 offset:12800
v_cvt_pk_bf16_f32 v182, v212, v213
v_mfma_f32_16x16x32_bf16 v[200:203], v[236:239], v[76:79], v[200:203]
v_cvt_pk_bf16_f32 v183, v214, v215
v_mfma_f32_16x16x32_bf16 v[204:207], v[232:235], v[104:107], v[204:207]
v_exp_f32 v216, v216
v_mfma_f32_16x16x32_bf16 v[204:207], v[236:239], v[108:111], v[204:207]
s_waitcnt lgkmcnt(2)
v_mfma_f32_16x16x32_bf16 v[192:195], v[240:243], v[16:19], v[192:195]
ds_read_b128 v[232:235], v248 offset:2048
v_mfma_f32_16x16x32_bf16 v[192:195], v[244:247], v[20:23], v[192:195]
v_exp_f32 v217, v217
v_mfma_f32_16x16x32_bf16 v[196:199], v[240:243], v[48:51], v[196:199]
v_exp_f32 v218, v218
v_mfma_f32_16x16x32_bf16 v[196:199], v[244:247], v[52:55], v[196:199]
v_exp_f32 v219, v219
v_mfma_f32_16x16x32_bf16 v[200:203], v[240:243], v[80:83], v[200:203]
ds_read_b128 v[236:239], v248 offset:2560
v_cvt_pk_bf16_f32 v186, v216, v217
v_mfma_f32_16x16x32_bf16 v[200:203], v[244:247], v[84:87], v[200:203]
v_cvt_pk_bf16_f32 v187, v218, v219
v_mfma_f32_16x16x32_bf16 v[204:207], v[240:243], v[112:115], v[204:207]
v_exp_f32 v220, v220
v_mfma_f32_16x16x32_bf16 v[204:207], v[244:247], v[116:119], v[204:207]
s_waitcnt lgkmcnt(2)
v_mfma_f32_16x16x32_bf16 v[192:195], v[224:227], v[24:27], v[192:195]
ds_read_b128 v[240:243], v248 offset:6144
v_mfma_f32_16x16x32_bf16 v[192:195], v[228:231], v[28:31], v[192:195]
v_exp_f32 v221, v221
v_mfma_f32_16x16x32_bf16 v[196:199], v[224:227], v[56:59], v[196:199]
v_exp_f32 v222, v222
v_mfma_f32_16x16x32_bf16 v[196:199], v[228:231], v[60:63], v[196:199]
v_exp_f32 v223, v223
v_mfma_f32_16x16x32_bf16 v[200:203], v[224:227], v[88:91], v[200:203]
ds_read_b128 v[244:247], v248 offset:6656
v_cvt_pk_bf16_f32 v190, v220, v221
v_mfma_f32_16x16x32_bf16 v[200:203], v[228:231], v[92:95], v[200:203]
v_cvt_pk_bf16_f32 v191, v222, v223
v_mfma_f32_16x16x32_bf16 v[204:207], v[224:227], v[120:123], v[204:207]
v_mfma_f32_16x16x32_bf16 v[204:207], v[228:231], v[124:127], v[204:207]
s_waitcnt lgkmcnt(2)
v_mfma_f32_16x16x32_bf16 v[208:211], v[232:235], v[0:3], 0
ds_read_b128 v[224:227], v248 offset:10240
v_mfma_f32_16x16x32_bf16 v[208:211], v[236:239], v[4:7], v[208:211]
v_exp_f32 v192, v192
v_mfma_f32_16x16x32_bf16 v[212:215], v[232:235], v[32:35], 0
v_exp_f32 v193, v193
v_mfma_f32_16x16x32_bf16 v[212:215], v[236:239], v[36:39], v[212:215]
v_exp_f32 v194, v194
v_mfma_f32_16x16x32_bf16 v[216:219], v[232:235], v[64:67], 0
ds_read_b128 v[228:231], v248 offset:10752
v_cvt_pk_bf16_f32 v0, v192, v193
v_mfma_f32_16x16x32_bf16 v[216:219], v[236:239], v[68:71], v[216:219]
v_exp_f32 v195, v195
v_mfma_f32_16x16x32_bf16 v[220:223], v[232:235], v[96:99], 0
v_exp_f32 v196, v196
v_mfma_f32_16x16x32_bf16 v[220:223], v[236:239], v[100:103], v[220:223]
s_waitcnt lgkmcnt(2)
v_cvt_pk_bf16_f32 v1, v194, v195
v_mfma_f32_16x16x32_bf16 v[208:211], v[240:243], v[8:11], v[208:211]
ds_read_b128 v[232:235], v248 offset:14336
v_mfma_f32_16x16x32_bf16 v[208:211], v[244:247], v[12:15], v[208:211]
v_exp_f32 v197, v197
v_mfma_f32_16x16x32_bf16 v[212:215], v[240:243], v[40:43], v[212:215]
ds_read_b128 v[4:7], v255 offset:0
ds_read_b128 v[36:39], v255 offset:1024
v_mfma_f32_16x16x32_bf16 v[212:215], v[244:247], v[44:47], v[212:215]
v_exp_f32 v198, v198
v_mfma_f32_16x16x32_bf16 v[216:219], v[240:243], v[72:75], v[216:219]
ds_read_b128 v[236:239], v248 offset:14848
v_xor_b32 v12, 0x10000, v249
v_mfma_f32_16x16x32_bf16 v[216:219], v[244:247], v[76:79], v[216:219]
v_xor_b32 v13, 0x10000, v250
v_cvt_pk_bf16_f32 v32, v196, v197
v_mfma_f32_16x16x32_bf16 v[220:223], v[240:243], v[104:107], v[220:223]
ds_read_b128 v[68:71], v255 offset:2048
ds_read_b128 v[100:103], v255 offset:3072
v_mfma_f32_16x16x32_bf16 v[220:223], v[244:247], v[108:111], v[220:223]
s_waitcnt lgkmcnt(6)
v_mfma_f32_16x16x32_bf16 v[208:211], v[224:227], v[16:19], v[208:211]
ds_read_b64_tr_b16 v[240:241], v12 offset:0
ds_read_b64_tr_b16 v[242:243], v12 offset:2048
v_mfma_f32_16x16x32_bf16 v[208:211], v[228:231], v[20:23], v[208:211]
v_exp_f32 v199, v199
v_mfma_f32_16x16x32_bf16 v[212:215], v[224:227], v[48:51], v[212:215]
ds_read_b128 v[8:11], v255 offset:4096
ds_read_b128 v[40:43], v255 offset:5120
v_mfma_f32_16x16x32_bf16 v[212:215], v[228:231], v[52:55], v[212:215]
v_cvt_pk_bf16_f32 v33, v198, v199
v_mfma_f32_16x16x32_bf16 v[216:219], v[224:227], v[80:83], v[216:219]
ds_read_b64_tr_b16 v[244:245], v12 offset:16384
ds_read_b64_tr_b16 v[246:247], v12 offset:18432
v_mfma_f32_16x16x32_bf16 v[216:219], v[228:231], v[84:87], v[216:219]
v_exp_f32 v200, v200
v_mfma_f32_16x16x32_bf16 v[220:223], v[224:227], v[112:115], v[220:223]
ds_read_b128 v[72:75], v255 offset:6144
ds_read_b128 v[104:107], v255 offset:7168
v_mfma_f32_16x16x32_bf16 v[220:223], v[228:231], v[116:119], v[220:223]
s_waitcnt lgkmcnt(10)
v_mfma_f32_16x16x32_bf16 v[208:211], v[232:235], v[24:27], v[208:211]
ds_read_b64_tr_b16 v[224:225], v12 offset:32768
ds_read_b64_tr_b16 v[226:227], v12 offset:34816
v_mfma_f32_16x16x32_bf16 v[208:211], v[236:239], v[28:31], v[208:211]
v_exp_f32 v201, v201
v_mfma_f32_16x16x32_bf16 v[212:215], v[232:235], v[56:59], v[212:215]
v_exp_f32 v202, v202
v_mfma_f32_16x16x32_bf16 v[212:215], v[236:239], v[60:63], v[212:215]
v_exp_f32 v203, v203
v_mfma_f32_16x16x32_bf16 v[216:219], v[232:235], v[88:91], v[216:219]
ds_read_b64_tr_b16 v[228:229], v12 offset:49152
ds_read_b64_tr_b16 v[230:231], v12 offset:51200
v_mfma_f32_16x16x32_bf16 v[216:219], v[236:239], v[92:95], v[216:219]
v_cvt_pk_bf16_f32 v64, v200, v201
v_cvt_pk_bf16_f32 v65, v202, v203
v_mfma_f32_16x16x32_bf16 v[220:223], v[232:235], v[120:123], v[220:223]
v_exp_f32 v204, v204
v_mfma_f32_16x16x32_bf16 v[220:223], v[236:239], v[124:127], v[220:223]
s_waitcnt lgkmcnt(6)
s_waitcnt lgkmcnt(4)
v_mfma_f32_16x16x32_bf16 a[0:3], v[240:243], v[128:131], a[0:3]
ds_read_b64_tr_b16 v[232:233], v13 offset:0
ds_read_b64_tr_b16 v[234:235], v13 offset:2048
v_mfma_f32_16x16x32_bf16 a[0:3], v[244:247], v[144:147], a[0:3]
v_exp_f32 v205, v205
v_mfma_f32_16x16x32_bf16 a[4:7], v[240:243], v[132:135], a[4:7]
v_exp_f32 v206, v206
v_mfma_f32_16x16x32_bf16 a[4:7], v[244:247], v[148:151], a[4:7]
v_exp_f32 v207, v207
v_mfma_f32_16x16x32_bf16 a[8:11], v[240:243], v[136:139], a[8:11]
ds_read_b64_tr_b16 v[236:237], v13 offset:16384
ds_read_b64_tr_b16 v[238:239], v13 offset:18432
v_mfma_f32_16x16x32_bf16 a[8:11], v[244:247], v[152:155], a[8:11]
v_cvt_pk_bf16_f32 v96, v204, v205
v_cvt_pk_bf16_f32 v97, v206, v207
v_mfma_f32_16x16x32_bf16 a[12:15], v[240:243], v[140:143], a[12:15]
v_exp_f32 v208, v208
v_mfma_f32_16x16x32_bf16 a[12:15], v[244:247], v[156:159], a[12:15]
s_waitcnt lgkmcnt(4)
v_mfma_f32_16x16x32_bf16 a[0:3], v[224:227], v[160:163], a[0:3]
ds_read_b64_tr_b16 v[240:241], v13 offset:32768
ds_read_b64_tr_b16 v[242:243], v13 offset:34816
v_mfma_f32_16x16x32_bf16 a[0:3], v[228:231], v[176:179], a[0:3]
v_exp_f32 v209, v209
v_mfma_f32_16x16x32_bf16 a[4:7], v[224:227], v[164:167], a[4:7]
v_exp_f32 v210, v210
v_mfma_f32_16x16x32_bf16 a[4:7], v[228:231], v[180:183], a[4:7]
v_exp_f32 v211, v211
v_mfma_f32_16x16x32_bf16 a[8:11], v[224:227], v[168:171], a[8:11]
ds_read_b64_tr_b16 v[244:245], v13 offset:49152
ds_read_b64_tr_b16 v[246:247], v13 offset:51200
v_mfma_f32_16x16x32_bf16 a[8:11], v[228:231], v[184:187], a[8:11]
v_cvt_pk_bf16_f32 v2, v208, v209
v_cvt_pk_bf16_f32 v3, v210, v211
v_mfma_f32_16x16x32_bf16 a[12:15], v[224:227], v[172:175], a[12:15]
v_exp_f32 v212, v212
v_mfma_f32_16x16x32_bf16 a[12:15], v[228:231], v[188:191], a[12:15]
s_waitcnt lgkmcnt(4)
v_mfma_f32_16x16x32_bf16 a[16:19], v[232:235], v[128:131], a[16:19]
ds_read_b64_tr_b16 v[224:225], v249 offset:33280
ds_read_b64_tr_b16 v[226:227], v249 offset:35328
v_mfma_f32_16x16x32_bf16 a[16:19], v[236:239], v[144:147], a[16:19]
v_exp_f32 v213, v213
v_mfma_f32_16x16x32_bf16 a[20:23], v[232:235], v[132:135], a[20:23]
v_exp_f32 v214, v214
v_mfma_f32_16x16x32_bf16 a[20:23], v[236:239], v[148:151], a[20:23]
v_exp_f32 v215, v215
v_mfma_f32_16x16x32_bf16 a[24:27], v[232:235], v[136:139], a[24:27]
ds_read_b64_tr_b16 v[228:229], v249 offset:49664
ds_read_b64_tr_b16 v[230:231], v249 offset:51712
v_mfma_f32_16x16x32_bf16 a[24:27], v[236:239], v[152:155], a[24:27]
v_cvt_pk_bf16_f32 v34, v212, v213
v_cvt_pk_bf16_f32 v35, v214, v215
v_mfma_f32_16x16x32_bf16 a[28:31], v[232:235], v[140:143], a[28:31]
v_exp_f32 v216, v216
v_mfma_f32_16x16x32_bf16 a[28:31], v[236:239], v[156:159], a[28:31]
s_waitcnt lgkmcnt(4)
v_mfma_f32_16x16x32_bf16 a[16:19], v[240:243], v[160:163], a[16:19]
ds_read_b64_tr_b16 v[232:233], v249 offset:0
ds_read_b64_tr_b16 v[234:235], v249 offset:2048
v_mfma_f32_16x16x32_bf16 a[16:19], v[244:247], v[176:179], a[16:19]
v_exp_f32 v217, v217
v_mfma_f32_16x16x32_bf16 a[20:23], v[240:243], v[164:167], a[20:23]
v_exp_f32 v218, v218
v_mfma_f32_16x16x32_bf16 a[20:23], v[244:247], v[180:183], a[20:23]
v_exp_f32 v219, v219
v_mfma_f32_16x16x32_bf16 a[24:27], v[240:243], v[168:171], a[24:27]
ds_read_b64_tr_b16 v[236:237], v250 offset:0
ds_read_b64_tr_b16 v[238:239], v250 offset:2048
v_mfma_f32_16x16x32_bf16 a[24:27], v[244:247], v[184:187], a[24:27]
v_cvt_pk_bf16_f32 v66, v216, v217
v_cvt_pk_bf16_f32 v67, v218, v219
v_mfma_f32_16x16x32_bf16 a[28:31], v[240:243], v[172:175], a[28:31]
v_exp_f32 v220, v220
v_mfma_f32_16x16x32_bf16 a[28:31], v[244:247], v[188:191], a[28:31]
s_waitcnt lgkmcnt(4)
v_mfma_f32_16x16x32_bf16 a[32:35], v[224:227], v[4:7], a[32:35]
ds_read_b64_tr_b16 v[240:241], v12 offset:512
ds_read_b64_tr_b16 v[242:243], v12 offset:2560
v_mfma_f32_16x16x32_bf16 a[32:35], v[228:231], v[8:11], a[32:35]
v_exp_f32 v221, v221
v_mfma_f32_16x16x32_bf16 a[36:39], v[224:227], v[36:39], a[36:39]
v_exp_f32 v222, v222
v_mfma_f32_16x16x32_bf16 a[36:39], v[228:231], v[40:43], a[36:39]
v_exp_f32 v223, v223
v_mfma_f32_16x16x32_bf16 a[40:43], v[224:227], v[68:71], a[40:43]
ds_read_b64_tr_b16 v[244:245], v12 offset:16896
ds_read_b64_tr_b16 v[246:247], v12 offset:18944
v_mfma_f32_16x16x32_bf16 a[40:43], v[228:231], v[72:75], a[40:43]
v_cvt_pk_bf16_f32 v98, v220, v221
v_cvt_pk_bf16_f32 v99, v222, v223
v_mfma_f32_16x16x32_bf16 a[44:47], v[224:227], v[100:103], a[44:47]
v_mfma_f32_16x16x32_bf16 a[44:47], v[228:231], v[104:107], a[44:47]
s_waitcnt lgkmcnt(4)
v_mfma_f32_16x16x32_bf16 a[0:3], v[232:235], v[0:3], a[0:3]
ds_read_b64_tr_b16 v[224:225], v12 offset:33280
ds_read_b64_tr_b16 v[226:227], v12 offset:35328
v_mfma_f32_16x16x32_bf16 a[4:7], v[232:235], v[32:35], a[4:7]
v_mfma_f32_16x16x32_bf16 a[8:11], v[232:235], v[64:67], a[8:11]
v_mfma_f32_16x16x32_bf16 a[12:15], v[232:235], v[96:99], a[12:15]
v_mfma_f32_16x16x32_bf16 a[16:19], v[236:239], v[0:3], a[16:19]
ds_read_b64_tr_b16 v[228:229], v12 offset:49664
ds_read_b64_tr_b16 v[230:231], v12 offset:51712
v_mfma_f32_16x16x32_bf16 a[20:23], v[236:239], v[32:35], a[20:23]
v_mfma_f32_16x16x32_bf16 a[24:27], v[236:239], v[64:67], a[24:27]
v_mfma_f32_16x16x32_bf16 a[28:31], v[236:239], v[96:99], a[28:31]
s_waitcnt lgkmcnt(4)
v_mfma_f32_16x16x32_bf16 a[32:35], v[240:243], v[128:131], a[32:35]
ds_read_b64_tr_b16 v[232:233], v249 offset:512
ds_read_b64_tr_b16 v[234:235], v249 offset:2560
v_mfma_f32_16x16x32_bf16 a[32:35], v[244:247], v[144:147], a[32:35]
v_mfma_f32_16x16x32_bf16 a[36:39], v[240:243], v[132:135], a[36:39]
v_mfma_f32_16x16x32_bf16 a[36:39], v[244:247], v[148:151], a[36:39]
v_mfma_f32_16x16x32_bf16 a[40:43], v[240:243], v[136:139], a[40:43]
ds_read_b64_tr_b16 v[236:237], v250 offset:512
ds_read_b64_tr_b16 v[238:239], v250 offset:2560
v_accvgpr_read_b32 v192, a0
v_mfma_f32_16x16x32_bf16 a[40:43], v[244:247], v[152:155], a[40:43]
v_accvgpr_read_b32 v193, a4
v_accvgpr_read_b32 v194, a8
v_accvgpr_read_b32 v195, a12
v_mfma_f32_16x16x32_bf16 a[44:47], v[240:243], v[140:143], a[44:47]
v_lshlrev_b32 v253, 2, v252
v_subrev_u32 v196, 0x0d800000, v192
v_subrev_u32 v197, 0x0d800000, v193
v_mfma_f32_16x16x32_bf16 a[44:47], v[244:247], v[156:159], a[44:47]
s_waitcnt lgkmcnt(4)
v_subrev_u32 v198, 0x0d800000, v194
v_subrev_u32 v199, 0x0d800000, v195
v_mfma_f32_16x16x32_bf16 a[32:35], v[224:227], v[160:163], a[32:35]
ds_read_b64_tr_b16 v[240:241], v250 offset:33280
ds_read_b64_tr_b16 v[242:243], v250 offset:35328
v_max3_u32 v254, v196, v197, v198
v_mfma_f32_16x16x32_bf16 a[32:35], v[228:231], v[176:179], a[32:35]
v_max_u32 v254, v254, v199
v_mfma_f32_16x16x32_bf16 a[36:39], v[224:227], v[164:167], a[36:39]
s_mov_b64 exec, 0xffff
s_xor_b32 s35, s48, 0
buffer_store_dword v192, v253, s[24:27], s35 offen offset:4 sc1
s_xor_b32 s35, s48, 1024
buffer_store_dword v193, v253, s[24:27], s35 offen offset:4 sc1
s_xor_b32 s35, s48, 2048
buffer_store_dword v194, v253, s[24:27], s35 offen offset:4 sc1
s_xor_b32 s35, s48, 3072
buffer_store_dword v195, v253, s[24:27], s35 offen offset:4 sc1
v_cmp_le_u32 vcc, 0x64000000, v254
s_mov_b64 exec, -1
v_mfma_f32_16x16x32_bf16 a[36:39], v[228:231], v[180:183], a[36:39]
v_accvgpr_read_b32 v192, a0
v_accvgpr_read_b32 v193, a1
v_mfma_f32_16x16x32_bf16 a[40:43], v[224:227], v[168:171], a[40:43]
ds_read_b64_tr_b16 v[244:245], v250 offset:49664
ds_read_b64_tr_b16 v[246:247], v250 offset:51712
v_mfma_f32_16x16x32_bf16 a[40:43], v[228:231], v[184:187], a[40:43]
v_accvgpr_read_b32 v194, a2
v_accvgpr_read_b32 v195, a3
v_mfma_f32_16x16x32_bf16 a[44:47], v[224:227], v[172:175], a[44:47]
v_cvt_pk_bf16_f32 v16, v192, v193
v_cvt_pk_bf16_f32 v17, v194, v195
v_mfma_f32_16x16x32_bf16 a[44:47], v[228:231], v[188:191], a[44:47]
s_waitcnt lgkmcnt(4)
v_accvgpr_read_b32 v200, a4
v_mfma_f32_16x16x32_bf16 a[32:35], v[232:235], v[0:3], a[32:35]
ds_read_b64_tr_b16 v[224:225], v13 offset:512
ds_read_b64_tr_b16 v[226:227], v13 offset:2560
v_mfma_f32_16x16x32_bf16 a[36:39], v[232:235], v[32:35], a[36:39]
v_accvgpr_read_b32 v201, a5
v_accvgpr_read_b32 v202, a6
v_mfma_f32_16x16x32_bf16 a[40:43], v[232:235], v[64:67], a[40:43]
v_accvgpr_read_b32 v203, a7
v_cvt_pk_bf16_f32 v48, v200, v201
v_mfma_f32_16x16x32_bf16 a[44:47], v[232:235], v[96:99], a[44:47]
v_cvt_pk_bf16_f32 v49, v202, v203
v_accvgpr_read_b32 v208, a8
v_mfma_f32_16x16x32_bf16 a[48:51], v[236:239], v[0:3], a[48:51]
ds_read_b64_tr_b16 v[228:229], v13 offset:16896
ds_read_b64_tr_b16 v[230:231], v13 offset:18944
v_mfma_f32_16x16x32_bf16 a[52:55], v[236:239], v[32:35], a[52:55]
v_accvgpr_read_b32 v209, a9
v_accvgpr_read_b32 v210, a10
v_mfma_f32_16x16x32_bf16 a[56:59], v[236:239], v[64:67], a[56:59]
v_accvgpr_read_b32 v211, a11
v_cvt_pk_bf16_f32 v80, v208, v209
v_mfma_f32_16x16x32_bf16 a[60:63], v[236:239], v[96:99], a[60:63]
s_waitcnt lgkmcnt(4)
v_cvt_pk_bf16_f32 v81, v210, v211
v_mfma_f32_16x16x32_bf16 a[48:51], v[240:243], v[4:7], a[48:51]
ds_read_b64_tr_b16 v[232:233], v13 offset:33280
ds_read_b64_tr_b16 v[234:235], v13 offset:35328
v_mfma_f32_16x16x32_bf16 a[48:51], v[244:247], v[8:11], a[48:51]
v_accvgpr_read_b32 v216, a12
v_accvgpr_read_b32 v217, a13
v_mfma_f32_16x16x32_bf16 a[52:55], v[240:243], v[36:39], a[52:55]
v_accvgpr_read_b32 v218, a14
v_accvgpr_read_b32 v219, a15
v_mfma_f32_16x16x32_bf16 a[52:55], v[244:247], v[40:43], a[52:55]
v_cvt_pk_bf16_f32 v112, v216, v217
v_cvt_pk_bf16_f32 v113, v218, v219
v_mfma_f32_16x16x32_bf16 a[56:59], v[240:243], v[68:71], a[56:59]
ds_read_b64_tr_b16 v[236:237], v13 offset:49664
ds_read_b64_tr_b16 v[238:239], v13 offset:51712
v_mfma_f32_16x16x32_bf16 a[56:59], v[244:247], v[72:75], a[56:59]
v_accvgpr_read_b32 v196, a16
v_accvgpr_read_b32 v197, a17
v_mfma_f32_16x16x32_bf16 a[60:63], v[240:243], v[100:103], a[60:63]
v_accvgpr_read_b32 v198, a18
v_accvgpr_read_b32 v199, a19
v_mfma_f32_16x16x32_bf16 a[60:63], v[244:247], v[104:107], a[60:63]
s_waitcnt lgkmcnt(4)
v_cvt_pk_bf16_f32 v18, v196, v197
v_mfma_f32_16x16x32_bf16 a[48:51], v[224:227], v[128:131], a[48:51]
ds_read_b64_tr_b16 v[240:241], v249 offset:36864
ds_read_b64_tr_b16 v[242:243], v249 offset:38912
v_mfma_f32_16x16x32_bf16 a[48:51], v[228:231], v[144:147], a[48:51]
v_cvt_pk_bf16_f32 v19, v198, v199
buffer_store_dwordx4 v[16:19], v252, s[20:23], s40 offen offset:0 sc1
v_mfma_f32_16x16x32_bf16 a[52:55], v[224:227], v[132:135], a[52:55]
v_accvgpr_read_b32 v204, a20
v_accvgpr_read_b32 v205, a21
v_mfma_f32_16x16x32_bf16 a[52:55], v[228:231], v[148:151], a[52:55]
v_accvgpr_read_b32 v206, a22
v_accvgpr_read_b32 v207, a23
v_mfma_f32_16x16x32_bf16 a[56:59], v[224:227], v[136:139], a[56:59]
ds_read_b64_tr_b16 v[244:245], v249 offset:53248
ds_read_b64_tr_b16 v[246:247], v249 offset:55296
v_mfma_f32_16x16x32_bf16 a[56:59], v[228:231], v[152:155], a[56:59]
v_cvt_pk_bf16_f32 v50, v204, v205
v_cvt_pk_bf16_f32 v51, v206, v207
v_mfma_f32_16x16x32_bf16 a[60:63], v[224:227], v[140:143], a[60:63]
buffer_store_dwordx4 v[48:51], v252, s[20:23], s41 offen offset:0 sc1
v_accvgpr_read_b32 v212, a24
v_mfma_f32_16x16x32_bf16 a[60:63], v[228:231], v[156:159], a[60:63]
s_waitcnt lgkmcnt(4)
v_accvgpr_read_b32 v213, a25
v_mfma_f32_16x16x32_bf16 a[48:51], v[232:235], v[160:163], a[48:51]
ds_read_b64_tr_b16 v[224:225], v12 offset:4096
ds_read_b64_tr_b16 v[226:227], v12 offset:6144
v_mfma_f32_16x16x32_bf16 a[48:51], v[236:239], v[176:179], a[48:51]
v_accvgpr_read_b32 v214, a26
v_accvgpr_read_b32 v215, a27
v_mfma_f32_16x16x32_bf16 a[52:55], v[232:235], v[164:167], a[52:55]
v_cvt_pk_bf16_f32 v82, v212, v213
v_cvt_pk_bf16_f32 v83, v214, v215
v_mfma_f32_16x16x32_bf16 a[52:55], v[236:239], v[180:183], a[52:55]
buffer_store_dwordx4 v[80:83], v252, s[20:23], s42 offen offset:0 sc1
v_accvgpr_read_b32 v220, a28
v_mfma_f32_16x16x32_bf16 a[56:59], v[232:235], v[168:171], a[56:59]
ds_read_b64_tr_b16 v[228:229], v12 offset:20480
ds_read_b64_tr_b16 v[230:231], v12 offset:22528
v_mfma_f32_16x16x32_bf16 a[56:59], v[236:239], v[184:187], a[56:59]
v_accvgpr_read_b32 v221, a29
v_accvgpr_read_b32 v222, a30
v_mfma_f32_16x16x32_bf16 a[60:63], v[232:235], v[172:175], a[60:63]
v_accvgpr_read_b32 v223, a31
v_cvt_pk_bf16_f32 v114, v220, v221
v_mfma_f32_16x16x32_bf16 a[60:63], v[236:239], v[188:191], a[60:63]
s_waitcnt lgkmcnt(4)
v_cvt_pk_bf16_f32 v115, v222, v223
v_mfma_f32_16x16x32_bf16 a[64:67], v[240:243], v[4:7], a[64:67]
ds_read_b64_tr_b16 v[232:233], v12 offset:36864
ds_read_b64_tr_b16 v[234:235], v12 offset:38912
v_mfma_f32_16x16x32_bf16 a[64:67], v[244:247], v[8:11], a[64:67]
buffer_store_dwordx4 v[112:115], v252, s[20:23], s43 offen offset:0 sc1
v_accvgpr_read_b32 v192, a32
v_mfma_f32_16x16x32_bf16 a[68:71], v[240:243], v[36:39], a[68:71]
v_accvgpr_read_b32 v193, a33
v_accvgpr_read_b32 v194, a34
v_mfma_f32_16x16x32_bf16 a[68:71], v[244:247], v[40:43], a[68:71]
v_accvgpr_read_b32 v195, a35
v_cvt_pk_bf16_f32 v20, v192, v193
v_mfma_f32_16x16x32_bf16 a[72:75], v[240:243], v[68:71], a[72:75]
ds_read_b64_tr_b16 v[236:237], v12 offset:53248
ds_read_b64_tr_b16 v[238:239], v12 offset:55296
v_mfma_f32_16x16x32_bf16 a[72:75], v[244:247], v[72:75], a[72:75]
v_cvt_pk_bf16_f32 v21, v194, v195
v_accvgpr_read_b32 v200, a36
v_mfma_f32_16x16x32_bf16 a[76:79], v[240:243], v[100:103], a[76:79]
v_accvgpr_read_b32 v201, a37
v_accvgpr_read_b32 v202, a38
v_mfma_f32_16x16x32_bf16 a[76:79], v[244:247], v[104:107], a[76:79]
s_waitcnt lgkmcnt(4)
v_accvgpr_read_b32 v203, a39
v_mfma_f32_16x16x32_bf16 a[64:67], v[224:227], v[128:131], a[64:67]
ds_read_b64_tr_b16 v[240:241], v249 offset:4096
ds_read_b64_tr_b16 v[242:243], v249 offset:6144
v_mfma_f32_16x16x32_bf16 a[64:67], v[228:231], v[144:147], a[64:67]
v_cvt_pk_bf16_f32 v52, v200, v201
v_cvt_pk_bf16_f32 v53, v202, v203
v_mfma_f32_16x16x32_bf16 a[68:71], v[224:227], v[132:135], a[68:71]
v_accvgpr_read_b32 v208, a40
v_accvgpr_read_b32 v209, a41
v_mfma_f32_16x16x32_bf16 a[68:71], v[228:231], v[148:151], a[68:71]
v_accvgpr_read_b32 v210, a42
v_accvgpr_read_b32 v211, a43
v_mfma_f32_16x16x32_bf16 a[72:75], v[224:227], v[136:139], a[72:75]
ds_read_b64_tr_b16 v[244:245], v250 offset:4096
ds_read_b64_tr_b16 v[246:247], v250 offset:6144
v_mfma_f32_16x16x32_bf16 a[72:75], v[228:231], v[152:155], a[72:75]
v_cvt_pk_bf16_f32 v84, v208, v209
v_cvt_pk_bf16_f32 v85, v210, v211
v_mfma_f32_16x16x32_bf16 a[76:79], v[224:227], v[140:143], a[76:79]
v_accvgpr_read_b32 v216, a44
v_accvgpr_read_b32 v217, a45
v_mfma_f32_16x16x32_bf16 a[76:79], v[228:231], v[156:159], a[76:79]
s_waitcnt lgkmcnt(4)
v_accvgpr_read_b32 v218, a46
v_mfma_f32_16x16x32_bf16 a[64:67], v[232:235], v[160:163], a[64:67]
ds_read_b64_tr_b16 v[224:225], v250 offset:36864
ds_read_b64_tr_b16 v[226:227], v250 offset:38912
v_mfma_f32_16x16x32_bf16 a[64:67], v[236:239], v[176:179], a[64:67]
v_accvgpr_read_b32 v219, a47
v_cvt_pk_bf16_f32 v116, v216, v217
v_mfma_f32_16x16x32_bf16 a[68:71], v[232:235], v[164:167], a[68:71]
v_cvt_pk_bf16_f32 v117, v218, v219
v_accvgpr_read_b32 v196, a48
v_mfma_f32_16x16x32_bf16 a[68:71], v[236:239], v[180:183], a[68:71]
v_accvgpr_read_b32 v197, a49
v_accvgpr_read_b32 v198, a50
v_mfma_f32_16x16x32_bf16 a[72:75], v[232:235], v[168:171], a[72:75]
ds_read_b64_tr_b16 v[228:229], v250 offset:53248
ds_read_b64_tr_b16 v[230:231], v250 offset:55296
v_mfma_f32_16x16x32_bf16 a[72:75], v[236:239], v[184:187], a[72:75]
v_accvgpr_read_b32 v199, a51
v_cvt_pk_bf16_f32 v22, v196, v197
v_mfma_f32_16x16x32_bf16 a[76:79], v[232:235], v[172:175], a[76:79]
v_cvt_pk_bf16_f32 v23, v198, v199
buffer_store_dwordx4 v[20:23], v252, s[20:23], s40 offen offset:1024 sc1
v_mfma_f32_16x16x32_bf16 a[76:79], v[236:239], v[188:191], a[76:79]
s_waitcnt lgkmcnt(4)
v_accvgpr_read_b32 v204, a52
v_mfma_f32_16x16x32_bf16 a[64:67], v[240:243], v[0:3], a[64:67]
ds_read_b64_tr_b16 v[232:233], v13 offset:4096
ds_read_b64_tr_b16 v[234:235], v13 offset:6144
v_mfma_f32_16x16x32_bf16 a[68:71], v[240:243], v[32:35], a[68:71]
v_accvgpr_read_b32 v205, a53
v_accvgpr_read_b32 v206, a54
v_mfma_f32_16x16x32_bf16 a[72:75], v[240:243], v[64:67], a[72:75]
v_accvgpr_read_b32 v207, a55
v_cvt_pk_bf16_f32 v54, v204, v205
v_mfma_f32_16x16x32_bf16 a[76:79], v[240:243], v[96:99], a[76:79]
v_cvt_pk_bf16_f32 v55, v206, v207
buffer_store_dwordx4 v[52:55], v252, s[20:23], s41 offen offset:1024 sc1
v_mfma_f32_16x16x32_bf16 a[80:83], v[244:247], v[0:3], a[80:83]
ds_read_b64_tr_b16 v[236:237], v13 offset:20480
ds_read_b64_tr_b16 v[238:239], v13 offset:22528
v_mfma_f32_16x16x32_bf16 a[84:87], v[244:247], v[32:35], a[84:87]
v_accvgpr_read_b32 v212, a56
v_accvgpr_read_b32 v213, a57
v_mfma_f32_16x16x32_bf16 a[88:91], v[244:247], v[64:67], a[88:91]
v_accvgpr_read_b32 v214, a58
v_accvgpr_read_b32 v215, a59
v_mfma_f32_16x16x32_bf16 a[92:95], v[244:247], v[96:99], a[92:95]
s_waitcnt lgkmcnt(4)
v_cvt_pk_bf16_f32 v86, v212, v213
v_mfma_f32_16x16x32_bf16 a[80:83], v[224:227], v[4:7], a[80:83]
ds_read_b64_tr_b16 v[240:241], v13 offset:36864
ds_read_b64_tr_b16 v[242:243], v13 offset:38912
v_mfma_f32_16x16x32_bf16 a[80:83], v[228:231], v[8:11], a[80:83]
v_cvt_pk_bf16_f32 v87, v214, v215
buffer_store_dwordx4 v[84:87], v252, s[20:23], s42 offen offset:1024 sc1
v_mfma_f32_16x16x32_bf16 a[84:87], v[224:227], v[36:39], a[84:87]
v_accvgpr_read_b32 v220, a60
v_accvgpr_read_b32 v221, a61
v_mfma_f32_16x16x32_bf16 a[84:87], v[228:231], v[40:43], a[84:87]
v_accvgpr_read_b32 v222, a62
v_accvgpr_read_b32 v223, a63
v_mfma_f32_16x16x32_bf16 a[88:91], v[224:227], v[68:71], a[88:91]
ds_read_b64_tr_b16 v[244:245], v13 offset:53248
ds_read_b64_tr_b16 v[246:247], v13 offset:55296
v_mfma_f32_16x16x32_bf16 a[88:91], v[228:231], v[72:75], a[88:91]
v_cvt_pk_bf16_f32 v118, v220, v221
v_cvt_pk_bf16_f32 v119, v222, v223
v_mfma_f32_16x16x32_bf16 a[92:95], v[224:227], v[100:103], a[92:95]
buffer_store_dwordx4 v[116:119], v252, s[20:23], s43 offen offset:1024 sc1
v_accvgpr_read_b32 v192, a64
v_mfma_f32_16x16x32_bf16 a[92:95], v[228:231], v[104:107], a[92:95]
s_waitcnt lgkmcnt(4)
v_accvgpr_read_b32 v193, a65
v_mfma_f32_16x16x32_bf16 a[80:83], v[232:235], v[128:131], a[80:83]
ds_read_b64_tr_b16 v[224:225], v249 offset:37376
ds_read_b64_tr_b16 v[226:227], v249 offset:39424
v_mfma_f32_16x16x32_bf16 a[80:83], v[236:239], v[144:147], a[80:83]
v_accvgpr_read_b32 v194, a66
v_accvgpr_read_b32 v195, a67
v_mfma_f32_16x16x32_bf16 a[84:87], v[232:235], v[132:135], a[84:87]
v_cvt_pk_bf16_f32 v24, v192, v193
v_cvt_pk_bf16_f32 v25, v194, v195
v_mfma_f32_16x16x32_bf16 a[84:87], v[236:239], v[148:151], a[84:87]
v_accvgpr_read_b32 v200, a68
v_accvgpr_read_b32 v201, a69
v_mfma_f32_16x16x32_bf16 a[88:91], v[232:235], v[136:139], a[88:91]
ds_read_b64_tr_b16 v[228:229], v249 offset:53760
ds_read_b64_tr_b16 v[230:231], v249 offset:55808
v_mfma_f32_16x16x32_bf16 a[88:91], v[236:239], v[152:155], a[88:91]
v_accvgpr_read_b32 v202, a70
v_accvgpr_read_b32 v203, a71
v_mfma_f32_16x16x32_bf16 a[92:95], v[232:235], v[140:143], a[92:95]
v_cvt_pk_bf16_f32 v56, v200, v201
v_cvt_pk_bf16_f32 v57, v202, v203
v_mfma_f32_16x16x32_bf16 a[92:95], v[236:239], v[156:159], a[92:95]
s_waitcnt lgkmcnt(4)
v_accvgpr_read_b32 v208, a72
v_mfma_f32_16x16x32_bf16 a[80:83], v[240:243], v[160:163], a[80:83]
ds_read_b64_tr_b16 v[232:233], v12 offset:4608
ds_read_b64_tr_b16 v[234:235], v12 offset:6656
v_mfma_f32_16x16x32_bf16 a[80:83], v[244:247], v[176:179], a[80:83]
v_accvgpr_read_b32 v209, a73
v_accvgpr_read_b32 v210, a74
v_mfma_f32_16x16x32_bf16 a[84:87], v[240:243], v[164:167], a[84:87]
v_accvgpr_read_b32 v211, a75
v_cvt_pk_bf16_f32 v88, v208, v209
v_mfma_f32_16x16x32_bf16 a[84:87], v[244:247], v[180:183], a[84:87]
v_cvt_pk_bf16_f32 v89, v210, v211
v_accvgpr_read_b32 v216, a76
v_mfma_f32_16x16x32_bf16 a[88:91], v[240:243], v[168:171], a[88:91]
ds_read_b64_tr_b16 v[236:237], v12 offset:20992
ds_read_b64_tr_b16 v[238:239], v12 offset:23040
v_mfma_f32_16x16x32_bf16 a[88:91], v[244:247], v[184:187], a[88:91]
v_accvgpr_read_b32 v217, a77
v_accvgpr_read_b32 v218, a78
v_mfma_f32_16x16x32_bf16 a[92:95], v[240:243], v[172:175], a[92:95]
v_accvgpr_read_b32 v219, a79
v_cvt_pk_bf16_f32 v120, v216, v217
v_mfma_f32_16x16x32_bf16 a[92:95], v[244:247], v[188:191], a[92:95]
s_waitcnt lgkmcnt(4)
v_cvt_pk_bf16_f32 v121, v218, v219
v_mfma_f32_16x16x32_bf16 a[96:99], v[224:227], v[4:7], a[96:99]
ds_read_b64_tr_b16 v[240:241], v12 offset:37376
ds_read_b64_tr_b16 v[242:243], v12 offset:39424
v_mfma_f32_16x16x32_bf16 a[96:99], v[228:231], v[8:11], a[96:99]
v_accvgpr_read_b32 v196, a80
v_accvgpr_read_b32 v197, a81
v_mfma_f32_16x16x32_bf16 a[100:103], v[224:227], v[36:39], a[100:103]
v_accvgpr_read_b32 v198, a82
v_accvgpr_read_b32 v199, a83
v_mfma_f32_16x16x32_bf16 a[100:103], v[228:231], v[40:43], a[100:103]
v_cvt_pk_bf16_f32 v26, v196, v197
v_cvt_pk_bf16_f32 v27, v198, v199
v_mfma_f32_16x16x32_bf16 a[104:107], v[224:227], v[68:71], a[104:107]
ds_read_b64_tr_b16 v[244:245], v12 offset:53760
ds_read_b64_tr_b16 v[246:247], v12 offset:55808
v_mfma_f32_16x16x32_bf16 a[104:107], v[228:231], v[72:75], a[104:107]
buffer_store_dwordx4 v[24:27], v252, s[20:23], s40 offen offset:2048 sc1
v_accvgpr_read_b32 v204, a84
v_mfma_f32_16x16x32_bf16 a[108:111], v[224:227], v[100:103], a[108:111]
v_accvgpr_read_b32 v205, a85
v_accvgpr_read_b32 v206, a86
v_mfma_f32_16x16x32_bf16 a[108:111], v[228:231], v[104:107], a[108:111]
s_waitcnt lgkmcnt(4)
v_accvgpr_read_b32 v207, a87
v_mfma_f32_16x16x32_bf16 a[96:99], v[232:235], v[128:131], a[96:99]
ds_read_b64_tr_b16 v[224:225], v249 offset:4608
ds_read_b64_tr_b16 v[226:227], v249 offset:6656
v_mfma_f32_16x16x32_bf16 a[96:99], v[236:239], v[144:147], a[96:99]
v_cvt_pk_bf16_f32 v58, v204, v205
v_cvt_pk_bf16_f32 v59, v206, v207
v_mfma_f32_16x16x32_bf16 a[100:103], v[232:235], v[132:135], a[100:103]
buffer_store_dwordx4 v[56:59], v252, s[20:23], s41 offen offset:2048 sc1
v_accvgpr_read_b32 v212, a88
v_mfma_f32_16x16x32_bf16 a[100:103], v[236:239], v[148:151], a[100:103]
v_accvgpr_read_b32 v213, a89
v_accvgpr_read_b32 v214, a90
v_mfma_f32_16x16x32_bf16 a[104:107], v[232:235], v[136:139], a[104:107]
ds_read_b64_tr_b16 v[228:229], v250 offset:4608
ds_read_b64_tr_b16 v[230:231], v250 offset:6656
v_mfma_f32_16x16x32_bf16 a[104:107], v[236:239], v[152:155], a[104:107]
v_accvgpr_read_b32 v215, a91
v_cvt_pk_bf16_f32 v90, v212, v213
v_mfma_f32_16x16x32_bf16 a[108:111], v[232:235], v[140:143], a[108:111]
v_cvt_pk_bf16_f32 v91, v214, v215
buffer_store_dwordx4 v[88:91], v252, s[20:23], s42 offen offset:2048 sc1
v_mfma_f32_16x16x32_bf16 a[108:111], v[236:239], v[156:159], a[108:111]
s_waitcnt lgkmcnt(4)
v_accvgpr_read_b32 v220, a92
v_mfma_f32_16x16x32_bf16 a[96:99], v[240:243], v[160:163], a[96:99]
ds_read_b64_tr_b16 v[232:233], v250 offset:37376
ds_read_b64_tr_b16 v[234:235], v250 offset:39424
v_mfma_f32_16x16x32_bf16 a[96:99], v[244:247], v[176:179], a[96:99]
v_accvgpr_read_b32 v221, a93
v_accvgpr_read_b32 v222, a94
v_mfma_f32_16x16x32_bf16 a[100:103], v[240:243], v[164:167], a[100:103]
v_accvgpr_read_b32 v223, a95
v_cvt_pk_bf16_f32 v122, v220, v221
v_mfma_f32_16x16x32_bf16 a[100:103], v[244:247], v[180:183], a[100:103]
v_cvt_pk_bf16_f32 v123, v222, v223
buffer_store_dwordx4 v[120:123], v252, s[20:23], s43 offen offset:2048 sc1
v_mfma_f32_16x16x32_bf16 a[104:107], v[240:243], v[168:171], a[104:107]
ds_read_b64_tr_b16 v[236:237], v250 offset:53760
ds_read_b64_tr_b16 v[238:239], v250 offset:55808
v_mfma_f32_16x16x32_bf16 a[104:107], v[244:247], v[184:187], a[104:107]
v_mfma_f32_16x16x32_bf16 a[108:111], v[240:243], v[172:175], a[108:111]
v_mfma_f32_16x16x32_bf16 a[108:111], v[244:247], v[188:191], a[108:111]
s_waitcnt lgkmcnt(4)
v_mfma_f32_16x16x32_bf16 a[96:99], v[224:227], v[0:3], a[96:99]
ds_read_b64_tr_b16 v[240:241], v13 offset:4608
ds_read_b64_tr_b16 v[242:243], v13 offset:6656
v_mfma_f32_16x16x32_bf16 a[100:103], v[224:227], v[32:35], a[100:103]
v_mfma_f32_16x16x32_bf16 a[104:107], v[224:227], v[64:67], a[104:107]
v_mfma_f32_16x16x32_bf16 a[108:111], v[224:227], v[96:99], a[108:111]
v_mfma_f32_16x16x32_bf16 a[112:115], v[228:231], v[0:3], a[112:115]
ds_read_b64_tr_b16 v[244:245], v13 offset:20992
ds_read_b64_tr_b16 v[246:247], v13 offset:23040
v_mfma_f32_16x16x32_bf16 a[116:119], v[228:231], v[32:35], a[116:119]
v_accvgpr_read_b32 v192, a96
v_accvgpr_read_b32 v193, a97
v_mfma_f32_16x16x32_bf16 a[120:123], v[228:231], v[64:67], a[120:123]
v_accvgpr_read_b32 v194, a98
v_accvgpr_read_b32 v195, a99
v_mfma_f32_16x16x32_bf16 a[124:127], v[228:231], v[96:99], a[124:127]
s_waitcnt lgkmcnt(4)
v_cvt_pk_bf16_f32 v28, v192, v193
v_mfma_f32_16x16x32_bf16 a[112:115], v[232:235], v[4:7], a[112:115]
ds_read_b64_tr_b16 v[224:225], v13 offset:37376
ds_read_b64_tr_b16 v[226:227], v13 offset:39424
v_mfma_f32_16x16x32_bf16 a[112:115], v[236:239], v[8:11], a[112:115]
v_cvt_pk_bf16_f32 v29, v194, v195
v_accvgpr_read_b32 v200, a100
v_mfma_f32_16x16x32_bf16 a[116:119], v[232:235], v[36:39], a[116:119]
v_accvgpr_read_b32 v201, a101
v_accvgpr_read_b32 v202, a102
v_mfma_f32_16x16x32_bf16 a[116:119], v[236:239], v[40:43], a[116:119]
v_accvgpr_read_b32 v203, a103
v_cvt_pk_bf16_f32 v60, v200, v201
v_mfma_f32_16x16x32_bf16 a[120:123], v[232:235], v[68:71], a[120:123]
ds_read_b64_tr_b16 v[228:229], v13 offset:53760
ds_read_b64_tr_b16 v[230:231], v13 offset:55808
v_mfma_f32_16x16x32_bf16 a[120:123], v[236:239], v[72:75], a[120:123]
v_cvt_pk_bf16_f32 v61, v202, v203
v_accvgpr_read_b32 v208, a104
v_mfma_f32_16x16x32_bf16 a[124:127], v[232:235], v[100:103], a[124:127]
v_accvgpr_read_b32 v209, a105
v_accvgpr_read_b32 v210, a106
v_mfma_f32_16x16x32_bf16 a[124:127], v[236:239], v[104:107], a[124:127]
s_waitcnt lgkmcnt(4)
v_accvgpr_read_b32 v211, a107
v_mfma_f32_16x16x32_bf16 a[112:115], v[240:243], v[128:131], a[112:115]
ds_read_b64_tr_b16 v[232:233], v249 offset:40960
ds_read_b64_tr_b16 v[234:235], v249 offset:43008
v_mfma_f32_16x16x32_bf16 a[112:115], v[244:247], v[144:147], a[112:115]
v_cvt_pk_bf16_f32 v92, v208, v209
v_cvt_pk_bf16_f32 v93, v210, v211
v_mfma_f32_16x16x32_bf16 a[116:119], v[240:243], v[132:135], a[116:119]
v_accvgpr_read_b32 v216, a108
v_accvgpr_read_b32 v217, a109
v_mfma_f32_16x16x32_bf16 a[116:119], v[244:247], v[148:151], a[116:119]
v_accvgpr_read_b32 v218, a110
v_accvgpr_read_b32 v219, a111
v_mfma_f32_16x16x32_bf16 a[120:123], v[240:243], v[136:139], a[120:123]
ds_read_b64_tr_b16 v[236:237], v249 offset:57344
ds_read_b64_tr_b16 v[238:239], v249 offset:59392
v_mfma_f32_16x16x32_bf16 a[120:123], v[244:247], v[152:155], a[120:123]
v_cvt_pk_bf16_f32 v124, v216, v217
v_cvt_pk_bf16_f32 v125, v218, v219
v_mfma_f32_16x16x32_bf16 a[124:127], v[240:243], v[140:143], a[124:127]
v_mfma_f32_16x16x32_bf16 a[124:127], v[244:247], v[156:159], a[124:127]
s_waitcnt lgkmcnt(4)
v_mfma_f32_16x16x32_bf16 a[112:115], v[224:227], v[160:163], a[112:115]
ds_read_b64_tr_b16 v[240:241], v12 offset:8192
ds_read_b64_tr_b16 v[242:243], v12 offset:10240
v_mfma_f32_16x16x32_bf16 a[112:115], v[228:231], v[176:179], a[112:115]
v_mfma_f32_16x16x32_bf16 a[116:119], v[224:227], v[164:167], a[116:119]
v_mfma_f32_16x16x32_bf16 a[116:119], v[228:231], v[180:183], a[116:119]
v_mfma_f32_16x16x32_bf16 a[120:123], v[224:227], v[168:171], a[120:123]
ds_read_b64_tr_b16 v[244:245], v12 offset:24576
ds_read_b64_tr_b16 v[246:247], v12 offset:26624
v_mfma_f32_16x16x32_bf16 a[120:123], v[228:231], v[184:187], a[120:123]
v_mfma_f32_16x16x32_bf16 a[124:127], v[224:227], v[172:175], a[124:127]
s_nop 0
v_accvgpr_read_b32 v196, a112
v_accvgpr_read_b32 v197, a113
v_mfma_f32_16x16x32_bf16 a[124:127], v[228:231], v[188:191], a[124:127]
s_waitcnt lgkmcnt(4)
v_accvgpr_read_b32 v198, a114
v_mfma_f32_16x16x32_bf16 a[128:131], v[232:235], v[4:7], a[128:131]
ds_read_b64_tr_b16 v[224:225], v12 offset:40960
ds_read_b64_tr_b16 v[226:227], v12 offset:43008
v_mfma_f32_16x16x32_bf16 a[128:131], v[236:239], v[8:11], a[128:131]
v_accvgpr_read_b32 v199, a115
v_cvt_pk_bf16_f32 v30, v196, v197
v_mfma_f32_16x16x32_bf16 a[132:135], v[232:235], v[36:39], a[132:135]
v_cvt_pk_bf16_f32 v31, v198, v199
buffer_store_dwordx4 v[28:31], v252, s[20:23], s40 offen offset:3072 sc1
v_mfma_f32_16x16x32_bf16 a[132:135], v[236:239], v[40:43], a[132:135]
v_accvgpr_read_b32 v204, a116
v_accvgpr_read_b32 v205, a117
v_mfma_f32_16x16x32_bf16 a[136:139], v[232:235], v[68:71], a[136:139]
ds_read_b64_tr_b16 v[228:229], v12 offset:57344
ds_read_b64_tr_b16 v[230:231], v12 offset:59392
v_mfma_f32_16x16x32_bf16 a[136:139], v[236:239], v[72:75], a[136:139]
v_accvgpr_read_b32 v206, a118
v_accvgpr_read_b32 v207, a119
v_mfma_f32_16x16x32_bf16 a[140:143], v[232:235], v[100:103], a[140:143]
v_cvt_pk_bf16_f32 v62, v204, v205
v_cvt_pk_bf16_f32 v63, v206, v207
v_mfma_f32_16x16x32_bf16 a[140:143], v[236:239], v[104:107], a[140:143]
s_waitcnt lgkmcnt(4)
buffer_store_dwordx4 v[60:63], v252, s[20:23], s41 offen offset:3072 sc1
v_mfma_f32_16x16x32_bf16 a[128:131], v[240:243], v[128:131], a[128:131]
ds_read_b64_tr_b16 v[232:233], v249 offset:8192
ds_read_b64_tr_b16 v[234:235], v249 offset:10240
v_mfma_f32_16x16x32_bf16 a[128:131], v[244:247], v[144:147], a[128:131]
v_accvgpr_read_b32 v212, a120
v_accvgpr_read_b32 v213, a121
v_mfma_f32_16x16x32_bf16 a[132:135], v[240:243], v[132:135], a[132:135]
v_accvgpr_read_b32 v214, a122
v_accvgpr_read_b32 v215, a123
v_mfma_f32_16x16x32_bf16 a[132:135], v[244:247], v[148:151], a[132:135]
v_cvt_pk_bf16_f32 v94, v212, v213
v_cvt_pk_bf16_f32 v95, v214, v215
v_mfma_f32_16x16x32_bf16 a[136:139], v[240:243], v[136:139], a[136:139]
ds_read_b64_tr_b16 v[236:237], v250 offset:8192
ds_read_b64_tr_b16 v[238:239], v250 offset:10240
v_mfma_f32_16x16x32_bf16 a[136:139], v[244:247], v[152:155], a[136:139]
buffer_store_dwordx4 v[92:95], v252, s[20:23], s42 offen offset:3072 sc1
v_accvgpr_read_b32 v220, a124
v_mfma_f32_16x16x32_bf16 a[140:143], v[240:243], v[140:143], a[140:143]
v_accvgpr_read_b32 v221, a125
v_accvgpr_read_b32 v222, a126
v_mfma_f32_16x16x32_bf16 a[140:143], v[244:247], v[156:159], a[140:143]
s_waitcnt lgkmcnt(4)
v_accvgpr_read_b32 v223, a127
v_mfma_f32_16x16x32_bf16 a[128:131], v[224:227], v[160:163], a[128:131]
ds_read_b64_tr_b16 v[240:241], v250 offset:40960
ds_read_b64_tr_b16 v[242:243], v250 offset:43008
v_mfma_f32_16x16x32_bf16 a[128:131], v[228:231], v[176:179], a[128:131]
v_cvt_pk_bf16_f32 v126, v220, v221
v_cvt_pk_bf16_f32 v127, v222, v223
v_mfma_f32_16x16x32_bf16 a[132:135], v[224:227], v[164:167], a[132:135]
buffer_store_dwordx4 v[124:127], v252, s[20:23], s43 offen offset:3072 sc1
v_mfma_f32_16x16x32_bf16 a[132:135], v[228:231], v[180:183], a[132:135]
v_mfma_f32_16x16x32_bf16 a[136:139], v[224:227], v[168:171], a[136:139]
ds_read_b64_tr_b16 v[244:245], v250 offset:57344
ds_read_b64_tr_b16 v[246:247], v250 offset:59392
v_mfma_f32_16x16x32_bf16 a[136:139], v[228:231], v[184:187], a[136:139]
v_mfma_f32_16x16x32_bf16 a[140:143], v[224:227], v[172:175], a[140:143]
v_mfma_f32_16x16x32_bf16 a[140:143], v[228:231], v[188:191], a[140:143]
s_waitcnt lgkmcnt(4)
v_mfma_f32_16x16x32_bf16 a[128:131], v[232:235], v[0:3], a[128:131]
ds_read_b64_tr_b16 v[224:225], v13 offset:8192
ds_read_b64_tr_b16 v[226:227], v13 offset:10240
v_mfma_f32_16x16x32_bf16 a[132:135], v[232:235], v[32:35], a[132:135]
v_mfma_f32_16x16x32_bf16 a[136:139], v[232:235], v[64:67], a[136:139]
v_mfma_f32_16x16x32_bf16 a[140:143], v[232:235], v[96:99], a[140:143]
v_mfma_f32_16x16x32_bf16 a[144:147], v[236:239], v[0:3], a[144:147]
ds_read_b64_tr_b16 v[228:229], v13 offset:24576
ds_read_b64_tr_b16 v[230:231], v13 offset:26624
v_mfma_f32_16x16x32_bf16 a[148:151], v[236:239], v[32:35], a[148:151]
v_accvgpr_read_b32 v192, a128
v_accvgpr_read_b32 v193, a129
v_mfma_f32_16x16x32_bf16 a[152:155], v[236:239], v[64:67], a[152:155]
v_accvgpr_read_b32 v194, a130
v_accvgpr_read_b32 v195, a131
v_mfma_f32_16x16x32_bf16 a[156:159], v[236:239], v[96:99], a[156:159]
s_waitcnt lgkmcnt(4)
v_cvt_pk_bf16_f32 v16, v192, v193
v_mfma_f32_16x16x32_bf16 a[144:147], v[240:243], v[4:7], a[144:147]
ds_read_b64_tr_b16 v[232:233], v13 offset:40960
ds_read_b64_tr_b16 v[234:235], v13 offset:43008
v_mfma_f32_16x16x32_bf16 a[144:147], v[244:247], v[8:11], a[144:147]
v_cvt_pk_bf16_f32 v17, v194, v195
v_accvgpr_read_b32 v200, a132
v_mfma_f32_16x16x32_bf16 a[148:151], v[240:243], v[36:39], a[148:151]
v_accvgpr_read_b32 v201, a133
v_accvgpr_read_b32 v202, a134
v_mfma_f32_16x16x32_bf16 a[148:151], v[244:247], v[40:43], a[148:151]
v_accvgpr_read_b32 v203, a135
v_cvt_pk_bf16_f32 v48, v200, v201
v_mfma_f32_16x16x32_bf16 a[152:155], v[240:243], v[68:71], a[152:155]
ds_read_b64_tr_b16 v[236:237], v13 offset:57344
ds_read_b64_tr_b16 v[238:239], v13 offset:59392
v_mfma_f32_16x16x32_bf16 a[152:155], v[244:247], v[72:75], a[152:155]
v_cvt_pk_bf16_f32 v49, v202, v203
v_accvgpr_read_b32 v208, a136
v_mfma_f32_16x16x32_bf16 a[156:159], v[240:243], v[100:103], a[156:159]
v_accvgpr_read_b32 v209, a137
v_accvgpr_read_b32 v210, a138
v_mfma_f32_16x16x32_bf16 a[156:159], v[244:247], v[104:107], a[156:159]
s_waitcnt lgkmcnt(4)
v_accvgpr_read_b32 v211, a139
v_mfma_f32_16x16x32_bf16 a[144:147], v[224:227], v[128:131], a[144:147]
ds_read_b64_tr_b16 v[240:241], v249 offset:41472
ds_read_b64_tr_b16 v[242:243], v249 offset:43520
v_mfma_f32_16x16x32_bf16 a[144:147], v[228:231], v[144:147], a[144:147]
v_cvt_pk_bf16_f32 v80, v208, v209
v_cvt_pk_bf16_f32 v81, v210, v211
v_mfma_f32_16x16x32_bf16 a[148:151], v[224:227], v[132:135], a[148:151]
v_accvgpr_read_b32 v216, a140
v_accvgpr_read_b32 v217, a141
v_mfma_f32_16x16x32_bf16 a[148:151], v[228:231], v[148:151], a[148:151]
v_accvgpr_read_b32 v218, a142
v_accvgpr_read_b32 v219, a143
v_mfma_f32_16x16x32_bf16 a[152:155], v[224:227], v[136:139], a[152:155]
ds_read_b64_tr_b16 v[244:245], v249 offset:57856
ds_read_b64_tr_b16 v[246:247], v249 offset:59904
v_mfma_f32_16x16x32_bf16 a[152:155], v[228:231], v[152:155], a[152:155]
v_cvt_pk_bf16_f32 v112, v216, v217
v_cvt_pk_bf16_f32 v113, v218, v219
v_mfma_f32_16x16x32_bf16 a[156:159], v[224:227], v[140:143], a[156:159]
v_mfma_f32_16x16x32_bf16 a[156:159], v[228:231], v[156:159], a[156:159]
s_waitcnt lgkmcnt(4)
v_mfma_f32_16x16x32_bf16 a[144:147], v[232:235], v[160:163], a[144:147]
ds_read_b64_tr_b16 v[224:225], v12 offset:8704
ds_read_b64_tr_b16 v[226:227], v12 offset:10752
v_mfma_f32_16x16x32_bf16 a[144:147], v[236:239], v[176:179], a[144:147]
v_mfma_f32_16x16x32_bf16 a[148:151], v[232:235], v[164:167], a[148:151]
v_mfma_f32_16x16x32_bf16 a[148:151], v[236:239], v[180:183], a[148:151]
v_mfma_f32_16x16x32_bf16 a[152:155], v[232:235], v[168:171], a[152:155]
ds_read_b64_tr_b16 v[228:229], v12 offset:25088
ds_read_b64_tr_b16 v[230:231], v12 offset:27136
v_mfma_f32_16x16x32_bf16 a[152:155], v[236:239], v[184:187], a[152:155]
v_mfma_f32_16x16x32_bf16 a[156:159], v[232:235], v[172:175], a[156:159]
s_nop 0
v_accvgpr_read_b32 v196, a144
v_accvgpr_read_b32 v197, a145
v_mfma_f32_16x16x32_bf16 a[156:159], v[236:239], v[188:191], a[156:159]
s_waitcnt lgkmcnt(4)
v_accvgpr_read_b32 v198, a146
v_mfma_f32_16x16x32_bf16 a[160:163], v[240:243], v[4:7], a[160:163]
ds_read_b64_tr_b16 v[232:233], v12 offset:41472
ds_read_b64_tr_b16 v[234:235], v12 offset:43520
v_mfma_f32_16x16x32_bf16 a[160:163], v[244:247], v[8:11], a[160:163]
v_accvgpr_read_b32 v199, a147
v_cvt_pk_bf16_f32 v18, v196, v197
v_mfma_f32_16x16x32_bf16 a[164:167], v[240:243], v[36:39], a[164:167]
v_cvt_pk_bf16_f32 v19, v198, v199
buffer_store_dwordx4 v[16:19], v252, s[20:23], s44 offen offset:0 sc1
v_mfma_f32_16x16x32_bf16 a[164:167], v[244:247], v[40:43], a[164:167]
v_accvgpr_read_b32 v204, a148
v_accvgpr_read_b32 v205, a149
v_mfma_f32_16x16x32_bf16 a[168:171], v[240:243], v[68:71], a[168:171]
ds_read_b64_tr_b16 v[236:237], v12 offset:57856
ds_read_b64_tr_b16 v[238:239], v12 offset:59904
v_mfma_f32_16x16x32_bf16 a[168:171], v[244:247], v[72:75], a[168:171]
v_accvgpr_read_b32 v206, a150
v_accvgpr_read_b32 v207, a151
v_mfma_f32_16x16x32_bf16 a[172:175], v[240:243], v[100:103], a[172:175]
v_cvt_pk_bf16_f32 v50, v204, v205
v_cvt_pk_bf16_f32 v51, v206, v207
v_mfma_f32_16x16x32_bf16 a[172:175], v[244:247], v[104:107], a[172:175]
s_waitcnt lgkmcnt(4)
buffer_store_dwordx4 v[48:51], v252, s[20:23], s45 offen offset:0 sc1
v_mfma_f32_16x16x32_bf16 a[160:163], v[224:227], v[128:131], a[160:163]
ds_read_b64_tr_b16 v[240:241], v249 offset:8704
ds_read_b64_tr_b16 v[242:243], v249 offset:10752
v_mfma_f32_16x16x32_bf16 a[160:163], v[228:231], v[144:147], a[160:163]
v_accvgpr_read_b32 v212, a152
v_accvgpr_read_b32 v213, a153
v_mfma_f32_16x16x32_bf16 a[164:167], v[224:227], v[132:135], a[164:167]
v_accvgpr_read_b32 v214, a154
v_accvgpr_read_b32 v215, a155
v_mfma_f32_16x16x32_bf16 a[164:167], v[228:231], v[148:151], a[164:167]
v_cvt_pk_bf16_f32 v82, v212, v213
v_cvt_pk_bf16_f32 v83, v214, v215
v_mfma_f32_16x16x32_bf16 a[168:171], v[224:227], v[136:139], a[168:171]
ds_read_b64_tr_b16 v[244:245], v250 offset:8704
ds_read_b64_tr_b16 v[246:247], v250 offset:10752
v_mfma_f32_16x16x32_bf16 a[168:171], v[228:231], v[152:155], a[168:171]
buffer_store_dwordx4 v[80:83], v252, s[20:23], s46 offen offset:0 sc1
v_accvgpr_read_b32 v220, a156
v_mfma_f32_16x16x32_bf16 a[172:175], v[224:227], v[140:143], a[172:175]
v_accvgpr_read_b32 v221, a157
v_accvgpr_read_b32 v222, a158
v_mfma_f32_16x16x32_bf16 a[172:175], v[228:231], v[156:159], a[172:175]
s_waitcnt lgkmcnt(4)
v_accvgpr_read_b32 v223, a159
v_mfma_f32_16x16x32_bf16 a[160:163], v[232:235], v[160:163], a[160:163]
ds_read_b64_tr_b16 v[224:225], v250 offset:41472
ds_read_b64_tr_b16 v[226:227], v250 offset:43520
v_mfma_f32_16x16x32_bf16 a[160:163], v[236:239], v[176:179], a[160:163]
v_cvt_pk_bf16_f32 v114, v220, v221
v_cvt_pk_bf16_f32 v115, v222, v223
v_mfma_f32_16x16x32_bf16 a[164:167], v[232:235], v[164:167], a[164:167]
buffer_store_dwordx4 v[112:115], v252, s[20:23], s47 offen offset:0 sc1
v_mfma_f32_16x16x32_bf16 a[164:167], v[236:239], v[180:183], a[164:167]
v_mfma_f32_16x16x32_bf16 a[168:171], v[232:235], v[168:171], a[168:171]
ds_read_b64_tr_b16 v[228:229], v250 offset:57856
ds_read_b64_tr_b16 v[230:231], v250 offset:59904
v_mfma_f32_16x16x32_bf16 a[168:171], v[236:239], v[184:187], a[168:171]
v_mfma_f32_16x16x32_bf16 a[172:175], v[232:235], v[172:175], a[172:175]
v_mfma_f32_16x16x32_bf16 a[172:175], v[236:239], v[188:191], a[172:175]
s_waitcnt lgkmcnt(4)
v_mfma_f32_16x16x32_bf16 a[160:163], v[240:243], v[0:3], a[160:163]
ds_read_b64_tr_b16 v[232:233], v13 offset:8704
ds_read_b64_tr_b16 v[234:235], v13 offset:10752
v_mfma_f32_16x16x32_bf16 a[164:167], v[240:243], v[32:35], a[164:167]
v_mfma_f32_16x16x32_bf16 a[168:171], v[240:243], v[64:67], a[168:171]
v_mfma_f32_16x16x32_bf16 a[172:175], v[240:243], v[96:99], a[172:175]
v_mfma_f32_16x16x32_bf16 a[176:179], v[244:247], v[0:3], a[176:179]
ds_read_b64_tr_b16 v[236:237], v13 offset:25088
ds_read_b64_tr_b16 v[238:239], v13 offset:27136
v_mfma_f32_16x16x32_bf16 a[180:183], v[244:247], v[32:35], a[180:183]
v_accvgpr_read_b32 v192, a160
v_accvgpr_read_b32 v193, a161
v_mfma_f32_16x16x32_bf16 a[184:187], v[244:247], v[64:67], a[184:187]
v_accvgpr_read_b32 v194, a162
v_accvgpr_read_b32 v195, a163
v_mfma_f32_16x16x32_bf16 a[188:191], v[244:247], v[96:99], a[188:191]
s_waitcnt lgkmcnt(4)
v_cvt_pk_bf16_f32 v20, v192, v193
v_mfma_f32_16x16x32_bf16 a[176:179], v[224:227], v[4:7], a[176:179]
ds_read_b64_tr_b16 v[240:241], v13 offset:41472
ds_read_b64_tr_b16 v[242:243], v13 offset:43520
v_mfma_f32_16x16x32_bf16 a[176:179], v[228:231], v[8:11], a[176:179]
v_cvt_pk_bf16_f32 v21, v194, v195
v_accvgpr_read_b32 v200, a164
v_mfma_f32_16x16x32_bf16 a[180:183], v[224:227], v[36:39], a[180:183]
v_accvgpr_read_b32 v201, a165
v_accvgpr_read_b32 v202, a166
v_mfma_f32_16x16x32_bf16 a[180:183], v[228:231], v[40:43], a[180:183]
v_accvgpr_read_b32 v203, a167
v_cvt_pk_bf16_f32 v52, v200, v201
v_mfma_f32_16x16x32_bf16 a[184:187], v[224:227], v[68:71], a[184:187]
ds_read_b64_tr_b16 v[244:245], v13 offset:57856
ds_read_b64_tr_b16 v[246:247], v13 offset:59904
v_mfma_f32_16x16x32_bf16 a[184:187], v[228:231], v[72:75], a[184:187]
v_cvt_pk_bf16_f32 v53, v202, v203
v_accvgpr_read_b32 v208, a168
v_mfma_f32_16x16x32_bf16 a[188:191], v[224:227], v[100:103], a[188:191]
v_accvgpr_read_b32 v209, a169
v_accvgpr_read_b32 v210, a170
v_mfma_f32_16x16x32_bf16 a[188:191], v[228:231], v[104:107], a[188:191]
s_waitcnt lgkmcnt(4)
v_accvgpr_read_b32 v211, a171
v_mfma_f32_16x16x32_bf16 a[176:179], v[232:235], v[128:131], a[176:179]
ds_read_b64_tr_b16 v[224:225], v249 offset:45056
ds_read_b64_tr_b16 v[226:227], v249 offset:47104
v_mfma_f32_16x16x32_bf16 a[176:179], v[236:239], v[144:147], a[176:179]
v_cvt_pk_bf16_f32 v84, v208, v209
v_cvt_pk_bf16_f32 v85, v210, v211
v_mfma_f32_16x16x32_bf16 a[180:183], v[232:235], v[132:135], a[180:183]
v_accvgpr_read_b32 v216, a172
v_accvgpr_read_b32 v217, a173
v_mfma_f32_16x16x32_bf16 a[180:183], v[236:239], v[148:151], a[180:183]
v_accvgpr_read_b32 v218, a174
v_accvgpr_read_b32 v219, a175
v_mfma_f32_16x16x32_bf16 a[184:187], v[232:235], v[136:139], a[184:187]
ds_read_b64_tr_b16 v[228:229], v249 offset:61440
ds_read_b64_tr_b16 v[230:231], v249 offset:63488
v_mfma_f32_16x16x32_bf16 a[184:187], v[236:239], v[152:155], a[184:187]
v_cvt_pk_bf16_f32 v116, v216, v217
v_cvt_pk_bf16_f32 v117, v218, v219
v_mfma_f32_16x16x32_bf16 a[188:191], v[232:235], v[140:143], a[188:191]
v_mfma_f32_16x16x32_bf16 a[188:191], v[236:239], v[156:159], a[188:191]
s_waitcnt lgkmcnt(4)
v_mfma_f32_16x16x32_bf16 a[176:179], v[240:243], v[160:163], a[176:179]
ds_read_b64_tr_b16 v[232:233], v12 offset:12288
ds_read_b64_tr_b16 v[234:235], v12 offset:14336
v_mfma_f32_16x16x32_bf16 a[176:179], v[244:247], v[176:179], a[176:179]
v_mfma_f32_16x16x32_bf16 a[180:183], v[240:243], v[164:167], a[180:183]
v_mfma_f32_16x16x32_bf16 a[180:183], v[244:247], v[180:183], a[180:183]
v_mfma_f32_16x16x32_bf16 a[184:187], v[240:243], v[168:171], a[184:187]
ds_read_b64_tr_b16 v[236:237], v12 offset:28672
ds_read_b64_tr_b16 v[238:239], v12 offset:30720
v_mfma_f32_16x16x32_bf16 a[184:187], v[244:247], v[184:187], a[184:187]
v_mfma_f32_16x16x32_bf16 a[188:191], v[240:243], v[172:175], a[188:191]
s_nop 0
v_accvgpr_read_b32 v196, a176
v_accvgpr_read_b32 v197, a177
v_mfma_f32_16x16x32_bf16 a[188:191], v[244:247], v[188:191], a[188:191]
s_waitcnt lgkmcnt(4)
v_accvgpr_read_b32 v198, a178
v_mfma_f32_16x16x32_bf16 a[192:195], v[224:227], v[4:7], a[192:195]
ds_read_b64_tr_b16 v[240:241], v12 offset:45056
ds_read_b64_tr_b16 v[242:243], v12 offset:47104
v_mfma_f32_16x16x32_bf16 a[192:195], v[228:231], v[8:11], a[192:195]
v_accvgpr_read_b32 v199, a179
v_cvt_pk_bf16_f32 v22, v196, v197
v_mfma_f32_16x16x32_bf16 a[196:199], v[224:227], v[36:39], a[196:199]
v_cvt_pk_bf16_f32 v23, v198, v199
buffer_store_dwordx4 v[20:23], v252, s[20:23], s44 offen offset:1024 sc1
v_mfma_f32_16x16x32_bf16 a[196:199], v[228:231], v[40:43], a[196:199]
v_accvgpr_read_b32 v204, a180
v_accvgpr_read_b32 v205, a181
v_mfma_f32_16x16x32_bf16 a[200:203], v[224:227], v[68:71], a[200:203]
ds_read_b64_tr_b16 v[244:245], v12 offset:61440
ds_read_b64_tr_b16 v[246:247], v12 offset:63488
v_mfma_f32_16x16x32_bf16 a[200:203], v[228:231], v[72:75], a[200:203]
v_accvgpr_read_b32 v206, a182
v_accvgpr_read_b32 v207, a183
v_mfma_f32_16x16x32_bf16 a[204:207], v[224:227], v[100:103], a[204:207]
v_cvt_pk_bf16_f32 v54, v204, v205
v_cvt_pk_bf16_f32 v55, v206, v207
v_mfma_f32_16x16x32_bf16 a[204:207], v[228:231], v[104:107], a[204:207]
s_waitcnt lgkmcnt(4)
buffer_store_dwordx4 v[52:55], v252, s[20:23], s45 offen offset:1024 sc1
v_mfma_f32_16x16x32_bf16 a[192:195], v[232:235], v[128:131], a[192:195]
ds_read_b64_tr_b16 v[224:225], v249 offset:12288
ds_read_b64_tr_b16 v[226:227], v249 offset:14336
v_mfma_f32_16x16x32_bf16 a[192:195], v[236:239], v[144:147], a[192:195]
v_accvgpr_read_b32 v212, a184
v_accvgpr_read_b32 v213, a185
v_mfma_f32_16x16x32_bf16 a[196:199], v[232:235], v[132:135], a[196:199]
v_accvgpr_read_b32 v214, a186
v_accvgpr_read_b32 v215, a187
v_mfma_f32_16x16x32_bf16 a[196:199], v[236:239], v[148:151], a[196:199]
v_cvt_pk_bf16_f32 v86, v212, v213
v_cvt_pk_bf16_f32 v87, v214, v215
v_mfma_f32_16x16x32_bf16 a[200:203], v[232:235], v[136:139], a[200:203]
ds_read_b64_tr_b16 v[228:229], v250 offset:12288
ds_read_b64_tr_b16 v[230:231], v250 offset:14336
v_mfma_f32_16x16x32_bf16 a[200:203], v[236:239], v[152:155], a[200:203]
buffer_store_dwordx4 v[84:87], v252, s[20:23], s46 offen offset:1024 sc1
v_accvgpr_read_b32 v220, a188
v_mfma_f32_16x16x32_bf16 a[204:207], v[232:235], v[140:143], a[204:207]
v_accvgpr_read_b32 v221, a189
v_accvgpr_read_b32 v222, a190
v_mfma_f32_16x16x32_bf16 a[204:207], v[236:239], v[156:159], a[204:207]
s_waitcnt lgkmcnt(4)
v_accvgpr_read_b32 v223, a191
v_mfma_f32_16x16x32_bf16 a[192:195], v[240:243], v[160:163], a[192:195]
ds_read_b64_tr_b16 v[232:233], v250 offset:45056
ds_read_b64_tr_b16 v[234:235], v250 offset:47104
v_mfma_f32_16x16x32_bf16 a[192:195], v[244:247], v[176:179], a[192:195]
v_cvt_pk_bf16_f32 v118, v220, v221
v_cvt_pk_bf16_f32 v119, v222, v223
v_mfma_f32_16x16x32_bf16 a[196:199], v[240:243], v[164:167], a[196:199]
buffer_store_dwordx4 v[116:119], v252, s[20:23], s47 offen offset:1024 sc1
v_mfma_f32_16x16x32_bf16 a[196:199], v[244:247], v[180:183], a[196:199]
v_mfma_f32_16x16x32_bf16 a[200:203], v[240:243], v[168:171], a[200:203]
ds_read_b64_tr_b16 v[236:237], v250 offset:61440
ds_read_b64_tr_b16 v[238:239], v250 offset:63488
v_mfma_f32_16x16x32_bf16 a[200:203], v[244:247], v[184:187], a[200:203]
v_mfma_f32_16x16x32_bf16 a[204:207], v[240:243], v[172:175], a[204:207]
v_mfma_f32_16x16x32_bf16 a[204:207], v[244:247], v[188:191], a[204:207]
s_waitcnt lgkmcnt(4)
v_mfma_f32_16x16x32_bf16 a[192:195], v[224:227], v[0:3], a[192:195]
ds_read_b64_tr_b16 v[240:241], v13 offset:12288
ds_read_b64_tr_b16 v[242:243], v13 offset:14336
v_mfma_f32_16x16x32_bf16 a[196:199], v[224:227], v[32:35], a[196:199]
v_mfma_f32_16x16x32_bf16 a[200:203], v[224:227], v[64:67], a[200:203]
v_mfma_f32_16x16x32_bf16 a[204:207], v[224:227], v[96:99], a[204:207]
v_mfma_f32_16x16x32_bf16 a[208:211], v[228:231], v[0:3], a[208:211]
ds_read_b64_tr_b16 v[244:245], v13 offset:28672
ds_read_b64_tr_b16 v[246:247], v13 offset:30720
v_mfma_f32_16x16x32_bf16 a[212:215], v[228:231], v[32:35], a[212:215]
v_accvgpr_read_b32 v192, a192
v_accvgpr_read_b32 v193, a193
v_mfma_f32_16x16x32_bf16 a[216:219], v[228:231], v[64:67], a[216:219]
v_accvgpr_read_b32 v194, a194
v_accvgpr_read_b32 v195, a195
v_mfma_f32_16x16x32_bf16 a[220:223], v[228:231], v[96:99], a[220:223]
s_waitcnt lgkmcnt(4)
v_cvt_pk_bf16_f32 v24, v192, v193
v_mfma_f32_16x16x32_bf16 a[208:211], v[232:235], v[4:7], a[208:211]
ds_read_b64_tr_b16 v[224:225], v13 offset:45056
ds_read_b64_tr_b16 v[226:227], v13 offset:47104
v_mfma_f32_16x16x32_bf16 a[208:211], v[236:239], v[8:11], a[208:211]
v_cvt_pk_bf16_f32 v25, v194, v195
v_accvgpr_read_b32 v200, a196
v_mfma_f32_16x16x32_bf16 a[212:215], v[232:235], v[36:39], a[212:215]
v_accvgpr_read_b32 v201, a197
v_accvgpr_read_b32 v202, a198
v_mfma_f32_16x16x32_bf16 a[212:215], v[236:239], v[40:43], a[212:215]
v_accvgpr_read_b32 v203, a199
v_cvt_pk_bf16_f32 v56, v200, v201
v_mfma_f32_16x16x32_bf16 a[216:219], v[232:235], v[68:71], a[216:219]
ds_read_b64_tr_b16 v[228:229], v13 offset:61440
ds_read_b64_tr_b16 v[230:231], v13 offset:63488
v_mfma_f32_16x16x32_bf16 a[216:219], v[236:239], v[72:75], a[216:219]
v_cvt_pk_bf16_f32 v57, v202, v203
v_accvgpr_read_b32 v208, a200
v_mfma_f32_16x16x32_bf16 a[220:223], v[232:235], v[100:103], a[220:223]
v_accvgpr_read_b32 v209, a201
v_accvgpr_read_b32 v210, a202
v_mfma_f32_16x16x32_bf16 a[220:223], v[236:239], v[104:107], a[220:223]
s_waitcnt lgkmcnt(4)
v_accvgpr_read_b32 v211, a203
v_mfma_f32_16x16x32_bf16 a[208:211], v[240:243], v[128:131], a[208:211]
ds_read_b64_tr_b16 v[232:233], v249 offset:45568
ds_read_b64_tr_b16 v[234:235], v249 offset:47616
v_mfma_f32_16x16x32_bf16 a[208:211], v[244:247], v[144:147], a[208:211]
v_cvt_pk_bf16_f32 v88, v208, v209
v_cvt_pk_bf16_f32 v89, v210, v211
v_mfma_f32_16x16x32_bf16 a[212:215], v[240:243], v[132:135], a[212:215]
v_accvgpr_read_b32 v216, a204
v_accvgpr_read_b32 v217, a205
v_mfma_f32_16x16x32_bf16 a[212:215], v[244:247], v[148:151], a[212:215]
v_accvgpr_read_b32 v218, a206
v_accvgpr_read_b32 v219, a207
v_mfma_f32_16x16x32_bf16 a[216:219], v[240:243], v[136:139], a[216:219]
ds_read_b64_tr_b16 v[236:237], v249 offset:61952
ds_read_b64_tr_b16 v[238:239], v249 offset:64000
v_mfma_f32_16x16x32_bf16 a[216:219], v[244:247], v[152:155], a[216:219]
v_cvt_pk_bf16_f32 v120, v216, v217
v_cvt_pk_bf16_f32 v121, v218, v219
v_mfma_f32_16x16x32_bf16 a[220:223], v[240:243], v[140:143], a[220:223]
v_mfma_f32_16x16x32_bf16 a[220:223], v[244:247], v[156:159], a[220:223]
s_waitcnt lgkmcnt(4)
v_mfma_f32_16x16x32_bf16 a[208:211], v[224:227], v[160:163], a[208:211]
ds_read_b64_tr_b16 v[240:241], v12 offset:12800
ds_read_b64_tr_b16 v[242:243], v12 offset:14848
v_mfma_f32_16x16x32_bf16 a[208:211], v[228:231], v[176:179], a[208:211]
v_mfma_f32_16x16x32_bf16 a[212:215], v[224:227], v[164:167], a[212:215]
v_mfma_f32_16x16x32_bf16 a[212:215], v[228:231], v[180:183], a[212:215]
v_mfma_f32_16x16x32_bf16 a[216:219], v[224:227], v[168:171], a[216:219]
ds_read_b64_tr_b16 v[244:245], v12 offset:29184
ds_read_b64_tr_b16 v[246:247], v12 offset:31232
v_mfma_f32_16x16x32_bf16 a[216:219], v[228:231], v[184:187], a[216:219]
v_mfma_f32_16x16x32_bf16 a[220:223], v[224:227], v[172:175], a[220:223]
s_nop 0
v_accvgpr_read_b32 v196, a208
v_accvgpr_read_b32 v197, a209
v_mfma_f32_16x16x32_bf16 a[220:223], v[228:231], v[188:191], a[220:223]
s_waitcnt lgkmcnt(4)
v_accvgpr_read_b32 v198, a210
v_mfma_f32_16x16x32_bf16 a[224:227], v[232:235], v[4:7], a[224:227]
ds_read_b64_tr_b16 v[224:225], v12 offset:45568
ds_read_b64_tr_b16 v[226:227], v12 offset:47616
v_mfma_f32_16x16x32_bf16 a[224:227], v[236:239], v[8:11], a[224:227]
v_accvgpr_read_b32 v199, a211
v_cvt_pk_bf16_f32 v26, v196, v197
v_mfma_f32_16x16x32_bf16 a[228:231], v[232:235], v[36:39], a[228:231]
v_cvt_pk_bf16_f32 v27, v198, v199
buffer_store_dwordx4 v[24:27], v252, s[20:23], s44 offen offset:2048 sc1
v_mfma_f32_16x16x32_bf16 a[228:231], v[236:239], v[40:43], a[228:231]
v_accvgpr_read_b32 v204, a212
v_accvgpr_read_b32 v205, a213
v_mfma_f32_16x16x32_bf16 a[232:235], v[232:235], v[68:71], a[232:235]
ds_read_b64_tr_b16 v[228:229], v12 offset:61952
ds_read_b64_tr_b16 v[230:231], v12 offset:64000
v_mfma_f32_16x16x32_bf16 a[232:235], v[236:239], v[72:75], a[232:235]
v_accvgpr_read_b32 v206, a214
v_accvgpr_read_b32 v207, a215
v_mfma_f32_16x16x32_bf16 a[236:239], v[232:235], v[100:103], a[236:239]
v_cvt_pk_bf16_f32 v58, v204, v205
v_cvt_pk_bf16_f32 v59, v206, v207
v_mfma_f32_16x16x32_bf16 a[236:239], v[236:239], v[104:107], a[236:239]
s_waitcnt lgkmcnt(4)
buffer_store_dwordx4 v[56:59], v252, s[20:23], s45 offen offset:2048 sc1
v_mfma_f32_16x16x32_bf16 a[224:227], v[240:243], v[128:131], a[224:227]
ds_read_b64_tr_b16 v[232:233], v249 offset:12800
ds_read_b64_tr_b16 v[234:235], v249 offset:14848
v_mfma_f32_16x16x32_bf16 a[224:227], v[244:247], v[144:147], a[224:227]
v_accvgpr_read_b32 v212, a216
v_accvgpr_read_b32 v213, a217
v_mfma_f32_16x16x32_bf16 a[228:231], v[240:243], v[132:135], a[228:231]
v_accvgpr_read_b32 v214, a218
v_accvgpr_read_b32 v215, a219
v_mfma_f32_16x16x32_bf16 a[228:231], v[244:247], v[148:151], a[228:231]
v_cvt_pk_bf16_f32 v90, v212, v213
v_cvt_pk_bf16_f32 v91, v214, v215
v_mfma_f32_16x16x32_bf16 a[232:235], v[240:243], v[136:139], a[232:235]
ds_read_b64_tr_b16 v[236:237], v250 offset:12800
ds_read_b64_tr_b16 v[238:239], v250 offset:14848
v_mfma_f32_16x16x32_bf16 a[232:235], v[244:247], v[152:155], a[232:235]
buffer_store_dwordx4 v[88:91], v252, s[20:23], s46 offen offset:2048 sc1
v_accvgpr_read_b32 v220, a220
v_mfma_f32_16x16x32_bf16 a[236:239], v[240:243], v[140:143], a[236:239]
v_accvgpr_read_b32 v221, a221
v_accvgpr_read_b32 v222, a222
v_mfma_f32_16x16x32_bf16 a[236:239], v[244:247], v[156:159], a[236:239]
s_waitcnt lgkmcnt(4)
v_accvgpr_read_b32 v223, a223
v_mfma_f32_16x16x32_bf16 a[224:227], v[224:227], v[160:163], a[224:227]
ds_read_b64_tr_b16 v[240:241], v250 offset:45568
ds_read_b64_tr_b16 v[242:243], v250 offset:47616
v_mfma_f32_16x16x32_bf16 a[224:227], v[228:231], v[176:179], a[224:227]
v_cvt_pk_bf16_f32 v122, v220, v221
v_cvt_pk_bf16_f32 v123, v222, v223
v_mfma_f32_16x16x32_bf16 a[228:231], v[224:227], v[164:167], a[228:231]
buffer_store_dwordx4 v[120:123], v252, s[20:23], s47 offen offset:2048 sc1
v_mfma_f32_16x16x32_bf16 a[228:231], v[228:231], v[180:183], a[228:231]
v_mfma_f32_16x16x32_bf16 a[232:235], v[224:227], v[168:171], a[232:235]
ds_read_b64_tr_b16 v[244:245], v250 offset:61952
ds_read_b64_tr_b16 v[246:247], v250 offset:64000
v_mfma_f32_16x16x32_bf16 a[232:235], v[228:231], v[184:187], a[232:235]
v_mfma_f32_16x16x32_bf16 a[236:239], v[224:227], v[172:175], a[236:239]
v_mfma_f32_16x16x32_bf16 a[236:239], v[228:231], v[188:191], a[236:239]
s_waitcnt lgkmcnt(4)
v_mfma_f32_16x16x32_bf16 a[224:227], v[232:235], v[0:3], a[224:227]
ds_read_b64_tr_b16 v[224:225], v13 offset:12800
ds_read_b64_tr_b16 v[226:227], v13 offset:14848
v_mfma_f32_16x16x32_bf16 a[228:231], v[232:235], v[32:35], a[228:231]
v_mfma_f32_16x16x32_bf16 a[232:235], v[232:235], v[64:67], a[232:235]
v_mfma_f32_16x16x32_bf16 a[236:239], v[232:235], v[96:99], a[236:239]
v_mfma_f32_16x16x32_bf16 a[240:243], v[236:239], v[0:3], a[240:243]
ds_read_b64_tr_b16 v[228:229], v13 offset:29184
ds_read_b64_tr_b16 v[230:231], v13 offset:31232
v_mfma_f32_16x16x32_bf16 a[244:247], v[236:239], v[32:35], a[244:247]
v_accvgpr_read_b32 v192, a224
v_accvgpr_read_b32 v193, a225
v_mfma_f32_16x16x32_bf16 a[248:251], v[236:239], v[64:67], a[248:251]
v_accvgpr_read_b32 v194, a226
v_accvgpr_read_b32 v195, a227
v_mfma_f32_16x16x32_bf16 a[252:255], v[236:239], v[96:99], a[252:255]
s_waitcnt lgkmcnt(4)
v_cvt_pk_bf16_f32 v28, v192, v193
v_mfma_f32_16x16x32_bf16 a[240:243], v[240:243], v[4:7], a[240:243]
ds_read_b64_tr_b16 v[232:233], v13 offset:45568
ds_read_b64_tr_b16 v[234:235], v13 offset:47616
v_mfma_f32_16x16x32_bf16 a[240:243], v[244:247], v[8:11], a[240:243]
v_cvt_pk_bf16_f32 v29, v194, v195
v_accvgpr_read_b32 v200, a228
v_mfma_f32_16x16x32_bf16 a[244:247], v[240:243], v[36:39], a[244:247]
v_accvgpr_read_b32 v201, a229
v_accvgpr_read_b32 v202, a230
v_mfma_f32_16x16x32_bf16 a[244:247], v[244:247], v[40:43], a[244:247]
v_accvgpr_read_b32 v203, a231
v_cvt_pk_bf16_f32 v60, v200, v201
v_mfma_f32_16x16x32_bf16 a[248:251], v[240:243], v[68:71], a[248:251]
ds_read_b64_tr_b16 v[236:237], v13 offset:61952
ds_read_b64_tr_b16 v[238:239], v13 offset:64000
v_mfma_f32_16x16x32_bf16 a[248:251], v[244:247], v[72:75], a[248:251]
v_cvt_pk_bf16_f32 v61, v202, v203
v_accvgpr_read_b32 v208, a232
v_mfma_f32_16x16x32_bf16 a[252:255], v[240:243], v[100:103], a[252:255]
v_accvgpr_read_b32 v209, a233
v_accvgpr_read_b32 v210, a234
v_mfma_f32_16x16x32_bf16 a[252:255], v[244:247], v[104:107], a[252:255]
s_waitcnt lgkmcnt(4)
v_accvgpr_read_b32 v211, a235
v_mfma_f32_16x16x32_bf16 a[240:243], v[224:227], v[128:131], a[240:243]
v_cvt_pk_bf16_f32 v92, v208, v209
v_cvt_pk_bf16_f32 v93, v210, v211
v_mfma_f32_16x16x32_bf16 a[240:243], v[228:231], v[144:147], a[240:243]
v_accvgpr_read_b32 v216, a236
v_accvgpr_read_b32 v217, a237
v_mfma_f32_16x16x32_bf16 a[244:247], v[224:227], v[132:135], a[244:247]
v_accvgpr_read_b32 v218, a238
v_accvgpr_read_b32 v219, a239
v_mfma_f32_16x16x32_bf16 a[244:247], v[228:231], v[148:151], a[244:247]
v_cvt_pk_bf16_f32 v124, v216, v217
v_cvt_pk_bf16_f32 v125, v218, v219
v_mfma_f32_16x16x32_bf16 a[248:251], v[224:227], v[136:139], a[248:251]
v_mfma_f32_16x16x32_bf16 a[248:251], v[228:231], v[152:155], a[248:251]
v_mfma_f32_16x16x32_bf16 a[252:255], v[224:227], v[140:143], a[252:255]
v_mfma_f32_16x16x32_bf16 a[252:255], v[228:231], v[156:159], a[252:255]
s_waitcnt lgkmcnt(0)
v_mfma_f32_16x16x32_bf16 a[240:243], v[232:235], v[160:163], a[240:243]
v_mfma_f32_16x16x32_bf16 a[240:243], v[236:239], v[176:179], a[240:243]
v_mfma_f32_16x16x32_bf16 a[244:247], v[232:235], v[164:167], a[244:247]
v_mfma_f32_16x16x32_bf16 a[244:247], v[236:239], v[180:183], a[244:247]
v_mfma_f32_16x16x32_bf16 a[248:251], v[232:235], v[168:171], a[248:251]
v_mfma_f32_16x16x32_bf16 a[248:251], v[236:239], v[184:187], a[248:251]
v_mfma_f32_16x16x32_bf16 a[252:255], v[232:235], v[172:175], a[252:255]
s_nop 2
v_accvgpr_read_b32 v196, a240
v_accvgpr_read_b32 v197, a241
v_accvgpr_read_b32 v198, a242
v_accvgpr_read_b32 v199, a243
v_mfma_f32_16x16x32_bf16 a[252:255], v[236:239], v[188:191], a[252:255]
v_cvt_pk_bf16_f32 v30, v196, v197
v_cvt_pk_bf16_f32 v31, v198, v199
buffer_store_dwordx4 v[28:31], v252, s[20:23], s44 offen offset:3072 sc1
v_accvgpr_read_b32 v204, a244
v_accvgpr_read_b32 v205, a245
v_accvgpr_read_b32 v206, a246
v_accvgpr_read_b32 v207, a247
v_cvt_pk_bf16_f32 v62, v204, v205
v_cvt_pk_bf16_f32 v63, v206, v207
buffer_store_dwordx4 v[60:63], v252, s[20:23], s45 offen offset:3072 sc1
v_accvgpr_read_b32 v212, a248
v_accvgpr_read_b32 v213, a249
v_accvgpr_read_b32 v214, a250
v_accvgpr_read_b32 v215, a251
v_cvt_pk_bf16_f32 v94, v212, v213
v_cvt_pk_bf16_f32 v95, v214, v215
buffer_store_dwordx4 v[92:95], v252, s[20:23], s46 offen offset:3072 sc1
v_accvgpr_read_b32 v220, a252
v_accvgpr_read_b32 v221, a253
v_accvgpr_read_b32 v222, a254
v_accvgpr_read_b32 v223, a255
v_cvt_pk_bf16_f32 v126, v220, v221
v_cvt_pk_bf16_f32 v127, v222, v223
buffer_store_dwordx4 v[124:127], v252, s[20:23], s47 offen offset:3072 sc1
s_branch L2_chk
L2_chk:
LC_start:
s_cmp_lg_u64 vcc, 0
s_cselect_b32 s98, 1, 0
LC_again:
s_lshl_b32 s48, s38, 7
s_lshl_b32 s49, s38, 7
s_lshl_b32 s50, s38, 7
s_mov_b32 s51, s37
s_cmp_eq_u32 s37, 5
s_cselect_b32 s14, 1, 0
s_cselect_b32 s52, 0x7fff0000, s52
s_cselect_b32 s53, 0x7fff0000, s53
s_cselect_b32 s54, 0x7fff0000, s54
s_cmp_eq_u32 s34, 0
s_cselect_b32 s15, 0x6c00000, s52
s_cselect_b32 s15, s15, 0x7fff0000
LC_common:
s_nop 0
s_bfe_u32 s3, s2, 0x30003
s_lshl_b32 s13, s34, 4
s_or_b32 s13, s13, s3
s_lshl_b32 s13, s13, 11
s_lshr_b32 s101, s3, 1
s_xor_b32 s101, s101, s34
s_lshl_b32 s101, s101, 10
s_add_u32 s101, s101, s100
s_cmp_eq_u32 s14, 1
s_cselect_b32 s13, 0x7fff0000, s13
s_add_u32 s28, s4, 0x7000000
s_addc_u32 s29, s5, 0
s_mov_b32 s30, 0x4e2000
s_mov_b32 s31, 0x00020000
s_lshl_b32 s33, s34, 7
v_bfe_u32 v5, v252, 4, 3
v_lshrrev_b32 v6, 8, v252
v_xor_b32 v5, v5, v6
v_lshrrev_b32 v6, 7, v252
v_lshl_add_u32 v6, v6, 9, s33
v_lshl_add_u32 v5, v5, 4, v6
v_xor_b32 v6, 64, v5
v_add_u32 v6, 0x1000, v6
s_cmp_ge_u32 s99, 60
s_cbranch_scc0 LC_side
LC_sideok:
s_add_u32 m0, s101, 0
s_nop 0
buffer_load_dwordx4 v5, s[28:31], s52 offen sc1 lds
s_add_u32 m0, s101, 4096
s_nop 0
buffer_load_dwordx4 v6, s[28:31], s52 offen sc1 lds
s_add_u32 m0, s101, 8192
s_nop 0
buffer_load_dwordx4 v5, s[28:31], s53 offen sc1 lds
s_add_u32 m0, s101, 12288
s_nop 0
buffer_load_dwordx4 v6, s[28:31], s53 offen sc1 lds
s_add_u32 m0, s101, 16384
s_nop 0
buffer_load_dwordx4 v5, s[28:31], s54 offen sc1 lds
s_add_u32 m0, s101, 20480
s_nop 0
buffer_load_dwordx4 v6, s[28:31], s54 offen sc1 lds
s_xor_b32 s33, s13, 0x0
buffer_load_dwordx4 a[0:3], v252, s[56:59], s33 offen offset:0
buffer_load_dwordx4 a[4:7], v252, s[56:59], s33 offen offset:1024
s_xor_b32 s35, s13, 0x4000
buffer_load_dwordx4 a[64:67], v252, s[56:59], s35 offen offset:0
buffer_load_dwordx4 a[68:71], v252, s[56:59], s35 offen offset:1024
s_xor_b32 s39, s13, 0x800
buffer_load_dwordx4 a[8:11], v252, s[56:59], s39 offen offset:0
buffer_load_dwordx4 a[12:15], v252, s[56:59], s39 offen offset:1024
s_xor_b32 s32, s13, 0x4800
buffer_load_dwordx4 a[72:75], v252, s[56:59], s32 offen offset:0
buffer_load_dwordx4 a[76:79], v252, s[56:59], s32 offen offset:1024
s_lshl_b32 s32, s34, 2
s_add_u32 s32, s32, s100
s_and_b32 s33, s98, 1
v_mov_b32 v42, s32
v_mov_b32 v43, s33
ds_write_b32 v42, v43 offset:24576
v_lshrrev_b32 v0, 4, v252
v_and_b32 v2, 15, v0
v_lshrrev_b32 v3, 4, v0
s_add_u32 s8, s6, 0x0
s_addc_u32 s9, s7, 0
s_mov_b32 s10, 0x4e2000
s_mov_b32 s11, 0x00020000
s_lshl_b32 s55, s34, 13
s_add_u32 s55, s55, 0x21000
s_lshl_b32 s33, s34, 7
v_bfe_u32 v9, v252, 4, 3
v_lshrrev_b32 v1, 7, v252
v_xor_b32 v9, v9, v1
v_lshl_add_u32 v1, v1, 9, s33
v_lshl_add_u32 v9, v9, 4, v1
s_and_b32 s72, s100, 0x8000
s_lshl_b32 s73, s34, 11
s_add_u32 s73, s73, 0xe000
s_xor_b32 s73, s73, s72
v_mov_b32 v4, 0x7fff0000
v_cmp_eq_u32 vcc, 0, v3
v_mov_b32 v1, s52
s_nop 0
v_cndmask_b32 v4, v4, v1, vcc
v_cmp_eq_u32 vcc, 1, v3
v_mov_b32 v1, s53
s_nop 0
v_cndmask_b32 v4, v4, v1, vcc
v_cmp_eq_u32 vcc, 2, v3
v_mov_b32 v1, s54
s_nop 0
v_cndmask_b32 v4, v4, v1, vcc
v_lshl_add_u32 v4, v2, 9, v4
v_lshrrev_b32 v7, 3, v4
s_add_u32 s20, s4, 0x2000000
s_addc_u32 s21, s5, 0
s_mov_b32 s22, 0x22e4000
s_mov_b32 s23, 0x00020000
s_add_u32 s40, s18, 0x0
s_addc_u32 s41, s19, 0
s_mov_b32 s42, 0x4e2000
s_mov_b32 s43, 0x00020000
s_add_u32 s60, s4, 0x7c00000
s_addc_u32 s61, s5, 0
s_mov_b32 s12, 0xffff0000
v_mov_b32 v40, s48
s_lshl_b32 s33, s34, 11
v_add_u32 v10, s33, v252
s_lshl_b32 s32, s3, 10
v_xor_b32 v38, s32, v10
s_xor_b32 s32, s72, 0x8000
v_add_u32 v38, s32, v38
v_add_u32 v15, s32, v252
v_xor_b32 v39, 0x400, v38
v_lshrrev_b32 v1, 1, v2
v_xor_b32 v1, v1, v3
v_lshrrev_b32 v11, 3, v2
v_lshlrev_b32 v11, 12, v11
v_lshl_add_u32 v11, v1, 4, v11
v_and_b32 v1, 7, v2
v_lshl_add_u32 v11, v1, 7, v11
s_and_b32 s32, s3, 1
s_lshl_b32 s32, s32, 6
v_xor_b32 v11, s32, v11
v_add_u32 v11, s100, v11
v_xor_b32 v12, 64, v11
s_lshl_b32 s33, s34, 12
s_add_u32 s33, s33, 0x18000
s_xor_b32 s33, s33, s72
v_lshl_add_u32 v13, v0, 6, s33
s_lshl_b32 s32, s51, 2
s_add_u32 s33, s33, s32
v_lshl_add_u32 v14, v2, 6, s33
v_xor_b32 v1, v1, v3
v_lshlrev_b32 v1, 4, v1
v_lshl_add_u32 v1, v2, 7, v1
v_add_u32 v32, s55, v1
v_xor_b32 v33, 64, v32
v_add_u32 v35, s73, v1
v_xor_b32 v36, 64, v35
v_add_u32 v34, s55, v252
v_add_u32 v37, s73, v252
s_lshl_b32 s32, s34, 11
s_xor_b32 s33, s72, 0x1b000
s_cmp_lt_u32 s34, 2
s_cselect_b32 s33, 0x20000, s33
s_cselect_b32 s35, 13, 12
s_add_u32 s32, s32, s33
s_mul_i32 s33, s51, 3
s_add_u32 s39, s33, 0
s_and_b32 s39, s39, 3
s_lshl_b32 s39, s39, s35
s_add_u32 s39, s39, s32
v_add_u32 v44, s39, v252
s_add_u32 s39, s33, 1
s_and_b32 s39, s39, 3
s_lshl_b32 s39, s39, s35
s_add_u32 s39, s39, s32
v_add_u32 v45, s39, v252
s_add_u32 s39, s33, 2
s_and_b32 s39, s39, 3
s_lshl_b32 s39, s39, s35
s_add_u32 s39, s39, s32
v_add_u32 v46, s39, v252
s_add_u32 s32, s51, 1
s_sub_u32 s33, s32, 6
s_cselect_b32 s32, s32, s33
s_mul_i32 s44, s32, 0x600000
s_add_u32 s32, s51, 2
s_sub_u32 s33, s32, 6
s_cselect_b32 s32, s32, s33
s_mul_i32 s45, s32, 0x600000
s_add_u32 s32, s51, 3
s_sub_u32 s33, s32, 6
s_cselect_b32 s32, s32, s33
s_mul_i32 s46, s32, 0x600000
s_add_u32 s32, s51, 4
s_sub_u32 s33, s32, 6
s_cselect_b32 s32, s32, s33
s_mul_i32 s47, s32, 0x600000
v_mov_b32 v41, 1
v_and_b32 v42, 3, v0
v_lshl_add_u32 v42, v42, 2, s100
s_lshl_b32 s33, s34, 12
s_sub_u32 s33, s33, s72
s_cmp_lt_u32 s98, 2
s_cselect_b32 s33, s33, 0x100000
v_add_u32 v1, s33, v252
v_add_u32 v1, 0x1c000, v1
s_waitcnt vmcnt(14)
s_waitcnt lgkmcnt(0)
s_barrier
ds_read_b32 v43, v42 offset:24576
ds_write_b128 v1, v[16:19] offset:0
ds_write_b128 v1, v[20:23] offset:1024
ds_write_b128 v1, v[24:27] offset:2048
ds_write_b128 v1, v[28:31] offset:3072
s_waitcnt lgkmcnt(4)
v_cmp_ne_u32 vcc, 0, v43
s_cbranch_vccnz LC_slow
s_mov_b64 exec, 1
buffer_atomic_add v41, v40, s[56:59], s15 offen
s_mov_b64 exec, -1
s_cmp_eq_u32 s14, 1
s_cbranch_scc1 L2_fin
s_add_u32 s32, s51, 5
s_sub_u32 s33, s32, 6
s_cselect_b32 s32, s32, s33
s_mul_i32 s15, s32, 0x600000
s_add_u32 m0, s73, 0
s_add_u32 s33, s54, 0
buffer_load_dwordx4 v9, s[8:11], s33 offen lds
s_add_u32 m0, s73, 1024
s_add_u32 s35, s54, 4096
buffer_load_dwordx4 v9, s[8:11], s35 offen lds
s_xor_b32 s39, s13, 0x1000
buffer_load_dwordx4 a[16:19], v252, s[56:59], s39 offen offset:0
buffer_load_dwordx4 a[20:23], v252, s[56:59], s39 offen offset:1024
s_xor_b32 s32, s13, 0x5000
buffer_load_dwordx4 a[80:83], v252, s[56:59], s32 offen offset:0
buffer_load_dwordx4 a[84:87], v252, s[56:59], s32 offen offset:1024
s_xor_b32 s33, s13, 0x1800
buffer_load_dwordx4 a[24:27], v252, s[56:59], s33 offen offset:0
buffer_load_dwordx4 a[28:31], v252, s[56:59], s33 offen offset:1024
s_xor_b32 s35, s13, 0x5800
buffer_load_dwordx4 a[88:91], v252, s[56:59], s35 offen offset:0
buffer_load_dwordx4 a[92:95], v252, s[56:59], s35 offen offset:1024
s_xor_b32 s39, s13, 0x2000
buffer_load_dwordx4 a[32:35], v252, s[56:59], s39 offen offset:0
buffer_load_dwordx4 a[36:39], v252, s[56:59], s39 offen offset:1024
ds_read_b128 v[52:55], v32 offset:0
ds_read_b128 v[60:63], v33 offset:0
s_waitcnt lgkmcnt(1)
v_lshlrev_b32 v48, 16, v52
v_and_b32 v49, s12, v52
v_lshlrev_b32 v50, 16, v53
v_and_b32 v51, s12, v53
v_lshlrev_b32 v52, 16, v54
v_and_b32 v53, s12, v54
v_lshlrev_b32 v54, 16, v55
v_and_b32 v55, s12, v55
s_waitcnt lgkmcnt(0)
v_lshlrev_b32 v56, 16, v60
v_and_b32 v57, s12, v60
v_lshlrev_b32 v58, 16, v61
v_and_b32 v59, s12, v61
v_lshlrev_b32 v60, 16, v62
v_and_b32 v61, s12, v62
v_lshlrev_b32 v62, 16, v63
v_and_b32 v63, s12, v63
ds_read_b128 v[68:71], v32 offset:2048
ds_read_b128 v[76:79], v33 offset:2048
s_waitcnt lgkmcnt(1)
v_lshlrev_b32 v64, 16, v68
v_and_b32 v65, s12, v68
v_lshlrev_b32 v66, 16, v69
v_and_b32 v67, s12, v69
v_lshlrev_b32 v68, 16, v70
v_and_b32 v69, s12, v70
v_lshlrev_b32 v70, 16, v71
v_and_b32 v71, s12, v71
s_waitcnt lgkmcnt(0)
v_lshlrev_b32 v72, 16, v76
v_and_b32 v73, s12, v76
v_lshlrev_b32 v74, 16, v77
v_and_b32 v75, s12, v77
v_lshlrev_b32 v76, 16, v78
v_and_b32 v77, s12, v78
v_lshlrev_b32 v78, 16, v79
v_and_b32 v79, s12, v79
s_waitcnt vmcnt(11)
s_xor_b32 s32, s13, 0x6000
buffer_load_dwordx4 a[96:99], v252, s[56:59], s32 offen offset:0
s_waitcnt vmcnt(11)
buffer_load_dwordx4 a[100:103], v252, s[56:59], s32 offen offset:1024
s_waitcnt vmcnt(11)
s_xor_b32 s33, s13, 0x2800
buffer_load_dwordx4 a[40:43], v252, s[56:59], s33 offen offset:0
s_waitcnt vmcnt(11)
buffer_load_dwordx4 a[44:47], v252, s[56:59], s33 offen offset:1024
s_waitcnt vmcnt(11)
s_xor_b32 s35, s13, 0x6800
buffer_load_dwordx4 a[104:107], v252, s[56:59], s35 offen offset:0
s_waitcnt vmcnt(11)
buffer_load_dwordx4 a[108:111], v252, s[56:59], s35 offen offset:1024
s_waitcnt vmcnt(11)
s_mov_b32 s70, 0
s_atomic_add s70, s[60:61], s48 glc
s_waitcnt vmcnt(10)
s_xor_b32 s39, s13, 0x3000
buffer_load_dwordx4 a[48:51], v252, s[56:59], s39 offen offset:0
s_waitcnt vmcnt(10)
buffer_load_dwordx4 a[52:55], v252, s[56:59], s39 offen offset:1024
s_waitcnt vmcnt(10)
s_xor_b32 s32, s13, 0x7000
buffer_load_dwordx4 a[112:115], v252, s[56:59], s32 offen offset:0
s_waitcnt vmcnt(10)
buffer_load_dwordx4 a[116:119], v252, s[56:59], s32 offen offset:1024
s_waitcnt vmcnt(10)
s_xor_b32 s33, s13, 0x3800
buffer_load_dwordx4 a[56:59], v252, s[56:59], s33 offen offset:0
s_waitcnt vmcnt(10)
buffer_load_dwordx4 a[60:63], v252, s[56:59], s33 offen offset:1024
s_waitcnt vmcnt(10)
s_xor_b32 s35, s13, 0x7800
buffer_load_dwordx4 a[120:123], v252, s[56:59], s35 offen offset:0
s_waitcnt vmcnt(10)
buffer_load_dwordx4 a[124:127], v252, s[56:59], s35 offen offset:1024
s_waitcnt lgkmcnt(0)
s_cmp_lt_u32 s70, 6
s_cbranch_scc1 LC_poll
s_cmp_ge_u32 s98, 2
s_cbranch_scc1 LC_poll
LC_got:
buffer_load_dwordx4 v[156:159], v7, s[24:27], 0 offen offset:0 sc1
buffer_load_dwordx4 v[160:163], v7, s[24:27], 0 offen offset:16 sc1
buffer_load_dwordx4 v[164:167], v7, s[24:27], 0 offen offset:32 sc1
s_add_u32 s39, s52, s44
buffer_load_dwordx4 v[168:171], v10, s[20:23], s39 offen offset:0 sc1
s_add_u32 s32, s52, s45
buffer_load_dwordx4 v[172:175], v10, s[20:23], s32 offen offset:0 sc1
s_add_u32 s33, s52, s46
buffer_load_dwordx4 v[176:179], v10, s[20:23], s33 offen offset:0 sc1
s_add_u32 s35, s52, s47
buffer_load_dwordx4 v[180:183], v10, s[20:23], s35 offen offset:0 sc1
s_add_u32 s39, s52, s15
buffer_load_dwordx4 v[184:187], v10, s[20:23], s39 offen offset:0 sc1
s_add_u32 s32, s52, s44
buffer_load_dwordx4 v[188:191], v10, s[20:23], s32 offen offset:1024 sc1
s_add_u32 s33, s52, s45
buffer_load_dwordx4 v[192:195], v10, s[20:23], s33 offen offset:1024 sc1
s_add_u32 s35, s52, s46
buffer_load_dwordx4 v[196:199], v10, s[20:23], s35 offen offset:1024 sc1
s_add_u32 s39, s52, s47
buffer_load_dwordx4 v[200:203], v10, s[20:23], s39 offen offset:1024 sc1
s_add_u32 s32, s52, s15
buffer_load_dwordx4 v[204:207], v10, s[20:23], s32 offen offset:1024 sc1
s_xor_b32 s33, s13, 0x20000
buffer_load_dwordx4 a[128:131], v252, s[56:59], s33 offen offset:0
s_barrier
ds_read_b128 v[132:135], v11 offset:0
ds_read_b128 v[136:139], v11 offset:8192
ds_read_b128 v[140:143], v11 offset:16384
ds_read_b128 v[144:147], v12 offset:0
ds_read_b128 v[148:151], v12 offset:8192
s_waitcnt vmcnt(24)
s_waitcnt vmcnt(23)
s_waitcnt vmcnt(22)
s_waitcnt vmcnt(21)
s_waitcnt vmcnt(20)
s_waitcnt vmcnt(19)
s_waitcnt vmcnt(18)
s_waitcnt vmcnt(17)
s_waitcnt vmcnt(16)
s_waitcnt vmcnt(15)
s_waitcnt vmcnt(14)
s_waitcnt lgkmcnt(4)
v_mfma_f32_16x16x32_bf16 v[48:51], a[0:3], v[132:135], v[48:51]
ds_read_b128 v[152:155], v12 offset:16384
v_mfma_f32_16x16x32_bf16 v[52:55], a[4:7], v[132:135], v[52:55]
v_mfma_f32_16x16x32_bf16 v[56:59], a[64:67], v[132:135], v[56:59]
v_mfma_f32_16x16x32_bf16 v[60:63], a[68:71], v[132:135], v[60:63]
s_waitcnt lgkmcnt(4)
v_mfma_f32_16x16x32_bf16 v[64:67], a[0:3], v[136:139], v[64:67]
ds_read_b128 v[132:135], v11 offset:1024
v_mfma_f32_16x16x32_bf16 v[68:71], a[4:7], v[136:139], v[68:71]
v_mfma_f32_16x16x32_bf16 v[72:75], a[64:67], v[136:139], v[72:75]
v_mfma_f32_16x16x32_bf16 v[76:79], a[68:71], v[136:139], v[76:79]
ds_read_b128 v[84:87], v35 offset:0
ds_read_b128 v[92:95], v36 offset:0
s_waitcnt lgkmcnt(1)
v_lshlrev_b32 v80, 16, v84
v_and_b32 v81, s12, v84
v_lshlrev_b32 v82, 16, v85
v_and_b32 v83, s12, v85
v_lshlrev_b32 v84, 16, v86
v_and_b32 v85, s12, v86
v_lshlrev_b32 v86, 16, v87
v_and_b32 v87, s12, v87
s_waitcnt lgkmcnt(0)
v_lshlrev_b32 v88, 16, v92
v_and_b32 v89, s12, v92
v_lshlrev_b32 v90, 16, v93
v_and_b32 v91, s12, v93
v_lshlrev_b32 v92, 16, v94
v_and_b32 v93, s12, v94
v_lshlrev_b32 v94, 16, v95
v_and_b32 v95, s12, v95
v_mfma_f32_16x16x32_bf16 v[80:83], a[0:3], v[140:143], v[80:83]
ds_read_b128 v[136:139], v11 offset:9216
v_mfma_f32_16x16x32_bf16 v[84:87], a[4:7], v[140:143], v[84:87]
v_mfma_f32_16x16x32_bf16 v[88:91], a[64:67], v[140:143], v[88:91]
v_mfma_f32_16x16x32_bf16 v[92:95], a[68:71], v[140:143], v[92:95]
v_mfma_f32_16x16x32_bf16 v[48:51], a[8:11], v[144:147], v[48:51]
ds_read_b128 v[140:143], v11 offset:17408
v_mfma_f32_16x16x32_bf16 v[52:55], a[12:15], v[144:147], v[52:55]
v_mfma_f32_16x16x32_bf16 v[56:59], a[72:75], v[144:147], v[56:59]
v_mfma_f32_16x16x32_bf16 v[60:63], a[76:79], v[144:147], v[60:63]
v_mfma_f32_16x16x32_bf16 v[64:67], a[8:11], v[148:151], v[64:67]
ds_read_b128 v[144:147], v12 offset:1024
v_mfma_f32_16x16x32_bf16 v[68:71], a[12:15], v[148:151], v[68:71]
v_mfma_f32_16x16x32_bf16 v[72:75], a[72:75], v[148:151], v[72:75]
v_mfma_f32_16x16x32_bf16 v[76:79], a[76:79], v[148:151], v[76:79]
v_mfma_f32_16x16x32_bf16 v[80:83], a[8:11], v[152:155], v[80:83]
ds_read_b128 v[148:151], v12 offset:9216
v_mfma_f32_16x16x32_bf16 v[84:87], a[12:15], v[152:155], v[84:87]
v_mfma_f32_16x16x32_bf16 v[88:91], a[72:75], v[152:155], v[88:91]
v_mfma_f32_16x16x32_bf16 v[92:95], a[76:79], v[152:155], v[92:95]
v_mfma_f32_16x16x32_bf16 v[48:51], a[16:19], v[132:135], v[48:51]
ds_read_b128 v[152:155], v12 offset:17408
v_mfma_f32_16x16x32_bf16 v[52:55], a[20:23], v[132:135], v[52:55]
v_mfma_f32_16x16x32_bf16 v[56:59], a[80:83], v[132:135], v[56:59]
v_mfma_f32_16x16x32_bf16 v[60:63], a[84:87], v[132:135], v[60:63]
s_waitcnt lgkmcnt(4)
v_mfma_f32_16x16x32_bf16 v[64:67], a[16:19], v[136:139], v[64:67]
ds_read_b128 v[132:135], v11 offset:2048
v_mfma_f32_16x16x32_bf16 v[68:71], a[20:23], v[136:139], v[68:71]
v_mfma_f32_16x16x32_bf16 v[72:75], a[80:83], v[136:139], v[72:75]
v_mfma_f32_16x16x32_bf16 v[76:79], a[84:87], v[136:139], v[76:79]
s_waitcnt lgkmcnt(4)
v_mfma_f32_16x16x32_bf16 v[80:83], a[16:19], v[140:143], v[80:83]
ds_read_b128 v[136:139], v11 offset:10240
v_mfma_f32_16x16x32_bf16 v[84:87], a[20:23], v[140:143], v[84:87]
v_mfma_f32_16x16x32_bf16 v[88:91], a[80:83], v[140:143], v[88:91]
v_mfma_f32_16x16x32_bf16 v[92:95], a[84:87], v[140:143], v[92:95]
s_waitcnt lgkmcnt(4)
v_mfma_f32_16x16x32_bf16 v[48:51], a[24:27], v[144:147], v[48:51]
ds_read_b128 v[140:143], v11 offset:18432
v_mfma_f32_16x16x32_bf16 v[52:55], a[28:31], v[144:147], v[52:55]
v_mfma_f32_16x16x32_bf16 v[56:59], a[88:91], v[144:147], v[56:59]
v_mfma_f32_16x16x32_bf16 v[60:63], a[92:95], v[144:147], v[60:63]
s_waitcnt lgkmcnt(4)
v_mfma_f32_16x16x32_bf16 v[64:67], a[24:27], v[148:151], v[64:67]
ds_read_b128 v[144:147], v12 offset:2048
v_mfma_f32_16x16x32_bf16 v[68:71], a[28:31], v[148:151], v[68:71]
v_mfma_f32_16x16x32_bf16 v[72:75], a[88:91], v[148:151], v[72:75]
v_mfma_f32_16x16x32_bf16 v[76:79], a[92:95], v[148:151], v[76:79]
s_waitcnt lgkmcnt(4)
v_mfma_f32_16x16x32_bf16 v[80:83], a[24:27], v[152:155], v[80:83]
ds_read_b128 v[148:151], v12 offset:10240
v_mfma_f32_16x16x32_bf16 v[84:87], a[28:31], v[152:155], v[84:87]
v_mfma_f32_16x16x32_bf16 v[88:91], a[88:91], v[152:155], v[88:91]
v_mfma_f32_16x16x32_bf16 v[92:95], a[92:95], v[152:155], v[92:95]
s_waitcnt lgkmcnt(4)
v_mfma_f32_16x16x32_bf16 v[48:51], a[32:35], v[132:135], v[48:51]
ds_read_b128 v[152:155], v12 offset:18432
v_mfma_f32_16x16x32_bf16 v[52:55], a[36:39], v[132:135], v[52:55]
v_mfma_f32_16x16x32_bf16 v[56:59], a[96:99], v[132:135], v[56:59]
v_mfma_f32_16x16x32_bf16 v[60:63], a[100:103], v[132:135], v[60:63]
s_waitcnt lgkmcnt(4)
v_mfma_f32_16x16x32_bf16 v[64:67], a[32:35], v[136:139], v[64:67]
ds_read_b128 v[132:135], v11 offset:3072
v_mfma_f32_16x16x32_bf16 v[68:71], a[36:39], v[136:139], v[68:71]
v_mfma_f32_16x16x32_bf16 v[72:75], a[96:99], v[136:139], v[72:75]
v_mfma_f32_16x16x32_bf16 v[76:79], a[100:103], v[136:139], v[76:79]
s_waitcnt lgkmcnt(4)
v_mfma_f32_16x16x32_bf16 v[80:83], a[32:35], v[140:143], v[80:83]
ds_read_b128 v[136:139], v11 offset:11264
v_mfma_f32_16x16x32_bf16 v[84:87], a[36:39], v[140:143], v[84:87]
v_mfma_f32_16x16x32_bf16 v[88:91], a[96:99], v[140:143], v[88:91]
v_mfma_f32_16x16x32_bf16 v[92:95], a[100:103], v[140:143], v[92:95]
s_waitcnt lgkmcnt(4)
v_mfma_f32_16x16x32_bf16 v[48:51], a[40:43], v[144:147], v[48:51]
ds_read_b128 v[140:143], v11 offset:19456
v_mfma_f32_16x16x32_bf16 v[52:55], a[44:47], v[144:147], v[52:55]
v_mfma_f32_16x16x32_bf16 v[56:59], a[104:107], v[144:147], v[56:59]
v_mfma_f32_16x16x32_bf16 v[60:63], a[108:111], v[144:147], v[60:63]
s_waitcnt lgkmcnt(4)
v_mfma_f32_16x16x32_bf16 v[64:67], a[40:43], v[148:151], v[64:67]
ds_read_b128 v[144:147], v12 offset:3072
v_mfma_f32_16x16x32_bf16 v[68:71], a[44:47], v[148:151], v[68:71]
v_mfma_f32_16x16x32_bf16 v[72:75], a[104:107], v[148:151], v[72:75]
v_mfma_f32_16x16x32_bf16 v[76:79], a[108:111], v[148:151], v[76:79]
s_waitcnt lgkmcnt(4)
v_mfma_f32_16x16x32_bf16 v[80:83], a[40:43], v[152:155], v[80:83]
ds_read_b128 v[148:151], v12 offset:11264
v_mfma_f32_16x16x32_bf16 v[84:87], a[44:47], v[152:155], v[84:87]
v_mfma_f32_16x16x32_bf16 v[88:91], a[104:107], v[152:155], v[88:91]
v_mfma_f32_16x16x32_bf16 v[92:95], a[108:111], v[152:155], v[92:95]
s_waitcnt lgkmcnt(4)
v_mfma_f32_16x16x32_bf16 v[48:51], a[48:51], v[132:135], v[48:51]
ds_read_b128 v[152:155], v12 offset:19456
v_mfma_f32_16x16x32_bf16 v[52:55], a[52:55], v[132:135], v[52:55]
v_mfma_f32_16x16x32_bf16 v[56:59], a[112:115], v[132:135], v[56:59]
v_mfma_f32_16x16x32_bf16 v[60:63], a[116:119], v[132:135], v[60:63]
s_waitcnt lgkmcnt(4)
v_mfma_f32_16x16x32_bf16 v[64:67], a[48:51], v[136:139], v[64:67]
v_mfma_f32_16x16x32_bf16 v[68:71], a[52:55], v[136:139], v[68:71]
v_mfma_f32_16x16x32_bf16 v[72:75], a[112:115], v[136:139], v[72:75]
v_mfma_f32_16x16x32_bf16 v[76:79], a[116:119], v[136:139], v[76:79]
s_waitcnt lgkmcnt(3)
v_mfma_f32_16x16x32_bf16 v[80:83], a[48:51], v[140:143], v[80:83]
v_mfma_f32_16x16x32_bf16 v[84:87], a[52:55], v[140:143], v[84:87]
v_mfma_f32_16x16x32_bf16 v[88:91], a[112:115], v[140:143], v[88:91]
v_mfma_f32_16x16x32_bf16 v[92:95], a[116:119], v[140:143], v[92:95]
s_waitcnt lgkmcnt(2)
v_mfma_f32_16x16x32_bf16 v[48:51], a[56:59], v[144:147], v[48:51]
v_mfma_f32_16x16x32_bf16 v[52:55], a[60:63], v[144:147], v[52:55]
v_mfma_f32_16x16x32_bf16 v[56:59], a[120:123], v[144:147], v[56:59]
v_mfma_f32_16x16x32_bf16 v[60:63], a[124:127], v[144:147], v[60:63]
s_waitcnt lgkmcnt(1)
v_mfma_f32_16x16x32_bf16 v[64:67], a[56:59], v[148:151], v[64:67]
v_mfma_f32_16x16x32_bf16 v[68:71], a[60:63], v[148:151], v[68:71]
v_mfma_f32_16x16x32_bf16 v[72:75], a[120:123], v[148:151], v[72:75]
v_mfma_f32_16x16x32_bf16 v[76:79], a[124:127], v[148:151], v[76:79]
s_waitcnt lgkmcnt(0)
v_mfma_f32_16x16x32_bf16 v[80:83], a[56:59], v[152:155], v[80:83]
v_mfma_f32_16x16x32_bf16 v[84:87], a[60:63], v[152:155], v[84:87]
v_mfma_f32_16x16x32_bf16 v[88:91], a[120:123], v[152:155], v[88:91]
v_mfma_f32_16x16x32_bf16 v[92:95], a[124:127], v[152:155], v[92:95]
s_waitcnt vmcnt(13)
buffer_load_dwordx4 a[132:135], v252, s[56:59], s33 offen offset:1024
s_waitcnt vmcnt(13)
s_xor_b32 s35, s13, 0x24000
buffer_load_dwordx4 a[192:195], v252, s[56:59], s35 offen offset:0
s_waitcnt vmcnt(13)
buffer_load_dwordx4 a[196:199], v252, s[56:59], s35 offen offset:1024
v_max3_f32 v1, v156, v158, v160
v_max3_f32 v117, v162, v164, v166
v_max_f32 v1, v1, v117
v_sub_f32 v156, v156, v1
v_sub_f32 v158, v158, v1
v_sub_f32 v160, v160, v1
v_sub_f32 v162, v162, v1
v_sub_f32 v164, v164, v1
v_sub_f32 v166, v166, v1
v_exp_f32 v156, v156
v_exp_f32 v158, v158
v_exp_f32 v160, v160
v_exp_f32 v162, v162
v_exp_f32 v164, v164
v_exp_f32 v166, v166
s_nop 0
v_mul_f32 v1, v156, v157
v_fmac_f32 v1, v158, v159
v_fmac_f32 v1, v160, v161
v_fmac_f32 v1, v162, v163
v_fmac_f32 v1, v164, v165
v_fmac_f32 v1, v166, v167
v_rcp_f32 v1, v1
s_nop 0
v_mul_f32 v108, v156, v1
v_mul_f32 v109, v158, v1
v_mul_f32 v110, v160, v1
v_mul_f32 v111, v162, v1
v_mul_f32 v112, v164, v1
v_mul_f32 v113, v166, v1
v_mul_f32 v114, v156, v1
v_mul_f32 v115, v158, v1
ds_write_b128 v13, v[108:111]
ds_write_b128 v13, v[112:115] offset:16
ds_write_b64 v13, v[110:111] offset:32
ds_write_b64 v13, v[112:113] offset:40
ds_read2_b32 v[100:101], v14 offset0:1 offset1:2
ds_read2_b32 v[102:103], v14 offset0:3 offset1:4
ds_read2_b32 v[104:105], v14 offset0:5 offset1:6
v_add_u32 v14, 0x400, v14
s_waitcnt vmcnt(13)
s_xor_b32 s39, s13, 0x20800
buffer_load_dwordx4 a[136:139], v252, s[56:59], s39 offen offset:0
ds_read_b128 v[96:99], v44 offset:0
s_waitcnt lgkmcnt(1)
v_lshlrev_b32 v118, 16, v168
v_and_b32 v119, s12, v168
v_mul_f32 v108, v118, v100
v_mul_f32 v109, v119, v100
v_lshlrev_b32 v120, 16, v169
v_and_b32 v121, s12, v169
v_mul_f32 v110, v120, v100
v_mul_f32 v111, v121, v100
v_lshlrev_b32 v122, 16, v170
v_and_b32 v123, s12, v170
v_mul_f32 v112, v122, v100
v_mul_f32 v113, v123, v100
v_lshlrev_b32 v116, 16, v171
v_and_b32 v117, s12, v171
v_mul_f32 v114, v116, v100
v_mul_f32 v115, v117, v100
s_waitcnt vmcnt(13)
buffer_load_dwordx4 a[140:143], v252, s[56:59], s39 offen offset:1024
v_lshlrev_b32 v118, 16, v172
v_and_b32 v119, s12, v172
v_fmac_f32 v108, v118, v101
v_fmac_f32 v109, v119, v101
v_lshlrev_b32 v120, 16, v173
v_and_b32 v121, s12, v173
v_fmac_f32 v110, v120, v101
v_fmac_f32 v111, v121, v101
v_lshlrev_b32 v122, 16, v174
v_and_b32 v123, s12, v174
v_fmac_f32 v112, v122, v101
v_fmac_f32 v113, v123, v101
v_lshlrev_b32 v116, 16, v175
v_and_b32 v117, s12, v175
v_fmac_f32 v114, v116, v101
v_fmac_f32 v115, v117, v101
s_waitcnt lgkmcnt(0)
v_lshlrev_b32 v118, 16, v96
v_and_b32 v119, s12, v96
v_fmac_f32 v108, v118, v105
v_fmac_f32 v109, v119, v105
v_lshlrev_b32 v120, 16, v97
v_and_b32 v121, s12, v97
v_fmac_f32 v110, v120, v105
v_fmac_f32 v111, v121, v105
v_lshlrev_b32 v122, 16, v98
v_and_b32 v123, s12, v98
v_fmac_f32 v112, v122, v105
v_fmac_f32 v113, v123, v105
v_lshlrev_b32 v116, 16, v99
v_and_b32 v117, s12, v99
v_fmac_f32 v114, v116, v105
v_fmac_f32 v115, v117, v105
s_waitcnt vmcnt(13)
s_xor_b32 s32, s13, 0x24800
buffer_load_dwordx4 a[200:203], v252, s[56:59], s32 offen offset:0
v_lshlrev_b32 v118, 16, v176
v_and_b32 v119, s12, v176
v_fmac_f32 v108, v118, v102
v_fmac_f32 v109, v119, v102
v_lshlrev_b32 v120, 16, v177
v_and_b32 v121, s12, v177
v_fmac_f32 v110, v120, v102
v_fmac_f32 v111, v121, v102
v_lshlrev_b32 v122, 16, v178
v_and_b32 v123, s12, v178
v_fmac_f32 v112, v122, v102
v_fmac_f32 v113, v123, v102
v_lshlrev_b32 v116, 16, v179
v_and_b32 v117, s12, v179
v_fmac_f32 v114, v116, v102
v_fmac_f32 v115, v117, v102
s_waitcnt vmcnt(13)
buffer_load_dwordx4 a[204:207], v252, s[56:59], s32 offen offset:1024
v_lshlrev_b32 v118, 16, v180
v_and_b32 v119, s12, v180
v_fmac_f32 v108, v118, v103
v_fmac_f32 v109, v119, v103
v_lshlrev_b32 v120, 16, v181
v_and_b32 v121, s12, v181
v_fmac_f32 v110, v120, v103
v_fmac_f32 v111, v121, v103
v_lshlrev_b32 v122, 16, v182
v_and_b32 v123, s12, v182
v_fmac_f32 v112, v122, v103
v_fmac_f32 v113, v123, v103
v_lshlrev_b32 v116, 16, v183
v_and_b32 v117, s12, v183
v_fmac_f32 v114, v116, v103
v_fmac_f32 v115, v117, v103
s_waitcnt vmcnt(13)
s_add_u32 s33, s53, s44
buffer_load_dwordx4 v[208:211], v10, s[20:23], s33 offen offset:0 sc1
v_lshlrev_b32 v118, 16, v184
v_and_b32 v119, s12, v184
v_fmac_f32 v108, v118, v104
v_fmac_f32 v109, v119, v104
v_lshlrev_b32 v120, 16, v185
v_and_b32 v121, s12, v185
v_fmac_f32 v110, v120, v104
v_fmac_f32 v111, v121, v104
v_lshlrev_b32 v122, 16, v186
v_and_b32 v123, s12, v186
v_fmac_f32 v112, v122, v104
v_fmac_f32 v113, v123, v104
v_lshlrev_b32 v116, 16, v187
v_and_b32 v117, s12, v187
v_fmac_f32 v114, v116, v104
v_fmac_f32 v115, v117, v104
v_cvt_pk_bf16_f32 v116, v108, v109
v_cvt_pk_bf16_f32 v117, v110, v111
v_cvt_pk_bf16_f32 v118, v112, v113
v_cvt_pk_bf16_f32 v119, v114, v115
ds_write_b128 v38, v[116:119] offset:0
s_waitcnt vmcnt(13)
s_xor_b32 s35, s13, 0x21000
buffer_load_dwordx4 a[144:147], v252, s[56:59], s35 offen offset:0
ds_read_b128 v[96:99], v44 offset:1024
v_lshlrev_b32 v118, 16, v188
v_and_b32 v119, s12, v188
v_mul_f32 v108, v118, v100
v_mul_f32 v109, v119, v100
v_lshlrev_b32 v120, 16, v189
v_and_b32 v121, s12, v189
v_mul_f32 v110, v120, v100
v_mul_f32 v111, v121, v100
v_lshlrev_b32 v122, 16, v190
v_and_b32 v123, s12, v190
v_mul_f32 v112, v122, v100
v_mul_f32 v113, v123, v100
v_lshlrev_b32 v116, 16, v191
v_and_b32 v117, s12, v191
v_mul_f32 v114, v116, v100
v_mul_f32 v115, v117, v100
s_waitcnt vmcnt(13)
buffer_load_dwordx4 a[148:151], v252, s[56:59], s35 offen offset:1024
v_lshlrev_b32 v118, 16, v192
v_and_b32 v119, s12, v192
v_fmac_f32 v108, v118, v101
v_fmac_f32 v109, v119, v101
v_lshlrev_b32 v120, 16, v193
v_and_b32 v121, s12, v193
v_fmac_f32 v110, v120, v101
v_fmac_f32 v111, v121, v101
v_lshlrev_b32 v122, 16, v194
v_and_b32 v123, s12, v194
v_fmac_f32 v112, v122, v101
v_fmac_f32 v113, v123, v101
v_lshlrev_b32 v116, 16, v195
v_and_b32 v117, s12, v195
v_fmac_f32 v114, v116, v101
v_fmac_f32 v115, v117, v101
s_waitcnt lgkmcnt(0)
v_lshlrev_b32 v118, 16, v96
v_and_b32 v119, s12, v96
v_fmac_f32 v108, v118, v105
v_fmac_f32 v109, v119, v105
v_lshlrev_b32 v120, 16, v97
v_and_b32 v121, s12, v97
v_fmac_f32 v110, v120, v105
v_fmac_f32 v111, v121, v105
v_lshlrev_b32 v122, 16, v98
v_and_b32 v123, s12, v98
v_fmac_f32 v112, v122, v105
v_fmac_f32 v113, v123, v105
v_lshlrev_b32 v116, 16, v99
v_and_b32 v117, s12, v99
v_fmac_f32 v114, v116, v105
v_fmac_f32 v115, v117, v105
s_waitcnt vmcnt(13)
s_add_u32 s39, s53, s45
buffer_load_dwordx4 v[212:215], v10, s[20:23], s39 offen offset:0 sc1
v_lshlrev_b32 v118, 16, v196
v_and_b32 v119, s12, v196
v_fmac_f32 v108, v118, v102
v_fmac_f32 v109, v119, v102
v_lshlrev_b32 v120, 16, v197
v_and_b32 v121, s12, v197
v_fmac_f32 v110, v120, v102
v_fmac_f32 v111, v121, v102
v_lshlrev_b32 v122, 16, v198
v_and_b32 v123, s12, v198
v_fmac_f32 v112, v122, v102
v_fmac_f32 v113, v123, v102
v_lshlrev_b32 v116, 16, v199
v_and_b32 v117, s12, v199
v_fmac_f32 v114, v116, v102
v_fmac_f32 v115, v117, v102
s_waitcnt vmcnt(13)
s_xor_b32 s32, s13, 0x25000
buffer_load_dwordx4 a[208:211], v252, s[56:59], s32 offen offset:0
v_lshlrev_b32 v118, 16, v200
v_and_b32 v119, s12, v200
v_fmac_f32 v108, v118, v103
v_fmac_f32 v109, v119, v103
v_lshlrev_b32 v120, 16, v201
v_and_b32 v121, s12, v201
v_fmac_f32 v110, v120, v103
v_fmac_f32 v111, v121, v103
v_lshlrev_b32 v122, 16, v202
v_and_b32 v123, s12, v202
v_fmac_f32 v112, v122, v103
v_fmac_f32 v113, v123, v103
v_lshlrev_b32 v116, 16, v203
v_and_b32 v117, s12, v203
v_fmac_f32 v114, v116, v103
v_fmac_f32 v115, v117, v103
s_waitcnt vmcnt(13)
buffer_load_dwordx4 a[212:215], v252, s[56:59], s32 offen offset:1024
v_lshlrev_b32 v118, 16, v204
v_and_b32 v119, s12, v204
v_fmac_f32 v108, v118, v104
v_fmac_f32 v109, v119, v104
v_lshlrev_b32 v120, 16, v205
v_and_b32 v121, s12, v205
v_fmac_f32 v110, v120, v104
v_fmac_f32 v111, v121, v104
v_lshlrev_b32 v122, 16, v206
v_and_b32 v123, s12, v206
v_fmac_f32 v112, v122, v104
v_fmac_f32 v113, v123, v104
v_lshlrev_b32 v116, 16, v207
v_and_b32 v117, s12, v207
v_fmac_f32 v114, v116, v104
v_fmac_f32 v115, v117, v104
ds_read2_b32 v[100:101], v14 offset0:1 offset1:2
ds_read2_b32 v[102:103], v14 offset0:3 offset1:4
ds_read2_b32 v[104:105], v14 offset0:5 offset1:6
v_add_u32 v14, 0x400, v14
v_cvt_pk_bf16_f32 v116, v108, v109
v_cvt_pk_bf16_f32 v117, v110, v111
v_cvt_pk_bf16_f32 v118, v112, v113
v_cvt_pk_bf16_f32 v119, v114, v115
ds_write_b128 v39, v[116:119] offset:0
s_waitcnt vmcnt(13)
s_add_u32 s33, s53, s46
buffer_load_dwordx4 v[216:219], v10, s[20:23], s33 offen offset:0 sc1
s_waitcnt vmcnt(13)
s_xor_b32 s35, s13, 0x21800
buffer_load_dwordx4 a[152:155], v252, s[56:59], s35 offen offset:0
s_waitcnt vmcnt(13)
buffer_load_dwordx4 a[156:159], v252, s[56:59], s35 offen offset:1024
s_waitcnt vmcnt(13)
s_add_u32 s39, s53, s47
buffer_load_dwordx4 v[220:223], v10, s[20:23], s39 offen offset:0 sc1
s_waitcnt vmcnt(13)
s_xor_b32 s32, s13, 0x25800
buffer_load_dwordx4 a[216:219], v252, s[56:59], s32 offen offset:0
s_waitcnt vmcnt(13)
buffer_load_dwordx4 a[220:223], v252, s[56:59], s32 offen offset:1024
s_waitcnt vmcnt(13)
s_add_u32 s33, s53, s15
buffer_load_dwordx4 v[224:227], v10, s[20:23], s33 offen offset:0 sc1
s_waitcnt vmcnt(13)
s_xor_b32 s35, s13, 0x22000
buffer_load_dwordx4 a[160:163], v252, s[56:59], s35 offen offset:0
s_waitcnt lgkmcnt(0)
s_barrier
ds_read_b128 v[132:135], v15 offset:0
ds_read_b128 v[136:139], v15 offset:1024
ds_read_b128 v[140:143], v15 offset:2048
ds_read_b128 v[144:147], v15 offset:3072
ds_read_b128 v[148:151], v15 offset:4096
s_waitcnt lgkmcnt(4)
v_mfma_f32_16x16x32_bf16 v[48:51], a[128:131], v[132:135], v[48:51]
ds_read_b128 v[152:155], v15 offset:5120
v_mfma_f32_16x16x32_bf16 v[52:55], a[132:135], v[132:135], v[52:55]
v_mfma_f32_16x16x32_bf16 v[56:59], a[192:195], v[132:135], v[56:59]
v_mfma_f32_16x16x32_bf16 v[60:63], a[196:199], v[132:135], v[60:63]
s_waitcnt vmcnt(13)
buffer_load_dwordx4 a[164:167], v252, s[56:59], s35 offen offset:1024
s_waitcnt lgkmcnt(4)
v_mfma_f32_16x16x32_bf16 v[48:51], a[136:139], v[136:139], v[48:51]
ds_read_b128 v[132:135], v15 offset:6144
ds_read_b128 v[96:99], v45 offset:0
v_lshlrev_b32 v118, 16, v208
v_and_b32 v119, s12, v208
v_mfma_f32_16x16x32_bf16 v[52:55], a[140:143], v[136:139], v[52:55]
v_mul_f32 v108, v118, v100
v_mul_f32 v109, v119, v100
v_lshlrev_b32 v120, 16, v209
v_mfma_f32_16x16x32_bf16 v[56:59], a[200:203], v[136:139], v[56:59]
v_and_b32 v121, s12, v209
v_mul_f32 v110, v120, v100
v_mul_f32 v111, v121, v100
v_mfma_f32_16x16x32_bf16 v[60:63], a[204:207], v[136:139], v[60:63]
v_lshlrev_b32 v122, 16, v210
v_and_b32 v123, s12, v210
v_mul_f32 v112, v122, v100
v_mul_f32 v113, v123, v100
v_lshlrev_b32 v116, 16, v211
v_and_b32 v117, s12, v211
v_mul_f32 v114, v116, v100
v_mul_f32 v115, v117, v100
s_waitcnt vmcnt(13)
s_add_u32 s39, s53, s44
buffer_load_dwordx4 v[228:231], v10, s[20:23], s39 offen offset:1024 sc1
s_waitcnt vmcnt(13)
s_xor_b32 s32, s13, 0x26000
buffer_load_dwordx4 a[224:227], v252, s[56:59], s32 offen offset:0
s_waitcnt vmcnt(13)
buffer_load_dwordx4 a[228:231], v252, s[56:59], s32 offen offset:1024
v_lshlrev_b32 v118, 16, v212
v_and_b32 v119, s12, v212
v_fmac_f32 v108, v118, v101
v_fmac_f32 v109, v119, v101
v_lshlrev_b32 v120, 16, v213
v_and_b32 v121, s12, v213
v_fmac_f32 v110, v120, v101
v_fmac_f32 v111, v121, v101
v_lshlrev_b32 v122, 16, v214
v_and_b32 v123, s12, v214
v_fmac_f32 v112, v122, v101
v_fmac_f32 v113, v123, v101
v_lshlrev_b32 v116, 16, v215
v_and_b32 v117, s12, v215
v_fmac_f32 v114, v116, v101
v_fmac_f32 v115, v117, v101
s_waitcnt lgkmcnt(0)
v_lshlrev_b32 v118, 16, v96
v_and_b32 v119, s12, v96
v_fmac_f32 v108, v118, v105
v_fmac_f32 v109, v119, v105
v_lshlrev_b32 v120, 16, v97
v_and_b32 v121, s12, v97
v_fmac_f32 v110, v120, v105
v_fmac_f32 v111, v121, v105
v_lshlrev_b32 v122, 16, v98
v_and_b32 v123, s12, v98
v_fmac_f32 v112, v122, v105
v_fmac_f32 v113, v123, v105
v_lshlrev_b32 v116, 16, v99
v_and_b32 v117, s12, v99
v_fmac_f32 v114, v116, v105
v_fmac_f32 v115, v117, v105
s_waitcnt vmcnt(13)
s_add_u32 s33, s53, s45
buffer_load_dwordx4 v[232:235], v10, s[20:23], s33 offen offset:1024 sc1
s_waitcnt vmcnt(13)
s_xor_b32 s35, s13, 0x22800
buffer_load_dwordx4 a[168:171], v252, s[56:59], s35 offen offset:0
v_mfma_f32_16x16x32_bf16 v[48:51], a[144:147], v[140:143], v[48:51]
v_mfma_f32_16x16x32_bf16 v[52:55], a[148:151], v[140:143], v[52:55]
v_mfma_f32_16x16x32_bf16 v[56:59], a[208:211], v[140:143], v[56:59]
v_mfma_f32_16x16x32_bf16 v[60:63], a[212:215], v[140:143], v[60:63]
s_waitcnt vmcnt(13)
buffer_load_dwordx4 a[172:175], v252, s[56:59], s35 offen offset:1024
v_lshlrev_b32 v118, 16, v216
v_and_b32 v119, s12, v216
v_fmac_f32 v108, v118, v102
v_fmac_f32 v109, v119, v102
v_lshlrev_b32 v120, 16, v217
v_and_b32 v121, s12, v217
v_fmac_f32 v110, v120, v102
v_fmac_f32 v111, v121, v102
v_lshlrev_b32 v122, 16, v218
v_and_b32 v123, s12, v218
v_fmac_f32 v112, v122, v102
v_fmac_f32 v113, v123, v102
v_lshlrev_b32 v116, 16, v219
v_and_b32 v117, s12, v219
v_fmac_f32 v114, v116, v102
v_fmac_f32 v115, v117, v102
s_waitcnt vmcnt(13)
s_add_u32 s39, s53, s46
buffer_load_dwordx4 v[236:239], v10, s[20:23], s39 offen offset:1024 sc1
s_waitcnt vmcnt(13)
s_xor_b32 s32, s13, 0x26800
buffer_load_dwordx4 a[232:235], v252, s[56:59], s32 offen offset:0
s_waitcnt vmcnt(13)
buffer_load_dwordx4 a[236:239], v252, s[56:59], s32 offen offset:1024
v_lshlrev_b32 v118, 16, v220
v_and_b32 v119, s12, v220
v_fmac_f32 v108, v118, v103
v_fmac_f32 v109, v119, v103
v_lshlrev_b32 v120, 16, v221
v_and_b32 v121, s12, v221
v_fmac_f32 v110, v120, v103
v_fmac_f32 v111, v121, v103
v_lshlrev_b32 v122, 16, v222
v_and_b32 v123, s12, v222
v_fmac_f32 v112, v122, v103
v_fmac_f32 v113, v123, v103
v_lshlrev_b32 v116, 16, v223
v_and_b32 v117, s12, v223
v_fmac_f32 v114, v116, v103
v_fmac_f32 v115, v117, v103
s_waitcnt vmcnt(13)
s_add_u32 s33, s53, s47
buffer_load_dwordx4 v[240:243], v10, s[20:23], s33 offen offset:1024 sc1
s_waitcnt vmcnt(13)
s_xor_b32 s35, s13, 0x23000
buffer_load_dwordx4 a[176:179], v252, s[56:59], s35 offen offset:0
v_mfma_f32_16x16x32_bf16 v[48:51], a[152:155], v[144:147], v[48:51]
v_mfma_f32_16x16x32_bf16 v[52:55], a[156:159], v[144:147], v[52:55]
v_mfma_f32_16x16x32_bf16 v[56:59], a[216:219], v[144:147], v[56:59]
v_mfma_f32_16x16x32_bf16 v[60:63], a[220:223], v[144:147], v[60:63]
s_waitcnt vmcnt(13)
buffer_load_dwordx4 a[180:183], v252, s[56:59], s35 offen offset:1024
v_lshlrev_b32 v118, 16, v224
v_and_b32 v119, s12, v224
v_fmac_f32 v108, v118, v104
v_fmac_f32 v109, v119, v104
v_lshlrev_b32 v120, 16, v225
v_and_b32 v121, s12, v225
v_fmac_f32 v110, v120, v104
v_fmac_f32 v111, v121, v104
v_lshlrev_b32 v122, 16, v226
v_and_b32 v123, s12, v226
v_fmac_f32 v112, v122, v104
v_fmac_f32 v113, v123, v104
v_lshlrev_b32 v116, 16, v227
v_and_b32 v117, s12, v227
v_fmac_f32 v114, v116, v104
v_fmac_f32 v115, v117, v104
v_cvt_pk_bf16_f32 v116, v108, v109
v_cvt_pk_bf16_f32 v117, v110, v111
v_cvt_pk_bf16_f32 v118, v112, v113
v_cvt_pk_bf16_f32 v119, v114, v115
ds_write_b128 v38, v[116:119] offset:8192
s_waitcnt vmcnt(13)
s_add_u32 s39, s53, s15
buffer_load_dwordx4 v[244:247], v10, s[20:23], s39 offen offset:1024 sc1
s_waitcnt vmcnt(13)
s_xor_b32 s32, s13, 0x27000
buffer_load_dwordx4 a[240:243], v252, s[56:59], s32 offen offset:0
s_waitcnt vmcnt(13)
buffer_load_dwordx4 a[244:247], v252, s[56:59], s32 offen offset:1024
ds_read_b128 v[96:99], v45 offset:1024
v_lshlrev_b32 v118, 16, v228
v_and_b32 v119, s12, v228
v_mul_f32 v108, v118, v100
v_mul_f32 v109, v119, v100
v_lshlrev_b32 v120, 16, v229
v_and_b32 v121, s12, v229
v_mul_f32 v110, v120, v100
v_mul_f32 v111, v121, v100
v_lshlrev_b32 v122, 16, v230
v_and_b32 v123, s12, v230
v_mul_f32 v112, v122, v100
v_mul_f32 v113, v123, v100
v_lshlrev_b32 v116, 16, v231
v_and_b32 v117, s12, v231
v_mul_f32 v114, v116, v100
v_mul_f32 v115, v117, v100
s_waitcnt vmcnt(13)
s_xor_b32 s33, s13, 0x23800
buffer_load_dwordx4 a[184:187], v252, s[56:59], s33 offen offset:0
s_waitcnt vmcnt(13)
buffer_load_dwordx4 a[188:191], v252, s[56:59], s33 offen offset:1024
v_mfma_f32_16x16x32_bf16 v[48:51], a[160:163], v[148:151], v[48:51]
v_mfma_f32_16x16x32_bf16 v[52:55], a[164:167], v[148:151], v[52:55]
v_mfma_f32_16x16x32_bf16 v[56:59], a[224:227], v[148:151], v[56:59]
v_mfma_f32_16x16x32_bf16 v[60:63], a[228:231], v[148:151], v[60:63]
s_waitcnt vmcnt(13)
s_xor_b32 s35, s13, 0x27800
buffer_load_dwordx4 a[248:251], v252, s[56:59], s35 offen offset:0
v_lshlrev_b32 v118, 16, v232
v_and_b32 v119, s12, v232
v_fmac_f32 v108, v118, v101
v_fmac_f32 v109, v119, v101
v_lshlrev_b32 v120, 16, v233
v_and_b32 v121, s12, v233
v_fmac_f32 v110, v120, v101
v_fmac_f32 v111, v121, v101
v_lshlrev_b32 v122, 16, v234
v_and_b32 v123, s12, v234
v_fmac_f32 v112, v122, v101
v_fmac_f32 v113, v123, v101
v_lshlrev_b32 v116, 16, v235
v_and_b32 v117, s12, v235
v_fmac_f32 v114, v116, v101
v_fmac_f32 v115, v117, v101
s_waitcnt lgkmcnt(0)
v_lshlrev_b32 v118, 16, v96
v_and_b32 v119, s12, v96
v_fmac_f32 v108, v118, v105
v_fmac_f32 v109, v119, v105
v_lshlrev_b32 v120, 16, v97
v_and_b32 v121, s12, v97
v_fmac_f32 v110, v120, v105
v_fmac_f32 v111, v121, v105
v_lshlrev_b32 v122, 16, v98
v_and_b32 v123, s12, v98
v_fmac_f32 v112, v122, v105
v_fmac_f32 v113, v123, v105
v_lshlrev_b32 v116, 16, v99
v_and_b32 v117, s12, v99
v_fmac_f32 v114, v116, v105
v_fmac_f32 v115, v117, v105
s_waitcnt vmcnt(13)
buffer_load_dwordx4 a[252:255], v252, s[56:59], s35 offen offset:1024
s_waitcnt vmcnt(13)
s_add_u32 s39, s54, s44
buffer_load_dwordx4 v[156:159], v10, s[20:23], s39 offen offset:0 sc1
s_waitcnt vmcnt(13)
s_add_u32 s32, s54, s45
buffer_load_dwordx4 v[160:163], v10, s[20:23], s32 offen offset:0 sc1
v_lshlrev_b32 v118, 16, v236
v_and_b32 v119, s12, v236
v_fmac_f32 v108, v118, v102
v_fmac_f32 v109, v119, v102
v_lshlrev_b32 v120, 16, v237
v_and_b32 v121, s12, v237
v_fmac_f32 v110, v120, v102
v_fmac_f32 v111, v121, v102
v_lshlrev_b32 v122, 16, v238
v_and_b32 v123, s12, v238
v_fmac_f32 v112, v122, v102
v_fmac_f32 v113, v123, v102
v_lshlrev_b32 v116, 16, v239
v_and_b32 v117, s12, v239
v_fmac_f32 v114, v116, v102
v_fmac_f32 v115, v117, v102
s_waitcnt vmcnt(13)
s_add_u32 s33, s54, s46
buffer_load_dwordx4 v[164:167], v10, s[20:23], s33 offen offset:0 sc1
s_waitcnt vmcnt(13)
s_add_u32 s35, s54, s47
buffer_load_dwordx4 v[168:171], v10, s[20:23], s35 offen offset:0 sc1
v_mfma_f32_16x16x32_bf16 v[48:51], a[168:171], v[152:155], v[48:51]
v_mfma_f32_16x16x32_bf16 v[52:55], a[172:175], v[152:155], v[52:55]
v_mfma_f32_16x16x32_bf16 v[56:59], a[232:235], v[152:155], v[56:59]
v_mfma_f32_16x16x32_bf16 v[60:63], a[236:239], v[152:155], v[60:63]
s_waitcnt vmcnt(13)
s_add_u32 s39, s54, s15
buffer_load_dwordx4 v[172:175], v10, s[20:23], s39 offen offset:0 sc1
v_lshlrev_b32 v118, 16, v240
v_and_b32 v119, s12, v240
v_fmac_f32 v108, v118, v103
v_fmac_f32 v109, v119, v103
v_lshlrev_b32 v120, 16, v241
v_and_b32 v121, s12, v241
v_fmac_f32 v110, v120, v103
v_fmac_f32 v111, v121, v103
v_lshlrev_b32 v122, 16, v242
v_and_b32 v123, s12, v242
v_fmac_f32 v112, v122, v103
v_fmac_f32 v113, v123, v103
v_lshlrev_b32 v116, 16, v243
v_and_b32 v117, s12, v243
v_fmac_f32 v114, v116, v103
v_fmac_f32 v115, v117, v103
s_waitcnt vmcnt(13)
s_add_u32 s32, s54, s44
buffer_load_dwordx4 v[176:179], v10, s[20:23], s32 offen offset:1024 sc1
s_waitcnt vmcnt(13)
s_add_u32 s33, s54, s45
buffer_load_dwordx4 v[180:183], v10, s[20:23], s33 offen offset:1024 sc1
s_waitcnt vmcnt(13)
s_add_u32 s35, s54, s46
buffer_load_dwordx4 v[184:187], v10, s[20:23], s35 offen offset:1024 sc1
v_lshlrev_b32 v118, 16, v244
v_and_b32 v119, s12, v244
v_fmac_f32 v108, v118, v104
v_fmac_f32 v109, v119, v104
v_lshlrev_b32 v120, 16, v245
v_and_b32 v121, s12, v245
v_fmac_f32 v110, v120, v104
v_fmac_f32 v111, v121, v104
v_lshlrev_b32 v122, 16, v246
v_and_b32 v123, s12, v246
v_fmac_f32 v112, v122, v104
v_fmac_f32 v113, v123, v104
v_lshlrev_b32 v116, 16, v247
v_and_b32 v117, s12, v247
v_fmac_f32 v114, v116, v104
v_fmac_f32 v115, v117, v104
ds_read2_b32 v[100:101], v14 offset0:1 offset1:2
ds_read2_b32 v[102:103], v14 offset0:3 offset1:4
ds_read2_b32 v[104:105], v14 offset0:5 offset1:6
v_cvt_pk_bf16_f32 v116, v108, v109
v_cvt_pk_bf16_f32 v117, v110, v111
v_cvt_pk_bf16_f32 v118, v112, v113
v_cvt_pk_bf16_f32 v119, v114, v115
ds_write_b128 v39, v[116:119] offset:8192
s_waitcnt vmcnt(13)
s_add_u32 s39, s54, s47
buffer_load_dwordx4 v[188:191], v10, s[20:23], s39 offen offset:1024 sc1
s_waitcnt vmcnt(13)
s_add_u32 s32, s54, s15
buffer_load_dwordx4 v[192:195], v10, s[20:23], s32 offen offset:1024 sc1
v_mfma_f32_16x16x32_bf16 v[48:51], a[176:179], v[132:135], v[48:51]
v_mfma_f32_16x16x32_bf16 v[52:55], a[180:183], v[132:135], v[52:55]
v_mfma_f32_16x16x32_bf16 v[56:59], a[240:243], v[132:135], v[56:59]
v_mfma_f32_16x16x32_bf16 v[60:63], a[244:247], v[132:135], v[60:63]
s_waitcnt vmcnt(13)
s_waitcnt vmcnt(12)
s_waitcnt vmcnt(11)
s_waitcnt vmcnt(10)
s_waitcnt lgkmcnt(0)
s_barrier
ds_read_b128 v[136:139], v15 offset:7168
ds_read_b128 v[140:143], v15 offset:8192
ds_read_b128 v[144:147], v15 offset:9216
ds_read_b128 v[148:151], v15 offset:10240
ds_read_b128 v[152:155], v15 offset:11264
s_waitcnt lgkmcnt(4)
v_mfma_f32_16x16x32_bf16 v[48:51], a[184:187], v[136:139], v[48:51]
ds_read_b128 v[132:135], v15 offset:12288
v_mfma_f32_16x16x32_bf16 v[52:55], a[188:191], v[136:139], v[52:55]
v_mfma_f32_16x16x32_bf16 v[56:59], a[248:251], v[136:139], v[56:59]
v_mfma_f32_16x16x32_bf16 v[60:63], a[252:255], v[136:139], v[60:63]
s_waitcnt lgkmcnt(4)
v_mfma_f32_16x16x32_bf16 v[64:67], a[128:131], v[140:143], v[64:67]
ds_read_b128 v[136:139], v15 offset:13312
v_mfma_f32_16x16x32_bf16 v[68:71], a[132:135], v[140:143], v[68:71]
v_mfma_f32_16x16x32_bf16 v[72:75], a[192:195], v[140:143], v[72:75]
v_mfma_f32_16x16x32_bf16 v[76:79], a[196:199], v[140:143], v[76:79]
v_cvt_pk_bf16_f32 v48, v48, v49
v_cvt_pk_bf16_f32 v49, v50, v51
v_cvt_pk_bf16_f32 v50, v52, v53
v_cvt_pk_bf16_f32 v51, v54, v55
ds_write_b128 v32, v[48:51] offset:0
v_cvt_pk_bf16_f32 v56, v56, v57
v_cvt_pk_bf16_f32 v57, v58, v59
v_cvt_pk_bf16_f32 v58, v60, v61
v_cvt_pk_bf16_f32 v59, v62, v63
ds_write_b128 v33, v[56:59] offset:0
ds_read_b128 v[52:55], v34 offset:0
ds_read_b128 v[60:63], v34 offset:1024
s_waitcnt lgkmcnt(8)
v_mfma_f32_16x16x32_bf16 v[64:67], a[136:139], v[144:147], v[64:67]
ds_read_b128 v[140:143], v15 offset:14336
v_mfma_f32_16x16x32_bf16 v[68:71], a[140:143], v[144:147], v[68:71]
v_mfma_f32_16x16x32_bf16 v[72:75], a[200:203], v[144:147], v[72:75]
v_mfma_f32_16x16x32_bf16 v[76:79], a[204:207], v[144:147], v[76:79]
s_waitcnt lgkmcnt(8)
v_mfma_f32_16x16x32_bf16 v[64:67], a[144:147], v[148:151], v[64:67]
ds_read_b128 v[144:147], v15 offset:15360
v_mfma_f32_16x16x32_bf16 v[68:71], a[148:151], v[148:151], v[68:71]
v_mfma_f32_16x16x32_bf16 v[72:75], a[208:211], v[148:151], v[72:75]
v_mfma_f32_16x16x32_bf16 v[76:79], a[212:215], v[148:151], v[76:79]
s_waitcnt lgkmcnt(8)
v_mfma_f32_16x16x32_bf16 v[64:67], a[152:155], v[152:155], v[64:67]
v_mfma_f32_16x16x32_bf16 v[68:71], a[156:159], v[152:155], v[68:71]
v_mfma_f32_16x16x32_bf16 v[72:75], a[216:219], v[152:155], v[72:75]
v_mfma_f32_16x16x32_bf16 v[76:79], a[220:223], v[152:155], v[76:79]
s_waitcnt lgkmcnt(7)
v_mfma_f32_16x16x32_bf16 v[64:67], a[160:163], v[132:135], v[64:67]
v_mfma_f32_16x16x32_bf16 v[68:71], a[164:167], v[132:135], v[68:71]
v_mfma_f32_16x16x32_bf16 v[72:75], a[224:227], v[132:135], v[72:75]
v_mfma_f32_16x16x32_bf16 v[76:79], a[228:231], v[132:135], v[76:79]
s_waitcnt lgkmcnt(6)
v_mfma_f32_16x16x32_bf16 v[64:67], a[168:171], v[136:139], v[64:67]
v_mfma_f32_16x16x32_bf16 v[68:71], a[172:175], v[136:139], v[68:71]
v_mfma_f32_16x16x32_bf16 v[72:75], a[232:235], v[136:139], v[72:75]
v_mfma_f32_16x16x32_bf16 v[76:79], a[236:239], v[136:139], v[76:79]
s_waitcnt lgkmcnt(1)
v_mfma_f32_16x16x32_bf16 v[64:67], a[176:179], v[140:143], v[64:67]
v_mfma_f32_16x16x32_bf16 v[68:71], a[180:183], v[140:143], v[68:71]
v_mfma_f32_16x16x32_bf16 v[72:75], a[240:243], v[140:143], v[72:75]
v_mfma_f32_16x16x32_bf16 v[76:79], a[244:247], v[140:143], v[76:79]
s_waitcnt lgkmcnt(0)
v_mfma_f32_16x16x32_bf16 v[64:67], a[184:187], v[144:147], v[64:67]
v_mfma_f32_16x16x32_bf16 v[68:71], a[188:191], v[144:147], v[68:71]
v_mfma_f32_16x16x32_bf16 v[72:75], a[248:251], v[144:147], v[72:75]
v_mfma_f32_16x16x32_bf16 v[76:79], a[252:255], v[144:147], v[76:79]
s_waitcnt vmcnt(9)
s_add_u32 s33, s52, 0
buffer_store_dwordx4 v[52:55], v9, s[40:43], s33 offen sc1
s_add_u32 s35, s52, 4096
buffer_store_dwordx4 v[60:63], v9, s[40:43], s35 offen sc1
v_cvt_pk_bf16_f32 v64, v64, v65
v_cvt_pk_bf16_f32 v65, v66, v67
v_cvt_pk_bf16_f32 v66, v68, v69
v_cvt_pk_bf16_f32 v67, v70, v71
ds_write_b128 v32, v[64:67] offset:2048
v_cvt_pk_bf16_f32 v72, v72, v73
v_cvt_pk_bf16_f32 v73, v74, v75
v_cvt_pk_bf16_f32 v74, v76, v77
v_cvt_pk_bf16_f32 v75, v78, v79
ds_write_b128 v33, v[72:75] offset:2048
ds_read_b128 v[68:71], v34 offset:2048
ds_read_b128 v[76:79], v34 offset:3072
ds_read_b128 v[96:99], v46 offset:0
v_lshlrev_b32 v118, 16, v156
v_and_b32 v119, s12, v156
v_mul_f32 v108, v118, v100
v_mul_f32 v109, v119, v100
v_lshlrev_b32 v120, 16, v157
v_and_b32 v121, s12, v157
v_mul_f32 v110, v120, v100
v_mul_f32 v111, v121, v100
v_lshlrev_b32 v122, 16, v158
v_and_b32 v123, s12, v158
v_mul_f32 v112, v122, v100
v_mul_f32 v113, v123, v100
v_lshlrev_b32 v116, 16, v159
v_and_b32 v117, s12, v159
v_mul_f32 v114, v116, v100
v_mul_f32 v115, v117, v100
s_waitcnt vmcnt(10)
s_add_u32 s39, s53, 0
s_waitcnt lgkmcnt(2)
buffer_store_dwordx4 v[68:71], v9, s[40:43], s39 offen sc1
s_add_u32 s32, s53, 4096
s_waitcnt lgkmcnt(1)
buffer_store_dwordx4 v[76:79], v9, s[40:43], s32 offen sc1
v_lshlrev_b32 v118, 16, v160
v_and_b32 v119, s12, v160
v_fmac_f32 v108, v118, v101
v_fmac_f32 v109, v119, v101
v_lshlrev_b32 v120, 16, v161
v_and_b32 v121, s12, v161
v_fmac_f32 v110, v120, v101
v_fmac_f32 v111, v121, v101
v_lshlrev_b32 v122, 16, v162
v_and_b32 v123, s12, v162
v_fmac_f32 v112, v122, v101
v_fmac_f32 v113, v123, v101
v_lshlrev_b32 v116, 16, v163
v_and_b32 v117, s12, v163
v_fmac_f32 v114, v116, v101
v_fmac_f32 v115, v117, v101
s_waitcnt lgkmcnt(0)
v_lshlrev_b32 v118, 16, v96
v_and_b32 v119, s12, v96
v_fmac_f32 v108, v118, v105
v_fmac_f32 v109, v119, v105
v_lshlrev_b32 v120, 16, v97
v_and_b32 v121, s12, v97
v_fmac_f32 v110, v120, v105
v_fmac_f32 v111, v121, v105
v_lshlrev_b32 v122, 16, v98
v_and_b32 v123, s12, v98
v_fmac_f32 v112, v122, v105
v_fmac_f32 v113, v123, v105
v_lshlrev_b32 v116, 16, v99
v_and_b32 v117, s12, v99
v_fmac_f32 v114, v116, v105
v_fmac_f32 v115, v117, v105
s_waitcnt vmcnt(11)
v_lshlrev_b32 v118, 16, v164
v_and_b32 v119, s12, v164
v_fmac_f32 v108, v118, v102
v_fmac_f32 v109, v119, v102
v_lshlrev_b32 v120, 16, v165
v_and_b32 v121, s12, v165
v_fmac_f32 v110, v120, v102
v_fmac_f32 v111, v121, v102
v_lshlrev_b32 v122, 16, v166
v_and_b32 v123, s12, v166
v_fmac_f32 v112, v122, v102
v_fmac_f32 v113, v123, v102
v_lshlrev_b32 v116, 16, v167
v_and_b32 v117, s12, v167
v_fmac_f32 v114, v116, v102
v_fmac_f32 v115, v117, v102
s_waitcnt vmcnt(10)
v_lshlrev_b32 v118, 16, v168
v_and_b32 v119, s12, v168
v_fmac_f32 v108, v118, v103
v_fmac_f32 v109, v119, v103
v_lshlrev_b32 v120, 16, v169
v_and_b32 v121, s12, v169
v_fmac_f32 v110, v120, v103
v_fmac_f32 v111, v121, v103
v_lshlrev_b32 v122, 16, v170
v_and_b32 v123, s12, v170
v_fmac_f32 v112, v122, v103
v_fmac_f32 v113, v123, v103
v_lshlrev_b32 v116, 16, v171
v_and_b32 v117, s12, v171
v_fmac_f32 v114, v116, v103
v_fmac_f32 v115, v117, v103
s_waitcnt vmcnt(9)
v_lshlrev_b32 v118, 16, v172
v_and_b32 v119, s12, v172
v_fmac_f32 v108, v118, v104
v_fmac_f32 v109, v119, v104
v_lshlrev_b32 v120, 16, v173
v_and_b32 v121, s12, v173
v_fmac_f32 v110, v120, v104
v_fmac_f32 v111, v121, v104
v_lshlrev_b32 v122, 16, v174
v_and_b32 v123, s12, v174
v_fmac_f32 v112, v122, v104
v_fmac_f32 v113, v123, v104
v_lshlrev_b32 v116, 16, v175
v_and_b32 v117, s12, v175
v_fmac_f32 v114, v116, v104
v_fmac_f32 v115, v117, v104
v_cvt_pk_bf16_f32 v116, v108, v109
v_cvt_pk_bf16_f32 v117, v110, v111
v_cvt_pk_bf16_f32 v118, v112, v113
v_cvt_pk_bf16_f32 v119, v114, v115
ds_write_b128 v38, v[116:119] offset:16384
s_waitcnt vmcnt(8)
ds_read_b128 v[96:99], v46 offset:1024
v_lshlrev_b32 v118, 16, v176
v_and_b32 v119, s12, v176
v_mul_f32 v108, v118, v100
v_mul_f32 v109, v119, v100
v_lshlrev_b32 v120, 16, v177
v_and_b32 v121, s12, v177
v_mul_f32 v110, v120, v100
v_mul_f32 v111, v121, v100
v_lshlrev_b32 v122, 16, v178
v_and_b32 v123, s12, v178
v_mul_f32 v112, v122, v100
v_mul_f32 v113, v123, v100
v_lshlrev_b32 v116, 16, v179
v_and_b32 v117, s12, v179
v_mul_f32 v114, v116, v100
v_mul_f32 v115, v117, v100
s_waitcnt vmcnt(7)
v_lshlrev_b32 v118, 16, v180
v_and_b32 v119, s12, v180
v_fmac_f32 v108, v118, v101
v_fmac_f32 v109, v119, v101
v_lshlrev_b32 v120, 16, v181
v_and_b32 v121, s12, v181
v_fmac_f32 v110, v120, v101
v_fmac_f32 v111, v121, v101
v_lshlrev_b32 v122, 16, v182
v_and_b32 v123, s12, v182
v_fmac_f32 v112, v122, v101
v_fmac_f32 v113, v123, v101
v_lshlrev_b32 v116, 16, v183
v_and_b32 v117, s12, v183
v_fmac_f32 v114, v116, v101
v_fmac_f32 v115, v117, v101
s_waitcnt lgkmcnt(0)
v_lshlrev_b32 v118, 16, v96
v_and_b32 v119, s12, v96
v_fmac_f32 v108, v118, v105
v_fmac_f32 v109, v119, v105
v_lshlrev_b32 v120, 16, v97
v_and_b32 v121, s12, v97
v_fmac_f32 v110, v120, v105
v_fmac_f32 v111, v121, v105
v_lshlrev_b32 v122, 16, v98
v_and_b32 v123, s12, v98
v_fmac_f32 v112, v122, v105
v_fmac_f32 v113, v123, v105
v_lshlrev_b32 v116, 16, v99
v_and_b32 v117, s12, v99
v_fmac_f32 v114, v116, v105
v_fmac_f32 v115, v117, v105
s_waitcnt vmcnt(6)
v_lshlrev_b32 v118, 16, v184
v_and_b32 v119, s12, v184
v_fmac_f32 v108, v118, v102
v_fmac_f32 v109, v119, v102
v_lshlrev_b32 v120, 16, v185
v_and_b32 v121, s12, v185
v_fmac_f32 v110, v120, v102
v_fmac_f32 v111, v121, v102
v_lshlrev_b32 v122, 16, v186
v_and_b32 v123, s12, v186
v_fmac_f32 v112, v122, v102
v_fmac_f32 v113, v123, v102
v_lshlrev_b32 v116, 16, v187
v_and_b32 v117, s12, v187
v_fmac_f32 v114, v116, v102
v_fmac_f32 v115, v117, v102
s_waitcnt vmcnt(5)
v_lshlrev_b32 v118, 16, v188
v_and_b32 v119, s12, v188
v_fmac_f32 v108, v118, v103
v_fmac_f32 v109, v119, v103
v_lshlrev_b32 v120, 16, v189
v_and_b32 v121, s12, v189
v_fmac_f32 v110, v120, v103
v_fmac_f32 v111, v121, v103
v_lshlrev_b32 v122, 16, v190
v_and_b32 v123, s12, v190
v_fmac_f32 v112, v122, v103
v_fmac_f32 v113, v123, v103
v_lshlrev_b32 v116, 16, v191
v_and_b32 v117, s12, v191
v_fmac_f32 v114, v116, v103
v_fmac_f32 v115, v117, v103
s_waitcnt vmcnt(4)
v_lshlrev_b32 v118, 16, v192
v_and_b32 v119, s12, v192
v_fmac_f32 v108, v118, v104
v_fmac_f32 v109, v119, v104
v_lshlrev_b32 v120, 16, v193
v_and_b32 v121, s12, v193
v_fmac_f32 v110, v120, v104
v_fmac_f32 v111, v121, v104
v_lshlrev_b32 v122, 16, v194
v_and_b32 v123, s12, v194
v_fmac_f32 v112, v122, v104
v_fmac_f32 v113, v123, v104
v_lshlrev_b32 v116, 16, v195
v_and_b32 v117, s12, v195
v_fmac_f32 v114, v116, v104
v_fmac_f32 v115, v117, v104
v_cvt_pk_bf16_f32 v116, v108, v109
v_cvt_pk_bf16_f32 v117, v110, v111
v_cvt_pk_bf16_f32 v118, v112, v113
v_cvt_pk_bf16_f32 v119, v114, v115
ds_write_b128 v39, v[116:119] offset:16384
s_waitcnt lgkmcnt(0)
s_barrier
ds_read_b128 v[148:151], v15 offset:16384
ds_read_b128 v[152:155], v15 offset:17408
ds_read_b128 v[132:135], v15 offset:18432
ds_read_b128 v[136:139], v15 offset:19456
ds_read_b128 v[140:143], v15 offset:20480
s_waitcnt lgkmcnt(4)
v_mfma_f32_16x16x32_bf16 v[80:83], a[128:131], v[148:151], v[80:83]
ds_read_b128 v[144:147], v15 offset:21504
v_mfma_f32_16x16x32_bf16 v[84:87], a[132:135], v[148:151], v[84:87]
v_mfma_f32_16x16x32_bf16 v[88:91], a[192:195], v[148:151], v[88:91]
v_mfma_f32_16x16x32_bf16 v[92:95], a[196:199], v[148:151], v[92:95]
s_waitcnt lgkmcnt(4)
v_mfma_f32_16x16x32_bf16 v[80:83], a[136:139], v[152:155], v[80:83]
ds_read_b128 v[148:151], v15 offset:22528
v_mfma_f32_16x16x32_bf16 v[84:87], a[140:143], v[152:155], v[84:87]
v_mfma_f32_16x16x32_bf16 v[88:91], a[200:203], v[152:155], v[88:91]
v_mfma_f32_16x16x32_bf16 v[92:95], a[204:207], v[152:155], v[92:95]
s_waitcnt lgkmcnt(4)
v_mfma_f32_16x16x32_bf16 v[80:83], a[144:147], v[132:135], v[80:83]
ds_read_b128 v[152:155], v15 offset:23552
v_mfma_f32_16x16x32_bf16 v[84:87], a[148:151], v[132:135], v[84:87]
v_mfma_f32_16x16x32_bf16 v[88:91], a[208:211], v[132:135], v[88:91]
v_mfma_f32_16x16x32_bf16 v[92:95], a[212:215], v[132:135], v[92:95]
s_waitcnt lgkmcnt(4)
v_mfma_f32_16x16x32_bf16 v[80:83], a[152:155], v[136:139], v[80:83]
v_mfma_f32_16x16x32_bf16 v[84:87], a[156:159], v[136:139], v[84:87]
v_mfma_f32_16x16x32_bf16 v[88:91], a[216:219], v[136:139], v[88:91]
v_mfma_f32_16x16x32_bf16 v[92:95], a[220:223], v[136:139], v[92:95]
s_waitcnt lgkmcnt(3)
v_mfma_f32_16x16x32_bf16 v[80:83], a[160:163], v[140:143], v[80:83]
v_mfma_f32_16x16x32_bf16 v[84:87], a[164:167], v[140:143], v[84:87]
v_mfma_f32_16x16x32_bf16 v[88:91], a[224:227], v[140:143], v[88:91]
v_mfma_f32_16x16x32_bf16 v[92:95], a[228:231], v[140:143], v[92:95]
s_waitcnt lgkmcnt(2)
v_mfma_f32_16x16x32_bf16 v[80:83], a[168:171], v[144:147], v[80:83]
v_mfma_f32_16x16x32_bf16 v[84:87], a[172:175], v[144:147], v[84:87]
v_mfma_f32_16x16x32_bf16 v[88:91], a[232:235], v[144:147], v[88:91]
v_mfma_f32_16x16x32_bf16 v[92:95], a[236:239], v[144:147], v[92:95]
s_waitcnt lgkmcnt(1)
v_mfma_f32_16x16x32_bf16 v[80:83], a[176:179], v[148:151], v[80:83]
v_mfma_f32_16x16x32_bf16 v[84:87], a[180:183], v[148:151], v[84:87]
v_mfma_f32_16x16x32_bf16 v[88:91], a[240:243], v[148:151], v[88:91]
v_mfma_f32_16x16x32_bf16 v[92:95], a[244:247], v[148:151], v[92:95]
s_waitcnt lgkmcnt(0)
v_mfma_f32_16x16x32_bf16 v[80:83], a[184:187], v[152:155], v[80:83]
v_mfma_f32_16x16x32_bf16 v[84:87], a[188:191], v[152:155], v[84:87]
v_mfma_f32_16x16x32_bf16 v[88:91], a[248:251], v[152:155], v[88:91]
v_mfma_f32_16x16x32_bf16 v[92:95], a[252:255], v[152:155], v[92:95]
s_nop 4
v_cvt_pk_bf16_f32 v80, v80, v81
v_cvt_pk_bf16_f32 v81, v82, v83
v_cvt_pk_bf16_f32 v82, v84, v85
v_cvt_pk_bf16_f32 v83, v86, v87
ds_write_b128 v35, v[80:83] offset:0
v_cvt_pk_bf16_f32 v88, v88, v89
v_cvt_pk_bf16_f32 v89, v90, v91
v_cvt_pk_bf16_f32 v90, v92, v93
v_cvt_pk_bf16_f32 v91, v94, v95
ds_write_b128 v36, v[88:91] offset:0
ds_read_b128 v[84:87], v37 offset:0
ds_read_b128 v[92:95], v37 offset:1024
s_add_u32 s33, s54, 0
s_waitcnt lgkmcnt(1)
buffer_store_dwordx4 v[84:87], v9, s[40:43], s33 offen sc1
s_add_u32 s35, s54, 4096
s_waitcnt lgkmcnt(0)
buffer_store_dwordx4 v[92:95], v9, s[40:43], s35 offen sc1
s_branch L2_fin
LC_poll:
s_mov_b32 s36, 0
s_cmp_lt_u32 s98, 2
s_cselect_b32 s33, 0xfff, -1
s_cselect_b32 s35, 6, 0x6
LC_poll2:
s_mov_b32 s70, 0
s_atomic_add s70, s[60:61], s48 glc
s_cmp_lt_u32 s2, 240
s_cbranch_scc1 LC_poll3
s_mov_b32 s71, 0
s_atomic_add s71, s[60:61], s49 glc
s_mov_b32 s72, 0
s_atomic_add s72, s[60:61], s50 glc
s_waitcnt lgkmcnt(0)
s_min_u32 s70, s70, s71
s_min_u32 s70, s70, s72
LC_poll3:
s_waitcnt lgkmcnt(0)
s_and_b32 s70, s70, s33
s_cmp_ge_u32 s70, s35
s_cbranch_scc1 LC_poll4
s_sleep 2
s_add_u32 s36, s36, 1
s_cmp_gt_u32 s36, 0x40000
s_cbranch_scc0 LC_poll2
LC_poll4:
s_cmp_lt_u32 s98, 2
s_cbranch_scc1 LC_got
s_mul_i32 s33, s51, 0x600000
v_readfirstlane_b32 s32, v44
s_add_u32 s35, s33, s52
s_mov_b32 m0, s32
s_nop 0
buffer_load_dwordx4 v10, s[20:23], s35 offen offset:0 sc1 lds
buffer_load_dwordx4 v10, s[20:23], s35 offen offset:1024 sc1 lds
v_readfirstlane_b32 s32, v45
s_add_u32 s35, s33, s53
s_mov_b32 m0, s32
s_nop 0
buffer_load_dwordx4 v10, s[20:23], s35 offen offset:0 sc1 lds
buffer_load_dwordx4 v10, s[20:23], s35 offen offset:1024 sc1 lds
v_readfirstlane_b32 s32, v46
s_add_u32 s35, s33, s54
s_mov_b32 m0, s32
s_nop 0
buffer_load_dwordx4 v10, s[20:23], s35 offen offset:0 sc1 lds
buffer_load_dwordx4 v10, s[20:23], s35 offen offset:1024 sc1 lds
s_waitcnt vmcnt(0)
s_branch LC_got
LC_side:
s_cmp_eq_u32 s14, 1
s_cbranch_scc1 LC_sideok
s_cmp_lt_u32 s2, 240
s_cbranch_scc1 LC_side1
s_barrier
LC_side1:
s_mov_b32 s36, 0
s_mov_b32 s33, 0x6c01400
LC_side2:
buffer_load_dword v1, off, s[56:59], s33 sc1
s_waitcnt vmcnt(0)
v_readfirstlane_b32 s99, v1
s_add_u32 s36, s36, 1
s_cmp_gt_u32 s36, 0x40000
s_cbranch_scc1 LC_side3
s_cmp_ge_u32 s99, 60
s_cbranch_scc1 LC_side3
s_sleep 8
s_branch LC_side2
LC_side3:
s_cmp_lt_u32 s98, 2
s_cbranch_scc1 LC_sideok
s_add_u32 s8, s6, 0x0
s_addc_u32 s9, s7, 0
s_mov_b32 s10, 0x4e2000
s_mov_b32 s11, 0x00020000
s_lshl_b32 s55, s34, 13
s_add_u32 s55, s55, 0x21000
s_lshl_b32 s33, s34, 7
v_bfe_u32 v9, v252, 4, 3
v_lshrrev_b32 v1, 7, v252
v_xor_b32 v9, v9, v1
v_lshl_add_u32 v1, v1, 9, s33
v_lshl_add_u32 v9, v9, 4, v1
s_add_u32 m0, s55, 0
s_add_u32 s39, s52, 0
buffer_load_dwordx4 v9, s[8:11], s39 offen lds
s_add_u32 m0, s55, 1024
s_add_u32 s32, s52, 4096
buffer_load_dwordx4 v9, s[8:11], s32 offen lds
s_add_u32 m0, s55, 2048
s_add_u32 s33, s53, 0
buffer_load_dwordx4 v9, s[8:11], s33 offen lds
s_add_u32 m0, s55, 3072
s_add_u32 s35, s53, 4096
buffer_load_dwordx4 v9, s[8:11], s35 offen lds
s_waitcnt vmcnt(0)
s_branch LC_sideok
LC_slow:
s_waitcnt vmcnt(0) lgkmcnt(0)
s_barrier
s_mov_b32 s50, 0xe1a06800
s_mov_b32 s51, 0x4e608d04
s_mul_i32 s39, s37, 9
s_lshr_b64 s[50:51], s[50:51], s39
s_and_b32 s39, s50, 0x1ff
s_bfe_u32 s49, s50, 0x90009
s_sub_u32 s29, s49, s39
s_lshl_b32 s50, s37, 2
s_lshr_b32 s59, 0x766666, s50
s_and_b32 s59, s59, 15
s_sub_u32 s31, s29, s59
s_lshr_b32 s31, s31, 1
s_sub_u32 s31, s31, 1
s_lshl_b32 s39, s39, 14
s_lshl_b32 s49, s49, 14
s_add_u32 s28, s39, 0x4000
s_cmp_eq_u32 s37, 5
s_cselect_b32 s33, 0xff800000, 0
s_mov_b32 s32, 0xffff
s_add_u32 s12, s4, 0x6800000
s_addc_u32 s13, s5, 0
s_mov_b32 s14, s49
s_mov_b32 s15, 0x00020000
s_add_u32 s8, s4, 0x0
s_addc_u32 s9, s5, 0
s_mov_b32 s10, 0x4e4000
s_mov_b32 s11, 0x00020000
s_mul_i32 s35, s37, 0x600000
s_add_u32 s20, s4, 0x2000000
s_addc_u32 s21, s5, 0
s_add_u32 s20, s20, s35
s_addc_u32 s21, s21, 0
s_mov_b32 s22, 0x4e4000
s_mov_b32 s23, 0x00020000
s_add_u32 s24, s4, 0x6000000
s_addc_u32 s25, s5, 0
s_mov_b32 s26, 0x9c800
s_mov_b32 s27, 0x00020000
s_lshl_b32 s35, s38, 4
s_lshl_b32 s41, s34, 2
s_add_u32 s35, s35, s41
s_lshl_b32 s40, s35, 13
s_lshl_b32 s48, s35, 10
s_lshl_b32 s35, s37, 3
s_add_u32 s48, s48, s35
v_bfe_u32 v248, v252, 4, 3
v_lshlrev_b32 v248, 6, v248
v_bfe_u32 v253, v252, 7, 1
v_lshl_or_b32 v248, v253, 10, v248
v_bfe_u32 v253, v252, 8, 2
v_lshl_or_b32 v248, v253, 4, v248
v_bfe_u32 v253, v252, 6, 1
v_lshlrev_b32 v253, 5, v253
v_xor_b32 v248, v248, v253
v_and_b32 v249, 0x1c0, v252
v_bfe_u32 v253, v252, 9, 1
v_lshl_or_b32 v249, v253, 10, v249
v_bfe_u32 v253, v252, 8, 1
v_lshl_or_b32 v249, v253, 5, v249
v_bfe_u32 v253, v252, 4, 2
v_lshl_or_b32 v249, v253, 3, v249
v_xor_b32 v250, 32, v249
v_and_b32 v251, 0xfffffe7f, v251
s_mul_i32 s36, s34, 0xa000
s_mov_b32 s56, s36
s_add_u32 s57, s56, 32768
s_mov_b32 s55, 4
v_bfe_i32 v188, v252, 8, 1
LS_q:
s_add_u32 s44, s40, 4096
buffer_load_dwordx4 v[0:3], v252, s[8:11], s40 offen offset:0
buffer_load_dwordx4 v[4:7], v252, s[8:11], s40 offen offset:1024
buffer_load_dwordx4 v[8:11], v252, s[8:11], s40 offen offset:2048
buffer_load_dwordx4 v[12:15], v252, s[8:11], s40 offen offset:3072
buffer_load_dwordx4 v[16:19], v252, s[8:11], s44 offen offset:0
buffer_load_dwordx4 v[20:23], v252, s[8:11], s44 offen offset:1024
buffer_load_dwordx4 v[24:27], v252, s[8:11], s44 offen offset:2048
buffer_load_dwordx4 v[28:31], v252, s[8:11], s44 offen offset:3072
s_mov_b32 s53, s56
s_mov_b32 s58, s39
s_add_u32 m0, s53, 0
s_add_u32 s54, s58, 0
buffer_load_dwordx4 v251, s[12:15], s54 offen offset:0 lds
buffer_load_dwordx4 v251, s[12:15], s54 offen offset:1024 lds
buffer_load_dwordx4 v251, s[12:15], s54 offen offset:2048 lds
buffer_load_dwordx4 v251, s[12:15], s54 offen offset:3072 lds
s_add_u32 m0, s53, 4096
s_add_u32 s54, s58, 128
buffer_load_dwordx4 v251, s[12:15], s54 offen offset:0 lds
buffer_load_dwordx4 v251, s[12:15], s54 offen offset:1024 lds
buffer_load_dwordx4 v251, s[12:15], s54 offen offset:2048 lds
buffer_load_dwordx4 v251, s[12:15], s54 offen offset:3072 lds
s_add_u32 m0, s53, 8192
s_add_u32 s54, s58, 256
buffer_load_dwordx4 v251, s[12:15], s54 offen offset:0 lds
buffer_load_dwordx4 v251, s[12:15], s54 offen offset:1024 lds
buffer_load_dwordx4 v251, s[12:15], s54 offen offset:2048 lds
buffer_load_dwordx4 v251, s[12:15], s54 offen offset:3072 lds
s_add_u32 m0, s53, 12288
s_add_u32 s54, s58, 384
buffer_load_dwordx4 v251, s[12:15], s54 offen offset:0 lds
buffer_load_dwordx4 v251, s[12:15], s54 offen offset:1024 lds
buffer_load_dwordx4 v251, s[12:15], s54 offen offset:2048 lds
buffer_load_dwordx4 v251, s[12:15], s54 offen offset:3072 lds
s_add_u32 s53, s53, 0x4000
s_cmp_eq_u32 s53, s57
s_cselect_b32 s53, s56, s53
s_add_u32 s58, s58, 0x4000
s_mov_b32 s51, s29
s_mov_b32 s52, s56
v_mov_b32 v172, 0xff800000
v_accvgpr_write_b32 a0, 0
v_accvgpr_write_b32 a1, 0
v_accvgpr_write_b32 a2, 0
v_accvgpr_write_b32 a3, 0
v_accvgpr_write_b32 a4, 0
v_accvgpr_write_b32 a5, 0
v_accvgpr_write_b32 a6, 0
v_accvgpr_write_b32 a7, 0
v_accvgpr_write_b32 a8, 0
v_accvgpr_write_b32 a9, 0
v_accvgpr_write_b32 a10, 0
v_accvgpr_write_b32 a11, 0
v_accvgpr_write_b32 a12, 0
v_accvgpr_write_b32 a13, 0
v_accvgpr_write_b32 a14, 0
v_accvgpr_write_b32 a15, 0
v_accvgpr_write_b32 a16, 0
v_accvgpr_write_b32 a17, 0
v_accvgpr_write_b32 a18, 0
v_accvgpr_write_b32 a19, 0
v_accvgpr_write_b32 a20, 0
v_accvgpr_write_b32 a21, 0
v_accvgpr_write_b32 a22, 0
v_accvgpr_write_b32 a23, 0
v_accvgpr_write_b32 a24, 0
v_accvgpr_write_b32 a25, 0
v_accvgpr_write_b32 a26, 0
v_accvgpr_write_b32 a27, 0
v_accvgpr_write_b32 a28, 0
v_accvgpr_write_b32 a29, 0
v_accvgpr_write_b32 a30, 0
v_accvgpr_write_b32 a31, 0
v_accvgpr_write_b32 a32, 0
v_accvgpr_write_b32 a33, 0
v_accvgpr_write_b32 a34, 0
v_accvgpr_write_b32 a35, 0
v_accvgpr_write_b32 a36, 0
v_accvgpr_write_b32 a37, 0
v_accvgpr_write_b32 a38, 0
v_accvgpr_write_b32 a39, 0
v_accvgpr_write_b32 a40, 0
v_accvgpr_write_b32 a41, 0
v_accvgpr_write_b32 a42, 0
v_accvgpr_write_b32 a43, 0
v_accvgpr_write_b32 a44, 0
v_accvgpr_write_b32 a45, 0
v_accvgpr_write_b32 a46, 0
v_accvgpr_write_b32 a47, 0
v_accvgpr_write_b32 a48, 0
v_accvgpr_write_b32 a49, 0
v_accvgpr_write_b32 a50, 0
v_accvgpr_write_b32 a51, 0
v_accvgpr_write_b32 a52, 0
v_accvgpr_write_b32 a53, 0
v_accvgpr_write_b32 a54, 0
v_accvgpr_write_b32 a55, 0
v_accvgpr_write_b32 a56, 0
v_accvgpr_write_b32 a57, 0
v_accvgpr_write_b32 a58, 0
v_accvgpr_write_b32 a59, 0
v_accvgpr_write_b32 a60, 0
v_accvgpr_write_b32 a61, 0
v_accvgpr_write_b32 a62, 0
v_accvgpr_write_b32 a63, 0
LS_loop:
s_add_u32 m0, s53, 0
s_add_u32 s54, s58, 0
buffer_load_dwordx4 v251, s[12:15], s54 offen offset:0 lds
buffer_load_dwordx4 v251, s[12:15], s54 offen offset:1024 lds
buffer_load_dwordx4 v251, s[12:15], s54 offen offset:2048 lds
buffer_load_dwordx4 v251, s[12:15], s54 offen offset:3072 lds
s_add_u32 m0, s53, 4096
s_add_u32 s54, s58, 128
buffer_load_dwordx4 v251, s[12:15], s54 offen offset:0 lds
buffer_load_dwordx4 v251, s[12:15], s54 offen offset:1024 lds
buffer_load_dwordx4 v251, s[12:15], s54 offen offset:2048 lds
buffer_load_dwordx4 v251, s[12:15], s54 offen offset:3072 lds
s_add_u32 m0, s53, 8192
s_add_u32 s54, s58, 256
buffer_load_dwordx4 v251, s[12:15], s54 offen offset:0 lds
buffer_load_dwordx4 v251, s[12:15], s54 offen offset:1024 lds
buffer_load_dwordx4 v251, s[12:15], s54 offen offset:2048 lds
buffer_load_dwordx4 v251, s[12:15], s54 offen offset:3072 lds
s_add_u32 m0, s53, 12288
s_add_u32 s54, s58, 384
buffer_load_dwordx4 v251, s[12:15], s54 offen offset:0 lds
buffer_load_dwordx4 v251, s[12:15], s54 offen offset:1024 lds
buffer_load_dwordx4 v251, s[12:15], s54 offen offset:2048 lds
buffer_load_dwordx4 v251, s[12:15], s54 offen offset:3072 lds
s_add_u32 s53, s53, 0x4000
s_cmp_eq_u32 s53, s57
s_cselect_b32 s53, s56, s53
s_add_u32 s58, s58, 0x4000
v_add_u32 v177, s52, v248
v_add_u32 v178, s52, v249
v_add_u32 v179, s52, v250
s_add_u32 s52, s52, 0x4000
s_cmp_eq_u32 s52, s57
s_cselect_b32 s52, s56, s52
s_cmp_eq_u32 s51, 1
s_cselect_b32 s54, s33, 0
v_and_b32 v192, s54, v188
v_and_b32 v193, s54, v188
v_and_b32 v194, s54, v188
v_and_b32 v195, s54, v188
s_waitcnt vmcnt(16)
ds_read_b128 v[32:35], v177 offset:0
ds_read_b128 v[64:67], v177 offset:2048
ds_read_b128 v[36:39], v177 offset:512
ds_read_b128 v[68:71], v177 offset:2560
ds_read_b128 v[40:43], v177 offset:4096
ds_read_b128 v[72:75], v177 offset:6144
ds_read_b128 v[44:47], v177 offset:4608
ds_read_b128 v[76:79], v177 offset:6656
ds_read_b128 v[48:51], v177 offset:8192
ds_read_b128 v[80:83], v177 offset:10240
ds_read_b128 v[52:55], v177 offset:8704
ds_read_b128 v[84:87], v177 offset:10752
ds_read_b128 v[56:59], v177 offset:12288
ds_read_b128 v[88:91], v177 offset:14336
ds_read_b128 v[60:63], v177 offset:12800
ds_read_b128 v[92:95], v177 offset:14848
s_waitcnt lgkmcnt(14)
v_mfma_f32_16x16x32_bf16 v[160:163], v[32:35], v[0:3], v[192:195]
v_mfma_f32_16x16x32_bf16 v[164:167], v[64:67], v[0:3], v[192:195]
s_waitcnt lgkmcnt(12)
v_mfma_f32_16x16x32_bf16 v[160:163], v[36:39], v[4:7], v[160:163]
v_mfma_f32_16x16x32_bf16 v[164:167], v[68:71], v[4:7], v[164:167]
s_waitcnt lgkmcnt(10)
v_mfma_f32_16x16x32_bf16 v[160:163], v[40:43], v[8:11], v[160:163]
v_mfma_f32_16x16x32_bf16 v[164:167], v[72:75], v[8:11], v[164:167]
s_waitcnt lgkmcnt(8)
v_mfma_f32_16x16x32_bf16 v[160:163], v[44:47], v[12:15], v[160:163]
v_mfma_f32_16x16x32_bf16 v[164:167], v[76:79], v[12:15], v[164:167]
s_waitcnt lgkmcnt(6)
v_mfma_f32_16x16x32_bf16 v[160:163], v[48:51], v[16:19], v[160:163]
v_mfma_f32_16x16x32_bf16 v[164:167], v[80:83], v[16:19], v[164:167]
s_waitcnt lgkmcnt(4)
v_mfma_f32_16x16x32_bf16 v[160:163], v[52:55], v[20:23], v[160:163]
v_mfma_f32_16x16x32_bf16 v[164:167], v[84:87], v[20:23], v[164:167]
s_waitcnt lgkmcnt(2)
v_mfma_f32_16x16x32_bf16 v[160:163], v[56:59], v[24:27], v[160:163]
v_mfma_f32_16x16x32_bf16 v[164:167], v[88:91], v[24:27], v[164:167]
s_waitcnt lgkmcnt(0)
v_mfma_f32_16x16x32_bf16 v[160:163], v[60:63], v[28:31], v[160:163]
v_mfma_f32_16x16x32_bf16 v[164:167], v[92:95], v[28:31], v[164:167]
ds_read_b64_tr_b16 v[96:97], v178 offset:0
ds_read_b64_tr_b16 v[98:99], v178 offset:2048
ds_read_b64_tr_b16 v[100:101], v179 offset:0
ds_read_b64_tr_b16 v[102:103], v179 offset:2048
ds_read_b64_tr_b16 v[104:105], v178 offset:512
ds_read_b64_tr_b16 v[106:107], v178 offset:2560
ds_read_b64_tr_b16 v[108:109], v179 offset:512
ds_read_b64_tr_b16 v[110:111], v179 offset:2560
ds_read_b64_tr_b16 v[112:113], v178 offset:4096
ds_read_b64_tr_b16 v[114:115], v178 offset:6144
ds_read_b64_tr_b16 v[116:117], v179 offset:4096
ds_read_b64_tr_b16 v[118:119], v179 offset:6144
ds_read_b64_tr_b16 v[120:121], v178 offset:4608
ds_read_b64_tr_b16 v[122:123], v178 offset:6656
ds_read_b64_tr_b16 v[124:125], v179 offset:4608
ds_read_b64_tr_b16 v[126:127], v179 offset:6656
ds_read_b64_tr_b16 v[128:129], v178 offset:8192
ds_read_b64_tr_b16 v[130:131], v178 offset:10240
ds_read_b64_tr_b16 v[132:133], v179 offset:8192
ds_read_b64_tr_b16 v[134:135], v179 offset:10240
ds_read_b64_tr_b16 v[136:137], v178 offset:8704
ds_read_b64_tr_b16 v[138:139], v178 offset:10752
ds_read_b64_tr_b16 v[140:141], v179 offset:8704
ds_read_b64_tr_b16 v[142:143], v179 offset:10752
ds_read_b64_tr_b16 v[144:145], v178 offset:12288
ds_read_b64_tr_b16 v[146:147], v178 offset:14336
ds_read_b64_tr_b16 v[148:149], v179 offset:12288
ds_read_b64_tr_b16 v[150:151], v179 offset:14336
ds_read_b64_tr_b16 v[152:153], v178 offset:12800
ds_read_b64_tr_b16 v[154:155], v178 offset:14848
ds_read_b64_tr_b16 v[156:157], v179 offset:12800
ds_read_b64_tr_b16 v[158:159], v179 offset:14848
s_nop 7
v_max3_f32 v175, v160, v161, v162
v_max3_f32 v175, v175, v163, v164
v_max3_f32 v175, v175, v165, v166
v_max3_f32 v175, v175, v167, v172
v_mov_b32 v176, v175
s_nop 1
v_permlane32_swap_b32 v175, v176
s_nop 1
v_max_f32 v175, v175, v176
v_mov_b32 v176, v175
s_nop 1
v_permlane16_swap_b32 v175, v176
s_nop 1
v_max_f32 v175, v175, v176
v_sub_f32 v174, v172, v175
v_exp_f32 v174, v174
v_mov_b32 v172, v175
v_sub_f32 v160, v160, v172
v_sub_f32 v161, v161, v172
v_sub_f32 v162, v162, v172
v_sub_f32 v163, v163, v172
v_sub_f32 v164, v164, v172
v_sub_f32 v165, v165, v172
v_sub_f32 v166, v166, v172
v_sub_f32 v167, v167, v172
v_exp_f32 v160, v160
v_exp_f32 v161, v161
v_exp_f32 v162, v162
v_exp_f32 v163, v163
v_exp_f32 v164, v164
v_exp_f32 v165, v165
v_exp_f32 v166, v166
v_exp_f32 v167, v167
v_cmp_neq_f32 vcc, 1.0, v174
v_cvt_pk_bf16_f32 v168, v160, v161
v_cvt_pk_bf16_f32 v169, v162, v163
v_cvt_pk_bf16_f32 v170, v164, v165
v_cvt_pk_bf16_f32 v171, v166, v167
s_cbranch_vccz LS_nors
v_accvgpr_read_b32 v180, a0
v_accvgpr_read_b32 v181, a1
v_accvgpr_read_b32 v182, a2
v_accvgpr_read_b32 v183, a3
v_accvgpr_read_b32 v184, a4
v_accvgpr_read_b32 v185, a5
v_accvgpr_read_b32 v186, a6
v_accvgpr_read_b32 v187, a7
v_mul_f32 v180, v180, v174
v_mul_f32 v181, v181, v174
v_mul_f32 v182, v182, v174
v_mul_f32 v183, v183, v174
v_mul_f32 v184, v184, v174
v_mul_f32 v185, v185, v174
v_mul_f32 v186, v186, v174
v_mul_f32 v187, v187, v174
v_accvgpr_write_b32 a0, v180
v_accvgpr_write_b32 a1, v181
v_accvgpr_write_b32 a2, v182
v_accvgpr_write_b32 a3, v183
v_accvgpr_write_b32 a4, v184
v_accvgpr_write_b32 a5, v185
v_accvgpr_write_b32 a6, v186
v_accvgpr_write_b32 a7, v187
v_accvgpr_read_b32 v180, a8
v_accvgpr_read_b32 v181, a9
v_accvgpr_read_b32 v182, a10
v_accvgpr_read_b32 v183, a11
v_accvgpr_read_b32 v184, a12
v_accvgpr_read_b32 v185, a13
v_accvgpr_read_b32 v186, a14
v_accvgpr_read_b32 v187, a15
v_mul_f32 v180, v180, v174
v_mul_f32 v181, v181, v174
v_mul_f32 v182, v182, v174
v_mul_f32 v183, v183, v174
v_mul_f32 v184, v184, v174
v_mul_f32 v185, v185, v174
v_mul_f32 v186, v186, v174
v_mul_f32 v187, v187, v174
v_accvgpr_write_b32 a8, v180
v_accvgpr_write_b32 a9, v181
v_accvgpr_write_b32 a10, v182
v_accvgpr_write_b32 a11, v183
v_accvgpr_write_b32 a12, v184
v_accvgpr_write_b32 a13, v185
v_accvgpr_write_b32 a14, v186
v_accvgpr_write_b32 a15, v187
v_accvgpr_read_b32 v180, a16
v_accvgpr_read_b32 v181, a17
v_accvgpr_read_b32 v182, a18
v_accvgpr_read_b32 v183, a19
v_accvgpr_read_b32 v184, a20
v_accvgpr_read_b32 v185, a21
v_accvgpr_read_b32 v186, a22
v_accvgpr_read_b32 v187, a23
v_mul_f32 v180, v180, v174
v_mul_f32 v181, v181, v174
v_mul_f32 v182, v182, v174
v_mul_f32 v183, v183, v174
v_mul_f32 v184, v184, v174
v_mul_f32 v185, v185, v174
v_mul_f32 v186, v186, v174
v_mul_f32 v187, v187, v174
v_accvgpr_write_b32 a16, v180
v_accvgpr_write_b32 a17, v181
v_accvgpr_write_b32 a18, v182
v_accvgpr_write_b32 a19, v183
v_accvgpr_write_b32 a20, v184
v_accvgpr_write_b32 a21, v185
v_accvgpr_write_b32 a22, v186
v_accvgpr_write_b32 a23, v187
v_accvgpr_read_b32 v180, a24
v_accvgpr_read_b32 v181, a25
v_accvgpr_read_b32 v182, a26
v_accvgpr_read_b32 v183, a27
v_accvgpr_read_b32 v184, a28
v_accvgpr_read_b32 v185, a29
v_accvgpr_read_b32 v186, a30
v_accvgpr_read_b32 v187, a31
v_mul_f32 v180, v180, v174
v_mul_f32 v181, v181, v174
v_mul_f32 v182, v182, v174
v_mul_f32 v183, v183, v174
v_mul_f32 v184, v184, v174
v_mul_f32 v185, v185, v174
v_mul_f32 v186, v186, v174
v_mul_f32 v187, v187, v174
v_accvgpr_write_b32 a24, v180
v_accvgpr_write_b32 a25, v181
v_accvgpr_write_b32 a26, v182
v_accvgpr_write_b32 a27, v183
v_accvgpr_write_b32 a28, v184
v_accvgpr_write_b32 a29, v185
v_accvgpr_write_b32 a30, v186
v_accvgpr_write_b32 a31, v187
v_accvgpr_read_b32 v180, a32
v_accvgpr_read_b32 v181, a33
v_accvgpr_read_b32 v182, a34
v_accvgpr_read_b32 v183, a35
v_accvgpr_read_b32 v184, a36
v_accvgpr_read_b32 v185, a37
v_accvgpr_read_b32 v186, a38
v_accvgpr_read_b32 v187, a39
v_mul_f32 v180, v180, v174
v_mul_f32 v181, v181, v174
v_mul_f32 v182, v182, v174
v_mul_f32 v183, v183, v174
v_mul_f32 v184, v184, v174
v_mul_f32 v185, v185, v174
v_mul_f32 v186, v186, v174
v_mul_f32 v187, v187, v174
v_accvgpr_write_b32 a32, v180
v_accvgpr_write_b32 a33, v181
v_accvgpr_write_b32 a34, v182
v_accvgpr_write_b32 a35, v183
v_accvgpr_write_b32 a36, v184
v_accvgpr_write_b32 a37, v185
v_accvgpr_write_b32 a38, v186
v_accvgpr_write_b32 a39, v187
v_accvgpr_read_b32 v180, a40
v_accvgpr_read_b32 v181, a41
v_accvgpr_read_b32 v182, a42
v_accvgpr_read_b32 v183, a43
v_accvgpr_read_b32 v184, a44
v_accvgpr_read_b32 v185, a45
v_accvgpr_read_b32 v186, a46
v_accvgpr_read_b32 v187, a47
v_mul_f32 v180, v180, v174
v_mul_f32 v181, v181, v174
v_mul_f32 v182, v182, v174
v_mul_f32 v183, v183, v174
v_mul_f32 v184, v184, v174
v_mul_f32 v185, v185, v174
v_mul_f32 v186, v186, v174
v_mul_f32 v187, v187, v174
v_accvgpr_write_b32 a40, v180
v_accvgpr_write_b32 a41, v181
v_accvgpr_write_b32 a42, v182
v_accvgpr_write_b32 a43, v183
v_accvgpr_write_b32 a44, v184
v_accvgpr_write_b32 a45, v185
v_accvgpr_write_b32 a46, v186
v_accvgpr_write_b32 a47, v187
v_accvgpr_read_b32 v180, a48
v_accvgpr_read_b32 v181, a49
v_accvgpr_read_b32 v182, a50
v_accvgpr_read_b32 v183, a51
v_accvgpr_read_b32 v184, a52
v_accvgpr_read_b32 v185, a53
v_accvgpr_read_b32 v186, a54
v_accvgpr_read_b32 v187, a55
v_mul_f32 v180, v180, v174
v_mul_f32 v181, v181, v174
v_mul_f32 v182, v182, v174
v_mul_f32 v183, v183, v174
v_mul_f32 v184, v184, v174
v_mul_f32 v185, v185, v174
v_mul_f32 v186, v186, v174
v_mul_f32 v187, v187, v174
v_accvgpr_write_b32 a48, v180
v_accvgpr_write_b32 a49, v181
v_accvgpr_write_b32 a50, v182
v_accvgpr_write_b32 a51, v183
v_accvgpr_write_b32 a52, v184
v_accvgpr_write_b32 a53, v185
v_accvgpr_write_b32 a54, v186
v_accvgpr_write_b32 a55, v187
v_accvgpr_read_b32 v180, a56
v_accvgpr_read_b32 v181, a57
v_accvgpr_read_b32 v182, a58
v_accvgpr_read_b32 v183, a59
v_accvgpr_read_b32 v184, a60
v_accvgpr_read_b32 v185, a61
v_accvgpr_read_b32 v186, a62
v_accvgpr_read_b32 v187, a63
v_mul_f32 v180, v180, v174
v_mul_f32 v181, v181, v174
v_mul_f32 v182, v182, v174
v_mul_f32 v183, v183, v174
v_mul_f32 v184, v184, v174
v_mul_f32 v185, v185, v174
v_mul_f32 v186, v186, v174
v_mul_f32 v187, v187, v174
v_accvgpr_write_b32 a56, v180
v_accvgpr_write_b32 a57, v181
v_accvgpr_write_b32 a58, v182
v_accvgpr_write_b32 a59, v183
v_accvgpr_write_b32 a60, v184
v_accvgpr_write_b32 a61, v185
v_accvgpr_write_b32 a62, v186
v_accvgpr_write_b32 a63, v187
LS_nors:
s_waitcnt lgkmcnt(0)
s_nop 1
v_mfma_f32_16x16x32_bf16 a[0:3], v[96:99], v[168:171], a[0:3]
v_mfma_f32_16x16x32_bf16 a[4:7], v[100:103], v[168:171], a[4:7]
v_mfma_f32_16x16x32_bf16 a[8:11], v[104:107], v[168:171], a[8:11]
v_mfma_f32_16x16x32_bf16 a[12:15], v[108:111], v[168:171], a[12:15]
v_mfma_f32_16x16x32_bf16 a[16:19], v[112:115], v[168:171], a[16:19]
v_mfma_f32_16x16x32_bf16 a[20:23], v[116:119], v[168:171], a[20:23]
v_mfma_f32_16x16x32_bf16 a[24:27], v[120:123], v[168:171], a[24:27]
v_mfma_f32_16x16x32_bf16 a[28:31], v[124:127], v[168:171], a[28:31]
v_mfma_f32_16x16x32_bf16 a[32:35], v[128:131], v[168:171], a[32:35]
v_mfma_f32_16x16x32_bf16 a[36:39], v[132:135], v[168:171], a[36:39]
v_mfma_f32_16x16x32_bf16 a[40:43], v[136:139], v[168:171], a[40:43]
v_mfma_f32_16x16x32_bf16 a[44:47], v[140:143], v[168:171], a[44:47]
v_mfma_f32_16x16x32_bf16 a[48:51], v[144:147], v[168:171], a[48:51]
v_mfma_f32_16x16x32_bf16 a[52:55], v[148:151], v[168:171], a[52:55]
v_mfma_f32_16x16x32_bf16 a[56:59], v[152:155], v[168:171], a[56:59]
v_mfma_f32_16x16x32_bf16 a[60:63], v[156:159], v[168:171], a[60:63]
s_sub_u32 s51, s51, 1
s_cmp_lg_u32 s51, 0
s_cbranch_scc1 LS_loop
s_nop 15
v_accvgpr_read_b32 v173, a0
v_accvgpr_read_b32 v180, a0
v_accvgpr_read_b32 v181, a1
v_accvgpr_read_b32 v182, a2
v_accvgpr_read_b32 v183, a3
v_accvgpr_read_b32 v184, a4
v_accvgpr_read_b32 v185, a5
v_accvgpr_read_b32 v186, a6
v_accvgpr_read_b32 v187, a7
v_cvt_pk_bf16_f32 v32, v180, v181
v_cvt_pk_bf16_f32 v33, v182, v183
v_cvt_pk_bf16_f32 v34, v184, v185
v_cvt_pk_bf16_f32 v35, v186, v187
buffer_store_dwordx4 v[32:35], v252, s[20:23], s40 offen offset:0 sc1
v_accvgpr_read_b32 v180, a8
v_accvgpr_read_b32 v181, a9
v_accvgpr_read_b32 v182, a10
v_accvgpr_read_b32 v183, a11
v_accvgpr_read_b32 v184, a12
v_accvgpr_read_b32 v185, a13
v_accvgpr_read_b32 v186, a14
v_accvgpr_read_b32 v187, a15
v_cvt_pk_bf16_f32 v36, v180, v181
v_cvt_pk_bf16_f32 v37, v182, v183
v_cvt_pk_bf16_f32 v38, v184, v185
v_cvt_pk_bf16_f32 v39, v186, v187
buffer_store_dwordx4 v[36:39], v252, s[20:23], s40 offen offset:1024 sc1
v_accvgpr_read_b32 v180, a16
v_accvgpr_read_b32 v181, a17
v_accvgpr_read_b32 v182, a18
v_accvgpr_read_b32 v183, a19
v_accvgpr_read_b32 v184, a20
v_accvgpr_read_b32 v185, a21
v_accvgpr_read_b32 v186, a22
v_accvgpr_read_b32 v187, a23
v_cvt_pk_bf16_f32 v40, v180, v181
v_cvt_pk_bf16_f32 v41, v182, v183
v_cvt_pk_bf16_f32 v42, v184, v185
v_cvt_pk_bf16_f32 v43, v186, v187
buffer_store_dwordx4 v[40:43], v252, s[20:23], s40 offen offset:2048 sc1
v_accvgpr_read_b32 v180, a24
v_accvgpr_read_b32 v181, a25
v_accvgpr_read_b32 v182, a26
v_accvgpr_read_b32 v183, a27
v_accvgpr_read_b32 v184, a28
v_accvgpr_read_b32 v185, a29
v_accvgpr_read_b32 v186, a30
v_accvgpr_read_b32 v187, a31
v_cvt_pk_bf16_f32 v44, v180, v181
v_cvt_pk_bf16_f32 v45, v182, v183
v_cvt_pk_bf16_f32 v46, v184, v185
v_cvt_pk_bf16_f32 v47, v186, v187
buffer_store_dwordx4 v[44:47], v252, s[20:23], s40 offen offset:3072 sc1
v_accvgpr_read_b32 v180, a32
v_accvgpr_read_b32 v181, a33
v_accvgpr_read_b32 v182, a34
v_accvgpr_read_b32 v183, a35
v_accvgpr_read_b32 v184, a36
v_accvgpr_read_b32 v185, a37
v_accvgpr_read_b32 v186, a38
v_accvgpr_read_b32 v187, a39
v_cvt_pk_bf16_f32 v48, v180, v181
v_cvt_pk_bf16_f32 v49, v182, v183
v_cvt_pk_bf16_f32 v50, v184, v185
v_cvt_pk_bf16_f32 v51, v186, v187
buffer_store_dwordx4 v[48:51], v252, s[20:23], s44 offen offset:0 sc1
v_accvgpr_read_b32 v180, a40
v_accvgpr_read_b32 v181, a41
v_accvgpr_read_b32 v182, a42
v_accvgpr_read_b32 v183, a43
v_accvgpr_read_b32 v184, a44
v_accvgpr_read_b32 v185, a45
v_accvgpr_read_b32 v186, a46
v_accvgpr_read_b32 v187, a47
v_cvt_pk_bf16_f32 v52, v180, v181
v_cvt_pk_bf16_f32 v53, v182, v183
v_cvt_pk_bf16_f32 v54, v184, v185
v_cvt_pk_bf16_f32 v55, v186, v187
buffer_store_dwordx4 v[52:55], v252, s[20:23], s44 offen offset:1024 sc1
v_accvgpr_read_b32 v180, a48
v_accvgpr_read_b32 v181, a49
v_accvgpr_read_b32 v182, a50
v_accvgpr_read_b32 v183, a51
v_accvgpr_read_b32 v184, a52
v_accvgpr_read_b32 v185, a53
v_accvgpr_read_b32 v186, a54
v_accvgpr_read_b32 v187, a55
v_cvt_pk_bf16_f32 v56, v180, v181
v_cvt_pk_bf16_f32 v57, v182, v183
v_cvt_pk_bf16_f32 v58, v184, v185
v_cvt_pk_bf16_f32 v59, v186, v187
buffer_store_dwordx4 v[56:59], v252, s[20:23], s44 offen offset:2048 sc1
v_accvgpr_read_b32 v180, a56
v_accvgpr_read_b32 v181, a57
v_accvgpr_read_b32 v182, a58
v_accvgpr_read_b32 v183, a59
v_accvgpr_read_b32 v184, a60
v_accvgpr_read_b32 v185, a61
v_accvgpr_read_b32 v186, a62
v_accvgpr_read_b32 v187, a63
v_cvt_pk_bf16_f32 v60, v180, v181
v_cvt_pk_bf16_f32 v61, v182, v183
v_cvt_pk_bf16_f32 v62, v184, v185
v_cvt_pk_bf16_f32 v63, v186, v187
buffer_store_dwordx4 v[60:63], v252, s[20:23], s44 offen offset:3072 sc1
v_lshlrev_b32 v175, 2, v252
s_mov_b64 exec, 0xffff
buffer_store_dwordx2 v[172:173], v175, s[24:27], s48 offen sc1
s_mov_b64 exec, -1
s_waitcnt vmcnt(0)
s_add_u32 s40, s40, 8192
s_add_u32 s48, s48, 1024
s_sub_u32 s55, s55, 1
s_cmp_lg_u32 s55, 0
s_cbranch_scc1 LS_q
s_barrier
s_add_u32 s56, s4, 0x1000000
s_addc_u32 s57, s5, 0
s_mov_b32 s58, 0x6c02000
s_mov_b32 s59, 0x00020000
s_mul_i32 s35, s37, 3
s_and_b32 s36, s35, 3
s_lshl_b32 s36, s36, 2
s_lshr_b32 s52, s35, 2
s_add_u32 s36, s36, s52
s_lshl_b32 s52, s38, 4
s_add_u32 s52, s52, s36
s_lshl_b32 s52, s52, 13
s_add_u32 s35, s35, 1
s_and_b32 s36, s35, 3
s_lshl_b32 s36, s36, 2
s_lshr_b32 s53, s35, 2
s_add_u32 s36, s36, s53
s_lshl_b32 s53, s38, 4
s_add_u32 s53, s53, s36
s_lshl_b32 s53, s53, 13
s_add_u32 s35, s35, 1
s_and_b32 s36, s35, 3
s_lshl_b32 s36, s36, 2
s_lshr_b32 s54, s35, 2
s_add_u32 s36, s36, s54
s_lshl_b32 s54, s38, 4
s_add_u32 s54, s54, s36
s_lshl_b32 s54, s54, 13
s_mov_b32 s99, 0
s_mov_b32 s98, 2
s_branch LC_again
LT_disp:
s_cmp_eq_u32 s34, 0
s_cbranch_scc1 LT_start
s_mov_b32 s41, s34
s_mul_i32 s40, s34, 6
s_add_u32 s40, s40, s37
s_add_u32 s40, s40, 42
s_cmp_lt_u32 s40, 60
s_cbranch_scc1 LE_common
s_branch L2_end
LT_start:
s_waitcnt lgkmcnt(0)
s_add_u32 s12, s4, 0x6800000
s_addc_u32 s13, s5, 0
s_mov_b32 s14, s49
s_mov_b32 s15, 0x00020000
s_add_u32 s8, s4, 0x0
s_addc_u32 s9, s5, 0
s_mov_b32 s10, 0x4e4000
s_mov_b32 s11, 0x00020000
s_mul_i32 s35, s37, 0x600000
s_add_u32 s20, s4, 0x2000000
s_addc_u32 s21, s5, 0
s_add_u32 s20, s20, s35
s_addc_u32 s21, s21, 0
s_mov_b32 s22, 0x4e4000
s_mov_b32 s23, 0x00020000
s_add_u32 s24, s4, 0x6000000
s_addc_u32 s25, s5, 0
s_mov_b32 s26, 0x9c800
s_mov_b32 s27, 0x00020000
s_lshl_b32 s35, s38, 4
s_lshl_b32 s41, s34, 2
s_add_u32 s35, s35, s41
s_lshl_b32 s40, s35, 13
s_lshl_b32 s48, s35, 10
s_lshl_b32 s35, s37, 3
s_add_u32 s48, s48, s35
v_bfe_u32 v248, v252, 4, 3
v_lshlrev_b32 v248, 6, v248
v_bfe_u32 v253, v252, 7, 1
v_lshl_or_b32 v248, v253, 10, v248
v_bfe_u32 v253, v252, 8, 2
v_lshl_or_b32 v248, v253, 4, v248
v_bfe_u32 v253, v252, 6, 1
v_lshlrev_b32 v253, 5, v253
v_xor_b32 v248, v248, v253
v_and_b32 v249, 0x1c0, v252
v_bfe_u32 v253, v252, 9, 1
v_lshl_or_b32 v249, v253, 10, v249
v_bfe_u32 v253, v252, 8, 1
v_lshl_or_b32 v249, v253, 5, v249
v_bfe_u32 v253, v252, 4, 2
v_lshl_or_b32 v249, v253, 3, v249
v_xor_b32 v250, 32, v249
s_mov_b32 s56, 90112
s_add_u32 s57, s56, 65536
s_mov_b32 s55, 1
v_bfe_i32 v188, v252, 8, 1
LT_q:
s_add_u32 s44, s40, 4096
buffer_load_dwordx4 v[0:3], v252, s[8:11], s40 offen offset:0
buffer_load_dwordx4 v[4:7], v252, s[8:11], s40 offen offset:1024
buffer_load_dwordx4 v[8:11], v252, s[8:11], s40 offen offset:2048
buffer_load_dwordx4 v[12:15], v252, s[8:11], s40 offen offset:3072
buffer_load_dwordx4 v[16:19], v252, s[8:11], s44 offen offset:0
buffer_load_dwordx4 v[20:23], v252, s[8:11], s44 offen offset:1024
buffer_load_dwordx4 v[24:27], v252, s[8:11], s44 offen offset:2048
buffer_load_dwordx4 v[28:31], v252, s[8:11], s44 offen offset:3072
s_mov_b32 s53, s56
s_mov_b32 s58, s39
s_add_u32 m0, s53, 0
s_add_u32 s54, s58, 0
buffer_load_dwordx4 v251, s[12:15], s54 offen offset:0 lds
buffer_load_dwordx4 v251, s[12:15], s54 offen offset:1024 lds
buffer_load_dwordx4 v251, s[12:15], s54 offen offset:2048 lds
buffer_load_dwordx4 v251, s[12:15], s54 offen offset:3072 lds
s_add_u32 m0, s53, 4096
s_add_u32 s54, s58, 128
buffer_load_dwordx4 v251, s[12:15], s54 offen offset:0 lds
buffer_load_dwordx4 v251, s[12:15], s54 offen offset:1024 lds
buffer_load_dwordx4 v251, s[12:15], s54 offen offset:2048 lds
buffer_load_dwordx4 v251, s[12:15], s54 offen offset:3072 lds
s_add_u32 m0, s53, 8192
s_add_u32 s54, s58, 256
buffer_load_dwordx4 v251, s[12:15], s54 offen offset:0 lds
buffer_load_dwordx4 v251, s[12:15], s54 offen offset:1024 lds
buffer_load_dwordx4 v251, s[12:15], s54 offen offset:2048 lds
buffer_load_dwordx4 v251, s[12:15], s54 offen offset:3072 lds
s_add_u32 m0, s53, 12288
s_add_u32 s54, s58, 384
buffer_load_dwordx4 v251, s[12:15], s54 offen offset:0 lds
buffer_load_dwordx4 v251, s[12:15], s54 offen offset:1024 lds
buffer_load_dwordx4 v251, s[12:15], s54 offen offset:2048 lds
buffer_load_dwordx4 v251, s[12:15], s54 offen offset:3072 lds
s_add_u32 s53, s53, 0x4000
s_cmp_eq_u32 s53, s57
s_cselect_b32 s53, s56, s53
s_add_u32 s58, s58, 0x4000
s_add_u32 m0, s53, 0
s_add_u32 s54, s58, 0
buffer_load_dwordx4 v251, s[12:15], s54 offen offset:0 lds
buffer_load_dwordx4 v251, s[12:15], s54 offen offset:1024 lds
buffer_load_dwordx4 v251, s[12:15], s54 offen offset:2048 lds
buffer_load_dwordx4 v251, s[12:15], s54 offen offset:3072 lds
s_add_u32 m0, s53, 4096
s_add_u32 s54, s58, 128
buffer_load_dwordx4 v251, s[12:15], s54 offen offset:0 lds
buffer_load_dwordx4 v251, s[12:15], s54 offen offset:1024 lds
buffer_load_dwordx4 v251, s[12:15], s54 offen offset:2048 lds
buffer_load_dwordx4 v251, s[12:15], s54 offen offset:3072 lds
s_add_u32 m0, s53, 8192
s_add_u32 s54, s58, 256
buffer_load_dwordx4 v251, s[12:15], s54 offen offset:0 lds
buffer_load_dwordx4 v251, s[12:15], s54 offen offset:1024 lds
buffer_load_dwordx4 v251, s[12:15], s54 offen offset:2048 lds
buffer_load_dwordx4 v251, s[12:15], s54 offen offset:3072 lds
s_add_u32 m0, s53, 12288
s_add_u32 s54, s58, 384
buffer_load_dwordx4 v251, s[12:15], s54 offen offset:0 lds
buffer_load_dwordx4 v251, s[12:15], s54 offen offset:1024 lds
buffer_load_dwordx4 v251, s[12:15], s54 offen offset:2048 lds
buffer_load_dwordx4 v251, s[12:15], s54 offen offset:3072 lds
s_add_u32 s53, s53, 0x4000
s_cmp_eq_u32 s53, s57
s_cselect_b32 s53, s56, s53
s_add_u32 s58, s58, 0x4000
s_add_u32 m0, s53, 0
s_add_u32 s54, s58, 0
buffer_load_dwordx4 v251, s[12:15], s54 offen offset:0 lds
buffer_load_dwordx4 v251, s[12:15], s54 offen offset:1024 lds
buffer_load_dwordx4 v251, s[12:15], s54 offen offset:2048 lds
buffer_load_dwordx4 v251, s[12:15], s54 offen offset:3072 lds
s_add_u32 m0, s53, 4096
s_add_u32 s54, s58, 128
buffer_load_dwordx4 v251, s[12:15], s54 offen offset:0 lds
buffer_load_dwordx4 v251, s[12:15], s54 offen offset:1024 lds
buffer_load_dwordx4 v251, s[12:15], s54 offen offset:2048 lds
buffer_load_dwordx4 v251, s[12:15], s54 offen offset:3072 lds
s_add_u32 m0, s53, 8192
s_add_u32 s54, s58, 256
buffer_load_dwordx4 v251, s[12:15], s54 offen offset:0 lds
buffer_load_dwordx4 v251, s[12:15], s54 offen offset:1024 lds
buffer_load_dwordx4 v251, s[12:15], s54 offen offset:2048 lds
buffer_load_dwordx4 v251, s[12:15], s54 offen offset:3072 lds
s_add_u32 m0, s53, 12288
s_add_u32 s54, s58, 384
buffer_load_dwordx4 v251, s[12:15], s54 offen offset:0 lds
buffer_load_dwordx4 v251, s[12:15], s54 offen offset:1024 lds
buffer_load_dwordx4 v251, s[12:15], s54 offen offset:2048 lds
buffer_load_dwordx4 v251, s[12:15], s54 offen offset:3072 lds
s_add_u32 s53, s53, 0x4000
s_cmp_eq_u32 s53, s57
s_cselect_b32 s53, s56, s53
s_add_u32 s58, s58, 0x4000
s_mov_b32 s51, s29
s_mov_b32 s52, s56
v_mov_b32 v172, 0xff800000
v_accvgpr_write_b32 a0, 0
v_accvgpr_write_b32 a1, 0
v_accvgpr_write_b32 a2, 0
v_accvgpr_write_b32 a3, 0
v_accvgpr_write_b32 a4, 0
v_accvgpr_write_b32 a5, 0
v_accvgpr_write_b32 a6, 0
v_accvgpr_write_b32 a7, 0
v_accvgpr_write_b32 a8, 0
v_accvgpr_write_b32 a9, 0
v_accvgpr_write_b32 a10, 0
v_accvgpr_write_b32 a11, 0
v_accvgpr_write_b32 a12, 0
v_accvgpr_write_b32 a13, 0
v_accvgpr_write_b32 a14, 0
v_accvgpr_write_b32 a15, 0
v_accvgpr_write_b32 a16, 0
v_accvgpr_write_b32 a17, 0
v_accvgpr_write_b32 a18, 0
v_accvgpr_write_b32 a19, 0
v_accvgpr_write_b32 a20, 0
v_accvgpr_write_b32 a21, 0
v_accvgpr_write_b32 a22, 0
v_accvgpr_write_b32 a23, 0
v_accvgpr_write_b32 a24, 0
v_accvgpr_write_b32 a25, 0
v_accvgpr_write_b32 a26, 0
v_accvgpr_write_b32 a27, 0
v_accvgpr_write_b32 a28, 0
v_accvgpr_write_b32 a29, 0
v_accvgpr_write_b32 a30, 0
v_accvgpr_write_b32 a31, 0
v_accvgpr_write_b32 a32, 0
v_accvgpr_write_b32 a33, 0
v_accvgpr_write_b32 a34, 0
v_accvgpr_write_b32 a35, 0
v_accvgpr_write_b32 a36, 0
v_accvgpr_write_b32 a37, 0
v_accvgpr_write_b32 a38, 0
v_accvgpr_write_b32 a39, 0
v_accvgpr_write_b32 a40, 0
v_accvgpr_write_b32 a41, 0
v_accvgpr_write_b32 a42, 0
v_accvgpr_write_b32 a43, 0
v_accvgpr_write_b32 a44, 0
v_accvgpr_write_b32 a45, 0
v_accvgpr_write_b32 a46, 0
v_accvgpr_write_b32 a47, 0
v_accvgpr_write_b32 a48, 0
v_accvgpr_write_b32 a49, 0
v_accvgpr_write_b32 a50, 0
v_accvgpr_write_b32 a51, 0
v_accvgpr_write_b32 a52, 0
v_accvgpr_write_b32 a53, 0
v_accvgpr_write_b32 a54, 0
v_accvgpr_write_b32 a55, 0
v_accvgpr_write_b32 a56, 0
v_accvgpr_write_b32 a57, 0
v_accvgpr_write_b32 a58, 0
v_accvgpr_write_b32 a59, 0
v_accvgpr_write_b32 a60, 0
v_accvgpr_write_b32 a61, 0
v_accvgpr_write_b32 a62, 0
v_accvgpr_write_b32 a63, 0
LT_loop:
s_add_u32 m0, s53, 0
s_add_u32 s54, s58, 0
buffer_load_dwordx4 v251, s[12:15], s54 offen offset:0 lds
buffer_load_dwordx4 v251, s[12:15], s54 offen offset:1024 lds
buffer_load_dwordx4 v251, s[12:15], s54 offen offset:2048 lds
buffer_load_dwordx4 v251, s[12:15], s54 offen offset:3072 lds
s_add_u32 m0, s53, 4096
s_add_u32 s54, s58, 128
buffer_load_dwordx4 v251, s[12:15], s54 offen offset:0 lds
buffer_load_dwordx4 v251, s[12:15], s54 offen offset:1024 lds
buffer_load_dwordx4 v251, s[12:15], s54 offen offset:2048 lds
buffer_load_dwordx4 v251, s[12:15], s54 offen offset:3072 lds
s_add_u32 m0, s53, 8192
s_add_u32 s54, s58, 256
buffer_load_dwordx4 v251, s[12:15], s54 offen offset:0 lds
buffer_load_dwordx4 v251, s[12:15], s54 offen offset:1024 lds
buffer_load_dwordx4 v251, s[12:15], s54 offen offset:2048 lds
buffer_load_dwordx4 v251, s[12:15], s54 offen offset:3072 lds
s_add_u32 m0, s53, 12288
s_add_u32 s54, s58, 384
buffer_load_dwordx4 v251, s[12:15], s54 offen offset:0 lds
buffer_load_dwordx4 v251, s[12:15], s54 offen offset:1024 lds
buffer_load_dwordx4 v251, s[12:15], s54 offen offset:2048 lds
buffer_load_dwordx4 v251, s[12:15], s54 offen offset:3072 lds
s_add_u32 s53, s53, 0x4000
s_cmp_eq_u32 s53, s57
s_cselect_b32 s53, s56, s53
s_add_u32 s58, s58, 0x4000
v_add_u32 v177, s52, v248
v_add_u32 v178, s52, v249
v_add_u32 v179, s52, v250
s_add_u32 s52, s52, 0x4000
s_cmp_eq_u32 s52, s57
s_cselect_b32 s52, s56, s52
s_cmp_eq_u32 s51, 1
s_cselect_b32 s54, s33, 0
v_and_b32 v192, s54, v188
v_and_b32 v193, s54, v188
v_and_b32 v194, s54, v188
v_and_b32 v195, s54, v188
s_waitcnt vmcnt(48)
ds_read_b128 v[32:35], v177 offset:0
ds_read_b128 v[64:67], v177 offset:2048
ds_read_b128 v[36:39], v177 offset:512
ds_read_b128 v[68:71], v177 offset:2560
ds_read_b128 v[40:43], v177 offset:4096
ds_read_b128 v[72:75], v177 offset:6144
ds_read_b128 v[44:47], v177 offset:4608
ds_read_b128 v[76:79], v177 offset:6656
ds_read_b128 v[48:51], v177 offset:8192
ds_read_b128 v[80:83], v177 offset:10240
ds_read_b128 v[52:55], v177 offset:8704
ds_read_b128 v[84:87], v177 offset:10752
ds_read_b128 v[56:59], v177 offset:12288
ds_read_b128 v[88:91], v177 offset:14336
ds_read_b128 v[60:63], v177 offset:12800
ds_read_b128 v[92:95], v177 offset:14848
s_waitcnt lgkmcnt(14)
v_mfma_f32_16x16x32_bf16 v[160:163], v[32:35], v[0:3], v[192:195]
v_mfma_f32_16x16x32_bf16 v[164:167], v[64:67], v[0:3], v[192:195]
s_waitcnt lgkmcnt(12)
v_mfma_f32_16x16x32_bf16 v[160:163], v[36:39], v[4:7], v[160:163]
v_mfma_f32_16x16x32_bf16 v[164:167], v[68:71], v[4:7], v[164:167]
s_waitcnt lgkmcnt(10)
v_mfma_f32_16x16x32_bf16 v[160:163], v[40:43], v[8:11], v[160:163]
v_mfma_f32_16x16x32_bf16 v[164:167], v[72:75], v[8:11], v[164:167]
s_waitcnt lgkmcnt(8)
v_mfma_f32_16x16x32_bf16 v[160:163], v[44:47], v[12:15], v[160:163]
v_mfma_f32_16x16x32_bf16 v[164:167], v[76:79], v[12:15], v[164:167]
s_waitcnt lgkmcnt(6)
v_mfma_f32_16x16x32_bf16 v[160:163], v[48:51], v[16:19], v[160:163]
v_mfma_f32_16x16x32_bf16 v[164:167], v[80:83], v[16:19], v[164:167]
s_waitcnt lgkmcnt(4)
v_mfma_f32_16x16x32_bf16 v[160:163], v[52:55], v[20:23], v[160:163]
v_mfma_f32_16x16x32_bf16 v[164:167], v[84:87], v[20:23], v[164:167]
s_waitcnt lgkmcnt(2)
v_mfma_f32_16x16x32_bf16 v[160:163], v[56:59], v[24:27], v[160:163]
v_mfma_f32_16x16x32_bf16 v[164:167], v[88:91], v[24:27], v[164:167]
s_waitcnt lgkmcnt(0)
v_mfma_f32_16x16x32_bf16 v[160:163], v[60:63], v[28:31], v[160:163]
v_mfma_f32_16x16x32_bf16 v[164:167], v[92:95], v[28:31], v[164:167]
ds_read_b64_tr_b16 v[96:97], v178 offset:0
ds_read_b64_tr_b16 v[98:99], v178 offset:2048
ds_read_b64_tr_b16 v[100:101], v179 offset:0
ds_read_b64_tr_b16 v[102:103], v179 offset:2048
ds_read_b64_tr_b16 v[104:105], v178 offset:512
ds_read_b64_tr_b16 v[106:107], v178 offset:2560
ds_read_b64_tr_b16 v[108:109], v179 offset:512
ds_read_b64_tr_b16 v[110:111], v179 offset:2560
ds_read_b64_tr_b16 v[112:113], v178 offset:4096
ds_read_b64_tr_b16 v[114:115], v178 offset:6144
ds_read_b64_tr_b16 v[116:117], v179 offset:4096
ds_read_b64_tr_b16 v[118:119], v179 offset:6144
ds_read_b64_tr_b16 v[120:121], v178 offset:4608
ds_read_b64_tr_b16 v[122:123], v178 offset:6656
ds_read_b64_tr_b16 v[124:125], v179 offset:4608
ds_read_b64_tr_b16 v[126:127], v179 offset:6656
ds_read_b64_tr_b16 v[128:129], v178 offset:8192
ds_read_b64_tr_b16 v[130:131], v178 offset:10240
ds_read_b64_tr_b16 v[132:133], v179 offset:8192
ds_read_b64_tr_b16 v[134:135], v179 offset:10240
ds_read_b64_tr_b16 v[136:137], v178 offset:8704
ds_read_b64_tr_b16 v[138:139], v178 offset:10752
ds_read_b64_tr_b16 v[140:141], v179 offset:8704
ds_read_b64_tr_b16 v[142:143], v179 offset:10752
ds_read_b64_tr_b16 v[144:145], v178 offset:12288
ds_read_b64_tr_b16 v[146:147], v178 offset:14336
ds_read_b64_tr_b16 v[148:149], v179 offset:12288
ds_read_b64_tr_b16 v[150:151], v179 offset:14336
ds_read_b64_tr_b16 v[152:153], v178 offset:12800
ds_read_b64_tr_b16 v[154:155], v178 offset:14848
ds_read_b64_tr_b16 v[156:157], v179 offset:12800
ds_read_b64_tr_b16 v[158:159], v179 offset:14848
s_nop 7
v_max3_f32 v175, v160, v161, v162
v_max3_f32 v175, v175, v163, v164
v_max3_f32 v175, v175, v165, v166
v_max3_f32 v175, v175, v167, v172
v_mov_b32 v176, v175
s_nop 1
v_permlane32_swap_b32 v175, v176
s_nop 1
v_max_f32 v175, v175, v176
v_mov_b32 v176, v175
s_nop 1
v_permlane16_swap_b32 v175, v176
s_nop 1
v_max_f32 v175, v175, v176
v_sub_f32 v174, v172, v175
v_exp_f32 v174, v174
v_mov_b32 v172, v175
v_sub_f32 v160, v160, v172
v_sub_f32 v161, v161, v172
v_sub_f32 v162, v162, v172
v_sub_f32 v163, v163, v172
v_sub_f32 v164, v164, v172
v_sub_f32 v165, v165, v172
v_sub_f32 v166, v166, v172
v_sub_f32 v167, v167, v172
v_exp_f32 v160, v160
v_exp_f32 v161, v161
v_exp_f32 v162, v162
v_exp_f32 v163, v163
v_exp_f32 v164, v164
v_exp_f32 v165, v165
v_exp_f32 v166, v166
v_exp_f32 v167, v167
v_cmp_neq_f32 vcc, 1.0, v174
v_cvt_pk_bf16_f32 v168, v160, v161
v_cvt_pk_bf16_f32 v169, v162, v163
v_cvt_pk_bf16_f32 v170, v164, v165
v_cvt_pk_bf16_f32 v171, v166, v167
s_cbranch_vccz LT_nors
v_accvgpr_read_b32 v180, a0
v_accvgpr_read_b32 v181, a1
v_accvgpr_read_b32 v182, a2
v_accvgpr_read_b32 v183, a3
v_accvgpr_read_b32 v184, a4
v_accvgpr_read_b32 v185, a5
v_accvgpr_read_b32 v186, a6
v_accvgpr_read_b32 v187, a7
v_mul_f32 v180, v180, v174
v_mul_f32 v181, v181, v174
v_mul_f32 v182, v182, v174
v_mul_f32 v183, v183, v174
v_mul_f32 v184, v184, v174
v_mul_f32 v185, v185, v174
v_mul_f32 v186, v186, v174
v_mul_f32 v187, v187, v174
v_accvgpr_write_b32 a0, v180
v_accvgpr_write_b32 a1, v181
v_accvgpr_write_b32 a2, v182
v_accvgpr_write_b32 a3, v183
v_accvgpr_write_b32 a4, v184
v_accvgpr_write_b32 a5, v185
v_accvgpr_write_b32 a6, v186
v_accvgpr_write_b32 a7, v187
v_accvgpr_read_b32 v180, a8
v_accvgpr_read_b32 v181, a9
v_accvgpr_read_b32 v182, a10
v_accvgpr_read_b32 v183, a11
v_accvgpr_read_b32 v184, a12
v_accvgpr_read_b32 v185, a13
v_accvgpr_read_b32 v186, a14
v_accvgpr_read_b32 v187, a15
v_mul_f32 v180, v180, v174
v_mul_f32 v181, v181, v174
v_mul_f32 v182, v182, v174
v_mul_f32 v183, v183, v174
v_mul_f32 v184, v184, v174
v_mul_f32 v185, v185, v174
v_mul_f32 v186, v186, v174
v_mul_f32 v187, v187, v174
v_accvgpr_write_b32 a8, v180
v_accvgpr_write_b32 a9, v181
v_accvgpr_write_b32 a10, v182
v_accvgpr_write_b32 a11, v183
v_accvgpr_write_b32 a12, v184
v_accvgpr_write_b32 a13, v185
v_accvgpr_write_b32 a14, v186
v_accvgpr_write_b32 a15, v187
v_accvgpr_read_b32 v180, a16
v_accvgpr_read_b32 v181, a17
v_accvgpr_read_b32 v182, a18
v_accvgpr_read_b32 v183, a19
v_accvgpr_read_b32 v184, a20
v_accvgpr_read_b32 v185, a21
v_accvgpr_read_b32 v186, a22
v_accvgpr_read_b32 v187, a23
v_mul_f32 v180, v180, v174
v_mul_f32 v181, v181, v174
v_mul_f32 v182, v182, v174
v_mul_f32 v183, v183, v174
v_mul_f32 v184, v184, v174
v_mul_f32 v185, v185, v174
v_mul_f32 v186, v186, v174
v_mul_f32 v187, v187, v174
v_accvgpr_write_b32 a16, v180
v_accvgpr_write_b32 a17, v181
v_accvgpr_write_b32 a18, v182
v_accvgpr_write_b32 a19, v183
v_accvgpr_write_b32 a20, v184
v_accvgpr_write_b32 a21, v185
v_accvgpr_write_b32 a22, v186
v_accvgpr_write_b32 a23, v187
v_accvgpr_read_b32 v180, a24
v_accvgpr_read_b32 v181, a25
v_accvgpr_read_b32 v182, a26
v_accvgpr_read_b32 v183, a27
v_accvgpr_read_b32 v184, a28
v_accvgpr_read_b32 v185, a29
v_accvgpr_read_b32 v186, a30
v_accvgpr_read_b32 v187, a31
v_mul_f32 v180, v180, v174
v_mul_f32 v181, v181, v174
v_mul_f32 v182, v182, v174
v_mul_f32 v183, v183, v174
v_mul_f32 v184, v184, v174
v_mul_f32 v185, v185, v174
v_mul_f32 v186, v186, v174
v_mul_f32 v187, v187, v174
v_accvgpr_write_b32 a24, v180
v_accvgpr_write_b32 a25, v181
v_accvgpr_write_b32 a26, v182
v_accvgpr_write_b32 a27, v183
v_accvgpr_write_b32 a28, v184
v_accvgpr_write_b32 a29, v185
v_accvgpr_write_b32 a30, v186
v_accvgpr_write_b32 a31, v187
v_accvgpr_read_b32 v180, a32
v_accvgpr_read_b32 v181, a33
v_accvgpr_read_b32 v182, a34
v_accvgpr_read_b32 v183, a35
v_accvgpr_read_b32 v184, a36
v_accvgpr_read_b32 v185, a37
v_accvgpr_read_b32 v186, a38
v_accvgpr_read_b32 v187, a39
v_mul_f32 v180, v180, v174
v_mul_f32 v181, v181, v174
v_mul_f32 v182, v182, v174
v_mul_f32 v183, v183, v174
v_mul_f32 v184, v184, v174
v_mul_f32 v185, v185, v174
v_mul_f32 v186, v186, v174
v_mul_f32 v187, v187, v174
v_accvgpr_write_b32 a32, v180
v_accvgpr_write_b32 a33, v181
v_accvgpr_write_b32 a34, v182
v_accvgpr_write_b32 a35, v183
v_accvgpr_write_b32 a36, v184
v_accvgpr_write_b32 a37, v185
v_accvgpr_write_b32 a38, v186
v_accvgpr_write_b32 a39, v187
v_accvgpr_read_b32 v180, a40
v_accvgpr_read_b32 v181, a41
v_accvgpr_read_b32 v182, a42
v_accvgpr_read_b32 v183, a43
v_accvgpr_read_b32 v184, a44
v_accvgpr_read_b32 v185, a45
v_accvgpr_read_b32 v186, a46
v_accvgpr_read_b32 v187, a47
v_mul_f32 v180, v180, v174
v_mul_f32 v181, v181, v174
v_mul_f32 v182, v182, v174
v_mul_f32 v183, v183, v174
v_mul_f32 v184, v184, v174
v_mul_f32 v185, v185, v174
v_mul_f32 v186, v186, v174
v_mul_f32 v187, v187, v174
v_accvgpr_write_b32 a40, v180
v_accvgpr_write_b32 a41, v181
v_accvgpr_write_b32 a42, v182
v_accvgpr_write_b32 a43, v183
v_accvgpr_write_b32 a44, v184
v_accvgpr_write_b32 a45, v185
v_accvgpr_write_b32 a46, v186
v_accvgpr_write_b32 a47, v187
v_accvgpr_read_b32 v180, a48
v_accvgpr_read_b32 v181, a49
v_accvgpr_read_b32 v182, a50
v_accvgpr_read_b32 v183, a51
v_accvgpr_read_b32 v184, a52
v_accvgpr_read_b32 v185, a53
v_accvgpr_read_b32 v186, a54
v_accvgpr_read_b32 v187, a55
v_mul_f32 v180, v180, v174
v_mul_f32 v181, v181, v174
v_mul_f32 v182, v182, v174
v_mul_f32 v183, v183, v174
v_mul_f32 v184, v184, v174
v_mul_f32 v185, v185, v174
v_mul_f32 v186, v186, v174
v_mul_f32 v187, v187, v174
v_accvgpr_write_b32 a48, v180
v_accvgpr_write_b32 a49, v181
v_accvgpr_write_b32 a50, v182
v_accvgpr_write_b32 a51, v183
v_accvgpr_write_b32 a52, v184
v_accvgpr_write_b32 a53, v185
v_accvgpr_write_b32 a54, v186
v_accvgpr_write_b32 a55, v187
v_accvgpr_read_b32 v180, a56
v_accvgpr_read_b32 v181, a57
v_accvgpr_read_b32 v182, a58
v_accvgpr_read_b32 v183, a59
v_accvgpr_read_b32 v184, a60
v_accvgpr_read_b32 v185, a61
v_accvgpr_read_b32 v186, a62
v_accvgpr_read_b32 v187, a63
v_mul_f32 v180, v180, v174
v_mul_f32 v181, v181, v174
v_mul_f32 v182, v182, v174
v_mul_f32 v183, v183, v174
v_mul_f32 v184, v184, v174
v_mul_f32 v185, v185, v174
v_mul_f32 v186, v186, v174
v_mul_f32 v187, v187, v174
v_accvgpr_write_b32 a56, v180
v_accvgpr_write_b32 a57, v181
v_accvgpr_write_b32 a58, v182
v_accvgpr_write_b32 a59, v183
v_accvgpr_write_b32 a60, v184
v_accvgpr_write_b32 a61, v185
v_accvgpr_write_b32 a62, v186
v_accvgpr_write_b32 a63, v187
LT_nors:
s_waitcnt lgkmcnt(0)
s_nop 1
v_mfma_f32_16x16x32_bf16 a[0:3], v[96:99], v[168:171], a[0:3]
v_mfma_f32_16x16x32_bf16 a[4:7], v[100:103], v[168:171], a[4:7]
v_mfma_f32_16x16x32_bf16 a[8:11], v[104:107], v[168:171], a[8:11]
v_mfma_f32_16x16x32_bf16 a[12:15], v[108:111], v[168:171], a[12:15]
v_mfma_f32_16x16x32_bf16 a[16:19], v[112:115], v[168:171], a[16:19]
v_mfma_f32_16x16x32_bf16 a[20:23], v[116:119], v[168:171], a[20:23]
v_mfma_f32_16x16x32_bf16 a[24:27], v[120:123], v[168:171], a[24:27]
v_mfma_f32_16x16x32_bf16 a[28:31], v[124:127], v[168:171], a[28:31]
v_mfma_f32_16x16x32_bf16 a[32:35], v[128:131], v[168:171], a[32:35]
v_mfma_f32_16x16x32_bf16 a[36:39], v[132:135], v[168:171], a[36:39]
v_mfma_f32_16x16x32_bf16 a[40:43], v[136:139], v[168:171], a[40:43]
v_mfma_f32_16x16x32_bf16 a[44:47], v[140:143], v[168:171], a[44:47]
v_mfma_f32_16x16x32_bf16 a[48:51], v[144:147], v[168:171], a[48:51]
v_mfma_f32_16x16x32_bf16 a[52:55], v[148:151], v[168:171], a[52:55]
v_mfma_f32_16x16x32_bf16 a[56:59], v[152:155], v[168:171], a[56:59]
v_mfma_f32_16x16x32_bf16 a[60:63], v[156:159], v[168:171], a[60:63]
s_sub_u32 s51, s51, 1
s_cmp_lg_u32 s51, 0
s_cbranch_scc1 LT_loop
s_nop 15
v_accvgpr_read_b32 v173, a0
v_accvgpr_read_b32 v180, a0
v_accvgpr_read_b32 v181, a1
v_accvgpr_read_b32 v182, a2
v_accvgpr_read_b32 v183, a3
v_accvgpr_read_b32 v184, a4
v_accvgpr_read_b32 v185, a5
v_accvgpr_read_b32 v186, a6
v_accvgpr_read_b32 v187, a7
v_cvt_pk_bf16_f32 v32, v180, v181
v_cvt_pk_bf16_f32 v33, v182, v183
v_cvt_pk_bf16_f32 v34, v184, v185
v_cvt_pk_bf16_f32 v35, v186, v187
buffer_store_dwordx4 v[32:35], v252, s[20:23], s40 offen offset:0 sc1
v_accvgpr_read_b32 v180, a8
v_accvgpr_read_b32 v181, a9
v_accvgpr_read_b32 v182, a10
v_accvgpr_read_b32 v183, a11
v_accvgpr_read_b32 v184, a12
v_accvgpr_read_b32 v185, a13
v_accvgpr_read_b32 v186, a14
v_accvgpr_read_b32 v187, a15
v_cvt_pk_bf16_f32 v36, v180, v181
v_cvt_pk_bf16_f32 v37, v182, v183
v_cvt_pk_bf16_f32 v38, v184, v185
v_cvt_pk_bf16_f32 v39, v186, v187
buffer_store_dwordx4 v[36:39], v252, s[20:23], s40 offen offset:1024 sc1
v_accvgpr_read_b32 v180, a16
v_accvgpr_read_b32 v181, a17
v_accvgpr_read_b32 v182, a18
v_accvgpr_read_b32 v183, a19
v_accvgpr_read_b32 v184, a20
v_accvgpr_read_b32 v185, a21
v_accvgpr_read_b32 v186, a22
v_accvgpr_read_b32 v187, a23
v_cvt_pk_bf16_f32 v40, v180, v181
v_cvt_pk_bf16_f32 v41, v182, v183
v_cvt_pk_bf16_f32 v42, v184, v185
v_cvt_pk_bf16_f32 v43, v186, v187
buffer_store_dwordx4 v[40:43], v252, s[20:23], s40 offen offset:2048 sc1
v_accvgpr_read_b32 v180, a24
v_accvgpr_read_b32 v181, a25
v_accvgpr_read_b32 v182, a26
v_accvgpr_read_b32 v183, a27
v_accvgpr_read_b32 v184, a28
v_accvgpr_read_b32 v185, a29
v_accvgpr_read_b32 v186, a30
v_accvgpr_read_b32 v187, a31
v_cvt_pk_bf16_f32 v44, v180, v181
v_cvt_pk_bf16_f32 v45, v182, v183
v_cvt_pk_bf16_f32 v46, v184, v185
v_cvt_pk_bf16_f32 v47, v186, v187
buffer_store_dwordx4 v[44:47], v252, s[20:23], s40 offen offset:3072 sc1
v_accvgpr_read_b32 v180, a32
v_accvgpr_read_b32 v181, a33
v_accvgpr_read_b32 v182, a34
v_accvgpr_read_b32 v183, a35
v_accvgpr_read_b32 v184, a36
v_accvgpr_read_b32 v185, a37
v_accvgpr_read_b32 v186, a38
v_accvgpr_read_b32 v187, a39
v_cvt_pk_bf16_f32 v48, v180, v181
v_cvt_pk_bf16_f32 v49, v182, v183
v_cvt_pk_bf16_f32 v50, v184, v185
v_cvt_pk_bf16_f32 v51, v186, v187
buffer_store_dwordx4 v[48:51], v252, s[20:23], s44 offen offset:0 sc1
v_accvgpr_read_b32 v180, a40
v_accvgpr_read_b32 v181, a41
v_accvgpr_read_b32 v182, a42
v_accvgpr_read_b32 v183, a43
v_accvgpr_read_b32 v184, a44
v_accvgpr_read_b32 v185, a45
v_accvgpr_read_b32 v186, a46
v_accvgpr_read_b32 v187, a47
v_cvt_pk_bf16_f32 v52, v180, v181
v_cvt_pk_bf16_f32 v53, v182, v183
v_cvt_pk_bf16_f32 v54, v184, v185
v_cvt_pk_bf16_f32 v55, v186, v187
buffer_store_dwordx4 v[52:55], v252, s[20:23], s44 offen offset:1024 sc1
v_accvgpr_read_b32 v180, a48
v_accvgpr_read_b32 v181, a49
v_accvgpr_read_b32 v182, a50
v_accvgpr_read_b32 v183, a51
v_accvgpr_read_b32 v184, a52
v_accvgpr_read_b32 v185, a53
v_accvgpr_read_b32 v186, a54
v_accvgpr_read_b32 v187, a55
v_cvt_pk_bf16_f32 v56, v180, v181
v_cvt_pk_bf16_f32 v57, v182, v183
v_cvt_pk_bf16_f32 v58, v184, v185
v_cvt_pk_bf16_f32 v59, v186, v187
buffer_store_dwordx4 v[56:59], v252, s[20:23], s44 offen offset:2048 sc1
v_accvgpr_read_b32 v180, a56
v_accvgpr_read_b32 v181, a57
v_accvgpr_read_b32 v182, a58
v_accvgpr_read_b32 v183, a59
v_accvgpr_read_b32 v184, a60
v_accvgpr_read_b32 v185, a61
v_accvgpr_read_b32 v186, a62
v_accvgpr_read_b32 v187, a63
v_cvt_pk_bf16_f32 v60, v180, v181
v_cvt_pk_bf16_f32 v61, v182, v183
v_cvt_pk_bf16_f32 v62, v184, v185
v_cvt_pk_bf16_f32 v63, v186, v187
buffer_store_dwordx4 v[60:63], v252, s[20:23], s44 offen offset:3072 sc1
v_lshlrev_b32 v175, 2, v252
s_mov_b64 exec, 0xffff
buffer_store_dwordx2 v[172:173], v175, s[24:27], s48 offen sc1
s_mov_b64 exec, -1
s_waitcnt vmcnt(0)
s_add_u32 s40, s40, 8192
s_add_u32 s48, s48, 1024
s_sub_u32 s55, s55, 1
s_cmp_lg_u32 s55, 0
s_cbranch_scc1 LT_q
s_add_u32 s52, s4, 0x7c00000
s_addc_u32 s53, s5, 0
s_mov_b32 s54, 0x2000
s_mov_b32 s55, 0x00020000
v_mov_b32 v1, 4992
v_mov_b32 v2, 1
s_mov_b64 exec, 1
s_waitcnt vmcnt(0)
buffer_atomic_add v2, v1, s[52:55], 0 offen
s_mov_b64 exec, -1
s_branch L2_fin
LE_start:
s_cmp_ge_u32 s37, 32
s_cbranch_scc1 L2_end
v_lshrrev_b32 v1, 6, v0
s_sub_u32 s37, s37, 30
s_lshl_b32 s35, s35, 1
v_readfirstlane_b32 s41, v1
s_add_u32 s35, s35, s37
s_mul_i32 s35, s35, 3
s_add_u32 s40, s35, s41
s_cmp_ge_u32 s41, 3
s_cbranch_scc1 LC_help
LE_common:
v_and_b32 v1, 63, v0
s_load_dwordx2 s[58:59], s[0:1], 24
s_mov_b32 s42, 0
s_mov_b32 s49, 512
v_lshrrev_b32 v33, 1, v1
v_and_b32 v34, 1, v1
v_mul_u32_u24 v6, 0x5000, v33
v_lshl_add_u32 v6, v34, 4, v6
v_lshlrev_b32 v33, 2, v33
s_mul_i32 s50, s40, 655360
s_mul_i32 s48, s40, 128
s_waitcnt lgkmcnt(0)
s_add_u32 s8, s4, 0x7800000
s_addc_u32 s9, s5, 0
s_mov_b32 s10, 0x2000
s_mov_b32 s11, 0x00020000
s_add_u32 s12, s4, 0x8000000
s_addc_u32 s13, s5, 0
s_mov_b32 s14, 0x2800000
s_mov_b32 s15, 0x00020000
buffer_load_dword v4, v33, s[8:11], s48 offen
buffer_load_dwordx4 v[192:195], v6, s[12:15], s50 offen offset:0
buffer_load_dwordx4 v[196:199], v6, s[12:15], s50 offen offset:32
buffer_load_dwordx4 v[200:203], v6, s[12:15], s50 offen offset:64
buffer_load_dwordx4 v[204:207], v6, s[12:15], s50 offen offset:96
buffer_load_dwordx4 v[208:211], v6, s[12:15], s50 offen offset:128
buffer_load_dwordx4 v[212:215], v6, s[12:15], s50 offen offset:160
buffer_load_dwordx4 v[216:219], v6, s[12:15], s50 offen offset:192
buffer_load_dwordx4 v[220:223], v6, s[12:15], s50 offen offset:224
buffer_load_dwordx4 v[224:227], v6, s[12:15], s50 offen offset:256
buffer_load_dwordx4 v[228:231], v6, s[12:15], s50 offen offset:288
buffer_load_dwordx4 v[232:235], v6, s[12:15], s50 offen offset:320
buffer_load_dwordx4 v[236:239], v6, s[12:15], s50 offen offset:352
buffer_load_dwordx4 v[240:243], v6, s[12:15], s50 offen offset:384
buffer_load_dwordx4 v[244:247], v6, s[12:15], s50 offen offset:416
buffer_load_dwordx4 v[248:251], v6, s[12:15], s50 offen offset:448
buffer_load_dwordx4 v[252:255], v6, s[12:15], s50 offen offset:480
s_add_u32 s16, s58, 0x0
s_addc_u32 s17, s59, 0
s_mov_b32 s18, 0x4e20
s_mov_b32 s19, 0x00020000
v_lshlrev_b32 v35, 1, v1
s_mul_i32 s48, s40, 334
buffer_load_ushort v76, v35, s[16:19], s48 offen offset:0
buffer_load_ushort v77, v35, s[16:19], s48 offen offset:128
buffer_load_ushort v78, v35, s[16:19], s48 offen offset:256
s_add_u32 s16, s4, 0x6800000
s_addc_u32 s17, s5, 0
s_mov_b32 s18, 0x4e2000
s_mov_b32 s19, 0x00020000
s_add_u32 s20, s4, 0x7000000
s_addc_u32 s21, s5, 0
s_mov_b32 s22, 0x4e2000
s_mov_b32 s23, 0x00020000
v_lshlrev_b32 v5, 2, v34
v_and_b32 v2, 15, v1
v_lshrrev_b32 v3, 4, v1
v_mov_b32 v16, 1
v_mov_b32 v17, 4
v_and_b32 v33, 1, v2
v_lshlrev_b32 v33, 4, v33
v_lshlrev_b32 v33, v33, v16
v_mul_u32_u24 v33, 0x3f80, v33
v_lshrrev_b32 v34, 1, v2
v_cmp_eq_u32 vcc, 0, v34
s_nop 1
v_cndmask_b32 v40, 0, v33, vcc
v_cmp_eq_u32 vcc, 1, v34
s_nop 1
v_cndmask_b32 v41, 0, v33, vcc
v_cmp_eq_u32 vcc, 2, v34
s_nop 1
v_cndmask_b32 v42, 0, v33, vcc
v_cmp_eq_u32 vcc, 3, v34
s_nop 1
v_cndmask_b32 v43, 0, v33, vcc
v_cmp_eq_u32 vcc, 4, v34
s_nop 1
v_cndmask_b32 v44, 0, v33, vcc
v_cmp_eq_u32 vcc, 5, v34
s_nop 1
v_cndmask_b32 v45, 0, v33, vcc
v_cmp_eq_u32 vcc, 6, v34
s_nop 1
v_cndmask_b32 v46, 0, v33, vcc
v_cmp_eq_u32 vcc, 7, v34
s_nop 1
v_cndmask_b32 v47, 0, v33, vcc
v_lshlrev_b32 v39, 5, v2
v_lshl_add_u32 v39, v3, 3, v39
v_lshlrev_b32 v2, 4, v2
s_mul_i32 s48, s41, 21504
s_add_u32 s48, s48, 4096
v_mov_b32 v36, s48
v_lshl_add_u32 v38, v3, 2, v36
s_lshl_b32 s36, s41, 10
v_mov_b32 v7, s36
v_lshlrev_b32 v35, 4, v1
v_add_u32 v68, s48, v35
v_add_u32 v35, s36, v35
v_lshlrev_b32 v33, 2, v1
v_mov_b32 v72, 0xffff
v_mov_b32 v73, 0xffff
v_mov_b32 v74, 0xffff
v_mov_b32 v75, 0xffff
v_cmp_gt_u32 vcc, 167, v33
v_mov_b32 v48, 0
s_nop 0
v_cndmask_b32 v18, 0, v16, vcc
v_cmp_gt_u32 vcc, 166, v33
v_mov_b32 v49, 0
s_nop 0
v_cndmask_b32 v19, 0, v16, vcc
v_cmp_gt_u32 vcc, 165, v33
v_mov_b32 v50, 0
s_nop 0
v_cndmask_b32 v20, 0, v16, vcc
v_cmp_gt_u32 vcc, 164, v33
v_mov_b32 v51, 0
s_nop 0
v_cndmask_b32 v21, 0, v16, vcc
LE_pass:
ds_write_b128 v35, v[48:51]
ds_write_b128 v68, v[72:75] offset:0
ds_write_b128 v68, v[72:75] offset:1024
ds_write_b128 v68, v[72:75] offset:2048
ds_write_b128 v68, v[72:75] offset:3072
ds_write_b128 v68, v[72:75] offset:4096
ds_write_b128 v68, v[72:75] offset:5120
ds_write_b128 v68, v[72:75] offset:6144
ds_write_b128 v68, v[72:75] offset:7168
ds_write_b128 v68, v[72:75] offset:8192
ds_write_b128 v68, v[72:75] offset:9216
ds_write_b128 v68, v[72:75] offset:10240
ds_write_b128 v68, v[72:75] offset:11264
ds_write_b128 v68, v[72:75] offset:12288
ds_write_b128 v68, v[72:75] offset:13312
ds_write_b128 v68, v[72:75] offset:14336
ds_write_b128 v68, v[72:75] offset:15360
ds_write_b128 v68, v[72:75] offset:16384
ds_write_b128 v68, v[72:75] offset:17408
ds_write_b128 v68, v[72:75] offset:18432
ds_write_b128 v68, v[72:75] offset:19456
v_lshl_add_u32 v32, v1, 2, v36
ds_write_b32 v32, v48 offset:20480
s_waitcnt vmcnt(19)
v_sub_u32 v32, v4, v5
s_waitcnt vmcnt(15)
v_cmpx_lt_i32 vcc, 0, v32
s_cbranch_execz LE_c
v_mad_u32_u16 v128, v192, 1, v7 op_sel:[1,0,0,0]
ds_add_u32 v128, v16
v_cmpx_lt_i32 vcc, 1, v32
v_mad_u32_u16 v129, v193, 1, v7 op_sel:[1,0,0,0]
ds_add_u32 v129, v16
v_cmpx_lt_i32 vcc, 2, v32
v_mad_u32_u16 v130, v194, 1, v7 op_sel:[1,0,0,0]
ds_add_u32 v130, v16
v_cmpx_lt_i32 vcc, 3, v32
v_mad_u32_u16 v131, v195, 1, v7 op_sel:[1,0,0,0]
ds_add_u32 v131, v16
s_waitcnt vmcnt(14)
v_cmpx_lt_i32 vcc, 8, v32
s_cbranch_execz LE_c
v_mad_u32_u16 v132, v196, 1, v7 op_sel:[1,0,0,0]
ds_add_u32 v132, v16
v_cmpx_lt_i32 vcc, 9, v32
v_mad_u32_u16 v133, v197, 1, v7 op_sel:[1,0,0,0]
ds_add_u32 v133, v16
v_cmpx_lt_i32 vcc, 10, v32
v_mad_u32_u16 v134, v198, 1, v7 op_sel:[1,0,0,0]
ds_add_u32 v134, v16
v_cmpx_lt_i32 vcc, 11, v32
v_mad_u32_u16 v135, v199, 1, v7 op_sel:[1,0,0,0]
ds_add_u32 v135, v16
s_waitcnt vmcnt(13)
v_cmpx_lt_i32 vcc, 16, v32
s_cbranch_execz LE_c
v_mad_u32_u16 v136, v200, 1, v7 op_sel:[1,0,0,0]
ds_add_u32 v136, v16
v_cmpx_lt_i32 vcc, 17, v32
v_mad_u32_u16 v137, v201, 1, v7 op_sel:[1,0,0,0]
ds_add_u32 v137, v16
v_cmpx_lt_i32 vcc, 18, v32
v_mad_u32_u16 v138, v202, 1, v7 op_sel:[1,0,0,0]
ds_add_u32 v138, v16
v_cmpx_lt_i32 vcc, 19, v32
v_mad_u32_u16 v139, v203, 1, v7 op_sel:[1,0,0,0]
ds_add_u32 v139, v16
s_waitcnt vmcnt(12)
v_cmpx_lt_i32 vcc, 24, v32
s_cbranch_execz LE_c
v_mad_u32_u16 v140, v204, 1, v7 op_sel:[1,0,0,0]
ds_add_u32 v140, v16
v_cmpx_lt_i32 vcc, 25, v32
v_mad_u32_u16 v141, v205, 1, v7 op_sel:[1,0,0,0]
ds_add_u32 v141, v16
v_cmpx_lt_i32 vcc, 26, v32
v_mad_u32_u16 v142, v206, 1, v7 op_sel:[1,0,0,0]
ds_add_u32 v142, v16
v_cmpx_lt_i32 vcc, 27, v32
v_mad_u32_u16 v143, v207, 1, v7 op_sel:[1,0,0,0]
ds_add_u32 v143, v16
s_waitcnt vmcnt(11)
v_cmpx_lt_i32 vcc, 32, v32
s_cbranch_execz LE_c
v_mad_u32_u16 v144, v208, 1, v7 op_sel:[1,0,0,0]
ds_add_u32 v144, v16
v_cmpx_lt_i32 vcc, 33, v32
v_mad_u32_u16 v145, v209, 1, v7 op_sel:[1,0,0,0]
ds_add_u32 v145, v16
v_cmpx_lt_i32 vcc, 34, v32
v_mad_u32_u16 v146, v210, 1, v7 op_sel:[1,0,0,0]
ds_add_u32 v146, v16
v_cmpx_lt_i32 vcc, 35, v32
v_mad_u32_u16 v147, v211, 1, v7 op_sel:[1,0,0,0]
ds_add_u32 v147, v16
s_waitcnt vmcnt(10)
v_cmpx_lt_i32 vcc, 40, v32
s_cbranch_execz LE_c
v_mad_u32_u16 v148, v212, 1, v7 op_sel:[1,0,0,0]
ds_add_u32 v148, v16
v_cmpx_lt_i32 vcc, 41, v32
v_mad_u32_u16 v149, v213, 1, v7 op_sel:[1,0,0,0]
ds_add_u32 v149, v16
v_cmpx_lt_i32 vcc, 42, v32
v_mad_u32_u16 v150, v214, 1, v7 op_sel:[1,0,0,0]
ds_add_u32 v150, v16
v_cmpx_lt_i32 vcc, 43, v32
v_mad_u32_u16 v151, v215, 1, v7 op_sel:[1,0,0,0]
ds_add_u32 v151, v16
s_waitcnt vmcnt(9)
v_cmpx_lt_i32 vcc, 48, v32
s_cbranch_execz LE_c
v_mad_u32_u16 v152, v216, 1, v7 op_sel:[1,0,0,0]
ds_add_u32 v152, v16
v_cmpx_lt_i32 vcc, 49, v32
v_mad_u32_u16 v153, v217, 1, v7 op_sel:[1,0,0,0]
ds_add_u32 v153, v16
v_cmpx_lt_i32 vcc, 50, v32
v_mad_u32_u16 v154, v218, 1, v7 op_sel:[1,0,0,0]
ds_add_u32 v154, v16
v_cmpx_lt_i32 vcc, 51, v32
v_mad_u32_u16 v155, v219, 1, v7 op_sel:[1,0,0,0]
ds_add_u32 v155, v16
s_waitcnt vmcnt(8)
v_cmpx_lt_i32 vcc, 56, v32
s_cbranch_execz LE_c
v_mad_u32_u16 v156, v220, 1, v7 op_sel:[1,0,0,0]
ds_add_u32 v156, v16
v_cmpx_lt_i32 vcc, 57, v32
v_mad_u32_u16 v157, v221, 1, v7 op_sel:[1,0,0,0]
ds_add_u32 v157, v16
v_cmpx_lt_i32 vcc, 58, v32
v_mad_u32_u16 v158, v222, 1, v7 op_sel:[1,0,0,0]
ds_add_u32 v158, v16
v_cmpx_lt_i32 vcc, 59, v32
v_mad_u32_u16 v159, v223, 1, v7 op_sel:[1,0,0,0]
ds_add_u32 v159, v16
s_waitcnt vmcnt(7)
v_cmpx_lt_i32 vcc, 64, v32
s_cbranch_execz LE_c
v_mad_u32_u16 v160, v224, 1, v7 op_sel:[1,0,0,0]
ds_add_u32 v160, v16
v_cmpx_lt_i32 vcc, 65, v32
v_mad_u32_u16 v161, v225, 1, v7 op_sel:[1,0,0,0]
ds_add_u32 v161, v16
v_cmpx_lt_i32 vcc, 66, v32
v_mad_u32_u16 v162, v226, 1, v7 op_sel:[1,0,0,0]
ds_add_u32 v162, v16
v_cmpx_lt_i32 vcc, 67, v32
v_mad_u32_u16 v163, v227, 1, v7 op_sel:[1,0,0,0]
ds_add_u32 v163, v16
s_waitcnt vmcnt(6)
v_cmpx_lt_i32 vcc, 72, v32
s_cbranch_execz LE_c
v_mad_u32_u16 v164, v228, 1, v7 op_sel:[1,0,0,0]
ds_add_u32 v164, v16
v_cmpx_lt_i32 vcc, 73, v32
v_mad_u32_u16 v165, v229, 1, v7 op_sel:[1,0,0,0]
ds_add_u32 v165, v16
v_cmpx_lt_i32 vcc, 74, v32
v_mad_u32_u16 v166, v230, 1, v7 op_sel:[1,0,0,0]
ds_add_u32 v166, v16
v_cmpx_lt_i32 vcc, 75, v32
v_mad_u32_u16 v167, v231, 1, v7 op_sel:[1,0,0,0]
ds_add_u32 v167, v16
s_waitcnt vmcnt(5)
v_cmpx_lt_i32 vcc, 80, v32
s_cbranch_execz LE_c
v_mad_u32_u16 v168, v232, 1, v7 op_sel:[1,0,0,0]
ds_add_u32 v168, v16
v_cmpx_lt_i32 vcc, 81, v32
v_mad_u32_u16 v169, v233, 1, v7 op_sel:[1,0,0,0]
ds_add_u32 v169, v16
v_cmpx_lt_i32 vcc, 82, v32
v_mad_u32_u16 v170, v234, 1, v7 op_sel:[1,0,0,0]
ds_add_u32 v170, v16
v_cmpx_lt_i32 vcc, 83, v32
v_mad_u32_u16 v171, v235, 1, v7 op_sel:[1,0,0,0]
ds_add_u32 v171, v16
s_waitcnt vmcnt(4)
v_cmpx_lt_i32 vcc, 88, v32
s_cbranch_execz LE_c
v_mad_u32_u16 v172, v236, 1, v7 op_sel:[1,0,0,0]
ds_add_u32 v172, v16
v_cmpx_lt_i32 vcc, 89, v32
v_mad_u32_u16 v173, v237, 1, v7 op_sel:[1,0,0,0]
ds_add_u32 v173, v16
v_cmpx_lt_i32 vcc, 90, v32
v_mad_u32_u16 v174, v238, 1, v7 op_sel:[1,0,0,0]
ds_add_u32 v174, v16
v_cmpx_lt_i32 vcc, 91, v32
v_mad_u32_u16 v175, v239, 1, v7 op_sel:[1,0,0,0]
ds_add_u32 v175, v16
s_waitcnt vmcnt(3)
v_cmpx_lt_i32 vcc, 96, v32
s_cbranch_execz LE_c
v_mad_u32_u16 v176, v240, 1, v7 op_sel:[1,0,0,0]
ds_add_u32 v176, v16
v_cmpx_lt_i32 vcc, 97, v32
v_mad_u32_u16 v177, v241, 1, v7 op_sel:[1,0,0,0]
ds_add_u32 v177, v16
v_cmpx_lt_i32 vcc, 98, v32
v_mad_u32_u16 v178, v242, 1, v7 op_sel:[1,0,0,0]
ds_add_u32 v178, v16
v_cmpx_lt_i32 vcc, 99, v32
v_mad_u32_u16 v179, v243, 1, v7 op_sel:[1,0,0,0]
ds_add_u32 v179, v16
s_waitcnt vmcnt(2)
v_cmpx_lt_i32 vcc, 104, v32
s_cbranch_execz LE_c
v_mad_u32_u16 v180, v244, 1, v7 op_sel:[1,0,0,0]
ds_add_u32 v180, v16
v_cmpx_lt_i32 vcc, 105, v32
v_mad_u32_u16 v181, v245, 1, v7 op_sel:[1,0,0,0]
ds_add_u32 v181, v16
v_cmpx_lt_i32 vcc, 106, v32
v_mad_u32_u16 v182, v246, 1, v7 op_sel:[1,0,0,0]
ds_add_u32 v182, v16
v_cmpx_lt_i32 vcc, 107, v32
v_mad_u32_u16 v183, v247, 1, v7 op_sel:[1,0,0,0]
ds_add_u32 v183, v16
s_waitcnt vmcnt(1)
v_cmpx_lt_i32 vcc, 112, v32
s_cbranch_execz LE_c
v_mad_u32_u16 v184, v248, 1, v7 op_sel:[1,0,0,0]
ds_add_u32 v184, v16
v_cmpx_lt_i32 vcc, 113, v32
v_mad_u32_u16 v185, v249, 1, v7 op_sel:[1,0,0,0]
ds_add_u32 v185, v16
v_cmpx_lt_i32 vcc, 114, v32
v_mad_u32_u16 v186, v250, 1, v7 op_sel:[1,0,0,0]
ds_add_u32 v186, v16
v_cmpx_lt_i32 vcc, 115, v32
v_mad_u32_u16 v187, v251, 1, v7 op_sel:[1,0,0,0]
ds_add_u32 v187, v16
s_waitcnt vmcnt(0)
v_cmpx_lt_i32 vcc, 120, v32
s_cbranch_execz LE_c
v_mad_u32_u16 v188, v252, 1, v7 op_sel:[1,0,0,0]
ds_add_u32 v188, v16
v_cmpx_lt_i32 vcc, 121, v32
v_mad_u32_u16 v189, v253, 1, v7 op_sel:[1,0,0,0]
ds_add_u32 v189, v16
v_cmpx_lt_i32 vcc, 122, v32
v_mad_u32_u16 v190, v254, 1, v7 op_sel:[1,0,0,0]
ds_add_u32 v190, v16
v_cmpx_lt_i32 vcc, 123, v32
v_mad_u32_u16 v191, v255, 1, v7 op_sel:[1,0,0,0]
ds_add_u32 v191, v16
LE_c:
s_mov_b64 exec, -1
ds_read_b128 v[24:27], v35
s_waitcnt lgkmcnt(0)
v_add_u32 v24, 3, v24
v_lshrrev_b32 v24, 2, v24
v_max_u32 v24, v24, v18
v_add_u32 v25, 3, v25
v_lshrrev_b32 v25, 2, v25
v_max_u32 v25, v25, v19
v_add_u32 v26, 3, v26
v_lshrrev_b32 v26, 2, v26
v_max_u32 v26, v26, v20
v_add_u32 v27, 3, v27
v_lshrrev_b32 v27, 2, v27
v_max_u32 v27, v27, v21
v_add_u32 v33, v24, v25
v_add3_u32 v33, v33, v26, v27
v_mov_b32 v64, v33
s_nop 1
v_add_u32_dpp v64, v64, v64 row_shr:1 row_mask:0xf bank_mask:0xf
s_nop 1
v_add_u32_dpp v64, v64, v64 row_shr:2 row_mask:0xf bank_mask:0xf
s_nop 1
v_add_u32_dpp v64, v64, v64 row_shr:4 row_mask:0xf bank_mask:0xf
s_nop 1
v_add_u32_dpp v64, v64, v64 row_shr:8 row_mask:0xf bank_mask:0xf
s_nop 1
v_add_u32_dpp v64, v64, v64 row_bcast:15 row_mask:0xa bank_mask:0xf
s_nop 1
v_add_u32_dpp v64, v64, v64 row_bcast:31 row_mask:0xc bank_mask:0xf
s_nop 1
v_readlane_b32 s44, v64, 63
v_sub_u32 v28, v64, v33
v_add_u32 v29, v28, v24
v_add_u32 v30, v29, v25
v_add_u32 v31, v30, v26
v_add3_u32 v33, v28, v24, -1
v_lshlrev_b32 v34, v33, v18
v_lshrrev_b32 v33, 5, v33
v_lshl_add_u32 v33, v33, 2, v36
ds_or_b32 v33, v34 offset:20480
v_lshl_add_u32 v28, v28, 4, v36
v_add3_u32 v33, v29, v25, -1
v_lshlrev_b32 v34, v33, v19
v_lshrrev_b32 v33, 5, v33
v_lshl_add_u32 v33, v33, 2, v36
ds_or_b32 v33, v34 offset:20480
v_lshl_add_u32 v29, v29, 4, v36
v_add3_u32 v33, v30, v26, -1
v_lshlrev_b32 v34, v33, v20
v_lshrrev_b32 v33, 5, v33
v_lshl_add_u32 v33, v33, 2, v36
ds_or_b32 v33, v34 offset:20480
v_lshl_add_u32 v30, v30, 4, v36
v_add3_u32 v33, v31, v27, -1
v_lshlrev_b32 v34, v33, v21
v_lshrrev_b32 v33, 5, v33
v_lshl_add_u32 v33, v33, 2, v36
ds_or_b32 v33, v34 offset:20480
v_lshl_add_u32 v31, v31, 4, v36
ds_write_b128 v35, v[28:31]
s_add_u32 s44, s44, 31
s_lshr_b32 s44, s44, 5
v_cmpx_lt_i32 vcc, 0, v32
s_cbranch_execz LE_p
ds_add_rtn_u32 v128, v128, v17
v_cmpx_lt_i32 vcc, 1, v32
ds_add_rtn_u32 v129, v129, v17
v_cmpx_lt_i32 vcc, 2, v32
ds_add_rtn_u32 v130, v130, v17
v_cmpx_lt_i32 vcc, 3, v32
ds_add_rtn_u32 v131, v131, v17
v_cmpx_lt_i32 vcc, 8, v32
s_cbranch_execz LE_p
ds_add_rtn_u32 v132, v132, v17
v_cmpx_lt_i32 vcc, 9, v32
ds_add_rtn_u32 v133, v133, v17
v_cmpx_lt_i32 vcc, 10, v32
ds_add_rtn_u32 v134, v134, v17
v_cmpx_lt_i32 vcc, 11, v32
ds_add_rtn_u32 v135, v135, v17
v_cmpx_lt_i32 vcc, 16, v32
s_cbranch_execz LE_p
ds_add_rtn_u32 v136, v136, v17
v_cmpx_lt_i32 vcc, 17, v32
ds_add_rtn_u32 v137, v137, v17
v_cmpx_lt_i32 vcc, 18, v32
ds_add_rtn_u32 v138, v138, v17
v_cmpx_lt_i32 vcc, 19, v32
ds_add_rtn_u32 v139, v139, v17
v_cmpx_lt_i32 vcc, 24, v32
s_cbranch_execz LE_p
ds_add_rtn_u32 v140, v140, v17
v_cmpx_lt_i32 vcc, 25, v32
ds_add_rtn_u32 v141, v141, v17
v_cmpx_lt_i32 vcc, 26, v32
ds_add_rtn_u32 v142, v142, v17
v_cmpx_lt_i32 vcc, 27, v32
ds_add_rtn_u32 v143, v143, v17
v_cmpx_lt_i32 vcc, 32, v32
s_cbranch_execz LE_p
ds_add_rtn_u32 v144, v144, v17
v_cmpx_lt_i32 vcc, 33, v32
ds_add_rtn_u32 v145, v145, v17
v_cmpx_lt_i32 vcc, 34, v32
ds_add_rtn_u32 v146, v146, v17
v_cmpx_lt_i32 vcc, 35, v32
ds_add_rtn_u32 v147, v147, v17
v_cmpx_lt_i32 vcc, 40, v32
s_cbranch_execz LE_p
ds_add_rtn_u32 v148, v148, v17
v_cmpx_lt_i32 vcc, 41, v32
ds_add_rtn_u32 v149, v149, v17
v_cmpx_lt_i32 vcc, 42, v32
ds_add_rtn_u32 v150, v150, v17
v_cmpx_lt_i32 vcc, 43, v32
ds_add_rtn_u32 v151, v151, v17
v_cmpx_lt_i32 vcc, 48, v32
s_cbranch_execz LE_p
ds_add_rtn_u32 v152, v152, v17
v_cmpx_lt_i32 vcc, 49, v32
ds_add_rtn_u32 v153, v153, v17
v_cmpx_lt_i32 vcc, 50, v32
ds_add_rtn_u32 v154, v154, v17
v_cmpx_lt_i32 vcc, 51, v32
ds_add_rtn_u32 v155, v155, v17
v_cmpx_lt_i32 vcc, 56, v32
s_cbranch_execz LE_p
ds_add_rtn_u32 v156, v156, v17
v_cmpx_lt_i32 vcc, 57, v32
ds_add_rtn_u32 v157, v157, v17
v_cmpx_lt_i32 vcc, 58, v32
ds_add_rtn_u32 v158, v158, v17
v_cmpx_lt_i32 vcc, 59, v32
ds_add_rtn_u32 v159, v159, v17
v_cmpx_lt_i32 vcc, 64, v32
s_cbranch_execz LE_p
ds_add_rtn_u32 v160, v160, v17
v_cmpx_lt_i32 vcc, 65, v32
ds_add_rtn_u32 v161, v161, v17
v_cmpx_lt_i32 vcc, 66, v32
ds_add_rtn_u32 v162, v162, v17
v_cmpx_lt_i32 vcc, 67, v32
ds_add_rtn_u32 v163, v163, v17
v_cmpx_lt_i32 vcc, 72, v32
s_cbranch_execz LE_p
ds_add_rtn_u32 v164, v164, v17
v_cmpx_lt_i32 vcc, 73, v32
ds_add_rtn_u32 v165, v165, v17
v_cmpx_lt_i32 vcc, 74, v32
ds_add_rtn_u32 v166, v166, v17
v_cmpx_lt_i32 vcc, 75, v32
ds_add_rtn_u32 v167, v167, v17
v_cmpx_lt_i32 vcc, 80, v32
s_cbranch_execz LE_p
ds_add_rtn_u32 v168, v168, v17
v_cmpx_lt_i32 vcc, 81, v32
ds_add_rtn_u32 v169, v169, v17
v_cmpx_lt_i32 vcc, 82, v32
ds_add_rtn_u32 v170, v170, v17
v_cmpx_lt_i32 vcc, 83, v32
ds_add_rtn_u32 v171, v171, v17
v_cmpx_lt_i32 vcc, 88, v32
s_cbranch_execz LE_p
ds_add_rtn_u32 v172, v172, v17
v_cmpx_lt_i32 vcc, 89, v32
ds_add_rtn_u32 v173, v173, v17
v_cmpx_lt_i32 vcc, 90, v32
ds_add_rtn_u32 v174, v174, v17
v_cmpx_lt_i32 vcc, 91, v32
ds_add_rtn_u32 v175, v175, v17
v_cmpx_lt_i32 vcc, 96, v32
s_cbranch_execz LE_p
ds_add_rtn_u32 v176, v176, v17
v_cmpx_lt_i32 vcc, 97, v32
ds_add_rtn_u32 v177, v177, v17
v_cmpx_lt_i32 vcc, 98, v32
ds_add_rtn_u32 v178, v178, v17
v_cmpx_lt_i32 vcc, 99, v32
ds_add_rtn_u32 v179, v179, v17
v_cmpx_lt_i32 vcc, 104, v32
s_cbranch_execz LE_p
ds_add_rtn_u32 v180, v180, v17
v_cmpx_lt_i32 vcc, 105, v32
ds_add_rtn_u32 v181, v181, v17
v_cmpx_lt_i32 vcc, 106, v32
ds_add_rtn_u32 v182, v182, v17
v_cmpx_lt_i32 vcc, 107, v32
ds_add_rtn_u32 v183, v183, v17
v_cmpx_lt_i32 vcc, 112, v32
s_cbranch_execz LE_p
ds_add_rtn_u32 v184, v184, v17
v_cmpx_lt_i32 vcc, 113, v32
ds_add_rtn_u32 v185, v185, v17
v_cmpx_lt_i32 vcc, 114, v32
ds_add_rtn_u32 v186, v186, v17
v_cmpx_lt_i32 vcc, 115, v32
ds_add_rtn_u32 v187, v187, v17
v_cmpx_lt_i32 vcc, 120, v32
s_cbranch_execz LE_p
ds_add_rtn_u32 v188, v188, v17
v_cmpx_lt_i32 vcc, 121, v32
ds_add_rtn_u32 v189, v189, v17
v_cmpx_lt_i32 vcc, 122, v32
ds_add_rtn_u32 v190, v190, v17
v_cmpx_lt_i32 vcc, 123, v32
ds_add_rtn_u32 v191, v191, v17
LE_p:
s_mov_b64 exec, -1
v_lshl_add_u32 v33, v1, 2, v36
ds_read_b32 v37, v33 offset:20480
s_waitcnt lgkmcnt(0)
v_cmpx_lt_i32 vcc, 0, v32
s_cbranch_execz LE_w
ds_write_b32 v128, v192
v_cmpx_lt_i32 vcc, 1, v32
ds_write_b32 v129, v193
v_cmpx_lt_i32 vcc, 2, v32
ds_write_b32 v130, v194
v_cmpx_lt_i32 vcc, 3, v32
ds_write_b32 v131, v195
v_cmpx_lt_i32 vcc, 8, v32
s_cbranch_execz LE_w
ds_write_b32 v132, v196
v_cmpx_lt_i32 vcc, 9, v32
ds_write_b32 v133, v197
v_cmpx_lt_i32 vcc, 10, v32
ds_write_b32 v134, v198
v_cmpx_lt_i32 vcc, 11, v32
ds_write_b32 v135, v199
v_cmpx_lt_i32 vcc, 16, v32
s_cbranch_execz LE_w
ds_write_b32 v136, v200
v_cmpx_lt_i32 vcc, 17, v32
ds_write_b32 v137, v201
v_cmpx_lt_i32 vcc, 18, v32
ds_write_b32 v138, v202
v_cmpx_lt_i32 vcc, 19, v32
ds_write_b32 v139, v203
v_cmpx_lt_i32 vcc, 24, v32
s_cbranch_execz LE_w
ds_write_b32 v140, v204
v_cmpx_lt_i32 vcc, 25, v32
ds_write_b32 v141, v205
v_cmpx_lt_i32 vcc, 26, v32
ds_write_b32 v142, v206
v_cmpx_lt_i32 vcc, 27, v32
ds_write_b32 v143, v207
v_cmpx_lt_i32 vcc, 32, v32
s_cbranch_execz LE_w
ds_write_b32 v144, v208
v_cmpx_lt_i32 vcc, 33, v32
ds_write_b32 v145, v209
v_cmpx_lt_i32 vcc, 34, v32
ds_write_b32 v146, v210
v_cmpx_lt_i32 vcc, 35, v32
ds_write_b32 v147, v211
v_cmpx_lt_i32 vcc, 40, v32
s_cbranch_execz LE_w
ds_write_b32 v148, v212
v_cmpx_lt_i32 vcc, 41, v32
ds_write_b32 v149, v213
v_cmpx_lt_i32 vcc, 42, v32
ds_write_b32 v150, v214
v_cmpx_lt_i32 vcc, 43, v32
ds_write_b32 v151, v215
v_cmpx_lt_i32 vcc, 48, v32
s_cbranch_execz LE_w
ds_write_b32 v152, v216
v_cmpx_lt_i32 vcc, 49, v32
ds_write_b32 v153, v217
v_cmpx_lt_i32 vcc, 50, v32
ds_write_b32 v154, v218
v_cmpx_lt_i32 vcc, 51, v32
ds_write_b32 v155, v219
v_cmpx_lt_i32 vcc, 56, v32
s_cbranch_execz LE_w
ds_write_b32 v156, v220
v_cmpx_lt_i32 vcc, 57, v32
ds_write_b32 v157, v221
v_cmpx_lt_i32 vcc, 58, v32
ds_write_b32 v158, v222
v_cmpx_lt_i32 vcc, 59, v32
ds_write_b32 v159, v223
v_cmpx_lt_i32 vcc, 64, v32
s_cbranch_execz LE_w
ds_write_b32 v160, v224
v_cmpx_lt_i32 vcc, 65, v32
ds_write_b32 v161, v225
v_cmpx_lt_i32 vcc, 66, v32
ds_write_b32 v162, v226
v_cmpx_lt_i32 vcc, 67, v32
ds_write_b32 v163, v227
v_cmpx_lt_i32 vcc, 72, v32
s_cbranch_execz LE_w
ds_write_b32 v164, v228
v_cmpx_lt_i32 vcc, 73, v32
ds_write_b32 v165, v229
v_cmpx_lt_i32 vcc, 74, v32
ds_write_b32 v166, v230
v_cmpx_lt_i32 vcc, 75, v32
ds_write_b32 v167, v231
v_cmpx_lt_i32 vcc, 80, v32
s_cbranch_execz LE_w
ds_write_b32 v168, v232
v_cmpx_lt_i32 vcc, 81, v32
ds_write_b32 v169, v233
v_cmpx_lt_i32 vcc, 82, v32
ds_write_b32 v170, v234
v_cmpx_lt_i32 vcc, 83, v32
ds_write_b32 v171, v235
v_cmpx_lt_i32 vcc, 88, v32
s_cbranch_execz LE_w
ds_write_b32 v172, v236
v_cmpx_lt_i32 vcc, 89, v32
ds_write_b32 v173, v237
v_cmpx_lt_i32 vcc, 90, v32
ds_write_b32 v174, v238
v_cmpx_lt_i32 vcc, 91, v32
ds_write_b32 v175, v239
v_cmpx_lt_i32 vcc, 96, v32
s_cbranch_execz LE_w
ds_write_b32 v176, v240
v_cmpx_lt_i32 vcc, 97, v32
ds_write_b32 v177, v241
v_cmpx_lt_i32 vcc, 98, v32
ds_write_b32 v178, v242
v_cmpx_lt_i32 vcc, 99, v32
ds_write_b32 v179, v243
v_cmpx_lt_i32 vcc, 104, v32
s_cbranch_execz LE_w
ds_write_b32 v180, v244
v_cmpx_lt_i32 vcc, 105, v32
ds_write_b32 v181, v245
v_cmpx_lt_i32 vcc, 106, v32
ds_write_b32 v182, v246
v_cmpx_lt_i32 vcc, 107, v32
ds_write_b32 v183, v247
v_cmpx_lt_i32 vcc, 112, v32
s_cbranch_execz LE_w
ds_write_b32 v184, v248
v_cmpx_lt_i32 vcc, 113, v32
ds_write_b32 v185, v249
v_cmpx_lt_i32 vcc, 114, v32
ds_write_b32 v186, v250
v_cmpx_lt_i32 vcc, 115, v32
ds_write_b32 v187, v251
v_cmpx_lt_i32 vcc, 120, v32
s_cbranch_execz LE_w
ds_write_b32 v188, v252
v_cmpx_lt_i32 vcc, 121, v32
ds_write_b32 v189, v253
v_cmpx_lt_i32 vcc, 122, v32
ds_write_b32 v190, v254
v_cmpx_lt_i32 vcc, 123, v32
ds_write_b32 v191, v255
LE_w:
s_mov_b64 exec, -1
s_waitcnt vmcnt(0)
s_mov_b32 s51, 0
v_lshlrev_b32 v80, 16, v76
v_lshlrev_b32 v81, 16, v77
v_lshlrev_b32 v82, 16, v78
v_mov_b32 v34, v38
ds_read2_b32 v[52:53], v34 offset0:0 offset1:4
ds_read2_b32 v[54:55], v34 offset0:8 offset1:12
s_waitcnt lgkmcnt(0)
ds_read2_b32 v[56:57], v34 offset0:16 offset1:20
ds_read2_b32 v[58:59], v34 offset0:24 offset1:28
v_mad_u32_u16 v60, v52, s49, v2
v_mad_u32_u16 v61, v53, s49, v2
v_mad_u32_u16 v62, v54, s49, v2
v_mad_u32_u16 v63, v55, s49, v2
buffer_load_dwordx4 a[0:3], v60, s[16:19], 0 offen
buffer_load_dwordx4 a[4:7], v60, s[16:19], 0 offen offset:256
buffer_load_dwordx4 a[8:11], v61, s[16:19], 0 offen
buffer_load_dwordx4 a[12:15], v61, s[16:19], 0 offen offset:256
buffer_load_dwordx4 a[16:19], v62, s[16:19], 0 offen
buffer_load_dwordx4 a[20:23], v62, s[16:19], 0 offen offset:256
buffer_load_dwordx4 a[24:27], v63, s[16:19], 0 offen
buffer_load_dwordx4 a[28:31], v63, s[16:19], 0 offen offset:256
s_waitcnt lgkmcnt(0)
ds_read2_b32 v[52:53], v34 offset0:32 offset1:36
ds_read2_b32 v[54:55], v34 offset0:40 offset1:44
v_mad_u32_u16 v60, v56, s49, v2
v_mad_u32_u16 v61, v57, s49, v2
v_mad_u32_u16 v62, v58, s49, v2
v_mad_u32_u16 v63, v59, s49, v2
buffer_load_dwordx4 a[32:35], v60, s[16:19], 0 offen
buffer_load_dwordx4 a[36:39], v60, s[16:19], 0 offen offset:256
buffer_load_dwordx4 a[40:43], v61, s[16:19], 0 offen
buffer_load_dwordx4 a[44:47], v61, s[16:19], 0 offen offset:256
buffer_load_dwordx4 a[48:51], v62, s[16:19], 0 offen
buffer_load_dwordx4 a[52:55], v62, s[16:19], 0 offen offset:256
buffer_load_dwordx4 a[56:59], v63, s[16:19], 0 offen
buffer_load_dwordx4 a[60:63], v63, s[16:19], 0 offen offset:256
s_waitcnt lgkmcnt(0)
ds_read2_b32 v[56:57], v34 offset0:48 offset1:52
ds_read2_b32 v[58:59], v34 offset0:56 offset1:60
v_mad_u32_u16 v60, v52, s49, v2
v_mad_u32_u16 v61, v53, s49, v2
v_mad_u32_u16 v62, v54, s49, v2
v_mad_u32_u16 v63, v55, s49, v2
buffer_load_dwordx4 a[64:67], v60, s[16:19], 0 offen
buffer_load_dwordx4 a[68:71], v60, s[16:19], 0 offen offset:256
buffer_load_dwordx4 a[72:75], v61, s[16:19], 0 offen
buffer_load_dwordx4 a[76:79], v61, s[16:19], 0 offen offset:256
buffer_load_dwordx4 a[80:83], v62, s[16:19], 0 offen
buffer_load_dwordx4 a[84:87], v62, s[16:19], 0 offen offset:256
buffer_load_dwordx4 a[88:91], v63, s[16:19], 0 offen
buffer_load_dwordx4 a[92:95], v63, s[16:19], 0 offen offset:256
s_waitcnt lgkmcnt(0)
ds_read2_b32 v[52:53], v34 offset0:64 offset1:68
ds_read2_b32 v[54:55], v34 offset0:72 offset1:76
v_mad_u32_u16 v60, v56, s49, v2
v_mad_u32_u16 v61, v57, s49, v2
v_mad_u32_u16 v62, v58, s49, v2
v_mad_u32_u16 v63, v59, s49, v2
buffer_load_dwordx4 a[96:99], v60, s[16:19], 0 offen
buffer_load_dwordx4 a[100:103], v60, s[16:19], 0 offen offset:256
buffer_load_dwordx4 a[104:107], v61, s[16:19], 0 offen
buffer_load_dwordx4 a[108:111], v61, s[16:19], 0 offen offset:256
buffer_load_dwordx4 a[112:115], v62, s[16:19], 0 offen
buffer_load_dwordx4 a[116:119], v62, s[16:19], 0 offen offset:256
buffer_load_dwordx4 a[120:123], v63, s[16:19], 0 offen
buffer_load_dwordx4 a[124:127], v63, s[16:19], 0 offen offset:256
s_waitcnt lgkmcnt(0)
ds_read2_b32 v[56:57], v34 offset0:80 offset1:84
ds_read2_b32 v[58:59], v34 offset0:88 offset1:92
v_mad_u32_u16 v60, v52, s49, v2
v_mad_u32_u16 v61, v53, s49, v2
v_mad_u32_u16 v62, v54, s49, v2
v_mad_u32_u16 v63, v55, s49, v2
buffer_load_dwordx4 a[128:131], v60, s[16:19], 0 offen
buffer_load_dwordx4 a[132:135], v60, s[16:19], 0 offen offset:256
buffer_load_dwordx4 a[136:139], v61, s[16:19], 0 offen
buffer_load_dwordx4 a[140:143], v61, s[16:19], 0 offen offset:256
buffer_load_dwordx4 a[144:147], v62, s[16:19], 0 offen
buffer_load_dwordx4 a[148:151], v62, s[16:19], 0 offen offset:256
buffer_load_dwordx4 a[152:155], v63, s[16:19], 0 offen
buffer_load_dwordx4 a[156:159], v63, s[16:19], 0 offen offset:256
s_waitcnt lgkmcnt(0)
ds_read2_b32 v[52:53], v34 offset0:96 offset1:100
ds_read2_b32 v[54:55], v34 offset0:104 offset1:108
v_mad_u32_u16 v60, v56, s49, v2
v_mad_u32_u16 v61, v57, s49, v2
v_mad_u32_u16 v62, v58, s49, v2
v_mad_u32_u16 v63, v59, s49, v2
buffer_load_dwordx4 a[160:163], v60, s[16:19], 0 offen
buffer_load_dwordx4 a[164:167], v60, s[16:19], 0 offen offset:256
buffer_load_dwordx4 a[168:171], v61, s[16:19], 0 offen
buffer_load_dwordx4 a[172:175], v61, s[16:19], 0 offen offset:256
buffer_load_dwordx4 a[176:179], v62, s[16:19], 0 offen
buffer_load_dwordx4 a[180:183], v62, s[16:19], 0 offen offset:256
buffer_load_dwordx4 a[184:187], v63, s[16:19], 0 offen
buffer_load_dwordx4 a[188:191], v63, s[16:19], 0 offen offset:256
s_waitcnt lgkmcnt(0)
ds_read2_b32 v[56:57], v34 offset0:112 offset1:116
ds_read2_b32 v[58:59], v34 offset0:120 offset1:124
v_mad_u32_u16 v60, v52, s49, v2
v_mad_u32_u16 v61, v53, s49, v2
v_mad_u32_u16 v62, v54, s49, v2
v_mad_u32_u16 v63, v55, s49, v2
buffer_load_dwordx4 a[192:195], v60, s[16:19], 0 offen
buffer_load_dwordx4 a[196:199], v60, s[16:19], 0 offen offset:256
buffer_load_dwordx4 a[200:203], v61, s[16:19], 0 offen
buffer_load_dwordx4 a[204:207], v61, s[16:19], 0 offen offset:256
buffer_load_dwordx4 a[208:211], v62, s[16:19], 0 offen
buffer_load_dwordx4 a[212:215], v62, s[16:19], 0 offen offset:256
buffer_load_dwordx4 a[216:219], v63, s[16:19], 0 offen
buffer_load_dwordx4 a[220:223], v63, s[16:19], 0 offen offset:256
s_waitcnt lgkmcnt(0)
ds_read2_b32 v[52:53], v34 offset0:128 offset1:132
ds_read2_b32 v[54:55], v34 offset0:136 offset1:140
v_mad_u32_u16 v60, v56, s49, v2
v_mad_u32_u16 v61, v57, s49, v2
v_mad_u32_u16 v62, v58, s49, v2
v_mad_u32_u16 v63, v59, s49, v2
buffer_load_dwordx4 a[224:227], v60, s[16:19], 0 offen
buffer_load_dwordx4 a[228:231], v60, s[16:19], 0 offen offset:256
buffer_load_dwordx4 a[232:235], v61, s[16:19], 0 offen
buffer_load_dwordx4 a[236:239], v61, s[16:19], 0 offen offset:256
buffer_load_dwordx4 a[240:243], v62, s[16:19], 0 offen
buffer_load_dwordx4 a[244:247], v62, s[16:19], 0 offen offset:256
buffer_load_dwordx4 a[248:251], v63, s[16:19], 0 offen
buffer_load_dwordx4 a[252:255], v63, s[16:19], 0 offen offset:256
v_add_u32 v34, 512, v34
s_mov_b32 s45, 0
s_mul_i32 s47, s40, 85504
LE_loop:
v_readlane_b32 s46, v37, s45
s_add_u32 s45, s45, 1
s_waitcnt vmcnt(56)
v_mfma_f32_16x16x32_bf16 v[48:51], a[0:3], v[40:43], v[48:51]
v_mfma_f32_16x16x32_bf16 v[48:51], a[4:7], v[44:47], v[48:51]
s_bitcmp1_b32 s46, 0
s_cbranch_scc0 LE_nf0
v_readlane_b32 s57, v80, s51
s_add_u32 s51, s51, 1
s_and_b32 s51, s51, 63
s_cbranch_scc1 LE_dg0
v_mov_b32 v80, v81
v_mov_b32 v81, v82
LE_dg0:
s_nop 3
v_mul_f32 v48, s57, v48
v_mul_f32 v49, s57, v49
v_mul_f32 v50, s57, v50
v_mul_f32 v51, s57, v51
s_cmp_eq_u32 s42, 0
s_cbranch_scc1 LE_fl0
buffer_load_dwordx2 v[66:67], v39, s[20:23], s47 offen sc1
s_waitcnt vmcnt(0)
v_lshlrev_b32 v64, 16, v66
v_and_b32 v65, 0xffff0000, v66
v_add_f32 v48, v48, v64
v_add_f32 v49, v49, v65
v_lshlrev_b32 v64, 16, v67
v_and_b32 v65, 0xffff0000, v67
v_add_f32 v50, v50, v64
v_add_f32 v51, v51, v65
LE_fl0:
v_cvt_pk_bf16_f32 v64, v48, v49
v_cvt_pk_bf16_f32 v65, v50, v51
v_mov_b32 v48, 0
v_mov_b32 v49, 0
v_mov_b32 v50, 0
v_mov_b32 v51, 0
buffer_store_dwordx2 v[64:65], v39, s[20:23], s47 offen sc1
s_add_u32 s47, s47, 512
LE_nf0:
v_mfma_f32_16x16x32_bf16 v[48:51], a[8:11], v[40:43], v[48:51]
v_mfma_f32_16x16x32_bf16 v[48:51], a[12:15], v[44:47], v[48:51]
s_bitcmp1_b32 s46, 1
s_cbranch_scc0 LE_nf1
v_readlane_b32 s57, v80, s51
s_add_u32 s51, s51, 1
s_and_b32 s51, s51, 63
s_cbranch_scc1 LE_dg1
v_mov_b32 v80, v81
v_mov_b32 v81, v82
LE_dg1:
s_nop 3
v_mul_f32 v48, s57, v48
v_mul_f32 v49, s57, v49
v_mul_f32 v50, s57, v50
v_mul_f32 v51, s57, v51
s_cmp_eq_u32 s42, 0
s_cbranch_scc1 LE_fl1
buffer_load_dwordx2 v[66:67], v39, s[20:23], s47 offen sc1
s_waitcnt vmcnt(0)
v_lshlrev_b32 v64, 16, v66
v_and_b32 v65, 0xffff0000, v66
v_add_f32 v48, v48, v64
v_add_f32 v49, v49, v65
v_lshlrev_b32 v64, 16, v67
v_and_b32 v65, 0xffff0000, v67
v_add_f32 v50, v50, v64
v_add_f32 v51, v51, v65
LE_fl1:
v_cvt_pk_bf16_f32 v64, v48, v49
v_cvt_pk_bf16_f32 v65, v50, v51
v_mov_b32 v48, 0
v_mov_b32 v49, 0
v_mov_b32 v50, 0
v_mov_b32 v51, 0
buffer_store_dwordx2 v[64:65], v39, s[20:23], s47 offen sc1
s_add_u32 s47, s47, 512
LE_nf1:
v_mfma_f32_16x16x32_bf16 v[48:51], a[16:19], v[40:43], v[48:51]
v_mfma_f32_16x16x32_bf16 v[48:51], a[20:23], v[44:47], v[48:51]
s_bitcmp1_b32 s46, 2
s_cbranch_scc0 LE_nf2
v_readlane_b32 s57, v80, s51
s_add_u32 s51, s51, 1
s_and_b32 s51, s51, 63
s_cbranch_scc1 LE_dg2
v_mov_b32 v80, v81
v_mov_b32 v81, v82
LE_dg2:
s_nop 3
v_mul_f32 v48, s57, v48
v_mul_f32 v49, s57, v49
v_mul_f32 v50, s57, v50
v_mul_f32 v51, s57, v51
s_cmp_eq_u32 s42, 0
s_cbranch_scc1 LE_fl2
buffer_load_dwordx2 v[66:67], v39, s[20:23], s47 offen sc1
s_waitcnt vmcnt(0)
v_lshlrev_b32 v64, 16, v66
v_and_b32 v65, 0xffff0000, v66
v_add_f32 v48, v48, v64
v_add_f32 v49, v49, v65
v_lshlrev_b32 v64, 16, v67
v_and_b32 v65, 0xffff0000, v67
v_add_f32 v50, v50, v64
v_add_f32 v51, v51, v65
LE_fl2:
v_cvt_pk_bf16_f32 v64, v48, v49
v_cvt_pk_bf16_f32 v65, v50, v51
v_mov_b32 v48, 0
v_mov_b32 v49, 0
v_mov_b32 v50, 0
v_mov_b32 v51, 0
buffer_store_dwordx2 v[64:65], v39, s[20:23], s47 offen sc1
s_add_u32 s47, s47, 512
LE_nf2:
v_mfma_f32_16x16x32_bf16 v[48:51], a[24:27], v[40:43], v[48:51]
v_mfma_f32_16x16x32_bf16 v[48:51], a[28:31], v[44:47], v[48:51]
s_bitcmp1_b32 s46, 3
s_cbranch_scc0 LE_nf3
v_readlane_b32 s57, v80, s51
s_add_u32 s51, s51, 1
s_and_b32 s51, s51, 63
s_cbranch_scc1 LE_dg3
v_mov_b32 v80, v81
v_mov_b32 v81, v82
LE_dg3:
s_nop 3
v_mul_f32 v48, s57, v48
v_mul_f32 v49, s57, v49
v_mul_f32 v50, s57, v50
v_mul_f32 v51, s57, v51
s_cmp_eq_u32 s42, 0
s_cbranch_scc1 LE_fl3
buffer_load_dwordx2 v[66:67], v39, s[20:23], s47 offen sc1
s_waitcnt vmcnt(0)
v_lshlrev_b32 v64, 16, v66
v_and_b32 v65, 0xffff0000, v66
v_add_f32 v48, v48, v64
v_add_f32 v49, v49, v65
v_lshlrev_b32 v64, 16, v67
v_and_b32 v65, 0xffff0000, v67
v_add_f32 v50, v50, v64
v_add_f32 v51, v51, v65
LE_fl3:
v_cvt_pk_bf16_f32 v64, v48, v49
v_cvt_pk_bf16_f32 v65, v50, v51
v_mov_b32 v48, 0
v_mov_b32 v49, 0
v_mov_b32 v50, 0
v_mov_b32 v51, 0
buffer_store_dwordx2 v[64:65], v39, s[20:23], s47 offen sc1
s_add_u32 s47, s47, 512
LE_nf3:
s_waitcnt lgkmcnt(0)
ds_read2_b32 v[56:57], v34 offset0:16 offset1:20
ds_read2_b32 v[58:59], v34 offset0:24 offset1:28
v_mad_u32_u16 v60, v52, s49, v2
v_mad_u32_u16 v61, v53, s49, v2
v_mad_u32_u16 v62, v54, s49, v2
v_mad_u32_u16 v63, v55, s49, v2
buffer_load_dwordx4 a[0:3], v60, s[16:19], 0 offen
buffer_load_dwordx4 a[4:7], v60, s[16:19], 0 offen offset:256
buffer_load_dwordx4 a[8:11], v61, s[16:19], 0 offen
buffer_load_dwordx4 a[12:15], v61, s[16:19], 0 offen offset:256
buffer_load_dwordx4 a[16:19], v62, s[16:19], 0 offen
buffer_load_dwordx4 a[20:23], v62, s[16:19], 0 offen offset:256
buffer_load_dwordx4 a[24:27], v63, s[16:19], 0 offen
buffer_load_dwordx4 a[28:31], v63, s[16:19], 0 offen offset:256
s_waitcnt vmcnt(56)
v_mfma_f32_16x16x32_bf16 v[48:51], a[32:35], v[40:43], v[48:51]
v_mfma_f32_16x16x32_bf16 v[48:51], a[36:39], v[44:47], v[48:51]
s_bitcmp1_b32 s46, 4
s_cbranch_scc0 LE_nf4
v_readlane_b32 s57, v80, s51
s_add_u32 s51, s51, 1
s_and_b32 s51, s51, 63
s_cbranch_scc1 LE_dg4
v_mov_b32 v80, v81
v_mov_b32 v81, v82
LE_dg4:
s_nop 3
v_mul_f32 v48, s57, v48
v_mul_f32 v49, s57, v49
v_mul_f32 v50, s57, v50
v_mul_f32 v51, s57, v51
s_cmp_eq_u32 s42, 0
s_cbranch_scc1 LE_fl4
buffer_load_dwordx2 v[66:67], v39, s[20:23], s47 offen sc1
s_waitcnt vmcnt(0)
v_lshlrev_b32 v64, 16, v66
v_and_b32 v65, 0xffff0000, v66
v_add_f32 v48, v48, v64
v_add_f32 v49, v49, v65
v_lshlrev_b32 v64, 16, v67
v_and_b32 v65, 0xffff0000, v67
v_add_f32 v50, v50, v64
v_add_f32 v51, v51, v65
LE_fl4:
v_cvt_pk_bf16_f32 v64, v48, v49
v_cvt_pk_bf16_f32 v65, v50, v51
v_mov_b32 v48, 0
v_mov_b32 v49, 0
v_mov_b32 v50, 0
v_mov_b32 v51, 0
buffer_store_dwordx2 v[64:65], v39, s[20:23], s47 offen sc1
s_add_u32 s47, s47, 512
LE_nf4:
v_mfma_f32_16x16x32_bf16 v[48:51], a[40:43], v[40:43], v[48:51]
v_mfma_f32_16x16x32_bf16 v[48:51], a[44:47], v[44:47], v[48:51]
s_bitcmp1_b32 s46, 5
s_cbranch_scc0 LE_nf5
v_readlane_b32 s57, v80, s51
s_add_u32 s51, s51, 1
s_and_b32 s51, s51, 63
s_cbranch_scc1 LE_dg5
v_mov_b32 v80, v81
v_mov_b32 v81, v82
LE_dg5:
s_nop 3
v_mul_f32 v48, s57, v48
v_mul_f32 v49, s57, v49
v_mul_f32 v50, s57, v50
v_mul_f32 v51, s57, v51
s_cmp_eq_u32 s42, 0
s_cbranch_scc1 LE_fl5
buffer_load_dwordx2 v[66:67], v39, s[20:23], s47 offen sc1
s_waitcnt vmcnt(0)
v_lshlrev_b32 v64, 16, v66
v_and_b32 v65, 0xffff0000, v66
v_add_f32 v48, v48, v64
v_add_f32 v49, v49, v65
v_lshlrev_b32 v64, 16, v67
v_and_b32 v65, 0xffff0000, v67
v_add_f32 v50, v50, v64
v_add_f32 v51, v51, v65
LE_fl5:
v_cvt_pk_bf16_f32 v64, v48, v49
v_cvt_pk_bf16_f32 v65, v50, v51
v_mov_b32 v48, 0
v_mov_b32 v49, 0
v_mov_b32 v50, 0
v_mov_b32 v51, 0
buffer_store_dwordx2 v[64:65], v39, s[20:23], s47 offen sc1
s_add_u32 s47, s47, 512
LE_nf5:
v_mfma_f32_16x16x32_bf16 v[48:51], a[48:51], v[40:43], v[48:51]
v_mfma_f32_16x16x32_bf16 v[48:51], a[52:55], v[44:47], v[48:51]
s_bitcmp1_b32 s46, 6
s_cbranch_scc0 LE_nf6
v_readlane_b32 s57, v80, s51
s_add_u32 s51, s51, 1
s_and_b32 s51, s51, 63
s_cbranch_scc1 LE_dg6
v_mov_b32 v80, v81
v_mov_b32 v81, v82
LE_dg6:
s_nop 3
v_mul_f32 v48, s57, v48
v_mul_f32 v49, s57, v49
v_mul_f32 v50, s57, v50
v_mul_f32 v51, s57, v51
s_cmp_eq_u32 s42, 0
s_cbranch_scc1 LE_fl6
buffer_load_dwordx2 v[66:67], v39, s[20:23], s47 offen sc1
s_waitcnt vmcnt(0)
v_lshlrev_b32 v64, 16, v66
v_and_b32 v65, 0xffff0000, v66
v_add_f32 v48, v48, v64
v_add_f32 v49, v49, v65
v_lshlrev_b32 v64, 16, v67
v_and_b32 v65, 0xffff0000, v67
v_add_f32 v50, v50, v64
v_add_f32 v51, v51, v65
LE_fl6:
v_cvt_pk_bf16_f32 v64, v48, v49
v_cvt_pk_bf16_f32 v65, v50, v51
v_mov_b32 v48, 0
v_mov_b32 v49, 0
v_mov_b32 v50, 0
v_mov_b32 v51, 0
buffer_store_dwordx2 v[64:65], v39, s[20:23], s47 offen sc1
s_add_u32 s47, s47, 512
LE_nf6:
v_mfma_f32_16x16x32_bf16 v[48:51], a[56:59], v[40:43], v[48:51]
v_mfma_f32_16x16x32_bf16 v[48:51], a[60:63], v[44:47], v[48:51]
s_bitcmp1_b32 s46, 7
s_cbranch_scc0 LE_nf7
v_readlane_b32 s57, v80, s51
s_add_u32 s51, s51, 1
s_and_b32 s51, s51, 63
s_cbranch_scc1 LE_dg7
v_mov_b32 v80, v81
v_mov_b32 v81, v82
LE_dg7:
s_nop 3
v_mul_f32 v48, s57, v48
v_mul_f32 v49, s57, v49
v_mul_f32 v50, s57, v50
v_mul_f32 v51, s57, v51
s_cmp_eq_u32 s42, 0
s_cbranch_scc1 LE_fl7
buffer_load_dwordx2 v[66:67], v39, s[20:23], s47 offen sc1
s_waitcnt vmcnt(0)
v_lshlrev_b32 v64, 16, v66
v_and_b32 v65, 0xffff0000, v66
v_add_f32 v48, v48, v64
v_add_f32 v49, v49, v65
v_lshlrev_b32 v64, 16, v67
v_and_b32 v65, 0xffff0000, v67
v_add_f32 v50, v50, v64
v_add_f32 v51, v51, v65
LE_fl7:
v_cvt_pk_bf16_f32 v64, v48, v49
v_cvt_pk_bf16_f32 v65, v50, v51
v_mov_b32 v48, 0
v_mov_b32 v49, 0
v_mov_b32 v50, 0
v_mov_b32 v51, 0
buffer_store_dwordx2 v[64:65], v39, s[20:23], s47 offen sc1
s_add_u32 s47, s47, 512
LE_nf7:
s_waitcnt lgkmcnt(0)
ds_read2_b32 v[52:53], v34 offset0:32 offset1:36
ds_read2_b32 v[54:55], v34 offset0:40 offset1:44
v_mad_u32_u16 v60, v56, s49, v2
v_mad_u32_u16 v61, v57, s49, v2
v_mad_u32_u16 v62, v58, s49, v2
v_mad_u32_u16 v63, v59, s49, v2
buffer_load_dwordx4 a[32:35], v60, s[16:19], 0 offen
buffer_load_dwordx4 a[36:39], v60, s[16:19], 0 offen offset:256
buffer_load_dwordx4 a[40:43], v61, s[16:19], 0 offen
buffer_load_dwordx4 a[44:47], v61, s[16:19], 0 offen offset:256
buffer_load_dwordx4 a[48:51], v62, s[16:19], 0 offen
buffer_load_dwordx4 a[52:55], v62, s[16:19], 0 offen offset:256
buffer_load_dwordx4 a[56:59], v63, s[16:19], 0 offen
buffer_load_dwordx4 a[60:63], v63, s[16:19], 0 offen offset:256
s_waitcnt vmcnt(56)
v_mfma_f32_16x16x32_bf16 v[48:51], a[64:67], v[40:43], v[48:51]
v_mfma_f32_16x16x32_bf16 v[48:51], a[68:71], v[44:47], v[48:51]
s_bitcmp1_b32 s46, 8
s_cbranch_scc0 LE_nf8
v_readlane_b32 s57, v80, s51
s_add_u32 s51, s51, 1
s_and_b32 s51, s51, 63
s_cbranch_scc1 LE_dg8
v_mov_b32 v80, v81
v_mov_b32 v81, v82
LE_dg8:
s_nop 3
v_mul_f32 v48, s57, v48
v_mul_f32 v49, s57, v49
v_mul_f32 v50, s57, v50
v_mul_f32 v51, s57, v51
s_cmp_eq_u32 s42, 0
s_cbranch_scc1 LE_fl8
buffer_load_dwordx2 v[66:67], v39, s[20:23], s47 offen sc1
s_waitcnt vmcnt(0)
v_lshlrev_b32 v64, 16, v66
v_and_b32 v65, 0xffff0000, v66
v_add_f32 v48, v48, v64
v_add_f32 v49, v49, v65
v_lshlrev_b32 v64, 16, v67
v_and_b32 v65, 0xffff0000, v67
v_add_f32 v50, v50, v64
v_add_f32 v51, v51, v65
LE_fl8:
v_cvt_pk_bf16_f32 v64, v48, v49
v_cvt_pk_bf16_f32 v65, v50, v51
v_mov_b32 v48, 0
v_mov_b32 v49, 0
v_mov_b32 v50, 0
v_mov_b32 v51, 0
buffer_store_dwordx2 v[64:65], v39, s[20:23], s47 offen sc1
s_add_u32 s47, s47, 512
LE_nf8:
v_mfma_f32_16x16x32_bf16 v[48:51], a[72:75], v[40:43], v[48:51]
v_mfma_f32_16x16x32_bf16 v[48:51], a[76:79], v[44:47], v[48:51]
s_bitcmp1_b32 s46, 9
s_cbranch_scc0 LE_nf9
v_readlane_b32 s57, v80, s51
s_add_u32 s51, s51, 1
s_and_b32 s51, s51, 63
s_cbranch_scc1 LE_dg9
v_mov_b32 v80, v81
v_mov_b32 v81, v82
LE_dg9:
s_nop 3
v_mul_f32 v48, s57, v48
v_mul_f32 v49, s57, v49
v_mul_f32 v50, s57, v50
v_mul_f32 v51, s57, v51
s_cmp_eq_u32 s42, 0
s_cbranch_scc1 LE_fl9
buffer_load_dwordx2 v[66:67], v39, s[20:23], s47 offen sc1
s_waitcnt vmcnt(0)
v_lshlrev_b32 v64, 16, v66
v_and_b32 v65, 0xffff0000, v66
v_add_f32 v48, v48, v64
v_add_f32 v49, v49, v65
v_lshlrev_b32 v64, 16, v67
v_and_b32 v65, 0xffff0000, v67
v_add_f32 v50, v50, v64
v_add_f32 v51, v51, v65
LE_fl9:
v_cvt_pk_bf16_f32 v64, v48, v49
v_cvt_pk_bf16_f32 v65, v50, v51
v_mov_b32 v48, 0
v_mov_b32 v49, 0
v_mov_b32 v50, 0
v_mov_b32 v51, 0
buffer_store_dwordx2 v[64:65], v39, s[20:23], s47 offen sc1
s_add_u32 s47, s47, 512
LE_nf9:
v_mfma_f32_16x16x32_bf16 v[48:51], a[80:83], v[40:43], v[48:51]
v_mfma_f32_16x16x32_bf16 v[48:51], a[84:87], v[44:47], v[48:51]
s_bitcmp1_b32 s46, 10
s_cbranch_scc0 LE_nf10
v_readlane_b32 s57, v80, s51
s_add_u32 s51, s51, 1
s_and_b32 s51, s51, 63
s_cbranch_scc1 LE_dg10
v_mov_b32 v80, v81
v_mov_b32 v81, v82
LE_dg10:
s_nop 3
v_mul_f32 v48, s57, v48
v_mul_f32 v49, s57, v49
v_mul_f32 v50, s57, v50
v_mul_f32 v51, s57, v51
s_cmp_eq_u32 s42, 0
s_cbranch_scc1 LE_fl10
buffer_load_dwordx2 v[66:67], v39, s[20:23], s47 offen sc1
s_waitcnt vmcnt(0)
v_lshlrev_b32 v64, 16, v66
v_and_b32 v65, 0xffff0000, v66
v_add_f32 v48, v48, v64
v_add_f32 v49, v49, v65
v_lshlrev_b32 v64, 16, v67
v_and_b32 v65, 0xffff0000, v67
v_add_f32 v50, v50, v64
v_add_f32 v51, v51, v65
LE_fl10:
v_cvt_pk_bf16_f32 v64, v48, v49
v_cvt_pk_bf16_f32 v65, v50, v51
v_mov_b32 v48, 0
v_mov_b32 v49, 0
v_mov_b32 v50, 0
v_mov_b32 v51, 0
buffer_store_dwordx2 v[64:65], v39, s[20:23], s47 offen sc1
s_add_u32 s47, s47, 512
LE_nf10:
v_mfma_f32_16x16x32_bf16 v[48:51], a[88:91], v[40:43], v[48:51]
v_mfma_f32_16x16x32_bf16 v[48:51], a[92:95], v[44:47], v[48:51]
s_bitcmp1_b32 s46, 11
s_cbranch_scc0 LE_nf11
v_readlane_b32 s57, v80, s51
s_add_u32 s51, s51, 1
s_and_b32 s51, s51, 63
s_cbranch_scc1 LE_dg11
v_mov_b32 v80, v81
v_mov_b32 v81, v82
LE_dg11:
s_nop 3
v_mul_f32 v48, s57, v48
v_mul_f32 v49, s57, v49
v_mul_f32 v50, s57, v50
v_mul_f32 v51, s57, v51
s_cmp_eq_u32 s42, 0
s_cbranch_scc1 LE_fl11
buffer_load_dwordx2 v[66:67], v39, s[20:23], s47 offen sc1
s_waitcnt vmcnt(0)
v_lshlrev_b32 v64, 16, v66
v_and_b32 v65, 0xffff0000, v66
v_add_f32 v48, v48, v64
v_add_f32 v49, v49, v65
v_lshlrev_b32 v64, 16, v67
v_and_b32 v65, 0xffff0000, v67
v_add_f32 v50, v50, v64
v_add_f32 v51, v51, v65
LE_fl11:
v_cvt_pk_bf16_f32 v64, v48, v49
v_cvt_pk_bf16_f32 v65, v50, v51
v_mov_b32 v48, 0
v_mov_b32 v49, 0
v_mov_b32 v50, 0
v_mov_b32 v51, 0
buffer_store_dwordx2 v[64:65], v39, s[20:23], s47 offen sc1
s_add_u32 s47, s47, 512
LE_nf11:
s_waitcnt lgkmcnt(0)
ds_read2_b32 v[56:57], v34 offset0:48 offset1:52
ds_read2_b32 v[58:59], v34 offset0:56 offset1:60
v_mad_u32_u16 v60, v52, s49, v2
v_mad_u32_u16 v61, v53, s49, v2
v_mad_u32_u16 v62, v54, s49, v2
v_mad_u32_u16 v63, v55, s49, v2
buffer_load_dwordx4 a[64:67], v60, s[16:19], 0 offen
buffer_load_dwordx4 a[68:71], v60, s[16:19], 0 offen offset:256
buffer_load_dwordx4 a[72:75], v61, s[16:19], 0 offen
buffer_load_dwordx4 a[76:79], v61, s[16:19], 0 offen offset:256
buffer_load_dwordx4 a[80:83], v62, s[16:19], 0 offen
buffer_load_dwordx4 a[84:87], v62, s[16:19], 0 offen offset:256
buffer_load_dwordx4 a[88:91], v63, s[16:19], 0 offen
buffer_load_dwordx4 a[92:95], v63, s[16:19], 0 offen offset:256
s_waitcnt vmcnt(56)
v_mfma_f32_16x16x32_bf16 v[48:51], a[96:99], v[40:43], v[48:51]
v_mfma_f32_16x16x32_bf16 v[48:51], a[100:103], v[44:47], v[48:51]
s_bitcmp1_b32 s46, 12
s_cbranch_scc0 LE_nf12
v_readlane_b32 s57, v80, s51
s_add_u32 s51, s51, 1
s_and_b32 s51, s51, 63
s_cbranch_scc1 LE_dg12
v_mov_b32 v80, v81
v_mov_b32 v81, v82
LE_dg12:
s_nop 3
v_mul_f32 v48, s57, v48
v_mul_f32 v49, s57, v49
v_mul_f32 v50, s57, v50
v_mul_f32 v51, s57, v51
s_cmp_eq_u32 s42, 0
s_cbranch_scc1 LE_fl12
buffer_load_dwordx2 v[66:67], v39, s[20:23], s47 offen sc1
s_waitcnt vmcnt(0)
v_lshlrev_b32 v64, 16, v66
v_and_b32 v65, 0xffff0000, v66
v_add_f32 v48, v48, v64
v_add_f32 v49, v49, v65
v_lshlrev_b32 v64, 16, v67
v_and_b32 v65, 0xffff0000, v67
v_add_f32 v50, v50, v64
v_add_f32 v51, v51, v65
LE_fl12:
v_cvt_pk_bf16_f32 v64, v48, v49
v_cvt_pk_bf16_f32 v65, v50, v51
v_mov_b32 v48, 0
v_mov_b32 v49, 0
v_mov_b32 v50, 0
v_mov_b32 v51, 0
buffer_store_dwordx2 v[64:65], v39, s[20:23], s47 offen sc1
s_add_u32 s47, s47, 512
LE_nf12:
v_mfma_f32_16x16x32_bf16 v[48:51], a[104:107], v[40:43], v[48:51]
v_mfma_f32_16x16x32_bf16 v[48:51], a[108:111], v[44:47], v[48:51]
s_bitcmp1_b32 s46, 13
s_cbranch_scc0 LE_nf13
v_readlane_b32 s57, v80, s51
s_add_u32 s51, s51, 1
s_and_b32 s51, s51, 63
s_cbranch_scc1 LE_dg13
v_mov_b32 v80, v81
v_mov_b32 v81, v82
LE_dg13:
s_nop 3
v_mul_f32 v48, s57, v48
v_mul_f32 v49, s57, v49
v_mul_f32 v50, s57, v50
v_mul_f32 v51, s57, v51
s_cmp_eq_u32 s42, 0
s_cbranch_scc1 LE_fl13
buffer_load_dwordx2 v[66:67], v39, s[20:23], s47 offen sc1
s_waitcnt vmcnt(0)
v_lshlrev_b32 v64, 16, v66
v_and_b32 v65, 0xffff0000, v66
v_add_f32 v48, v48, v64
v_add_f32 v49, v49, v65
v_lshlrev_b32 v64, 16, v67
v_and_b32 v65, 0xffff0000, v67
v_add_f32 v50, v50, v64
v_add_f32 v51, v51, v65
LE_fl13:
v_cvt_pk_bf16_f32 v64, v48, v49
v_cvt_pk_bf16_f32 v65, v50, v51
v_mov_b32 v48, 0
v_mov_b32 v49, 0
v_mov_b32 v50, 0
v_mov_b32 v51, 0
buffer_store_dwordx2 v[64:65], v39, s[20:23], s47 offen sc1
s_add_u32 s47, s47, 512
LE_nf13:
v_mfma_f32_16x16x32_bf16 v[48:51], a[112:115], v[40:43], v[48:51]
v_mfma_f32_16x16x32_bf16 v[48:51], a[116:119], v[44:47], v[48:51]
s_bitcmp1_b32 s46, 14
s_cbranch_scc0 LE_nf14
v_readlane_b32 s57, v80, s51
s_add_u32 s51, s51, 1
s_and_b32 s51, s51, 63
s_cbranch_scc1 LE_dg14
v_mov_b32 v80, v81
v_mov_b32 v81, v82
LE_dg14:
s_nop 3
v_mul_f32 v48, s57, v48
v_mul_f32 v49, s57, v49
v_mul_f32 v50, s57, v50
v_mul_f32 v51, s57, v51
s_cmp_eq_u32 s42, 0
s_cbranch_scc1 LE_fl14
buffer_load_dwordx2 v[66:67], v39, s[20:23], s47 offen sc1
s_waitcnt vmcnt(0)
v_lshlrev_b32 v64, 16, v66
v_and_b32 v65, 0xffff0000, v66
v_add_f32 v48, v48, v64
v_add_f32 v49, v49, v65
v_lshlrev_b32 v64, 16, v67
v_and_b32 v65, 0xffff0000, v67
v_add_f32 v50, v50, v64
v_add_f32 v51, v51, v65
LE_fl14:
v_cvt_pk_bf16_f32 v64, v48, v49
v_cvt_pk_bf16_f32 v65, v50, v51
v_mov_b32 v48, 0
v_mov_b32 v49, 0
v_mov_b32 v50, 0
v_mov_b32 v51, 0
buffer_store_dwordx2 v[64:65], v39, s[20:23], s47 offen sc1
s_add_u32 s47, s47, 512
LE_nf14:
v_mfma_f32_16x16x32_bf16 v[48:51], a[120:123], v[40:43], v[48:51]
v_mfma_f32_16x16x32_bf16 v[48:51], a[124:127], v[44:47], v[48:51]
s_bitcmp1_b32 s46, 15
s_cbranch_scc0 LE_nf15
v_readlane_b32 s57, v80, s51
s_add_u32 s51, s51, 1
s_and_b32 s51, s51, 63
s_cbranch_scc1 LE_dg15
v_mov_b32 v80, v81
v_mov_b32 v81, v82
LE_dg15:
s_nop 3
v_mul_f32 v48, s57, v48
v_mul_f32 v49, s57, v49
v_mul_f32 v50, s57, v50
v_mul_f32 v51, s57, v51
s_cmp_eq_u32 s42, 0
s_cbranch_scc1 LE_fl15
buffer_load_dwordx2 v[66:67], v39, s[20:23], s47 offen sc1
s_waitcnt vmcnt(0)
v_lshlrev_b32 v64, 16, v66
v_and_b32 v65, 0xffff0000, v66
v_add_f32 v48, v48, v64
v_add_f32 v49, v49, v65
v_lshlrev_b32 v64, 16, v67
v_and_b32 v65, 0xffff0000, v67
v_add_f32 v50, v50, v64
v_add_f32 v51, v51, v65
LE_fl15:
v_cvt_pk_bf16_f32 v64, v48, v49
v_cvt_pk_bf16_f32 v65, v50, v51
v_mov_b32 v48, 0
v_mov_b32 v49, 0
v_mov_b32 v50, 0
v_mov_b32 v51, 0
buffer_store_dwordx2 v[64:65], v39, s[20:23], s47 offen sc1
s_add_u32 s47, s47, 512
LE_nf15:
s_waitcnt lgkmcnt(0)
ds_read2_b32 v[52:53], v34 offset0:64 offset1:68
ds_read2_b32 v[54:55], v34 offset0:72 offset1:76
v_mad_u32_u16 v60, v56, s49, v2
v_mad_u32_u16 v61, v57, s49, v2
v_mad_u32_u16 v62, v58, s49, v2
v_mad_u32_u16 v63, v59, s49, v2
buffer_load_dwordx4 a[96:99], v60, s[16:19], 0 offen
buffer_load_dwordx4 a[100:103], v60, s[16:19], 0 offen offset:256
buffer_load_dwordx4 a[104:107], v61, s[16:19], 0 offen
buffer_load_dwordx4 a[108:111], v61, s[16:19], 0 offen offset:256
buffer_load_dwordx4 a[112:115], v62, s[16:19], 0 offen
buffer_load_dwordx4 a[116:119], v62, s[16:19], 0 offen offset:256
buffer_load_dwordx4 a[120:123], v63, s[16:19], 0 offen
buffer_load_dwordx4 a[124:127], v63, s[16:19], 0 offen offset:256
s_waitcnt vmcnt(56)
v_mfma_f32_16x16x32_bf16 v[48:51], a[128:131], v[40:43], v[48:51]
v_mfma_f32_16x16x32_bf16 v[48:51], a[132:135], v[44:47], v[48:51]
s_bitcmp1_b32 s46, 16
s_cbranch_scc0 LE_nf16
v_readlane_b32 s57, v80, s51
s_add_u32 s51, s51, 1
s_and_b32 s51, s51, 63
s_cbranch_scc1 LE_dg16
v_mov_b32 v80, v81
v_mov_b32 v81, v82
LE_dg16:
s_nop 3
v_mul_f32 v48, s57, v48
v_mul_f32 v49, s57, v49
v_mul_f32 v50, s57, v50
v_mul_f32 v51, s57, v51
s_cmp_eq_u32 s42, 0
s_cbranch_scc1 LE_fl16
buffer_load_dwordx2 v[66:67], v39, s[20:23], s47 offen sc1
s_waitcnt vmcnt(0)
v_lshlrev_b32 v64, 16, v66
v_and_b32 v65, 0xffff0000, v66
v_add_f32 v48, v48, v64
v_add_f32 v49, v49, v65
v_lshlrev_b32 v64, 16, v67
v_and_b32 v65, 0xffff0000, v67
v_add_f32 v50, v50, v64
v_add_f32 v51, v51, v65
LE_fl16:
v_cvt_pk_bf16_f32 v64, v48, v49
v_cvt_pk_bf16_f32 v65, v50, v51
v_mov_b32 v48, 0
v_mov_b32 v49, 0
v_mov_b32 v50, 0
v_mov_b32 v51, 0
buffer_store_dwordx2 v[64:65], v39, s[20:23], s47 offen sc1
s_add_u32 s47, s47, 512
LE_nf16:
v_mfma_f32_16x16x32_bf16 v[48:51], a[136:139], v[40:43], v[48:51]
v_mfma_f32_16x16x32_bf16 v[48:51], a[140:143], v[44:47], v[48:51]
s_bitcmp1_b32 s46, 17
s_cbranch_scc0 LE_nf17
v_readlane_b32 s57, v80, s51
s_add_u32 s51, s51, 1
s_and_b32 s51, s51, 63
s_cbranch_scc1 LE_dg17
v_mov_b32 v80, v81
v_mov_b32 v81, v82
LE_dg17:
s_nop 3
v_mul_f32 v48, s57, v48
v_mul_f32 v49, s57, v49
v_mul_f32 v50, s57, v50
v_mul_f32 v51, s57, v51
s_cmp_eq_u32 s42, 0
s_cbranch_scc1 LE_fl17
buffer_load_dwordx2 v[66:67], v39, s[20:23], s47 offen sc1
s_waitcnt vmcnt(0)
v_lshlrev_b32 v64, 16, v66
v_and_b32 v65, 0xffff0000, v66
v_add_f32 v48, v48, v64
v_add_f32 v49, v49, v65
v_lshlrev_b32 v64, 16, v67
v_and_b32 v65, 0xffff0000, v67
v_add_f32 v50, v50, v64
v_add_f32 v51, v51, v65
LE_fl17:
v_cvt_pk_bf16_f32 v64, v48, v49
v_cvt_pk_bf16_f32 v65, v50, v51
v_mov_b32 v48, 0
v_mov_b32 v49, 0
v_mov_b32 v50, 0
v_mov_b32 v51, 0
buffer_store_dwordx2 v[64:65], v39, s[20:23], s47 offen sc1
s_add_u32 s47, s47, 512
LE_nf17:
v_mfma_f32_16x16x32_bf16 v[48:51], a[144:147], v[40:43], v[48:51]
v_mfma_f32_16x16x32_bf16 v[48:51], a[148:151], v[44:47], v[48:51]
s_bitcmp1_b32 s46, 18
s_cbranch_scc0 LE_nf18
v_readlane_b32 s57, v80, s51
s_add_u32 s51, s51, 1
s_and_b32 s51, s51, 63
s_cbranch_scc1 LE_dg18
v_mov_b32 v80, v81
v_mov_b32 v81, v82
LE_dg18:
s_nop 3
v_mul_f32 v48, s57, v48
v_mul_f32 v49, s57, v49
v_mul_f32 v50, s57, v50
v_mul_f32 v51, s57, v51
s_cmp_eq_u32 s42, 0
s_cbranch_scc1 LE_fl18
buffer_load_dwordx2 v[66:67], v39, s[20:23], s47 offen sc1
s_waitcnt vmcnt(0)
v_lshlrev_b32 v64, 16, v66
v_and_b32 v65, 0xffff0000, v66
v_add_f32 v48, v48, v64
v_add_f32 v49, v49, v65
v_lshlrev_b32 v64, 16, v67
v_and_b32 v65, 0xffff0000, v67
v_add_f32 v50, v50, v64
v_add_f32 v51, v51, v65
LE_fl18:
v_cvt_pk_bf16_f32 v64, v48, v49
v_cvt_pk_bf16_f32 v65, v50, v51
v_mov_b32 v48, 0
v_mov_b32 v49, 0
v_mov_b32 v50, 0
v_mov_b32 v51, 0
buffer_store_dwordx2 v[64:65], v39, s[20:23], s47 offen sc1
s_add_u32 s47, s47, 512
LE_nf18:
v_mfma_f32_16x16x32_bf16 v[48:51], a[152:155], v[40:43], v[48:51]
v_mfma_f32_16x16x32_bf16 v[48:51], a[156:159], v[44:47], v[48:51]
s_bitcmp1_b32 s46, 19
s_cbranch_scc0 LE_nf19
v_readlane_b32 s57, v80, s51
s_add_u32 s51, s51, 1
s_and_b32 s51, s51, 63
s_cbranch_scc1 LE_dg19
v_mov_b32 v80, v81
v_mov_b32 v81, v82
LE_dg19:
s_nop 3
v_mul_f32 v48, s57, v48
v_mul_f32 v49, s57, v49
v_mul_f32 v50, s57, v50
v_mul_f32 v51, s57, v51
s_cmp_eq_u32 s42, 0
s_cbranch_scc1 LE_fl19
buffer_load_dwordx2 v[66:67], v39, s[20:23], s47 offen sc1
s_waitcnt vmcnt(0)
v_lshlrev_b32 v64, 16, v66
v_and_b32 v65, 0xffff0000, v66
v_add_f32 v48, v48, v64
v_add_f32 v49, v49, v65
v_lshlrev_b32 v64, 16, v67
v_and_b32 v65, 0xffff0000, v67
v_add_f32 v50, v50, v64
v_add_f32 v51, v51, v65
LE_fl19:
v_cvt_pk_bf16_f32 v64, v48, v49
v_cvt_pk_bf16_f32 v65, v50, v51
v_mov_b32 v48, 0
v_mov_b32 v49, 0
v_mov_b32 v50, 0
v_mov_b32 v51, 0
buffer_store_dwordx2 v[64:65], v39, s[20:23], s47 offen sc1
s_add_u32 s47, s47, 512
LE_nf19:
s_waitcnt lgkmcnt(0)
ds_read2_b32 v[56:57], v34 offset0:80 offset1:84
ds_read2_b32 v[58:59], v34 offset0:88 offset1:92
v_mad_u32_u16 v60, v52, s49, v2
v_mad_u32_u16 v61, v53, s49, v2
v_mad_u32_u16 v62, v54, s49, v2
v_mad_u32_u16 v63, v55, s49, v2
buffer_load_dwordx4 a[128:131], v60, s[16:19], 0 offen
buffer_load_dwordx4 a[132:135], v60, s[16:19], 0 offen offset:256
buffer_load_dwordx4 a[136:139], v61, s[16:19], 0 offen
buffer_load_dwordx4 a[140:143], v61, s[16:19], 0 offen offset:256
buffer_load_dwordx4 a[144:147], v62, s[16:19], 0 offen
buffer_load_dwordx4 a[148:151], v62, s[16:19], 0 offen offset:256
buffer_load_dwordx4 a[152:155], v63, s[16:19], 0 offen
buffer_load_dwordx4 a[156:159], v63, s[16:19], 0 offen offset:256
s_waitcnt vmcnt(56)
v_mfma_f32_16x16x32_bf16 v[48:51], a[160:163], v[40:43], v[48:51]
v_mfma_f32_16x16x32_bf16 v[48:51], a[164:167], v[44:47], v[48:51]
s_bitcmp1_b32 s46, 20
s_cbranch_scc0 LE_nf20
v_readlane_b32 s57, v80, s51
s_add_u32 s51, s51, 1
s_and_b32 s51, s51, 63
s_cbranch_scc1 LE_dg20
v_mov_b32 v80, v81
v_mov_b32 v81, v82
LE_dg20:
s_nop 3
v_mul_f32 v48, s57, v48
v_mul_f32 v49, s57, v49
v_mul_f32 v50, s57, v50
v_mul_f32 v51, s57, v51
s_cmp_eq_u32 s42, 0
s_cbranch_scc1 LE_fl20
buffer_load_dwordx2 v[66:67], v39, s[20:23], s47 offen sc1
s_waitcnt vmcnt(0)
v_lshlrev_b32 v64, 16, v66
v_and_b32 v65, 0xffff0000, v66
v_add_f32 v48, v48, v64
v_add_f32 v49, v49, v65
v_lshlrev_b32 v64, 16, v67
v_and_b32 v65, 0xffff0000, v67
v_add_f32 v50, v50, v64
v_add_f32 v51, v51, v65
LE_fl20:
v_cvt_pk_bf16_f32 v64, v48, v49
v_cvt_pk_bf16_f32 v65, v50, v51
v_mov_b32 v48, 0
v_mov_b32 v49, 0
v_mov_b32 v50, 0
v_mov_b32 v51, 0
buffer_store_dwordx2 v[64:65], v39, s[20:23], s47 offen sc1
s_add_u32 s47, s47, 512
LE_nf20:
v_mfma_f32_16x16x32_bf16 v[48:51], a[168:171], v[40:43], v[48:51]
v_mfma_f32_16x16x32_bf16 v[48:51], a[172:175], v[44:47], v[48:51]
s_bitcmp1_b32 s46, 21
s_cbranch_scc0 LE_nf21
v_readlane_b32 s57, v80, s51
s_add_u32 s51, s51, 1
s_and_b32 s51, s51, 63
s_cbranch_scc1 LE_dg21
v_mov_b32 v80, v81
v_mov_b32 v81, v82
LE_dg21:
s_nop 3
v_mul_f32 v48, s57, v48
v_mul_f32 v49, s57, v49
v_mul_f32 v50, s57, v50
v_mul_f32 v51, s57, v51
s_cmp_eq_u32 s42, 0
s_cbranch_scc1 LE_fl21
buffer_load_dwordx2 v[66:67], v39, s[20:23], s47 offen sc1
s_waitcnt vmcnt(0)
v_lshlrev_b32 v64, 16, v66
v_and_b32 v65, 0xffff0000, v66
v_add_f32 v48, v48, v64
v_add_f32 v49, v49, v65
v_lshlrev_b32 v64, 16, v67
v_and_b32 v65, 0xffff0000, v67
v_add_f32 v50, v50, v64
v_add_f32 v51, v51, v65
LE_fl21:
v_cvt_pk_bf16_f32 v64, v48, v49
v_cvt_pk_bf16_f32 v65, v50, v51
v_mov_b32 v48, 0
v_mov_b32 v49, 0
v_mov_b32 v50, 0
v_mov_b32 v51, 0
buffer_store_dwordx2 v[64:65], v39, s[20:23], s47 offen sc1
s_add_u32 s47, s47, 512
LE_nf21:
v_mfma_f32_16x16x32_bf16 v[48:51], a[176:179], v[40:43], v[48:51]
v_mfma_f32_16x16x32_bf16 v[48:51], a[180:183], v[44:47], v[48:51]
s_bitcmp1_b32 s46, 22
s_cbranch_scc0 LE_nf22
v_readlane_b32 s57, v80, s51
s_add_u32 s51, s51, 1
s_and_b32 s51, s51, 63
s_cbranch_scc1 LE_dg22
v_mov_b32 v80, v81
v_mov_b32 v81, v82
LE_dg22:
s_nop 3
v_mul_f32 v48, s57, v48
v_mul_f32 v49, s57, v49
v_mul_f32 v50, s57, v50
v_mul_f32 v51, s57, v51
s_cmp_eq_u32 s42, 0
s_cbranch_scc1 LE_fl22
buffer_load_dwordx2 v[66:67], v39, s[20:23], s47 offen sc1
s_waitcnt vmcnt(0)
v_lshlrev_b32 v64, 16, v66
v_and_b32 v65, 0xffff0000, v66
v_add_f32 v48, v48, v64
v_add_f32 v49, v49, v65
v_lshlrev_b32 v64, 16, v67
v_and_b32 v65, 0xffff0000, v67
v_add_f32 v50, v50, v64
v_add_f32 v51, v51, v65
LE_fl22:
v_cvt_pk_bf16_f32 v64, v48, v49
v_cvt_pk_bf16_f32 v65, v50, v51
v_mov_b32 v48, 0
v_mov_b32 v49, 0
v_mov_b32 v50, 0
v_mov_b32 v51, 0
buffer_store_dwordx2 v[64:65], v39, s[20:23], s47 offen sc1
s_add_u32 s47, s47, 512
LE_nf22:
v_mfma_f32_16x16x32_bf16 v[48:51], a[184:187], v[40:43], v[48:51]
v_mfma_f32_16x16x32_bf16 v[48:51], a[188:191], v[44:47], v[48:51]
s_bitcmp1_b32 s46, 23
s_cbranch_scc0 LE_nf23
v_readlane_b32 s57, v80, s51
s_add_u32 s51, s51, 1
s_and_b32 s51, s51, 63
s_cbranch_scc1 LE_dg23
v_mov_b32 v80, v81
v_mov_b32 v81, v82
LE_dg23:
s_nop 3
v_mul_f32 v48, s57, v48
v_mul_f32 v49, s57, v49
v_mul_f32 v50, s57, v50
v_mul_f32 v51, s57, v51
s_cmp_eq_u32 s42, 0
s_cbranch_scc1 LE_fl23
buffer_load_dwordx2 v[66:67], v39, s[20:23], s47 offen sc1
s_waitcnt vmcnt(0)
v_lshlrev_b32 v64, 16, v66
v_and_b32 v65, 0xffff0000, v66
v_add_f32 v48, v48, v64
v_add_f32 v49, v49, v65
v_lshlrev_b32 v64, 16, v67
v_and_b32 v65, 0xffff0000, v67
v_add_f32 v50, v50, v64
v_add_f32 v51, v51, v65
LE_fl23:
v_cvt_pk_bf16_f32 v64, v48, v49
v_cvt_pk_bf16_f32 v65, v50, v51
v_mov_b32 v48, 0
v_mov_b32 v49, 0
v_mov_b32 v50, 0
v_mov_b32 v51, 0
buffer_store_dwordx2 v[64:65], v39, s[20:23], s47 offen sc1
s_add_u32 s47, s47, 512
LE_nf23:
s_waitcnt lgkmcnt(0)
ds_read2_b32 v[52:53], v34 offset0:96 offset1:100
ds_read2_b32 v[54:55], v34 offset0:104 offset1:108
v_mad_u32_u16 v60, v56, s49, v2
v_mad_u32_u16 v61, v57, s49, v2
v_mad_u32_u16 v62, v58, s49, v2
v_mad_u32_u16 v63, v59, s49, v2
buffer_load_dwordx4 a[160:163], v60, s[16:19], 0 offen
buffer_load_dwordx4 a[164:167], v60, s[16:19], 0 offen offset:256
buffer_load_dwordx4 a[168:171], v61, s[16:19], 0 offen
buffer_load_dwordx4 a[172:175], v61, s[16:19], 0 offen offset:256
buffer_load_dwordx4 a[176:179], v62, s[16:19], 0 offen
buffer_load_dwordx4 a[180:183], v62, s[16:19], 0 offen offset:256
buffer_load_dwordx4 a[184:187], v63, s[16:19], 0 offen
buffer_load_dwordx4 a[188:191], v63, s[16:19], 0 offen offset:256
s_waitcnt vmcnt(56)
v_mfma_f32_16x16x32_bf16 v[48:51], a[192:195], v[40:43], v[48:51]
v_mfma_f32_16x16x32_bf16 v[48:51], a[196:199], v[44:47], v[48:51]
s_bitcmp1_b32 s46, 24
s_cbranch_scc0 LE_nf24
v_readlane_b32 s57, v80, s51
s_add_u32 s51, s51, 1
s_and_b32 s51, s51, 63
s_cbranch_scc1 LE_dg24
v_mov_b32 v80, v81
v_mov_b32 v81, v82
LE_dg24:
s_nop 3
v_mul_f32 v48, s57, v48
v_mul_f32 v49, s57, v49
v_mul_f32 v50, s57, v50
v_mul_f32 v51, s57, v51
s_cmp_eq_u32 s42, 0
s_cbranch_scc1 LE_fl24
buffer_load_dwordx2 v[66:67], v39, s[20:23], s47 offen sc1
s_waitcnt vmcnt(0)
v_lshlrev_b32 v64, 16, v66
v_and_b32 v65, 0xffff0000, v66
v_add_f32 v48, v48, v64
v_add_f32 v49, v49, v65
v_lshlrev_b32 v64, 16, v67
v_and_b32 v65, 0xffff0000, v67
v_add_f32 v50, v50, v64
v_add_f32 v51, v51, v65
LE_fl24:
v_cvt_pk_bf16_f32 v64, v48, v49
v_cvt_pk_bf16_f32 v65, v50, v51
v_mov_b32 v48, 0
v_mov_b32 v49, 0
v_mov_b32 v50, 0
v_mov_b32 v51, 0
buffer_store_dwordx2 v[64:65], v39, s[20:23], s47 offen sc1
s_add_u32 s47, s47, 512
LE_nf24:
v_mfma_f32_16x16x32_bf16 v[48:51], a[200:203], v[40:43], v[48:51]
v_mfma_f32_16x16x32_bf16 v[48:51], a[204:207], v[44:47], v[48:51]
s_bitcmp1_b32 s46, 25
s_cbranch_scc0 LE_nf25
v_readlane_b32 s57, v80, s51
s_add_u32 s51, s51, 1
s_and_b32 s51, s51, 63
s_cbranch_scc1 LE_dg25
v_mov_b32 v80, v81
v_mov_b32 v81, v82
LE_dg25:
s_nop 3
v_mul_f32 v48, s57, v48
v_mul_f32 v49, s57, v49
v_mul_f32 v50, s57, v50
v_mul_f32 v51, s57, v51
s_cmp_eq_u32 s42, 0
s_cbranch_scc1 LE_fl25
buffer_load_dwordx2 v[66:67], v39, s[20:23], s47 offen sc1
s_waitcnt vmcnt(0)
v_lshlrev_b32 v64, 16, v66
v_and_b32 v65, 0xffff0000, v66
v_add_f32 v48, v48, v64
v_add_f32 v49, v49, v65
v_lshlrev_b32 v64, 16, v67
v_and_b32 v65, 0xffff0000, v67
v_add_f32 v50, v50, v64
v_add_f32 v51, v51, v65
LE_fl25:
v_cvt_pk_bf16_f32 v64, v48, v49
v_cvt_pk_bf16_f32 v65, v50, v51
v_mov_b32 v48, 0
v_mov_b32 v49, 0
v_mov_b32 v50, 0
v_mov_b32 v51, 0
buffer_store_dwordx2 v[64:65], v39, s[20:23], s47 offen sc1
s_add_u32 s47, s47, 512
LE_nf25:
v_mfma_f32_16x16x32_bf16 v[48:51], a[208:211], v[40:43], v[48:51]
v_mfma_f32_16x16x32_bf16 v[48:51], a[212:215], v[44:47], v[48:51]
s_bitcmp1_b32 s46, 26
s_cbranch_scc0 LE_nf26
v_readlane_b32 s57, v80, s51
s_add_u32 s51, s51, 1
s_and_b32 s51, s51, 63
s_cbranch_scc1 LE_dg26
v_mov_b32 v80, v81
v_mov_b32 v81, v82
LE_dg26:
s_nop 3
v_mul_f32 v48, s57, v48
v_mul_f32 v49, s57, v49
v_mul_f32 v50, s57, v50
v_mul_f32 v51, s57, v51
s_cmp_eq_u32 s42, 0
s_cbranch_scc1 LE_fl26
buffer_load_dwordx2 v[66:67], v39, s[20:23], s47 offen sc1
s_waitcnt vmcnt(0)
v_lshlrev_b32 v64, 16, v66
v_and_b32 v65, 0xffff0000, v66
v_add_f32 v48, v48, v64
v_add_f32 v49, v49, v65
v_lshlrev_b32 v64, 16, v67
v_and_b32 v65, 0xffff0000, v67
v_add_f32 v50, v50, v64
v_add_f32 v51, v51, v65
LE_fl26:
v_cvt_pk_bf16_f32 v64, v48, v49
v_cvt_pk_bf16_f32 v65, v50, v51
v_mov_b32 v48, 0
v_mov_b32 v49, 0
v_mov_b32 v50, 0
v_mov_b32 v51, 0
buffer_store_dwordx2 v[64:65], v39, s[20:23], s47 offen sc1
s_add_u32 s47, s47, 512
LE_nf26:
v_mfma_f32_16x16x32_bf16 v[48:51], a[216:219], v[40:43], v[48:51]
v_mfma_f32_16x16x32_bf16 v[48:51], a[220:223], v[44:47], v[48:51]
s_bitcmp1_b32 s46, 27
s_cbranch_scc0 LE_nf27
v_readlane_b32 s57, v80, s51
s_add_u32 s51, s51, 1
s_and_b32 s51, s51, 63
s_cbranch_scc1 LE_dg27
v_mov_b32 v80, v81
v_mov_b32 v81, v82
LE_dg27:
s_nop 3
v_mul_f32 v48, s57, v48
v_mul_f32 v49, s57, v49
v_mul_f32 v50, s57, v50
v_mul_f32 v51, s57, v51
s_cmp_eq_u32 s42, 0
s_cbranch_scc1 LE_fl27
buffer_load_dwordx2 v[66:67], v39, s[20:23], s47 offen sc1
s_waitcnt vmcnt(0)
v_lshlrev_b32 v64, 16, v66
v_and_b32 v65, 0xffff0000, v66
v_add_f32 v48, v48, v64
v_add_f32 v49, v49, v65
v_lshlrev_b32 v64, 16, v67
v_and_b32 v65, 0xffff0000, v67
v_add_f32 v50, v50, v64
v_add_f32 v51, v51, v65
LE_fl27:
v_cvt_pk_bf16_f32 v64, v48, v49
v_cvt_pk_bf16_f32 v65, v50, v51
v_mov_b32 v48, 0
v_mov_b32 v49, 0
v_mov_b32 v50, 0
v_mov_b32 v51, 0
buffer_store_dwordx2 v[64:65], v39, s[20:23], s47 offen sc1
s_add_u32 s47, s47, 512
LE_nf27:
s_waitcnt lgkmcnt(0)
ds_read2_b32 v[56:57], v34 offset0:112 offset1:116
ds_read2_b32 v[58:59], v34 offset0:120 offset1:124
v_mad_u32_u16 v60, v52, s49, v2
v_mad_u32_u16 v61, v53, s49, v2
v_mad_u32_u16 v62, v54, s49, v2
v_mad_u32_u16 v63, v55, s49, v2
buffer_load_dwordx4 a[192:195], v60, s[16:19], 0 offen
buffer_load_dwordx4 a[196:199], v60, s[16:19], 0 offen offset:256
buffer_load_dwordx4 a[200:203], v61, s[16:19], 0 offen
buffer_load_dwordx4 a[204:207], v61, s[16:19], 0 offen offset:256
buffer_load_dwordx4 a[208:211], v62, s[16:19], 0 offen
buffer_load_dwordx4 a[212:215], v62, s[16:19], 0 offen offset:256
buffer_load_dwordx4 a[216:219], v63, s[16:19], 0 offen
buffer_load_dwordx4 a[220:223], v63, s[16:19], 0 offen offset:256
s_waitcnt vmcnt(56)
v_mfma_f32_16x16x32_bf16 v[48:51], a[224:227], v[40:43], v[48:51]
v_mfma_f32_16x16x32_bf16 v[48:51], a[228:231], v[44:47], v[48:51]
s_bitcmp1_b32 s46, 28
s_cbranch_scc0 LE_nf28
v_readlane_b32 s57, v80, s51
s_add_u32 s51, s51, 1
s_and_b32 s51, s51, 63
s_cbranch_scc1 LE_dg28
v_mov_b32 v80, v81
v_mov_b32 v81, v82
LE_dg28:
s_nop 3
v_mul_f32 v48, s57, v48
v_mul_f32 v49, s57, v49
v_mul_f32 v50, s57, v50
v_mul_f32 v51, s57, v51
s_cmp_eq_u32 s42, 0
s_cbranch_scc1 LE_fl28
buffer_load_dwordx2 v[66:67], v39, s[20:23], s47 offen sc1
s_waitcnt vmcnt(0)
v_lshlrev_b32 v64, 16, v66
v_and_b32 v65, 0xffff0000, v66
v_add_f32 v48, v48, v64
v_add_f32 v49, v49, v65
v_lshlrev_b32 v64, 16, v67
v_and_b32 v65, 0xffff0000, v67
v_add_f32 v50, v50, v64
v_add_f32 v51, v51, v65
LE_fl28:
v_cvt_pk_bf16_f32 v64, v48, v49
v_cvt_pk_bf16_f32 v65, v50, v51
v_mov_b32 v48, 0
v_mov_b32 v49, 0
v_mov_b32 v50, 0
v_mov_b32 v51, 0
buffer_store_dwordx2 v[64:65], v39, s[20:23], s47 offen sc1
s_add_u32 s47, s47, 512
LE_nf28:
v_mfma_f32_16x16x32_bf16 v[48:51], a[232:235], v[40:43], v[48:51]
v_mfma_f32_16x16x32_bf16 v[48:51], a[236:239], v[44:47], v[48:51]
s_bitcmp1_b32 s46, 29
s_cbranch_scc0 LE_nf29
v_readlane_b32 s57, v80, s51
s_add_u32 s51, s51, 1
s_and_b32 s51, s51, 63
s_cbranch_scc1 LE_dg29
v_mov_b32 v80, v81
v_mov_b32 v81, v82
LE_dg29:
s_nop 3
v_mul_f32 v48, s57, v48
v_mul_f32 v49, s57, v49
v_mul_f32 v50, s57, v50
v_mul_f32 v51, s57, v51
s_cmp_eq_u32 s42, 0
s_cbranch_scc1 LE_fl29
buffer_load_dwordx2 v[66:67], v39, s[20:23], s47 offen sc1
s_waitcnt vmcnt(0)
v_lshlrev_b32 v64, 16, v66
v_and_b32 v65, 0xffff0000, v66
v_add_f32 v48, v48, v64
v_add_f32 v49, v49, v65
v_lshlrev_b32 v64, 16, v67
v_and_b32 v65, 0xffff0000, v67
v_add_f32 v50, v50, v64
v_add_f32 v51, v51, v65
LE_fl29:
v_cvt_pk_bf16_f32 v64, v48, v49
v_cvt_pk_bf16_f32 v65, v50, v51
v_mov_b32 v48, 0
v_mov_b32 v49, 0
v_mov_b32 v50, 0
v_mov_b32 v51, 0
buffer_store_dwordx2 v[64:65], v39, s[20:23], s47 offen sc1
s_add_u32 s47, s47, 512
LE_nf29:
v_mfma_f32_16x16x32_bf16 v[48:51], a[240:243], v[40:43], v[48:51]
v_mfma_f32_16x16x32_bf16 v[48:51], a[244:247], v[44:47], v[48:51]
s_bitcmp1_b32 s46, 30
s_cbranch_scc0 LE_nf30
v_readlane_b32 s57, v80, s51
s_add_u32 s51, s51, 1
s_and_b32 s51, s51, 63
s_cbranch_scc1 LE_dg30
v_mov_b32 v80, v81
v_mov_b32 v81, v82
LE_dg30:
s_nop 3
v_mul_f32 v48, s57, v48
v_mul_f32 v49, s57, v49
v_mul_f32 v50, s57, v50
v_mul_f32 v51, s57, v51
s_cmp_eq_u32 s42, 0
s_cbranch_scc1 LE_fl30
buffer_load_dwordx2 v[66:67], v39, s[20:23], s47 offen sc1
s_waitcnt vmcnt(0)
v_lshlrev_b32 v64, 16, v66
v_and_b32 v65, 0xffff0000, v66
v_add_f32 v48, v48, v64
v_add_f32 v49, v49, v65
v_lshlrev_b32 v64, 16, v67
v_and_b32 v65, 0xffff0000, v67
v_add_f32 v50, v50, v64
v_add_f32 v51, v51, v65
LE_fl30:
v_cvt_pk_bf16_f32 v64, v48, v49
v_cvt_pk_bf16_f32 v65, v50, v51
v_mov_b32 v48, 0
v_mov_b32 v49, 0
v_mov_b32 v50, 0
v_mov_b32 v51, 0
buffer_store_dwordx2 v[64:65], v39, s[20:23], s47 offen sc1
s_add_u32 s47, s47, 512
LE_nf30:
v_mfma_f32_16x16x32_bf16 v[48:51], a[248:251], v[40:43], v[48:51]
v_mfma_f32_16x16x32_bf16 v[48:51], a[252:255], v[44:47], v[48:51]
s_bitcmp1_b32 s46, 31
s_cbranch_scc0 LE_nf31
v_readlane_b32 s57, v80, s51
s_add_u32 s51, s51, 1
s_and_b32 s51, s51, 63
s_cbranch_scc1 LE_dg31
v_mov_b32 v80, v81
v_mov_b32 v81, v82
LE_dg31:
s_nop 3
v_mul_f32 v48, s57, v48
v_mul_f32 v49, s57, v49
v_mul_f32 v50, s57, v50
v_mul_f32 v51, s57, v51
s_cmp_eq_u32 s42, 0
s_cbranch_scc1 LE_fl31
buffer_load_dwordx2 v[66:67], v39, s[20:23], s47 offen sc1
s_waitcnt vmcnt(0)
v_lshlrev_b32 v64, 16, v66
v_and_b32 v65, 0xffff0000, v66
v_add_f32 v48, v48, v64
v_add_f32 v49, v49, v65
v_lshlrev_b32 v64, 16, v67
v_and_b32 v65, 0xffff0000, v67
v_add_f32 v50, v50, v64
v_add_f32 v51, v51, v65
LE_fl31:
v_cvt_pk_bf16_f32 v64, v48, v49
v_cvt_pk_bf16_f32 v65, v50, v51
v_mov_b32 v48, 0
v_mov_b32 v49, 0
v_mov_b32 v50, 0
v_mov_b32 v51, 0
buffer_store_dwordx2 v[64:65], v39, s[20:23], s47 offen sc1
s_add_u32 s47, s47, 512
LE_nf31:
s_waitcnt lgkmcnt(0)
ds_read2_b32 v[52:53], v34 offset0:128 offset1:132
ds_read2_b32 v[54:55], v34 offset0:136 offset1:140
v_mad_u32_u16 v60, v56, s49, v2
v_mad_u32_u16 v61, v57, s49, v2
v_mad_u32_u16 v62, v58, s49, v2
v_mad_u32_u16 v63, v59, s49, v2
buffer_load_dwordx4 a[224:227], v60, s[16:19], 0 offen
buffer_load_dwordx4 a[228:231], v60, s[16:19], 0 offen offset:256
buffer_load_dwordx4 a[232:235], v61, s[16:19], 0 offen
buffer_load_dwordx4 a[236:239], v61, s[16:19], 0 offen offset:256
buffer_load_dwordx4 a[240:243], v62, s[16:19], 0 offen
buffer_load_dwordx4 a[244:247], v62, s[16:19], 0 offen offset:256
buffer_load_dwordx4 a[248:251], v63, s[16:19], 0 offen
buffer_load_dwordx4 a[252:255], v63, s[16:19], 0 offen offset:256
v_add_u32 v34, 512, v34
s_cmp_lt_u32 s45, s44
s_cbranch_scc1 LE_loop
s_add_u32 s42, s42, 1
s_mul_i32 s43, s42, 128
v_cmp_lt_u32 vcc, s43, v4
s_cbranch_vccz LE_done
s_cmp_ge_u32 s42, 40
s_cbranch_scc1 LE_done
s_waitcnt vmcnt(0) lgkmcnt(0)
s_add_u32 s50, s50, 512
v_add_u32 v5, 0x80, v5
buffer_load_dwordx4 v[192:195], v6, s[12:15], s50 offen offset:0
buffer_load_dwordx4 v[196:199], v6, s[12:15], s50 offen offset:32
buffer_load_dwordx4 v[200:203], v6, s[12:15], s50 offen offset:64
buffer_load_dwordx4 v[204:207], v6, s[12:15], s50 offen offset:96
buffer_load_dwordx4 v[208:211], v6, s[12:15], s50 offen offset:128
buffer_load_dwordx4 v[212:215], v6, s[12:15], s50 offen offset:160
buffer_load_dwordx4 v[216:219], v6, s[12:15], s50 offen offset:192
buffer_load_dwordx4 v[220:223], v6, s[12:15], s50 offen offset:224
buffer_load_dwordx4 v[224:227], v6, s[12:15], s50 offen offset:256
buffer_load_dwordx4 v[228:231], v6, s[12:15], s50 offen offset:288
buffer_load_dwordx4 v[232:235], v6, s[12:15], s50 offen offset:320
buffer_load_dwordx4 v[236:239], v6, s[12:15], s50 offen offset:352
buffer_load_dwordx4 v[240:243], v6, s[12:15], s50 offen offset:384
buffer_load_dwordx4 v[244:247], v6, s[12:15], s50 offen offset:416
buffer_load_dwordx4 v[248:251], v6, s[12:15], s50 offen offset:448
buffer_load_dwordx4 v[252:255], v6, s[12:15], s50 offen offset:480
s_branch LE_pass
LE_done:
s_add_u32 s52, s4, 0x7c00000
s_addc_u32 s53, s5, 0
s_mov_b32 s54, 0x2000
s_mov_b32 s55, 0x00020000
v_mov_b32 v20, 5120
v_mov_b32 v21, 1
s_mov_b64 exec, 1
s_waitcnt vmcnt(0)
buffer_atomic_add v21, v20, s[52:55], 0 offen
s_mov_b64 exec, -1
s_getpc_b64 s[52:53]
LE_pc:
s_sub_u32 s52, s52, LE_pc-L2_tails
s_subb_u32 s53, s53, 0
s_mov_b32 s54, LT_disp-L2_tails
s_mov_b32 s55, 0x00020000
s_mov_b64 exec, -1
v_lshlrev_b32 v30, 7, v1
s_mov_b32 s56, 0x0
buffer_load_dword v32, v30, s[52:55], s56 offen
s_mov_b32 s56, 0x2000
buffer_load_dword v33, v30, s[52:55], s56 offen
s_mov_b32 s56, 0x4000
buffer_load_dword v34, v30, s[52:55], s56 offen
s_mov_b32 s56, 0x6000
buffer_load_dword v35, v30, s[52:55], s56 offen
s_mov_b32 s56, 0x8000
buffer_load_dword v36, v30, s[52:55], s56 offen
s_mov_b32 s56, 0xa000
buffer_load_dword v37, v30, s[52:55], s56 offen
s_mov_b32 s56, 0xc000
buffer_load_dword v38, v30, s[52:55], s56 offen
s_cmp_ge_u32 s2, 240
s_cbranch_scc1 LC_help
s_branch L2_end
LC_help:
s_waitcnt vmcnt(0)
s_mov_b32 s100, 0
s_load_dwordx2 s[6:7], s[0:1], 0
s_load_dwordx2 s[18:19], s[0:1], 72
s_mov_b32 s34, s41
v_mbcnt_lo_u32_b32 v252, -1, 0
v_mbcnt_hi_u32_b32 v252, -1, v252
v_lshlrev_b32 v252, 4, v252
s_and_b32 s32, s2, 7
s_mul_i32 s32, s32, 5
s_bfe_u32 s33, s2, 0x10003
s_mul_i32 s35, s33, 3
s_add_u32 s32, s32, s35
s_add_u32 s35, s32, 0
s_lshl_b32 s48, s35, 7
s_lshl_b32 s52, s35, 17
s_add_u32 s52, s52, 122880
s_add_u32 s35, s32, 1
s_lshl_b32 s49, s35, 7
s_lshl_b32 s53, s35, 17
s_add_u32 s53, s53, 122880
s_add_u32 s35, s32, 2
s_lshl_b32 s50, s35, 7
s_lshl_b32 s54, s35, 17
s_add_u32 s54, s54, 122880
s_cmp_eq_u32 s49, 4992
s_cselect_b32 s53, 5111808, s53
s_cmp_eq_u32 s33, 1
s_cselect_b32 s54, 0x7fff0000, s54
s_cselect_b32 s50, s48, s50
s_mov_b32 s15, 0x7fff0000
s_mov_b32 s14, 0
s_mov_b32 s99, 0
s_mov_b32 s51, 0
s_mov_b32 s98, 2
s_waitcnt lgkmcnt(0)
s_add_u32 s24, s4, 0x6000000
s_addc_u32 s25, s5, 0
s_mov_b32 s26, 0x9c800
s_mov_b32 s27, 0x00020000
s_add_u32 s56, s4, 0x1000000
s_addc_u32 s57, s5, 0
s_mov_b32 s58, 0x6c02000
s_mov_b32 s59, 0x00020000
s_branch LC_common
L2_fin:
L2_end:
s_endpgm
.section .rodata,"a"
.p2align 6
.amdhsa_kernel k1_kernel
  .amdhsa_next_free_vgpr 256
  .amdhsa_next_free_sgpr 102
  .amdhsa_accum_offset 256
  .amdhsa_group_segment_fixed_size 0
  .amdhsa_kernarg_size 96
  .amdhsa_user_sgpr_count 2
  .amdhsa_user_sgpr_kernarg_segment_ptr 1
  .amdhsa_system_sgpr_workgroup_id_x 1
.end_amdhsa_kernel
.p2align 6
.amdhsa_kernel k2_kernel
  .amdhsa_next_free_vgpr 512
  .amdhsa_next_free_sgpr 102
  .amdhsa_accum_offset 256
  .amdhsa_group_segment_fixed_size 0
  .amdhsa_kernarg_size 96
  .amdhsa_user_sgpr_count 2
  .amdhsa_user_sgpr_kernarg_segment_ptr 1
  .amdhsa_system_sgpr_workgroup_id_x 1
.end_amdhsa_kernel
```

```asm
; @launch kernel=k1_kernel grid=(249,1,1) block=(512,1,1) lds=163840
; @launch kernel=k2_kernel grid=(256,1,1) block=(256,1,1) lds=163840
.amdgcn_target "amdgcn-amd-amdhsa--gfx950"
.text
.globl k1_kernel
.p2align 8
.type k1_kernel,@function
k1_kernel:
s_getpc_b64 s[56:57]
s_load_dwordx16 s[16:31], s[0:1], 0
s_load_dwordx8 s[32:39], s[0:1], 64
s_cmp_ge_u32 s2, 249
s_cbranch_scc1 L1_end
v_lshrrev_b32 v1, 6, v0
v_and_b32 v2, 63, v0
s_lshr_b32 s3, s2, 3
v_readfirstlane_b32 s60, v1
s_mul_i32 s5, s3, 8
s_add_u32 s5, s5, s60
s_and_b32 s56, s56, 0xffffff00
s_mov_b32 s58, L2_end-k1_kernel
s_mov_b32 s59, 0x00020000
s_and_b32 s6, s5, 15
s_lshl_b32 s6, s6, 13
v_lshlrev_b32 v10, 7, v2
buffer_load_dword v255, v10, s[56:59], s6 offen
v_and_b32 v3, 15, v2
v_lshrrev_b32 v4, 4, v2
s_and_b32 s62, s3, 7
s_sub_u32 s4, s2, 40
s_cmp_lt_u32 s2, 40
s_cbranch_scc1 L1_notq
s_mov_b32 s61, 0
v_lshlrev_b32 v16, 4, v2
s_mul_i32 s63, s60, 6144
s_mul_i32 s6, s4, 24576
s_mul_i32 s7, s60, 3072
s_add_u32 s64, s6, s7
s_add_u32 s65, s64, 4096
s_lshl_b32 s7, s60, 6
v_lshrrev_b32 v5, 2, v2
v_and_b32 v6, 3, v2
v_lshrrev_b32 v7, 5, v2
v_lshlrev_b32 v7, 1, v7
v_xor_b32 v6, v6, v7
v_lshl_add_u32 v5, v5, 9, s7
v_lshl_add_u32 v17, v6, 4, v5
v_add_u32 v18, 0x1c00, v17
s_xor_b32 s6, s62, 0
s_lshl_b32 s66, s6, 14
s_xor_b32 s6, s62, 1
s_lshl_b32 s67, s6, 14
s_xor_b32 s6, s62, 2
s_lshl_b32 s68, s6, 14
s_xor_b32 s6, s62, 3
s_lshl_b32 s69, s6, 14
s_xor_b32 s6, s62, 4
s_lshl_b32 s70, s6, 14
s_xor_b32 s6, s62, 5
s_lshl_b32 s71, s6, 14
s_xor_b32 s6, s62, 6
s_lshl_b32 s72, s6, 14
s_xor_b32 s6, s62, 7
s_lshl_b32 s73, s6, 14
s_waitcnt lgkmcnt(0)
s_add_u32 s40, s16, 0x0
s_addc_u32 s41, s17, 0
s_mov_b32 s42, 0x4e2000
s_mov_b32 s43, 0x00020000
s_add_u32 s44, s26, 0x0
s_addc_u32 s45, s27, 0
s_mov_b32 s46, 0x20000
s_mov_b32 s47, 0x00020000
buffer_load_dwordx4 v[40:43], v16, s[40:43], s64 offen offset:0
buffer_load_dwordx4 v[44:47], v16, s[40:43], s64 offen offset:1024
buffer_load_dwordx4 v[48:51], v16, s[40:43], s64 offen offset:2048
s_add_u32 m0, s63, 0x0
s_nop 0
buffer_load_dwordx4 v17, s[44:47], s66 offen offset:0 lds
buffer_load_dwordx4 v18, s[44:47], s66 offen offset:1024 lds
s_add_u32 m0, s63, 0x800
s_nop 0
buffer_load_dwordx4 v17, s[44:47], s67 offen offset:0 lds
buffer_load_dwordx4 v18, s[44:47], s67 offen offset:1024 lds
v_bfe_u32 v5, v2, 2, 3
v_xor_b32 v5, s62, v5
v_and_b32 v6, 3, v2
v_lshlrev_b32 v7, 10, v5
v_lshl_add_u32 v7, v6, 8, v7
v_add_u32 v7, 0xc000, v7
v_and_b32 v5, 1, v5
v_lshl_or_b32 v6, v5, 2, v6
v_lshrrev_b32 v5, 5, v2
s_mul_i32 s6, s60, 6
v_add3_u32 v8, v5, s6, 0
v_lshrrev_b32 v9, 4, v8
v_lshl_add_u32 v9, v9, 13, v7
v_and_b32 v8, 15, v8
v_xor_b32 v8, v8, v6
v_lshl_add_u32 v36, v8, 4, v9
v_add3_u32 v8, v5, s6, 2
v_lshrrev_b32 v9, 4, v8
v_lshl_add_u32 v9, v9, 13, v7
v_and_b32 v8, 15, v8
v_xor_b32 v8, v8, v6
v_lshl_add_u32 v37, v8, 4, v9
v_add3_u32 v8, v5, s6, 4
v_lshrrev_b32 v9, 4, v8
v_lshl_add_u32 v9, v9, 13, v7
v_and_b32 v8, 15, v8
v_xor_b32 v8, v8, v6
v_lshl_add_u32 v38, v8, 4, v9
v_xor_b32 v5, v3, v4
v_lshlrev_b32 v5, 4, v5
v_lshl_add_u32 v5, v4, 8, v5
v_add_u32 v31, 0xc000, v5
v_xor_b32 v32, 64, v31
v_lshrrev_b32 v5, 2, v3
v_and_b32 v6, 3, v3
v_and_b32 v7, 1, v4
v_lshlrev_b32 v7, 1, v7
v_lshl_add_u32 v8, v4, 3, v5
v_lshlrev_b32 v8, 6, v8
v_add_u32 v8, s63, v8
v_and_b32 v9, 1, v6
v_lshl_add_u32 v8, v9, 3, v8
v_lshrrev_b32 v6, 1, v6
v_xor_b32 v6, v6, v7
v_xor_b32 v9, 0, v6
v_lshl_add_u32 v25, v9, 4, v8
v_xor_b32 v9, 2, v6
v_lshl_add_u32 v26, v9, 4, v8
v_lshrrev_b32 v5, 3, v2
v_and_b32 v6, 7, v2
v_lshrrev_b32 v7, 1, v5
v_xor_b32 v6, v6, v7
v_and_b32 v7, 4, v5
v_add_u32 v5, v5, v7
s_mul_i32 s6, s60, 16384
v_lshl_add_u32 v5, v5, 9, s6
v_lshl_add_u32 v21, v6, 4, v5
v_xor_b32 v6, 4, v6
v_lshl_add_u32 v22, v6, 4, v5
v_add_u32 v22, 0x1c00, v22
s_lshr_b32 s7, s62, 1
s_xor_b32 s6, s7, 0
s_lshl_b32 s74, s6, 7
s_add_u32 s75, s74, 2048
s_xor_b32 s6, s7, 1
s_lshl_b32 s76, s6, 7
s_add_u32 s77, s76, 2048
s_xor_b32 s6, s7, 2
s_lshl_b32 s78, s6, 7
s_add_u32 s79, s78, 2048
s_xor_b32 s6, s7, 3
s_lshl_b32 s80, s6, 7
s_add_u32 s81, s80, 2048
s_and_b32 s6, s62, 1
s_lshl_b32 s6, s6, 2
v_lshrrev_b32 v5, 1, v3
v_xor_b32 v5, v5, v4
v_xor_b32 v5, s6, v5
v_lshl_add_u32 v6, v3, 7, s63
v_lshl_add_u32 v29, v5, 4, v6
v_xor_b32 v30, 64, v29
s_mul_i32 s6, s60, 1
s_xor_b32 s6, s6, s62
s_lshl_b32 s6, s6, 10
s_add_u32 s6, s6, 0x12000
v_lshrrev_b32 v5, 1, v4
v_and_b32 v6, 1, v4
v_lshl_add_u32 v5, v5, 8, s6
v_lshl_add_u32 v5, v6, 3, v5
v_lshl_add_u32 v33, v3, 4, v5
v_xor_b32 v34, 0x400, v33
v_add_u32 v35, 0x12000, v16
s_mul_i32 s6, s4, 24576
s_mul_i32 s7, s60, 1024
s_add_u32 s82, s6, s7
s_add_u32 s83, s82, 8192
s_add_u32 s84, s82, 16384
s_mov_b32 s86, 0x3db8aa3b
s_mov_b32 s87, 0x3db8aa3b
s_mov_b32 s88, 0x3727c5ac
s_mov_b32 s89, 0x3b800000
s_mov_b32 s90, 0xffff0000
s_add_u32 s48, s28, 0x0
s_addc_u32 s49, s29, 0
s_mov_b32 s50, 0x20000
s_mov_b32 s51, 0x00020000
s_add_u32 s52, s38, 0x0
s_addc_u32 s53, s39, 0
s_mov_b32 s54, 0x4e4000
s_mov_b32 s55, 0x00020000
s_add_u32 s56, s38, 0x6800000
s_addc_u32 s57, s39, 0
s_mov_b32 s58, 0x4e4000
s_mov_b32 s59, 0x00020000
v_lshlrev_b32 v11, 4, v4
s_lshr_b32 s8, s66, 8
buffer_load_dwordx4 v[172:175], v11, s[48:51], s8 offen
s_lshr_b32 s8, s67, 8
buffer_load_dwordx4 v[176:179], v11, s[48:51], s8 offen
s_lshr_b32 s8, s68, 8
buffer_load_dwordx4 v[180:183], v11, s[48:51], s8 offen
s_lshr_b32 s8, s69, 8
buffer_load_dwordx4 v[184:187], v11, s[48:51], s8 offen
s_lshr_b32 s8, s70, 8
buffer_load_dwordx4 v[188:191], v11, s[48:51], s8 offen
s_lshr_b32 s8, s71, 8
buffer_load_dwordx4 v[192:195], v11, s[48:51], s8 offen
s_lshr_b32 s8, s72, 8
buffer_load_dwordx4 v[196:199], v11, s[48:51], s8 offen
s_lshr_b32 s8, s73, 8
buffer_load_dwordx4 v[200:203], v11, s[48:51], s8 offen
s_waitcnt vmcnt(14)
v_lshlrev_b32 v76, 16, v40
v_and_b32 v77, s90, v40
v_lshlrev_b32 v78, 16, v41
v_and_b32 v79, s90, v41
v_lshlrev_b32 v80, 16, v42
v_and_b32 v81, s90, v42
v_lshlrev_b32 v82, 16, v43
v_and_b32 v83, s90, v43
v_pk_add_f32 v[100:101], v[76:77], v[78:79]
v_pk_mul_f32 v[102:103], v[76:77], v[76:77]
v_pk_add_f32 v[40:41], v[80:81], v[82:83]
v_pk_fma_f32 v[102:103], v[78:79], v[78:79], v[102:103]
v_pk_add_f32 v[100:101], v[100:101], v[40:41]
v_pk_fma_f32 v[102:103], v[80:81], v[80:81], v[102:103]
v_add_f32 v100, v100, v101
v_pk_fma_f32 v[102:103], v[82:83], v[82:83], v[102:103]
v_add_f32 v102, v102, v103
s_waitcnt vmcnt(13)
v_lshlrev_b32 v84, 16, v44
v_and_b32 v85, s90, v44
v_lshlrev_b32 v86, 16, v45
v_and_b32 v87, s90, v45
v_lshlrev_b32 v88, 16, v46
v_and_b32 v89, s90, v46
v_lshlrev_b32 v90, 16, v47
v_and_b32 v91, s90, v47
v_pk_add_f32 v[104:105], v[84:85], v[86:87]
v_pk_mul_f32 v[106:107], v[84:85], v[84:85]
v_pk_add_f32 v[44:45], v[88:89], v[90:91]
v_pk_fma_f32 v[106:107], v[86:87], v[86:87], v[106:107]
v_pk_add_f32 v[104:105], v[104:105], v[44:45]
v_pk_fma_f32 v[106:107], v[88:89], v[88:89], v[106:107]
v_add_f32 v104, v104, v105
v_pk_fma_f32 v[106:107], v[90:91], v[90:91], v[106:107]
v_add_f32 v106, v106, v107
s_waitcnt vmcnt(12)
v_lshlrev_b32 v92, 16, v48
v_and_b32 v93, s90, v48
v_lshlrev_b32 v94, 16, v49
v_and_b32 v95, s90, v49
v_lshlrev_b32 v96, 16, v50
v_and_b32 v97, s90, v50
v_lshlrev_b32 v98, 16, v51
v_and_b32 v99, s90, v51
v_pk_add_f32 v[108:109], v[92:93], v[94:95]
v_pk_mul_f32 v[110:111], v[92:93], v[92:93]
v_pk_add_f32 v[48:49], v[96:97], v[98:99]
v_pk_fma_f32 v[110:111], v[94:95], v[94:95], v[110:111]
v_pk_add_f32 v[108:109], v[108:109], v[48:49]
v_pk_fma_f32 v[110:111], v[96:97], v[96:97], v[110:111]
v_add_f32 v108, v108, v109
v_pk_fma_f32 v[110:111], v[98:99], v[98:99], v[110:111]
v_add_f32 v110, v110, v111
v_permlane16_swap_b32 v100, v102
v_permlane16_swap_b32 v104, v106
v_permlane16_swap_b32 v108, v110
v_add_f32 v100, v100, v102
v_add_f32 v104, v104, v106
v_add_f32 v108, v108, v110
v_add_f32_dpp v101, v100, v100 row_ror:8 row_mask:0xf bank_mask:0x3
v_add_f32_dpp v101, v104, v104 row_ror:8 row_mask:0xf bank_mask:0xc
v_add_f32_dpp v109, v108, v108 row_ror:8 row_mask:0xf bank_mask:0xf
s_nop 0
v_add_f32_dpp v102, v101, v101 row_half_mirror row_mask:0xf bank_mask:0x5
v_add_f32_dpp v102, v109, v109 row_half_mirror row_mask:0xf bank_mask:0xa
s_nop 1
v_add_f32_dpp v102, v102, v102 quad_perm:[1,0,3,2] row_mask:0xf bank_mask:0xf
s_nop 1
v_add_f32_dpp v102, v102, v102 quad_perm:[2,3,0,1] row_mask:0xf bank_mask:0xf
v_mov_b32 v103, v102
s_nop 1
v_permlane16_swap_b32 v103, v102
v_mul_f32 v103, s89, v103
v_mul_f32 v102, s89, v102
v_fma_f32 v102, -v103, v103, v102
v_max_f32 v102, 0, v102
v_cvt_pk_bf16_f32 v102, v102, v102
v_and_b32 v102, s90, v102
v_add_f32 v102, s88, v102
v_cvt_pk_bf16_f32 v102, v102, v102
v_and_b32 v102, s90, v102
v_sqrt_f32 v102, v102
s_nop 0
v_cvt_pk_bf16_f32 v102, v102, v102
v_and_b32 v102, s90, v102
v_rcp_f32 v102, v102
s_nop 0
v_mul_f32 v103, -v103, v102
s_nop 1
v_mov_b64_dpp v[100:101], v[102:103] row_newbcast:0 row_mask:0xf bank_mask:0xf
v_mov_b64_dpp v[104:105], v[102:103] row_newbcast:8 row_mask:0xf bank_mask:0xf
v_mov_b64_dpp v[108:109], v[102:103] row_newbcast:4 row_mask:0xf bank_mask:0xf
v_fma_f32 v76, v76, v100, v101
v_fma_f32 v77, v77, v100, v101
v_fma_f32 v78, v78, v100, v101
v_fma_f32 v79, v79, v100, v101
v_fma_f32 v80, v80, v100, v101
v_fma_f32 v81, v81, v100, v101
v_fma_f32 v82, v82, v100, v101
v_fma_f32 v83, v83, v100, v101
v_cvt_pk_bf16_f32 v40, v76, v77
v_cvt_pk_bf16_f32 v41, v78, v79
v_cvt_pk_bf16_f32 v42, v80, v81
v_cvt_pk_bf16_f32 v43, v82, v83
ds_write_b128 v36, v[40:43]
v_fma_f32 v84, v84, v104, v105
v_fma_f32 v85, v85, v104, v105
v_fma_f32 v86, v86, v104, v105
v_fma_f32 v87, v87, v104, v105
v_fma_f32 v88, v88, v104, v105
v_fma_f32 v89, v89, v104, v105
v_fma_f32 v90, v90, v104, v105
v_fma_f32 v91, v91, v104, v105
v_cvt_pk_bf16_f32 v44, v84, v85
v_cvt_pk_bf16_f32 v45, v86, v87
v_cvt_pk_bf16_f32 v46, v88, v89
v_cvt_pk_bf16_f32 v47, v90, v91
ds_write_b128 v37, v[44:47]
v_fma_f32 v92, v92, v108, v109
v_fma_f32 v93, v93, v108, v109
v_fma_f32 v94, v94, v108, v109
v_fma_f32 v95, v95, v108, v109
v_fma_f32 v96, v96, v108, v109
v_fma_f32 v97, v97, v108, v109
v_fma_f32 v98, v98, v108, v109
v_fma_f32 v99, v99, v108, v109
v_cvt_pk_bf16_f32 v48, v92, v93
v_cvt_pk_bf16_f32 v49, v94, v95
v_cvt_pk_bf16_f32 v50, v96, v97
v_cvt_pk_bf16_f32 v51, v98, v99
ds_write_b128 v38, v[48:51]
s_add_u32 m0, s63, 0x1000
s_nop 0
buffer_load_dwordx4 v17, s[44:47], s68 offen offset:0 lds
buffer_load_dwordx4 v18, s[44:47], s68 offen offset:1024 lds
s_waitcnt vmcnt(12)
ds_read_b64_tr_b16 v[100:101], v25 offset:0
ds_read_b64_tr_b16 v[102:103], v25 offset:256
ds_read_b64_tr_b16 v[104:105], v26 offset:0
ds_read_b64_tr_b16 v[106:107], v26 offset:256
s_waitcnt lgkmcnt(4)
s_barrier
ds_read_b128 v[124:127], v31 offset:0
ds_read_b128 v[128:131], v31 offset:8192
ds_read_b128 v[132:135], v31 offset:16384
ds_read_b128 v[136:139], v32 offset:1024
s_waitcnt vmcnt(10)
ds_read_b64_tr_b16 v[108:109], v25 offset:2048
ds_read_b64_tr_b16 v[110:111], v25 offset:2304
s_waitcnt lgkmcnt(5)
v_mfma_f32_16x16x32_bf16 v[52:55], v[100:103], v[124:127], 0
ds_read_b128 v[140:143], v32 offset:9216
s_waitcnt lgkmcnt(5)
v_mfma_f32_16x16x32_bf16 v[56:59], v[100:103], v[128:131], 0
ds_read_b128 v[144:147], v32 offset:17408
s_waitcnt lgkmcnt(5)
v_mfma_f32_16x16x32_bf16 v[60:63], v[100:103], v[132:135], 0
ds_read_b64_tr_b16 v[112:113], v26 offset:2048
ds_read_b64_tr_b16 v[114:115], v26 offset:2304
v_mfma_f32_16x16x32_bf16 v[64:67], v[104:107], v[124:127], 0
s_add_u32 m0, s63, 0x0
s_nop 0
buffer_load_dwordx4 v17, s[44:47], s69 offen offset:0 lds
buffer_load_dwordx4 v18, s[44:47], s69 offen offset:1024 lds
v_mfma_f32_16x16x32_bf16 v[68:71], v[104:107], v[128:131], 0
v_and_b32 v5, 31, v2
v_lshrrev_b32 v6, 5, v2
v_mfma_f32_16x16x32_bf16 v[72:75], v[104:107], v[132:135], 0
ds_read_b128 v[148:151], v31 offset:2048
s_waitcnt vmcnt(2)
ds_read_b64_tr_b16 v[116:117], v25 offset:4096
ds_read_b64_tr_b16 v[118:119], v25 offset:4352
s_waitcnt lgkmcnt(7)
v_mfma_f32_16x16x32_bf16 v[52:55], v[108:111], v[136:139], v[52:55]
ds_read_b128 v[152:155], v31 offset:10240
s_lshr_b32 s6, s64, 9
s_waitcnt lgkmcnt(7)
v_mfma_f32_16x16x32_bf16 v[56:59], v[108:111], v[140:143], v[56:59]
ds_read_b128 v[156:159], v31 offset:18432
v_cmp_eq_u32 vcc, 0, v5
s_waitcnt lgkmcnt(7)
v_mfma_f32_16x16x32_bf16 v[60:63], v[108:111], v[144:147], v[60:63]
ds_read_b64_tr_b16 v[120:121], v26 offset:4096
ds_read_b64_tr_b16 v[122:123], v26 offset:4352
s_waitcnt lgkmcnt(7)
v_mfma_f32_16x16x32_bf16 v[64:67], v[112:115], v[136:139], v[64:67]
s_add_u32 m0, s63, 0x800
s_nop 0
buffer_load_dwordx4 v17, s[44:47], s70 offen offset:0 lds
buffer_load_dwordx4 v18, s[44:47], s70 offen offset:1024 lds
v_mfma_f32_16x16x32_bf16 v[68:71], v[112:115], v[140:143], v[68:71]
s_sub_u32 s6, 10000, s6
v_mov_b32 v7, 0x7fffffff
v_mfma_f32_16x16x32_bf16 v[72:75], v[112:115], v[144:147], v[72:75]
ds_read_b128 v[160:163], v32 offset:3072
s_waitcnt vmcnt(2)
ds_read_b64_tr_b16 v[100:101], v25 offset:0
ds_read_b64_tr_b16 v[102:103], v25 offset:256
s_waitcnt lgkmcnt(7)
v_mfma_f32_16x16x32_bf16 v[52:55], v[116:119], v[148:151], v[52:55]
ds_read_b128 v[164:167], v32 offset:11264
v_cndmask_b32 v6, v7, v6, vcc
s_waitcnt lgkmcnt(7)
v_mfma_f32_16x16x32_bf16 v[56:59], v[116:119], v[152:155], v[56:59]
ds_read_b128 v[168:171], v32 offset:19456
v_cmp_gt_i32 vcc, s6, v6
s_waitcnt lgkmcnt(7)
v_mfma_f32_16x16x32_bf16 v[60:63], v[116:119], v[156:159], v[60:63]
ds_read_b64_tr_b16 v[104:105], v26 offset:0
ds_read_b64_tr_b16 v[106:107], v26 offset:256
s_waitcnt lgkmcnt(7)
v_mfma_f32_16x16x32_bf16 v[64:67], v[120:123], v[148:151], v[64:67]
s_add_u32 m0, s63, 0x1000
s_nop 0
buffer_load_dwordx4 v17, s[44:47], s71 offen offset:0 lds
buffer_load_dwordx4 v18, s[44:47], s71 offen offset:1024 lds
v_mfma_f32_16x16x32_bf16 v[68:71], v[120:123], v[152:155], v[68:71]
v_and_b32 v5, s90, v40
v_or_b32 v5, 0x3f80, v5
v_mfma_f32_16x16x32_bf16 v[72:75], v[120:123], v[156:159], v[72:75]
ds_read_b128 v[124:127], v31 offset:4096
s_waitcnt vmcnt(2)
ds_read_b64_tr_b16 v[108:109], v25 offset:2048
ds_read_b64_tr_b16 v[110:111], v25 offset:2304
s_waitcnt lgkmcnt(7)
v_mfma_f32_16x16x32_bf16 v[52:55], v[100:103], v[160:163], v[52:55]
ds_read_b128 v[128:131], v31 offset:12288
s_sub_u32 s6, s6, 2
s_waitcnt lgkmcnt(7)
v_mfma_f32_16x16x32_bf16 v[56:59], v[100:103], v[164:167], v[56:59]
ds_read_b128 v[132:135], v31 offset:20480
v_cndmask_b32 v40, v40, v5, vcc
s_waitcnt lgkmcnt(7)
v_mfma_f32_16x16x32_bf16 v[60:63], v[100:103], v[168:171], v[60:63]
ds_read_b64_tr_b16 v[112:113], v26 offset:2048
ds_read_b64_tr_b16 v[114:115], v26 offset:2304
s_waitcnt lgkmcnt(7)
v_mfma_f32_16x16x32_bf16 v[64:67], v[104:107], v[160:163], v[64:67]
s_add_u32 m0, s63, 0x0
s_nop 0
buffer_load_dwordx4 v17, s[44:47], s72 offen offset:0 lds
buffer_load_dwordx4 v18, s[44:47], s72 offen offset:1024 lds
v_mfma_f32_16x16x32_bf16 v[68:71], v[104:107], v[164:167], v[68:71]
v_cmp_gt_i32 vcc, s6, v6
v_and_b32 v5, s90, v44
v_mfma_f32_16x16x32_bf16 v[72:75], v[104:107], v[168:171], v[72:75]
ds_read_b128 v[136:139], v32 offset:5120
s_waitcnt vmcnt(2)
ds_read_b64_tr_b16 v[116:117], v25 offset:4096
ds_read_b64_tr_b16 v[118:119], v25 offset:4352
s_waitcnt lgkmcnt(7)
v_mfma_f32_16x16x32_bf16 v[52:55], v[108:111], v[124:127], v[52:55]
ds_read_b128 v[140:143], v32 offset:13312
v_or_b32 v5, 0x3f80, v5
s_waitcnt lgkmcnt(7)
v_mfma_f32_16x16x32_bf16 v[56:59], v[108:111], v[128:131], v[56:59]
ds_read_b128 v[144:147], v32 offset:21504
s_sub_u32 s6, s6, 2
s_waitcnt lgkmcnt(7)
v_mfma_f32_16x16x32_bf16 v[60:63], v[108:111], v[132:135], v[60:63]
ds_read_b64_tr_b16 v[120:121], v26 offset:4096
ds_read_b64_tr_b16 v[122:123], v26 offset:4352
s_waitcnt lgkmcnt(7)
v_mfma_f32_16x16x32_bf16 v[64:67], v[112:115], v[124:127], v[64:67]
s_add_u32 m0, s63, 0x800
s_nop 0
buffer_load_dwordx4 v17, s[44:47], s73 offen offset:0 lds
buffer_load_dwordx4 v18, s[44:47], s73 offen offset:1024 lds
v_mfma_f32_16x16x32_bf16 v[68:71], v[112:115], v[128:131], v[68:71]
v_cndmask_b32 v44, v44, v5, vcc
v_cmp_gt_i32 vcc, s6, v6
v_mfma_f32_16x16x32_bf16 v[72:75], v[112:115], v[132:135], v[72:75]
ds_read_b128 v[148:151], v31 offset:6144
s_waitcnt vmcnt(2)
ds_read_b64_tr_b16 v[100:101], v25 offset:0
ds_read_b64_tr_b16 v[102:103], v25 offset:256
s_waitcnt lgkmcnt(7)
v_mfma_f32_16x16x32_bf16 v[52:55], v[116:119], v[136:139], v[52:55]
ds_read_b128 v[152:155], v31 offset:14336
v_and_b32 v5, s90, v48
s_waitcnt lgkmcnt(7)
v_mfma_f32_16x16x32_bf16 v[56:59], v[116:119], v[140:143], v[56:59]
ds_read_b128 v[156:159], v31 offset:22528
v_or_b32 v5, 0x3f80, v5
s_waitcnt lgkmcnt(7)
v_mfma_f32_16x16x32_bf16 v[60:63], v[116:119], v[144:147], v[60:63]
ds_read_b64_tr_b16 v[104:105], v26 offset:0
ds_read_b64_tr_b16 v[106:107], v26 offset:256
s_waitcnt lgkmcnt(7)
v_mfma_f32_16x16x32_bf16 v[64:67], v[120:123], v[136:139], v[64:67]
s_add_u32 m0, s63, 0x1000
s_nop 0
buffer_load_dwordx4 v21, s[48:51], s74 offen offset:0 lds
buffer_load_dwordx4 v22, s[48:51], s74 offen offset:1024 lds
v_mfma_f32_16x16x32_bf16 v[68:71], v[120:123], v[140:143], v[68:71]
s_sub_u32 s6, s6, 2
v_cndmask_b32 v48, v48, v5, vcc
v_mfma_f32_16x16x32_bf16 v[72:75], v[120:123], v[144:147], v[72:75]
ds_read_b128 v[160:163], v32 offset:7168
s_waitcnt vmcnt(2)
ds_read_b64_tr_b16 v[108:109], v25 offset:2048
ds_read_b64_tr_b16 v[110:111], v25 offset:2304
s_waitcnt lgkmcnt(7)
v_mfma_f32_16x16x32_bf16 v[52:55], v[100:103], v[148:151], v[52:55]
ds_read_b128 v[164:167], v32 offset:15360
s_waitcnt lgkmcnt(7)
v_mfma_f32_16x16x32_bf16 v[56:59], v[100:103], v[152:155], v[56:59]
ds_read_b128 v[168:171], v32 offset:23552
s_waitcnt lgkmcnt(7)
v_mfma_f32_16x16x32_bf16 v[60:63], v[100:103], v[156:159], v[60:63]
ds_read_b64_tr_b16 v[112:113], v26 offset:2048
ds_read_b64_tr_b16 v[114:115], v26 offset:2304
s_waitcnt lgkmcnt(7)
v_mfma_f32_16x16x32_bf16 v[64:67], v[104:107], v[148:151], v[64:67]
s_add_u32 m0, s63, 0x0
s_nop 0
buffer_load_dwordx4 v21, s[48:51], s75 offen offset:0 lds
buffer_load_dwordx4 v22, s[48:51], s75 offen offset:1024 lds
v_mfma_f32_16x16x32_bf16 v[68:71], v[104:107], v[152:155], v[68:71]
v_mfma_f32_16x16x32_bf16 v[72:75], v[104:107], v[156:159], v[72:75]
s_waitcnt lgkmcnt(4)
v_mfma_f32_16x16x32_bf16 v[52:55], v[108:111], v[160:163], v[52:55]
s_waitcnt lgkmcnt(3)
v_mfma_f32_16x16x32_bf16 v[56:59], v[108:111], v[164:167], v[56:59]
s_waitcnt lgkmcnt(2)
v_mfma_f32_16x16x32_bf16 v[60:63], v[108:111], v[168:171], v[60:63]
s_waitcnt lgkmcnt(0)
v_mfma_f32_16x16x32_bf16 v[64:67], v[112:115], v[160:163], v[64:67]
s_nop 1
v_cvt_pk_bf16_f32 v52, v52, v53
v_cvt_pk_bf16_f32 v53, v54, v55
ds_write_b64 v33, v[52:53] offset:0
s_add_u32 m0, s63, 0x800
s_nop 0
buffer_load_dwordx4 v21, s[48:51], s76 offen offset:0 lds
buffer_load_dwordx4 v22, s[48:51], s76 offen offset:1024 lds
v_mfma_f32_16x16x32_bf16 v[68:71], v[112:115], v[164:167], v[68:71]
v_cvt_pk_bf16_f32 v56, v56, v57
v_cvt_pk_bf16_f32 v57, v58, v59
ds_write_b64 v33, v[56:57] offset:8192
v_mfma_f32_16x16x32_bf16 v[72:75], v[112:115], v[168:171], v[72:75]
v_cvt_pk_bf16_f32 v60, v60, v61
v_cvt_pk_bf16_f32 v61, v62, v63
ds_write_b64 v33, v[60:61] offset:16384
v_cvt_pk_bf16_f32 v64, v64, v65
v_cvt_pk_bf16_f32 v65, v66, v67
ds_write_b64 v33, v[64:65] offset:512
v_cvt_pk_bf16_f32 v68, v68, v69
v_cvt_pk_bf16_f32 v69, v70, v71
ds_write_b64 v33, v[68:69] offset:8704
v_cvt_pk_bf16_f32 v72, v72, v73
v_cvt_pk_bf16_f32 v73, v74, v75
ds_write_b64 v33, v[72:73] offset:16896
s_waitcnt vmcnt(4)
ds_read_b128 v[116:119], v29 offset:4096
ds_read_b128 v[120:123], v30 offset:4096
s_waitcnt lgkmcnt(2)
s_barrier
ds_read_b128 v[124:127], v35 offset:0
ds_read_b128 v[128:131], v35 offset:8192
ds_read_b128 v[132:135], v35 offset:16384
ds_read_b128 v[136:139], v35 offset:1024
s_waitcnt lgkmcnt(3)
v_mfma_f32_16x16x32_bf16 v[76:79], v[116:119], v[124:127], 0
ds_read_b128 v[140:143], v35 offset:9216
s_waitcnt lgkmcnt(3)
v_mfma_f32_16x16x32_bf16 v[84:87], v[116:119], v[128:131], 0
ds_read_b128 v[144:147], v35 offset:17408
s_waitcnt lgkmcnt(3)
v_mfma_f32_16x16x32_bf16 v[92:95], v[116:119], v[132:135], 0
v_mfma_f32_16x16x32_bf16 v[204:207], v[172:175], v[124:127], 0
v_mfma_f32_16x16x32_bf16 v[208:211], v[172:175], v[128:131], 0
v_mfma_f32_16x16x32_bf16 v[212:215], v[172:175], v[132:135], 0
s_waitcnt vmcnt(2)
ds_read_b128 v[100:103], v29 offset:0
s_waitcnt lgkmcnt(3)
v_mfma_f32_16x16x32_bf16 v[76:79], v[120:123], v[136:139], v[76:79]
s_add_u32 m0, s63, 0x1000
s_nop 0
buffer_load_dwordx4 v21, s[48:51], s77 offen offset:0 lds
buffer_load_dwordx4 v22, s[48:51], s77 offen offset:1024 lds
s_waitcnt lgkmcnt(2)
v_mfma_f32_16x16x32_bf16 v[84:87], v[120:123], v[140:143], v[84:87]
s_waitcnt lgkmcnt(1)
v_mfma_f32_16x16x32_bf16 v[92:95], v[120:123], v[144:147], v[92:95]
ds_read_b128 v[104:107], v30 offset:0
v_mfma_f32_16x16x32_bf16 v[204:207], v[176:179], v[136:139], v[204:207]
v_mfma_f32_16x16x32_bf16 v[208:211], v[176:179], v[140:143], v[208:211]
v_mfma_f32_16x16x32_bf16 v[212:215], v[176:179], v[144:147], v[212:215]
ds_read_b128 v[148:151], v35 offset:2048
s_waitcnt vmcnt(2)
ds_read_b128 v[108:111], v29 offset:2048
s_waitcnt lgkmcnt(3)
v_mfma_f32_16x16x32_bf16 v[80:83], v[100:103], v[124:127], 0
ds_read_b128 v[152:155], v35 offset:10240
v_mfma_f32_16x16x32_bf16 v[88:91], v[100:103], v[128:131], 0
ds_read_b128 v[156:159], v35 offset:18432
v_mfma_f32_16x16x32_bf16 v[96:99], v[100:103], v[132:135], 0
s_waitcnt lgkmcnt(4)
v_mfma_f32_16x16x32_bf16 v[80:83], v[104:107], v[136:139], v[80:83]
s_add_u32 m0, s63, 0x0
s_nop 0
buffer_load_dwordx4 v21, s[48:51], s78 offen offset:0 lds
buffer_load_dwordx4 v22, s[48:51], s78 offen offset:1024 lds
v_mfma_f32_16x16x32_bf16 v[88:91], v[104:107], v[140:143], v[88:91]
v_mfma_f32_16x16x32_bf16 v[96:99], v[104:107], v[144:147], v[96:99]
ds_read_b128 v[160:163], v35 offset:3072
ds_read_b128 v[112:115], v30 offset:2048
s_waitcnt lgkmcnt(4)
v_mfma_f32_16x16x32_bf16 v[76:79], v[108:111], v[148:151], v[76:79]
ds_read_b128 v[164:167], v35 offset:11264
s_waitcnt lgkmcnt(4)
v_mfma_f32_16x16x32_bf16 v[84:87], v[108:111], v[152:155], v[84:87]
ds_read_b128 v[168:171], v35 offset:19456
s_waitcnt lgkmcnt(4)
v_mfma_f32_16x16x32_bf16 v[92:95], v[108:111], v[156:159], v[92:95]
v_mfma_f32_16x16x32_bf16 v[204:207], v[180:183], v[148:151], v[204:207]
v_mfma_f32_16x16x32_bf16 v[208:211], v[180:183], v[152:155], v[208:211]
v_mfma_f32_16x16x32_bf16 v[212:215], v[180:183], v[156:159], v[212:215]
s_waitcnt vmcnt(2)
ds_read_b128 v[116:119], v29 offset:4096
s_waitcnt lgkmcnt(3)
v_mfma_f32_16x16x32_bf16 v[76:79], v[112:115], v[160:163], v[76:79]
s_add_u32 m0, s63, 0x800
s_nop 0
buffer_load_dwordx4 v21, s[48:51], s79 offen offset:0 lds
buffer_load_dwordx4 v22, s[48:51], s79 offen offset:1024 lds
s_waitcnt lgkmcnt(2)
v_mfma_f32_16x16x32_bf16 v[84:87], v[112:115], v[164:167], v[84:87]
s_waitcnt lgkmcnt(1)
v_mfma_f32_16x16x32_bf16 v[92:95], v[112:115], v[168:171], v[92:95]
ds_read_b128 v[120:123], v30 offset:4096
v_mfma_f32_16x16x32_bf16 v[204:207], v[184:187], v[160:163], v[204:207]
v_mfma_f32_16x16x32_bf16 v[208:211], v[184:187], v[164:167], v[208:211]
v_mfma_f32_16x16x32_bf16 v[212:215], v[184:187], v[168:171], v[212:215]
ds_read_b128 v[124:127], v35 offset:4096
s_waitcnt vmcnt(2)
ds_read_b128 v[100:103], v29 offset:0
s_waitcnt lgkmcnt(3)
v_mfma_f32_16x16x32_bf16 v[80:83], v[116:119], v[148:151], v[80:83]
ds_read_b128 v[128:131], v35 offset:12288
v_mfma_f32_16x16x32_bf16 v[88:91], v[116:119], v[152:155], v[88:91]
ds_read_b128 v[132:135], v35 offset:20480
v_mfma_f32_16x16x32_bf16 v[96:99], v[116:119], v[156:159], v[96:99]
s_waitcnt lgkmcnt(4)
v_mfma_f32_16x16x32_bf16 v[80:83], v[120:123], v[160:163], v[80:83]
s_add_u32 m0, s63, 0x1000
s_nop 0
buffer_load_dwordx4 v21, s[48:51], s80 offen offset:0 lds
buffer_load_dwordx4 v22, s[48:51], s80 offen offset:1024 lds
v_mfma_f32_16x16x32_bf16 v[88:91], v[120:123], v[164:167], v[88:91]
v_mfma_f32_16x16x32_bf16 v[96:99], v[120:123], v[168:171], v[96:99]
ds_read_b128 v[136:139], v35 offset:5120
ds_read_b128 v[104:107], v30 offset:0
s_waitcnt lgkmcnt(4)
v_mfma_f32_16x16x32_bf16 v[76:79], v[100:103], v[124:127], v[76:79]
ds_read_b128 v[140:143], v35 offset:13312
s_waitcnt lgkmcnt(4)
v_mfma_f32_16x16x32_bf16 v[84:87], v[100:103], v[128:131], v[84:87]
ds_read_b128 v[144:147], v35 offset:21504
s_waitcnt lgkmcnt(4)
v_mfma_f32_16x16x32_bf16 v[92:95], v[100:103], v[132:135], v[92:95]
v_mfma_f32_16x16x32_bf16 v[204:207], v[188:191], v[124:127], v[204:207]
v_mfma_f32_16x16x32_bf16 v[208:211], v[188:191], v[128:131], v[208:211]
v_mfma_f32_16x16x32_bf16 v[212:215], v[188:191], v[132:135], v[212:215]
s_waitcnt vmcnt(2)
ds_read_b128 v[108:111], v29 offset:2048
s_waitcnt lgkmcnt(3)
v_mfma_f32_16x16x32_bf16 v[76:79], v[104:107], v[136:139], v[76:79]
s_add_u32 m0, s63, 0x0
s_nop 0
buffer_load_dwordx4 v21, s[48:51], s81 offen offset:0 lds
buffer_load_dwordx4 v22, s[48:51], s81 offen offset:1024 lds
s_waitcnt lgkmcnt(2)
v_mfma_f32_16x16x32_bf16 v[84:87], v[104:107], v[140:143], v[84:87]
buffer_store_dwordx4 v[40:43], v16, s[56:59], s64 offen offset:0 sc1
buffer_store_dwordx4 v[44:47], v16, s[56:59], s64 offen offset:1024 sc1
s_waitcnt lgkmcnt(1)
v_mfma_f32_16x16x32_bf16 v[92:95], v[104:107], v[144:147], v[92:95]
ds_read_b128 v[112:115], v30 offset:2048
buffer_store_dwordx4 v[48:51], v16, s[56:59], s64 offen offset:2048 sc1
v_mfma_f32_16x16x32_bf16 v[204:207], v[192:195], v[136:139], v[204:207]
v_mfma_f32_16x16x32_bf16 v[208:211], v[192:195], v[140:143], v[208:211]
v_mfma_f32_16x16x32_bf16 v[212:215], v[192:195], v[144:147], v[212:215]
ds_read_b128 v[148:151], v35 offset:6144
s_waitcnt vmcnt(5)
ds_read_b128 v[116:119], v29 offset:4096
s_waitcnt lgkmcnt(3)
v_mfma_f32_16x16x32_bf16 v[80:83], v[108:111], v[124:127], v[80:83]
ds_read_b128 v[152:155], v35 offset:14336
v_mfma_f32_16x16x32_bf16 v[88:91], v[108:111], v[128:131], v[88:91]
ds_read_b128 v[156:159], v35 offset:22528
v_mfma_f32_16x16x32_bf16 v[96:99], v[108:111], v[132:135], v[96:99]
s_waitcnt lgkmcnt(4)
v_mfma_f32_16x16x32_bf16 v[80:83], v[112:115], v[136:139], v[80:83]
v_mfma_f32_16x16x32_bf16 v[88:91], v[112:115], v[140:143], v[88:91]
v_mfma_f32_16x16x32_bf16 v[96:99], v[112:115], v[144:147], v[96:99]
ds_read_b128 v[160:163], v35 offset:7168
ds_read_b128 v[120:123], v30 offset:4096
s_waitcnt lgkmcnt(4)
v_mfma_f32_16x16x32_bf16 v[76:79], v[116:119], v[148:151], v[76:79]
ds_read_b128 v[164:167], v35 offset:15360
s_waitcnt lgkmcnt(4)
v_mfma_f32_16x16x32_bf16 v[84:87], v[116:119], v[152:155], v[84:87]
ds_read_b128 v[168:171], v35 offset:23552
s_waitcnt lgkmcnt(4)
v_mfma_f32_16x16x32_bf16 v[92:95], v[116:119], v[156:159], v[92:95]
v_mfma_f32_16x16x32_bf16 v[204:207], v[196:199], v[148:151], v[204:207]
v_mfma_f32_16x16x32_bf16 v[208:211], v[196:199], v[152:155], v[208:211]
v_mfma_f32_16x16x32_bf16 v[212:215], v[196:199], v[156:159], v[212:215]
s_waitcnt vmcnt(3)
ds_read_b128 v[100:103], v29 offset:0
s_waitcnt lgkmcnt(3)
v_mfma_f32_16x16x32_bf16 v[76:79], v[120:123], v[160:163], v[76:79]
s_waitcnt lgkmcnt(2)
v_mfma_f32_16x16x32_bf16 v[84:87], v[120:123], v[164:167], v[84:87]
s_waitcnt lgkmcnt(1)
v_mfma_f32_16x16x32_bf16 v[92:95], v[120:123], v[168:171], v[92:95]
ds_read_b128 v[104:107], v30 offset:0
v_mfma_f32_16x16x32_bf16 v[204:207], v[200:203], v[160:163], v[204:207]
v_mfma_f32_16x16x32_bf16 v[208:211], v[200:203], v[164:167], v[208:211]
v_mfma_f32_16x16x32_bf16 v[212:215], v[200:203], v[168:171], v[212:215]
s_waitcnt lgkmcnt(1)
v_mfma_f32_16x16x32_bf16 v[80:83], v[100:103], v[148:151], v[80:83]
s_nop 3
v_mul_f32 v204, -v204, s86
v_mfma_f32_16x16x32_bf16 v[88:91], v[100:103], v[152:155], v[88:91]
v_mul_f32 v208, -v208, s86
v_mfma_f32_16x16x32_bf16 v[96:99], v[100:103], v[156:159], v[96:99]
v_mul_f32 v212, -v212, s86
s_waitcnt lgkmcnt(0)
v_mfma_f32_16x16x32_bf16 v[80:83], v[104:107], v[160:163], v[80:83]
v_mfma_f32_16x16x32_bf16 v[88:91], v[104:107], v[164:167], v[88:91]
v_mfma_f32_16x16x32_bf16 v[96:99], v[104:107], v[168:171], v[96:99]
v_fma_f32 v76, v76, s86, v204
v_fma_f32 v77, v77, s86, v204
v_fma_f32 v78, v78, s86, v204
v_fma_f32 v79, v79, s86, v204
s_nop 1
v_fma_f32 v80, v80, s86, v204
v_fma_f32 v81, v81, s86, v204
v_fma_f32 v82, v82, s86, v204
v_fma_f32 v83, v83, s86, v204
v_cvt_pk_bf16_f32 v76, v76, v77
v_cvt_pk_bf16_f32 v77, v78, v79
v_cvt_pk_bf16_f32 v78, v80, v81
v_cvt_pk_bf16_f32 v79, v82, v83
buffer_store_dwordx4 v[76:79], v16, s[52:55], s82 offen offset:0 sc1
v_fma_f32 v84, v84, s86, v208
v_fma_f32 v85, v85, s86, v208
v_fma_f32 v86, v86, s86, v208
v_fma_f32 v87, v87, s86, v208
v_fma_f32 v88, v88, s86, v208
v_fma_f32 v89, v89, s86, v208
v_fma_f32 v90, v90, s86, v208
v_fma_f32 v91, v91, s86, v208
v_cvt_pk_bf16_f32 v84, v84, v85
v_cvt_pk_bf16_f32 v85, v86, v87
v_cvt_pk_bf16_f32 v86, v88, v89
v_cvt_pk_bf16_f32 v87, v90, v91
buffer_store_dwordx4 v[84:87], v16, s[52:55], s83 offen offset:0 sc1
v_fma_f32 v92, v92, s86, v212
v_fma_f32 v93, v93, s86, v212
v_fma_f32 v94, v94, s86, v212
v_fma_f32 v95, v95, s86, v212
v_fma_f32 v96, v96, s86, v212
v_fma_f32 v97, v97, s86, v212
v_fma_f32 v98, v98, s86, v212
v_fma_f32 v99, v99, s86, v212
v_cvt_pk_bf16_f32 v92, v92, v93
v_cvt_pk_bf16_f32 v93, v94, v95
v_cvt_pk_bf16_f32 v94, v96, v97
v_cvt_pk_bf16_f32 v95, v98, v99
buffer_store_dwordx4 v[92:95], v16, s[52:55], s84 offen offset:0 sc1
s_branch L1_fin
L1_notq:
s_sub_u32 s4, s2, 32
s_cmp_lt_u32 s2, 32
s_cbranch_scc1 L1_edge
s_mov_b32 s61, 1
v_lshlrev_b32 v16, 4, v2
s_mul_i32 s63, s60, 6144
s_and_b32 s6, s4, 3
s_lshl_b32 s6, s6, 6
s_mul_i32 s7, s60, 8
s_add_u32 s6, s6, s7
v_lshrrev_b32 v5, 5, v2
v_and_b32 v6, 31, v2
v_lshlrev_b32 v6, 4, v6
v_mov_b32 v176, v6
s_cmp_ge_u32 s4, 4
s_cselect_b64 vcc, -1, 0
v_add3_u32 v7, v5, s6, 0
v_and_b32 v8, 0x80, v7
v_bfe_u32 v9, v7, 2, 1
v_lshl_or_b32 v8, v9, 6, v8
v_bfe_u32 v9, v7, 4, 1
v_lshl_or_b32 v8, v9, 5, v8
v_and_b32 v9, 3, v7
v_lshl_or_b32 v8, v9, 3, v8
v_bfe_u32 v9, v7, 5, 2
v_lshl_or_b32 v8, v9, 1, v8
v_bfe_u32 v9, v7, 3, 1
v_or_b32 v8, v9, v8
v_cndmask_b32 v8, v8, v7, vcc
v_lshl_add_u32 v40, v8, 9, v6
v_add3_u32 v7, v5, s6, 2
v_and_b32 v8, 0x80, v7
v_bfe_u32 v9, v7, 2, 1
v_lshl_or_b32 v8, v9, 6, v8
v_bfe_u32 v9, v7, 4, 1
v_lshl_or_b32 v8, v9, 5, v8
v_and_b32 v9, 3, v7
v_lshl_or_b32 v8, v9, 3, v8
v_bfe_u32 v9, v7, 5, 2
v_lshl_or_b32 v8, v9, 1, v8
v_bfe_u32 v9, v7, 3, 1
v_or_b32 v8, v9, v8
v_cndmask_b32 v8, v8, v7, vcc
v_lshl_add_u32 v44, v8, 9, v6
v_add3_u32 v7, v5, s6, 4
v_and_b32 v8, 0x80, v7
v_bfe_u32 v9, v7, 2, 1
v_lshl_or_b32 v8, v9, 6, v8
v_bfe_u32 v9, v7, 4, 1
v_lshl_or_b32 v8, v9, 5, v8
v_and_b32 v9, 3, v7
v_lshl_or_b32 v8, v9, 3, v8
v_bfe_u32 v9, v7, 5, 2
v_lshl_or_b32 v8, v9, 1, v8
v_bfe_u32 v9, v7, 3, 1
v_or_b32 v8, v9, v8
v_cndmask_b32 v8, v8, v7, vcc
v_lshl_add_u32 v48, v8, 9, v6
v_add3_u32 v7, v5, s6, 6
v_and_b32 v8, 0x80, v7
v_bfe_u32 v9, v7, 2, 1
v_lshl_or_b32 v8, v9, 6, v8
v_bfe_u32 v9, v7, 4, 1
v_lshl_or_b32 v8, v9, 5, v8
v_and_b32 v9, 3, v7
v_lshl_or_b32 v8, v9, 3, v8
v_bfe_u32 v9, v7, 5, 2
v_lshl_or_b32 v8, v9, 1, v8
v_bfe_u32 v9, v7, 3, 1
v_or_b32 v8, v9, v8
v_cndmask_b32 v8, v8, v7, vcc
v_lshl_add_u32 v52, v8, 9, v6
s_lshl_b32 s7, s60, 6
v_lshrrev_b32 v5, 2, v2
v_and_b32 v6, 3, v2
v_lshrrev_b32 v7, 5, v2
v_lshlrev_b32 v7, 1, v7
v_xor_b32 v6, v6, v7
v_lshl_add_u32 v5, v5, 9, s7
v_lshl_add_u32 v17, v6, 4, v5
v_add_u32 v18, 0x1c00, v17
s_xor_b32 s6, s62, 0
s_lshl_b32 s66, s6, 14
s_xor_b32 s6, s62, 1
s_lshl_b32 s67, s6, 14
s_xor_b32 s6, s62, 2
s_lshl_b32 s68, s6, 14
s_xor_b32 s6, s62, 3
s_lshl_b32 s69, s6, 14
s_xor_b32 s6, s62, 4
s_lshl_b32 s70, s6, 14
s_xor_b32 s6, s62, 5
s_lshl_b32 s71, s6, 14
s_xor_b32 s6, s62, 6
s_lshl_b32 s72, s6, 14
s_xor_b32 s6, s62, 7
s_lshl_b32 s73, s6, 14
s_waitcnt lgkmcnt(0)
s_cmp_ge_u32 s4, 4
s_cselect_b32 s6, s30, s24
s_cselect_b32 s7, s31, s25
s_add_u32 s40, s6, 0x0
s_addc_u32 s41, s7, 0
s_mov_b32 s42, 0x20000
s_mov_b32 s43, 0x00020000
s_add_u32 s44, s32, 0x0
s_addc_u32 s45, s33, 0
s_mov_b32 s46, 0x20000
s_mov_b32 s47, 0x00020000
buffer_load_dwordx4 v[40:43], v40, s[40:43], 0 offen
buffer_load_dwordx4 v[44:47], v44, s[40:43], 0 offen
buffer_load_dwordx4 v[48:51], v48, s[40:43], 0 offen
buffer_load_dwordx4 v[52:55], v52, s[40:43], 0 offen
buffer_load_dwordx4 v[176:179], v176, s[40:43], 0 offen
s_add_u32 m0, s63, 0x0
s_nop 0
buffer_load_dwordx4 v17, s[44:47], s66 offen offset:0 lds
buffer_load_dwordx4 v18, s[44:47], s66 offen offset:1024 lds
s_add_u32 m0, s63, 0x800
s_nop 0
buffer_load_dwordx4 v17, s[44:47], s67 offen offset:0 lds
buffer_load_dwordx4 v18, s[44:47], s67 offen offset:1024 lds
v_bfe_u32 v5, v2, 2, 3
v_xor_b32 v5, s62, v5
v_and_b32 v6, 3, v2
v_lshlrev_b32 v7, 10, v5
v_lshl_add_u32 v7, v6, 8, v7
v_add_u32 v7, 0xc000, v7
v_and_b32 v5, 1, v5
v_lshl_or_b32 v6, v5, 2, v6
v_lshrrev_b32 v5, 5, v2
s_mul_i32 s6, s60, 8
v_add3_u32 v8, v5, s6, 0
v_lshrrev_b32 v9, 4, v8
v_lshl_add_u32 v9, v9, 13, v7
v_and_b32 v8, 15, v8
v_xor_b32 v8, v8, v6
v_lshl_add_u32 v36, v8, 4, v9
v_add3_u32 v8, v5, s6, 2
v_lshrrev_b32 v9, 4, v8
v_lshl_add_u32 v9, v9, 13, v7
v_and_b32 v8, 15, v8
v_xor_b32 v8, v8, v6
v_lshl_add_u32 v37, v8, 4, v9
v_add3_u32 v8, v5, s6, 4
v_lshrrev_b32 v9, 4, v8
v_lshl_add_u32 v9, v9, 13, v7
v_and_b32 v8, 15, v8
v_xor_b32 v8, v8, v6
v_lshl_add_u32 v38, v8, 4, v9
v_add3_u32 v8, v5, s6, 6
v_lshrrev_b32 v9, 4, v8
v_lshl_add_u32 v9, v9, 13, v7
v_and_b32 v8, 15, v8
v_xor_b32 v8, v8, v6
v_lshl_add_u32 v39, v8, 4, v9
v_xor_b32 v5, v3, v4
v_lshlrev_b32 v5, 4, v5
v_lshl_add_u32 v5, v4, 8, v5
v_add_u32 v31, 0xc000, v5
v_xor_b32 v32, 64, v31
v_lshrrev_b32 v5, 2, v3
v_and_b32 v6, 3, v3
v_and_b32 v7, 1, v4
v_lshlrev_b32 v7, 1, v7
v_lshl_add_u32 v8, v4, 3, v5
v_lshlrev_b32 v8, 6, v8
v_add_u32 v8, s63, v8
v_xor_b32 v6, v6, v7
v_xor_b32 v9, 0, v6
v_lshl_add_u32 v25, v9, 4, v8
v_add_u32 v26, 8, v25
s_lshr_b32 s6, s4, 2
s_lshl_b32 s6, s6, 17
s_and_b32 s7, s4, 3
s_lshl_b32 s7, s7, 12
s_add_u32 s6, s6, s7
s_mul_i32 s7, s60, 16384
s_add_u32 s82, s6, s7
s_add_u32 s83, s82, 16384
s_add_u32 s52, s38, 0x1000000
s_addc_u32 s53, s39, 0
s_mov_b32 s54, 0x40000
s_mov_b32 s55, 0x00020000
s_mov_b32 s90, 0xffff0000
s_waitcnt vmcnt(4)
v_lshlrev_b32 v180, 16, v176
v_and_b32 v181, s90, v176
v_lshlrev_b32 v182, 16, v177
v_and_b32 v183, s90, v177
v_lshlrev_b32 v184, 16, v178
v_and_b32 v185, s90, v178
v_lshlrev_b32 v186, 16, v179
v_and_b32 v187, s90, v179
v_lshlrev_b32 v176, 16, v40
v_and_b32 v177, s90, v40
v_sub_f32 v176, v176, v180
v_sub_f32 v177, v177, v181
v_cvt_pk_bf16_f32 v40, v176, v177
v_lshlrev_b32 v176, 16, v41
v_and_b32 v177, s90, v41
v_sub_f32 v176, v176, v182
v_sub_f32 v177, v177, v183
v_cvt_pk_bf16_f32 v41, v176, v177
v_lshlrev_b32 v176, 16, v42
v_and_b32 v177, s90, v42
v_sub_f32 v176, v176, v184
v_sub_f32 v177, v177, v185
v_cvt_pk_bf16_f32 v42, v176, v177
v_lshlrev_b32 v176, 16, v43
v_and_b32 v177, s90, v43
v_sub_f32 v176, v176, v186
v_sub_f32 v177, v177, v187
v_cvt_pk_bf16_f32 v43, v176, v177
v_lshlrev_b32 v176, 16, v44
v_and_b32 v177, s90, v44
v_sub_f32 v176, v176, v180
v_sub_f32 v177, v177, v181
v_cvt_pk_bf16_f32 v44, v176, v177
v_lshlrev_b32 v176, 16, v45
v_and_b32 v177, s90, v45
v_sub_f32 v176, v176, v182
v_sub_f32 v177, v177, v183
v_cvt_pk_bf16_f32 v45, v176, v177
v_lshlrev_b32 v176, 16, v46
v_and_b32 v177, s90, v46
v_sub_f32 v176, v176, v184
v_sub_f32 v177, v177, v185
v_cvt_pk_bf16_f32 v46, v176, v177
v_lshlrev_b32 v176, 16, v47
v_and_b32 v177, s90, v47
v_sub_f32 v176, v176, v186
v_sub_f32 v177, v177, v187
v_cvt_pk_bf16_f32 v47, v176, v177
v_lshlrev_b32 v176, 16, v48
v_and_b32 v177, s90, v48
v_sub_f32 v176, v176, v180
v_sub_f32 v177, v177, v181
v_cvt_pk_bf16_f32 v48, v176, v177
v_lshlrev_b32 v176, 16, v49
v_and_b32 v177, s90, v49
v_sub_f32 v176, v176, v182
v_sub_f32 v177, v177, v183
v_cvt_pk_bf16_f32 v49, v176, v177
v_lshlrev_b32 v176, 16, v50
v_and_b32 v177, s90, v50
v_sub_f32 v176, v176, v184
v_sub_f32 v177, v177, v185
v_cvt_pk_bf16_f32 v50, v176, v177
v_lshlrev_b32 v176, 16, v51
v_and_b32 v177, s90, v51
v_sub_f32 v176, v176, v186
v_sub_f32 v177, v177, v187
v_cvt_pk_bf16_f32 v51, v176, v177
v_lshlrev_b32 v176, 16, v52
v_and_b32 v177, s90, v52
v_sub_f32 v176, v176, v180
v_sub_f32 v177, v177, v181
v_cvt_pk_bf16_f32 v52, v176, v177
v_lshlrev_b32 v176, 16, v53
v_and_b32 v177, s90, v53
v_sub_f32 v176, v176, v182
v_sub_f32 v177, v177, v183
v_cvt_pk_bf16_f32 v53, v176, v177
v_lshlrev_b32 v176, 16, v54
v_and_b32 v177, s90, v54
v_sub_f32 v176, v176, v184
v_sub_f32 v177, v177, v185
v_cvt_pk_bf16_f32 v54, v176, v177
v_lshlrev_b32 v176, 16, v55
v_and_b32 v177, s90, v55
v_sub_f32 v176, v176, v186
v_sub_f32 v177, v177, v187
v_cvt_pk_bf16_f32 v55, v176, v177
ds_write_b128 v36, v[40:43]
ds_write_b128 v37, v[44:47]
ds_write_b128 v38, v[48:51]
ds_write_b128 v39, v[52:55]
s_add_u32 m0, s63, 0x1000
s_nop 0
buffer_load_dwordx4 v17, s[44:47], s68 offen offset:0 lds
buffer_load_dwordx4 v18, s[44:47], s68 offen offset:1024 lds
s_waitcnt vmcnt(4)
ds_read_b64_tr_b16 v[88:89], v25 offset:0
ds_read_b64_tr_b16 v[90:91], v25 offset:256
ds_read_b64_tr_b16 v[92:93], v26 offset:0
ds_read_b64_tr_b16 v[94:95], v26 offset:256
s_waitcnt lgkmcnt(4)
s_barrier
ds_read_b128 v[112:115], v31 offset:0
ds_read_b128 v[116:119], v31 offset:8192
ds_read_b128 v[120:123], v31 offset:16384
ds_read_b128 v[124:127], v31 offset:24576
ds_read_b128 v[128:131], v32 offset:1024
s_waitcnt vmcnt(2)
ds_read_b64_tr_b16 v[96:97], v25 offset:2048
ds_read_b64_tr_b16 v[98:99], v25 offset:2304
s_waitcnt lgkmcnt(6)
v_mfma_f32_16x16x32_bf16 v[56:59], v[112:115], v[88:91], 0
ds_read_b128 v[132:135], v32 offset:9216
s_waitcnt lgkmcnt(6)
v_mfma_f32_16x16x32_bf16 v[60:63], v[116:119], v[88:91], 0
ds_read_b128 v[136:139], v32 offset:17408
s_waitcnt lgkmcnt(6)
v_mfma_f32_16x16x32_bf16 v[64:67], v[120:123], v[88:91], 0
ds_read_b128 v[140:143], v32 offset:25600
s_waitcnt lgkmcnt(6)
v_mfma_f32_16x16x32_bf16 v[68:71], v[124:127], v[88:91], 0
ds_read_b64_tr_b16 v[100:101], v26 offset:2048
ds_read_b64_tr_b16 v[102:103], v26 offset:2304
v_mfma_f32_16x16x32_bf16 v[72:75], v[112:115], v[92:95], 0
s_add_u32 m0, s63, 0x0
s_nop 0
buffer_load_dwordx4 v17, s[44:47], s69 offen offset:0 lds
buffer_load_dwordx4 v18, s[44:47], s69 offen offset:1024 lds
v_mfma_f32_16x16x32_bf16 v[76:79], v[116:119], v[92:95], 0
v_mfma_f32_16x16x32_bf16 v[80:83], v[120:123], v[92:95], 0
v_mfma_f32_16x16x32_bf16 v[84:87], v[124:127], v[92:95], 0
ds_read_b128 v[144:147], v31 offset:2048
s_waitcnt vmcnt(2)
ds_read_b64_tr_b16 v[104:105], v25 offset:4096
ds_read_b64_tr_b16 v[106:107], v25 offset:4352
s_waitcnt lgkmcnt(8)
v_mfma_f32_16x16x32_bf16 v[56:59], v[128:131], v[96:99], v[56:59]
ds_read_b128 v[148:151], v31 offset:10240
s_waitcnt lgkmcnt(8)
v_mfma_f32_16x16x32_bf16 v[60:63], v[132:135], v[96:99], v[60:63]
ds_read_b128 v[152:155], v31 offset:18432
s_waitcnt lgkmcnt(8)
v_mfma_f32_16x16x32_bf16 v[64:67], v[136:139], v[96:99], v[64:67]
ds_read_b128 v[156:159], v31 offset:26624
s_waitcnt lgkmcnt(8)
v_mfma_f32_16x16x32_bf16 v[68:71], v[140:143], v[96:99], v[68:71]
ds_read_b64_tr_b16 v[108:109], v26 offset:4096
ds_read_b64_tr_b16 v[110:111], v26 offset:4352
s_waitcnt lgkmcnt(8)
v_mfma_f32_16x16x32_bf16 v[72:75], v[128:131], v[100:103], v[72:75]
s_add_u32 m0, s63, 0x800
s_nop 0
buffer_load_dwordx4 v17, s[44:47], s70 offen offset:0 lds
buffer_load_dwordx4 v18, s[44:47], s70 offen offset:1024 lds
v_mfma_f32_16x16x32_bf16 v[76:79], v[132:135], v[100:103], v[76:79]
v_mfma_f32_16x16x32_bf16 v[80:83], v[136:139], v[100:103], v[80:83]
v_mfma_f32_16x16x32_bf16 v[84:87], v[140:143], v[100:103], v[84:87]
ds_read_b128 v[160:163], v32 offset:3072
s_waitcnt vmcnt(2)
ds_read_b64_tr_b16 v[88:89], v25 offset:0
ds_read_b64_tr_b16 v[90:91], v25 offset:256
s_waitcnt lgkmcnt(8)
v_mfma_f32_16x16x32_bf16 v[56:59], v[144:147], v[104:107], v[56:59]
ds_read_b128 v[164:167], v32 offset:11264
s_waitcnt lgkmcnt(8)
v_mfma_f32_16x16x32_bf16 v[60:63], v[148:151], v[104:107], v[60:63]
ds_read_b128 v[168:171], v32 offset:19456
s_waitcnt lgkmcnt(8)
v_mfma_f32_16x16x32_bf16 v[64:67], v[152:155], v[104:107], v[64:67]
ds_read_b128 v[172:175], v32 offset:27648
s_waitcnt lgkmcnt(8)
v_mfma_f32_16x16x32_bf16 v[68:71], v[156:159], v[104:107], v[68:71]
ds_read_b64_tr_b16 v[92:93], v26 offset:0
ds_read_b64_tr_b16 v[94:95], v26 offset:256
s_waitcnt lgkmcnt(8)
v_mfma_f32_16x16x32_bf16 v[72:75], v[144:147], v[108:111], v[72:75]
s_add_u32 m0, s63, 0x1000
s_nop 0
buffer_load_dwordx4 v17, s[44:47], s71 offen offset:0 lds
buffer_load_dwordx4 v18, s[44:47], s71 offen offset:1024 lds
v_mfma_f32_16x16x32_bf16 v[76:79], v[148:151], v[108:111], v[76:79]
v_mfma_f32_16x16x32_bf16 v[80:83], v[152:155], v[108:111], v[80:83]
v_mfma_f32_16x16x32_bf16 v[84:87], v[156:159], v[108:111], v[84:87]
ds_read_b128 v[112:115], v31 offset:4096
s_waitcnt vmcnt(2)
ds_read_b64_tr_b16 v[96:97], v25 offset:2048
ds_read_b64_tr_b16 v[98:99], v25 offset:2304
s_waitcnt lgkmcnt(8)
v_mfma_f32_16x16x32_bf16 v[56:59], v[160:163], v[88:91], v[56:59]
ds_read_b128 v[116:119], v31 offset:12288
s_waitcnt lgkmcnt(8)
v_mfma_f32_16x16x32_bf16 v[60:63], v[164:167], v[88:91], v[60:63]
ds_read_b128 v[120:123], v31 offset:20480
s_waitcnt lgkmcnt(8)
v_mfma_f32_16x16x32_bf16 v[64:67], v[168:171], v[88:91], v[64:67]
ds_read_b128 v[124:127], v31 offset:28672
s_waitcnt lgkmcnt(8)
v_mfma_f32_16x16x32_bf16 v[68:71], v[172:175], v[88:91], v[68:71]
ds_read_b64_tr_b16 v[100:101], v26 offset:2048
ds_read_b64_tr_b16 v[102:103], v26 offset:2304
s_waitcnt lgkmcnt(8)
v_mfma_f32_16x16x32_bf16 v[72:75], v[160:163], v[92:95], v[72:75]
s_add_u32 m0, s63, 0x0
s_nop 0
buffer_load_dwordx4 v17, s[44:47], s72 offen offset:0 lds
buffer_load_dwordx4 v18, s[44:47], s72 offen offset:1024 lds
v_mfma_f32_16x16x32_bf16 v[76:79], v[164:167], v[92:95], v[76:79]
v_mfma_f32_16x16x32_bf16 v[80:83], v[168:171], v[92:95], v[80:83]
v_mfma_f32_16x16x32_bf16 v[84:87], v[172:175], v[92:95], v[84:87]
ds_read_b128 v[128:131], v32 offset:5120
s_waitcnt vmcnt(2)
ds_read_b64_tr_b16 v[104:105], v25 offset:4096
ds_read_b64_tr_b16 v[106:107], v25 offset:4352
s_waitcnt lgkmcnt(8)
v_mfma_f32_16x16x32_bf16 v[56:59], v[112:115], v[96:99], v[56:59]
ds_read_b128 v[132:135], v32 offset:13312
s_waitcnt lgkmcnt(8)
v_mfma_f32_16x16x32_bf16 v[60:63], v[116:119], v[96:99], v[60:63]
ds_read_b128 v[136:139], v32 offset:21504
s_waitcnt lgkmcnt(8)
v_mfma_f32_16x16x32_bf16 v[64:67], v[120:123], v[96:99], v[64:67]
ds_read_b128 v[140:143], v32 offset:29696
s_waitcnt lgkmcnt(8)
v_mfma_f32_16x16x32_bf16 v[68:71], v[124:127], v[96:99], v[68:71]
ds_read_b64_tr_b16 v[108:109], v26 offset:4096
ds_read_b64_tr_b16 v[110:111], v26 offset:4352
s_waitcnt lgkmcnt(8)
v_mfma_f32_16x16x32_bf16 v[72:75], v[112:115], v[100:103], v[72:75]
s_add_u32 m0, s63, 0x800
s_nop 0
buffer_load_dwordx4 v17, s[44:47], s73 offen offset:0 lds
buffer_load_dwordx4 v18, s[44:47], s73 offen offset:1024 lds
v_mfma_f32_16x16x32_bf16 v[76:79], v[116:119], v[100:103], v[76:79]
v_mfma_f32_16x16x32_bf16 v[80:83], v[120:123], v[100:103], v[80:83]
v_mfma_f32_16x16x32_bf16 v[84:87], v[124:127], v[100:103], v[84:87]
ds_read_b128 v[144:147], v31 offset:6144
s_waitcnt vmcnt(2)
ds_read_b64_tr_b16 v[88:89], v25 offset:0
ds_read_b64_tr_b16 v[90:91], v25 offset:256
s_waitcnt lgkmcnt(8)
v_mfma_f32_16x16x32_bf16 v[56:59], v[128:131], v[104:107], v[56:59]
ds_read_b128 v[148:151], v31 offset:14336
s_waitcnt lgkmcnt(8)
v_mfma_f32_16x16x32_bf16 v[60:63], v[132:135], v[104:107], v[60:63]
ds_read_b128 v[152:155], v31 offset:22528
s_waitcnt lgkmcnt(8)
v_mfma_f32_16x16x32_bf16 v[64:67], v[136:139], v[104:107], v[64:67]
ds_read_b128 v[156:159], v31 offset:30720
s_waitcnt lgkmcnt(8)
v_mfma_f32_16x16x32_bf16 v[68:71], v[140:143], v[104:107], v[68:71]
ds_read_b64_tr_b16 v[92:93], v26 offset:0
ds_read_b64_tr_b16 v[94:95], v26 offset:256
s_waitcnt lgkmcnt(8)
v_mfma_f32_16x16x32_bf16 v[72:75], v[128:131], v[108:111], v[72:75]
v_mfma_f32_16x16x32_bf16 v[76:79], v[132:135], v[108:111], v[76:79]
v_mfma_f32_16x16x32_bf16 v[80:83], v[136:139], v[108:111], v[80:83]
v_mfma_f32_16x16x32_bf16 v[84:87], v[140:143], v[108:111], v[84:87]
ds_read_b128 v[160:163], v32 offset:7168
s_waitcnt vmcnt(0)
ds_read_b64_tr_b16 v[96:97], v25 offset:2048
ds_read_b64_tr_b16 v[98:99], v25 offset:2304
s_waitcnt lgkmcnt(8)
v_mfma_f32_16x16x32_bf16 v[56:59], v[144:147], v[88:91], v[56:59]
ds_read_b128 v[164:167], v32 offset:15360
s_waitcnt lgkmcnt(8)
v_mfma_f32_16x16x32_bf16 v[60:63], v[148:151], v[88:91], v[60:63]
ds_read_b128 v[168:171], v32 offset:23552
s_waitcnt lgkmcnt(8)
v_mfma_f32_16x16x32_bf16 v[64:67], v[152:155], v[88:91], v[64:67]
ds_read_b128 v[172:175], v32 offset:31744
s_waitcnt lgkmcnt(8)
v_mfma_f32_16x16x32_bf16 v[68:71], v[156:159], v[88:91], v[68:71]
ds_read_b64_tr_b16 v[100:101], v26 offset:2048
ds_read_b64_tr_b16 v[102:103], v26 offset:2304
s_waitcnt lgkmcnt(8)
v_mfma_f32_16x16x32_bf16 v[72:75], v[144:147], v[92:95], v[72:75]
v_mfma_f32_16x16x32_bf16 v[76:79], v[148:151], v[92:95], v[76:79]
v_mfma_f32_16x16x32_bf16 v[80:83], v[152:155], v[92:95], v[80:83]
v_mfma_f32_16x16x32_bf16 v[84:87], v[156:159], v[92:95], v[84:87]
s_waitcnt lgkmcnt(5)
v_mfma_f32_16x16x32_bf16 v[56:59], v[160:163], v[96:99], v[56:59]
s_waitcnt lgkmcnt(4)
v_mfma_f32_16x16x32_bf16 v[60:63], v[164:167], v[96:99], v[60:63]
s_waitcnt lgkmcnt(3)
v_mfma_f32_16x16x32_bf16 v[64:67], v[168:171], v[96:99], v[64:67]
s_waitcnt lgkmcnt(2)
v_mfma_f32_16x16x32_bf16 v[68:71], v[172:175], v[96:99], v[68:71]
s_waitcnt lgkmcnt(0)
v_mfma_f32_16x16x32_bf16 v[72:75], v[160:163], v[100:103], v[72:75]
v_cvt_pk_bf16_f32 v56, v56, v57
v_cvt_pk_bf16_f32 v57, v58, v59
v_cvt_pk_bf16_f32 v58, v60, v61
v_cvt_pk_bf16_f32 v59, v62, v63
buffer_store_dwordx4 v[56:59], v16, s[52:55], s82 offen offset:0 sc1
v_mfma_f32_16x16x32_bf16 v[76:79], v[164:167], v[100:103], v[76:79]
v_mfma_f32_16x16x32_bf16 v[80:83], v[168:171], v[100:103], v[80:83]
v_cvt_pk_bf16_f32 v64, v64, v65
v_cvt_pk_bf16_f32 v65, v66, v67
v_cvt_pk_bf16_f32 v66, v68, v69
v_cvt_pk_bf16_f32 v67, v70, v71
buffer_store_dwordx4 v[64:67], v16, s[52:55], s82 offen offset:2048 sc1
v_mfma_f32_16x16x32_bf16 v[84:87], v[172:175], v[100:103], v[84:87]
v_cvt_pk_bf16_f32 v72, v72, v73
v_cvt_pk_bf16_f32 v73, v74, v75
v_cvt_pk_bf16_f32 v74, v76, v77
v_cvt_pk_bf16_f32 v75, v78, v79
buffer_store_dwordx4 v[72:75], v16, s[52:55], s82 offen offset:1024 sc1
v_cvt_pk_bf16_f32 v80, v80, v81
v_cvt_pk_bf16_f32 v81, v82, v83
s_nop 0
v_cvt_pk_bf16_f32 v82, v84, v85
v_cvt_pk_bf16_f32 v83, v86, v87
buffer_store_dwordx4 v[80:83], v16, s[52:55], s82 offen offset:3072 sc1
s_branch L1_fin
L1_edge:
s_mov_b32 s61, 4
s_mov_b32 s4, s2
s_mul_i32 s6, s4, 20000
v_lshlrev_b32 v5, 4, v0
v_lshlrev_b32 v6, 2, v2
v_add_u32 v6, 0x10000, v6
v_mov_b32 v7, 0
ds_write_b32 v6, v7
s_mov_b32 s66, 0
s_mov_b32 s67, 8192
s_mov_b32 s68, 16384
s_waitcnt lgkmcnt(0)
s_add_u32 s56, s38, 0x7c00000
s_addc_u32 s57, s39, 0
s_mov_b32 s58, 0x2000
s_mov_b32 s59, 0x00020000
s_cmp_eq_u32 s4, 0
s_cselect_b32 s9, 0, 0x7fff0000
v_mov_b32 v8, 0
v_mov_b32 v9, 0
v_mov_b32 v10, 0
v_mov_b32 v11, 0
buffer_store_dwordx4 v[8:11], v5, s[56:59], s9 offen
s_add_u32 s40, s20, 0x0
s_addc_u32 s41, s21, 0
s_add_u32 s40, s40, s6
s_addc_u32 s41, s41, 0
s_mov_b32 s42, 0x4e20
s_mov_b32 s43, 0x00020000
s_add_u32 s44, s18, 0x0
s_addc_u32 s45, s19, 0
s_add_u32 s44, s44, s6
s_addc_u32 s45, s45, 0
s_mov_b32 s46, 0x4e20
s_mov_b32 s47, 0x00020000
buffer_load_dwordx4 v[16:19], v5, s[40:43], s66 offen
buffer_load_dwordx4 v[20:23], v5, s[40:43], s67 offen
buffer_load_dwordx4 v[24:27], v5, s[40:43], s68 offen
buffer_load_dwordx4 v[28:31], v5, s[44:47], s66 offen
buffer_load_dwordx4 v[32:35], v5, s[44:47], s67 offen
buffer_load_dwordx4 v[36:39], v5, s[44:47], s68 offen
s_add_u32 s48, s38, 0x8000000
s_addc_u32 s49, s39, 0
s_mov_b32 s50, 0x2800000
s_mov_b32 s51, 0x00020000
s_add_u32 s52, s38, 0x7800000
s_addc_u32 s53, s39, 0
s_mov_b32 s54, 0x2000
s_mov_b32 s55, 0x00020000
s_mov_b32 s9, 6279
s_mov_b32 s10, 4294967129
s_mov_b32 s11, 0x10000
v_mov_b32 v7, 1
v_cmp_gt_u32 vcc, 0xe2, v0
s_mov_b64 s[12:13], vcc
s_barrier
s_waitcnt vmcnt(5)
v_mul_u32_u24 v40, s9, v16
v_lshrrev_b32 v40, 20, v40
v_lshl_add_u32 v52, v40, 2, s11
ds_add_rtn_u32 v52, v52, v7
v_mad_i32_i24 v16, v40, s10, v16
v_mul_u32_u24 v41, s9, v17
v_lshrrev_b32 v41, 20, v41
v_lshl_add_u32 v53, v41, 2, s11
ds_add_rtn_u32 v53, v53, v7
v_mad_i32_i24 v17, v41, s10, v17
v_mul_u32_u24 v42, s9, v18
v_lshrrev_b32 v42, 20, v42
v_lshl_add_u32 v54, v42, 2, s11
ds_add_rtn_u32 v54, v54, v7
v_mad_i32_i24 v18, v42, s10, v18
v_mul_u32_u24 v43, s9, v19
v_lshrrev_b32 v43, 20, v43
v_lshl_add_u32 v55, v43, 2, s11
ds_add_rtn_u32 v55, v55, v7
v_mad_i32_i24 v19, v43, s10, v19
s_waitcnt vmcnt(4)
v_mul_u32_u24 v44, s9, v20
v_lshrrev_b32 v44, 20, v44
v_lshl_add_u32 v56, v44, 2, s11
ds_add_rtn_u32 v56, v56, v7
v_mad_i32_i24 v20, v44, s10, v20
v_mul_u32_u24 v45, s9, v21
v_lshrrev_b32 v45, 20, v45
v_lshl_add_u32 v57, v45, 2, s11
ds_add_rtn_u32 v57, v57, v7
v_mad_i32_i24 v21, v45, s10, v21
v_mul_u32_u24 v46, s9, v22
v_lshrrev_b32 v46, 20, v46
v_lshl_add_u32 v58, v46, 2, s11
ds_add_rtn_u32 v58, v58, v7
v_mad_i32_i24 v22, v46, s10, v22
v_mul_u32_u24 v47, s9, v23
v_lshrrev_b32 v47, 20, v47
v_lshl_add_u32 v59, v47, 2, s11
ds_add_rtn_u32 v59, v59, v7
v_mad_i32_i24 v23, v47, s10, v23
s_waitcnt vmcnt(3)
s_mov_b64 exec, s[12:13]
v_mul_u32_u24 v48, s9, v24
v_lshrrev_b32 v48, 20, v48
v_lshl_add_u32 v60, v48, 2, s11
ds_add_rtn_u32 v60, v60, v7
v_mad_i32_i24 v24, v48, s10, v24
v_mul_u32_u24 v49, s9, v25
v_lshrrev_b32 v49, 20, v49
v_lshl_add_u32 v61, v49, 2, s11
ds_add_rtn_u32 v61, v61, v7
v_mad_i32_i24 v25, v49, s10, v25
v_mul_u32_u24 v50, s9, v26
v_lshrrev_b32 v50, 20, v50
v_lshl_add_u32 v62, v50, 2, s11
ds_add_rtn_u32 v62, v62, v7
v_mad_i32_i24 v26, v50, s10, v26
v_mul_u32_u24 v51, s9, v27
v_lshrrev_b32 v51, 20, v51
v_lshl_add_u32 v63, v51, 2, s11
ds_add_rtn_u32 v63, v63, v7
v_mad_i32_i24 v27, v51, s10, v27
s_mov_b64 exec, -1
s_waitcnt vmcnt(2) lgkmcnt(4)
v_and_b32 v8, 0x7f, v52
v_lshl_or_b32 v28, v16, 18, v28
v_lshlrev_b32 v8, 2, v8
v_lshl_add_u32 v8, v40, 9, v8
ds_write_b32 v8, v28
v_and_b32 v8, 0x7f, v53
v_lshl_or_b32 v29, v17, 18, v29
v_lshlrev_b32 v8, 2, v8
v_lshl_add_u32 v8, v41, 9, v8
ds_write_b32 v8, v29
v_and_b32 v8, 0x7f, v54
v_lshl_or_b32 v30, v18, 18, v30
v_lshlrev_b32 v8, 2, v8
v_lshl_add_u32 v8, v42, 9, v8
ds_write_b32 v8, v30
v_and_b32 v8, 0x7f, v55
v_lshl_or_b32 v31, v19, 18, v31
v_lshlrev_b32 v8, 2, v8
v_lshl_add_u32 v8, v43, 9, v8
ds_write_b32 v8, v31
s_waitcnt vmcnt(1) lgkmcnt(4)
v_and_b32 v8, 0x7f, v56
v_lshl_or_b32 v32, v20, 18, v32
v_lshlrev_b32 v8, 2, v8
v_lshl_add_u32 v8, v44, 9, v8
ds_write_b32 v8, v32
v_and_b32 v8, 0x7f, v57
v_lshl_or_b32 v33, v21, 18, v33
v_lshlrev_b32 v8, 2, v8
v_lshl_add_u32 v8, v45, 9, v8
ds_write_b32 v8, v33
v_and_b32 v8, 0x7f, v58
v_lshl_or_b32 v34, v22, 18, v34
v_lshlrev_b32 v8, 2, v8
v_lshl_add_u32 v8, v46, 9, v8
ds_write_b32 v8, v34
v_and_b32 v8, 0x7f, v59
v_lshl_or_b32 v35, v23, 18, v35
v_lshlrev_b32 v8, 2, v8
v_lshl_add_u32 v8, v47, 9, v8
ds_write_b32 v8, v35
s_waitcnt vmcnt(0) lgkmcnt(8)
s_mov_b64 exec, s[12:13]
v_and_b32 v8, 0x7f, v60
v_lshl_or_b32 v36, v24, 18, v36
v_lshlrev_b32 v8, 2, v8
v_lshl_add_u32 v8, v48, 9, v8
ds_write_b32 v8, v36
v_and_b32 v8, 0x7f, v61
v_lshl_or_b32 v37, v25, 18, v37
v_lshlrev_b32 v8, 2, v8
v_lshl_add_u32 v8, v49, 9, v8
ds_write_b32 v8, v37
v_and_b32 v8, 0x7f, v62
v_lshl_or_b32 v38, v26, 18, v38
v_lshlrev_b32 v8, 2, v8
v_lshl_add_u32 v8, v50, 9, v8
ds_write_b32 v8, v38
v_and_b32 v8, 0x7f, v63
v_lshl_or_b32 v39, v27, 18, v39
v_lshlrev_b32 v8, 2, v8
v_lshl_add_u32 v8, v51, 9, v8
ds_write_b32 v8, v39
s_mov_b64 exec, -1
s_waitcnt lgkmcnt(0)
s_barrier
ds_read_b32 v8, v6
s_mul_i32 s6, s60, 4096
v_lshlrev_b32 v10, 4, v2
v_add_u32 v9, s6, v10
ds_read_b128 v[64:67], v9 offset:0
ds_read_b128 v[68:71], v9 offset:1024
ds_read_b128 v[72:75], v9 offset:2048
ds_read_b128 v[76:79], v9 offset:3072
v_lshrrev_b32 v11, 5, v2
v_mul_u32_u24 v11, 0x9fe00, v11
v_add_u32 v10, v10, v11
s_mul_i32 s6, s60, 5242880
s_mul_i32 s7, s4, 20480
s_add_u32 s6, s6, s7
v_lshlrev_b32 v9, 7, v2
s_lshl_b32 s8, s4, 2
s_cmp_eq_u32 s60, 0
s_cselect_b32 s8, s8, 0x7fff0000
s_waitcnt lgkmcnt(4)
buffer_store_dword v8, v9, s[52:55], s8 offen sc1
v_cmp_lt_u32 vcc, 0x80, v8
s_cbranch_vccnz L1_eslow
s_waitcnt lgkmcnt(3)
buffer_store_dwordx4 v[64:67], v10, s[48:51], s6 offen sc1
s_add_u32 s6, s6, 1310720
s_waitcnt lgkmcnt(2)
buffer_store_dwordx4 v[68:71], v10, s[48:51], s6 offen sc1
s_add_u32 s6, s6, 1310720
s_waitcnt lgkmcnt(1)
buffer_store_dwordx4 v[72:75], v10, s[48:51], s6 offen sc1
s_add_u32 s6, s6, 1310720
s_waitcnt lgkmcnt(0)
buffer_store_dwordx4 v[76:79], v10, s[48:51], s6 offen sc1
s_add_u32 s6, s6, 1310720
s_branch L1_fin
L1_eslow:
s_mov_b32 s9, 655360
v_mul_u32_u24 v40, s9, v40
v_lshl_add_u32 v40, v52, 2, v40
v_mul_u32_u24 v41, s9, v41
v_lshl_add_u32 v41, v53, 2, v41
v_mul_u32_u24 v42, s9, v42
v_lshl_add_u32 v42, v54, 2, v42
v_mul_u32_u24 v43, s9, v43
v_lshl_add_u32 v43, v55, 2, v43
v_mul_u32_u24 v44, s9, v44
v_lshl_add_u32 v44, v56, 2, v44
v_mul_u32_u24 v45, s9, v45
v_lshl_add_u32 v45, v57, 2, v45
v_mul_u32_u24 v46, s9, v46
v_lshl_add_u32 v46, v58, 2, v46
v_mul_u32_u24 v47, s9, v47
v_lshl_add_u32 v47, v59, 2, v47
v_mul_u32_u24 v48, s9, v48
v_lshl_add_u32 v48, v60, 2, v48
v_mul_u32_u24 v49, s9, v49
v_lshl_add_u32 v49, v61, 2, v49
v_mul_u32_u24 v50, s9, v50
v_lshl_add_u32 v50, v62, 2, v50
v_mul_u32_u24 v51, s9, v51
v_lshl_add_u32 v51, v63, 2, v51
buffer_store_dword v28, v40, s[48:51], s7 offen
buffer_store_dword v29, v41, s[48:51], s7 offen
buffer_store_dword v30, v42, s[48:51], s7 offen
buffer_store_dword v31, v43, s[48:51], s7 offen
buffer_store_dword v32, v44, s[48:51], s7 offen
buffer_store_dword v33, v45, s[48:51], s7 offen
buffer_store_dword v34, v46, s[48:51], s7 offen
buffer_store_dword v35, v47, s[48:51], s7 offen
s_mov_b64 exec, s[12:13]
buffer_store_dword v36, v48, s[48:51], s7 offen
buffer_store_dword v37, v49, s[48:51], s7 offen
buffer_store_dword v38, v50, s[48:51], s7 offen
buffer_store_dword v39, v51, s[48:51], s7 offen
s_mov_b64 exec, -1
L1_fin:
L1_end:
s_endpgm
.globl k2_kernel
.p2align 8
.type k2_kernel,@function
k2_kernel:
s_load_dwordx2 s[4:5], s[0:1], 88
s_load_dwordx2 s[6:7], s[0:1], 0
s_load_dwordx2 s[16:17], s[0:1], 24
s_load_dwordx2 s[18:19], s[0:1], 72
s_and_b32 s35, s2, 7
s_lshr_b32 s37, s2, 3
s_cmp_ge_u32 s37, 30
s_cbranch_scc1 LE_start
s_mul_i32 s38, s37, 52
s_lshr_b32 s38, s38, 8
s_mul_i32 s39, s38, 5
s_sub_u32 s39, s37, s39
s_mov_b32 s37, s38
s_mul_i32 s38, s35, 5
s_add_u32 s38, s38, s39
v_lshrrev_b32 v1, 6, v0
v_and_b32 v252, 63, v0
v_lshlrev_b32 v252, 4, v252
v_readfirstlane_b32 s34, v1
s_mov_b32 s50, 0xe1a06800
s_mov_b32 s51, 0x4e608d04
s_mul_i32 s39, s37, 9
s_lshr_b64 s[50:51], s[50:51], s39
s_and_b32 s39, s50, 0x1ff
s_bfe_u32 s49, s50, 0x90009
s_sub_u32 s29, s49, s39
s_lshl_b32 s50, s37, 2
s_lshr_b32 s59, 0x766666, s50
s_and_b32 s59, s59, 15
s_sub_u32 s31, s29, s59
s_lshr_b32 s31, s31, 1
s_sub_u32 s31, s31, 1
s_lshl_b32 s39, s39, 14
s_lshl_b32 s49, s49, 14
s_add_u32 s28, s39, 0x4000
s_cmp_eq_u32 s37, 5
s_cselect_b32 s33, 0xff800000, 0
s_mov_b32 s32, 0xffff
v_and_b32 v2, 63, v0
v_bfe_u32 v3, v2, 3, 2
v_bfe_u32 v4, v2, 2, 1
v_lshlrev_b32 v251, 12, v3
v_lshl_or_b32 v251, v4, 9, v251
v_lshl_or_b32 v251, v1, 7, v251
v_lshrrev_b32 v4, 5, v2
v_lshl_or_b32 v251, v4, 6, v251
v_and_b32 v3, 2, v3
v_and_b32 v4, 3, v2
v_xor_b32 v3, v3, v4
v_lshl_or_b32 v251, v3, 4, v251
s_cmp_eq_u32 s38, 39
s_cbranch_scc1 LT_disp
s_lshl_b32 s30, s34, 12
s_mov_b32 m0, s30
s_waitcnt lgkmcnt(0)
s_add_u32 s12, s4, 0x6800000
s_addc_u32 s13, s5, 0
s_mov_b32 s14, s49
s_mov_b32 s15, 0x00020000
buffer_load_dwordx4 v251, s[12:15], s39 offen offset:0 lds
buffer_load_dwordx4 v251, s[12:15], s39 offen offset:1024 lds
buffer_load_dwordx4 v251, s[12:15], s39 offen offset:2048 lds
buffer_load_dwordx4 v251, s[12:15], s39 offen offset:3072 lds
s_add_u32 m0, s30, 0x4000
s_nop 0
buffer_load_dwordx4 v251, s[12:15], s28 offen offset:0 lds
buffer_load_dwordx4 v251, s[12:15], s28 offen offset:1024 lds
s_add_u32 s8, s4, 0x0
s_addc_u32 s9, s5, 0
s_mov_b32 s10, 0x4e4000
s_mov_b32 s11, 0x00020000
s_mul_i32 s35, s37, 0x600000
s_add_u32 s20, s4, 0x2000000
s_addc_u32 s21, s5, 0
s_add_u32 s20, s20, s35
s_addc_u32 s21, s21, 0
s_mov_b32 s22, 0x4e4000
s_mov_b32 s23, 0x00020000
s_add_u32 s24, s4, 0x6000000
s_addc_u32 s25, s5, 0
s_mov_b32 s26, 0x9c800
s_mov_b32 s27, 0x00020000
s_lshl_b32 s35, s38, 4
s_lshl_b32 s41, s34, 2
s_add_u32 s35, s35, s41
s_mul_i32 s41, s37, 3
s_sub_u32 s42, s34, s41
s_and_b32 s42, s42, 3
s_add_u32 s41, s41, s42
s_lshr_b32 s41, s41, 2
s_cmp_eq_u32 s37, 5
s_cselect_b32 s42, 3, s42
s_cmp_lt_u32 s42, 3
s_cselect_b32 s41, s41, 0
s_cselect_b32 s50, 1, 0
s_add_u32 s35, s35, s41
s_lshl_b32 s40, s35, 13
s_lshl_b32 s48, s35, 10
s_lshl_b32 s35, s37, 3
s_add_u32 s48, s48, s35
s_xor_b32 s41, s40, 8192
s_xor_b32 s42, s40, 16384
s_xor_b32 s43, s40, 24576
s_add_u32 s44, s40, 4096
s_add_u32 s45, s41, 4096
s_add_u32 s46, s42, 4096
s_add_u32 s47, s43, 4096
s_mul_i32 s35, s37, 3
s_and_b32 s36, s35, 3
s_lshl_b32 s36, s36, 2
s_lshr_b32 s52, s35, 2
s_add_u32 s36, s36, s52
s_lshl_b32 s52, s38, 4
s_add_u32 s52, s52, s36
s_lshl_b32 s52, s52, 13
s_add_u32 s35, s35, 1
s_and_b32 s36, s35, 3
s_lshl_b32 s36, s36, 2
s_lshr_b32 s53, s35, 2
s_add_u32 s36, s36, s53
s_lshl_b32 s53, s38, 4
s_add_u32 s53, s53, s36
s_lshl_b32 s53, s53, 13
s_add_u32 s35, s35, 1
s_and_b32 s36, s35, 3
s_lshl_b32 s36, s36, 2
s_lshr_b32 s54, s35, 2
s_add_u32 s36, s36, s54
s_lshl_b32 s54, s38, 4
s_add_u32 s54, s54, s36
s_lshl_b32 s54, s54, 13
v_mov_b32 v208, 0
v_mov_b32 v209, 0
v_mov_b32 v210, 0
v_mov_b32 v211, 0
buffer_load_dwordx4 v[0:3], v252, s[8:11], s40 offen offset:0
buffer_load_dwordx4 v[32:35], v252, s[8:11], s41 offen offset:0
v_mfma_f32_32x32x16_bf16 a[0:15], v[208:211], v[208:211], 0
buffer_load_dwordx4 v[64:67], v252, s[8:11], s42 offen offset:0
v_mfma_f32_32x32x16_bf16 a[16:31], v[208:211], v[208:211], 0
buffer_load_dwordx4 v[96:99], v252, s[8:11], s43 offen offset:0
buffer_load_dwordx4 v[4:7], v252, s[8:11], s40 offen offset:1024
v_mfma_f32_32x32x16_bf16 a[32:47], v[208:211], v[208:211], 0
buffer_load_dwordx4 v[36:39], v252, s[8:11], s41 offen offset:1024
v_mfma_f32_32x32x16_bf16 a[48:63], v[208:211], v[208:211], 0
buffer_load_dwordx4 v[68:71], v252, s[8:11], s42 offen offset:1024
buffer_load_dwordx4 v[100:103], v252, s[8:11], s43 offen offset:1024
v_mfma_f32_32x32x16_bf16 a[64:79], v[208:211], v[208:211], 0
buffer_load_dwordx4 v[8:11], v252, s[8:11], s40 offen offset:2048
v_mfma_f32_32x32x16_bf16 a[80:95], v[208:211], v[208:211], 0
buffer_load_dwordx4 v[40:43], v252, s[8:11], s41 offen offset:2048
buffer_load_dwordx4 v[72:75], v252, s[8:11], s42 offen offset:2048
v_mfma_f32_32x32x16_bf16 a[96:111], v[208:211], v[208:211], 0
buffer_load_dwordx4 v[104:107], v252, s[8:11], s43 offen offset:2048
v_mfma_f32_32x32x16_bf16 a[112:127], v[208:211], v[208:211], 0
buffer_load_dwordx4 v[12:15], v252, s[8:11], s40 offen offset:3072
buffer_load_dwordx4 v[44:47], v252, s[8:11], s41 offen offset:3072
v_mfma_f32_32x32x16_bf16 a[128:143], v[208:211], v[208:211], 0
buffer_load_dwordx4 v[76:79], v252, s[8:11], s42 offen offset:3072
v_mfma_f32_32x32x16_bf16 a[144:159], v[208:211], v[208:211], 0
buffer_load_dwordx4 v[108:111], v252, s[8:11], s43 offen offset:3072
buffer_load_dwordx4 v[16:19], v252, s[8:11], s44 offen offset:0
v_mfma_f32_32x32x16_bf16 a[160:175], v[208:211], v[208:211], 0
buffer_load_dwordx4 v[48:51], v252, s[8:11], s45 offen offset:0
v_mfma_f32_32x32x16_bf16 a[176:191], v[208:211], v[208:211], 0
buffer_load_dwordx4 v[80:83], v252, s[8:11], s46 offen offset:0
buffer_load_dwordx4 v[112:115], v252, s[8:11], s47 offen offset:0
v_mfma_f32_32x32x16_bf16 a[192:207], v[208:211], v[208:211], 0
buffer_load_dwordx4 v[20:23], v252, s[8:11], s44 offen offset:1024
v_mfma_f32_32x32x16_bf16 a[208:223], v[208:211], v[208:211], 0
buffer_load_dwordx4 v[52:55], v252, s[8:11], s45 offen offset:1024
buffer_load_dwordx4 v[84:87], v252, s[8:11], s46 offen offset:1024
v_mfma_f32_32x32x16_bf16 a[224:239], v[208:211], v[208:211], 0
buffer_load_dwordx4 v[116:119], v252, s[8:11], s47 offen offset:1024
v_mfma_f32_32x32x16_bf16 a[240:255], v[208:211], v[208:211], 0
v_bfe_u32 v248, v252, 4, 3
v_lshlrev_b32 v248, 6, v248
v_bfe_u32 v253, v252, 7, 1
v_lshl_or_b32 v248, v253, 10, v248
v_bfe_u32 v253, v252, 8, 2
v_lshl_or_b32 v248, v253, 4, v248
v_bfe_u32 v253, v252, 6, 1
v_lshlrev_b32 v253, 5, v253
v_xor_b32 v248, v248, v253
v_and_b32 v249, 0x1c0, v252
v_bfe_u32 v253, v252, 9, 1
v_lshl_or_b32 v249, v253, 10, v249
v_bfe_u32 v253, v252, 8, 1
v_lshl_or_b32 v249, v253, 5, v249
v_bfe_u32 v253, v252, 4, 2
v_lshl_or_b32 v249, v253, 3, v249
v_xor_b32 v250, 32, v249
s_waitcnt vmcnt(24)
s_barrier
ds_read_b128 v[224:227], v248 offset:0
ds_read_b128 v[228:231], v248 offset:512
ds_read_b128 v[232:235], v248 offset:2048
ds_read_b128 v[236:239], v248 offset:2560
s_waitcnt lgkmcnt(2)
s_waitcnt vmcnt(16)
v_mfma_f32_16x16x32_bf16 v[160:163], v[224:227], v[0:3], 0
ds_read_b128 v[240:243], v248 offset:16384
v_mfma_f32_16x16x32_bf16 v[160:163], v[228:231], v[4:7], v[160:163]
buffer_load_dwordx4 v[24:27], v252, s[8:11], s44 offen offset:2048
v_mfma_f32_16x16x32_bf16 v[164:167], v[224:227], v[32:35], 0
v_mfma_f32_16x16x32_bf16 v[164:167], v[228:231], v[36:39], v[164:167]
buffer_load_dwordx4 v[56:59], v252, s[8:11], s45 offen offset:2048
v_mfma_f32_16x16x32_bf16 v[168:171], v[224:227], v[64:67], 0
ds_read_b128 v[244:247], v248 offset:16896
v_mfma_f32_16x16x32_bf16 v[168:171], v[228:231], v[68:71], v[168:171]
buffer_load_dwordx4 v[88:91], v252, s[8:11], s46 offen offset:2048
v_mfma_f32_16x16x32_bf16 v[172:175], v[224:227], v[96:99], 0
v_mfma_f32_16x16x32_bf16 v[172:175], v[228:231], v[100:103], v[172:175]
s_waitcnt lgkmcnt(2)
buffer_load_dwordx4 v[120:123], v252, s[8:11], s47 offen offset:2048
v_mfma_f32_16x16x32_bf16 v[176:179], v[232:235], v[0:3], 0
ds_read_b128 v[224:227], v248 offset:4096
v_mfma_f32_16x16x32_bf16 v[176:179], v[236:239], v[4:7], v[176:179]
buffer_load_dwordx4 v[28:31], v252, s[8:11], s44 offen offset:3072
v_mfma_f32_16x16x32_bf16 v[180:183], v[232:235], v[32:35], 0
v_mfma_f32_16x16x32_bf16 v[180:183], v[236:239], v[36:39], v[180:183]
buffer_load_dwordx4 v[60:63], v252, s[8:11], s45 offen offset:3072
v_mfma_f32_16x16x32_bf16 v[184:187], v[232:235], v[64:67], 0
ds_read_b128 v[228:231], v248 offset:4608
v_mfma_f32_16x16x32_bf16 v[184:187], v[236:239], v[68:71], v[184:187]
buffer_load_dwordx4 v[92:95], v252, s[8:11], s46 offen offset:3072
v_mfma_f32_16x16x32_bf16 v[188:191], v[232:235], v[96:99], 0
v_mfma_f32_16x16x32_bf16 v[188:191], v[236:239], v[100:103], v[188:191]
s_waitcnt lgkmcnt(2)
buffer_load_dwordx4 v[124:127], v252, s[8:11], s47 offen offset:3072
v_mfma_f32_16x16x32_bf16 v[192:195], v[240:243], v[0:3], 0
ds_read_b128 v[232:235], v248 offset:6144
v_mfma_f32_16x16x32_bf16 v[192:195], v[244:247], v[4:7], v[192:195]
v_mfma_f32_16x16x32_bf16 v[196:199], v[240:243], v[32:35], 0
v_mfma_f32_16x16x32_bf16 v[196:199], v[244:247], v[36:39], v[196:199]
v_mfma_f32_16x16x32_bf16 v[200:203], v[240:243], v[64:67], 0
ds_read_b128 v[236:239], v248 offset:6656
v_mfma_f32_16x16x32_bf16 v[200:203], v[244:247], v[68:71], v[200:203]
v_mfma_f32_16x16x32_bf16 v[204:207], v[240:243], v[96:99], 0
v_mfma_f32_16x16x32_bf16 v[204:207], v[244:247], v[100:103], v[204:207]
s_waitcnt lgkmcnt(2)
s_waitcnt vmcnt(16)
v_mfma_f32_16x16x32_bf16 v[160:163], v[224:227], v[8:11], v[160:163]
ds_read_b128 v[240:243], v248 offset:20480
v_mfma_f32_16x16x32_bf16 v[160:163], v[228:231], v[12:15], v[160:163]
buffer_load_dwordx4 v251, s[12:15], s28 offen offset:2048 lds
v_mfma_f32_16x16x32_bf16 v[164:167], v[224:227], v[40:43], v[164:167]
v_mfma_f32_16x16x32_bf16 v[164:167], v[228:231], v[44:47], v[164:167]
buffer_load_dwordx4 v251, s[12:15], s28 offen offset:3072 lds
v_mfma_f32_16x16x32_bf16 v[168:171], v[224:227], v[72:75], v[168:171]
ds_read_b128 v[244:247], v248 offset:20992
v_mfma_f32_16x16x32_bf16 v[168:171], v[228:231], v[76:79], v[168:171]
s_add_u32 s28, s28, 0x4000
s_add_u32 m0, s30, 0x8000
s_nop 0
v_mfma_f32_16x16x32_bf16 v[172:175], v[224:227], v[104:107], v[172:175]
v_mfma_f32_16x16x32_bf16 v[172:175], v[228:231], v[108:111], v[172:175]
s_waitcnt lgkmcnt(2)
buffer_load_dwordx4 v251, s[12:15], s28 offen offset:0 lds
v_mfma_f32_16x16x32_bf16 v[176:179], v[232:235], v[8:11], v[176:179]
ds_read_b128 v[224:227], v248 offset:8192
v_mfma_f32_16x16x32_bf16 v[176:179], v[236:239], v[12:15], v[176:179]
buffer_load_dwordx4 v251, s[12:15], s28 offen offset:1024 lds
v_mfma_f32_16x16x32_bf16 v[180:183], v[232:235], v[40:43], v[180:183]
v_mfma_f32_16x16x32_bf16 v[180:183], v[236:239], v[44:47], v[180:183]
buffer_load_dwordx4 v251, s[12:15], s28 offen offset:2048 lds
v_mfma_f32_16x16x32_bf16 v[184:187], v[232:235], v[72:75], v[184:187]
ds_read_b128 v[228:231], v248 offset:8704
v_mfma_f32_16x16x32_bf16 v[184:187], v[236:239], v[76:79], v[184:187]
buffer_load_dwordx4 v251, s[12:15], s28 offen offset:3072 lds
v_mfma_f32_16x16x32_bf16 v[188:191], v[232:235], v[104:107], v[188:191]
v_mfma_f32_16x16x32_bf16 v[188:191], v[236:239], v[108:111], v[188:191]
s_waitcnt lgkmcnt(2)
v_mfma_f32_16x16x32_bf16 v[192:195], v[240:243], v[8:11], v[192:195]
ds_read_b128 v[232:235], v248 offset:10240
v_mfma_f32_16x16x32_bf16 v[192:195], v[244:247], v[12:15], v[192:195]
v_mfma_f32_16x16x32_bf16 v[196:199], v[240:243], v[40:43], v[196:199]
v_mfma_f32_16x16x32_bf16 v[196:199], v[244:247], v[44:47], v[196:199]
v_mfma_f32_16x16x32_bf16 v[200:203], v[240:243], v[72:75], v[200:203]
ds_read_b128 v[236:239], v248 offset:10752
v_mfma_f32_16x16x32_bf16 v[200:203], v[244:247], v[76:79], v[200:203]
v_mfma_f32_16x16x32_bf16 v[204:207], v[240:243], v[104:107], v[204:207]
v_mfma_f32_16x16x32_bf16 v[204:207], v[244:247], v[108:111], v[204:207]
s_waitcnt lgkmcnt(2)
s_waitcnt vmcnt(14)
v_mfma_f32_16x16x32_bf16 v[160:163], v[224:227], v[16:19], v[160:163]
ds_read_b128 v[240:243], v248 offset:24576
v_mfma_f32_16x16x32_bf16 v[160:163], v[228:231], v[20:23], v[160:163]
s_add_u32 s28, s28, 0x4000
s_add_u32 m0, s30, 0xc000
s_nop 0
v_mfma_f32_16x16x32_bf16 v[164:167], v[224:227], v[48:51], v[164:167]
v_mfma_f32_16x16x32_bf16 v[164:167], v[228:231], v[52:55], v[164:167]
buffer_load_dwordx4 v251, s[12:15], s28 offen offset:0 lds
v_mfma_f32_16x16x32_bf16 v[168:171], v[224:227], v[80:83], v[168:171]
ds_read_b128 v[244:247], v248 offset:25088
v_mfma_f32_16x16x32_bf16 v[168:171], v[228:231], v[84:87], v[168:171]
buffer_load_dwordx4 v251, s[12:15], s28 offen offset:1024 lds
v_mfma_f32_16x16x32_bf16 v[172:175], v[224:227], v[112:115], v[172:175]
v_mfma_f32_16x16x32_bf16 v[172:175], v[228:231], v[116:119], v[172:175]
s_waitcnt lgkmcnt(2)
buffer_load_dwordx4 v251, s[12:15], s28 offen offset:2048 lds
v_mfma_f32_16x16x32_bf16 v[176:179], v[232:235], v[16:19], v[176:179]
ds_read_b128 v[224:227], v248 offset:12288
v_mfma_f32_16x16x32_bf16 v[176:179], v[236:239], v[20:23], v[176:179]
buffer_load_dwordx4 v251, s[12:15], s28 offen offset:3072 lds
v_mfma_f32_16x16x32_bf16 v[180:183], v[232:235], v[48:51], v[180:183]
v_mfma_f32_16x16x32_bf16 v[180:183], v[236:239], v[52:55], v[180:183]
v_mfma_f32_16x16x32_bf16 v[184:187], v[232:235], v[80:83], v[184:187]
ds_read_b128 v[228:231], v248 offset:12800
v_mfma_f32_16x16x32_bf16 v[184:187], v[236:239], v[84:87], v[184:187]
v_mfma_f32_16x16x32_bf16 v[188:191], v[232:235], v[112:115], v[188:191]
v_mfma_f32_16x16x32_bf16 v[188:191], v[236:239], v[116:119], v[188:191]
s_waitcnt lgkmcnt(2)
v_mfma_f32_16x16x32_bf16 v[192:195], v[240:243], v[16:19], v[192:195]
ds_read_b128 v[232:235], v248 offset:14336
v_mfma_f32_16x16x32_bf16 v[192:195], v[244:247], v[20:23], v[192:195]
v_mfma_f32_16x16x32_bf16 v[196:199], v[240:243], v[48:51], v[196:199]
v_mfma_f32_16x16x32_bf16 v[196:199], v[244:247], v[52:55], v[196:199]
v_mfma_f32_16x16x32_bf16 v[200:203], v[240:243], v[80:83], v[200:203]
ds_read_b128 v[236:239], v248 offset:14848
v_mfma_f32_16x16x32_bf16 v[200:203], v[244:247], v[84:87], v[200:203]
v_mfma_f32_16x16x32_bf16 v[204:207], v[240:243], v[112:115], v[204:207]
v_mfma_f32_16x16x32_bf16 v[204:207], v[244:247], v[116:119], v[204:207]
s_waitcnt lgkmcnt(2)
s_waitcnt vmcnt(10)
v_mfma_f32_16x16x32_bf16 v[160:163], v[224:227], v[24:27], v[160:163]
ds_read_b128 v[240:243], v248 offset:28672
v_mfma_f32_16x16x32_bf16 v[160:163], v[228:231], v[28:31], v[160:163]
s_add_u32 s28, s28, 0x4000
s_add_u32 m0, s30, 0x10000
s_nop 0
v_mfma_f32_16x16x32_bf16 v[164:167], v[224:227], v[56:59], v[164:167]
v_mfma_f32_16x16x32_bf16 v[164:167], v[228:231], v[60:63], v[164:167]
buffer_load_dwordx4 v251, s[12:15], s28 offen offset:0 lds
v_mfma_f32_16x16x32_bf16 v[168:171], v[224:227], v[88:91], v[168:171]
ds_read_b128 v[244:247], v248 offset:29184
v_mfma_f32_16x16x32_bf16 v[168:171], v[228:231], v[92:95], v[168:171]
buffer_load_dwordx4 v251, s[12:15], s28 offen offset:1024 lds
v_mfma_f32_16x16x32_bf16 v[172:175], v[224:227], v[120:123], v[172:175]
v_mfma_f32_16x16x32_bf16 v[172:175], v[228:231], v[124:127], v[172:175]
s_waitcnt lgkmcnt(2)
buffer_load_dwordx4 v251, s[12:15], s28 offen offset:2048 lds
v_mfma_f32_16x16x32_bf16 v[176:179], v[232:235], v[24:27], v[176:179]
v_mfma_f32_16x16x32_bf16 v[176:179], v[236:239], v[28:31], v[176:179]
buffer_load_dwordx4 v251, s[12:15], s28 offen offset:3072 lds
v_mfma_f32_16x16x32_bf16 v[180:183], v[232:235], v[56:59], v[180:183]
v_mfma_f32_16x16x32_bf16 v[180:183], v[236:239], v[60:63], v[180:183]
v_mfma_f32_16x16x32_bf16 v[184:187], v[232:235], v[88:91], v[184:187]
v_mfma_f32_16x16x32_bf16 v[184:187], v[236:239], v[92:95], v[184:187]
v_mfma_f32_16x16x32_bf16 v[188:191], v[232:235], v[120:123], v[188:191]
v_mfma_f32_16x16x32_bf16 v[188:191], v[236:239], v[124:127], v[188:191]
s_waitcnt lgkmcnt(0)
v_mfma_f32_16x16x32_bf16 v[192:195], v[240:243], v[24:27], v[192:195]
v_mfma_f32_16x16x32_bf16 v[192:195], v[244:247], v[28:31], v[192:195]
v_mfma_f32_16x16x32_bf16 v[196:199], v[240:243], v[56:59], v[196:199]
v_mfma_f32_16x16x32_bf16 v[196:199], v[244:247], v[60:63], v[196:199]
v_mfma_f32_16x16x32_bf16 v[200:203], v[240:243], v[88:91], v[200:203]
v_mfma_f32_16x16x32_bf16 v[200:203], v[244:247], v[92:95], v[200:203]
v_mfma_f32_16x16x32_bf16 v[204:207], v[240:243], v[120:123], v[204:207]
v_mfma_f32_16x16x32_bf16 v[204:207], v[244:247], v[124:127], v[204:207]
s_nop 3
v_max3_f32 v224, v160, v161, v162
v_max3_f32 v225, v164, v165, v166
v_max3_f32 v226, v168, v169, v170
v_max3_f32 v227, v172, v173, v174
v_max3_f32 v224, v224, v163, v176
v_max3_f32 v225, v225, v167, v180
v_max3_f32 v226, v226, v171, v184
v_max3_f32 v227, v227, v175, v188
v_max3_f32 v224, v224, v177, v178
v_max3_f32 v225, v225, v181, v182
v_max3_f32 v226, v226, v185, v186
v_max3_f32 v227, v227, v189, v190
v_max_f32 v224, v224, v179
v_max_f32 v225, v225, v183
v_max_f32 v226, v226, v187
v_max_f32 v227, v227, v191
s_add_u32 s28, s28, 0x4000
s_xor_b32 s30, s30, 0x10000
v_mov_b32 v228, v224
v_mov_b32 v229, v225
v_mov_b32 v230, v226
v_mov_b32 v231, v227
v_permlane32_swap_b32 v224, v228
v_permlane32_swap_b32 v225, v229
v_permlane32_swap_b32 v226, v230
v_permlane32_swap_b32 v227, v231
v_max_f32 v224, v224, v228
v_max_f32 v225, v225, v229
v_max_f32 v226, v226, v230
v_max_f32 v227, v227, v231
v_mov_b32 v228, v224
v_mov_b32 v229, v225
v_mov_b32 v230, v226
v_mov_b32 v231, v227
v_permlane16_swap_b32 v224, v228
v_permlane16_swap_b32 v225, v229
v_permlane16_swap_b32 v226, v230
v_permlane16_swap_b32 v227, v231
v_max_f32 v224, v224, v228
v_max_f32 v225, v225, v229
v_max_f32 v226, v226, v230
v_max_f32 v227, v227, v231
s_waitcnt vmcnt(8)
s_barrier
ds_read_b128 v[232:235], v248 offset:18432
ds_read_b128 v[236:239], v248 offset:18944
ds_read_b128 v[240:243], v248 offset:22528
ds_read_b128 v[244:247], v248 offset:23040
v_cvt_pk_bf16_f32 v228, -v224, -v224
v_cvt_pk_bf16_f32 v229, -v225, -v225
v_cvt_pk_bf16_f32 v230, -v226, -v226
v_cvt_pk_bf16_f32 v231, -v227, -v227
v_lshlrev_b32 v253, 2, v252
v_lshlrev_b32 v147, 16, v228
v_lshlrev_b32 v151, 16, v229
v_lshlrev_b32 v155, 16, v230
v_lshlrev_b32 v159, 16, v231
s_mov_b64 exec, 0xffff
v_bfi_b32 v0, s32, v228, v0
v_bfi_b32 v32, s32, v229, v32
v_bfi_b32 v64, s32, v230, v64
v_bfi_b32 v96, s32, v231, v96
v_xor_b32 v224, 0x80000000, v147
v_xor_b32 v225, 0x80000000, v151
v_xor_b32 v226, 0x80000000, v155
v_xor_b32 v227, 0x80000000, v159
s_xor_b32 s35, s48, 0
buffer_store_dword v224, v253, s[24:27], s35 offen offset:0 sc1
s_xor_b32 s35, s48, 1024
buffer_store_dword v225, v253, s[24:27], s35 offen offset:0 sc1
s_xor_b32 s35, s48, 2048
buffer_store_dword v226, v253, s[24:27], s35 offen offset:0 sc1
s_xor_b32 s35, s48, 3072
buffer_store_dword v227, v253, s[24:27], s35 offen offset:0 sc1
s_mov_b64 exec, -1
s_waitcnt lgkmcnt(2)
v_mfma_f32_16x16x32_bf16 v[208:211], v[232:235], v[0:3], 0
ds_read_b128 v[224:227], v248 offset:26624
v_add_f32 v192, v192, v147
v_add_f32 v193, v193, v147
v_add_f32 v194, v194, v147
v_mfma_f32_16x16x32_bf16 v[208:211], v[236:239], v[4:7], v[208:211]
v_add_f32 v195, v195, v147
v_exp_f32 v192, v192
v_mfma_f32_16x16x32_bf16 v[212:215], v[232:235], v[32:35], 0
v_exp_f32 v193, v193
v_exp_f32 v194, v194
v_mfma_f32_16x16x32_bf16 v[212:215], v[236:239], v[36:39], v[212:215]
v_exp_f32 v195, v195
v_add_f32 v196, v196, v151
v_add_f32 v197, v197, v151
v_mfma_f32_16x16x32_bf16 v[216:219], v[232:235], v[64:67], 0
ds_read_b128 v[228:231], v248 offset:27136
v_cvt_pk_bf16_f32 v144, v192, v193
v_cvt_pk_bf16_f32 v145, v194, v195
v_add_f32 v198, v198, v151
v_mfma_f32_16x16x32_bf16 v[216:219], v[236:239], v[68:71], v[216:219]
v_add_f32 v199, v199, v151
v_exp_f32 v196, v196
v_mfma_f32_16x16x32_bf16 v[220:223], v[232:235], v[96:99], 0
v_exp_f32 v197, v197
v_exp_f32 v198, v198
v_mfma_f32_16x16x32_bf16 v[220:223], v[236:239], v[100:103], v[220:223]
s_waitcnt lgkmcnt(2)
v_exp_f32 v199, v199
v_cvt_pk_bf16_f32 v148, v196, v197
v_mfma_f32_16x16x32_bf16 v[208:211], v[240:243], v[8:11], v[208:211]
ds_read_b128 v[232:235], v248 offset:30720
v_cvt_pk_bf16_f32 v149, v198, v199
v_add_f32 v200, v200, v155
v_add_f32 v201, v201, v155
v_mfma_f32_16x16x32_bf16 v[208:211], v[244:247], v[12:15], v[208:211]
v_add_f32 v202, v202, v155
v_add_f32 v203, v203, v155
v_exp_f32 v200, v200
v_mfma_f32_16x16x32_bf16 v[212:215], v[240:243], v[40:43], v[212:215]
v_exp_f32 v201, v201
v_exp_f32 v202, v202
v_mfma_f32_16x16x32_bf16 v[212:215], v[244:247], v[44:47], v[212:215]
v_exp_f32 v203, v203
v_add_f32 v204, v204, v159
v_add_f32 v205, v205, v159
v_mfma_f32_16x16x32_bf16 v[216:219], v[240:243], v[72:75], v[216:219]
ds_read_b128 v[236:239], v248 offset:31232
v_cvt_pk_bf16_f32 v152, v200, v201
v_cvt_pk_bf16_f32 v153, v202, v203
v_add_f32 v206, v206, v159
v_mfma_f32_16x16x32_bf16 v[216:219], v[244:247], v[76:79], v[216:219]
v_add_f32 v207, v207, v159
v_exp_f32 v204, v204
v_mfma_f32_16x16x32_bf16 v[220:223], v[240:243], v[104:107], v[220:223]
v_exp_f32 v205, v205
v_exp_f32 v206, v206
v_mfma_f32_16x16x32_bf16 v[220:223], v[244:247], v[108:111], v[220:223]
s_waitcnt lgkmcnt(2)
v_exp_f32 v207, v207
v_cvt_pk_bf16_f32 v156, v204, v205
v_mfma_f32_16x16x32_bf16 v[208:211], v[224:227], v[16:19], v[208:211]
ds_read_b128 v[240:243], v248 offset:32768
v_cvt_pk_bf16_f32 v157, v206, v207
v_add_f32 v160, v160, v147
v_add_f32 v161, v161, v147
v_mfma_f32_16x16x32_bf16 v[208:211], v[228:231], v[20:23], v[208:211]
v_add_f32 v162, v162, v147
v_add_f32 v163, v163, v147
v_exp_f32 v160, v160
v_mfma_f32_16x16x32_bf16 v[212:215], v[224:227], v[48:51], v[212:215]
v_exp_f32 v161, v161
v_exp_f32 v162, v162
v_mfma_f32_16x16x32_bf16 v[212:215], v[228:231], v[52:55], v[212:215]
v_exp_f32 v163, v163
v_add_f32 v164, v164, v151
v_add_f32 v165, v165, v151
v_mfma_f32_16x16x32_bf16 v[216:219], v[224:227], v[80:83], v[216:219]
ds_read_b128 v[244:247], v248 offset:33280
v_cvt_pk_bf16_f32 v128, v160, v161
v_cvt_pk_bf16_f32 v129, v162, v163
v_add_f32 v166, v166, v151
v_mfma_f32_16x16x32_bf16 v[216:219], v[228:231], v[84:87], v[216:219]
v_add_f32 v167, v167, v151
v_exp_f32 v164, v164
v_mfma_f32_16x16x32_bf16 v[220:223], v[224:227], v[112:115], v[220:223]
v_exp_f32 v165, v165
v_exp_f32 v166, v166
v_mfma_f32_16x16x32_bf16 v[220:223], v[228:231], v[116:119], v[220:223]
s_waitcnt lgkmcnt(2)
v_exp_f32 v167, v167
v_cvt_pk_bf16_f32 v132, v164, v165
v_mfma_f32_16x16x32_bf16 v[208:211], v[232:235], v[24:27], v[208:211]
ds_read_b128 v[224:227], v248 offset:36864
v_cvt_pk_bf16_f32 v133, v166, v167
v_add_f32 v168, v168, v155
v_add_f32 v169, v169, v155
v_mfma_f32_16x16x32_bf16 v[208:211], v[236:239], v[28:31], v[208:211]
v_add_f32 v170, v170, v155
v_add_f32 v171, v171, v155
v_exp_f32 v168, v168
v_mfma_f32_16x16x32_bf16 v[212:215], v[232:235], v[56:59], v[212:215]
v_exp_f32 v169, v169
v_exp_f32 v170, v170
v_mfma_f32_16x16x32_bf16 v[212:215], v[236:239], v[60:63], v[212:215]
v_exp_f32 v171, v171
v_add_f32 v172, v172, v159
v_add_f32 v173, v173, v159
v_mfma_f32_16x16x32_bf16 v[216:219], v[232:235], v[88:91], v[216:219]
ds_read_b128 v[228:231], v248 offset:37376
v_cvt_pk_bf16_f32 v136, v168, v169
v_cvt_pk_bf16_f32 v137, v170, v171
v_add_f32 v174, v174, v159
v_mfma_f32_16x16x32_bf16 v[216:219], v[236:239], v[92:95], v[216:219]
v_add_f32 v175, v175, v159
v_exp_f32 v172, v172
v_mfma_f32_16x16x32_bf16 v[220:223], v[232:235], v[120:123], v[220:223]
v_exp_f32 v173, v173
v_exp_f32 v174, v174
v_mfma_f32_16x16x32_bf16 v[220:223], v[236:239], v[124:127], v[220:223]
s_waitcnt lgkmcnt(2)
v_exp_f32 v175, v175
v_cvt_pk_bf16_f32 v140, v172, v173
v_mfma_f32_16x16x32_bf16 v[192:195], v[240:243], v[0:3], 0
ds_read_b128 v[232:235], v248 offset:40960
v_cvt_pk_bf16_f32 v141, v174, v175
v_add_f32 v176, v176, v147
v_add_f32 v177, v177, v147
v_mfma_f32_16x16x32_bf16 v[192:195], v[244:247], v[4:7], v[192:195]
v_add_f32 v178, v178, v147
v_add_f32 v179, v179, v147
v_exp_f32 v176, v176
v_mfma_f32_16x16x32_bf16 v[196:199], v[240:243], v[32:35], 0
v_exp_f32 v177, v177
v_exp_f32 v178, v178
v_mfma_f32_16x16x32_bf16 v[196:199], v[244:247], v[36:39], v[196:199]
v_exp_f32 v179, v179
v_add_f32 v180, v180, v151
v_add_f32 v181, v181, v151
v_mfma_f32_16x16x32_bf16 v[200:203], v[240:243], v[64:67], 0
ds_read_b128 v[236:239], v248 offset:41472
v_cvt_pk_bf16_f32 v130, v176, v177
v_cvt_pk_bf16_f32 v131, v178, v179
v_add_f32 v182, v182, v151
v_mfma_f32_16x16x32_bf16 v[200:203], v[244:247], v[68:71], v[200:203]
v_add_f32 v183, v183, v151
v_exp_f32 v180, v180
v_mfma_f32_16x16x32_bf16 v[204:207], v[240:243], v[96:99], 0
v_exp_f32 v181, v181
v_exp_f32 v182, v182
v_mfma_f32_16x16x32_bf16 v[204:207], v[244:247], v[100:103], v[204:207]
s_waitcnt lgkmcnt(2)
v_exp_f32 v183, v183
v_cvt_pk_bf16_f32 v134, v180, v181
v_mfma_f32_16x16x32_bf16 v[192:195], v[224:227], v[8:11], v[192:195]
ds_read_b128 v[240:243], v248 offset:45056
v_cvt_pk_bf16_f32 v135, v182, v183
v_add_f32 v184, v184, v155
v_add_f32 v185, v185, v155
v_mfma_f32_16x16x32_bf16 v[192:195], v[228:231], v[12:15], v[192:195]
v_add_f32 v186, v186, v155
v_add_f32 v187, v187, v155
v_exp_f32 v184, v184
v_mfma_f32_16x16x32_bf16 v[196:199], v[224:227], v[40:43], v[196:199]
v_exp_f32 v185, v185
v_exp_f32 v186, v186
v_mfma_f32_16x16x32_bf16 v[196:199], v[228:231], v[44:47], v[196:199]
v_exp_f32 v187, v187
v_add_f32 v188, v188, v159
v_add_f32 v189, v189, v159
v_mfma_f32_16x16x32_bf16 v[200:203], v[224:227], v[72:75], v[200:203]
ds_read_b128 v[244:247], v248 offset:45568
v_cvt_pk_bf16_f32 v138, v184, v185
v_cvt_pk_bf16_f32 v139, v186, v187
v_add_f32 v190, v190, v159
v_mfma_f32_16x16x32_bf16 v[200:203], v[228:231], v[76:79], v[200:203]
v_add_f32 v191, v191, v159
v_exp_f32 v188, v188
v_mfma_f32_16x16x32_bf16 v[204:207], v[224:227], v[104:107], v[204:207]
v_exp_f32 v189, v189
v_exp_f32 v190, v190
v_mfma_f32_16x16x32_bf16 v[204:207], v[228:231], v[108:111], v[204:207]
s_waitcnt lgkmcnt(2)
v_exp_f32 v191, v191
v_cvt_pk_bf16_f32 v142, v188, v189
v_mfma_f32_16x16x32_bf16 v[192:195], v[232:235], v[16:19], v[192:195]
ds_read_b64_tr_b16 v[224:225], v249 offset:0
v_cvt_pk_bf16_f32 v143, v190, v191
v_exp_f32 v208, v208
v_mfma_f32_16x16x32_bf16 v[192:195], v[236:239], v[20:23], v[192:195]
v_exp_f32 v209, v209
v_exp_f32 v210, v210
v_mfma_f32_16x16x32_bf16 v[196:199], v[232:235], v[48:51], v[196:199]
ds_read_b64_tr_b16 v[226:227], v249 offset:2048
v_exp_f32 v211, v211
v_cvt_pk_bf16_f32 v146, v208, v209
v_mfma_f32_16x16x32_bf16 v[196:199], v[236:239], v[52:55], v[196:199]
v_cvt_pk_bf16_f32 v147, v210, v211
v_exp_f32 v212, v212
v_mfma_f32_16x16x32_bf16 v[200:203], v[232:235], v[80:83], v[200:203]
ds_read_b64_tr_b16 v[228:229], v249 offset:16384
v_exp_f32 v213, v213
v_mfma_f32_16x16x32_bf16 v[200:203], v[236:239], v[84:87], v[200:203]
v_exp_f32 v214, v214
v_exp_f32 v215, v215
v_mfma_f32_16x16x32_bf16 v[204:207], v[232:235], v[112:115], v[204:207]
ds_read_b64_tr_b16 v[230:231], v249 offset:18432
v_cvt_pk_bf16_f32 v150, v212, v213
v_cvt_pk_bf16_f32 v151, v214, v215
v_mfma_f32_16x16x32_bf16 v[204:207], v[236:239], v[116:119], v[204:207]
s_waitcnt lgkmcnt(4)
v_exp_f32 v216, v216
v_mfma_f32_16x16x32_bf16 v[192:195], v[240:243], v[24:27], v[192:195]
ds_read_b64_tr_b16 v[232:233], v250 offset:0
v_exp_f32 v217, v217
v_mfma_f32_16x16x32_bf16 v[192:195], v[244:247], v[28:31], v[192:195]
v_exp_f32 v218, v218
v_exp_f32 v219, v219
v_mfma_f32_16x16x32_bf16 v[196:199], v[240:243], v[56:59], v[196:199]
ds_read_b64_tr_b16 v[234:235], v250 offset:2048
v_cvt_pk_bf16_f32 v154, v216, v217
v_cvt_pk_bf16_f32 v155, v218, v219
v_mfma_f32_16x16x32_bf16 v[196:199], v[244:247], v[60:63], v[196:199]
v_exp_f32 v220, v220
v_exp_f32 v221, v221
v_mfma_f32_16x16x32_bf16 v[200:203], v[240:243], v[88:91], v[200:203]
ds_read_b64_tr_b16 v[236:237], v250 offset:16384
v_exp_f32 v222, v222
v_cvt_pk_bf16_f32 v158, v220, v221
v_mfma_f32_16x16x32_bf16 v[200:203], v[244:247], v[92:95], v[200:203]
v_exp_f32 v223, v223
v_mfma_f32_16x16x32_bf16 v[204:207], v[240:243], v[120:123], v[204:207]
ds_read_b64_tr_b16 v[238:239], v250 offset:18432
v_cvt_pk_bf16_f32 v159, v222, v223
v_mfma_f32_16x16x32_bf16 v[204:207], v[244:247], v[124:127], v[204:207]
s_cmp_eq_u32 s50, 1
s_cselect_b32 s40, 0x7fff0000, s40
s_cselect_b32 s44, 0x7fff0000, s44
.p2align 6
L2_loop:
s_waitcnt lgkmcnt(4)
v_mfma_f32_16x16x32_bf16 a[0:3], v[224:227], v[128:131], a[0:3]
ds_read_b64_tr_b16 v[240:241], v249 offset:512
v_mfma_f32_16x16x32_bf16 a[0:3], v[228:231], v[144:147], a[0:3]
v_mfma_f32_16x16x32_bf16 a[4:7], v[224:227], v[132:135], a[4:7]
ds_read_b64_tr_b16 v[242:243], v249 offset:2560
v_mfma_f32_16x16x32_bf16 a[4:7], v[228:231], v[148:151], a[4:7]
v_exp_f32 v192, v192
v_mfma_f32_16x16x32_bf16 a[8:11], v[224:227], v[136:139], a[8:11]
ds_read_b64_tr_b16 v[244:245], v249 offset:16896
v_mfma_f32_16x16x32_bf16 a[8:11], v[228:231], v[152:155], a[8:11]
v_exp_f32 v193, v193
v_mfma_f32_16x16x32_bf16 a[12:15], v[224:227], v[140:143], a[12:15]
ds_read_b64_tr_b16 v[246:247], v249 offset:18944
v_cvt_pk_bf16_f32 v160, v192, v193
v_mfma_f32_16x16x32_bf16 a[12:15], v[228:231], v[156:159], a[12:15]
s_waitcnt lgkmcnt(4)
v_mfma_f32_16x16x32_bf16 a[16:19], v[232:235], v[128:131], a[16:19]
ds_read_b64_tr_b16 v[176:177], v250 offset:512
v_mfma_f32_16x16x32_bf16 a[16:19], v[236:239], v[144:147], a[16:19]
v_exp_f32 v194, v194
v_mfma_f32_16x16x32_bf16 a[20:23], v[232:235], v[132:135], a[20:23]
ds_read_b64_tr_b16 v[178:179], v250 offset:2560
v_mfma_f32_16x16x32_bf16 a[20:23], v[236:239], v[148:151], a[20:23]
v_exp_f32 v195, v195
v_mfma_f32_16x16x32_bf16 a[24:27], v[232:235], v[136:139], a[24:27]
ds_read_b64_tr_b16 v[180:181], v250 offset:16896
v_cvt_pk_bf16_f32 v161, v194, v195
v_mfma_f32_16x16x32_bf16 a[24:27], v[236:239], v[152:155], a[24:27]
v_exp_f32 v196, v196
v_mfma_f32_16x16x32_bf16 a[28:31], v[232:235], v[140:143], a[28:31]
ds_read_b64_tr_b16 v[182:183], v250 offset:18944
v_mfma_f32_16x16x32_bf16 a[28:31], v[236:239], v[156:159], a[28:31]
s_waitcnt lgkmcnt(4)
v_mfma_f32_16x16x32_bf16 a[32:35], v[240:243], v[128:131], a[32:35]
ds_read_b128 v[224:227], v248 offset:34816
v_mfma_f32_16x16x32_bf16 a[32:35], v[244:247], v[144:147], a[32:35]
v_exp_f32 v197, v197
v_mfma_f32_16x16x32_bf16 a[36:39], v[240:243], v[132:135], a[36:39]
v_exp_f32 v198, v198
v_mfma_f32_16x16x32_bf16 a[36:39], v[244:247], v[148:151], a[36:39]
v_exp_f32 v199, v199
v_mfma_f32_16x16x32_bf16 a[40:43], v[240:243], v[136:139], a[40:43]
ds_read_b128 v[228:231], v248 offset:35328
v_cvt_pk_bf16_f32 v164, v196, v197
v_mfma_f32_16x16x32_bf16 a[40:43], v[244:247], v[152:155], a[40:43]
v_cvt_pk_bf16_f32 v165, v198, v199
v_mfma_f32_16x16x32_bf16 a[44:47], v[240:243], v[140:143], a[44:47]
v_exp_f32 v200, v200
v_mfma_f32_16x16x32_bf16 a[44:47], v[244:247], v[156:159], a[44:47]
s_waitcnt lgkmcnt(2)
v_mfma_f32_16x16x32_bf16 a[48:51], v[176:179], v[128:131], a[48:51]
ds_read_b128 v[232:235], v248 offset:38912
v_mfma_f32_16x16x32_bf16 a[48:51], v[180:183], v[144:147], a[48:51]
v_exp_f32 v201, v201
v_mfma_f32_16x16x32_bf16 a[52:55], v[176:179], v[132:135], a[52:55]
v_exp_f32 v202, v202
v_mfma_f32_16x16x32_bf16 a[52:55], v[180:183], v[148:151], a[52:55]
v_exp_f32 v203, v203
v_mfma_f32_16x16x32_bf16 a[56:59], v[176:179], v[136:139], a[56:59]
ds_read_b128 v[236:239], v248 offset:39424
v_cvt_pk_bf16_f32 v168, v200, v201
v_mfma_f32_16x16x32_bf16 a[56:59], v[180:183], v[152:155], a[56:59]
v_cvt_pk_bf16_f32 v169, v202, v203
v_mfma_f32_16x16x32_bf16 a[60:63], v[176:179], v[140:143], a[60:63]
v_exp_f32 v204, v204
v_mfma_f32_16x16x32_bf16 a[60:63], v[180:183], v[156:159], a[60:63]
s_waitcnt lgkmcnt(2)
v_mfma_f32_16x16x32_bf16 v[208:211], v[224:227], v[0:3], 0
ds_read_b128 v[240:243], v248 offset:43008
v_mfma_f32_16x16x32_bf16 v[208:211], v[228:231], v[4:7], v[208:211]
v_exp_f32 v205, v205
v_mfma_f32_16x16x32_bf16 v[212:215], v[224:227], v[32:35], 0
v_exp_f32 v206, v206
v_mfma_f32_16x16x32_bf16 v[212:215], v[228:231], v[36:39], v[212:215]
v_exp_f32 v207, v207
v_mfma_f32_16x16x32_bf16 v[216:219], v[224:227], v[64:67], 0
ds_read_b128 v[244:247], v248 offset:43520
v_cvt_pk_bf16_f32 v172, v204, v205
v_mfma_f32_16x16x32_bf16 v[216:219], v[228:231], v[68:71], v[216:219]
v_cvt_pk_bf16_f32 v173, v206, v207
v_mfma_f32_16x16x32_bf16 v[220:223], v[224:227], v[96:99], 0
v_mfma_f32_16x16x32_bf16 v[220:223], v[228:231], v[100:103], v[220:223]
s_waitcnt lgkmcnt(2)
v_mfma_f32_16x16x32_bf16 v[208:211], v[232:235], v[8:11], v[208:211]
ds_read_b128 v[176:179], v248 offset:47104
v_mfma_f32_16x16x32_bf16 v[208:211], v[236:239], v[12:15], v[208:211]
v_mfma_f32_16x16x32_bf16 v[212:215], v[232:235], v[40:43], v[212:215]
v_mfma_f32_16x16x32_bf16 v[212:215], v[236:239], v[44:47], v[212:215]
v_mfma_f32_16x16x32_bf16 v[216:219], v[232:235], v[72:75], v[216:219]
ds_read_b128 v[180:183], v248 offset:47616
v_mfma_f32_16x16x32_bf16 v[216:219], v[236:239], v[76:79], v[216:219]
v_mfma_f32_16x16x32_bf16 v[220:223], v[232:235], v[104:107], v[220:223]
v_mfma_f32_16x16x32_bf16 v[220:223], v[236:239], v[108:111], v[220:223]
s_waitcnt lgkmcnt(2)
v_mfma_f32_16x16x32_bf16 v[208:211], v[240:243], v[16:19], v[208:211]
ds_read_b64_tr_b16 v[224:225], v249 offset:4096
v_mfma_f32_16x16x32_bf16 v[208:211], v[244:247], v[20:23], v[208:211]
v_mfma_f32_16x16x32_bf16 v[212:215], v[240:243], v[48:51], v[212:215]
ds_read_b64_tr_b16 v[226:227], v249 offset:6144
v_mfma_f32_16x16x32_bf16 v[212:215], v[244:247], v[52:55], v[212:215]
v_mfma_f32_16x16x32_bf16 v[216:219], v[240:243], v[80:83], v[216:219]
ds_read_b64_tr_b16 v[228:229], v249 offset:20480
v_mfma_f32_16x16x32_bf16 v[216:219], v[244:247], v[84:87], v[216:219]
v_mfma_f32_16x16x32_bf16 v[220:223], v[240:243], v[112:115], v[220:223]
ds_read_b64_tr_b16 v[230:231], v249 offset:22528
v_mfma_f32_16x16x32_bf16 v[220:223], v[244:247], v[116:119], v[220:223]
s_waitcnt lgkmcnt(4)
v_mfma_f32_16x16x32_bf16 v[208:211], v[176:179], v[24:27], v[208:211]
ds_read_b64_tr_b16 v[232:233], v250 offset:4096
v_mfma_f32_16x16x32_bf16 v[208:211], v[180:183], v[28:31], v[208:211]
v_mfma_f32_16x16x32_bf16 v[212:215], v[176:179], v[56:59], v[212:215]
ds_read_b64_tr_b16 v[234:235], v250 offset:6144
v_mfma_f32_16x16x32_bf16 v[212:215], v[180:183], v[60:63], v[212:215]
v_mfma_f32_16x16x32_bf16 v[216:219], v[176:179], v[88:91], v[216:219]
ds_read_b64_tr_b16 v[236:237], v250 offset:20480
v_mfma_f32_16x16x32_bf16 v[216:219], v[180:183], v[92:95], v[216:219]
v_mfma_f32_16x16x32_bf16 v[220:223], v[176:179], v[120:123], v[220:223]
ds_read_b64_tr_b16 v[238:239], v250 offset:22528
v_mfma_f32_16x16x32_bf16 v[220:223], v[180:183], v[124:127], v[220:223]
s_waitcnt lgkmcnt(4)
v_mfma_f32_16x16x32_bf16 a[64:67], v[224:227], v[128:131], a[64:67]
ds_read_b64_tr_b16 v[240:241], v249 offset:4608
v_mfma_f32_16x16x32_bf16 a[64:67], v[228:231], v[144:147], a[64:67]
v_mfma_f32_16x16x32_bf16 a[68:71], v[224:227], v[132:135], a[68:71]
ds_read_b64_tr_b16 v[242:243], v249 offset:6656
v_mfma_f32_16x16x32_bf16 a[68:71], v[228:231], v[148:151], a[68:71]
v_exp_f32 v208, v208
v_mfma_f32_16x16x32_bf16 a[72:75], v[224:227], v[136:139], a[72:75]
ds_read_b64_tr_b16 v[244:245], v249 offset:20992
v_mfma_f32_16x16x32_bf16 a[72:75], v[228:231], v[152:155], a[72:75]
v_exp_f32 v209, v209
v_mfma_f32_16x16x32_bf16 a[76:79], v[224:227], v[140:143], a[76:79]
ds_read_b64_tr_b16 v[246:247], v249 offset:23040
v_cvt_pk_bf16_f32 v162, v208, v209
v_mfma_f32_16x16x32_bf16 a[76:79], v[228:231], v[156:159], a[76:79]
s_waitcnt lgkmcnt(4)
s_waitcnt vmcnt(0)
s_barrier
s_add_u32 m0, s30, 0x4000
v_mfma_f32_16x16x32_bf16 a[80:83], v[232:235], v[128:131], a[80:83]
ds_read_b64_tr_b16 v[224:225], v250 offset:4608
v_mfma_f32_16x16x32_bf16 a[80:83], v[236:239], v[144:147], a[80:83]
buffer_load_dwordx4 v251, s[12:15], s28 offen offset:0 lds
v_mfma_f32_16x16x32_bf16 a[84:87], v[232:235], v[132:135], a[84:87]
ds_read_b64_tr_b16 v[226:227], v250 offset:6656
v_mfma_f32_16x16x32_bf16 a[84:87], v[236:239], v[148:151], a[84:87]
v_exp_f32 v210, v210
v_mfma_f32_16x16x32_bf16 a[88:91], v[232:235], v[136:139], a[88:91]
ds_read_b64_tr_b16 v[228:229], v250 offset:20992
v_mfma_f32_16x16x32_bf16 a[88:91], v[236:239], v[152:155], a[88:91]
v_exp_f32 v211, v211
v_mfma_f32_16x16x32_bf16 a[92:95], v[232:235], v[140:143], a[92:95]
ds_read_b64_tr_b16 v[230:231], v250 offset:23040
v_cvt_pk_bf16_f32 v163, v210, v211
v_mfma_f32_16x16x32_bf16 a[92:95], v[236:239], v[156:159], a[92:95]
s_waitcnt lgkmcnt(4)
v_mfma_f32_16x16x32_bf16 a[96:99], v[240:243], v[128:131], a[96:99]
ds_read_b128 v[232:235], v248 offset:49152
v_mfma_f32_16x16x32_bf16 a[96:99], v[244:247], v[144:147], a[96:99]
buffer_load_dwordx4 v251, s[12:15], s28 offen offset:1024 lds
v_mfma_f32_16x16x32_bf16 a[100:103], v[240:243], v[132:135], a[100:103]
v_exp_f32 v212, v212
v_mfma_f32_16x16x32_bf16 a[100:103], v[244:247], v[148:151], a[100:103]
v_exp_f32 v213, v213
v_mfma_f32_16x16x32_bf16 a[104:107], v[240:243], v[136:139], a[104:107]
ds_read_b128 v[236:239], v248 offset:49664
v_cvt_pk_bf16_f32 v166, v212, v213
v_mfma_f32_16x16x32_bf16 a[104:107], v[244:247], v[152:155], a[104:107]
v_exp_f32 v214, v214
v_mfma_f32_16x16x32_bf16 a[108:111], v[240:243], v[140:143], a[108:111]
v_exp_f32 v215, v215
v_mfma_f32_16x16x32_bf16 a[108:111], v[244:247], v[156:159], a[108:111]
s_waitcnt lgkmcnt(2)
v_cvt_pk_bf16_f32 v167, v214, v215
v_mfma_f32_16x16x32_bf16 a[112:115], v[224:227], v[128:131], a[112:115]
ds_read_b128 v[240:243], v248 offset:53248
v_mfma_f32_16x16x32_bf16 a[112:115], v[228:231], v[144:147], a[112:115]
buffer_load_dwordx4 v251, s[12:15], s28 offen offset:2048 lds
v_mfma_f32_16x16x32_bf16 a[116:119], v[224:227], v[132:135], a[116:119]
v_exp_f32 v216, v216
v_mfma_f32_16x16x32_bf16 a[116:119], v[228:231], v[148:151], a[116:119]
v_exp_f32 v217, v217
v_mfma_f32_16x16x32_bf16 a[120:123], v[224:227], v[136:139], a[120:123]
ds_read_b128 v[244:247], v248 offset:53760
v_cvt_pk_bf16_f32 v170, v216, v217
v_mfma_f32_16x16x32_bf16 a[120:123], v[228:231], v[152:155], a[120:123]
v_exp_f32 v218, v218
v_mfma_f32_16x16x32_bf16 a[124:127], v[224:227], v[140:143], a[124:127]
v_exp_f32 v219, v219
v_mfma_f32_16x16x32_bf16 a[124:127], v[228:231], v[156:159], a[124:127]
s_waitcnt lgkmcnt(2)
v_cvt_pk_bf16_f32 v171, v218, v219
v_mfma_f32_16x16x32_bf16 v[192:195], v[232:235], v[0:3], 0
ds_read_b128 v[224:227], v248 offset:57344
v_mfma_f32_16x16x32_bf16 v[192:195], v[236:239], v[4:7], v[192:195]
buffer_load_dwordx4 v251, s[12:15], s28 offen offset:3072 lds
v_mfma_f32_16x16x32_bf16 v[196:199], v[232:235], v[32:35], 0
v_exp_f32 v220, v220
v_mfma_f32_16x16x32_bf16 v[196:199], v[236:239], v[36:39], v[196:199]
s_add_u32 s28, s28, 0x4000
v_mfma_f32_16x16x32_bf16 v[200:203], v[232:235], v[64:67], 0
ds_read_b128 v[228:231], v248 offset:57856
v_mfma_f32_16x16x32_bf16 v[200:203], v[236:239], v[68:71], v[200:203]
v_exp_f32 v221, v221
v_mfma_f32_16x16x32_bf16 v[204:207], v[232:235], v[96:99], 0
v_exp_f32 v222, v222
v_mfma_f32_16x16x32_bf16 v[204:207], v[236:239], v[100:103], v[204:207]
s_waitcnt lgkmcnt(2)
s_add_u32 m0, s30, 0x8000
v_mfma_f32_16x16x32_bf16 v[192:195], v[240:243], v[8:11], v[192:195]
ds_read_b128 v[232:235], v248 offset:61440
v_cvt_pk_bf16_f32 v174, v220, v221
v_mfma_f32_16x16x32_bf16 v[192:195], v[244:247], v[12:15], v[192:195]
buffer_load_dwordx4 v251, s[12:15], s28 offen offset:0 lds
v_mfma_f32_16x16x32_bf16 v[196:199], v[240:243], v[40:43], v[196:199]
v_exp_f32 v223, v223
v_mfma_f32_16x16x32_bf16 v[196:199], v[244:247], v[44:47], v[196:199]
v_mfma_f32_16x16x32_bf16 v[200:203], v[240:243], v[72:75], v[200:203]
ds_read_b128 v[236:239], v248 offset:61952
v_cvt_pk_bf16_f32 v175, v222, v223
v_mfma_f32_16x16x32_bf16 v[200:203], v[244:247], v[76:79], v[200:203]
v_mfma_f32_16x16x32_bf16 v[204:207], v[240:243], v[104:107], v[204:207]
v_mfma_f32_16x16x32_bf16 v[204:207], v[244:247], v[108:111], v[204:207]
s_waitcnt lgkmcnt(2)
v_mfma_f32_16x16x32_bf16 v[192:195], v[224:227], v[16:19], v[192:195]
ds_read_b64_tr_b16 v[240:241], v249 offset:8192
v_mfma_f32_16x16x32_bf16 v[192:195], v[228:231], v[20:23], v[192:195]
buffer_load_dwordx4 v251, s[12:15], s28 offen offset:1024 lds
v_mfma_f32_16x16x32_bf16 v[196:199], v[224:227], v[48:51], v[196:199]
ds_read_b64_tr_b16 v[242:243], v249 offset:10240
v_mfma_f32_16x16x32_bf16 v[196:199], v[228:231], v[52:55], v[196:199]
v_mfma_f32_16x16x32_bf16 v[200:203], v[224:227], v[80:83], v[200:203]
ds_read_b64_tr_b16 v[244:245], v249 offset:24576
v_mfma_f32_16x16x32_bf16 v[200:203], v[228:231], v[84:87], v[200:203]
v_mfma_f32_16x16x32_bf16 v[204:207], v[224:227], v[112:115], v[204:207]
ds_read_b64_tr_b16 v[246:247], v249 offset:26624
v_mfma_f32_16x16x32_bf16 v[204:207], v[228:231], v[116:119], v[204:207]
s_waitcnt lgkmcnt(4)
v_mfma_f32_16x16x32_bf16 v[192:195], v[232:235], v[24:27], v[192:195]
ds_read_b64_tr_b16 v[224:225], v250 offset:8192
v_mfma_f32_16x16x32_bf16 v[192:195], v[236:239], v[28:31], v[192:195]
buffer_load_dwordx4 v251, s[12:15], s28 offen offset:2048 lds
v_mfma_f32_16x16x32_bf16 v[196:199], v[232:235], v[56:59], v[196:199]
ds_read_b64_tr_b16 v[226:227], v250 offset:10240
v_mfma_f32_16x16x32_bf16 v[196:199], v[236:239], v[60:63], v[196:199]
v_mfma_f32_16x16x32_bf16 v[200:203], v[232:235], v[88:91], v[200:203]
ds_read_b64_tr_b16 v[228:229], v250 offset:24576
v_mfma_f32_16x16x32_bf16 v[200:203], v[236:239], v[92:95], v[200:203]
v_mfma_f32_16x16x32_bf16 v[204:207], v[232:235], v[120:123], v[204:207]
ds_read_b64_tr_b16 v[230:231], v250 offset:26624
v_mfma_f32_16x16x32_bf16 v[204:207], v[236:239], v[124:127], v[204:207]
s_waitcnt lgkmcnt(4)
v_mfma_f32_16x16x32_bf16 a[128:131], v[240:243], v[128:131], a[128:131]
ds_read_b64_tr_b16 v[232:233], v249 offset:8704
v_mfma_f32_16x16x32_bf16 a[128:131], v[244:247], v[144:147], a[128:131]
buffer_load_dwordx4 v251, s[12:15], s28 offen offset:3072 lds
v_mfma_f32_16x16x32_bf16 a[132:135], v[240:243], v[132:135], a[132:135]
ds_read_b64_tr_b16 v[234:235], v249 offset:10752
v_mfma_f32_16x16x32_bf16 a[132:135], v[244:247], v[148:151], a[132:135]
s_add_u32 s28, s28, 0x4000
v_mfma_f32_16x16x32_bf16 a[136:139], v[240:243], v[136:139], a[136:139]
ds_read_b64_tr_b16 v[236:237], v249 offset:25088
v_mfma_f32_16x16x32_bf16 a[136:139], v[244:247], v[152:155], a[136:139]
v_exp_f32 v192, v192
v_mfma_f32_16x16x32_bf16 a[140:143], v[240:243], v[140:143], a[140:143]
ds_read_b64_tr_b16 v[238:239], v249 offset:27136
v_mfma_f32_16x16x32_bf16 a[140:143], v[244:247], v[156:159], a[140:143]
s_waitcnt lgkmcnt(4)
v_mfma_f32_16x16x32_bf16 a[144:147], v[224:227], v[128:131], a[144:147]
ds_read_b64_tr_b16 v[240:241], v250 offset:8704
v_mfma_f32_16x16x32_bf16 a[144:147], v[228:231], v[144:147], a[144:147]
v_exp_f32 v193, v193
v_mfma_f32_16x16x32_bf16 a[148:151], v[224:227], v[132:135], a[148:151]
ds_read_b64_tr_b16 v[242:243], v250 offset:10752
v_cvt_pk_bf16_f32 v176, v192, v193
v_mfma_f32_16x16x32_bf16 a[148:151], v[228:231], v[148:151], a[148:151]
v_exp_f32 v194, v194
v_mfma_f32_16x16x32_bf16 a[152:155], v[224:227], v[136:139], a[152:155]
ds_read_b64_tr_b16 v[244:245], v250 offset:25088
v_mfma_f32_16x16x32_bf16 a[152:155], v[228:231], v[152:155], a[152:155]
v_exp_f32 v195, v195
v_mfma_f32_16x16x32_bf16 a[156:159], v[224:227], v[140:143], a[156:159]
ds_read_b64_tr_b16 v[246:247], v250 offset:27136
v_cvt_pk_bf16_f32 v177, v194, v195
v_mfma_f32_16x16x32_bf16 a[156:159], v[228:231], v[156:159], a[156:159]
s_waitcnt lgkmcnt(4)
v_mfma_f32_16x16x32_bf16 a[160:163], v[232:235], v[128:131], a[160:163]
ds_read_b128 v[224:227], v248 offset:51200
v_mfma_f32_16x16x32_bf16 a[160:163], v[236:239], v[144:147], a[160:163]
v_exp_f32 v196, v196
v_mfma_f32_16x16x32_bf16 a[164:167], v[232:235], v[132:135], a[164:167]
v_exp_f32 v197, v197
v_mfma_f32_16x16x32_bf16 a[164:167], v[236:239], v[148:151], a[164:167]
v_exp_f32 v198, v198
v_mfma_f32_16x16x32_bf16 a[168:171], v[232:235], v[136:139], a[168:171]
ds_read_b128 v[228:231], v248 offset:51712
v_cvt_pk_bf16_f32 v180, v196, v197
v_mfma_f32_16x16x32_bf16 a[168:171], v[236:239], v[152:155], a[168:171]
v_exp_f32 v199, v199
v_mfma_f32_16x16x32_bf16 a[172:175], v[232:235], v[140:143], a[172:175]
v_exp_f32 v200, v200
v_mfma_f32_16x16x32_bf16 a[172:175], v[236:239], v[156:159], a[172:175]
s_waitcnt lgkmcnt(2)
v_cvt_pk_bf16_f32 v181, v198, v199
v_mfma_f32_16x16x32_bf16 a[176:179], v[240:243], v[128:131], a[176:179]
ds_read_b128 v[232:235], v248 offset:55296
v_mfma_f32_16x16x32_bf16 a[176:179], v[244:247], v[144:147], a[176:179]
v_exp_f32 v201, v201
v_mfma_f32_16x16x32_bf16 a[180:183], v[240:243], v[132:135], a[180:183]
v_exp_f32 v202, v202
v_mfma_f32_16x16x32_bf16 a[180:183], v[244:247], v[148:151], a[180:183]
v_exp_f32 v203, v203
v_mfma_f32_16x16x32_bf16 a[184:187], v[240:243], v[136:139], a[184:187]
ds_read_b128 v[236:239], v248 offset:55808
v_cvt_pk_bf16_f32 v184, v200, v201
v_mfma_f32_16x16x32_bf16 a[184:187], v[244:247], v[152:155], a[184:187]
v_cvt_pk_bf16_f32 v185, v202, v203
v_mfma_f32_16x16x32_bf16 a[188:191], v[240:243], v[140:143], a[188:191]
v_exp_f32 v204, v204
v_mfma_f32_16x16x32_bf16 a[188:191], v[244:247], v[156:159], a[188:191]
s_waitcnt lgkmcnt(2)
v_mfma_f32_16x16x32_bf16 v[208:211], v[224:227], v[0:3], 0
ds_read_b128 v[240:243], v248 offset:59392
v_mfma_f32_16x16x32_bf16 v[208:211], v[228:231], v[4:7], v[208:211]
v_exp_f32 v205, v205
v_mfma_f32_16x16x32_bf16 v[212:215], v[224:227], v[32:35], 0
v_exp_f32 v206, v206
v_mfma_f32_16x16x32_bf16 v[212:215], v[228:231], v[36:39], v[212:215]
v_exp_f32 v207, v207
v_mfma_f32_16x16x32_bf16 v[216:219], v[224:227], v[64:67], 0
ds_read_b128 v[244:247], v248 offset:59904
v_cvt_pk_bf16_f32 v188, v204, v205
v_mfma_f32_16x16x32_bf16 v[216:219], v[228:231], v[68:71], v[216:219]
v_cvt_pk_bf16_f32 v189, v206, v207
v_mfma_f32_16x16x32_bf16 v[220:223], v[224:227], v[96:99], 0
v_mfma_f32_16x16x32_bf16 v[220:223], v[228:231], v[100:103], v[220:223]
s_waitcnt lgkmcnt(2)
v_mfma_f32_16x16x32_bf16 v[208:211], v[232:235], v[8:11], v[208:211]
ds_read_b128 v[224:227], v248 offset:63488
v_mfma_f32_16x16x32_bf16 v[208:211], v[236:239], v[12:15], v[208:211]
v_mfma_f32_16x16x32_bf16 v[212:215], v[232:235], v[40:43], v[212:215]
v_mfma_f32_16x16x32_bf16 v[212:215], v[236:239], v[44:47], v[212:215]
v_mfma_f32_16x16x32_bf16 v[216:219], v[232:235], v[72:75], v[216:219]
ds_read_b128 v[228:231], v248 offset:64000
v_mfma_f32_16x16x32_bf16 v[216:219], v[236:239], v[76:79], v[216:219]
v_mfma_f32_16x16x32_bf16 v[220:223], v[232:235], v[104:107], v[220:223]
v_mfma_f32_16x16x32_bf16 v[220:223], v[236:239], v[108:111], v[220:223]
s_waitcnt lgkmcnt(2)
v_mfma_f32_16x16x32_bf16 v[208:211], v[240:243], v[16:19], v[208:211]
ds_read_b64_tr_b16 v[232:233], v249 offset:12288
v_mfma_f32_16x16x32_bf16 v[208:211], v[244:247], v[20:23], v[208:211]
v_mfma_f32_16x16x32_bf16 v[212:215], v[240:243], v[48:51], v[212:215]
ds_read_b64_tr_b16 v[234:235], v249 offset:14336
v_mfma_f32_16x16x32_bf16 v[212:215], v[244:247], v[52:55], v[212:215]
v_mfma_f32_16x16x32_bf16 v[216:219], v[240:243], v[80:83], v[216:219]
ds_read_b64_tr_b16 v[236:237], v249 offset:28672
v_mfma_f32_16x16x32_bf16 v[216:219], v[244:247], v[84:87], v[216:219]
v_mfma_f32_16x16x32_bf16 v[220:223], v[240:243], v[112:115], v[220:223]
ds_read_b64_tr_b16 v[238:239], v249 offset:30720
v_mfma_f32_16x16x32_bf16 v[220:223], v[244:247], v[116:119], v[220:223]
s_waitcnt lgkmcnt(4)
v_mfma_f32_16x16x32_bf16 v[208:211], v[224:227], v[24:27], v[208:211]
ds_read_b64_tr_b16 v[240:241], v250 offset:12288
v_mfma_f32_16x16x32_bf16 v[208:211], v[228:231], v[28:31], v[208:211]
v_mfma_f32_16x16x32_bf16 v[212:215], v[224:227], v[56:59], v[212:215]
ds_read_b64_tr_b16 v[242:243], v250 offset:14336
v_mfma_f32_16x16x32_bf16 v[212:215], v[228:231], v[60:63], v[212:215]
v_mfma_f32_16x16x32_bf16 v[216:219], v[224:227], v[88:91], v[216:219]
ds_read_b64_tr_b16 v[244:245], v250 offset:28672
v_mfma_f32_16x16x32_bf16 v[216:219], v[228:231], v[92:95], v[216:219]
v_mfma_f32_16x16x32_bf16 v[220:223], v[224:227], v[120:123], v[220:223]
ds_read_b64_tr_b16 v[246:247], v250 offset:30720
v_xor_b32 v248, 0x10000, v248
v_mfma_f32_16x16x32_bf16 v[220:223], v[228:231], v[124:127], v[220:223]
s_waitcnt lgkmcnt(4)
v_mfma_f32_16x16x32_bf16 a[192:195], v[232:235], v[128:131], a[192:195]
ds_read_b64_tr_b16 v[224:225], v249 offset:12800
v_mfma_f32_16x16x32_bf16 a[192:195], v[236:239], v[144:147], a[192:195]
v_mfma_f32_16x16x32_bf16 a[196:199], v[232:235], v[132:135], a[196:199]
ds_read_b64_tr_b16 v[226:227], v249 offset:14848
v_mfma_f32_16x16x32_bf16 a[196:199], v[236:239], v[148:151], a[196:199]
v_exp_f32 v208, v208
v_mfma_f32_16x16x32_bf16 a[200:203], v[232:235], v[136:139], a[200:203]
ds_read_b64_tr_b16 v[228:229], v249 offset:29184
v_mfma_f32_16x16x32_bf16 a[200:203], v[236:239], v[152:155], a[200:203]
v_exp_f32 v209, v209
v_mfma_f32_16x16x32_bf16 a[204:207], v[232:235], v[140:143], a[204:207]
ds_read_b64_tr_b16 v[230:231], v249 offset:31232
v_cvt_pk_bf16_f32 v178, v208, v209
v_mfma_f32_16x16x32_bf16 a[204:207], v[236:239], v[156:159], a[204:207]
s_waitcnt lgkmcnt(4)
v_mfma_f32_16x16x32_bf16 a[208:211], v[240:243], v[128:131], a[208:211]
ds_read_b64_tr_b16 v[232:233], v250 offset:12800
v_mfma_f32_16x16x32_bf16 a[208:211], v[244:247], v[144:147], a[208:211]
v_exp_f32 v210, v210
v_mfma_f32_16x16x32_bf16 a[212:215], v[240:243], v[132:135], a[212:215]
ds_read_b64_tr_b16 v[234:235], v250 offset:14848
v_mfma_f32_16x16x32_bf16 a[212:215], v[244:247], v[148:151], a[212:215]
v_exp_f32 v211, v211
v_mfma_f32_16x16x32_bf16 a[216:219], v[240:243], v[136:139], a[216:219]
ds_read_b64_tr_b16 v[236:237], v250 offset:29184
v_cvt_pk_bf16_f32 v179, v210, v211
v_mfma_f32_16x16x32_bf16 a[216:219], v[244:247], v[152:155], a[216:219]
v_exp_f32 v212, v212
v_mfma_f32_16x16x32_bf16 a[220:223], v[240:243], v[140:143], a[220:223]
ds_read_b64_tr_b16 v[238:239], v250 offset:31232
v_mfma_f32_16x16x32_bf16 a[220:223], v[244:247], v[156:159], a[220:223]
s_waitcnt lgkmcnt(4)
v_mfma_f32_16x16x32_bf16 a[224:227], v[224:227], v[128:131], a[224:227]
ds_read_b128 v[240:243], v248 offset:0
v_mfma_f32_16x16x32_bf16 a[224:227], v[228:231], v[144:147], a[224:227]
v_exp_f32 v213, v213
v_mfma_f32_16x16x32_bf16 a[228:231], v[224:227], v[132:135], a[228:231]
v_exp_f32 v214, v214
v_mfma_f32_16x16x32_bf16 a[228:231], v[228:231], v[148:151], a[228:231]
v_exp_f32 v215, v215
v_mfma_f32_16x16x32_bf16 a[232:235], v[224:227], v[136:139], a[232:235]
ds_read_b128 v[244:247], v248 offset:512
v_cvt_pk_bf16_f32 v182, v212, v213
v_mfma_f32_16x16x32_bf16 a[232:235], v[228:231], v[152:155], a[232:235]
v_cvt_pk_bf16_f32 v183, v214, v215
v_mfma_f32_16x16x32_bf16 a[236:239], v[224:227], v[140:143], a[236:239]
v_exp_f32 v216, v216
v_mfma_f32_16x16x32_bf16 a[236:239], v[228:231], v[156:159], a[236:239]
s_waitcnt lgkmcnt(2)
v_mfma_f32_16x16x32_bf16 a[240:243], v[232:235], v[128:131], a[240:243]
ds_read_b128 v[224:227], v248 offset:4096
v_mfma_f32_16x16x32_bf16 a[240:243], v[236:239], v[144:147], a[240:243]
v_exp_f32 v217, v217
v_mfma_f32_16x16x32_bf16 a[244:247], v[232:235], v[132:135], a[244:247]
v_exp_f32 v218, v218
v_mfma_f32_16x16x32_bf16 a[244:247], v[236:239], v[148:151], a[244:247]
v_exp_f32 v219, v219
v_mfma_f32_16x16x32_bf16 a[248:251], v[232:235], v[136:139], a[248:251]
ds_read_b128 v[228:231], v248 offset:4608
v_cvt_pk_bf16_f32 v186, v216, v217
v_mfma_f32_16x16x32_bf16 a[248:251], v[236:239], v[152:155], a[248:251]
v_cvt_pk_bf16_f32 v187, v218, v219
v_mfma_f32_16x16x32_bf16 a[252:255], v[232:235], v[140:143], a[252:255]
v_exp_f32 v220, v220
v_mfma_f32_16x16x32_bf16 a[252:255], v[236:239], v[156:159], a[252:255]
s_waitcnt lgkmcnt(2)
v_mfma_f32_16x16x32_bf16 v[192:195], v[240:243], v[0:3], 0
ds_read_b128 v[232:235], v248 offset:8192
v_mfma_f32_16x16x32_bf16 v[192:195], v[244:247], v[4:7], v[192:195]
v_exp_f32 v221, v221
v_mfma_f32_16x16x32_bf16 v[196:199], v[240:243], v[32:35], 0
v_exp_f32 v222, v222
v_mfma_f32_16x16x32_bf16 v[196:199], v[244:247], v[36:39], v[196:199]
v_exp_f32 v223, v223
v_mfma_f32_16x16x32_bf16 v[200:203], v[240:243], v[64:67], 0
ds_read_b128 v[236:239], v248 offset:8704
v_cvt_pk_bf16_f32 v190, v220, v221
v_mfma_f32_16x16x32_bf16 v[200:203], v[244:247], v[68:71], v[200:203]
v_cvt_pk_bf16_f32 v191, v222, v223
v_mfma_f32_16x16x32_bf16 v[204:207], v[240:243], v[96:99], 0
v_mfma_f32_16x16x32_bf16 v[204:207], v[244:247], v[100:103], v[204:207]
s_waitcnt lgkmcnt(2)
v_mfma_f32_16x16x32_bf16 v[192:195], v[224:227], v[8:11], v[192:195]
ds_read_b128 v[240:243], v248 offset:12288
v_mfma_f32_16x16x32_bf16 v[192:195], v[228:231], v[12:15], v[192:195]
v_mfma_f32_16x16x32_bf16 v[196:199], v[224:227], v[40:43], v[196:199]
v_mfma_f32_16x16x32_bf16 v[196:199], v[228:231], v[44:47], v[196:199]
v_mfma_f32_16x16x32_bf16 v[200:203], v[224:227], v[72:75], v[200:203]
ds_read_b128 v[244:247], v248 offset:12800
v_mfma_f32_16x16x32_bf16 v[200:203], v[228:231], v[76:79], v[200:203]
v_mfma_f32_16x16x32_bf16 v[204:207], v[224:227], v[104:107], v[204:207]
v_mfma_f32_16x16x32_bf16 v[204:207], v[228:231], v[108:111], v[204:207]
s_waitcnt lgkmcnt(2)
v_mfma_f32_16x16x32_bf16 v[192:195], v[232:235], v[16:19], v[192:195]
ds_read_b64_tr_b16 v[224:225], v249 offset:32768
v_mfma_f32_16x16x32_bf16 v[192:195], v[236:239], v[20:23], v[192:195]
v_mfma_f32_16x16x32_bf16 v[196:199], v[232:235], v[48:51], v[196:199]
ds_read_b64_tr_b16 v[226:227], v249 offset:34816
v_mfma_f32_16x16x32_bf16 v[196:199], v[236:239], v[52:55], v[196:199]
v_mfma_f32_16x16x32_bf16 v[200:203], v[232:235], v[80:83], v[200:203]
ds_read_b64_tr_b16 v[228:229], v249 offset:49152
v_mfma_f32_16x16x32_bf16 v[200:203], v[236:239], v[84:87], v[200:203]
v_mfma_f32_16x16x32_bf16 v[204:207], v[232:235], v[112:115], v[204:207]
ds_read_b64_tr_b16 v[230:231], v249 offset:51200
v_mfma_f32_16x16x32_bf16 v[204:207], v[236:239], v[116:119], v[204:207]
s_waitcnt lgkmcnt(4)
v_mfma_f32_16x16x32_bf16 v[192:195], v[240:243], v[24:27], v[192:195]
ds_read_b64_tr_b16 v[232:233], v250 offset:32768
v_mfma_f32_16x16x32_bf16 v[192:195], v[244:247], v[28:31], v[192:195]
v_mfma_f32_16x16x32_bf16 v[196:199], v[240:243], v[56:59], v[196:199]
ds_read_b64_tr_b16 v[234:235], v250 offset:34816
v_mfma_f32_16x16x32_bf16 v[196:199], v[244:247], v[60:63], v[196:199]
v_mfma_f32_16x16x32_bf16 v[200:203], v[240:243], v[88:91], v[200:203]
ds_read_b64_tr_b16 v[236:237], v250 offset:49152
v_mfma_f32_16x16x32_bf16 v[200:203], v[244:247], v[92:95], v[200:203]
s_sub_u32 s31, s31, 1
v_mfma_f32_16x16x32_bf16 v[204:207], v[240:243], v[120:123], v[204:207]
ds_read_b64_tr_b16 v[238:239], v250 offset:51200
v_mfma_f32_16x16x32_bf16 v[204:207], v[244:247], v[124:127], v[204:207]
s_cbranch_scc1 L2_tail_1
s_waitcnt lgkmcnt(4)
v_mfma_f32_16x16x32_bf16 a[0:3], v[224:227], v[160:163], a[0:3]
ds_read_b64_tr_b16 v[240:241], v249 offset:33280
v_mfma_f32_16x16x32_bf16 a[0:3], v[228:231], v[176:179], a[0:3]
v_mfma_f32_16x16x32_bf16 a[4:7], v[224:227], v[164:167], a[4:7]
ds_read_b64_tr_b16 v[242:243], v249 offset:35328
v_mfma_f32_16x16x32_bf16 a[4:7], v[228:231], v[180:183], a[4:7]
v_exp_f32 v192, v192
v_mfma_f32_16x16x32_bf16 a[8:11], v[224:227], v[168:171], a[8:11]
ds_read_b64_tr_b16 v[244:245], v249 offset:49664
v_mfma_f32_16x16x32_bf16 a[8:11], v[228:231], v[184:187], a[8:11]
v_exp_f32 v193, v193
v_mfma_f32_16x16x32_bf16 a[12:15], v[224:227], v[172:175], a[12:15]
ds_read_b64_tr_b16 v[246:247], v249 offset:51712
v_cvt_pk_bf16_f32 v128, v192, v193
v_mfma_f32_16x16x32_bf16 a[12:15], v[228:231], v[188:191], a[12:15]
s_waitcnt lgkmcnt(4)
v_mfma_f32_16x16x32_bf16 a[16:19], v[232:235], v[160:163], a[16:19]
ds_read_b64_tr_b16 v[144:145], v250 offset:33280
v_mfma_f32_16x16x32_bf16 a[16:19], v[236:239], v[176:179], a[16:19]
v_exp_f32 v194, v194
v_mfma_f32_16x16x32_bf16 a[20:23], v[232:235], v[164:167], a[20:23]
ds_read_b64_tr_b16 v[146:147], v250 offset:35328
v_mfma_f32_16x16x32_bf16 a[20:23], v[236:239], v[180:183], a[20:23]
v_exp_f32 v195, v195
v_mfma_f32_16x16x32_bf16 a[24:27], v[232:235], v[168:171], a[24:27]
ds_read_b64_tr_b16 v[148:149], v250 offset:49664
v_cvt_pk_bf16_f32 v129, v194, v195
v_mfma_f32_16x16x32_bf16 a[24:27], v[236:239], v[184:187], a[24:27]
v_exp_f32 v196, v196
v_mfma_f32_16x16x32_bf16 a[28:31], v[232:235], v[172:175], a[28:31]
ds_read_b64_tr_b16 v[150:151], v250 offset:51712
v_mfma_f32_16x16x32_bf16 a[28:31], v[236:239], v[188:191], a[28:31]
s_waitcnt lgkmcnt(4)
v_mfma_f32_16x16x32_bf16 a[32:35], v[240:243], v[160:163], a[32:35]
ds_read_b128 v[224:227], v248 offset:2048
v_mfma_f32_16x16x32_bf16 a[32:35], v[244:247], v[176:179], a[32:35]
v_exp_f32 v197, v197
v_mfma_f32_16x16x32_bf16 a[36:39], v[240:243], v[164:167], a[36:39]
v_exp_f32 v198, v198
v_mfma_f32_16x16x32_bf16 a[36:39], v[244:247], v[180:183], a[36:39]
v_exp_f32 v199, v199
v_mfma_f32_16x16x32_bf16 a[40:43], v[240:243], v[168:171], a[40:43]
ds_read_b128 v[228:231], v248 offset:2560
v_cvt_pk_bf16_f32 v132, v196, v197
v_mfma_f32_16x16x32_bf16 a[40:43], v[244:247], v[184:187], a[40:43]
v_cvt_pk_bf16_f32 v133, v198, v199
v_mfma_f32_16x16x32_bf16 a[44:47], v[240:243], v[172:175], a[44:47]
v_exp_f32 v200, v200
v_mfma_f32_16x16x32_bf16 a[44:47], v[244:247], v[188:191], a[44:47]
s_waitcnt lgkmcnt(2)
v_mfma_f32_16x16x32_bf16 a[48:51], v[144:147], v[160:163], a[48:51]
ds_read_b128 v[232:235], v248 offset:6144
v_mfma_f32_16x16x32_bf16 a[48:51], v[148:151], v[176:179], a[48:51]
v_exp_f32 v201, v201
v_mfma_f32_16x16x32_bf16 a[52:55], v[144:147], v[164:167], a[52:55]
v_exp_f32 v202, v202
v_mfma_f32_16x16x32_bf16 a[52:55], v[148:151], v[180:183], a[52:55]
v_exp_f32 v203, v203
v_mfma_f32_16x16x32_bf16 a[56:59], v[144:147], v[168:171], a[56:59]
ds_read_b128 v[236:239], v248 offset:6656
v_cvt_pk_bf16_f32 v136, v200, v201
v_mfma_f32_16x16x32_bf16 a[56:59], v[148:151], v[184:187], a[56:59]
v_cvt_pk_bf16_f32 v137, v202, v203
v_mfma_f32_16x16x32_bf16 a[60:63], v[144:147], v[172:175], a[60:63]
v_exp_f32 v204, v204
v_mfma_f32_16x16x32_bf16 a[60:63], v[148:151], v[188:191], a[60:63]
s_waitcnt lgkmcnt(2)
v_mfma_f32_16x16x32_bf16 v[208:211], v[224:227], v[0:3], 0
ds_read_b128 v[240:243], v248 offset:10240
v_mfma_f32_16x16x32_bf16 v[208:211], v[228:231], v[4:7], v[208:211]
v_exp_f32 v205, v205
v_mfma_f32_16x16x32_bf16 v[212:215], v[224:227], v[32:35], 0
v_exp_f32 v206, v206
v_mfma_f32_16x16x32_bf16 v[212:215], v[228:231], v[36:39], v[212:215]
v_exp_f32 v207, v207
v_mfma_f32_16x16x32_bf16 v[216:219], v[224:227], v[64:67], 0
ds_read_b128 v[244:247], v248 offset:10752
v_cvt_pk_bf16_f32 v140, v204, v205
v_mfma_f32_16x16x32_bf16 v[216:219], v[228:231], v[68:71], v[216:219]
v_cvt_pk_bf16_f32 v141, v206, v207
v_mfma_f32_16x16x32_bf16 v[220:223], v[224:227], v[96:99], 0
v_mfma_f32_16x16x32_bf16 v[220:223], v[228:231], v[100:103], v[220:223]
s_waitcnt lgkmcnt(2)
v_mfma_f32_16x16x32_bf16 v[208:211], v[232:235], v[8:11], v[208:211]
ds_read_b128 v[144:147], v248 offset:14336
v_mfma_f32_16x16x32_bf16 v[208:211], v[236:239], v[12:15], v[208:211]
v_mfma_f32_16x16x32_bf16 v[212:215], v[232:235], v[40:43], v[212:215]
v_mfma_f32_16x16x32_bf16 v[212:215], v[236:239], v[44:47], v[212:215]
v_mfma_f32_16x16x32_bf16 v[216:219], v[232:235], v[72:75], v[216:219]
ds_read_b128 v[148:151], v248 offset:14848
v_mfma_f32_16x16x32_bf16 v[216:219], v[236:239], v[76:79], v[216:219]
v_mfma_f32_16x16x32_bf16 v[220:223], v[232:235], v[104:107], v[220:223]
v_mfma_f32_16x16x32_bf16 v[220:223], v[236:239], v[108:111], v[220:223]
s_waitcnt lgkmcnt(2)
v_mfma_f32_16x16x32_bf16 v[208:211], v[240:243], v[16:19], v[208:211]
ds_read_b64_tr_b16 v[224:225], v249 offset:36864
v_mfma_f32_16x16x32_bf16 v[208:211], v[244:247], v[20:23], v[208:211]
v_mfma_f32_16x16x32_bf16 v[212:215], v[240:243], v[48:51], v[212:215]
ds_read_b64_tr_b16 v[226:227], v249 offset:38912
v_mfma_f32_16x16x32_bf16 v[212:215], v[244:247], v[52:55], v[212:215]
v_mfma_f32_16x16x32_bf16 v[216:219], v[240:243], v[80:83], v[216:219]
ds_read_b64_tr_b16 v[228:229], v249 offset:53248
v_mfma_f32_16x16x32_bf16 v[216:219], v[244:247], v[84:87], v[216:219]
v_mfma_f32_16x16x32_bf16 v[220:223], v[240:243], v[112:115], v[220:223]
ds_read_b64_tr_b16 v[230:231], v249 offset:55296
v_mfma_f32_16x16x32_bf16 v[220:223], v[244:247], v[116:119], v[220:223]
s_waitcnt lgkmcnt(4)
v_mfma_f32_16x16x32_bf16 v[208:211], v[144:147], v[24:27], v[208:211]
ds_read_b64_tr_b16 v[232:233], v250 offset:36864
v_mfma_f32_16x16x32_bf16 v[208:211], v[148:151], v[28:31], v[208:211]
v_mfma_f32_16x16x32_bf16 v[212:215], v[144:147], v[56:59], v[212:215]
ds_read_b64_tr_b16 v[234:235], v250 offset:38912
v_mfma_f32_16x16x32_bf16 v[212:215], v[148:151], v[60:63], v[212:215]
v_mfma_f32_16x16x32_bf16 v[216:219], v[144:147], v[88:91], v[216:219]
ds_read_b64_tr_b16 v[236:237], v250 offset:53248
v_mfma_f32_16x16x32_bf16 v[216:219], v[148:151], v[92:95], v[216:219]
v_mfma_f32_16x16x32_bf16 v[220:223], v[144:147], v[120:123], v[220:223]
ds_read_b64_tr_b16 v[238:239], v250 offset:55296
v_mfma_f32_16x16x32_bf16 v[220:223], v[148:151], v[124:127], v[220:223]
s_waitcnt lgkmcnt(4)
v_mfma_f32_16x16x32_bf16 a[64:67], v[224:227], v[160:163], a[64:67]
ds_read_b64_tr_b16 v[240:241], v249 offset:37376
v_mfma_f32_16x16x32_bf16 a[64:67], v[228:231], v[176:179], a[64:67]
v_mfma_f32_16x16x32_bf16 a[68:71], v[224:227], v[164:167], a[68:71]
ds_read_b64_tr_b16 v[242:243], v249 offset:39424
v_mfma_f32_16x16x32_bf16 a[68:71], v[228:231], v[180:183], a[68:71]
v_exp_f32 v208, v208
v_mfma_f32_16x16x32_bf16 a[72:75], v[224:227], v[168:171], a[72:75]
ds_read_b64_tr_b16 v[244:245], v249 offset:53760
v_mfma_f32_16x16x32_bf16 a[72:75], v[228:231], v[184:187], a[72:75]
v_exp_f32 v209, v209
v_mfma_f32_16x16x32_bf16 a[76:79], v[224:227], v[172:175], a[76:79]
ds_read_b64_tr_b16 v[246:247], v249 offset:55808
v_cvt_pk_bf16_f32 v130, v208, v209
v_mfma_f32_16x16x32_bf16 a[76:79], v[228:231], v[188:191], a[76:79]
s_waitcnt lgkmcnt(4)
s_waitcnt vmcnt(0)
s_barrier
s_add_u32 m0, s30, 0xc000
v_mfma_f32_16x16x32_bf16 a[80:83], v[232:235], v[160:163], a[80:83]
ds_read_b64_tr_b16 v[224:225], v250 offset:37376
v_mfma_f32_16x16x32_bf16 a[80:83], v[236:239], v[176:179], a[80:83]
buffer_load_dwordx4 v251, s[12:15], s28 offen offset:0 lds
v_mfma_f32_16x16x32_bf16 a[84:87], v[232:235], v[164:167], a[84:87]
ds_read_b64_tr_b16 v[226:227], v250 offset:39424
v_mfma_f32_16x16x32_bf16 a[84:87], v[236:239], v[180:183], a[84:87]
v_exp_f32 v210, v210
v_mfma_f32_16x16x32_bf16 a[88:91], v[232:235], v[168:171], a[88:91]
ds_read_b64_tr_b16 v[228:229], v250 offset:53760
v_mfma_f32_16x16x32_bf16 a[88:91], v[236:239], v[184:187], a[88:91]
v_exp_f32 v211, v211
v_mfma_f32_16x16x32_bf16 a[92:95], v[232:235], v[172:175], a[92:95]
ds_read_b64_tr_b16 v[230:231], v250 offset:55808
v_cvt_pk_bf16_f32 v131, v210, v211
v_mfma_f32_16x16x32_bf16 a[92:95], v[236:239], v[188:191], a[92:95]
s_waitcnt lgkmcnt(4)
v_mfma_f32_16x16x32_bf16 a[96:99], v[240:243], v[160:163], a[96:99]
ds_read_b128 v[232:235], v248 offset:16384
v_mfma_f32_16x16x32_bf16 a[96:99], v[244:247], v[176:179], a[96:99]
buffer_load_dwordx4 v251, s[12:15], s28 offen offset:1024 lds
v_mfma_f32_16x16x32_bf16 a[100:103], v[240:243], v[164:167], a[100:103]
v_exp_f32 v212, v212
v_mfma_f32_16x16x32_bf16 a[100:103], v[244:247], v[180:183], a[100:103]
v_exp_f32 v213, v213
v_mfma_f32_16x16x32_bf16 a[104:107], v[240:243], v[168:171], a[104:107]
ds_read_b128 v[236:239], v248 offset:16896
v_cvt_pk_bf16_f32 v134, v212, v213
v_mfma_f32_16x16x32_bf16 a[104:107], v[244:247], v[184:187], a[104:107]
v_exp_f32 v214, v214
v_mfma_f32_16x16x32_bf16 a[108:111], v[240:243], v[172:175], a[108:111]
v_exp_f32 v215, v215
v_mfma_f32_16x16x32_bf16 a[108:111], v[244:247], v[188:191], a[108:111]
s_waitcnt lgkmcnt(2)
v_cvt_pk_bf16_f32 v135, v214, v215
v_mfma_f32_16x16x32_bf16 a[112:115], v[224:227], v[160:163], a[112:115]
ds_read_b128 v[240:243], v248 offset:20480
v_mfma_f32_16x16x32_bf16 a[112:115], v[228:231], v[176:179], a[112:115]
buffer_load_dwordx4 v251, s[12:15], s28 offen offset:2048 lds
v_mfma_f32_16x16x32_bf16 a[116:119], v[224:227], v[164:167], a[116:119]
v_exp_f32 v216, v216
v_mfma_f32_16x16x32_bf16 a[116:119], v[228:231], v[180:183], a[116:119]
v_exp_f32 v217, v217
v_mfma_f32_16x16x32_bf16 a[120:123], v[224:227], v[168:171], a[120:123]
ds_read_b128 v[244:247], v248 offset:20992
v_cvt_pk_bf16_f32 v138, v216, v217
v_mfma_f32_16x16x32_bf16 a[120:123], v[228:231], v[184:187], a[120:123]
v_exp_f32 v218, v218
v_mfma_f32_16x16x32_bf16 a[124:127], v[224:227], v[172:175], a[124:127]
v_exp_f32 v219, v219
v_mfma_f32_16x16x32_bf16 a[124:127], v[228:231], v[188:191], a[124:127]
s_waitcnt lgkmcnt(2)
v_cvt_pk_bf16_f32 v139, v218, v219
v_mfma_f32_16x16x32_bf16 v[192:195], v[232:235], v[0:3], 0
ds_read_b128 v[224:227], v248 offset:24576
v_mfma_f32_16x16x32_bf16 v[192:195], v[236:239], v[4:7], v[192:195]
buffer_load_dwordx4 v251, s[12:15], s28 offen offset:3072 lds
v_mfma_f32_16x16x32_bf16 v[196:199], v[232:235], v[32:35], 0
s_xor_b32 s30, s30, 0x10000
v_mfma_f32_16x16x32_bf16 v[196:199], v[236:239], v[36:39], v[196:199]
s_add_u32 s28, s28, 0x4000
v_mfma_f32_16x16x32_bf16 v[200:203], v[232:235], v[64:67], 0
ds_read_b128 v[228:231], v248 offset:25088
v_mfma_f32_16x16x32_bf16 v[200:203], v[236:239], v[68:71], v[200:203]
v_exp_f32 v220, v220
v_mfma_f32_16x16x32_bf16 v[204:207], v[232:235], v[96:99], 0
v_exp_f32 v221, v221
v_mfma_f32_16x16x32_bf16 v[204:207], v[236:239], v[100:103], v[204:207]
s_waitcnt lgkmcnt(2)
s_add_u32 m0, s30, 0x0
v_mfma_f32_16x16x32_bf16 v[192:195], v[240:243], v[8:11], v[192:195]
ds_read_b128 v[232:235], v248 offset:28672
v_cvt_pk_bf16_f32 v142, v220, v221
v_mfma_f32_16x16x32_bf16 v[192:195], v[244:247], v[12:15], v[192:195]
buffer_load_dwordx4 v251, s[12:15], s28 offen offset:0 lds
v_mfma_f32_16x16x32_bf16 v[196:199], v[240:243], v[40:43], v[196:199]
v_exp_f32 v222, v222
v_mfma_f32_16x16x32_bf16 v[196:199], v[244:247], v[44:47], v[196:199]
v_exp_f32 v223, v223
v_mfma_f32_16x16x32_bf16 v[200:203], v[240:243], v[72:75], v[200:203]
ds_read_b128 v[236:239], v248 offset:29184
v_cvt_pk_bf16_f32 v143, v222, v223
v_mfma_f32_16x16x32_bf16 v[200:203], v[244:247], v[76:79], v[200:203]
v_mfma_f32_16x16x32_bf16 v[204:207], v[240:243], v[104:107], v[204:207]
v_mfma_f32_16x16x32_bf16 v[204:207], v[244:247], v[108:111], v[204:207]
s_waitcnt lgkmcnt(2)
v_mfma_f32_16x16x32_bf16 v[192:195], v[224:227], v[16:19], v[192:195]
ds_read_b64_tr_b16 v[240:241], v249 offset:40960
v_mfma_f32_16x16x32_bf16 v[192:195], v[228:231], v[20:23], v[192:195]
buffer_load_dwordx4 v251, s[12:15], s28 offen offset:1024 lds
v_mfma_f32_16x16x32_bf16 v[196:199], v[224:227], v[48:51], v[196:199]
ds_read_b64_tr_b16 v[242:243], v249 offset:43008
v_mfma_f32_16x16x32_bf16 v[196:199], v[228:231], v[52:55], v[196:199]
v_mfma_f32_16x16x32_bf16 v[200:203], v[224:227], v[80:83], v[200:203]
ds_read_b64_tr_b16 v[244:245], v249 offset:57344
v_mfma_f32_16x16x32_bf16 v[200:203], v[228:231], v[84:87], v[200:203]
v_mfma_f32_16x16x32_bf16 v[204:207], v[224:227], v[112:115], v[204:207]
ds_read_b64_tr_b16 v[246:247], v249 offset:59392
v_mfma_f32_16x16x32_bf16 v[204:207], v[228:231], v[116:119], v[204:207]
s_waitcnt lgkmcnt(4)
v_mfma_f32_16x16x32_bf16 v[192:195], v[232:235], v[24:27], v[192:195]
ds_read_b64_tr_b16 v[224:225], v250 offset:40960
v_mfma_f32_16x16x32_bf16 v[192:195], v[236:239], v[28:31], v[192:195]
buffer_load_dwordx4 v251, s[12:15], s28 offen offset:2048 lds
v_mfma_f32_16x16x32_bf16 v[196:199], v[232:235], v[56:59], v[196:199]
ds_read_b64_tr_b16 v[226:227], v250 offset:43008
v_mfma_f32_16x16x32_bf16 v[196:199], v[236:239], v[60:63], v[196:199]
v_mfma_f32_16x16x32_bf16 v[200:203], v[232:235], v[88:91], v[200:203]
ds_read_b64_tr_b16 v[228:229], v250 offset:57344
v_mfma_f32_16x16x32_bf16 v[200:203], v[236:239], v[92:95], v[200:203]
v_mfma_f32_16x16x32_bf16 v[204:207], v[232:235], v[120:123], v[204:207]
ds_read_b64_tr_b16 v[230:231], v250 offset:59392
v_mfma_f32_16x16x32_bf16 v[204:207], v[236:239], v[124:127], v[204:207]
s_waitcnt lgkmcnt(4)
v_mfma_f32_16x16x32_bf16 a[128:131], v[240:243], v[160:163], a[128:131]
ds_read_b64_tr_b16 v[232:233], v249 offset:41472
v_mfma_f32_16x16x32_bf16 a[128:131], v[244:247], v[176:179], a[128:131]
buffer_load_dwordx4 v251, s[12:15], s28 offen offset:3072 lds
v_mfma_f32_16x16x32_bf16 a[132:135], v[240:243], v[164:167], a[132:135]
ds_read_b64_tr_b16 v[234:235], v249 offset:43520
v_mfma_f32_16x16x32_bf16 a[132:135], v[244:247], v[180:183], a[132:135]
s_add_u32 s28, s28, 0x4000
v_mfma_f32_16x16x32_bf16 a[136:139], v[240:243], v[168:171], a[136:139]
ds_read_b64_tr_b16 v[236:237], v249 offset:57856
v_mfma_f32_16x16x32_bf16 a[136:139], v[244:247], v[184:187], a[136:139]
v_exp_f32 v192, v192
v_mfma_f32_16x16x32_bf16 a[140:143], v[240:243], v[172:175], a[140:143]
ds_read_b64_tr_b16 v[238:239], v249 offset:59904
v_mfma_f32_16x16x32_bf16 a[140:143], v[244:247], v[188:191], a[140:143]
s_waitcnt lgkmcnt(4)
v_mfma_f32_16x16x32_bf16 a[144:147], v[224:227], v[160:163], a[144:147]
ds_read_b64_tr_b16 v[240:241], v250 offset:41472
v_mfma_f32_16x16x32_bf16 a[144:147], v[228:231], v[176:179], a[144:147]
v_exp_f32 v193, v193
v_mfma_f32_16x16x32_bf16 a[148:151], v[224:227], v[164:167], a[148:151]
ds_read_b64_tr_b16 v[242:243], v250 offset:43520
v_cvt_pk_bf16_f32 v144, v192, v193
v_mfma_f32_16x16x32_bf16 a[148:151], v[228:231], v[180:183], a[148:151]
v_exp_f32 v194, v194
v_mfma_f32_16x16x32_bf16 a[152:155], v[224:227], v[168:171], a[152:155]
ds_read_b64_tr_b16 v[244:245], v250 offset:57856
v_mfma_f32_16x16x32_bf16 a[152:155], v[228:231], v[184:187], a[152:155]
v_exp_f32 v195, v195
v_mfma_f32_16x16x32_bf16 a[156:159], v[224:227], v[172:175], a[156:159]
ds_read_b64_tr_b16 v[246:247], v250 offset:59904
v_cvt_pk_bf16_f32 v145, v194, v195
v_mfma_f32_16x16x32_bf16 a[156:159], v[228:231], v[188:191], a[156:159]
s_waitcnt lgkmcnt(4)
v_mfma_f32_16x16x32_bf16 a[160:163], v[232:235], v[160:163], a[160:163]
ds_read_b128 v[224:227], v248 offset:18432
v_mfma_f32_16x16x32_bf16 a[160:163], v[236:239], v[176:179], a[160:163]
v_exp_f32 v196, v196
v_mfma_f32_16x16x32_bf16 a[164:167], v[232:235], v[164:167], a[164:167]
v_exp_f32 v197, v197
v_mfma_f32_16x16x32_bf16 a[164:167], v[236:239], v[180:183], a[164:167]
v_exp_f32 v198, v198
v_mfma_f32_16x16x32_bf16 a[168:171], v[232:235], v[168:171], a[168:171]
ds_read_b128 v[228:231], v248 offset:18944
v_cvt_pk_bf16_f32 v148, v196, v197
v_mfma_f32_16x16x32_bf16 a[168:171], v[236:239], v[184:187], a[168:171]
v_exp_f32 v199, v199
v_mfma_f32_16x16x32_bf16 a[172:175], v[232:235], v[172:175], a[172:175]
v_exp_f32 v200, v200
v_mfma_f32_16x16x32_bf16 a[172:175], v[236:239], v[188:191], a[172:175]
s_waitcnt lgkmcnt(2)
v_cvt_pk_bf16_f32 v149, v198, v199
v_mfma_f32_16x16x32_bf16 a[176:179], v[240:243], v[160:163], a[176:179]
ds_read_b128 v[232:235], v248 offset:22528
v_mfma_f32_16x16x32_bf16 a[176:179], v[244:247], v[176:179], a[176:179]
v_exp_f32 v201, v201
v_mfma_f32_16x16x32_bf16 a[180:183], v[240:243], v[164:167], a[180:183]
v_exp_f32 v202, v202
v_mfma_f32_16x16x32_bf16 a[180:183], v[244:247], v[180:183], a[180:183]
v_exp_f32 v203, v203
v_mfma_f32_16x16x32_bf16 a[184:187], v[240:243], v[168:171], a[184:187]
ds_read_b128 v[236:239], v248 offset:23040
v_cvt_pk_bf16_f32 v152, v200, v201
v_mfma_f32_16x16x32_bf16 a[184:187], v[244:247], v[184:187], a[184:187]
v_cvt_pk_bf16_f32 v153, v202, v203
v_mfma_f32_16x16x32_bf16 a[188:191], v[240:243], v[172:175], a[188:191]
v_exp_f32 v204, v204
v_mfma_f32_16x16x32_bf16 a[188:191], v[244:247], v[188:191], a[188:191]
s_waitcnt lgkmcnt(2)
v_mfma_f32_16x16x32_bf16 v[208:211], v[224:227], v[0:3], 0
ds_read_b128 v[240:243], v248 offset:26624
v_mfma_f32_16x16x32_bf16 v[208:211], v[228:231], v[4:7], v[208:211]
v_exp_f32 v205, v205
v_mfma_f32_16x16x32_bf16 v[212:215], v[224:227], v[32:35], 0
v_exp_f32 v206, v206
v_mfma_f32_16x16x32_bf16 v[212:215], v[228:231], v[36:39], v[212:215]
v_exp_f32 v207, v207
v_mfma_f32_16x16x32_bf16 v[216:219], v[224:227], v[64:67], 0
ds_read_b128 v[244:247], v248 offset:27136
v_cvt_pk_bf16_f32 v156, v204, v205
v_mfma_f32_16x16x32_bf16 v[216:219], v[228:231], v[68:71], v[216:219]
v_cvt_pk_bf16_f32 v157, v206, v207
v_mfma_f32_16x16x32_bf16 v[220:223], v[224:227], v[96:99], 0
v_mfma_f32_16x16x32_bf16 v[220:223], v[228:231], v[100:103], v[220:223]
s_waitcnt lgkmcnt(2)
v_mfma_f32_16x16x32_bf16 v[208:211], v[232:235], v[8:11], v[208:211]
ds_read_b128 v[224:227], v248 offset:30720
v_mfma_f32_16x16x32_bf16 v[208:211], v[236:239], v[12:15], v[208:211]
v_mfma_f32_16x16x32_bf16 v[212:215], v[232:235], v[40:43], v[212:215]
v_mfma_f32_16x16x32_bf16 v[212:215], v[236:239], v[44:47], v[212:215]
v_mfma_f32_16x16x32_bf16 v[216:219], v[232:235], v[72:75], v[216:219]
ds_read_b128 v[228:231], v248 offset:31232
v_mfma_f32_16x16x32_bf16 v[216:219], v[236:239], v[76:79], v[216:219]
v_mfma_f32_16x16x32_bf16 v[220:223], v[232:235], v[104:107], v[220:223]
v_mfma_f32_16x16x32_bf16 v[220:223], v[236:239], v[108:111], v[220:223]
s_waitcnt lgkmcnt(2)
v_mfma_f32_16x16x32_bf16 v[208:211], v[240:243], v[16:19], v[208:211]
ds_read_b64_tr_b16 v[232:233], v249 offset:45056
v_mfma_f32_16x16x32_bf16 v[208:211], v[244:247], v[20:23], v[208:211]
v_mfma_f32_16x16x32_bf16 v[212:215], v[240:243], v[48:51], v[212:215]
ds_read_b64_tr_b16 v[234:235], v249 offset:47104
v_mfma_f32_16x16x32_bf16 v[212:215], v[244:247], v[52:55], v[212:215]
v_mfma_f32_16x16x32_bf16 v[216:219], v[240:243], v[80:83], v[216:219]
ds_read_b64_tr_b16 v[236:237], v249 offset:61440
v_mfma_f32_16x16x32_bf16 v[216:219], v[244:247], v[84:87], v[216:219]
v_mfma_f32_16x16x32_bf16 v[220:223], v[240:243], v[112:115], v[220:223]
ds_read_b64_tr_b16 v[238:239], v249 offset:63488
v_mfma_f32_16x16x32_bf16 v[220:223], v[244:247], v[116:119], v[220:223]
s_waitcnt lgkmcnt(4)
v_mfma_f32_16x16x32_bf16 v[208:211], v[224:227], v[24:27], v[208:211]
ds_read_b64_tr_b16 v[240:241], v250 offset:45056
v_mfma_f32_16x16x32_bf16 v[208:211], v[228:231], v[28:31], v[208:211]
v_mfma_f32_16x16x32_bf16 v[212:215], v[224:227], v[56:59], v[212:215]
ds_read_b64_tr_b16 v[242:243], v250 offset:47104
v_mfma_f32_16x16x32_bf16 v[212:215], v[228:231], v[60:63], v[212:215]
v_mfma_f32_16x16x32_bf16 v[216:219], v[224:227], v[88:91], v[216:219]
ds_read_b64_tr_b16 v[244:245], v250 offset:61440
v_mfma_f32_16x16x32_bf16 v[216:219], v[228:231], v[92:95], v[216:219]
v_mfma_f32_16x16x32_bf16 v[220:223], v[224:227], v[120:123], v[220:223]
ds_read_b64_tr_b16 v[246:247], v250 offset:63488
v_mfma_f32_16x16x32_bf16 v[220:223], v[228:231], v[124:127], v[220:223]
s_waitcnt lgkmcnt(4)
v_mfma_f32_16x16x32_bf16 a[192:195], v[232:235], v[160:163], a[192:195]
ds_read_b64_tr_b16 v[224:225], v249 offset:45568
v_mfma_f32_16x16x32_bf16 a[192:195], v[236:239], v[176:179], a[192:195]
v_mfma_f32_16x16x32_bf16 a[196:199], v[232:235], v[164:167], a[196:199]
ds_read_b64_tr_b16 v[226:227], v249 offset:47616
v_mfma_f32_16x16x32_bf16 a[196:199], v[236:239], v[180:183], a[196:199]
v_exp_f32 v208, v208
v_mfma_f32_16x16x32_bf16 a[200:203], v[232:235], v[168:171], a[200:203]
ds_read_b64_tr_b16 v[228:229], v249 offset:61952
v_mfma_f32_16x16x32_bf16 a[200:203], v[236:239], v[184:187], a[200:203]
v_exp_f32 v209, v209
v_mfma_f32_16x16x32_bf16 a[204:207], v[232:235], v[172:175], a[204:207]
ds_read_b64_tr_b16 v[230:231], v249 offset:64000
v_cvt_pk_bf16_f32 v146, v208, v209
v_mfma_f32_16x16x32_bf16 a[204:207], v[236:239], v[188:191], a[204:207]
s_waitcnt lgkmcnt(4)
v_mfma_f32_16x16x32_bf16 a[208:211], v[240:243], v[160:163], a[208:211]
ds_read_b64_tr_b16 v[232:233], v250 offset:45568
v_mfma_f32_16x16x32_bf16 a[208:211], v[244:247], v[176:179], a[208:211]
v_exp_f32 v210, v210
v_mfma_f32_16x16x32_bf16 a[212:215], v[240:243], v[164:167], a[212:215]
ds_read_b64_tr_b16 v[234:235], v250 offset:47616
v_mfma_f32_16x16x32_bf16 a[212:215], v[244:247], v[180:183], a[212:215]
v_exp_f32 v211, v211
v_mfma_f32_16x16x32_bf16 a[216:219], v[240:243], v[168:171], a[216:219]
ds_read_b64_tr_b16 v[236:237], v250 offset:61952
v_cvt_pk_bf16_f32 v147, v210, v211
v_mfma_f32_16x16x32_bf16 a[216:219], v[244:247], v[184:187], a[216:219]
v_exp_f32 v212, v212
v_mfma_f32_16x16x32_bf16 a[220:223], v[240:243], v[172:175], a[220:223]
ds_read_b64_tr_b16 v[238:239], v250 offset:64000
v_mfma_f32_16x16x32_bf16 a[220:223], v[244:247], v[188:191], a[220:223]
s_waitcnt lgkmcnt(4)
v_mfma_f32_16x16x32_bf16 a[224:227], v[224:227], v[160:163], a[224:227]
ds_read_b128 v[240:243], v248 offset:32768
v_mfma_f32_16x16x32_bf16 a[224:227], v[228:231], v[176:179], a[224:227]
v_exp_f32 v213, v213
v_mfma_f32_16x16x32_bf16 a[228:231], v[224:227], v[164:167], a[228:231]
v_exp_f32 v214, v214
v_mfma_f32_16x16x32_bf16 a[228:231], v[228:231], v[180:183], a[228:231]
v_exp_f32 v215, v215
v_mfma_f32_16x16x32_bf16 a[232:235], v[224:227], v[168:171], a[232:235]
ds_read_b128 v[244:247], v248 offset:33280
v_cvt_pk_bf16_f32 v150, v212, v213
v_mfma_f32_16x16x32_bf16 a[232:235], v[228:231], v[184:187], a[232:235]
v_cvt_pk_bf16_f32 v151, v214, v215
v_mfma_f32_16x16x32_bf16 a[236:239], v[224:227], v[172:175], a[236:239]
v_exp_f32 v216, v216
v_mfma_f32_16x16x32_bf16 a[236:239], v[228:231], v[188:191], a[236:239]
s_waitcnt lgkmcnt(2)
v_mfma_f32_16x16x32_bf16 a[240:243], v[232:235], v[160:163], a[240:243]
ds_read_b128 v[224:227], v248 offset:36864
v_mfma_f32_16x16x32_bf16 a[240:243], v[236:239], v[176:179], a[240:243]
v_exp_f32 v217, v217
v_mfma_f32_16x16x32_bf16 a[244:247], v[232:235], v[164:167], a[244:247]
v_exp_f32 v218, v218
v_mfma_f32_16x16x32_bf16 a[244:247], v[236:239], v[180:183], a[244:247]
v_exp_f32 v219, v219
v_mfma_f32_16x16x32_bf16 a[248:251], v[232:235], v[168:171], a[248:251]
ds_read_b128 v[228:231], v248 offset:37376
v_cvt_pk_bf16_f32 v154, v216, v217
v_mfma_f32_16x16x32_bf16 a[248:251], v[236:239], v[184:187], a[248:251]
v_cvt_pk_bf16_f32 v155, v218, v219
v_mfma_f32_16x16x32_bf16 a[252:255], v[232:235], v[172:175], a[252:255]
v_exp_f32 v220, v220
v_mfma_f32_16x16x32_bf16 a[252:255], v[236:239], v[188:191], a[252:255]
s_waitcnt lgkmcnt(2)
v_mfma_f32_16x16x32_bf16 v[192:195], v[240:243], v[0:3], 0
ds_read_b128 v[232:235], v248 offset:40960
v_mfma_f32_16x16x32_bf16 v[192:195], v[244:247], v[4:7], v[192:195]
v_xor_b32 v249, 0x10000, v249
v_mfma_f32_16x16x32_bf16 v[196:199], v[240:243], v[32:35], 0
v_exp_f32 v221, v221
v_mfma_f32_16x16x32_bf16 v[196:199], v[244:247], v[36:39], v[196:199]
v_xor_b32 v250, 0x10000, v250
v_cvt_pk_bf16_f32 v158, v220, v221
v_mfma_f32_16x16x32_bf16 v[200:203], v[240:243], v[64:67], 0
ds_read_b128 v[236:239], v248 offset:41472
v_mfma_f32_16x16x32_bf16 v[200:203], v[244:247], v[68:71], v[200:203]
v_exp_f32 v222, v222
v_mfma_f32_16x16x32_bf16 v[204:207], v[240:243], v[96:99], 0
v_exp_f32 v223, v223
v_mfma_f32_16x16x32_bf16 v[204:207], v[244:247], v[100:103], v[204:207]
s_waitcnt lgkmcnt(2)
v_cvt_pk_bf16_f32 v159, v222, v223
v_mfma_f32_16x16x32_bf16 v[192:195], v[224:227], v[8:11], v[192:195]
ds_read_b128 v[240:243], v248 offset:45056
v_mfma_f32_16x16x32_bf16 v[192:195], v[228:231], v[12:15], v[192:195]
v_mfma_f32_16x16x32_bf16 v[196:199], v[224:227], v[40:43], v[196:199]
v_mfma_f32_16x16x32_bf16 v[196:199], v[228:231], v[44:47], v[196:199]
v_mfma_f32_16x16x32_bf16 v[200:203], v[224:227], v[72:75], v[200:203]
ds_read_b128 v[244:247], v248 offset:45568
v_mfma_f32_16x16x32_bf16 v[200:203], v[228:231], v[76:79], v[200:203]
v_mfma_f32_16x16x32_bf16 v[204:207], v[224:227], v[104:107], v[204:207]
v_mfma_f32_16x16x32_bf16 v[204:207], v[228:231], v[108:111], v[204:207]
s_waitcnt lgkmcnt(2)
v_mfma_f32_16x16x32_bf16 v[192:195], v[232:235], v[16:19], v[192:195]
ds_read_b64_tr_b16 v[224:225], v249 offset:0
v_mfma_f32_16x16x32_bf16 v[192:195], v[236:239], v[20:23], v[192:195]
v_mfma_f32_16x16x32_bf16 v[196:199], v[232:235], v[48:51], v[196:199]
ds_read_b64_tr_b16 v[226:227], v249 offset:2048
v_mfma_f32_16x16x32_bf16 v[196:199], v[236:239], v[52:55], v[196:199]
v_mfma_f32_16x16x32_bf16 v[200:203], v[232:235], v[80:83], v[200:203]
ds_read_b64_tr_b16 v[228:229], v249 offset:16384
v_mfma_f32_16x16x32_bf16 v[200:203], v[236:239], v[84:87], v[200:203]
v_mfma_f32_16x16x32_bf16 v[204:207], v[232:235], v[112:115], v[204:207]
ds_read_b64_tr_b16 v[230:231], v249 offset:18432
v_mfma_f32_16x16x32_bf16 v[204:207], v[236:239], v[116:119], v[204:207]
s_waitcnt lgkmcnt(4)
v_mfma_f32_16x16x32_bf16 v[192:195], v[240:243], v[24:27], v[192:195]
ds_read_b64_tr_b16 v[232:233], v250 offset:0
v_mfma_f32_16x16x32_bf16 v[192:195], v[244:247], v[28:31], v[192:195]
v_mfma_f32_16x16x32_bf16 v[196:199], v[240:243], v[56:59], v[196:199]
ds_read_b64_tr_b16 v[234:235], v250 offset:2048
v_mfma_f32_16x16x32_bf16 v[196:199], v[244:247], v[60:63], v[196:199]
v_mfma_f32_16x16x32_bf16 v[200:203], v[240:243], v[88:91], v[200:203]
ds_read_b64_tr_b16 v[236:237], v250 offset:16384
v_mfma_f32_16x16x32_bf16 v[200:203], v[244:247], v[92:95], v[200:203]
s_sub_u32 s31, s31, 1
v_mfma_f32_16x16x32_bf16 v[204:207], v[240:243], v[120:123], v[204:207]
ds_read_b64_tr_b16 v[238:239], v250 offset:18432
v_mfma_f32_16x16x32_bf16 v[204:207], v[244:247], v[124:127], v[204:207]
s_cbranch_scc0 L2_loop
L2_tails:
L2_tail_1:
s_cmp_eq_u32 s59, 7
s_cbranch_scc1 L2_tail_1_7
L2_tail_1_6:
s_waitcnt lgkmcnt(4)
v_mfma_f32_16x16x32_bf16 a[0:3], v[224:227], v[160:163], a[0:3]
ds_read_b128 v[240:243], v248 offset:2048
v_mfma_f32_16x16x32_bf16 a[0:3], v[228:231], v[176:179], a[0:3]
s_lshl_b32 s36, s34, 13
v_mfma_f32_16x16x32_bf16 a[4:7], v[224:227], v[164:167], a[4:7]
s_add_u32 s56, s4, 0x1000000
s_addc_u32 s57, s5, 0
v_mfma_f32_16x16x32_bf16 a[4:7], v[228:231], v[180:183], a[4:7]
s_add_u32 s36, s36, 0x20000
s_mov_b32 s58, 0x6c02000
v_mfma_f32_16x16x32_bf16 a[8:11], v[224:227], v[168:171], a[8:11]
ds_read_b128 v[244:247], v248 offset:2560
s_mov_b32 s59, 0x00020000
v_mfma_f32_16x16x32_bf16 a[8:11], v[228:231], v[184:187], a[8:11]
v_add_u32 v255, s36, v252
s_lshr_b32 s35, s2, 1
v_mfma_f32_16x16x32_bf16 a[12:15], v[224:227], v[172:175], a[12:15]
s_and_b32 s35, s35, 28
s_add_u32 s35, s35, s34
v_mfma_f32_16x16x32_bf16 a[12:15], v[228:231], v[188:191], a[12:15]
s_waitcnt lgkmcnt(2)
s_lshl_b32 s35, s35, 13
v_mfma_f32_16x16x32_bf16 a[16:19], v[232:235], v[160:163], a[16:19]
ds_read_b128 v[224:227], v248 offset:6144
v_lshlrev_b32 v253, 3, v252
v_mfma_f32_16x16x32_bf16 a[16:19], v[236:239], v[176:179], a[16:19]
buffer_load_dword v253, v253, s[56:59], s35 offen
ds_write_b128 v255, v[160:163] offset:0
v_mfma_f32_16x16x32_bf16 a[20:23], v[232:235], v[164:167], a[20:23]
v_exp_f32 v192, v192
v_mfma_f32_16x16x32_bf16 a[20:23], v[236:239], v[180:183], a[20:23]
v_exp_f32 v193, v193
v_mfma_f32_16x16x32_bf16 a[24:27], v[232:235], v[168:171], a[24:27]
ds_read_b128 v[228:231], v248 offset:6656
v_cvt_pk_bf16_f32 v128, v192, v193
v_mfma_f32_16x16x32_bf16 a[24:27], v[236:239], v[184:187], a[24:27]
v_exp_f32 v194, v194
v_mfma_f32_16x16x32_bf16 a[28:31], v[232:235], v[172:175], a[28:31]
v_exp_f32 v195, v195
v_mfma_f32_16x16x32_bf16 a[28:31], v[236:239], v[188:191], a[28:31]
s_waitcnt lgkmcnt(3)
v_cvt_pk_bf16_f32 v129, v194, v195
v_mfma_f32_16x16x32_bf16 v[208:211], v[240:243], v[0:3], 0
ds_read_b128 v[232:235], v248 offset:10240
ds_write_b128 v255, v[164:167] offset:1024
v_mfma_f32_16x16x32_bf16 v[208:211], v[244:247], v[4:7], v[208:211]
v_exp_f32 v196, v196
v_mfma_f32_16x16x32_bf16 v[212:215], v[240:243], v[32:35], 0
v_exp_f32 v197, v197
v_mfma_f32_16x16x32_bf16 v[212:215], v[244:247], v[36:39], v[212:215]
v_exp_f32 v198, v198
v_mfma_f32_16x16x32_bf16 v[216:219], v[240:243], v[64:67], 0
ds_read_b128 v[236:239], v248 offset:10752
v_cvt_pk_bf16_f32 v132, v196, v197
v_mfma_f32_16x16x32_bf16 v[216:219], v[244:247], v[68:71], v[216:219]
v_exp_f32 v199, v199
v_mfma_f32_16x16x32_bf16 v[220:223], v[240:243], v[96:99], 0
v_exp_f32 v200, v200
v_mfma_f32_16x16x32_bf16 v[220:223], v[244:247], v[100:103], v[220:223]
s_waitcnt lgkmcnt(3)
v_cvt_pk_bf16_f32 v133, v198, v199
v_mfma_f32_16x16x32_bf16 v[208:211], v[224:227], v[8:11], v[208:211]
ds_read_b128 v[240:243], v248 offset:14336
ds_write_b128 v255, v[168:171] offset:2048
v_mfma_f32_16x16x32_bf16 v[208:211], v[228:231], v[12:15], v[208:211]
v_exp_f32 v201, v201
v_mfma_f32_16x16x32_bf16 v[212:215], v[224:227], v[40:43], v[212:215]
v_exp_f32 v202, v202
v_mfma_f32_16x16x32_bf16 v[212:215], v[228:231], v[44:47], v[212:215]
v_exp_f32 v203, v203
v_mfma_f32_16x16x32_bf16 v[216:219], v[224:227], v[72:75], v[216:219]
ds_read_b128 v[244:247], v248 offset:14848
v_cvt_pk_bf16_f32 v136, v200, v201
v_mfma_f32_16x16x32_bf16 v[216:219], v[228:231], v[76:79], v[216:219]
v_cvt_pk_bf16_f32 v137, v202, v203
ds_write_b128 v255, v[172:175] offset:3072
v_mfma_f32_16x16x32_bf16 v[220:223], v[224:227], v[104:107], v[220:223]
v_exp_f32 v204, v204
v_mfma_f32_16x16x32_bf16 v[220:223], v[228:231], v[108:111], v[220:223]
s_waitcnt lgkmcnt(4)
s_waitcnt vmcnt(1)
s_barrier
v_mfma_f32_16x16x32_bf16 v[208:211], v[232:235], v[16:19], v[208:211]
ds_read_b128 v[224:227], v248 offset:16384
s_add_u32 m0, s30, 0xc000
v_mfma_f32_16x16x32_bf16 v[208:211], v[236:239], v[20:23], v[208:211]
s_and_b32 s100, s30, 0x10000
buffer_load_dwordx4 v251, s[12:15], s28 offen offset:0 lds
v_mfma_f32_16x16x32_bf16 v[212:215], v[232:235], v[48:51], v[212:215]
s_xor_b32 s100, s100, 0x10000
v_mfma_f32_16x16x32_bf16 v[212:215], v[236:239], v[52:55], v[212:215]
v_exp_f32 v205, v205
v_mfma_f32_16x16x32_bf16 v[216:219], v[232:235], v[80:83], v[216:219]
ds_read_b128 v[228:231], v248 offset:16896
v_cvt_pk_bf16_f32 v140, v204, v205
v_mfma_f32_16x16x32_bf16 v[216:219], v[236:239], v[84:87], v[216:219]
v_exp_f32 v206, v206
v_mfma_f32_16x16x32_bf16 v[220:223], v[232:235], v[112:115], v[220:223]
v_exp_f32 v207, v207
v_mfma_f32_16x16x32_bf16 v[220:223], v[236:239], v[116:119], v[220:223]
s_waitcnt lgkmcnt(3)
v_cvt_pk_bf16_f32 v141, v206, v207
v_mfma_f32_16x16x32_bf16 v[208:211], v[240:243], v[24:27], v[208:211]
ds_read_b128 v[232:235], v248 offset:20480
buffer_load_dwordx4 v251, s[12:15], s28 offen offset:1024 lds
v_mfma_f32_16x16x32_bf16 v[208:211], v[244:247], v[28:31], v[208:211]
v_mfma_f32_16x16x32_bf16 v[212:215], v[240:243], v[56:59], v[212:215]
buffer_load_dwordx4 v251, s[12:15], s28 offen offset:2048 lds
v_mfma_f32_16x16x32_bf16 v[212:215], v[244:247], v[60:63], v[212:215]
v_mfma_f32_16x16x32_bf16 v[216:219], v[240:243], v[88:91], v[216:219]
ds_read_b128 v[236:239], v248 offset:20992
buffer_load_dwordx4 v251, s[12:15], s28 offen offset:3072 lds
v_mfma_f32_16x16x32_bf16 v[216:219], v[244:247], v[92:95], v[216:219]
v_mfma_f32_16x16x32_bf16 v[220:223], v[240:243], v[120:123], v[220:223]
s_add_u32 s28, s28, 0x4000
v_mfma_f32_16x16x32_bf16 v[220:223], v[244:247], v[124:127], v[220:223]
s_waitcnt lgkmcnt(2)
v_mfma_f32_16x16x32_bf16 v[192:195], v[224:227], v[0:3], 0
ds_read_b128 v[240:243], v248 offset:24576
v_mfma_f32_16x16x32_bf16 v[192:195], v[228:231], v[4:7], v[192:195]
v_exp_f32 v208, v208
v_mfma_f32_16x16x32_bf16 v[196:199], v[224:227], v[32:35], 0
v_exp_f32 v209, v209
v_mfma_f32_16x16x32_bf16 v[196:199], v[228:231], v[36:39], v[196:199]
v_exp_f32 v210, v210
v_mfma_f32_16x16x32_bf16 v[200:203], v[224:227], v[64:67], 0
ds_read_b128 v[244:247], v248 offset:25088
v_cvt_pk_bf16_f32 v130, v208, v209
v_mfma_f32_16x16x32_bf16 v[200:203], v[228:231], v[68:71], v[200:203]
v_exp_f32 v211, v211
v_mfma_f32_16x16x32_bf16 v[204:207], v[224:227], v[96:99], 0
v_exp_f32 v212, v212
v_mfma_f32_16x16x32_bf16 v[204:207], v[228:231], v[100:103], v[204:207]
s_waitcnt lgkmcnt(2)
v_cvt_pk_bf16_f32 v131, v210, v211
v_mfma_f32_16x16x32_bf16 v[192:195], v[232:235], v[8:11], v[192:195]
ds_read_b128 v[224:227], v248 offset:28672
v_mfma_f32_16x16x32_bf16 v[192:195], v[236:239], v[12:15], v[192:195]
v_exp_f32 v213, v213
v_mfma_f32_16x16x32_bf16 v[196:199], v[232:235], v[40:43], v[196:199]
v_exp_f32 v214, v214
v_mfma_f32_16x16x32_bf16 v[196:199], v[236:239], v[44:47], v[196:199]
v_exp_f32 v215, v215
v_mfma_f32_16x16x32_bf16 v[200:203], v[232:235], v[72:75], v[200:203]
ds_read_b128 v[228:231], v248 offset:29184
v_cvt_pk_bf16_f32 v134, v212, v213
v_mfma_f32_16x16x32_bf16 v[200:203], v[236:239], v[76:79], v[200:203]
v_cvt_pk_bf16_f32 v135, v214, v215
v_mfma_f32_16x16x32_bf16 v[204:207], v[232:235], v[104:107], v[204:207]
v_exp_f32 v216, v216
v_mfma_f32_16x16x32_bf16 v[204:207], v[236:239], v[108:111], v[204:207]
s_waitcnt lgkmcnt(2)
v_mfma_f32_16x16x32_bf16 v[192:195], v[240:243], v[16:19], v[192:195]
ds_read_b128 v[232:235], v248 offset:18432
v_mfma_f32_16x16x32_bf16 v[192:195], v[244:247], v[20:23], v[192:195]
v_exp_f32 v217, v217
v_mfma_f32_16x16x32_bf16 v[196:199], v[240:243], v[48:51], v[196:199]
v_exp_f32 v218, v218
v_mfma_f32_16x16x32_bf16 v[196:199], v[244:247], v[52:55], v[196:199]
v_exp_f32 v219, v219
v_mfma_f32_16x16x32_bf16 v[200:203], v[240:243], v[80:83], v[200:203]
ds_read_b128 v[236:239], v248 offset:18944
v_cvt_pk_bf16_f32 v138, v216, v217
v_mfma_f32_16x16x32_bf16 v[200:203], v[244:247], v[84:87], v[200:203]
v_cvt_pk_bf16_f32 v139, v218, v219
v_mfma_f32_16x16x32_bf16 v[204:207], v[240:243], v[112:115], v[204:207]
v_exp_f32 v220, v220
v_mfma_f32_16x16x32_bf16 v[204:207], v[244:247], v[116:119], v[204:207]
s_waitcnt lgkmcnt(2)
v_mfma_f32_16x16x32_bf16 v[192:195], v[224:227], v[24:27], v[192:195]
ds_read_b128 v[240:243], v248 offset:22528
v_mfma_f32_16x16x32_bf16 v[192:195], v[228:231], v[28:31], v[192:195]
v_exp_f32 v221, v221
v_mfma_f32_16x16x32_bf16 v[196:199], v[224:227], v[56:59], v[196:199]
v_exp_f32 v222, v222
v_mfma_f32_16x16x32_bf16 v[196:199], v[228:231], v[60:63], v[196:199]
v_exp_f32 v223, v223
v_mfma_f32_16x16x32_bf16 v[200:203], v[224:227], v[88:91], v[200:203]
ds_read_b128 v[244:247], v248 offset:23040
v_cvt_pk_bf16_f32 v142, v220, v221
v_mfma_f32_16x16x32_bf16 v[200:203], v[228:231], v[92:95], v[200:203]
v_cvt_pk_bf16_f32 v143, v222, v223
v_mfma_f32_16x16x32_bf16 v[204:207], v[224:227], v[120:123], v[204:207]
v_mfma_f32_16x16x32_bf16 v[204:207], v[228:231], v[124:127], v[204:207]
s_waitcnt lgkmcnt(2)
v_mfma_f32_16x16x32_bf16 v[208:211], v[232:235], v[0:3], 0
ds_read_b128 v[224:227], v248 offset:26624
v_mfma_f32_16x16x32_bf16 v[208:211], v[236:239], v[4:7], v[208:211]
v_exp_f32 v192, v192
v_mfma_f32_16x16x32_bf16 v[212:215], v[232:235], v[32:35], 0
v_exp_f32 v193, v193
v_mfma_f32_16x16x32_bf16 v[212:215], v[236:239], v[36:39], v[212:215]
v_exp_f32 v194, v194
v_mfma_f32_16x16x32_bf16 v[216:219], v[232:235], v[64:67], 0
ds_read_b128 v[228:231], v248 offset:27136
v_cvt_pk_bf16_f32 v144, v192, v193
v_mfma_f32_16x16x32_bf16 v[216:219], v[236:239], v[68:71], v[216:219]
v_exp_f32 v195, v195
v_mfma_f32_16x16x32_bf16 v[220:223], v[232:235], v[96:99], 0
v_exp_f32 v196, v196
v_mfma_f32_16x16x32_bf16 v[220:223], v[236:239], v[100:103], v[220:223]
s_waitcnt lgkmcnt(2)
v_cvt_pk_bf16_f32 v145, v194, v195
v_mfma_f32_16x16x32_bf16 v[208:211], v[240:243], v[8:11], v[208:211]
ds_read_b128 v[232:235], v248 offset:30720
v_mfma_f32_16x16x32_bf16 v[208:211], v[244:247], v[12:15], v[208:211]
v_exp_f32 v197, v197
v_mfma_f32_16x16x32_bf16 v[212:215], v[240:243], v[40:43], v[212:215]
v_exp_f32 v198, v198
v_mfma_f32_16x16x32_bf16 v[212:215], v[244:247], v[44:47], v[212:215]
v_exp_f32 v199, v199
v_mfma_f32_16x16x32_bf16 v[216:219], v[240:243], v[72:75], v[216:219]
ds_read_b128 v[236:239], v248 offset:31232
v_cvt_pk_bf16_f32 v148, v196, v197
v_mfma_f32_16x16x32_bf16 v[216:219], v[244:247], v[76:79], v[216:219]
v_cvt_pk_bf16_f32 v149, v198, v199
v_mfma_f32_16x16x32_bf16 v[220:223], v[240:243], v[104:107], v[220:223]
v_exp_f32 v200, v200
v_mfma_f32_16x16x32_bf16 v[220:223], v[244:247], v[108:111], v[220:223]
s_waitcnt lgkmcnt(2)
v_mfma_f32_16x16x32_bf16 v[208:211], v[224:227], v[16:19], v[208:211]
ds_read_b128 v[240:243], v248 offset:32768
v_mfma_f32_16x16x32_bf16 v[208:211], v[228:231], v[20:23], v[208:211]
v_exp_f32 v201, v201
v_mfma_f32_16x16x32_bf16 v[212:215], v[224:227], v[48:51], v[212:215]
v_exp_f32 v202, v202
v_mfma_f32_16x16x32_bf16 v[212:215], v[228:231], v[52:55], v[212:215]
v_exp_f32 v203, v203
v_mfma_f32_16x16x32_bf16 v[216:219], v[224:227], v[80:83], v[216:219]
ds_read_b128 v[244:247], v248 offset:33280
v_cvt_pk_bf16_f32 v152, v200, v201
v_mfma_f32_16x16x32_bf16 v[216:219], v[228:231], v[84:87], v[216:219]
v_cvt_pk_bf16_f32 v153, v202, v203
v_mfma_f32_16x16x32_bf16 v[220:223], v[224:227], v[112:115], v[220:223]
v_exp_f32 v204, v204
v_mfma_f32_16x16x32_bf16 v[220:223], v[228:231], v[116:119], v[220:223]
s_waitcnt lgkmcnt(2)
v_mfma_f32_16x16x32_bf16 v[208:211], v[232:235], v[24:27], v[208:211]
ds_read_b128 v[224:227], v248 offset:36864
v_mfma_f32_16x16x32_bf16 v[208:211], v[236:239], v[28:31], v[208:211]
v_exp_f32 v205, v205
v_mfma_f32_16x16x32_bf16 v[212:215], v[232:235], v[56:59], v[212:215]
v_exp_f32 v206, v206
v_mfma_f32_16x16x32_bf16 v[212:215], v[236:239], v[60:63], v[212:215]
v_exp_f32 v207, v207
v_mfma_f32_16x16x32_bf16 v[216:219], v[232:235], v[88:91], v[216:219]
ds_read_b128 v[228:231], v248 offset:37376
v_cvt_pk_bf16_f32 v156, v204, v205
v_mfma_f32_16x16x32_bf16 v[216:219], v[236:239], v[92:95], v[216:219]
v_cvt_pk_bf16_f32 v157, v206, v207
v_mfma_f32_16x16x32_bf16 v[220:223], v[232:235], v[120:123], v[220:223]
v_mfma_f32_16x16x32_bf16 v[220:223], v[236:239], v[124:127], v[220:223]
s_waitcnt lgkmcnt(2)
v_mfma_f32_16x16x32_bf16 v[192:195], v[240:243], v[0:3], 0
ds_read_b128 v[232:235], v248 offset:40960
v_mfma_f32_16x16x32_bf16 v[192:195], v[244:247], v[4:7], v[192:195]
v_exp_f32 v208, v208
v_mfma_f32_16x16x32_bf16 v[196:199], v[240:243], v[32:35], 0
v_exp_f32 v209, v209
v_mfma_f32_16x16x32_bf16 v[196:199], v[244:247], v[36:39], v[196:199]
v_exp_f32 v210, v210
v_mfma_f32_16x16x32_bf16 v[200:203], v[240:243], v[64:67], 0
ds_read_b128 v[236:239], v248 offset:41472
v_cvt_pk_bf16_f32 v146, v208, v209
v_mfma_f32_16x16x32_bf16 v[200:203], v[244:247], v[68:71], v[200:203]
v_exp_f32 v211, v211
v_mfma_f32_16x16x32_bf16 v[204:207], v[240:243], v[96:99], 0
v_exp_f32 v212, v212
v_mfma_f32_16x16x32_bf16 v[204:207], v[244:247], v[100:103], v[204:207]
s_waitcnt lgkmcnt(2)
v_cvt_pk_bf16_f32 v147, v210, v211
v_mfma_f32_16x16x32_bf16 v[192:195], v[224:227], v[8:11], v[192:195]
ds_read_b128 v[240:243], v248 offset:45056
v_mfma_f32_16x16x32_bf16 v[192:195], v[228:231], v[12:15], v[192:195]
v_exp_f32 v213, v213
v_mfma_f32_16x16x32_bf16 v[196:199], v[224:227], v[40:43], v[196:199]
v_exp_f32 v214, v214
v_mfma_f32_16x16x32_bf16 v[196:199], v[228:231], v[44:47], v[196:199]
v_exp_f32 v215, v215
v_mfma_f32_16x16x32_bf16 v[200:203], v[224:227], v[72:75], v[200:203]
ds_read_b128 v[244:247], v248 offset:45568
v_cvt_pk_bf16_f32 v150, v212, v213
v_mfma_f32_16x16x32_bf16 v[200:203], v[228:231], v[76:79], v[200:203]
v_cvt_pk_bf16_f32 v151, v214, v215
v_mfma_f32_16x16x32_bf16 v[204:207], v[224:227], v[104:107], v[204:207]
v_exp_f32 v216, v216
v_mfma_f32_16x16x32_bf16 v[204:207], v[228:231], v[108:111], v[204:207]
s_waitcnt lgkmcnt(2)
v_mfma_f32_16x16x32_bf16 v[192:195], v[232:235], v[16:19], v[192:195]
ds_read_b128 v[224:227], v248 offset:34816
v_mfma_f32_16x16x32_bf16 v[192:195], v[236:239], v[20:23], v[192:195]
v_exp_f32 v217, v217
v_mfma_f32_16x16x32_bf16 v[196:199], v[232:235], v[48:51], v[196:199]
v_exp_f32 v218, v218
v_mfma_f32_16x16x32_bf16 v[196:199], v[236:239], v[52:55], v[196:199]
v_exp_f32 v219, v219
v_mfma_f32_16x16x32_bf16 v[200:203], v[232:235], v[80:83], v[200:203]
ds_read_b128 v[228:231], v248 offset:35328
v_cvt_pk_bf16_f32 v154, v216, v217
v_mfma_f32_16x16x32_bf16 v[200:203], v[236:239], v[84:87], v[200:203]
v_cvt_pk_bf16_f32 v155, v218, v219
v_mfma_f32_16x16x32_bf16 v[204:207], v[232:235], v[112:115], v[204:207]
v_exp_f32 v220, v220
v_mfma_f32_16x16x32_bf16 v[204:207], v[236:239], v[116:119], v[204:207]
s_waitcnt lgkmcnt(2)
v_mfma_f32_16x16x32_bf16 v[192:195], v[240:243], v[24:27], v[192:195]
ds_read_b128 v[232:235], v248 offset:38912
v_mfma_f32_16x16x32_bf16 v[192:195], v[244:247], v[28:31], v[192:195]
v_exp_f32 v221, v221
v_mfma_f32_16x16x32_bf16 v[196:199], v[240:243], v[56:59], v[196:199]
v_exp_f32 v222, v222
v_mfma_f32_16x16x32_bf16 v[196:199], v[244:247], v[60:63], v[196:199]
v_exp_f32 v223, v223
v_mfma_f32_16x16x32_bf16 v[200:203], v[240:243], v[88:91], v[200:203]
ds_read_b128 v[236:239], v248 offset:39424
v_cvt_pk_bf16_f32 v158, v220, v221
v_mfma_f32_16x16x32_bf16 v[200:203], v[244:247], v[92:95], v[200:203]
v_cvt_pk_bf16_f32 v159, v222, v223
v_mfma_f32_16x16x32_bf16 v[204:207], v[240:243], v[120:123], v[204:207]
v_mfma_f32_16x16x32_bf16 v[204:207], v[244:247], v[124:127], v[204:207]
s_waitcnt lgkmcnt(2)
v_mfma_f32_16x16x32_bf16 v[208:211], v[224:227], v[0:3], 0
ds_read_b128 v[240:243], v248 offset:43008
v_mfma_f32_16x16x32_bf16 v[208:211], v[228:231], v[4:7], v[208:211]
v_exp_f32 v192, v192
v_mfma_f32_16x16x32_bf16 v[212:215], v[224:227], v[32:35], 0
v_exp_f32 v193, v193
v_mfma_f32_16x16x32_bf16 v[212:215], v[228:231], v[36:39], v[212:215]
v_exp_f32 v194, v194
v_mfma_f32_16x16x32_bf16 v[216:219], v[224:227], v[64:67], 0
ds_read_b128 v[244:247], v248 offset:43520
v_cvt_pk_bf16_f32 v160, v192, v193
v_mfma_f32_16x16x32_bf16 v[216:219], v[228:231], v[68:71], v[216:219]
v_exp_f32 v195, v195
v_mfma_f32_16x16x32_bf16 v[220:223], v[224:227], v[96:99], 0
v_exp_f32 v196, v196
v_mfma_f32_16x16x32_bf16 v[220:223], v[228:231], v[100:103], v[220:223]
s_waitcnt lgkmcnt(2)
v_cvt_pk_bf16_f32 v161, v194, v195
v_mfma_f32_16x16x32_bf16 v[208:211], v[232:235], v[8:11], v[208:211]
ds_read_b128 v[224:227], v248 offset:47104
v_mfma_f32_16x16x32_bf16 v[208:211], v[236:239], v[12:15], v[208:211]
v_exp_f32 v197, v197
v_mfma_f32_16x16x32_bf16 v[212:215], v[232:235], v[40:43], v[212:215]
v_exp_f32 v198, v198
v_mfma_f32_16x16x32_bf16 v[212:215], v[236:239], v[44:47], v[212:215]
v_exp_f32 v199, v199
v_mfma_f32_16x16x32_bf16 v[216:219], v[232:235], v[72:75], v[216:219]
ds_read_b128 v[228:231], v248 offset:47616
v_cvt_pk_bf16_f32 v164, v196, v197
v_mfma_f32_16x16x32_bf16 v[216:219], v[236:239], v[76:79], v[216:219]
v_cvt_pk_bf16_f32 v165, v198, v199
v_mfma_f32_16x16x32_bf16 v[220:223], v[232:235], v[104:107], v[220:223]
v_exp_f32 v200, v200
v_mfma_f32_16x16x32_bf16 v[220:223], v[236:239], v[108:111], v[220:223]
s_waitcnt lgkmcnt(2)
s_waitcnt vmcnt(0)
s_barrier
v_mfma_f32_16x16x32_bf16 v[208:211], v[240:243], v[16:19], v[208:211]
ds_read_b128 v[232:235], v248 offset:49152
s_add_u32 s8, s6, 0x0
s_addc_u32 s9, s7, 0
v_mfma_f32_16x16x32_bf16 v[208:211], v[244:247], v[20:23], v[208:211]
v_exp_f32 v201, v201
s_mov_b32 s10, 0x4e2000
v_mfma_f32_16x16x32_bf16 v[212:215], v[240:243], v[48:51], v[212:215]
v_exp_f32 v202, v202
s_mov_b32 s11, 0x00020000
v_mfma_f32_16x16x32_bf16 v[212:215], v[244:247], v[52:55], v[212:215]
v_exp_f32 v203, v203
s_lshl_b32 s55, s34, 13
v_mfma_f32_16x16x32_bf16 v[216:219], v[240:243], v[80:83], v[216:219]
ds_read_b128 v[236:239], v248 offset:49664
v_cvt_pk_bf16_f32 v168, v200, v201
s_add_u32 s55, s55, 0x21000
v_mfma_f32_16x16x32_bf16 v[216:219], v[244:247], v[84:87], v[216:219]
v_cvt_pk_bf16_f32 v169, v202, v203
s_lshl_b32 s36, s34, 7
v_bfe_u32 v253, v252, 4, 3
v_mfma_f32_16x16x32_bf16 v[220:223], v[240:243], v[112:115], v[220:223]
v_exp_f32 v204, v204
v_lshrrev_b32 v254, 7, v252
v_mfma_f32_16x16x32_bf16 v[220:223], v[244:247], v[116:119], v[220:223]
s_waitcnt lgkmcnt(2)
v_xor_b32 v253, v253, v254
v_lshl_add_u32 v254, v254, 9, s36
v_mfma_f32_16x16x32_bf16 v[208:211], v[224:227], v[24:27], v[208:211]
ds_read_b128 v[240:243], v248 offset:53248
v_lshl_add_u32 v253, v253, 4, v254
s_add_u32 m0, s55, 0
v_mfma_f32_16x16x32_bf16 v[208:211], v[228:231], v[28:31], v[208:211]
v_exp_f32 v205, v205
s_add_u32 s35, s52, 0
v_mfma_f32_16x16x32_bf16 v[212:215], v[224:227], v[56:59], v[212:215]
v_exp_f32 v206, v206
buffer_load_dwordx4 v253, s[8:11], s35 offen lds
v_mfma_f32_16x16x32_bf16 v[212:215], v[228:231], v[60:63], v[212:215]
v_exp_f32 v207, v207
s_add_u32 m0, s55, 1024
v_mfma_f32_16x16x32_bf16 v[216:219], v[224:227], v[88:91], v[216:219]
ds_read_b128 v[244:247], v248 offset:53760
v_cvt_pk_bf16_f32 v172, v204, v205
s_add_u32 s35, s52, 4096
v_mfma_f32_16x16x32_bf16 v[216:219], v[228:231], v[92:95], v[216:219]
v_cvt_pk_bf16_f32 v173, v206, v207
buffer_load_dwordx4 v253, s[8:11], s35 offen lds
s_add_u32 m0, s55, 2048
v_mfma_f32_16x16x32_bf16 v[220:223], v[224:227], v[120:123], v[220:223]
s_add_u32 s35, s53, 0
buffer_load_dwordx4 v253, s[8:11], s35 offen lds
s_add_u32 m0, s55, 3072
v_mfma_f32_16x16x32_bf16 v[220:223], v[228:231], v[124:127], v[220:223]
s_waitcnt lgkmcnt(2)
s_add_u32 s35, s53, 4096
buffer_load_dwordx4 v253, s[8:11], s35 offen lds
v_mfma_f32_16x16x32_bf16 v[192:195], v[232:235], v[0:3], 0
ds_read_b128 v[224:227], v248 offset:57344
v_mfma_f32_16x16x32_bf16 v[192:195], v[236:239], v[4:7], v[192:195]
v_exp_f32 v208, v208
v_mfma_f32_16x16x32_bf16 v[196:199], v[232:235], v[32:35], 0
v_exp_f32 v209, v209
v_mfma_f32_16x16x32_bf16 v[196:199], v[236:239], v[36:39], v[196:199]
v_exp_f32 v210, v210
v_mfma_f32_16x16x32_bf16 v[200:203], v[232:235], v[64:67], 0
ds_read_b128 v[228:231], v248 offset:57856
v_cvt_pk_bf16_f32 v162, v208, v209
v_mfma_f32_16x16x32_bf16 v[200:203], v[236:239], v[68:71], v[200:203]
v_exp_f32 v211, v211
v_mfma_f32_16x16x32_bf16 v[204:207], v[232:235], v[96:99], 0
v_exp_f32 v212, v212
v_mfma_f32_16x16x32_bf16 v[204:207], v[236:239], v[100:103], v[204:207]
s_waitcnt lgkmcnt(2)
v_cvt_pk_bf16_f32 v163, v210, v211
v_mfma_f32_16x16x32_bf16 v[192:195], v[240:243], v[8:11], v[192:195]
ds_read_b128 v[232:235], v248 offset:61440
v_mfma_f32_16x16x32_bf16 v[192:195], v[244:247], v[12:15], v[192:195]
v_exp_f32 v213, v213
v_mfma_f32_16x16x32_bf16 v[196:199], v[240:243], v[40:43], v[196:199]
v_exp_f32 v214, v214
v_mfma_f32_16x16x32_bf16 v[196:199], v[244:247], v[44:47], v[196:199]
v_exp_f32 v215, v215
v_mfma_f32_16x16x32_bf16 v[200:203], v[240:243], v[72:75], v[200:203]
ds_read_b128 v[236:239], v248 offset:61952
v_cvt_pk_bf16_f32 v166, v212, v213
v_mfma_f32_16x16x32_bf16 v[200:203], v[244:247], v[76:79], v[200:203]
v_cvt_pk_bf16_f32 v167, v214, v215
v_mfma_f32_16x16x32_bf16 v[204:207], v[240:243], v[104:107], v[204:207]
v_exp_f32 v216, v216
v_mfma_f32_16x16x32_bf16 v[204:207], v[244:247], v[108:111], v[204:207]
s_waitcnt lgkmcnt(2)
v_mfma_f32_16x16x32_bf16 v[192:195], v[224:227], v[16:19], v[192:195]
ds_read_b128 v[240:243], v248 offset:51200
v_mfma_f32_16x16x32_bf16 v[192:195], v[228:231], v[20:23], v[192:195]
v_exp_f32 v217, v217
v_mfma_f32_16x16x32_bf16 v[196:199], v[224:227], v[48:51], v[196:199]
v_exp_f32 v218, v218
v_mfma_f32_16x16x32_bf16 v[196:199], v[228:231], v[52:55], v[196:199]
v_exp_f32 v219, v219
v_mfma_f32_16x16x32_bf16 v[200:203], v[224:227], v[80:83], v[200:203]
ds_read_b128 v[244:247], v248 offset:51712
v_cvt_pk_bf16_f32 v170, v216, v217
v_mfma_f32_16x16x32_bf16 v[200:203], v[228:231], v[84:87], v[200:203]
v_cvt_pk_bf16_f32 v171, v218, v219
v_mfma_f32_16x16x32_bf16 v[204:207], v[224:227], v[112:115], v[204:207]
v_exp_f32 v220, v220
v_mfma_f32_16x16x32_bf16 v[204:207], v[228:231], v[116:119], v[204:207]
s_waitcnt lgkmcnt(2)
v_mfma_f32_16x16x32_bf16 v[192:195], v[232:235], v[24:27], v[192:195]
ds_read_b128 v[224:227], v248 offset:55296
v_mfma_f32_16x16x32_bf16 v[192:195], v[236:239], v[28:31], v[192:195]
v_exp_f32 v221, v221
v_mfma_f32_16x16x32_bf16 v[196:199], v[232:235], v[56:59], v[196:199]
v_exp_f32 v222, v222
v_mfma_f32_16x16x32_bf16 v[196:199], v[236:239], v[60:63], v[196:199]
v_exp_f32 v223, v223
v_mfma_f32_16x16x32_bf16 v[200:203], v[232:235], v[88:91], v[200:203]
ds_read_b128 v[228:231], v248 offset:55808
v_cvt_pk_bf16_f32 v174, v220, v221
v_mfma_f32_16x16x32_bf16 v[200:203], v[236:239], v[92:95], v[200:203]
v_cvt_pk_bf16_f32 v175, v222, v223
v_mfma_f32_16x16x32_bf16 v[204:207], v[232:235], v[120:123], v[204:207]
v_mfma_f32_16x16x32_bf16 v[204:207], v[236:239], v[124:127], v[204:207]
s_waitcnt lgkmcnt(2)
v_mfma_f32_16x16x32_bf16 v[208:211], v[240:243], v[0:3], 0
ds_read_b128 v[232:235], v248 offset:59392
v_mfma_f32_16x16x32_bf16 v[208:211], v[244:247], v[4:7], v[208:211]
v_exp_f32 v192, v192
v_mfma_f32_16x16x32_bf16 v[212:215], v[240:243], v[32:35], 0
v_exp_f32 v193, v193
v_mfma_f32_16x16x32_bf16 v[212:215], v[244:247], v[36:39], v[212:215]
v_exp_f32 v194, v194
v_mfma_f32_16x16x32_bf16 v[216:219], v[240:243], v[64:67], 0
ds_read_b128 v[236:239], v248 offset:59904
v_cvt_pk_bf16_f32 v0, v192, v193
v_mfma_f32_16x16x32_bf16 v[216:219], v[244:247], v[68:71], v[216:219]
v_exp_f32 v195, v195
v_mfma_f32_16x16x32_bf16 v[220:223], v[240:243], v[96:99], 0
v_exp_f32 v196, v196
v_mfma_f32_16x16x32_bf16 v[220:223], v[244:247], v[100:103], v[220:223]
s_waitcnt lgkmcnt(2)
v_cvt_pk_bf16_f32 v1, v194, v195
v_mfma_f32_16x16x32_bf16 v[208:211], v[224:227], v[8:11], v[208:211]
ds_read_b128 v[240:243], v248 offset:63488
v_mfma_f32_16x16x32_bf16 v[208:211], v[228:231], v[12:15], v[208:211]
v_exp_f32 v197, v197
v_mfma_f32_16x16x32_bf16 v[212:215], v[224:227], v[40:43], v[212:215]
ds_read_b128 v[4:7], v255 offset:0
ds_read_b128 v[36:39], v255 offset:1024
v_mfma_f32_16x16x32_bf16 v[212:215], v[228:231], v[44:47], v[212:215]
v_exp_f32 v198, v198
v_mfma_f32_16x16x32_bf16 v[216:219], v[224:227], v[72:75], v[216:219]
ds_read_b128 v[244:247], v248 offset:64000
v_xor_b32 v12, 0x10000, v249
v_mfma_f32_16x16x32_bf16 v[216:219], v[228:231], v[76:79], v[216:219]
v_xor_b32 v13, 0x10000, v250
v_cvt_pk_bf16_f32 v32, v196, v197
v_mfma_f32_16x16x32_bf16 v[220:223], v[224:227], v[104:107], v[220:223]
ds_read_b128 v[68:71], v255 offset:2048
ds_read_b128 v[100:103], v255 offset:3072
v_mfma_f32_16x16x32_bf16 v[220:223], v[228:231], v[108:111], v[220:223]
s_waitcnt lgkmcnt(6)
v_mfma_f32_16x16x32_bf16 v[208:211], v[232:235], v[16:19], v[208:211]
ds_read_b64_tr_b16 v[224:225], v12 offset:0
ds_read_b64_tr_b16 v[226:227], v12 offset:2048
v_mfma_f32_16x16x32_bf16 v[208:211], v[236:239], v[20:23], v[208:211]
v_exp_f32 v199, v199
v_mfma_f32_16x16x32_bf16 v[212:215], v[232:235], v[48:51], v[212:215]
v_cvt_pk_bf16_f32 v33, v198, v199
v_mfma_f32_16x16x32_bf16 v[212:215], v[236:239], v[52:55], v[212:215]
v_exp_f32 v200, v200
v_mfma_f32_16x16x32_bf16 v[216:219], v[232:235], v[80:83], v[216:219]
ds_read_b64_tr_b16 v[228:229], v12 offset:16384
ds_read_b64_tr_b16 v[230:231], v12 offset:18432
v_mfma_f32_16x16x32_bf16 v[216:219], v[236:239], v[84:87], v[216:219]
v_exp_f32 v201, v201
v_mfma_f32_16x16x32_bf16 v[220:223], v[232:235], v[112:115], v[220:223]
v_exp_f32 v202, v202
v_mfma_f32_16x16x32_bf16 v[220:223], v[236:239], v[116:119], v[220:223]
s_waitcnt lgkmcnt(6)
v_cvt_pk_bf16_f32 v64, v200, v201
v_mfma_f32_16x16x32_bf16 v[208:211], v[240:243], v[24:27], v[208:211]
ds_read_b64_tr_b16 v[232:233], v13 offset:0
ds_read_b64_tr_b16 v[234:235], v13 offset:2048
v_mfma_f32_16x16x32_bf16 v[208:211], v[244:247], v[28:31], v[208:211]
v_exp_f32 v203, v203
v_mfma_f32_16x16x32_bf16 v[212:215], v[240:243], v[56:59], v[212:215]
v_cvt_pk_bf16_f32 v65, v202, v203
v_mfma_f32_16x16x32_bf16 v[212:215], v[244:247], v[60:63], v[212:215]
v_exp_f32 v204, v204
v_mfma_f32_16x16x32_bf16 v[216:219], v[240:243], v[88:91], v[216:219]
ds_read_b64_tr_b16 v[236:237], v13 offset:16384
ds_read_b64_tr_b16 v[238:239], v13 offset:18432
v_mfma_f32_16x16x32_bf16 v[216:219], v[244:247], v[92:95], v[216:219]
v_exp_f32 v205, v205
v_mfma_f32_16x16x32_bf16 v[220:223], v[240:243], v[120:123], v[220:223]
v_exp_f32 v206, v206
v_mfma_f32_16x16x32_bf16 v[220:223], v[244:247], v[124:127], v[220:223]
s_waitcnt lgkmcnt(4)
v_mfma_f32_16x16x32_bf16 a[0:3], v[224:227], v[128:131], a[0:3]
ds_read_b64_tr_b16 v[240:241], v249 offset:33280
ds_read_b64_tr_b16 v[242:243], v249 offset:35328
v_mfma_f32_16x16x32_bf16 a[0:3], v[228:231], v[144:147], a[0:3]
v_exp_f32 v207, v207
v_mfma_f32_16x16x32_bf16 a[4:7], v[224:227], v[132:135], a[4:7]
v_cvt_pk_bf16_f32 v96, v204, v205
v_cvt_pk_bf16_f32 v97, v206, v207
v_mfma_f32_16x16x32_bf16 a[4:7], v[228:231], v[148:151], a[4:7]
v_exp_f32 v208, v208
v_mfma_f32_16x16x32_bf16 a[8:11], v[224:227], v[136:139], a[8:11]
ds_read_b64_tr_b16 v[244:245], v249 offset:49664
ds_read_b64_tr_b16 v[246:247], v249 offset:51712
v_mfma_f32_16x16x32_bf16 a[8:11], v[228:231], v[152:155], a[8:11]
v_exp_f32 v209, v209
v_mfma_f32_16x16x32_bf16 a[12:15], v[224:227], v[140:143], a[12:15]
v_exp_f32 v210, v210
v_mfma_f32_16x16x32_bf16 a[12:15], v[228:231], v[156:159], a[12:15]
s_waitcnt lgkmcnt(4)
v_cvt_pk_bf16_f32 v2, v208, v209
v_mfma_f32_16x16x32_bf16 a[16:19], v[232:235], v[128:131], a[16:19]
ds_read_b64_tr_b16 v[224:225], v12 offset:512
ds_read_b64_tr_b16 v[226:227], v12 offset:2560
v_mfma_f32_16x16x32_bf16 a[16:19], v[236:239], v[144:147], a[16:19]
v_exp_f32 v211, v211
v_mfma_f32_16x16x32_bf16 a[20:23], v[232:235], v[132:135], a[20:23]
v_cvt_pk_bf16_f32 v3, v210, v211
v_mfma_f32_16x16x32_bf16 a[20:23], v[236:239], v[148:151], a[20:23]
v_exp_f32 v212, v212
v_mfma_f32_16x16x32_bf16 a[24:27], v[232:235], v[136:139], a[24:27]
ds_read_b64_tr_b16 v[228:229], v12 offset:16896
ds_read_b64_tr_b16 v[230:231], v12 offset:18944
v_mfma_f32_16x16x32_bf16 a[24:27], v[236:239], v[152:155], a[24:27]
v_exp_f32 v213, v213
v_mfma_f32_16x16x32_bf16 a[28:31], v[232:235], v[140:143], a[28:31]
v_exp_f32 v214, v214
v_mfma_f32_16x16x32_bf16 a[28:31], v[236:239], v[156:159], a[28:31]
s_waitcnt lgkmcnt(4)
v_cvt_pk_bf16_f32 v34, v212, v213
v_mfma_f32_16x16x32_bf16 a[32:35], v[240:243], v[4:7], a[32:35]
ds_read_b64_tr_b16 v[232:233], v250 offset:33280
ds_read_b64_tr_b16 v[234:235], v250 offset:35328
v_mfma_f32_16x16x32_bf16 a[32:35], v[244:247], v[176:179], a[32:35]
v_exp_f32 v215, v215
v_mfma_f32_16x16x32_bf16 a[36:39], v[240:243], v[36:39], a[36:39]
v_cvt_pk_bf16_f32 v35, v214, v215
v_mfma_f32_16x16x32_bf16 a[36:39], v[244:247], v[180:183], a[36:39]
v_exp_f32 v216, v216
v_mfma_f32_16x16x32_bf16 a[40:43], v[240:243], v[68:71], a[40:43]
ds_read_b64_tr_b16 v[236:237], v250 offset:49664
ds_read_b64_tr_b16 v[238:239], v250 offset:51712
v_mfma_f32_16x16x32_bf16 a[40:43], v[244:247], v[184:187], a[40:43]
v_exp_f32 v217, v217
v_mfma_f32_16x16x32_bf16 a[44:47], v[240:243], v[100:103], a[44:47]
v_exp_f32 v218, v218
v_mfma_f32_16x16x32_bf16 a[44:47], v[244:247], v[188:191], a[44:47]
s_waitcnt lgkmcnt(4)
v_cvt_pk_bf16_f32 v66, v216, v217
v_mfma_f32_16x16x32_bf16 a[32:35], v[224:227], v[128:131], a[32:35]
ds_read_b64_tr_b16 v[240:241], v12 offset:32768
ds_read_b64_tr_b16 v[242:243], v12 offset:34816
v_mfma_f32_16x16x32_bf16 a[32:35], v[228:231], v[144:147], a[32:35]
v_exp_f32 v219, v219
v_mfma_f32_16x16x32_bf16 a[36:39], v[224:227], v[132:135], a[36:39]
v_cvt_pk_bf16_f32 v67, v218, v219
v_mfma_f32_16x16x32_bf16 a[36:39], v[228:231], v[148:151], a[36:39]
v_exp_f32 v220, v220
v_mfma_f32_16x16x32_bf16 a[40:43], v[224:227], v[136:139], a[40:43]
ds_read_b64_tr_b16 v[244:245], v12 offset:49152
ds_read_b64_tr_b16 v[246:247], v12 offset:51200
v_mfma_f32_16x16x32_bf16 a[40:43], v[228:231], v[152:155], a[40:43]
v_exp_f32 v221, v221
v_mfma_f32_16x16x32_bf16 a[44:47], v[224:227], v[140:143], a[44:47]
v_exp_f32 v222, v222
v_mfma_f32_16x16x32_bf16 a[44:47], v[228:231], v[156:159], a[44:47]
s_waitcnt lgkmcnt(4)
v_cvt_pk_bf16_f32 v98, v220, v221
v_mfma_f32_16x16x32_bf16 a[48:51], v[232:235], v[4:7], a[48:51]
ds_read_b64_tr_b16 v[224:225], v13 offset:32768
ds_read_b64_tr_b16 v[226:227], v13 offset:34816
v_mfma_f32_16x16x32_bf16 a[48:51], v[236:239], v[176:179], a[48:51]
v_exp_f32 v223, v223
v_mfma_f32_16x16x32_bf16 a[52:55], v[232:235], v[36:39], a[52:55]
v_cvt_pk_bf16_f32 v99, v222, v223
v_mfma_f32_16x16x32_bf16 a[52:55], v[236:239], v[180:183], a[52:55]
v_mfma_f32_16x16x32_bf16 a[56:59], v[232:235], v[68:71], a[56:59]
ds_read_b64_tr_b16 v[228:229], v13 offset:49152
ds_read_b64_tr_b16 v[230:231], v13 offset:51200
v_mfma_f32_16x16x32_bf16 a[56:59], v[236:239], v[184:187], a[56:59]
v_mfma_f32_16x16x32_bf16 a[60:63], v[232:235], v[100:103], a[60:63]
v_mfma_f32_16x16x32_bf16 a[60:63], v[236:239], v[188:191], a[60:63]
s_waitcnt lgkmcnt(4)
v_mfma_f32_16x16x32_bf16 a[0:3], v[240:243], v[160:163], a[0:3]
ds_read_b64_tr_b16 v[232:233], v12 offset:33280
ds_read_b64_tr_b16 v[234:235], v12 offset:35328
v_mfma_f32_16x16x32_bf16 a[0:3], v[244:247], v[0:3], a[0:3]
v_mfma_f32_16x16x32_bf16 a[4:7], v[240:243], v[164:167], a[4:7]
v_mfma_f32_16x16x32_bf16 a[4:7], v[244:247], v[32:35], a[4:7]
v_mfma_f32_16x16x32_bf16 a[8:11], v[240:243], v[168:171], a[8:11]
ds_read_b64_tr_b16 v[236:237], v12 offset:49664
ds_read_b64_tr_b16 v[238:239], v12 offset:51712
v_mfma_f32_16x16x32_bf16 a[8:11], v[244:247], v[64:67], a[8:11]
v_mfma_f32_16x16x32_bf16 a[12:15], v[240:243], v[172:175], a[12:15]
v_mfma_f32_16x16x32_bf16 a[12:15], v[244:247], v[96:99], a[12:15]
s_waitcnt lgkmcnt(4)
v_mfma_f32_16x16x32_bf16 a[16:19], v[224:227], v[160:163], a[16:19]
ds_read_b64_tr_b16 v[240:241], v13 offset:512
ds_read_b64_tr_b16 v[242:243], v13 offset:2560
v_mfma_f32_16x16x32_bf16 a[16:19], v[228:231], v[0:3], a[16:19]
v_mfma_f32_16x16x32_bf16 a[20:23], v[224:227], v[164:167], a[20:23]
v_mfma_f32_16x16x32_bf16 a[20:23], v[228:231], v[32:35], a[20:23]
v_mfma_f32_16x16x32_bf16 a[24:27], v[224:227], v[168:171], a[24:27]
ds_read_b64_tr_b16 v[244:245], v13 offset:16896
ds_read_b64_tr_b16 v[246:247], v13 offset:18944
v_accvgpr_read_b32 v192, a0
v_mfma_f32_16x16x32_bf16 a[24:27], v[228:231], v[64:67], a[24:27]
v_accvgpr_read_b32 v193, a4
v_accvgpr_read_b32 v194, a8
v_accvgpr_read_b32 v195, a12
v_mfma_f32_16x16x32_bf16 a[28:31], v[224:227], v[172:175], a[28:31]
v_lshlrev_b32 v253, 2, v252
v_subrev_u32 v196, 0x0d800000, v192
v_subrev_u32 v197, 0x0d800000, v193
v_mfma_f32_16x16x32_bf16 a[28:31], v[228:231], v[96:99], a[28:31]
s_waitcnt lgkmcnt(4)
v_subrev_u32 v198, 0x0d800000, v194
v_subrev_u32 v199, 0x0d800000, v195
v_mfma_f32_16x16x32_bf16 a[32:35], v[232:235], v[160:163], a[32:35]
ds_read_b64_tr_b16 v[224:225], v13 offset:33280
ds_read_b64_tr_b16 v[226:227], v13 offset:35328
v_max3_u32 v254, v196, v197, v198
v_mfma_f32_16x16x32_bf16 a[32:35], v[236:239], v[0:3], a[32:35]
v_max_u32 v254, v254, v199
v_mfma_f32_16x16x32_bf16 a[36:39], v[232:235], v[164:167], a[36:39]
s_mov_b64 exec, 0xffff
s_xor_b32 s35, s48, 0
buffer_store_dword v192, v253, s[24:27], s35 offen offset:4 sc1
s_xor_b32 s35, s48, 1024
buffer_store_dword v193, v253, s[24:27], s35 offen offset:4 sc1
s_xor_b32 s35, s48, 2048
buffer_store_dword v194, v253, s[24:27], s35 offen offset:4 sc1
s_xor_b32 s35, s48, 3072
buffer_store_dword v195, v253, s[24:27], s35 offen offset:4 sc1
v_cmp_le_u32 vcc, 0x64000000, v254
s_mov_b64 exec, -1
v_mfma_f32_16x16x32_bf16 a[36:39], v[236:239], v[32:35], a[36:39]
v_accvgpr_read_b32 v192, a0
v_accvgpr_read_b32 v193, a1
v_mfma_f32_16x16x32_bf16 a[40:43], v[232:235], v[168:171], a[40:43]
ds_read_b64_tr_b16 v[228:229], v13 offset:49664
ds_read_b64_tr_b16 v[230:231], v13 offset:51712
v_mfma_f32_16x16x32_bf16 a[40:43], v[236:239], v[64:67], a[40:43]
v_accvgpr_read_b32 v194, a2
v_accvgpr_read_b32 v195, a3
v_mfma_f32_16x16x32_bf16 a[44:47], v[232:235], v[172:175], a[44:47]
v_cvt_pk_bf16_f32 v16, v192, v193
v_cvt_pk_bf16_f32 v17, v194, v195
v_mfma_f32_16x16x32_bf16 a[44:47], v[236:239], v[96:99], a[44:47]
s_waitcnt lgkmcnt(4)
v_accvgpr_read_b32 v200, a4
v_mfma_f32_16x16x32_bf16 a[48:51], v[240:243], v[128:131], a[48:51]
ds_read_b64_tr_b16 v[232:233], v249 offset:36864
ds_read_b64_tr_b16 v[234:235], v249 offset:38912
v_mfma_f32_16x16x32_bf16 a[48:51], v[244:247], v[144:147], a[48:51]
v_accvgpr_read_b32 v201, a5
v_accvgpr_read_b32 v202, a6
v_mfma_f32_16x16x32_bf16 a[52:55], v[240:243], v[132:135], a[52:55]
v_accvgpr_read_b32 v203, a7
v_cvt_pk_bf16_f32 v48, v200, v201
v_mfma_f32_16x16x32_bf16 a[52:55], v[244:247], v[148:151], a[52:55]
v_cvt_pk_bf16_f32 v49, v202, v203
v_accvgpr_read_b32 v208, a8
v_mfma_f32_16x16x32_bf16 a[56:59], v[240:243], v[136:139], a[56:59]
ds_read_b64_tr_b16 v[236:237], v249 offset:53248
ds_read_b64_tr_b16 v[238:239], v249 offset:55296
v_mfma_f32_16x16x32_bf16 a[56:59], v[244:247], v[152:155], a[56:59]
v_accvgpr_read_b32 v209, a9
v_accvgpr_read_b32 v210, a10
v_mfma_f32_16x16x32_bf16 a[60:63], v[240:243], v[140:143], a[60:63]
v_accvgpr_read_b32 v211, a11
v_cvt_pk_bf16_f32 v80, v208, v209
v_mfma_f32_16x16x32_bf16 a[60:63], v[244:247], v[156:159], a[60:63]
s_waitcnt lgkmcnt(4)
v_cvt_pk_bf16_f32 v81, v210, v211
v_mfma_f32_16x16x32_bf16 a[48:51], v[224:227], v[160:163], a[48:51]
ds_read_b64_tr_b16 v[240:241], v12 offset:4096
ds_read_b64_tr_b16 v[242:243], v12 offset:6144
v_mfma_f32_16x16x32_bf16 a[48:51], v[228:231], v[0:3], a[48:51]
v_accvgpr_read_b32 v216, a12
v_accvgpr_read_b32 v217, a13
v_mfma_f32_16x16x32_bf16 a[52:55], v[224:227], v[164:167], a[52:55]
v_accvgpr_read_b32 v218, a14
v_accvgpr_read_b32 v219, a15
v_mfma_f32_16x16x32_bf16 a[52:55], v[228:231], v[32:35], a[52:55]
v_cvt_pk_bf16_f32 v112, v216, v217
v_cvt_pk_bf16_f32 v113, v218, v219
v_mfma_f32_16x16x32_bf16 a[56:59], v[224:227], v[168:171], a[56:59]
ds_read_b64_tr_b16 v[244:245], v12 offset:20480
ds_read_b64_tr_b16 v[246:247], v12 offset:22528
v_mfma_f32_16x16x32_bf16 a[56:59], v[228:231], v[64:67], a[56:59]
v_accvgpr_read_b32 v196, a16
v_accvgpr_read_b32 v197, a17
v_mfma_f32_16x16x32_bf16 a[60:63], v[224:227], v[172:175], a[60:63]
v_accvgpr_read_b32 v198, a18
v_accvgpr_read_b32 v199, a19
v_mfma_f32_16x16x32_bf16 a[60:63], v[228:231], v[96:99], a[60:63]
s_waitcnt lgkmcnt(4)
v_cvt_pk_bf16_f32 v18, v196, v197
v_mfma_f32_16x16x32_bf16 a[64:67], v[232:235], v[4:7], a[64:67]
ds_read_b64_tr_b16 v[224:225], v12 offset:36864
ds_read_b64_tr_b16 v[226:227], v12 offset:38912
v_mfma_f32_16x16x32_bf16 a[64:67], v[236:239], v[176:179], a[64:67]
v_cvt_pk_bf16_f32 v19, v198, v199
buffer_store_dwordx4 v[16:19], v252, s[20:23], s40 offen offset:0 sc1
v_mfma_f32_16x16x32_bf16 a[68:71], v[232:235], v[36:39], a[68:71]
ds_write_b128 v255, v[16:19] offset:0
v_accvgpr_read_b32 v204, a20
v_mfma_f32_16x16x32_bf16 a[68:71], v[236:239], v[180:183], a[68:71]
v_accvgpr_read_b32 v205, a21
v_accvgpr_read_b32 v206, a22
v_mfma_f32_16x16x32_bf16 a[72:75], v[232:235], v[68:71], a[72:75]
ds_read_b64_tr_b16 v[228:229], v12 offset:53248
ds_read_b64_tr_b16 v[230:231], v12 offset:55296
v_mfma_f32_16x16x32_bf16 a[72:75], v[236:239], v[184:187], a[72:75]
v_accvgpr_read_b32 v207, a23
v_cvt_pk_bf16_f32 v50, v204, v205
v_mfma_f32_16x16x32_bf16 a[76:79], v[232:235], v[100:103], a[76:79]
v_cvt_pk_bf16_f32 v51, v206, v207
buffer_store_dwordx4 v[48:51], v252, s[20:23], s41 offen offset:0 sc1
v_mfma_f32_16x16x32_bf16 a[76:79], v[236:239], v[188:191], a[76:79]
s_waitcnt lgkmcnt(5)
v_accvgpr_read_b32 v212, a24
v_mfma_f32_16x16x32_bf16 a[64:67], v[240:243], v[128:131], a[64:67]
ds_read_b64_tr_b16 v[232:233], v250 offset:36864
ds_read_b64_tr_b16 v[234:235], v250 offset:38912
v_mfma_f32_16x16x32_bf16 a[64:67], v[244:247], v[144:147], a[64:67]
v_accvgpr_read_b32 v213, a25
v_accvgpr_read_b32 v214, a26
v_mfma_f32_16x16x32_bf16 a[68:71], v[240:243], v[132:135], a[68:71]
v_accvgpr_read_b32 v215, a27
v_cvt_pk_bf16_f32 v82, v212, v213
v_mfma_f32_16x16x32_bf16 a[68:71], v[244:247], v[148:151], a[68:71]
v_cvt_pk_bf16_f32 v83, v214, v215
buffer_store_dwordx4 v[80:83], v252, s[20:23], s42 offen offset:0 sc1
v_mfma_f32_16x16x32_bf16 a[72:75], v[240:243], v[136:139], a[72:75]
ds_read_b64_tr_b16 v[236:237], v250 offset:53248
ds_read_b64_tr_b16 v[238:239], v250 offset:55296
v_mfma_f32_16x16x32_bf16 a[72:75], v[244:247], v[152:155], a[72:75]
v_accvgpr_read_b32 v220, a28
v_accvgpr_read_b32 v221, a29
v_mfma_f32_16x16x32_bf16 a[76:79], v[240:243], v[140:143], a[76:79]
v_accvgpr_read_b32 v222, a30
v_accvgpr_read_b32 v223, a31
v_mfma_f32_16x16x32_bf16 a[76:79], v[244:247], v[156:159], a[76:79]
s_waitcnt lgkmcnt(4)
v_cvt_pk_bf16_f32 v114, v220, v221
v_mfma_f32_16x16x32_bf16 a[64:67], v[224:227], v[160:163], a[64:67]
ds_read_b64_tr_b16 v[240:241], v13 offset:4096
ds_read_b64_tr_b16 v[242:243], v13 offset:6144
v_mfma_f32_16x16x32_bf16 a[64:67], v[228:231], v[0:3], a[64:67]
v_cvt_pk_bf16_f32 v115, v222, v223
buffer_store_dwordx4 v[112:115], v252, s[20:23], s43 offen offset:0 sc1
v_mfma_f32_16x16x32_bf16 a[68:71], v[224:227], v[164:167], a[68:71]
v_accvgpr_read_b32 v192, a32
v_accvgpr_read_b32 v193, a33
v_mfma_f32_16x16x32_bf16 a[68:71], v[228:231], v[32:35], a[68:71]
v_accvgpr_read_b32 v194, a34
v_accvgpr_read_b32 v195, a35
v_mfma_f32_16x16x32_bf16 a[72:75], v[224:227], v[168:171], a[72:75]
ds_read_b64_tr_b16 v[244:245], v13 offset:20480
ds_read_b64_tr_b16 v[246:247], v13 offset:22528
v_mfma_f32_16x16x32_bf16 a[72:75], v[228:231], v[64:67], a[72:75]
v_cvt_pk_bf16_f32 v20, v192, v193
v_cvt_pk_bf16_f32 v21, v194, v195
v_mfma_f32_16x16x32_bf16 a[76:79], v[224:227], v[172:175], a[76:79]
v_accvgpr_read_b32 v200, a36
v_accvgpr_read_b32 v201, a37
v_mfma_f32_16x16x32_bf16 a[76:79], v[228:231], v[96:99], a[76:79]
s_waitcnt lgkmcnt(4)
v_accvgpr_read_b32 v202, a38
v_mfma_f32_16x16x32_bf16 a[80:83], v[232:235], v[4:7], a[80:83]
ds_read_b64_tr_b16 v[224:225], v13 offset:36864
ds_read_b64_tr_b16 v[226:227], v13 offset:38912
v_mfma_f32_16x16x32_bf16 a[80:83], v[236:239], v[176:179], a[80:83]
v_accvgpr_read_b32 v203, a39
v_cvt_pk_bf16_f32 v52, v200, v201
v_mfma_f32_16x16x32_bf16 a[84:87], v[232:235], v[36:39], a[84:87]
v_cvt_pk_bf16_f32 v53, v202, v203
v_accvgpr_read_b32 v208, a40
v_mfma_f32_16x16x32_bf16 a[84:87], v[236:239], v[180:183], a[84:87]
v_accvgpr_read_b32 v209, a41
v_accvgpr_read_b32 v210, a42
v_mfma_f32_16x16x32_bf16 a[88:91], v[232:235], v[68:71], a[88:91]
ds_read_b64_tr_b16 v[228:229], v13 offset:53248
ds_read_b64_tr_b16 v[230:231], v13 offset:55296
v_mfma_f32_16x16x32_bf16 a[88:91], v[236:239], v[184:187], a[88:91]
v_accvgpr_read_b32 v211, a43
v_cvt_pk_bf16_f32 v84, v208, v209
v_mfma_f32_16x16x32_bf16 a[92:95], v[232:235], v[100:103], a[92:95]
v_cvt_pk_bf16_f32 v85, v210, v211
v_accvgpr_read_b32 v216, a44
v_mfma_f32_16x16x32_bf16 a[92:95], v[236:239], v[188:191], a[92:95]
s_waitcnt lgkmcnt(4)
v_accvgpr_read_b32 v217, a45
v_mfma_f32_16x16x32_bf16 a[80:83], v[240:243], v[128:131], a[80:83]
ds_read_b64_tr_b16 v[232:233], v249 offset:37376
ds_read_b64_tr_b16 v[234:235], v249 offset:39424
v_mfma_f32_16x16x32_bf16 a[80:83], v[244:247], v[144:147], a[80:83]
v_accvgpr_read_b32 v218, a46
v_accvgpr_read_b32 v219, a47
v_mfma_f32_16x16x32_bf16 a[84:87], v[240:243], v[132:135], a[84:87]
v_cvt_pk_bf16_f32 v116, v216, v217
v_cvt_pk_bf16_f32 v117, v218, v219
v_mfma_f32_16x16x32_bf16 a[84:87], v[244:247], v[148:151], a[84:87]
v_accvgpr_read_b32 v196, a48
v_accvgpr_read_b32 v197, a49
v_mfma_f32_16x16x32_bf16 a[88:91], v[240:243], v[136:139], a[88:91]
ds_read_b64_tr_b16 v[236:237], v249 offset:53760
ds_read_b64_tr_b16 v[238:239], v249 offset:55808
v_mfma_f32_16x16x32_bf16 a[88:91], v[244:247], v[152:155], a[88:91]
v_accvgpr_read_b32 v198, a50
v_accvgpr_read_b32 v199, a51
v_mfma_f32_16x16x32_bf16 a[92:95], v[240:243], v[140:143], a[92:95]
v_cvt_pk_bf16_f32 v22, v196, v197
v_cvt_pk_bf16_f32 v23, v198, v199
v_mfma_f32_16x16x32_bf16 a[92:95], v[244:247], v[156:159], a[92:95]
s_waitcnt lgkmcnt(4)
buffer_store_dwordx4 v[20:23], v252, s[20:23], s40 offen offset:1024 sc1
v_mfma_f32_16x16x32_bf16 a[80:83], v[224:227], v[160:163], a[80:83]
ds_read_b64_tr_b16 v[240:241], v12 offset:4608
ds_read_b64_tr_b16 v[242:243], v12 offset:6656
v_mfma_f32_16x16x32_bf16 a[80:83], v[228:231], v[0:3], a[80:83]
ds_write_b128 v255, v[20:23] offset:1024
v_accvgpr_read_b32 v204, a52
v_mfma_f32_16x16x32_bf16 a[84:87], v[224:227], v[164:167], a[84:87]
v_accvgpr_read_b32 v205, a53
v_accvgpr_read_b32 v206, a54
v_mfma_f32_16x16x32_bf16 a[84:87], v[228:231], v[32:35], a[84:87]
v_accvgpr_read_b32 v207, a55
v_cvt_pk_bf16_f32 v54, v204, v205
v_mfma_f32_16x16x32_bf16 a[88:91], v[224:227], v[168:171], a[88:91]
ds_read_b64_tr_b16 v[244:245], v12 offset:20992
ds_read_b64_tr_b16 v[246:247], v12 offset:23040
v_mfma_f32_16x16x32_bf16 a[88:91], v[228:231], v[64:67], a[88:91]
v_cvt_pk_bf16_f32 v55, v206, v207
buffer_store_dwordx4 v[52:55], v252, s[20:23], s41 offen offset:1024 sc1
v_mfma_f32_16x16x32_bf16 a[92:95], v[224:227], v[172:175], a[92:95]
v_accvgpr_read_b32 v212, a56
v_accvgpr_read_b32 v213, a57
v_mfma_f32_16x16x32_bf16 a[92:95], v[228:231], v[96:99], a[92:95]
s_waitcnt lgkmcnt(5)
v_accvgpr_read_b32 v214, a58
v_mfma_f32_16x16x32_bf16 a[96:99], v[232:235], v[4:7], a[96:99]
ds_read_b64_tr_b16 v[224:225], v12 offset:37376
ds_read_b64_tr_b16 v[226:227], v12 offset:39424
v_mfma_f32_16x16x32_bf16 a[96:99], v[236:239], v[176:179], a[96:99]
v_accvgpr_read_b32 v215, a59
v_cvt_pk_bf16_f32 v86, v212, v213
v_mfma_f32_16x16x32_bf16 a[100:103], v[232:235], v[36:39], a[100:103]
v_cvt_pk_bf16_f32 v87, v214, v215
buffer_store_dwordx4 v[84:87], v252, s[20:23], s42 offen offset:1024 sc1
v_mfma_f32_16x16x32_bf16 a[100:103], v[236:239], v[180:183], a[100:103]
v_accvgpr_read_b32 v220, a60
v_accvgpr_read_b32 v221, a61
v_mfma_f32_16x16x32_bf16 a[104:107], v[232:235], v[68:71], a[104:107]
ds_read_b64_tr_b16 v[228:229], v12 offset:53760
ds_read_b64_tr_b16 v[230:231], v12 offset:55808
v_mfma_f32_16x16x32_bf16 a[104:107], v[236:239], v[184:187], a[104:107]
v_accvgpr_read_b32 v222, a62
v_accvgpr_read_b32 v223, a63
v_mfma_f32_16x16x32_bf16 a[108:111], v[232:235], v[100:103], a[108:111]
v_cvt_pk_bf16_f32 v118, v220, v221
v_cvt_pk_bf16_f32 v119, v222, v223
v_mfma_f32_16x16x32_bf16 a[108:111], v[236:239], v[188:191], a[108:111]
s_waitcnt lgkmcnt(4)
buffer_store_dwordx4 v[116:119], v252, s[20:23], s43 offen offset:1024 sc1
v_mfma_f32_16x16x32_bf16 a[96:99], v[240:243], v[128:131], a[96:99]
ds_read_b64_tr_b16 v[232:233], v250 offset:37376
ds_read_b64_tr_b16 v[234:235], v250 offset:39424
v_mfma_f32_16x16x32_bf16 a[96:99], v[244:247], v[144:147], a[96:99]
v_accvgpr_read_b32 v192, a64
v_accvgpr_read_b32 v193, a65
v_mfma_f32_16x16x32_bf16 a[100:103], v[240:243], v[132:135], a[100:103]
v_accvgpr_read_b32 v194, a66
v_accvgpr_read_b32 v195, a67
v_mfma_f32_16x16x32_bf16 a[100:103], v[244:247], v[148:151], a[100:103]
v_cvt_pk_bf16_f32 v24, v192, v193
v_cvt_pk_bf16_f32 v25, v194, v195
v_mfma_f32_16x16x32_bf16 a[104:107], v[240:243], v[136:139], a[104:107]
ds_read_b64_tr_b16 v[236:237], v250 offset:53760
ds_read_b64_tr_b16 v[238:239], v250 offset:55808
v_mfma_f32_16x16x32_bf16 a[104:107], v[244:247], v[152:155], a[104:107]
v_accvgpr_read_b32 v200, a68
v_accvgpr_read_b32 v201, a69
v_mfma_f32_16x16x32_bf16 a[108:111], v[240:243], v[140:143], a[108:111]
v_accvgpr_read_b32 v202, a70
v_accvgpr_read_b32 v203, a71
v_mfma_f32_16x16x32_bf16 a[108:111], v[244:247], v[156:159], a[108:111]
s_waitcnt lgkmcnt(4)
v_cvt_pk_bf16_f32 v56, v200, v201
v_mfma_f32_16x16x32_bf16 a[96:99], v[224:227], v[160:163], a[96:99]
ds_read_b64_tr_b16 v[240:241], v13 offset:4608
ds_read_b64_tr_b16 v[242:243], v13 offset:6656
v_mfma_f32_16x16x32_bf16 a[96:99], v[228:231], v[0:3], a[96:99]
v_cvt_pk_bf16_f32 v57, v202, v203
v_accvgpr_read_b32 v208, a72
v_mfma_f32_16x16x32_bf16 a[100:103], v[224:227], v[164:167], a[100:103]
v_accvgpr_read_b32 v209, a73
v_accvgpr_read_b32 v210, a74
v_mfma_f32_16x16x32_bf16 a[100:103], v[228:231], v[32:35], a[100:103]
v_accvgpr_read_b32 v211, a75
v_cvt_pk_bf16_f32 v88, v208, v209
v_mfma_f32_16x16x32_bf16 a[104:107], v[224:227], v[168:171], a[104:107]
ds_read_b64_tr_b16 v[244:245], v13 offset:20992
ds_read_b64_tr_b16 v[246:247], v13 offset:23040
v_mfma_f32_16x16x32_bf16 a[104:107], v[228:231], v[64:67], a[104:107]
v_cvt_pk_bf16_f32 v89, v210, v211
v_accvgpr_read_b32 v216, a76
v_mfma_f32_16x16x32_bf16 a[108:111], v[224:227], v[172:175], a[108:111]
v_accvgpr_read_b32 v217, a77
v_accvgpr_read_b32 v218, a78
v_mfma_f32_16x16x32_bf16 a[108:111], v[228:231], v[96:99], a[108:111]
s_waitcnt lgkmcnt(4)
v_accvgpr_read_b32 v219, a79
v_mfma_f32_16x16x32_bf16 a[112:115], v[232:235], v[4:7], a[112:115]
ds_read_b64_tr_b16 v[224:225], v13 offset:37376
ds_read_b64_tr_b16 v[226:227], v13 offset:39424
v_mfma_f32_16x16x32_bf16 a[112:115], v[236:239], v[176:179], a[112:115]
v_cvt_pk_bf16_f32 v120, v216, v217
v_cvt_pk_bf16_f32 v121, v218, v219
v_mfma_f32_16x16x32_bf16 a[116:119], v[232:235], v[36:39], a[116:119]
v_accvgpr_read_b32 v196, a80
v_accvgpr_read_b32 v197, a81
v_mfma_f32_16x16x32_bf16 a[116:119], v[236:239], v[180:183], a[116:119]
v_accvgpr_read_b32 v198, a82
v_accvgpr_read_b32 v199, a83
v_mfma_f32_16x16x32_bf16 a[120:123], v[232:235], v[68:71], a[120:123]
ds_read_b64_tr_b16 v[228:229], v13 offset:53760
ds_read_b64_tr_b16 v[230:231], v13 offset:55808
v_mfma_f32_16x16x32_bf16 a[120:123], v[236:239], v[184:187], a[120:123]
v_cvt_pk_bf16_f32 v26, v196, v197
v_cvt_pk_bf16_f32 v27, v198, v199
v_mfma_f32_16x16x32_bf16 a[124:127], v[232:235], v[100:103], a[124:127]
buffer_store_dwordx4 v[24:27], v252, s[20:23], s40 offen offset:2048 sc1
ds_write_b128 v255, v[24:27] offset:2048
v_mfma_f32_16x16x32_bf16 a[124:127], v[236:239], v[188:191], a[124:127]
s_waitcnt lgkmcnt(5)
v_accvgpr_read_b32 v204, a84
v_mfma_f32_16x16x32_bf16 a[112:115], v[240:243], v[128:131], a[112:115]
ds_read_b64_tr_b16 v[232:233], v249 offset:40960
ds_read_b64_tr_b16 v[234:235], v249 offset:43008
v_mfma_f32_16x16x32_bf16 a[112:115], v[244:247], v[144:147], a[112:115]
v_accvgpr_read_b32 v205, a85
v_accvgpr_read_b32 v206, a86
v_mfma_f32_16x16x32_bf16 a[116:119], v[240:243], v[132:135], a[116:119]
v_accvgpr_read_b32 v207, a87
v_cvt_pk_bf16_f32 v58, v204, v205
v_mfma_f32_16x16x32_bf16 a[116:119], v[244:247], v[148:151], a[116:119]
v_cvt_pk_bf16_f32 v59, v206, v207
buffer_store_dwordx4 v[56:59], v252, s[20:23], s41 offen offset:2048 sc1
v_mfma_f32_16x16x32_bf16 a[120:123], v[240:243], v[136:139], a[120:123]
ds_read_b64_tr_b16 v[236:237], v249 offset:57344
ds_read_b64_tr_b16 v[238:239], v249 offset:59392
v_mfma_f32_16x16x32_bf16 a[120:123], v[244:247], v[152:155], a[120:123]
v_accvgpr_read_b32 v212, a88
v_accvgpr_read_b32 v213, a89
v_mfma_f32_16x16x32_bf16 a[124:127], v[240:243], v[140:143], a[124:127]
v_accvgpr_read_b32 v214, a90
v_accvgpr_read_b32 v215, a91
v_mfma_f32_16x16x32_bf16 a[124:127], v[244:247], v[156:159], a[124:127]
s_waitcnt lgkmcnt(5)
v_cvt_pk_bf16_f32 v90, v212, v213
v_mfma_f32_16x16x32_bf16 a[112:115], v[224:227], v[160:163], a[112:115]
ds_read_b64_tr_b16 v[240:241], v12 offset:8192
ds_read_b64_tr_b16 v[242:243], v12 offset:10240
v_mfma_f32_16x16x32_bf16 a[112:115], v[228:231], v[0:3], a[112:115]
v_cvt_pk_bf16_f32 v91, v214, v215
buffer_store_dwordx4 v[88:91], v252, s[20:23], s42 offen offset:2048 sc1
v_mfma_f32_16x16x32_bf16 a[116:119], v[224:227], v[164:167], a[116:119]
v_accvgpr_read_b32 v220, a92
v_accvgpr_read_b32 v221, a93
v_mfma_f32_16x16x32_bf16 a[116:119], v[228:231], v[32:35], a[116:119]
v_accvgpr_read_b32 v222, a94
v_accvgpr_read_b32 v223, a95
v_mfma_f32_16x16x32_bf16 a[120:123], v[224:227], v[168:171], a[120:123]
ds_read_b64_tr_b16 v[244:245], v12 offset:24576
ds_read_b64_tr_b16 v[246:247], v12 offset:26624
v_mfma_f32_16x16x32_bf16 a[120:123], v[228:231], v[64:67], a[120:123]
v_cvt_pk_bf16_f32 v122, v220, v221
v_cvt_pk_bf16_f32 v123, v222, v223
v_mfma_f32_16x16x32_bf16 a[124:127], v[224:227], v[172:175], a[124:127]
buffer_store_dwordx4 v[120:123], v252, s[20:23], s43 offen offset:2048 sc1
v_accvgpr_read_b32 v192, a96
v_mfma_f32_16x16x32_bf16 a[124:127], v[228:231], v[96:99], a[124:127]
s_waitcnt lgkmcnt(4)
v_accvgpr_read_b32 v193, a97
v_mfma_f32_16x16x32_bf16 a[128:131], v[232:235], v[4:7], a[128:131]
ds_read_b64_tr_b16 v[224:225], v12 offset:40960
ds_read_b64_tr_b16 v[226:227], v12 offset:43008
v_mfma_f32_16x16x32_bf16 a[128:131], v[236:239], v[176:179], a[128:131]
v_accvgpr_read_b32 v194, a98
v_accvgpr_read_b32 v195, a99
v_mfma_f32_16x16x32_bf16 a[132:135], v[232:235], v[36:39], a[132:135]
v_cvt_pk_bf16_f32 v28, v192, v193
v_cvt_pk_bf16_f32 v29, v194, v195
v_mfma_f32_16x16x32_bf16 a[132:135], v[236:239], v[180:183], a[132:135]
v_accvgpr_read_b32 v200, a100
v_accvgpr_read_b32 v201, a101
v_mfma_f32_16x16x32_bf16 a[136:139], v[232:235], v[68:71], a[136:139]
ds_read_b64_tr_b16 v[228:229], v12 offset:57344
ds_read_b64_tr_b16 v[230:231], v12 offset:59392
v_mfma_f32_16x16x32_bf16 a[136:139], v[236:239], v[184:187], a[136:139]
v_accvgpr_read_b32 v202, a102
v_accvgpr_read_b32 v203, a103
v_mfma_f32_16x16x32_bf16 a[140:143], v[232:235], v[100:103], a[140:143]
v_cvt_pk_bf16_f32 v60, v200, v201
v_cvt_pk_bf16_f32 v61, v202, v203
v_mfma_f32_16x16x32_bf16 a[140:143], v[236:239], v[188:191], a[140:143]
s_waitcnt lgkmcnt(4)
v_accvgpr_read_b32 v208, a104
v_mfma_f32_16x16x32_bf16 a[128:131], v[240:243], v[128:131], a[128:131]
ds_read_b64_tr_b16 v[232:233], v250 offset:40960
ds_read_b64_tr_b16 v[234:235], v250 offset:43008
v_mfma_f32_16x16x32_bf16 a[128:131], v[244:247], v[144:147], a[128:131]
v_accvgpr_read_b32 v209, a105
v_accvgpr_read_b32 v210, a106
v_mfma_f32_16x16x32_bf16 a[132:135], v[240:243], v[132:135], a[132:135]
v_accvgpr_read_b32 v211, a107
v_cvt_pk_bf16_f32 v92, v208, v209
v_mfma_f32_16x16x32_bf16 a[132:135], v[244:247], v[148:151], a[132:135]
v_cvt_pk_bf16_f32 v93, v210, v211
v_accvgpr_read_b32 v216, a108
v_mfma_f32_16x16x32_bf16 a[136:139], v[240:243], v[136:139], a[136:139]
ds_read_b64_tr_b16 v[236:237], v250 offset:57344
ds_read_b64_tr_b16 v[238:239], v250 offset:59392
v_mfma_f32_16x16x32_bf16 a[136:139], v[244:247], v[152:155], a[136:139]
v_accvgpr_read_b32 v217, a109
v_accvgpr_read_b32 v218, a110
v_mfma_f32_16x16x32_bf16 a[140:143], v[240:243], v[140:143], a[140:143]
v_accvgpr_read_b32 v219, a111
v_cvt_pk_bf16_f32 v124, v216, v217
v_mfma_f32_16x16x32_bf16 a[140:143], v[244:247], v[156:159], a[140:143]
s_waitcnt lgkmcnt(4)
v_cvt_pk_bf16_f32 v125, v218, v219
v_mfma_f32_16x16x32_bf16 a[128:131], v[224:227], v[160:163], a[128:131]
ds_read_b64_tr_b16 v[240:241], v13 offset:8192
ds_read_b64_tr_b16 v[242:243], v13 offset:10240
v_mfma_f32_16x16x32_bf16 a[128:131], v[228:231], v[0:3], a[128:131]
v_accvgpr_read_b32 v196, a112
v_accvgpr_read_b32 v197, a113
v_mfma_f32_16x16x32_bf16 a[132:135], v[224:227], v[164:167], a[132:135]
v_accvgpr_read_b32 v198, a114
v_accvgpr_read_b32 v199, a115
v_mfma_f32_16x16x32_bf16 a[132:135], v[228:231], v[32:35], a[132:135]
v_cvt_pk_bf16_f32 v30, v196, v197
v_cvt_pk_bf16_f32 v31, v198, v199
v_mfma_f32_16x16x32_bf16 a[136:139], v[224:227], v[168:171], a[136:139]
ds_read_b64_tr_b16 v[244:245], v13 offset:24576
ds_read_b64_tr_b16 v[246:247], v13 offset:26624
v_mfma_f32_16x16x32_bf16 a[136:139], v[228:231], v[64:67], a[136:139]
buffer_store_dwordx4 v[28:31], v252, s[20:23], s40 offen offset:3072 sc1
ds_write_b128 v255, v[28:31] offset:3072
v_mfma_f32_16x16x32_bf16 a[140:143], v[224:227], v[172:175], a[140:143]
v_accvgpr_read_b32 v204, a116
v_accvgpr_read_b32 v205, a117
v_mfma_f32_16x16x32_bf16 a[140:143], v[228:231], v[96:99], a[140:143]
s_waitcnt lgkmcnt(5)
v_accvgpr_read_b32 v206, a118
v_mfma_f32_16x16x32_bf16 a[144:147], v[232:235], v[4:7], a[144:147]
ds_read_b64_tr_b16 v[224:225], v13 offset:40960
ds_read_b64_tr_b16 v[226:227], v13 offset:43008
v_mfma_f32_16x16x32_bf16 a[144:147], v[236:239], v[176:179], a[144:147]
v_accvgpr_read_b32 v207, a119
v_cvt_pk_bf16_f32 v62, v204, v205
v_mfma_f32_16x16x32_bf16 a[148:151], v[232:235], v[36:39], a[148:151]
v_cvt_pk_bf16_f32 v63, v206, v207
buffer_store_dwordx4 v[60:63], v252, s[20:23], s41 offen offset:3072 sc1
v_mfma_f32_16x16x32_bf16 a[148:151], v[236:239], v[180:183], a[148:151]
v_accvgpr_read_b32 v212, a120
v_accvgpr_read_b32 v213, a121
v_mfma_f32_16x16x32_bf16 a[152:155], v[232:235], v[68:71], a[152:155]
ds_read_b64_tr_b16 v[228:229], v13 offset:57344
ds_read_b64_tr_b16 v[230:231], v13 offset:59392
v_mfma_f32_16x16x32_bf16 a[152:155], v[236:239], v[184:187], a[152:155]
v_accvgpr_read_b32 v214, a122
v_accvgpr_read_b32 v215, a123
v_mfma_f32_16x16x32_bf16 a[156:159], v[232:235], v[100:103], a[156:159]
v_cvt_pk_bf16_f32 v94, v212, v213
v_cvt_pk_bf16_f32 v95, v214, v215
v_mfma_f32_16x16x32_bf16 a[156:159], v[236:239], v[188:191], a[156:159]
s_waitcnt lgkmcnt(5)
buffer_store_dwordx4 v[92:95], v252, s[20:23], s42 offen offset:3072 sc1
v_mfma_f32_16x16x32_bf16 a[144:147], v[240:243], v[128:131], a[144:147]
ds_read_b64_tr_b16 v[232:233], v249 offset:41472
ds_read_b64_tr_b16 v[234:235], v249 offset:43520
v_mfma_f32_16x16x32_bf16 a[144:147], v[244:247], v[144:147], a[144:147]
v_accvgpr_read_b32 v220, a124
v_accvgpr_read_b32 v221, a125
v_mfma_f32_16x16x32_bf16 a[148:151], v[240:243], v[132:135], a[148:151]
v_accvgpr_read_b32 v222, a126
v_accvgpr_read_b32 v223, a127
v_mfma_f32_16x16x32_bf16 a[148:151], v[244:247], v[148:151], a[148:151]
v_cvt_pk_bf16_f32 v126, v220, v221
v_cvt_pk_bf16_f32 v127, v222, v223
v_mfma_f32_16x16x32_bf16 a[152:155], v[240:243], v[136:139], a[152:155]
ds_read_b64_tr_b16 v[236:237], v249 offset:57856
ds_read_b64_tr_b16 v[238:239], v249 offset:59904
v_mfma_f32_16x16x32_bf16 a[152:155], v[244:247], v[152:155], a[152:155]
buffer_store_dwordx4 v[124:127], v252, s[20:23], s43 offen offset:3072 sc1
v_accvgpr_read_b32 v192, a128
v_mfma_f32_16x16x32_bf16 a[156:159], v[240:243], v[140:143], a[156:159]
v_accvgpr_read_b32 v193, a129
v_accvgpr_read_b32 v194, a130
v_mfma_f32_16x16x32_bf16 a[156:159], v[244:247], v[156:159], a[156:159]
s_waitcnt lgkmcnt(4)
v_accvgpr_read_b32 v195, a131
v_mfma_f32_16x16x32_bf16 a[144:147], v[224:227], v[160:163], a[144:147]
ds_read_b64_tr_b16 v[240:241], v12 offset:8704
ds_read_b64_tr_b16 v[242:243], v12 offset:10752
v_mfma_f32_16x16x32_bf16 a[144:147], v[228:231], v[0:3], a[144:147]
v_cvt_pk_bf16_f32 v16, v192, v193
v_cvt_pk_bf16_f32 v17, v194, v195
v_mfma_f32_16x16x32_bf16 a[148:151], v[224:227], v[164:167], a[148:151]
v_accvgpr_read_b32 v200, a132
v_accvgpr_read_b32 v201, a133
v_mfma_f32_16x16x32_bf16 a[148:151], v[228:231], v[32:35], a[148:151]
v_accvgpr_read_b32 v202, a134
v_accvgpr_read_b32 v203, a135
v_mfma_f32_16x16x32_bf16 a[152:155], v[224:227], v[168:171], a[152:155]
ds_read_b64_tr_b16 v[244:245], v12 offset:25088
ds_read_b64_tr_b16 v[246:247], v12 offset:27136
v_mfma_f32_16x16x32_bf16 a[152:155], v[228:231], v[64:67], a[152:155]
v_cvt_pk_bf16_f32 v48, v200, v201
v_cvt_pk_bf16_f32 v49, v202, v203
v_mfma_f32_16x16x32_bf16 a[156:159], v[224:227], v[172:175], a[156:159]
v_accvgpr_read_b32 v208, a136
v_accvgpr_read_b32 v209, a137
v_mfma_f32_16x16x32_bf16 a[156:159], v[228:231], v[96:99], a[156:159]
s_waitcnt lgkmcnt(4)
v_accvgpr_read_b32 v210, a138
v_mfma_f32_16x16x32_bf16 a[160:163], v[232:235], v[4:7], a[160:163]
ds_read_b64_tr_b16 v[224:225], v12 offset:41472
ds_read_b64_tr_b16 v[226:227], v12 offset:43520
v_mfma_f32_16x16x32_bf16 a[160:163], v[236:239], v[176:179], a[160:163]
v_accvgpr_read_b32 v211, a139
v_cvt_pk_bf16_f32 v80, v208, v209
v_mfma_f32_16x16x32_bf16 a[164:167], v[232:235], v[36:39], a[164:167]
v_cvt_pk_bf16_f32 v81, v210, v211
v_accvgpr_read_b32 v216, a140
v_mfma_f32_16x16x32_bf16 a[164:167], v[236:239], v[180:183], a[164:167]
v_accvgpr_read_b32 v217, a141
v_accvgpr_read_b32 v218, a142
v_mfma_f32_16x16x32_bf16 a[168:171], v[232:235], v[68:71], a[168:171]
ds_read_b64_tr_b16 v[228:229], v12 offset:57856
ds_read_b64_tr_b16 v[230:231], v12 offset:59904
v_mfma_f32_16x16x32_bf16 a[168:171], v[236:239], v[184:187], a[168:171]
v_accvgpr_read_b32 v219, a143
v_cvt_pk_bf16_f32 v112, v216, v217
v_mfma_f32_16x16x32_bf16 a[172:175], v[232:235], v[100:103], a[172:175]
v_cvt_pk_bf16_f32 v113, v218, v219
v_accvgpr_read_b32 v196, a144
v_mfma_f32_16x16x32_bf16 a[172:175], v[236:239], v[188:191], a[172:175]
s_waitcnt lgkmcnt(4)
v_accvgpr_read_b32 v197, a145
v_mfma_f32_16x16x32_bf16 a[160:163], v[240:243], v[128:131], a[160:163]
ds_read_b64_tr_b16 v[232:233], v250 offset:41472
ds_read_b64_tr_b16 v[234:235], v250 offset:43520
v_mfma_f32_16x16x32_bf16 a[160:163], v[244:247], v[144:147], a[160:163]
v_accvgpr_read_b32 v198, a146
v_accvgpr_read_b32 v199, a147
v_mfma_f32_16x16x32_bf16 a[164:167], v[240:243], v[132:135], a[164:167]
v_cvt_pk_bf16_f32 v18, v196, v197
v_cvt_pk_bf16_f32 v19, v198, v199
v_mfma_f32_16x16x32_bf16 a[164:167], v[244:247], v[148:151], a[164:167]
buffer_store_dwordx4 v[16:19], v252, s[20:23], s44 offen offset:0 sc1
v_accvgpr_read_b32 v204, a148
v_mfma_f32_16x16x32_bf16 a[168:171], v[240:243], v[136:139], a[168:171]
ds_read_b64_tr_b16 v[236:237], v250 offset:57856
ds_read_b64_tr_b16 v[238:239], v250 offset:59904
v_mfma_f32_16x16x32_bf16 a[168:171], v[244:247], v[152:155], a[168:171]
v_accvgpr_read_b32 v205, a149
v_accvgpr_read_b32 v206, a150
v_mfma_f32_16x16x32_bf16 a[172:175], v[240:243], v[140:143], a[172:175]
v_accvgpr_read_b32 v207, a151
v_cvt_pk_bf16_f32 v50, v204, v205
s_mov_b32 s33, 0x6c01400
v_mfma_f32_16x16x32_bf16 a[172:175], v[244:247], v[156:159], a[172:175]
s_waitcnt lgkmcnt(4)
v_cvt_pk_bf16_f32 v51, v206, v207
buffer_load_dword v254, off, s[56:59], s33 sc1
v_mfma_f32_16x16x32_bf16 a[160:163], v[224:227], v[160:163], a[160:163]
ds_read_b64_tr_b16 v[240:241], v13 offset:8704
ds_read_b64_tr_b16 v[242:243], v13 offset:10752
v_mfma_f32_16x16x32_bf16 a[160:163], v[228:231], v[0:3], a[160:163]
buffer_store_dwordx4 v[48:51], v252, s[20:23], s45 offen offset:0 sc1
v_accvgpr_read_b32 v212, a152
v_mfma_f32_16x16x32_bf16 a[164:167], v[224:227], v[164:167], a[164:167]
v_accvgpr_read_b32 v213, a153
v_accvgpr_read_b32 v214, a154
v_mfma_f32_16x16x32_bf16 a[164:167], v[228:231], v[32:35], a[164:167]
v_accvgpr_read_b32 v215, a155
v_cvt_pk_bf16_f32 v82, v212, v213
v_mfma_f32_16x16x32_bf16 a[168:171], v[224:227], v[168:171], a[168:171]
ds_read_b64_tr_b16 v[244:245], v13 offset:25088
ds_read_b64_tr_b16 v[246:247], v13 offset:27136
v_mfma_f32_16x16x32_bf16 a[168:171], v[228:231], v[64:67], a[168:171]
v_cvt_pk_bf16_f32 v83, v214, v215
buffer_store_dwordx4 v[80:83], v252, s[20:23], s46 offen offset:0 sc1
v_mfma_f32_16x16x32_bf16 a[172:175], v[224:227], v[172:175], a[172:175]
v_accvgpr_read_b32 v220, a156
v_accvgpr_read_b32 v221, a157
v_mfma_f32_16x16x32_bf16 a[172:175], v[228:231], v[96:99], a[172:175]
s_waitcnt lgkmcnt(4)
v_accvgpr_read_b32 v222, a158
v_mfma_f32_16x16x32_bf16 a[176:179], v[232:235], v[4:7], a[176:179]
ds_read_b64_tr_b16 v[224:225], v13 offset:41472
ds_read_b64_tr_b16 v[226:227], v13 offset:43520
v_mfma_f32_16x16x32_bf16 a[176:179], v[236:239], v[176:179], a[176:179]
v_accvgpr_read_b32 v223, a159
v_cvt_pk_bf16_f32 v114, v220, v221
v_mfma_f32_16x16x32_bf16 a[180:183], v[232:235], v[36:39], a[180:183]
v_cvt_pk_bf16_f32 v115, v222, v223
buffer_store_dwordx4 v[112:115], v252, s[20:23], s47 offen offset:0 sc1
v_mfma_f32_16x16x32_bf16 a[180:183], v[236:239], v[180:183], a[180:183]
v_accvgpr_read_b32 v192, a160
v_accvgpr_read_b32 v193, a161
v_mfma_f32_16x16x32_bf16 a[184:187], v[232:235], v[68:71], a[184:187]
ds_read_b64_tr_b16 v[228:229], v13 offset:57856
ds_read_b64_tr_b16 v[230:231], v13 offset:59904
v_mfma_f32_16x16x32_bf16 a[184:187], v[236:239], v[184:187], a[184:187]
v_accvgpr_read_b32 v194, a162
v_accvgpr_read_b32 v195, a163
v_mfma_f32_16x16x32_bf16 a[188:191], v[232:235], v[100:103], a[188:191]
v_cvt_pk_bf16_f32 v20, v192, v193
v_cvt_pk_bf16_f32 v21, v194, v195
v_mfma_f32_16x16x32_bf16 a[188:191], v[236:239], v[188:191], a[188:191]
s_waitcnt lgkmcnt(4)
v_accvgpr_read_b32 v200, a164
v_mfma_f32_16x16x32_bf16 a[176:179], v[240:243], v[128:131], a[176:179]
ds_read_b64_tr_b16 v[232:233], v249 offset:45056
ds_read_b64_tr_b16 v[234:235], v249 offset:47104
v_mfma_f32_16x16x32_bf16 a[176:179], v[244:247], v[144:147], a[176:179]
v_accvgpr_read_b32 v201, a165
v_accvgpr_read_b32 v202, a166
v_mfma_f32_16x16x32_bf16 a[180:183], v[240:243], v[132:135], a[180:183]
v_accvgpr_read_b32 v203, a167
v_cvt_pk_bf16_f32 v52, v200, v201
v_mfma_f32_16x16x32_bf16 a[180:183], v[244:247], v[148:151], a[180:183]
v_cvt_pk_bf16_f32 v53, v202, v203
v_accvgpr_read_b32 v208, a168
v_mfma_f32_16x16x32_bf16 a[184:187], v[240:243], v[136:139], a[184:187]
ds_read_b64_tr_b16 v[236:237], v249 offset:61440
ds_read_b64_tr_b16 v[238:239], v249 offset:63488
v_mfma_f32_16x16x32_bf16 a[184:187], v[244:247], v[152:155], a[184:187]
v_accvgpr_read_b32 v209, a169
v_accvgpr_read_b32 v210, a170
v_mfma_f32_16x16x32_bf16 a[188:191], v[240:243], v[140:143], a[188:191]
v_accvgpr_read_b32 v211, a171
v_cvt_pk_bf16_f32 v84, v208, v209
v_mfma_f32_16x16x32_bf16 a[188:191], v[244:247], v[156:159], a[188:191]
s_waitcnt lgkmcnt(4)
v_cvt_pk_bf16_f32 v85, v210, v211
v_mfma_f32_16x16x32_bf16 a[176:179], v[224:227], v[160:163], a[176:179]
ds_read_b64_tr_b16 v[240:241], v12 offset:12288
ds_read_b64_tr_b16 v[242:243], v12 offset:14336
v_mfma_f32_16x16x32_bf16 a[176:179], v[228:231], v[0:3], a[176:179]
v_accvgpr_read_b32 v216, a172
v_accvgpr_read_b32 v217, a173
v_mfma_f32_16x16x32_bf16 a[180:183], v[224:227], v[164:167], a[180:183]
v_accvgpr_read_b32 v218, a174
v_accvgpr_read_b32 v219, a175
v_mfma_f32_16x16x32_bf16 a[180:183], v[228:231], v[32:35], a[180:183]
v_cvt_pk_bf16_f32 v116, v216, v217
v_cvt_pk_bf16_f32 v117, v218, v219
v_mfma_f32_16x16x32_bf16 a[184:187], v[224:227], v[168:171], a[184:187]
ds_read_b64_tr_b16 v[244:245], v12 offset:28672
ds_read_b64_tr_b16 v[246:247], v12 offset:30720
v_mfma_f32_16x16x32_bf16 a[184:187], v[228:231], v[64:67], a[184:187]
v_mfma_f32_16x16x32_bf16 a[188:191], v[224:227], v[172:175], a[188:191]
v_accvgpr_read_b32 v196, a176
v_accvgpr_read_b32 v197, a177
v_mfma_f32_16x16x32_bf16 a[188:191], v[228:231], v[96:99], a[188:191]
s_waitcnt lgkmcnt(4)
v_accvgpr_read_b32 v198, a178
v_mfma_f32_16x16x32_bf16 a[192:195], v[232:235], v[4:7], a[192:195]
ds_read_b64_tr_b16 v[224:225], v12 offset:45056
ds_read_b64_tr_b16 v[226:227], v12 offset:47104
v_mfma_f32_16x16x32_bf16 a[192:195], v[236:239], v[176:179], a[192:195]
v_accvgpr_read_b32 v199, a179
v_cvt_pk_bf16_f32 v22, v196, v197
v_mfma_f32_16x16x32_bf16 a[196:199], v[232:235], v[36:39], a[196:199]
v_cvt_pk_bf16_f32 v23, v198, v199
buffer_store_dwordx4 v[20:23], v252, s[20:23], s44 offen offset:1024 sc1
v_mfma_f32_16x16x32_bf16 a[196:199], v[236:239], v[180:183], a[196:199]
v_accvgpr_read_b32 v204, a180
v_accvgpr_read_b32 v205, a181
v_mfma_f32_16x16x32_bf16 a[200:203], v[232:235], v[68:71], a[200:203]
ds_read_b64_tr_b16 v[228:229], v12 offset:61440
ds_read_b64_tr_b16 v[230:231], v12 offset:63488
v_mfma_f32_16x16x32_bf16 a[200:203], v[236:239], v[184:187], a[200:203]
v_accvgpr_read_b32 v206, a182
v_accvgpr_read_b32 v207, a183
v_mfma_f32_16x16x32_bf16 a[204:207], v[232:235], v[100:103], a[204:207]
v_cvt_pk_bf16_f32 v54, v204, v205
v_cvt_pk_bf16_f32 v55, v206, v207
v_mfma_f32_16x16x32_bf16 a[204:207], v[236:239], v[188:191], a[204:207]
s_waitcnt lgkmcnt(4)
buffer_store_dwordx4 v[52:55], v252, s[20:23], s45 offen offset:1024 sc1
v_mfma_f32_16x16x32_bf16 a[192:195], v[240:243], v[128:131], a[192:195]
ds_read_b64_tr_b16 v[232:233], v250 offset:45056
ds_read_b64_tr_b16 v[234:235], v250 offset:47104
v_mfma_f32_16x16x32_bf16 a[192:195], v[244:247], v[144:147], a[192:195]
v_accvgpr_read_b32 v212, a184
v_accvgpr_read_b32 v213, a185
v_mfma_f32_16x16x32_bf16 a[196:199], v[240:243], v[132:135], a[196:199]
v_accvgpr_read_b32 v214, a186
v_accvgpr_read_b32 v215, a187
v_mfma_f32_16x16x32_bf16 a[196:199], v[244:247], v[148:151], a[196:199]
v_cvt_pk_bf16_f32 v86, v212, v213
v_cvt_pk_bf16_f32 v87, v214, v215
v_mfma_f32_16x16x32_bf16 a[200:203], v[240:243], v[136:139], a[200:203]
ds_read_b64_tr_b16 v[236:237], v250 offset:61440
ds_read_b64_tr_b16 v[238:239], v250 offset:63488
v_mfma_f32_16x16x32_bf16 a[200:203], v[244:247], v[152:155], a[200:203]
buffer_store_dwordx4 v[84:87], v252, s[20:23], s46 offen offset:1024 sc1
v_accvgpr_read_b32 v220, a188
v_mfma_f32_16x16x32_bf16 a[204:207], v[240:243], v[140:143], a[204:207]
v_accvgpr_read_b32 v221, a189
v_accvgpr_read_b32 v222, a190
v_mfma_f32_16x16x32_bf16 a[204:207], v[244:247], v[156:159], a[204:207]
s_waitcnt lgkmcnt(4)
v_accvgpr_read_b32 v223, a191
v_mfma_f32_16x16x32_bf16 a[192:195], v[224:227], v[160:163], a[192:195]
ds_read_b64_tr_b16 v[240:241], v13 offset:12288
ds_read_b64_tr_b16 v[242:243], v13 offset:14336
v_mfma_f32_16x16x32_bf16 a[192:195], v[228:231], v[0:3], a[192:195]
v_cvt_pk_bf16_f32 v118, v220, v221
v_cvt_pk_bf16_f32 v119, v222, v223
v_mfma_f32_16x16x32_bf16 a[196:199], v[224:227], v[164:167], a[196:199]
buffer_store_dwordx4 v[116:119], v252, s[20:23], s47 offen offset:1024 sc1
v_mfma_f32_16x16x32_bf16 a[196:199], v[228:231], v[32:35], a[196:199]
v_mfma_f32_16x16x32_bf16 a[200:203], v[224:227], v[168:171], a[200:203]
ds_read_b64_tr_b16 v[244:245], v13 offset:28672
ds_read_b64_tr_b16 v[246:247], v13 offset:30720
v_mfma_f32_16x16x32_bf16 a[200:203], v[228:231], v[64:67], a[200:203]
v_mfma_f32_16x16x32_bf16 a[204:207], v[224:227], v[172:175], a[204:207]
v_accvgpr_read_b32 v192, a192
v_accvgpr_read_b32 v193, a193
v_mfma_f32_16x16x32_bf16 a[204:207], v[228:231], v[96:99], a[204:207]
s_waitcnt lgkmcnt(4)
v_accvgpr_read_b32 v194, a194
v_mfma_f32_16x16x32_bf16 a[208:211], v[232:235], v[4:7], a[208:211]
ds_read_b64_tr_b16 v[224:225], v13 offset:45056
ds_read_b64_tr_b16 v[226:227], v13 offset:47104
v_mfma_f32_16x16x32_bf16 a[208:211], v[236:239], v[176:179], a[208:211]
v_accvgpr_read_b32 v195, a195
v_cvt_pk_bf16_f32 v24, v192, v193
v_mfma_f32_16x16x32_bf16 a[212:215], v[232:235], v[36:39], a[212:215]
v_cvt_pk_bf16_f32 v25, v194, v195
v_accvgpr_read_b32 v200, a196
v_mfma_f32_16x16x32_bf16 a[212:215], v[236:239], v[180:183], a[212:215]
v_accvgpr_read_b32 v201, a197
v_accvgpr_read_b32 v202, a198
v_mfma_f32_16x16x32_bf16 a[216:219], v[232:235], v[68:71], a[216:219]
ds_read_b64_tr_b16 v[228:229], v13 offset:61440
ds_read_b64_tr_b16 v[230:231], v13 offset:63488
v_mfma_f32_16x16x32_bf16 a[216:219], v[236:239], v[184:187], a[216:219]
v_accvgpr_read_b32 v203, a199
v_cvt_pk_bf16_f32 v56, v200, v201
v_mfma_f32_16x16x32_bf16 a[220:223], v[232:235], v[100:103], a[220:223]
v_cvt_pk_bf16_f32 v57, v202, v203
v_accvgpr_read_b32 v208, a200
v_mfma_f32_16x16x32_bf16 a[220:223], v[236:239], v[188:191], a[220:223]
s_waitcnt lgkmcnt(4)
v_accvgpr_read_b32 v209, a201
v_mfma_f32_16x16x32_bf16 a[208:211], v[240:243], v[128:131], a[208:211]
ds_read_b64_tr_b16 v[232:233], v249 offset:45568
ds_read_b64_tr_b16 v[234:235], v249 offset:47616
v_mfma_f32_16x16x32_bf16 a[208:211], v[244:247], v[144:147], a[208:211]
v_accvgpr_read_b32 v210, a202
v_accvgpr_read_b32 v211, a203
v_mfma_f32_16x16x32_bf16 a[212:215], v[240:243], v[132:135], a[212:215]
v_cvt_pk_bf16_f32 v88, v208, v209
v_cvt_pk_bf16_f32 v89, v210, v211
v_mfma_f32_16x16x32_bf16 a[212:215], v[244:247], v[148:151], a[212:215]
v_accvgpr_read_b32 v216, a204
v_accvgpr_read_b32 v217, a205
v_mfma_f32_16x16x32_bf16 a[216:219], v[240:243], v[136:139], a[216:219]
ds_read_b64_tr_b16 v[236:237], v249 offset:61952
ds_read_b64_tr_b16 v[238:239], v249 offset:64000
v_mfma_f32_16x16x32_bf16 a[216:219], v[244:247], v[152:155], a[216:219]
v_accvgpr_read_b32 v218, a206
v_accvgpr_read_b32 v219, a207
v_mfma_f32_16x16x32_bf16 a[220:223], v[240:243], v[140:143], a[220:223]
v_cvt_pk_bf16_f32 v120, v216, v217
v_cvt_pk_bf16_f32 v121, v218, v219
v_mfma_f32_16x16x32_bf16 a[220:223], v[244:247], v[156:159], a[220:223]
s_waitcnt lgkmcnt(4)
v_mfma_f32_16x16x32_bf16 a[208:211], v[224:227], v[160:163], a[208:211]
ds_read_b64_tr_b16 v[240:241], v12 offset:12800
ds_read_b64_tr_b16 v[242:243], v12 offset:14848
v_mfma_f32_16x16x32_bf16 a[208:211], v[228:231], v[0:3], a[208:211]
v_mfma_f32_16x16x32_bf16 a[212:215], v[224:227], v[164:167], a[212:215]
v_mfma_f32_16x16x32_bf16 a[212:215], v[228:231], v[32:35], a[212:215]
v_mfma_f32_16x16x32_bf16 a[216:219], v[224:227], v[168:171], a[216:219]
ds_read_b64_tr_b16 v[244:245], v12 offset:29184
ds_read_b64_tr_b16 v[246:247], v12 offset:31232
v_mfma_f32_16x16x32_bf16 a[216:219], v[228:231], v[64:67], a[216:219]
v_mfma_f32_16x16x32_bf16 a[220:223], v[224:227], v[172:175], a[220:223]
s_nop 0
v_accvgpr_read_b32 v196, a208
v_accvgpr_read_b32 v197, a209
v_mfma_f32_16x16x32_bf16 a[220:223], v[228:231], v[96:99], a[220:223]
s_waitcnt lgkmcnt(4)
v_accvgpr_read_b32 v198, a210
v_mfma_f32_16x16x32_bf16 a[224:227], v[232:235], v[4:7], a[224:227]
ds_read_b64_tr_b16 v[224:225], v12 offset:45568
ds_read_b64_tr_b16 v[226:227], v12 offset:47616
v_mfma_f32_16x16x32_bf16 a[224:227], v[236:239], v[176:179], a[224:227]
v_accvgpr_read_b32 v199, a211
v_cvt_pk_bf16_f32 v26, v196, v197
v_mfma_f32_16x16x32_bf16 a[228:231], v[232:235], v[36:39], a[228:231]
v_cvt_pk_bf16_f32 v27, v198, v199
buffer_store_dwordx4 v[24:27], v252, s[20:23], s44 offen offset:2048 sc1
v_mfma_f32_16x16x32_bf16 a[228:231], v[236:239], v[180:183], a[228:231]
v_accvgpr_read_b32 v204, a212
v_accvgpr_read_b32 v205, a213
v_mfma_f32_16x16x32_bf16 a[232:235], v[232:235], v[68:71], a[232:235]
ds_read_b64_tr_b16 v[228:229], v12 offset:61952
ds_read_b64_tr_b16 v[230:231], v12 offset:64000
v_mfma_f32_16x16x32_bf16 a[232:235], v[236:239], v[184:187], a[232:235]
v_accvgpr_read_b32 v206, a214
v_accvgpr_read_b32 v207, a215
v_mfma_f32_16x16x32_bf16 a[236:239], v[232:235], v[100:103], a[236:239]
v_cvt_pk_bf16_f32 v58, v204, v205
v_cvt_pk_bf16_f32 v59, v206, v207
v_mfma_f32_16x16x32_bf16 a[236:239], v[236:239], v[188:191], a[236:239]
s_waitcnt lgkmcnt(4)
buffer_store_dwordx4 v[56:59], v252, s[20:23], s45 offen offset:2048 sc1
v_mfma_f32_16x16x32_bf16 a[224:227], v[240:243], v[128:131], a[224:227]
ds_read_b64_tr_b16 v[232:233], v250 offset:45568
ds_read_b64_tr_b16 v[234:235], v250 offset:47616
v_mfma_f32_16x16x32_bf16 a[224:227], v[244:247], v[144:147], a[224:227]
v_accvgpr_read_b32 v212, a216
v_accvgpr_read_b32 v213, a217
v_mfma_f32_16x16x32_bf16 a[228:231], v[240:243], v[132:135], a[228:231]
v_accvgpr_read_b32 v214, a218
v_accvgpr_read_b32 v215, a219
v_mfma_f32_16x16x32_bf16 a[228:231], v[244:247], v[148:151], a[228:231]
v_cvt_pk_bf16_f32 v90, v212, v213
v_cvt_pk_bf16_f32 v91, v214, v215
v_mfma_f32_16x16x32_bf16 a[232:235], v[240:243], v[136:139], a[232:235]
ds_read_b64_tr_b16 v[236:237], v250 offset:61952
ds_read_b64_tr_b16 v[238:239], v250 offset:64000
v_mfma_f32_16x16x32_bf16 a[232:235], v[244:247], v[152:155], a[232:235]
buffer_store_dwordx4 v[88:91], v252, s[20:23], s46 offen offset:2048 sc1
v_accvgpr_read_b32 v220, a220
v_mfma_f32_16x16x32_bf16 a[236:239], v[240:243], v[140:143], a[236:239]
v_accvgpr_read_b32 v221, a221
v_accvgpr_read_b32 v222, a222
v_mfma_f32_16x16x32_bf16 a[236:239], v[244:247], v[156:159], a[236:239]
s_waitcnt lgkmcnt(4)
v_accvgpr_read_b32 v223, a223
v_mfma_f32_16x16x32_bf16 a[224:227], v[224:227], v[160:163], a[224:227]
ds_read_b64_tr_b16 v[240:241], v13 offset:12800
ds_read_b64_tr_b16 v[242:243], v13 offset:14848
v_mfma_f32_16x16x32_bf16 a[224:227], v[228:231], v[0:3], a[224:227]
v_cvt_pk_bf16_f32 v122, v220, v221
v_cvt_pk_bf16_f32 v123, v222, v223
v_mfma_f32_16x16x32_bf16 a[228:231], v[224:227], v[164:167], a[228:231]
buffer_store_dwordx4 v[120:123], v252, s[20:23], s47 offen offset:2048 sc1
v_mfma_f32_16x16x32_bf16 a[228:231], v[228:231], v[32:35], a[228:231]
v_mfma_f32_16x16x32_bf16 a[232:235], v[224:227], v[168:171], a[232:235]
ds_read_b64_tr_b16 v[244:245], v13 offset:29184
ds_read_b64_tr_b16 v[246:247], v13 offset:31232
v_mfma_f32_16x16x32_bf16 a[232:235], v[228:231], v[64:67], a[232:235]
v_mfma_f32_16x16x32_bf16 a[236:239], v[224:227], v[172:175], a[236:239]
v_accvgpr_read_b32 v192, a224
v_accvgpr_read_b32 v193, a225
v_mfma_f32_16x16x32_bf16 a[236:239], v[228:231], v[96:99], a[236:239]
s_waitcnt lgkmcnt(4)
v_accvgpr_read_b32 v194, a226
v_mfma_f32_16x16x32_bf16 a[240:243], v[232:235], v[4:7], a[240:243]
ds_read_b64_tr_b16 v[224:225], v13 offset:45568
ds_read_b64_tr_b16 v[226:227], v13 offset:47616
v_mfma_f32_16x16x32_bf16 a[240:243], v[236:239], v[176:179], a[240:243]
v_accvgpr_read_b32 v195, a227
v_cvt_pk_bf16_f32 v28, v192, v193
v_mfma_f32_16x16x32_bf16 a[244:247], v[232:235], v[36:39], a[244:247]
v_cvt_pk_bf16_f32 v29, v194, v195
v_accvgpr_read_b32 v200, a228
v_mfma_f32_16x16x32_bf16 a[244:247], v[236:239], v[180:183], a[244:247]
v_accvgpr_read_b32 v201, a229
v_accvgpr_read_b32 v202, a230
v_mfma_f32_16x16x32_bf16 a[248:251], v[232:235], v[68:71], a[248:251]
ds_read_b64_tr_b16 v[228:229], v13 offset:61952
ds_read_b64_tr_b16 v[230:231], v13 offset:64000
v_mfma_f32_16x16x32_bf16 a[248:251], v[236:239], v[184:187], a[248:251]
v_accvgpr_read_b32 v203, a231
v_cvt_pk_bf16_f32 v60, v200, v201
v_mfma_f32_16x16x32_bf16 a[252:255], v[232:235], v[100:103], a[252:255]
v_cvt_pk_bf16_f32 v61, v202, v203
v_accvgpr_read_b32 v208, a232
v_mfma_f32_16x16x32_bf16 a[252:255], v[236:239], v[188:191], a[252:255]
s_waitcnt lgkmcnt(4)
v_accvgpr_read_b32 v209, a233
v_mfma_f32_16x16x32_bf16 a[240:243], v[240:243], v[128:131], a[240:243]
v_accvgpr_read_b32 v210, a234
v_accvgpr_read_b32 v211, a235
v_mfma_f32_16x16x32_bf16 a[240:243], v[244:247], v[144:147], a[240:243]
v_cvt_pk_bf16_f32 v92, v208, v209
v_cvt_pk_bf16_f32 v93, v210, v211
v_mfma_f32_16x16x32_bf16 a[244:247], v[240:243], v[132:135], a[244:247]
v_accvgpr_read_b32 v216, a236
v_accvgpr_read_b32 v217, a237
v_mfma_f32_16x16x32_bf16 a[244:247], v[244:247], v[148:151], a[244:247]
v_accvgpr_read_b32 v218, a238
v_accvgpr_read_b32 v219, a239
v_mfma_f32_16x16x32_bf16 a[248:251], v[240:243], v[136:139], a[248:251]
v_cvt_pk_bf16_f32 v124, v216, v217
v_cvt_pk_bf16_f32 v125, v218, v219
v_mfma_f32_16x16x32_bf16 a[248:251], v[244:247], v[152:155], a[248:251]
v_mfma_f32_16x16x32_bf16 a[252:255], v[240:243], v[140:143], a[252:255]
v_mfma_f32_16x16x32_bf16 a[252:255], v[244:247], v[156:159], a[252:255]
s_waitcnt lgkmcnt(0)
v_mfma_f32_16x16x32_bf16 a[240:243], v[224:227], v[160:163], a[240:243]
v_mfma_f32_16x16x32_bf16 a[240:243], v[228:231], v[0:3], a[240:243]
v_mfma_f32_16x16x32_bf16 a[244:247], v[224:227], v[164:167], a[244:247]
v_mfma_f32_16x16x32_bf16 a[244:247], v[228:231], v[32:35], a[244:247]
v_mfma_f32_16x16x32_bf16 a[248:251], v[224:227], v[168:171], a[248:251]
v_mfma_f32_16x16x32_bf16 a[248:251], v[228:231], v[64:67], a[248:251]
v_mfma_f32_16x16x32_bf16 a[252:255], v[224:227], v[172:175], a[252:255]
s_nop 2
v_accvgpr_read_b32 v196, a240
v_accvgpr_read_b32 v197, a241
v_accvgpr_read_b32 v198, a242
v_accvgpr_read_b32 v199, a243
v_mfma_f32_16x16x32_bf16 a[252:255], v[228:231], v[96:99], a[252:255]
v_cvt_pk_bf16_f32 v30, v196, v197
v_cvt_pk_bf16_f32 v31, v198, v199
buffer_store_dwordx4 v[28:31], v252, s[20:23], s44 offen offset:3072 sc1
v_accvgpr_read_b32 v204, a244
v_accvgpr_read_b32 v205, a245
v_accvgpr_read_b32 v206, a246
v_accvgpr_read_b32 v207, a247
v_cvt_pk_bf16_f32 v62, v204, v205
v_cvt_pk_bf16_f32 v63, v206, v207
buffer_store_dwordx4 v[60:63], v252, s[20:23], s45 offen offset:3072 sc1
v_accvgpr_read_b32 v212, a248
v_accvgpr_read_b32 v213, a249
v_accvgpr_read_b32 v214, a250
v_accvgpr_read_b32 v215, a251
v_cvt_pk_bf16_f32 v94, v212, v213
v_cvt_pk_bf16_f32 v95, v214, v215
buffer_store_dwordx4 v[92:95], v252, s[20:23], s46 offen offset:3072 sc1
v_accvgpr_read_b32 v220, a252
v_accvgpr_read_b32 v221, a253
v_accvgpr_read_b32 v222, a254
v_accvgpr_read_b32 v223, a255
v_cvt_pk_bf16_f32 v126, v220, v221
v_cvt_pk_bf16_f32 v127, v222, v223
buffer_store_dwordx4 v[124:127], v252, s[20:23], s47 offen offset:3072 sc1
s_waitcnt vmcnt(15)
v_readfirstlane_b32 s99, v254
s_branch L2_chk
L2_tail_1_7:
s_waitcnt lgkmcnt(4)
v_mfma_f32_16x16x32_bf16 a[0:3], v[224:227], v[160:163], a[0:3]
ds_read_b128 v[240:243], v248 offset:2048
v_mfma_f32_16x16x32_bf16 a[0:3], v[228:231], v[176:179], a[0:3]
s_lshl_b32 s36, s34, 13
v_mfma_f32_16x16x32_bf16 a[4:7], v[224:227], v[164:167], a[4:7]
s_add_u32 s56, s4, 0x1000000
s_addc_u32 s57, s5, 0
v_mfma_f32_16x16x32_bf16 a[4:7], v[228:231], v[180:183], a[4:7]
s_add_u32 s36, s36, 0x20000
s_mov_b32 s58, 0x6c02000
v_mfma_f32_16x16x32_bf16 a[8:11], v[224:227], v[168:171], a[8:11]
ds_read_b128 v[244:247], v248 offset:2560
s_mov_b32 s59, 0x00020000
v_mfma_f32_16x16x32_bf16 a[8:11], v[228:231], v[184:187], a[8:11]
v_add_u32 v255, s36, v252
s_lshr_b32 s35, s2, 1
v_mfma_f32_16x16x32_bf16 a[12:15], v[224:227], v[172:175], a[12:15]
s_and_b32 s35, s35, 28
s_add_u32 s35, s35, s34
v_mfma_f32_16x16x32_bf16 a[12:15], v[228:231], v[188:191], a[12:15]
s_waitcnt lgkmcnt(2)
s_lshl_b32 s35, s35, 13
v_mfma_f32_16x16x32_bf16 a[16:19], v[232:235], v[160:163], a[16:19]
ds_read_b128 v[224:227], v248 offset:6144
v_lshlrev_b32 v253, 3, v252
v_mfma_f32_16x16x32_bf16 a[16:19], v[236:239], v[176:179], a[16:19]
buffer_load_dword v253, v253, s[56:59], s35 offen
ds_write_b128 v255, v[160:163] offset:0
v_mfma_f32_16x16x32_bf16 a[20:23], v[232:235], v[164:167], a[20:23]
v_exp_f32 v192, v192
v_mfma_f32_16x16x32_bf16 a[20:23], v[236:239], v[180:183], a[20:23]
v_exp_f32 v193, v193
v_mfma_f32_16x16x32_bf16 a[24:27], v[232:235], v[168:171], a[24:27]
ds_read_b128 v[228:231], v248 offset:6656
v_cvt_pk_bf16_f32 v128, v192, v193
v_mfma_f32_16x16x32_bf16 a[24:27], v[236:239], v[184:187], a[24:27]
v_exp_f32 v194, v194
v_mfma_f32_16x16x32_bf16 a[28:31], v[232:235], v[172:175], a[28:31]
v_exp_f32 v195, v195
v_mfma_f32_16x16x32_bf16 a[28:31], v[236:239], v[188:191], a[28:31]
s_waitcnt lgkmcnt(3)
v_cvt_pk_bf16_f32 v129, v194, v195
v_mfma_f32_16x16x32_bf16 v[208:211], v[240:243], v[0:3], 0
ds_read_b128 v[232:235], v248 offset:10240
ds_write_b128 v255, v[164:167] offset:1024
v_mfma_f32_16x16x32_bf16 v[208:211], v[244:247], v[4:7], v[208:211]
v_exp_f32 v196, v196
v_mfma_f32_16x16x32_bf16 v[212:215], v[240:243], v[32:35], 0
v_exp_f32 v197, v197
v_mfma_f32_16x16x32_bf16 v[212:215], v[244:247], v[36:39], v[212:215]
v_exp_f32 v198, v198
v_mfma_f32_16x16x32_bf16 v[216:219], v[240:243], v[64:67], 0
ds_read_b128 v[236:239], v248 offset:10752
v_cvt_pk_bf16_f32 v132, v196, v197
v_mfma_f32_16x16x32_bf16 v[216:219], v[244:247], v[68:71], v[216:219]
v_exp_f32 v199, v199
v_mfma_f32_16x16x32_bf16 v[220:223], v[240:243], v[96:99], 0
v_exp_f32 v200, v200
v_mfma_f32_16x16x32_bf16 v[220:223], v[244:247], v[100:103], v[220:223]
s_waitcnt lgkmcnt(3)
v_cvt_pk_bf16_f32 v133, v198, v199
v_mfma_f32_16x16x32_bf16 v[208:211], v[224:227], v[8:11], v[208:211]
ds_read_b128 v[240:243], v248 offset:14336
ds_write_b128 v255, v[168:171] offset:2048
v_mfma_f32_16x16x32_bf16 v[208:211], v[228:231], v[12:15], v[208:211]
v_exp_f32 v201, v201
v_mfma_f32_16x16x32_bf16 v[212:215], v[224:227], v[40:43], v[212:215]
v_exp_f32 v202, v202
v_mfma_f32_16x16x32_bf16 v[212:215], v[228:231], v[44:47], v[212:215]
v_exp_f32 v203, v203
v_mfma_f32_16x16x32_bf16 v[216:219], v[224:227], v[72:75], v[216:219]
ds_read_b128 v[244:247], v248 offset:14848
v_cvt_pk_bf16_f32 v136, v200, v201
v_mfma_f32_16x16x32_bf16 v[216:219], v[228:231], v[76:79], v[216:219]
v_cvt_pk_bf16_f32 v137, v202, v203
ds_write_b128 v255, v[172:175] offset:3072
v_mfma_f32_16x16x32_bf16 v[220:223], v[224:227], v[104:107], v[220:223]
v_exp_f32 v204, v204
v_mfma_f32_16x16x32_bf16 v[220:223], v[228:231], v[108:111], v[220:223]
s_waitcnt lgkmcnt(4)
s_waitcnt vmcnt(1)
s_barrier
v_mfma_f32_16x16x32_bf16 v[208:211], v[232:235], v[16:19], v[208:211]
ds_read_b128 v[224:227], v248 offset:16384
s_add_u32 m0, s30, 0xc000
v_mfma_f32_16x16x32_bf16 v[208:211], v[236:239], v[20:23], v[208:211]
s_and_b32 s100, s30, 0x10000
buffer_load_dwordx4 v251, s[12:15], s28 offen offset:0 lds
v_mfma_f32_16x16x32_bf16 v[212:215], v[232:235], v[48:51], v[212:215]
s_xor_b32 s100, s100, 0x10000
ds_write_b128 v255, v[176:179] offset:4096
v_mfma_f32_16x16x32_bf16 v[212:215], v[236:239], v[52:55], v[212:215]
s_mov_b32 s99, 0
buffer_load_dwordx4 v251, s[12:15], s28 offen offset:1024 lds
v_mfma_f32_16x16x32_bf16 v[216:219], v[232:235], v[80:83], v[216:219]
ds_read_b128 v[228:231], v248 offset:16896
ds_write_b128 v255, v[180:183] offset:5120
v_mfma_f32_16x16x32_bf16 v[216:219], v[236:239], v[84:87], v[216:219]
v_exp_f32 v205, v205
v_mfma_f32_16x16x32_bf16 v[220:223], v[232:235], v[112:115], v[220:223]
v_exp_f32 v206, v206
v_mfma_f32_16x16x32_bf16 v[220:223], v[236:239], v[116:119], v[220:223]
s_waitcnt lgkmcnt(5)
v_cvt_pk_bf16_f32 v140, v204, v205
v_mfma_f32_16x16x32_bf16 v[208:211], v[240:243], v[24:27], v[208:211]
ds_read_b128 v[232:235], v248 offset:20480
buffer_load_dwordx4 v251, s[12:15], s28 offen offset:2048 lds
v_mfma_f32_16x16x32_bf16 v[208:211], v[244:247], v[28:31], v[208:211]
v_exp_f32 v207, v207
v_mfma_f32_16x16x32_bf16 v[212:215], v[240:243], v[56:59], v[212:215]
buffer_load_dwordx4 v251, s[12:15], s28 offen offset:3072 lds
ds_write_b128 v255, v[184:187] offset:6144
v_mfma_f32_16x16x32_bf16 v[212:215], v[244:247], v[60:63], v[212:215]
ds_write_b128 v255, v[188:191] offset:7168
v_mfma_f32_16x16x32_bf16 v[216:219], v[240:243], v[88:91], v[216:219]
ds_read_b128 v[236:239], v248 offset:20992
v_cvt_pk_bf16_f32 v141, v206, v207
v_mfma_f32_16x16x32_bf16 v[216:219], v[244:247], v[92:95], v[216:219]
s_add_u32 s28, s28, 0x4000
s_xor_b32 s30, s30, 0x10000
v_mfma_f32_16x16x32_bf16 v[220:223], v[240:243], v[120:123], v[220:223]
s_add_u32 m0, s30, 0x0
v_mfma_f32_16x16x32_bf16 v[220:223], v[244:247], v[124:127], v[220:223]
s_waitcnt lgkmcnt(5)
v_lshrrev_b32 v254, 1, v251
v_mfma_f32_16x16x32_bf16 v[192:195], v[224:227], v[0:3], 0
ds_read_b128 v[240:243], v248 offset:24576
v_and_b32 v254, 0x1800, v254
v_mfma_f32_16x16x32_bf16 v[192:195], v[228:231], v[4:7], v[192:195]
v_exp_f32 v208, v208
v_mfma_f32_16x16x32_bf16 v[196:199], v[224:227], v[32:35], 0
v_exp_f32 v209, v209
v_mfma_f32_16x16x32_bf16 v[196:199], v[228:231], v[36:39], v[196:199]
v_exp_f32 v210, v210
v_mfma_f32_16x16x32_bf16 v[200:203], v[224:227], v[64:67], 0
ds_read_b128 v[244:247], v248 offset:25088
v_cvt_pk_bf16_f32 v130, v208, v209
v_mfma_f32_16x16x32_bf16 v[200:203], v[228:231], v[68:71], v[200:203]
v_exp_f32 v211, v211
v_mfma_f32_16x16x32_bf16 v[204:207], v[224:227], v[96:99], 0
v_exp_f32 v212, v212
v_mfma_f32_16x16x32_bf16 v[204:207], v[228:231], v[100:103], v[204:207]
s_waitcnt lgkmcnt(2)
v_cvt_pk_bf16_f32 v131, v210, v211
v_mfma_f32_16x16x32_bf16 v[192:195], v[232:235], v[8:11], v[192:195]
ds_read_b128 v[224:227], v248 offset:28672
s_movk_i32 s35, 0x3ff
v_mfma_f32_16x16x32_bf16 v[192:195], v[236:239], v[12:15], v[192:195]
v_exp_f32 v213, v213
v_mfma_f32_16x16x32_bf16 v[196:199], v[232:235], v[40:43], v[196:199]
v_exp_f32 v214, v214
v_mfma_f32_16x16x32_bf16 v[196:199], v[236:239], v[44:47], v[196:199]
v_exp_f32 v215, v215
v_mfma_f32_16x16x32_bf16 v[200:203], v[232:235], v[72:75], v[200:203]
ds_read_b128 v[228:231], v248 offset:29184
v_cvt_pk_bf16_f32 v134, v212, v213
v_mfma_f32_16x16x32_bf16 v[200:203], v[236:239], v[76:79], v[200:203]
v_cvt_pk_bf16_f32 v135, v214, v215
v_and_or_b32 v254, v251, s35, v254
v_mfma_f32_16x16x32_bf16 v[204:207], v[232:235], v[104:107], v[204:207]
v_exp_f32 v216, v216
v_mfma_f32_16x16x32_bf16 v[204:207], v[236:239], v[108:111], v[204:207]
s_waitcnt lgkmcnt(2)
s_add_u32 s35, s28, 6144
v_mfma_f32_16x16x32_bf16 v[192:195], v[240:243], v[16:19], v[192:195]
ds_read_b128 v[232:235], v248 offset:18432
buffer_load_dwordx4 v254, s[12:15], s28 offen offset:0 lds
v_mfma_f32_16x16x32_bf16 v[192:195], v[244:247], v[20:23], v[192:195]
v_exp_f32 v217, v217
v_mfma_f32_16x16x32_bf16 v[196:199], v[240:243], v[48:51], v[196:199]
v_exp_f32 v218, v218
v_mfma_f32_16x16x32_bf16 v[196:199], v[244:247], v[52:55], v[196:199]
v_exp_f32 v219, v219
v_mfma_f32_16x16x32_bf16 v[200:203], v[240:243], v[80:83], v[200:203]
ds_read_b128 v[236:239], v248 offset:18944
v_cvt_pk_bf16_f32 v138, v216, v217
v_mfma_f32_16x16x32_bf16 v[200:203], v[244:247], v[84:87], v[200:203]
v_cvt_pk_bf16_f32 v139, v218, v219
buffer_load_dwordx4 v254, s[12:15], s28 offen offset:1024 lds
v_mfma_f32_16x16x32_bf16 v[204:207], v[240:243], v[112:115], v[204:207]
v_exp_f32 v220, v220
v_mfma_f32_16x16x32_bf16 v[204:207], v[244:247], v[116:119], v[204:207]
s_waitcnt lgkmcnt(2)
buffer_load_dwordx4 v254, s[12:15], s35 offen offset:2048 lds
v_mfma_f32_16x16x32_bf16 v[192:195], v[224:227], v[24:27], v[192:195]
ds_read_b128 v[240:243], v248 offset:22528
v_mfma_f32_16x16x32_bf16 v[192:195], v[228:231], v[28:31], v[192:195]
v_exp_f32 v221, v221
v_mfma_f32_16x16x32_bf16 v[196:199], v[224:227], v[56:59], v[196:199]
v_exp_f32 v222, v222
v_mfma_f32_16x16x32_bf16 v[196:199], v[228:231], v[60:63], v[196:199]
v_exp_f32 v223, v223
v_mfma_f32_16x16x32_bf16 v[200:203], v[224:227], v[88:91], v[200:203]
ds_read_b128 v[244:247], v248 offset:23040
v_cvt_pk_bf16_f32 v142, v220, v221
v_mfma_f32_16x16x32_bf16 v[200:203], v[228:231], v[92:95], v[200:203]
v_cvt_pk_bf16_f32 v143, v222, v223
buffer_load_dwordx4 v254, s[12:15], s35 offen offset:3072 lds
v_mfma_f32_16x16x32_bf16 v[204:207], v[224:227], v[120:123], v[204:207]
v_mfma_f32_16x16x32_bf16 v[204:207], v[228:231], v[124:127], v[204:207]
s_waitcnt lgkmcnt(2)
v_mfma_f32_16x16x32_bf16 v[208:211], v[232:235], v[0:3], 0
ds_read_b128 v[224:227], v248 offset:26624
v_mfma_f32_16x16x32_bf16 v[208:211], v[236:239], v[4:7], v[208:211]
v_exp_f32 v192, v192
v_mfma_f32_16x16x32_bf16 v[212:215], v[232:235], v[32:35], 0
v_exp_f32 v193, v193
v_mfma_f32_16x16x32_bf16 v[212:215], v[236:239], v[36:39], v[212:215]
v_exp_f32 v194, v194
v_mfma_f32_16x16x32_bf16 v[216:219], v[232:235], v[64:67], 0
ds_read_b128 v[228:231], v248 offset:27136
v_cvt_pk_bf16_f32 v144, v192, v193
v_mfma_f32_16x16x32_bf16 v[216:219], v[236:239], v[68:71], v[216:219]
v_exp_f32 v195, v195
v_mfma_f32_16x16x32_bf16 v[220:223], v[232:235], v[96:99], 0
v_exp_f32 v196, v196
v_mfma_f32_16x16x32_bf16 v[220:223], v[236:239], v[100:103], v[220:223]
s_waitcnt lgkmcnt(2)
v_cvt_pk_bf16_f32 v145, v194, v195
v_mfma_f32_16x16x32_bf16 v[208:211], v[240:243], v[8:11], v[208:211]
ds_read_b128 v[232:235], v248 offset:30720
v_mfma_f32_16x16x32_bf16 v[208:211], v[244:247], v[12:15], v[208:211]
v_exp_f32 v197, v197
v_mfma_f32_16x16x32_bf16 v[212:215], v[240:243], v[40:43], v[212:215]
v_exp_f32 v198, v198
v_mfma_f32_16x16x32_bf16 v[212:215], v[244:247], v[44:47], v[212:215]
v_exp_f32 v199, v199
v_mfma_f32_16x16x32_bf16 v[216:219], v[240:243], v[72:75], v[216:219]
ds_read_b128 v[236:239], v248 offset:31232
v_cvt_pk_bf16_f32 v148, v196, v197
v_mfma_f32_16x16x32_bf16 v[216:219], v[244:247], v[76:79], v[216:219]
v_cvt_pk_bf16_f32 v149, v198, v199
v_mfma_f32_16x16x32_bf16 v[220:223], v[240:243], v[104:107], v[220:223]
v_exp_f32 v200, v200
v_mfma_f32_16x16x32_bf16 v[220:223], v[244:247], v[108:111], v[220:223]
s_waitcnt lgkmcnt(2)
v_mfma_f32_16x16x32_bf16 v[208:211], v[224:227], v[16:19], v[208:211]
ds_read_b128 v[240:243], v248 offset:32768
v_mfma_f32_16x16x32_bf16 v[208:211], v[228:231], v[20:23], v[208:211]
v_exp_f32 v201, v201
v_mfma_f32_16x16x32_bf16 v[212:215], v[224:227], v[48:51], v[212:215]
v_exp_f32 v202, v202
v_mfma_f32_16x16x32_bf16 v[212:215], v[228:231], v[52:55], v[212:215]
v_exp_f32 v203, v203
v_mfma_f32_16x16x32_bf16 v[216:219], v[224:227], v[80:83], v[216:219]
ds_read_b128 v[244:247], v248 offset:33280
v_cvt_pk_bf16_f32 v152, v200, v201
v_mfma_f32_16x16x32_bf16 v[216:219], v[228:231], v[84:87], v[216:219]
v_cvt_pk_bf16_f32 v153, v202, v203
v_mfma_f32_16x16x32_bf16 v[220:223], v[224:227], v[112:115], v[220:223]
v_exp_f32 v204, v204
v_mfma_f32_16x16x32_bf16 v[220:223], v[228:231], v[116:119], v[220:223]
s_waitcnt lgkmcnt(2)
v_mfma_f32_16x16x32_bf16 v[208:211], v[232:235], v[24:27], v[208:211]
ds_read_b128 v[224:227], v248 offset:36864
v_mfma_f32_16x16x32_bf16 v[208:211], v[236:239], v[28:31], v[208:211]
v_exp_f32 v205, v205
v_mfma_f32_16x16x32_bf16 v[212:215], v[232:235], v[56:59], v[212:215]
v_exp_f32 v206, v206
v_mfma_f32_16x16x32_bf16 v[212:215], v[236:239], v[60:63], v[212:215]
v_exp_f32 v207, v207
v_mfma_f32_16x16x32_bf16 v[216:219], v[232:235], v[88:91], v[216:219]
ds_read_b128 v[228:231], v248 offset:37376
v_cvt_pk_bf16_f32 v156, v204, v205
v_mfma_f32_16x16x32_bf16 v[216:219], v[236:239], v[92:95], v[216:219]
v_cvt_pk_bf16_f32 v157, v206, v207
v_mfma_f32_16x16x32_bf16 v[220:223], v[232:235], v[120:123], v[220:223]
v_mfma_f32_16x16x32_bf16 v[220:223], v[236:239], v[124:127], v[220:223]
s_waitcnt lgkmcnt(2)
v_mfma_f32_16x16x32_bf16 v[192:195], v[240:243], v[0:3], 0
ds_read_b128 v[232:235], v248 offset:40960
v_mfma_f32_16x16x32_bf16 v[192:195], v[244:247], v[4:7], v[192:195]
v_exp_f32 v208, v208
v_mfma_f32_16x16x32_bf16 v[196:199], v[240:243], v[32:35], 0
v_exp_f32 v209, v209
v_mfma_f32_16x16x32_bf16 v[196:199], v[244:247], v[36:39], v[196:199]
v_exp_f32 v210, v210
v_mfma_f32_16x16x32_bf16 v[200:203], v[240:243], v[64:67], 0
ds_read_b128 v[236:239], v248 offset:41472
v_cvt_pk_bf16_f32 v146, v208, v209
v_mfma_f32_16x16x32_bf16 v[200:203], v[244:247], v[68:71], v[200:203]
v_exp_f32 v211, v211
v_mfma_f32_16x16x32_bf16 v[204:207], v[240:243], v[96:99], 0
v_exp_f32 v212, v212
v_mfma_f32_16x16x32_bf16 v[204:207], v[244:247], v[100:103], v[204:207]
s_waitcnt lgkmcnt(2)
v_cvt_pk_bf16_f32 v147, v210, v211
v_mfma_f32_16x16x32_bf16 v[192:195], v[224:227], v[8:11], v[192:195]
ds_read_b128 v[240:243], v248 offset:45056
v_mfma_f32_16x16x32_bf16 v[192:195], v[228:231], v[12:15], v[192:195]
v_exp_f32 v213, v213
v_mfma_f32_16x16x32_bf16 v[196:199], v[224:227], v[40:43], v[196:199]
v_exp_f32 v214, v214
v_mfma_f32_16x16x32_bf16 v[196:199], v[228:231], v[44:47], v[196:199]
v_exp_f32 v215, v215
v_mfma_f32_16x16x32_bf16 v[200:203], v[224:227], v[72:75], v[200:203]
ds_read_b128 v[244:247], v248 offset:45568
v_cvt_pk_bf16_f32 v150, v212, v213
v_mfma_f32_16x16x32_bf16 v[200:203], v[228:231], v[76:79], v[200:203]
v_cvt_pk_bf16_f32 v151, v214, v215
v_mfma_f32_16x16x32_bf16 v[204:207], v[224:227], v[104:107], v[204:207]
v_exp_f32 v216, v216
v_mfma_f32_16x16x32_bf16 v[204:207], v[228:231], v[108:111], v[204:207]
s_waitcnt lgkmcnt(2)
v_mfma_f32_16x16x32_bf16 v[192:195], v[232:235], v[16:19], v[192:195]
ds_read_b128 v[224:227], v248 offset:34816
v_mfma_f32_16x16x32_bf16 v[192:195], v[236:239], v[20:23], v[192:195]
v_exp_f32 v217, v217
v_mfma_f32_16x16x32_bf16 v[196:199], v[232:235], v[48:51], v[196:199]
v_exp_f32 v218, v218
v_mfma_f32_16x16x32_bf16 v[196:199], v[236:239], v[52:55], v[196:199]
v_exp_f32 v219, v219
v_mfma_f32_16x16x32_bf16 v[200:203], v[232:235], v[80:83], v[200:203]
ds_read_b128 v[228:231], v248 offset:35328
v_cvt_pk_bf16_f32 v154, v216, v217
v_mfma_f32_16x16x32_bf16 v[200:203], v[236:239], v[84:87], v[200:203]
v_cvt_pk_bf16_f32 v155, v218, v219
v_mfma_f32_16x16x32_bf16 v[204:207], v[232:235], v[112:115], v[204:207]
v_exp_f32 v220, v220
v_mfma_f32_16x16x32_bf16 v[204:207], v[236:239], v[116:119], v[204:207]
s_waitcnt lgkmcnt(2)
v_mfma_f32_16x16x32_bf16 v[192:195], v[240:243], v[24:27], v[192:195]
ds_read_b128 v[232:235], v248 offset:38912
v_mfma_f32_16x16x32_bf16 v[192:195], v[244:247], v[28:31], v[192:195]
v_exp_f32 v221, v221
v_mfma_f32_16x16x32_bf16 v[196:199], v[240:243], v[56:59], v[196:199]
v_exp_f32 v222, v222
v_mfma_f32_16x16x32_bf16 v[196:199], v[244:247], v[60:63], v[196:199]
v_exp_f32 v223, v223
v_mfma_f32_16x16x32_bf16 v[200:203], v[240:243], v[88:91], v[200:203]
ds_read_b128 v[236:239], v248 offset:39424
v_cvt_pk_bf16_f32 v158, v220, v221
v_mfma_f32_16x16x32_bf16 v[200:203], v[244:247], v[92:95], v[200:203]
v_cvt_pk_bf16_f32 v159, v222, v223
v_mfma_f32_16x16x32_bf16 v[204:207], v[240:243], v[120:123], v[204:207]
v_mfma_f32_16x16x32_bf16 v[204:207], v[244:247], v[124:127], v[204:207]
s_waitcnt lgkmcnt(2)
v_mfma_f32_16x16x32_bf16 v[208:211], v[224:227], v[0:3], 0
ds_read_b128 v[240:243], v248 offset:43008
v_mfma_f32_16x16x32_bf16 v[208:211], v[228:231], v[4:7], v[208:211]
v_exp_f32 v192, v192
v_mfma_f32_16x16x32_bf16 v[212:215], v[224:227], v[32:35], 0
v_exp_f32 v193, v193
v_mfma_f32_16x16x32_bf16 v[212:215], v[228:231], v[36:39], v[212:215]
v_exp_f32 v194, v194
v_mfma_f32_16x16x32_bf16 v[216:219], v[224:227], v[64:67], 0
ds_read_b128 v[244:247], v248 offset:43520
v_cvt_pk_bf16_f32 v160, v192, v193
v_mfma_f32_16x16x32_bf16 v[216:219], v[228:231], v[68:71], v[216:219]
v_exp_f32 v195, v195
v_mfma_f32_16x16x32_bf16 v[220:223], v[224:227], v[96:99], 0
v_exp_f32 v196, v196
v_mfma_f32_16x16x32_bf16 v[220:223], v[228:231], v[100:103], v[220:223]
s_waitcnt lgkmcnt(2)
v_cvt_pk_bf16_f32 v161, v194, v195
v_mfma_f32_16x16x32_bf16 v[208:211], v[232:235], v[8:11], v[208:211]
ds_read_b128 v[224:227], v248 offset:47104
v_mfma_f32_16x16x32_bf16 v[208:211], v[236:239], v[12:15], v[208:211]
v_exp_f32 v197, v197
v_mfma_f32_16x16x32_bf16 v[212:215], v[232:235], v[40:43], v[212:215]
v_exp_f32 v198, v198
v_mfma_f32_16x16x32_bf16 v[212:215], v[236:239], v[44:47], v[212:215]
v_exp_f32 v199, v199
v_mfma_f32_16x16x32_bf16 v[216:219], v[232:235], v[72:75], v[216:219]
ds_read_b128 v[228:231], v248 offset:47616
v_cvt_pk_bf16_f32 v164, v196, v197
v_mfma_f32_16x16x32_bf16 v[216:219], v[236:239], v[76:79], v[216:219]
v_cvt_pk_bf16_f32 v165, v198, v199
v_mfma_f32_16x16x32_bf16 v[220:223], v[232:235], v[104:107], v[220:223]
v_exp_f32 v200, v200
v_mfma_f32_16x16x32_bf16 v[220:223], v[236:239], v[108:111], v[220:223]
s_waitcnt lgkmcnt(2)
s_waitcnt vmcnt(0)
s_barrier
v_mfma_f32_16x16x32_bf16 v[208:211], v[240:243], v[16:19], v[208:211]
ds_read_b128 v[232:235], v248 offset:49152
v_mfma_f32_16x16x32_bf16 v[208:211], v[244:247], v[20:23], v[208:211]
v_exp_f32 v201, v201
v_mfma_f32_16x16x32_bf16 v[212:215], v[240:243], v[48:51], v[212:215]
v_exp_f32 v202, v202
v_mfma_f32_16x16x32_bf16 v[212:215], v[244:247], v[52:55], v[212:215]
v_exp_f32 v203, v203
v_mfma_f32_16x16x32_bf16 v[216:219], v[240:243], v[80:83], v[216:219]
ds_read_b128 v[236:239], v248 offset:49664
v_cvt_pk_bf16_f32 v168, v200, v201
v_mfma_f32_16x16x32_bf16 v[216:219], v[244:247], v[84:87], v[216:219]
v_cvt_pk_bf16_f32 v169, v202, v203
v_mfma_f32_16x16x32_bf16 v[220:223], v[240:243], v[112:115], v[220:223]
v_exp_f32 v204, v204
v_mfma_f32_16x16x32_bf16 v[220:223], v[244:247], v[116:119], v[220:223]
s_waitcnt lgkmcnt(2)
v_mfma_f32_16x16x32_bf16 v[208:211], v[224:227], v[24:27], v[208:211]
ds_read_b128 v[240:243], v248 offset:53248
v_mfma_f32_16x16x32_bf16 v[208:211], v[228:231], v[28:31], v[208:211]
v_exp_f32 v205, v205
v_mfma_f32_16x16x32_bf16 v[212:215], v[224:227], v[56:59], v[212:215]
v_exp_f32 v206, v206
v_mfma_f32_16x16x32_bf16 v[212:215], v[228:231], v[60:63], v[212:215]
v_exp_f32 v207, v207
v_mfma_f32_16x16x32_bf16 v[216:219], v[224:227], v[88:91], v[216:219]
ds_read_b128 v[244:247], v248 offset:53760
v_cvt_pk_bf16_f32 v172, v204, v205
v_mfma_f32_16x16x32_bf16 v[216:219], v[228:231], v[92:95], v[216:219]
v_cvt_pk_bf16_f32 v173, v206, v207
v_mfma_f32_16x16x32_bf16 v[220:223], v[224:227], v[120:123], v[220:223]
v_mfma_f32_16x16x32_bf16 v[220:223], v[228:231], v[124:127], v[220:223]
s_waitcnt lgkmcnt(2)
v_mfma_f32_16x16x32_bf16 v[192:195], v[232:235], v[0:3], 0
ds_read_b128 v[224:227], v248 offset:57344
v_mfma_f32_16x16x32_bf16 v[192:195], v[236:239], v[4:7], v[192:195]
v_exp_f32 v208, v208
v_mfma_f32_16x16x32_bf16 v[196:199], v[232:235], v[32:35], 0
v_exp_f32 v209, v209
v_mfma_f32_16x16x32_bf16 v[196:199], v[236:239], v[36:39], v[196:199]
v_exp_f32 v210, v210
v_mfma_f32_16x16x32_bf16 v[200:203], v[232:235], v[64:67], 0
ds_read_b128 v[228:231], v248 offset:57856
v_cvt_pk_bf16_f32 v162, v208, v209
v_mfma_f32_16x16x32_bf16 v[200:203], v[236:239], v[68:71], v[200:203]
v_exp_f32 v211, v211
v_mfma_f32_16x16x32_bf16 v[204:207], v[232:235], v[96:99], 0
v_exp_f32 v212, v212
v_mfma_f32_16x16x32_bf16 v[204:207], v[236:239], v[100:103], v[204:207]
s_waitcnt lgkmcnt(2)
v_cvt_pk_bf16_f32 v163, v210, v211
v_mfma_f32_16x16x32_bf16 v[192:195], v[240:243], v[8:11], v[192:195]
ds_read_b128 v[232:235], v248 offset:61440
v_mfma_f32_16x16x32_bf16 v[192:195], v[244:247], v[12:15], v[192:195]
v_exp_f32 v213, v213
v_mfma_f32_16x16x32_bf16 v[196:199], v[240:243], v[40:43], v[196:199]
v_exp_f32 v214, v214
v_mfma_f32_16x16x32_bf16 v[196:199], v[244:247], v[44:47], v[196:199]
v_exp_f32 v215, v215
v_mfma_f32_16x16x32_bf16 v[200:203], v[240:243], v[72:75], v[200:203]
ds_read_b128 v[236:239], v248 offset:61952
v_cvt_pk_bf16_f32 v166, v212, v213
v_mfma_f32_16x16x32_bf16 v[200:203], v[244:247], v[76:79], v[200:203]
v_cvt_pk_bf16_f32 v167, v214, v215
v_mfma_f32_16x16x32_bf16 v[204:207], v[240:243], v[104:107], v[204:207]
v_exp_f32 v216, v216
v_mfma_f32_16x16x32_bf16 v[204:207], v[244:247], v[108:111], v[204:207]
s_waitcnt lgkmcnt(2)
v_mfma_f32_16x16x32_bf16 v[192:195], v[224:227], v[16:19], v[192:195]
ds_read_b128 v[240:243], v248 offset:51200
v_mfma_f32_16x16x32_bf16 v[192:195], v[228:231], v[20:23], v[192:195]
v_exp_f32 v217, v217
v_mfma_f32_16x16x32_bf16 v[196:199], v[224:227], v[48:51], v[196:199]
v_exp_f32 v218, v218
v_mfma_f32_16x16x32_bf16 v[196:199], v[228:231], v[52:55], v[196:199]
v_exp_f32 v219, v219
v_mfma_f32_16x16x32_bf16 v[200:203], v[224:227], v[80:83], v[200:203]
ds_read_b128 v[244:247], v248 offset:51712
v_cvt_pk_bf16_f32 v170, v216, v217
v_mfma_f32_16x16x32_bf16 v[200:203], v[228:231], v[84:87], v[200:203]
v_cvt_pk_bf16_f32 v171, v218, v219
v_mfma_f32_16x16x32_bf16 v[204:207], v[224:227], v[112:115], v[204:207]
v_exp_f32 v220, v220
v_mfma_f32_16x16x32_bf16 v[204:207], v[228:231], v[116:119], v[204:207]
s_waitcnt lgkmcnt(2)
v_mfma_f32_16x16x32_bf16 v[192:195], v[232:235], v[24:27], v[192:195]
ds_read_b128 v[224:227], v248 offset:55296
v_mfma_f32_16x16x32_bf16 v[192:195], v[236:239], v[28:31], v[192:195]
v_exp_f32 v221, v221
v_mfma_f32_16x16x32_bf16 v[196:199], v[232:235], v[56:59], v[196:199]
v_exp_f32 v222, v222
v_mfma_f32_16x16x32_bf16 v[196:199], v[236:239], v[60:63], v[196:199]
v_exp_f32 v223, v223
v_mfma_f32_16x16x32_bf16 v[200:203], v[232:235], v[88:91], v[200:203]
ds_read_b128 v[228:231], v248 offset:55808
v_cvt_pk_bf16_f32 v174, v220, v221
v_mfma_f32_16x16x32_bf16 v[200:203], v[236:239], v[92:95], v[200:203]
v_cvt_pk_bf16_f32 v175, v222, v223
v_mfma_f32_16x16x32_bf16 v[204:207], v[232:235], v[120:123], v[204:207]
v_mfma_f32_16x16x32_bf16 v[204:207], v[236:239], v[124:127], v[204:207]
s_waitcnt lgkmcnt(2)
v_mfma_f32_16x16x32_bf16 v[208:211], v[240:243], v[0:3], 0
ds_read_b128 v[232:235], v248 offset:59392
v_mfma_f32_16x16x32_bf16 v[208:211], v[244:247], v[4:7], v[208:211]
v_exp_f32 v192, v192
v_mfma_f32_16x16x32_bf16 v[212:215], v[240:243], v[32:35], 0
v_exp_f32 v193, v193
v_mfma_f32_16x16x32_bf16 v[212:215], v[244:247], v[36:39], v[212:215]
v_exp_f32 v194, v194
v_mfma_f32_16x16x32_bf16 v[216:219], v[240:243], v[64:67], 0
ds_read_b128 v[236:239], v248 offset:59904
v_cvt_pk_bf16_f32 v176, v192, v193
v_mfma_f32_16x16x32_bf16 v[216:219], v[244:247], v[68:71], v[216:219]
v_exp_f32 v195, v195
v_mfma_f32_16x16x32_bf16 v[220:223], v[240:243], v[96:99], 0
v_exp_f32 v196, v196
v_mfma_f32_16x16x32_bf16 v[220:223], v[244:247], v[100:103], v[220:223]
s_waitcnt lgkmcnt(2)
v_cvt_pk_bf16_f32 v177, v194, v195
v_mfma_f32_16x16x32_bf16 v[208:211], v[224:227], v[8:11], v[208:211]
ds_read_b128 v[240:243], v248 offset:63488
v_mfma_f32_16x16x32_bf16 v[208:211], v[228:231], v[12:15], v[208:211]
v_exp_f32 v197, v197
v_mfma_f32_16x16x32_bf16 v[212:215], v[224:227], v[40:43], v[212:215]
v_exp_f32 v198, v198
v_mfma_f32_16x16x32_bf16 v[212:215], v[228:231], v[44:47], v[212:215]
v_exp_f32 v199, v199
v_mfma_f32_16x16x32_bf16 v[216:219], v[224:227], v[72:75], v[216:219]
ds_read_b128 v[244:247], v248 offset:64000
v_cvt_pk_bf16_f32 v180, v196, v197
v_mfma_f32_16x16x32_bf16 v[216:219], v[228:231], v[76:79], v[216:219]
v_cvt_pk_bf16_f32 v181, v198, v199
v_mfma_f32_16x16x32_bf16 v[220:223], v[224:227], v[104:107], v[220:223]
v_exp_f32 v200, v200
v_mfma_f32_16x16x32_bf16 v[220:223], v[228:231], v[108:111], v[220:223]
s_waitcnt lgkmcnt(2)
v_xor_b32 v248, 0x10000, v248
v_mfma_f32_16x16x32_bf16 v[208:211], v[232:235], v[16:19], v[208:211]
ds_read_b128 v[224:227], v248 offset:0
v_mfma_f32_16x16x32_bf16 v[208:211], v[236:239], v[20:23], v[208:211]
v_exp_f32 v201, v201
v_mfma_f32_16x16x32_bf16 v[212:215], v[232:235], v[48:51], v[212:215]
v_exp_f32 v202, v202
v_mfma_f32_16x16x32_bf16 v[212:215], v[236:239], v[52:55], v[212:215]
v_exp_f32 v203, v203
v_mfma_f32_16x16x32_bf16 v[216:219], v[232:235], v[80:83], v[216:219]
ds_read_b128 v[228:231], v248 offset:512
v_cvt_pk_bf16_f32 v184, v200, v201
v_mfma_f32_16x16x32_bf16 v[216:219], v[236:239], v[84:87], v[216:219]
v_cvt_pk_bf16_f32 v185, v202, v203
v_mfma_f32_16x16x32_bf16 v[220:223], v[232:235], v[112:115], v[220:223]
v_exp_f32 v204, v204
v_mfma_f32_16x16x32_bf16 v[220:223], v[236:239], v[116:119], v[220:223]
s_waitcnt lgkmcnt(2)
v_mfma_f32_16x16x32_bf16 v[208:211], v[240:243], v[24:27], v[208:211]
ds_read_b128 v[232:235], v248 offset:4096
v_mfma_f32_16x16x32_bf16 v[208:211], v[244:247], v[28:31], v[208:211]
v_exp_f32 v205, v205
v_mfma_f32_16x16x32_bf16 v[212:215], v[240:243], v[56:59], v[212:215]
v_exp_f32 v206, v206
v_mfma_f32_16x16x32_bf16 v[212:215], v[244:247], v[60:63], v[212:215]
v_exp_f32 v207, v207
v_mfma_f32_16x16x32_bf16 v[216:219], v[240:243], v[88:91], v[216:219]
ds_read_b128 v[236:239], v248 offset:4608
v_cvt_pk_bf16_f32 v188, v204, v205
v_mfma_f32_16x16x32_bf16 v[216:219], v[244:247], v[92:95], v[216:219]
v_cvt_pk_bf16_f32 v189, v206, v207
v_mfma_f32_16x16x32_bf16 v[220:223], v[240:243], v[120:123], v[220:223]
v_mfma_f32_16x16x32_bf16 v[220:223], v[244:247], v[124:127], v[220:223]
s_waitcnt lgkmcnt(2)
v_mfma_f32_16x16x32_bf16 v[192:195], v[224:227], v[0:3], 0
ds_read_b128 v[240:243], v248 offset:8192
v_mfma_f32_16x16x32_bf16 v[192:195], v[228:231], v[4:7], v[192:195]
v_exp_f32 v208, v208
v_mfma_f32_16x16x32_bf16 v[196:199], v[224:227], v[32:35], 0
v_exp_f32 v209, v209
v_mfma_f32_16x16x32_bf16 v[196:199], v[228:231], v[36:39], v[196:199]
v_exp_f32 v210, v210
v_mfma_f32_16x16x32_bf16 v[200:203], v[224:227], v[64:67], 0
ds_read_b128 v[244:247], v248 offset:8704
v_cvt_pk_bf16_f32 v178, v208, v209
v_mfma_f32_16x16x32_bf16 v[200:203], v[228:231], v[68:71], v[200:203]
v_exp_f32 v211, v211
v_mfma_f32_16x16x32_bf16 v[204:207], v[224:227], v[96:99], 0
v_exp_f32 v212, v212
v_mfma_f32_16x16x32_bf16 v[204:207], v[228:231], v[100:103], v[204:207]
s_waitcnt lgkmcnt(2)
v_cvt_pk_bf16_f32 v179, v210, v211
v_mfma_f32_16x16x32_bf16 v[192:195], v[232:235], v[8:11], v[192:195]
ds_read_b128 v[224:227], v248 offset:12288
v_mfma_f32_16x16x32_bf16 v[192:195], v[236:239], v[12:15], v[192:195]
v_exp_f32 v213, v213
v_mfma_f32_16x16x32_bf16 v[196:199], v[232:235], v[40:43], v[196:199]
ds_read_b128 v[4:7], v255 offset:0
ds_read_b128 v[36:39], v255 offset:1024
v_mfma_f32_16x16x32_bf16 v[196:199], v[236:239], v[44:47], v[196:199]
v_exp_f32 v214, v214
v_mfma_f32_16x16x32_bf16 v[200:203], v[232:235], v[72:75], v[200:203]
ds_read_b128 v[228:231], v248 offset:12800
v_xor_b32 v12, 0x10000, v249
v_mfma_f32_16x16x32_bf16 v[200:203], v[236:239], v[76:79], v[200:203]
v_xor_b32 v13, 0x10000, v250
v_cvt_pk_bf16_f32 v182, v212, v213
v_mfma_f32_16x16x32_bf16 v[204:207], v[232:235], v[104:107], v[204:207]
ds_read_b128 v[68:71], v255 offset:2048
ds_read_b128 v[100:103], v255 offset:3072
v_mfma_f32_16x16x32_bf16 v[204:207], v[236:239], v[108:111], v[204:207]
s_waitcnt lgkmcnt(6)
v_mov_b32 v2, 0
v_mfma_f32_16x16x32_bf16 v[192:195], v[240:243], v[16:19], v[192:195]
ds_read_b64_tr_b16 v[232:233], v12 offset:0
ds_read_b64_tr_b16 v[234:235], v12 offset:2048
v_mfma_f32_16x16x32_bf16 v[192:195], v[244:247], v[20:23], v[192:195]
v_exp_f32 v215, v215
v_mfma_f32_16x16x32_bf16 v[196:199], v[240:243], v[48:51], v[196:199]
ds_read_b128 v[8:11], v255 offset:4096
ds_read_b128 v[40:43], v255 offset:5120
v_mfma_f32_16x16x32_bf16 v[196:199], v[244:247], v[52:55], v[196:199]
v_cvt_pk_bf16_f32 v183, v214, v215
v_mov_b32 v3, 0
v_mfma_f32_16x16x32_bf16 v[200:203], v[240:243], v[80:83], v[200:203]
ds_read_b64_tr_b16 v[236:237], v12 offset:16384
ds_read_b64_tr_b16 v[238:239], v12 offset:18432
v_mfma_f32_16x16x32_bf16 v[200:203], v[244:247], v[84:87], v[200:203]
v_exp_f32 v216, v216
v_mfma_f32_16x16x32_bf16 v[204:207], v[240:243], v[112:115], v[204:207]
ds_read_b128 v[72:75], v255 offset:6144
ds_read_b128 v[104:107], v255 offset:7168
v_mfma_f32_16x16x32_bf16 v[204:207], v[244:247], v[116:119], v[204:207]
s_waitcnt lgkmcnt(10)
v_mov_b32 v34, 0
v_mfma_f32_16x16x32_bf16 v[192:195], v[224:227], v[24:27], v[192:195]
ds_read_b64_tr_b16 v[240:241], v12 offset:32768
ds_read_b64_tr_b16 v[242:243], v12 offset:34816
v_mfma_f32_16x16x32_bf16 v[192:195], v[228:231], v[28:31], v[192:195]
v_exp_f32 v217, v217
v_mfma_f32_16x16x32_bf16 v[196:199], v[224:227], v[56:59], v[196:199]
v_exp_f32 v218, v218
v_mfma_f32_16x16x32_bf16 v[196:199], v[228:231], v[60:63], v[196:199]
v_exp_f32 v219, v219
v_mfma_f32_16x16x32_bf16 v[200:203], v[224:227], v[88:91], v[200:203]
ds_read_b64_tr_b16 v[244:245], v12 offset:49152
ds_read_b64_tr_b16 v[246:247], v12 offset:51200
v_mfma_f32_16x16x32_bf16 v[200:203], v[228:231], v[92:95], v[200:203]
v_cvt_pk_bf16_f32 v186, v216, v217
v_cvt_pk_bf16_f32 v187, v218, v219
v_mfma_f32_16x16x32_bf16 v[204:207], v[224:227], v[120:123], v[204:207]
v_exp_f32 v220, v220
v_mfma_f32_16x16x32_bf16 v[204:207], v[228:231], v[124:127], v[204:207]
s_waitcnt lgkmcnt(6)
s_waitcnt lgkmcnt(4)
v_mfma_f32_16x16x32_bf16 a[0:3], v[232:235], v[128:131], a[0:3]
ds_read_b64_tr_b16 v[224:225], v13 offset:0
ds_read_b64_tr_b16 v[226:227], v13 offset:2048
v_mfma_f32_16x16x32_bf16 a[0:3], v[236:239], v[144:147], a[0:3]
v_exp_f32 v221, v221
v_mfma_f32_16x16x32_bf16 a[4:7], v[232:235], v[132:135], a[4:7]
v_exp_f32 v222, v222
v_mfma_f32_16x16x32_bf16 a[4:7], v[236:239], v[148:151], a[4:7]
v_exp_f32 v223, v223
v_mfma_f32_16x16x32_bf16 a[8:11], v[232:235], v[136:139], a[8:11]
ds_read_b64_tr_b16 v[228:229], v13 offset:16384
ds_read_b64_tr_b16 v[230:231], v13 offset:18432
v_mfma_f32_16x16x32_bf16 a[8:11], v[236:239], v[152:155], a[8:11]
v_cvt_pk_bf16_f32 v190, v220, v221
v_cvt_pk_bf16_f32 v191, v222, v223
v_mfma_f32_16x16x32_bf16 a[12:15], v[232:235], v[140:143], a[12:15]
v_exp_f32 v192, v192
v_mfma_f32_16x16x32_bf16 a[12:15], v[236:239], v[156:159], a[12:15]
s_waitcnt lgkmcnt(4)
v_mov_b32 v35, 0
v_mfma_f32_16x16x32_bf16 a[0:3], v[240:243], v[160:163], a[0:3]
ds_read_b64_tr_b16 v[232:233], v13 offset:32768
ds_read_b64_tr_b16 v[234:235], v13 offset:34816
v_mfma_f32_16x16x32_bf16 a[0:3], v[244:247], v[176:179], a[0:3]
v_exp_f32 v193, v193
v_mfma_f32_16x16x32_bf16 a[4:7], v[240:243], v[164:167], a[4:7]
v_exp_f32 v194, v194
v_mfma_f32_16x16x32_bf16 a[4:7], v[244:247], v[180:183], a[4:7]
v_exp_f32 v195, v195
v_mfma_f32_16x16x32_bf16 a[8:11], v[240:243], v[168:171], a[8:11]
ds_read_b64_tr_b16 v[236:237], v13 offset:49152
ds_read_b64_tr_b16 v[238:239], v13 offset:51200
v_mfma_f32_16x16x32_bf16 a[8:11], v[244:247], v[184:187], a[8:11]
v_cvt_pk_bf16_f32 v0, v192, v193
v_cvt_pk_bf16_f32 v1, v194, v195
v_mfma_f32_16x16x32_bf16 a[12:15], v[240:243], v[172:175], a[12:15]
v_exp_f32 v196, v196
v_mfma_f32_16x16x32_bf16 a[12:15], v[244:247], v[188:191], a[12:15]
s_waitcnt lgkmcnt(4)
v_mov_b32 v66, 0
v_mfma_f32_16x16x32_bf16 a[16:19], v[224:227], v[128:131], a[16:19]
ds_read_b64_tr_b16 v[240:241], v249 offset:33280
ds_read_b64_tr_b16 v[242:243], v249 offset:35328
v_mfma_f32_16x16x32_bf16 a[16:19], v[228:231], v[144:147], a[16:19]
v_exp_f32 v197, v197
v_mfma_f32_16x16x32_bf16 a[20:23], v[224:227], v[132:135], a[20:23]
v_exp_f32 v198, v198
v_mfma_f32_16x16x32_bf16 a[20:23], v[228:231], v[148:151], a[20:23]
v_exp_f32 v199, v199
v_mfma_f32_16x16x32_bf16 a[24:27], v[224:227], v[136:139], a[24:27]
ds_read_b64_tr_b16 v[244:245], v249 offset:49664
ds_read_b64_tr_b16 v[246:247], v249 offset:51712
v_mfma_f32_16x16x32_bf16 a[24:27], v[228:231], v[152:155], a[24:27]
v_cvt_pk_bf16_f32 v32, v196, v197
v_cvt_pk_bf16_f32 v33, v198, v199
v_mfma_f32_16x16x32_bf16 a[28:31], v[224:227], v[140:143], a[28:31]
v_exp_f32 v200, v200
v_mfma_f32_16x16x32_bf16 a[28:31], v[228:231], v[156:159], a[28:31]
s_waitcnt lgkmcnt(4)
v_mov_b32 v67, 0
v_mfma_f32_16x16x32_bf16 a[16:19], v[232:235], v[160:163], a[16:19]
ds_read_b64_tr_b16 v[224:225], v12 offset:512
ds_read_b64_tr_b16 v[226:227], v12 offset:2560
v_mfma_f32_16x16x32_bf16 a[16:19], v[236:239], v[176:179], a[16:19]
v_exp_f32 v201, v201
v_mfma_f32_16x16x32_bf16 a[20:23], v[232:235], v[164:167], a[20:23]
v_exp_f32 v202, v202
v_mfma_f32_16x16x32_bf16 a[20:23], v[236:239], v[180:183], a[20:23]
v_exp_f32 v203, v203
v_mfma_f32_16x16x32_bf16 a[24:27], v[232:235], v[168:171], a[24:27]
ds_read_b64_tr_b16 v[228:229], v12 offset:16896
ds_read_b64_tr_b16 v[230:231], v12 offset:18944
v_mfma_f32_16x16x32_bf16 a[24:27], v[236:239], v[184:187], a[24:27]
v_cvt_pk_bf16_f32 v64, v200, v201
v_cvt_pk_bf16_f32 v65, v202, v203
v_mfma_f32_16x16x32_bf16 a[28:31], v[232:235], v[172:175], a[28:31]
v_exp_f32 v204, v204
v_mfma_f32_16x16x32_bf16 a[28:31], v[236:239], v[188:191], a[28:31]
s_waitcnt lgkmcnt(4)
v_mov_b32 v98, 0
v_mfma_f32_16x16x32_bf16 a[32:35], v[240:243], v[4:7], a[32:35]
ds_read_b64_tr_b16 v[232:233], v249 offset:0
ds_read_b64_tr_b16 v[234:235], v249 offset:2048
v_mfma_f32_16x16x32_bf16 a[32:35], v[244:247], v[8:11], a[32:35]
v_exp_f32 v205, v205
v_mfma_f32_16x16x32_bf16 a[36:39], v[240:243], v[36:39], a[36:39]
v_exp_f32 v206, v206
v_mfma_f32_16x16x32_bf16 a[36:39], v[244:247], v[40:43], a[36:39]
v_exp_f32 v207, v207
v_mfma_f32_16x16x32_bf16 a[40:43], v[240:243], v[68:71], a[40:43]
ds_read_b64_tr_b16 v[236:237], v250 offset:0
ds_read_b64_tr_b16 v[238:239], v250 offset:2048
v_mfma_f32_16x16x32_bf16 a[40:43], v[244:247], v[72:75], a[40:43]
v_cvt_pk_bf16_f32 v96, v204, v205
v_cvt_pk_bf16_f32 v97, v206, v207
v_mfma_f32_16x16x32_bf16 a[44:47], v[240:243], v[100:103], a[44:47]
v_mov_b32 v99, 0
v_mfma_f32_16x16x32_bf16 a[44:47], v[244:247], v[104:107], a[44:47]
s_waitcnt lgkmcnt(4)
v_mfma_f32_16x16x32_bf16 a[32:35], v[224:227], v[128:131], a[32:35]
ds_read_b64_tr_b16 v[240:241], v12 offset:33280
ds_read_b64_tr_b16 v[242:243], v12 offset:35328
v_mfma_f32_16x16x32_bf16 a[32:35], v[228:231], v[144:147], a[32:35]
v_mfma_f32_16x16x32_bf16 a[36:39], v[224:227], v[132:135], a[36:39]
v_mfma_f32_16x16x32_bf16 a[36:39], v[228:231], v[148:151], a[36:39]
v_mfma_f32_16x16x32_bf16 a[40:43], v[224:227], v[136:139], a[40:43]
ds_read_b64_tr_b16 v[244:245], v12 offset:49664
ds_read_b64_tr_b16 v[246:247], v12 offset:51712
v_mfma_f32_16x16x32_bf16 a[40:43], v[228:231], v[152:155], a[40:43]
v_mfma_f32_16x16x32_bf16 a[44:47], v[224:227], v[140:143], a[44:47]
v_mfma_f32_16x16x32_bf16 a[44:47], v[228:231], v[156:159], a[44:47]
s_waitcnt lgkmcnt(4)
v_mfma_f32_16x16x32_bf16 a[0:3], v[232:235], v[0:3], a[0:3]
ds_read_b64_tr_b16 v[224:225], v249 offset:512
ds_read_b64_tr_b16 v[226:227], v249 offset:2560
v_mfma_f32_16x16x32_bf16 a[4:7], v[232:235], v[32:35], a[4:7]
v_mfma_f32_16x16x32_bf16 a[8:11], v[232:235], v[64:67], a[8:11]
v_mfma_f32_16x16x32_bf16 a[12:15], v[232:235], v[96:99], a[12:15]
v_mfma_f32_16x16x32_bf16 a[16:19], v[236:239], v[0:3], a[16:19]
ds_read_b64_tr_b16 v[228:229], v250 offset:512
ds_read_b64_tr_b16 v[230:231], v250 offset:2560
v_mfma_f32_16x16x32_bf16 a[20:23], v[236:239], v[32:35], a[20:23]
v_mfma_f32_16x16x32_bf16 a[24:27], v[236:239], v[64:67], a[24:27]
v_mfma_f32_16x16x32_bf16 a[28:31], v[236:239], v[96:99], a[28:31]
s_waitcnt lgkmcnt(4)
v_mfma_f32_16x16x32_bf16 a[32:35], v[240:243], v[160:163], a[32:35]
ds_read_b64_tr_b16 v[232:233], v250 offset:33280
ds_read_b64_tr_b16 v[234:235], v250 offset:35328
v_mfma_f32_16x16x32_bf16 a[32:35], v[244:247], v[176:179], a[32:35]
v_mfma_f32_16x16x32_bf16 a[36:39], v[240:243], v[164:167], a[36:39]
v_mfma_f32_16x16x32_bf16 a[36:39], v[244:247], v[180:183], a[36:39]
v_mfma_f32_16x16x32_bf16 a[40:43], v[240:243], v[168:171], a[40:43]
ds_read_b64_tr_b16 v[236:237], v250 offset:49664
ds_read_b64_tr_b16 v[238:239], v250 offset:51712
v_accvgpr_read_b32 v192, a0
v_mfma_f32_16x16x32_bf16 a[40:43], v[244:247], v[184:187], a[40:43]
v_accvgpr_read_b32 v193, a4
v_accvgpr_read_b32 v194, a8
v_accvgpr_read_b32 v195, a12
v_mfma_f32_16x16x32_bf16 a[44:47], v[240:243], v[172:175], a[44:47]
v_lshlrev_b32 v253, 2, v252
v_subrev_u32 v196, 0x0d800000, v192
v_subrev_u32 v197, 0x0d800000, v193
v_mfma_f32_16x16x32_bf16 a[44:47], v[244:247], v[188:191], a[44:47]
s_waitcnt lgkmcnt(4)
v_subrev_u32 v198, 0x0d800000, v194
v_subrev_u32 v199, 0x0d800000, v195
v_mfma_f32_16x16x32_bf16 a[32:35], v[224:227], v[0:3], a[32:35]
ds_read_b64_tr_b16 v[240:241], v13 offset:512
ds_read_b64_tr_b16 v[242:243], v13 offset:2560
v_max3_u32 v254, v196, v197, v198
v_mfma_f32_16x16x32_bf16 a[36:39], v[224:227], v[32:35], a[36:39]
v_max_u32 v254, v254, v199
v_mfma_f32_16x16x32_bf16 a[40:43], v[224:227], v[64:67], a[40:43]
s_mov_b64 exec, 0xffff
s_xor_b32 s35, s48, 0
buffer_store_dword v192, v253, s[24:27], s35 offen offset:4 sc1
s_xor_b32 s35, s48, 1024
buffer_store_dword v193, v253, s[24:27], s35 offen offset:4 sc1
s_xor_b32 s35, s48, 2048
buffer_store_dword v194, v253, s[24:27], s35 offen offset:4 sc1
s_xor_b32 s35, s48, 3072
buffer_store_dword v195, v253, s[24:27], s35 offen offset:4 sc1
v_cmp_le_u32 vcc, 0x64000000, v254
s_mov_b64 exec, -1
v_mfma_f32_16x16x32_bf16 a[44:47], v[224:227], v[96:99], a[44:47]
v_accvgpr_read_b32 v192, a0
v_accvgpr_read_b32 v193, a1
v_mfma_f32_16x16x32_bf16 a[48:51], v[228:231], v[0:3], a[48:51]
ds_read_b64_tr_b16 v[244:245], v13 offset:16896
ds_read_b64_tr_b16 v[246:247], v13 offset:18944
v_mfma_f32_16x16x32_bf16 a[52:55], v[228:231], v[32:35], a[52:55]
v_accvgpr_read_b32 v194, a2
v_accvgpr_read_b32 v195, a3
v_mfma_f32_16x16x32_bf16 a[56:59], v[228:231], v[64:67], a[56:59]
v_cvt_pk_bf16_f32 v16, v192, v193
v_cvt_pk_bf16_f32 v17, v194, v195
v_mfma_f32_16x16x32_bf16 a[60:63], v[228:231], v[96:99], a[60:63]
s_waitcnt lgkmcnt(4)
v_accvgpr_read_b32 v200, a4
v_mfma_f32_16x16x32_bf16 a[48:51], v[232:235], v[4:7], a[48:51]
ds_read_b64_tr_b16 v[224:225], v13 offset:33280
ds_read_b64_tr_b16 v[226:227], v13 offset:35328
v_mfma_f32_16x16x32_bf16 a[48:51], v[236:239], v[8:11], a[48:51]
v_accvgpr_read_b32 v201, a5
v_accvgpr_read_b32 v202, a6
v_mfma_f32_16x16x32_bf16 a[52:55], v[232:235], v[36:39], a[52:55]
v_accvgpr_read_b32 v203, a7
v_cvt_pk_bf16_f32 v48, v200, v201
v_mfma_f32_16x16x32_bf16 a[52:55], v[236:239], v[40:43], a[52:55]
v_cvt_pk_bf16_f32 v49, v202, v203
v_accvgpr_read_b32 v208, a8
v_mfma_f32_16x16x32_bf16 a[56:59], v[232:235], v[68:71], a[56:59]
ds_read_b64_tr_b16 v[228:229], v13 offset:49664
ds_read_b64_tr_b16 v[230:231], v13 offset:51712
v_mfma_f32_16x16x32_bf16 a[56:59], v[236:239], v[72:75], a[56:59]
v_accvgpr_read_b32 v209, a9
v_accvgpr_read_b32 v210, a10
v_mfma_f32_16x16x32_bf16 a[60:63], v[232:235], v[100:103], a[60:63]
v_accvgpr_read_b32 v211, a11
v_cvt_pk_bf16_f32 v80, v208, v209
v_mfma_f32_16x16x32_bf16 a[60:63], v[236:239], v[104:107], a[60:63]
s_waitcnt lgkmcnt(4)
v_cvt_pk_bf16_f32 v81, v210, v211
v_mfma_f32_16x16x32_bf16 a[48:51], v[240:243], v[128:131], a[48:51]
ds_read_b64_tr_b16 v[232:233], v249 offset:36864
ds_read_b64_tr_b16 v[234:235], v249 offset:38912
v_mfma_f32_16x16x32_bf16 a[48:51], v[244:247], v[144:147], a[48:51]
v_accvgpr_read_b32 v216, a12
v_accvgpr_read_b32 v217, a13
v_mfma_f32_16x16x32_bf16 a[52:55], v[240:243], v[132:135], a[52:55]
v_accvgpr_read_b32 v218, a14
v_accvgpr_read_b32 v219, a15
v_mfma_f32_16x16x32_bf16 a[52:55], v[244:247], v[148:151], a[52:55]
v_cvt_pk_bf16_f32 v112, v216, v217
v_cvt_pk_bf16_f32 v113, v218, v219
v_mfma_f32_16x16x32_bf16 a[56:59], v[240:243], v[136:139], a[56:59]
ds_read_b64_tr_b16 v[236:237], v249 offset:53248
ds_read_b64_tr_b16 v[238:239], v249 offset:55296
v_mfma_f32_16x16x32_bf16 a[56:59], v[244:247], v[152:155], a[56:59]
v_accvgpr_read_b32 v196, a16
v_accvgpr_read_b32 v197, a17
v_mfma_f32_16x16x32_bf16 a[60:63], v[240:243], v[140:143], a[60:63]
v_accvgpr_read_b32 v198, a18
v_accvgpr_read_b32 v199, a19
v_mfma_f32_16x16x32_bf16 a[60:63], v[244:247], v[156:159], a[60:63]
s_waitcnt lgkmcnt(4)
v_cvt_pk_bf16_f32 v18, v196, v197
v_mfma_f32_16x16x32_bf16 a[48:51], v[224:227], v[160:163], a[48:51]
ds_read_b64_tr_b16 v[240:241], v12 offset:4096
ds_read_b64_tr_b16 v[242:243], v12 offset:6144
v_mfma_f32_16x16x32_bf16 a[48:51], v[228:231], v[176:179], a[48:51]
v_cvt_pk_bf16_f32 v19, v198, v199
buffer_store_dwordx4 v[16:19], v252, s[20:23], s40 offen offset:0 sc1
v_mfma_f32_16x16x32_bf16 a[52:55], v[224:227], v[164:167], a[52:55]
v_accvgpr_read_b32 v204, a20
v_accvgpr_read_b32 v205, a21
v_mfma_f32_16x16x32_bf16 a[52:55], v[228:231], v[180:183], a[52:55]
v_accvgpr_read_b32 v206, a22
v_accvgpr_read_b32 v207, a23
v_mfma_f32_16x16x32_bf16 a[56:59], v[224:227], v[168:171], a[56:59]
ds_read_b64_tr_b16 v[244:245], v12 offset:20480
ds_read_b64_tr_b16 v[246:247], v12 offset:22528
v_mfma_f32_16x16x32_bf16 a[56:59], v[228:231], v[184:187], a[56:59]
v_cvt_pk_bf16_f32 v50, v204, v205
v_cvt_pk_bf16_f32 v51, v206, v207
v_mfma_f32_16x16x32_bf16 a[60:63], v[224:227], v[172:175], a[60:63]
buffer_store_dwordx4 v[48:51], v252, s[20:23], s41 offen offset:0 sc1
v_accvgpr_read_b32 v212, a24
v_mfma_f32_16x16x32_bf16 a[60:63], v[228:231], v[188:191], a[60:63]
s_waitcnt lgkmcnt(4)
v_accvgpr_read_b32 v213, a25
v_mfma_f32_16x16x32_bf16 a[64:67], v[232:235], v[4:7], a[64:67]
ds_read_b64_tr_b16 v[224:225], v12 offset:36864
ds_read_b64_tr_b16 v[226:227], v12 offset:38912
v_mfma_f32_16x16x32_bf16 a[64:67], v[236:239], v[8:11], a[64:67]
v_accvgpr_read_b32 v214, a26
v_accvgpr_read_b32 v215, a27
v_mfma_f32_16x16x32_bf16 a[68:71], v[232:235], v[36:39], a[68:71]
v_cvt_pk_bf16_f32 v82, v212, v213
v_cvt_pk_bf16_f32 v83, v214, v215
v_mfma_f32_16x16x32_bf16 a[68:71], v[236:239], v[40:43], a[68:71]
buffer_store_dwordx4 v[80:83], v252, s[20:23], s42 offen offset:0 sc1
v_accvgpr_read_b32 v220, a28
v_mfma_f32_16x16x32_bf16 a[72:75], v[232:235], v[68:71], a[72:75]
ds_read_b64_tr_b16 v[228:229], v12 offset:53248
ds_read_b64_tr_b16 v[230:231], v12 offset:55296
v_mfma_f32_16x16x32_bf16 a[72:75], v[236:239], v[72:75], a[72:75]
v_accvgpr_read_b32 v221, a29
v_accvgpr_read_b32 v222, a30
v_mfma_f32_16x16x32_bf16 a[76:79], v[232:235], v[100:103], a[76:79]
v_accvgpr_read_b32 v223, a31
v_cvt_pk_bf16_f32 v114, v220, v221
v_mfma_f32_16x16x32_bf16 a[76:79], v[236:239], v[104:107], a[76:79]
s_waitcnt lgkmcnt(4)
v_cvt_pk_bf16_f32 v115, v222, v223
v_mfma_f32_16x16x32_bf16 a[64:67], v[240:243], v[128:131], a[64:67]
ds_read_b64_tr_b16 v[232:233], v249 offset:4096
ds_read_b64_tr_b16 v[234:235], v249 offset:6144
v_mfma_f32_16x16x32_bf16 a[64:67], v[244:247], v[144:147], a[64:67]
buffer_store_dwordx4 v[112:115], v252, s[20:23], s43 offen offset:0 sc1
v_accvgpr_read_b32 v192, a32
v_mfma_f32_16x16x32_bf16 a[68:71], v[240:243], v[132:135], a[68:71]
v_accvgpr_read_b32 v193, a33
v_accvgpr_read_b32 v194, a34
v_mfma_f32_16x16x32_bf16 a[68:71], v[244:247], v[148:151], a[68:71]
v_accvgpr_read_b32 v195, a35
v_cvt_pk_bf16_f32 v20, v192, v193
v_mfma_f32_16x16x32_bf16 a[72:75], v[240:243], v[136:139], a[72:75]
ds_read_b64_tr_b16 v[236:237], v250 offset:4096
ds_read_b64_tr_b16 v[238:239], v250 offset:6144
v_mfma_f32_16x16x32_bf16 a[72:75], v[244:247], v[152:155], a[72:75]
v_cvt_pk_bf16_f32 v21, v194, v195
v_accvgpr_read_b32 v200, a36
v_mfma_f32_16x16x32_bf16 a[76:79], v[240:243], v[140:143], a[76:79]
v_accvgpr_read_b32 v201, a37
v_accvgpr_read_b32 v202, a38
v_mfma_f32_16x16x32_bf16 a[76:79], v[244:247], v[156:159], a[76:79]
s_waitcnt lgkmcnt(4)
v_accvgpr_read_b32 v203, a39
v_mfma_f32_16x16x32_bf16 a[64:67], v[224:227], v[160:163], a[64:67]
ds_read_b64_tr_b16 v[240:241], v250 offset:36864
ds_read_b64_tr_b16 v[242:243], v250 offset:38912
v_mfma_f32_16x16x32_bf16 a[64:67], v[228:231], v[176:179], a[64:67]
v_cvt_pk_bf16_f32 v52, v200, v201
v_cvt_pk_bf16_f32 v53, v202, v203
v_mfma_f32_16x16x32_bf16 a[68:71], v[224:227], v[164:167], a[68:71]
v_accvgpr_read_b32 v208, a40
v_accvgpr_read_b32 v209, a41
v_mfma_f32_16x16x32_bf16 a[68:71], v[228:231], v[180:183], a[68:71]
v_accvgpr_read_b32 v210, a42
v_accvgpr_read_b32 v211, a43
v_mfma_f32_16x16x32_bf16 a[72:75], v[224:227], v[168:171], a[72:75]
ds_read_b64_tr_b16 v[244:245], v250 offset:53248
ds_read_b64_tr_b16 v[246:247], v250 offset:55296
v_mfma_f32_16x16x32_bf16 a[72:75], v[228:231], v[184:187], a[72:75]
v_cvt_pk_bf16_f32 v84, v208, v209
v_cvt_pk_bf16_f32 v85, v210, v211
v_mfma_f32_16x16x32_bf16 a[76:79], v[224:227], v[172:175], a[76:79]
v_accvgpr_read_b32 v216, a44
v_accvgpr_read_b32 v217, a45
v_mfma_f32_16x16x32_bf16 a[76:79], v[228:231], v[188:191], a[76:79]
s_waitcnt lgkmcnt(4)
v_accvgpr_read_b32 v218, a46
v_mfma_f32_16x16x32_bf16 a[64:67], v[232:235], v[0:3], a[64:67]
ds_read_b64_tr_b16 v[224:225], v13 offset:4096
ds_read_b64_tr_b16 v[226:227], v13 offset:6144
v_mfma_f32_16x16x32_bf16 a[68:71], v[232:235], v[32:35], a[68:71]
v_accvgpr_read_b32 v219, a47
v_cvt_pk_bf16_f32 v116, v216, v217
v_mfma_f32_16x16x32_bf16 a[72:75], v[232:235], v[64:67], a[72:75]
v_cvt_pk_bf16_f32 v117, v218, v219
v_accvgpr_read_b32 v196, a48
v_mfma_f32_16x16x32_bf16 a[76:79], v[232:235], v[96:99], a[76:79]
v_accvgpr_read_b32 v197, a49
v_accvgpr_read_b32 v198, a50
v_mfma_f32_16x16x32_bf16 a[80:83], v[236:239], v[0:3], a[80:83]
ds_read_b64_tr_b16 v[228:229], v13 offset:20480
ds_read_b64_tr_b16 v[230:231], v13 offset:22528
v_mfma_f32_16x16x32_bf16 a[84:87], v[236:239], v[32:35], a[84:87]
v_accvgpr_read_b32 v199, a51
v_cvt_pk_bf16_f32 v22, v196, v197
v_mfma_f32_16x16x32_bf16 a[88:91], v[236:239], v[64:67], a[88:91]
v_cvt_pk_bf16_f32 v23, v198, v199
buffer_store_dwordx4 v[20:23], v252, s[20:23], s40 offen offset:1024 sc1
v_mfma_f32_16x16x32_bf16 a[92:95], v[236:239], v[96:99], a[92:95]
s_waitcnt lgkmcnt(4)
v_accvgpr_read_b32 v204, a52
v_mfma_f32_16x16x32_bf16 a[80:83], v[240:243], v[4:7], a[80:83]
ds_read_b64_tr_b16 v[232:233], v13 offset:36864
ds_read_b64_tr_b16 v[234:235], v13 offset:38912
v_mfma_f32_16x16x32_bf16 a[80:83], v[244:247], v[8:11], a[80:83]
v_accvgpr_read_b32 v205, a53
v_accvgpr_read_b32 v206, a54
v_mfma_f32_16x16x32_bf16 a[84:87], v[240:243], v[36:39], a[84:87]
v_accvgpr_read_b32 v207, a55
v_cvt_pk_bf16_f32 v54, v204, v205
v_mfma_f32_16x16x32_bf16 a[84:87], v[244:247], v[40:43], a[84:87]
v_cvt_pk_bf16_f32 v55, v206, v207
buffer_store_dwordx4 v[52:55], v252, s[20:23], s41 offen offset:1024 sc1
v_mfma_f32_16x16x32_bf16 a[88:91], v[240:243], v[68:71], a[88:91]
ds_read_b64_tr_b16 v[236:237], v13 offset:53248
ds_read_b64_tr_b16 v[238:239], v13 offset:55296
v_mfma_f32_16x16x32_bf16 a[88:91], v[244:247], v[72:75], a[88:91]
v_accvgpr_read_b32 v212, a56
v_accvgpr_read_b32 v213, a57
v_mfma_f32_16x16x32_bf16 a[92:95], v[240:243], v[100:103], a[92:95]
v_accvgpr_read_b32 v214, a58
v_accvgpr_read_b32 v215, a59
v_mfma_f32_16x16x32_bf16 a[92:95], v[244:247], v[104:107], a[92:95]
s_waitcnt lgkmcnt(4)
v_cvt_pk_bf16_f32 v86, v212, v213
v_mfma_f32_16x16x32_bf16 a[80:83], v[224:227], v[128:131], a[80:83]
ds_read_b64_tr_b16 v[240:241], v249 offset:37376
ds_read_b64_tr_b16 v[242:243], v249 offset:39424
v_mfma_f32_16x16x32_bf16 a[80:83], v[228:231], v[144:147], a[80:83]
v_cvt_pk_bf16_f32 v87, v214, v215
buffer_store_dwordx4 v[84:87], v252, s[20:23], s42 offen offset:1024 sc1
v_mfma_f32_16x16x32_bf16 a[84:87], v[224:227], v[132:135], a[84:87]
v_accvgpr_read_b32 v220, a60
v_accvgpr_read_b32 v221, a61
v_mfma_f32_16x16x32_bf16 a[84:87], v[228:231], v[148:151], a[84:87]
v_accvgpr_read_b32 v222, a62
v_accvgpr_read_b32 v223, a63
v_mfma_f32_16x16x32_bf16 a[88:91], v[224:227], v[136:139], a[88:91]
ds_read_b64_tr_b16 v[244:245], v249 offset:53760
ds_read_b64_tr_b16 v[246:247], v249 offset:55808
v_mfma_f32_16x16x32_bf16 a[88:91], v[228:231], v[152:155], a[88:91]
v_cvt_pk_bf16_f32 v118, v220, v221
v_cvt_pk_bf16_f32 v119, v222, v223
v_mfma_f32_16x16x32_bf16 a[92:95], v[224:227], v[140:143], a[92:95]
buffer_store_dwordx4 v[116:119], v252, s[20:23], s43 offen offset:1024 sc1
v_accvgpr_read_b32 v192, a64
v_mfma_f32_16x16x32_bf16 a[92:95], v[228:231], v[156:159], a[92:95]
s_waitcnt lgkmcnt(4)
v_accvgpr_read_b32 v193, a65
v_mfma_f32_16x16x32_bf16 a[80:83], v[232:235], v[160:163], a[80:83]
ds_read_b64_tr_b16 v[224:225], v12 offset:4608
ds_read_b64_tr_b16 v[226:227], v12 offset:6656
v_mfma_f32_16x16x32_bf16 a[80:83], v[236:239], v[176:179], a[80:83]
v_accvgpr_read_b32 v194, a66
v_accvgpr_read_b32 v195, a67
v_mfma_f32_16x16x32_bf16 a[84:87], v[232:235], v[164:167], a[84:87]
v_cvt_pk_bf16_f32 v24, v192, v193
v_cvt_pk_bf16_f32 v25, v194, v195
v_mfma_f32_16x16x32_bf16 a[84:87], v[236:239], v[180:183], a[84:87]
v_accvgpr_read_b32 v200, a68
v_accvgpr_read_b32 v201, a69
v_mfma_f32_16x16x32_bf16 a[88:91], v[232:235], v[168:171], a[88:91]
ds_read_b64_tr_b16 v[228:229], v12 offset:20992
ds_read_b64_tr_b16 v[230:231], v12 offset:23040
v_mfma_f32_16x16x32_bf16 a[88:91], v[236:239], v[184:187], a[88:91]
v_accvgpr_read_b32 v202, a70
v_accvgpr_read_b32 v203, a71
v_mfma_f32_16x16x32_bf16 a[92:95], v[232:235], v[172:175], a[92:95]
v_cvt_pk_bf16_f32 v56, v200, v201
v_cvt_pk_bf16_f32 v57, v202, v203
v_mfma_f32_16x16x32_bf16 a[92:95], v[236:239], v[188:191], a[92:95]
s_waitcnt lgkmcnt(4)
v_accvgpr_read_b32 v208, a72
v_mfma_f32_16x16x32_bf16 a[96:99], v[240:243], v[4:7], a[96:99]
ds_read_b64_tr_b16 v[232:233], v12 offset:37376
ds_read_b64_tr_b16 v[234:235], v12 offset:39424
v_mfma_f32_16x16x32_bf16 a[96:99], v[244:247], v[8:11], a[96:99]
v_accvgpr_read_b32 v209, a73
v_accvgpr_read_b32 v210, a74
v_mfma_f32_16x16x32_bf16 a[100:103], v[240:243], v[36:39], a[100:103]
v_accvgpr_read_b32 v211, a75
v_cvt_pk_bf16_f32 v88, v208, v209
v_mfma_f32_16x16x32_bf16 a[100:103], v[244:247], v[40:43], a[100:103]
v_cvt_pk_bf16_f32 v89, v210, v211
v_accvgpr_read_b32 v216, a76
v_mfma_f32_16x16x32_bf16 a[104:107], v[240:243], v[68:71], a[104:107]
ds_read_b64_tr_b16 v[236:237], v12 offset:53760
ds_read_b64_tr_b16 v[238:239], v12 offset:55808
v_mfma_f32_16x16x32_bf16 a[104:107], v[244:247], v[72:75], a[104:107]
v_accvgpr_read_b32 v217, a77
v_accvgpr_read_b32 v218, a78
v_mfma_f32_16x16x32_bf16 a[108:111], v[240:243], v[100:103], a[108:111]
v_accvgpr_read_b32 v219, a79
v_cvt_pk_bf16_f32 v120, v216, v217
v_mfma_f32_16x16x32_bf16 a[108:111], v[244:247], v[104:107], a[108:111]
s_waitcnt lgkmcnt(4)
v_cvt_pk_bf16_f32 v121, v218, v219
v_mfma_f32_16x16x32_bf16 a[96:99], v[224:227], v[128:131], a[96:99]
ds_read_b64_tr_b16 v[240:241], v249 offset:4608
ds_read_b64_tr_b16 v[242:243], v249 offset:6656
v_mfma_f32_16x16x32_bf16 a[96:99], v[228:231], v[144:147], a[96:99]
v_accvgpr_read_b32 v196, a80
v_accvgpr_read_b32 v197, a81
v_mfma_f32_16x16x32_bf16 a[100:103], v[224:227], v[132:135], a[100:103]
v_accvgpr_read_b32 v198, a82
v_accvgpr_read_b32 v199, a83
v_mfma_f32_16x16x32_bf16 a[100:103], v[228:231], v[148:151], a[100:103]
v_cvt_pk_bf16_f32 v26, v196, v197
v_cvt_pk_bf16_f32 v27, v198, v199
v_mfma_f32_16x16x32_bf16 a[104:107], v[224:227], v[136:139], a[104:107]
ds_read_b64_tr_b16 v[244:245], v250 offset:4608
ds_read_b64_tr_b16 v[246:247], v250 offset:6656
v_mfma_f32_16x16x32_bf16 a[104:107], v[228:231], v[152:155], a[104:107]
buffer_store_dwordx4 v[24:27], v252, s[20:23], s40 offen offset:2048 sc1
v_accvgpr_read_b32 v204, a84
v_mfma_f32_16x16x32_bf16 a[108:111], v[224:227], v[140:143], a[108:111]
v_accvgpr_read_b32 v205, a85
v_accvgpr_read_b32 v206, a86
v_mfma_f32_16x16x32_bf16 a[108:111], v[228:231], v[156:159], a[108:111]
s_waitcnt lgkmcnt(4)
v_accvgpr_read_b32 v207, a87
v_mfma_f32_16x16x32_bf16 a[96:99], v[232:235], v[160:163], a[96:99]
ds_read_b64_tr_b16 v[224:225], v250 offset:37376
ds_read_b64_tr_b16 v[226:227], v250 offset:39424
v_mfma_f32_16x16x32_bf16 a[96:99], v[236:239], v[176:179], a[96:99]
v_cvt_pk_bf16_f32 v58, v204, v205
v_cvt_pk_bf16_f32 v59, v206, v207
v_mfma_f32_16x16x32_bf16 a[100:103], v[232:235], v[164:167], a[100:103]
buffer_store_dwordx4 v[56:59], v252, s[20:23], s41 offen offset:2048 sc1
v_accvgpr_read_b32 v212, a88
v_mfma_f32_16x16x32_bf16 a[100:103], v[236:239], v[180:183], a[100:103]
v_accvgpr_read_b32 v213, a89
v_accvgpr_read_b32 v214, a90
v_mfma_f32_16x16x32_bf16 a[104:107], v[232:235], v[168:171], a[104:107]
ds_read_b64_tr_b16 v[228:229], v250 offset:53760
ds_read_b64_tr_b16 v[230:231], v250 offset:55808
v_mfma_f32_16x16x32_bf16 a[104:107], v[236:239], v[184:187], a[104:107]
v_accvgpr_read_b32 v215, a91
v_cvt_pk_bf16_f32 v90, v212, v213
v_mfma_f32_16x16x32_bf16 a[108:111], v[232:235], v[172:175], a[108:111]
v_cvt_pk_bf16_f32 v91, v214, v215
buffer_store_dwordx4 v[88:91], v252, s[20:23], s42 offen offset:2048 sc1
v_mfma_f32_16x16x32_bf16 a[108:111], v[236:239], v[188:191], a[108:111]
s_waitcnt lgkmcnt(4)
v_accvgpr_read_b32 v220, a92
v_mfma_f32_16x16x32_bf16 a[96:99], v[240:243], v[0:3], a[96:99]
ds_read_b64_tr_b16 v[232:233], v13 offset:4608
ds_read_b64_tr_b16 v[234:235], v13 offset:6656
v_mfma_f32_16x16x32_bf16 a[100:103], v[240:243], v[32:35], a[100:103]
v_accvgpr_read_b32 v221, a93
v_accvgpr_read_b32 v222, a94
v_mfma_f32_16x16x32_bf16 a[104:107], v[240:243], v[64:67], a[104:107]
v_accvgpr_read_b32 v223, a95
v_cvt_pk_bf16_f32 v122, v220, v221
v_mfma_f32_16x16x32_bf16 a[108:111], v[240:243], v[96:99], a[108:111]
v_cvt_pk_bf16_f32 v123, v222, v223
buffer_store_dwordx4 v[120:123], v252, s[20:23], s43 offen offset:2048 sc1
v_mfma_f32_16x16x32_bf16 a[112:115], v[244:247], v[0:3], a[112:115]
ds_read_b64_tr_b16 v[236:237], v13 offset:20992
ds_read_b64_tr_b16 v[238:239], v13 offset:23040
v_mfma_f32_16x16x32_bf16 a[116:119], v[244:247], v[32:35], a[116:119]
v_accvgpr_read_b32 v192, a96
v_accvgpr_read_b32 v193, a97
v_mfma_f32_16x16x32_bf16 a[120:123], v[244:247], v[64:67], a[120:123]
v_accvgpr_read_b32 v194, a98
v_accvgpr_read_b32 v195, a99
v_mfma_f32_16x16x32_bf16 a[124:127], v[244:247], v[96:99], a[124:127]
s_waitcnt lgkmcnt(4)
v_cvt_pk_bf16_f32 v28, v192, v193
v_mfma_f32_16x16x32_bf16 a[112:115], v[224:227], v[4:7], a[112:115]
ds_read_b64_tr_b16 v[240:241], v13 offset:37376
ds_read_b64_tr_b16 v[242:243], v13 offset:39424
v_mfma_f32_16x16x32_bf16 a[112:115], v[228:231], v[8:11], a[112:115]
v_cvt_pk_bf16_f32 v29, v194, v195
v_accvgpr_read_b32 v200, a100
v_mfma_f32_16x16x32_bf16 a[116:119], v[224:227], v[36:39], a[116:119]
v_accvgpr_read_b32 v201, a101
v_accvgpr_read_b32 v202, a102
v_mfma_f32_16x16x32_bf16 a[116:119], v[228:231], v[40:43], a[116:119]
v_accvgpr_read_b32 v203, a103
v_cvt_pk_bf16_f32 v60, v200, v201
v_mfma_f32_16x16x32_bf16 a[120:123], v[224:227], v[68:71], a[120:123]
ds_read_b64_tr_b16 v[244:245], v13 offset:53760
ds_read_b64_tr_b16 v[246:247], v13 offset:55808
v_mfma_f32_16x16x32_bf16 a[120:123], v[228:231], v[72:75], a[120:123]
v_cvt_pk_bf16_f32 v61, v202, v203
v_accvgpr_read_b32 v208, a104
v_mfma_f32_16x16x32_bf16 a[124:127], v[224:227], v[100:103], a[124:127]
v_accvgpr_read_b32 v209, a105
v_accvgpr_read_b32 v210, a106
v_mfma_f32_16x16x32_bf16 a[124:127], v[228:231], v[104:107], a[124:127]
s_waitcnt lgkmcnt(4)
v_accvgpr_read_b32 v211, a107
v_mfma_f32_16x16x32_bf16 a[112:115], v[232:235], v[128:131], a[112:115]
ds_read_b64_tr_b16 v[224:225], v249 offset:40960
ds_read_b64_tr_b16 v[226:227], v249 offset:43008
v_mfma_f32_16x16x32_bf16 a[112:115], v[236:239], v[144:147], a[112:115]
v_cvt_pk_bf16_f32 v92, v208, v209
v_cvt_pk_bf16_f32 v93, v210, v211
v_mfma_f32_16x16x32_bf16 a[116:119], v[232:235], v[132:135], a[116:119]
v_accvgpr_read_b32 v216, a108
v_accvgpr_read_b32 v217, a109
v_mfma_f32_16x16x32_bf16 a[116:119], v[236:239], v[148:151], a[116:119]
v_accvgpr_read_b32 v218, a110
v_accvgpr_read_b32 v219, a111
v_mfma_f32_16x16x32_bf16 a[120:123], v[232:235], v[136:139], a[120:123]
ds_read_b64_tr_b16 v[228:229], v249 offset:57344
ds_read_b64_tr_b16 v[230:231], v249 offset:59392
v_mfma_f32_16x16x32_bf16 a[120:123], v[236:239], v[152:155], a[120:123]
v_cvt_pk_bf16_f32 v124, v216, v217
v_cvt_pk_bf16_f32 v125, v218, v219
v_mfma_f32_16x16x32_bf16 a[124:127], v[232:235], v[140:143], a[124:127]
v_mfma_f32_16x16x32_bf16 a[124:127], v[236:239], v[156:159], a[124:127]
s_waitcnt lgkmcnt(4)
v_mfma_f32_16x16x32_bf16 a[112:115], v[240:243], v[160:163], a[112:115]
ds_read_b64_tr_b16 v[232:233], v12 offset:8192
ds_read_b64_tr_b16 v[234:235], v12 offset:10240
v_mfma_f32_16x16x32_bf16 a[112:115], v[244:247], v[176:179], a[112:115]
v_mfma_f32_16x16x32_bf16 a[116:119], v[240:243], v[164:167], a[116:119]
v_mfma_f32_16x16x32_bf16 a[116:119], v[244:247], v[180:183], a[116:119]
v_mfma_f32_16x16x32_bf16 a[120:123], v[240:243], v[168:171], a[120:123]
ds_read_b64_tr_b16 v[236:237], v12 offset:24576
ds_read_b64_tr_b16 v[238:239], v12 offset:26624
v_mfma_f32_16x16x32_bf16 a[120:123], v[244:247], v[184:187], a[120:123]
v_mfma_f32_16x16x32_bf16 a[124:127], v[240:243], v[172:175], a[124:127]
s_nop 0
v_accvgpr_read_b32 v196, a112
v_accvgpr_read_b32 v197, a113
v_mfma_f32_16x16x32_bf16 a[124:127], v[244:247], v[188:191], a[124:127]
s_waitcnt lgkmcnt(4)
v_accvgpr_read_b32 v198, a114
v_mfma_f32_16x16x32_bf16 a[128:131], v[224:227], v[4:7], a[128:131]
ds_read_b64_tr_b16 v[240:241], v12 offset:40960
ds_read_b64_tr_b16 v[242:243], v12 offset:43008
v_mfma_f32_16x16x32_bf16 a[128:131], v[228:231], v[8:11], a[128:131]
v_accvgpr_read_b32 v199, a115
v_cvt_pk_bf16_f32 v30, v196, v197
v_mfma_f32_16x16x32_bf16 a[132:135], v[224:227], v[36:39], a[132:135]
v_cvt_pk_bf16_f32 v31, v198, v199
buffer_store_dwordx4 v[28:31], v252, s[20:23], s40 offen offset:3072 sc1
v_mfma_f32_16x16x32_bf16 a[132:135], v[228:231], v[40:43], a[132:135]
v_accvgpr_read_b32 v204, a116
v_accvgpr_read_b32 v205, a117
v_mfma_f32_16x16x32_bf16 a[136:139], v[224:227], v[68:71], a[136:139]
ds_read_b64_tr_b16 v[244:245], v12 offset:57344
ds_read_b64_tr_b16 v[246:247], v12 offset:59392
v_mfma_f32_16x16x32_bf16 a[136:139], v[228:231], v[72:75], a[136:139]
v_accvgpr_read_b32 v206, a118
v_accvgpr_read_b32 v207, a119
v_mfma_f32_16x16x32_bf16 a[140:143], v[224:227], v[100:103], a[140:143]
v_cvt_pk_bf16_f32 v62, v204, v205
v_cvt_pk_bf16_f32 v63, v206, v207
v_mfma_f32_16x16x32_bf16 a[140:143], v[228:231], v[104:107], a[140:143]
s_waitcnt lgkmcnt(4)
buffer_store_dwordx4 v[60:63], v252, s[20:23], s41 offen offset:3072 sc1
v_mfma_f32_16x16x32_bf16 a[128:131], v[232:235], v[128:131], a[128:131]
ds_read_b64_tr_b16 v[224:225], v249 offset:8192
ds_read_b64_tr_b16 v[226:227], v249 offset:10240
v_mfma_f32_16x16x32_bf16 a[128:131], v[236:239], v[144:147], a[128:131]
v_accvgpr_read_b32 v212, a120
v_accvgpr_read_b32 v213, a121
v_mfma_f32_16x16x32_bf16 a[132:135], v[232:235], v[132:135], a[132:135]
v_accvgpr_read_b32 v214, a122
v_accvgpr_read_b32 v215, a123
v_mfma_f32_16x16x32_bf16 a[132:135], v[236:239], v[148:151], a[132:135]
v_cvt_pk_bf16_f32 v94, v212, v213
v_cvt_pk_bf16_f32 v95, v214, v215
v_mfma_f32_16x16x32_bf16 a[136:139], v[232:235], v[136:139], a[136:139]
ds_read_b64_tr_b16 v[228:229], v250 offset:8192
ds_read_b64_tr_b16 v[230:231], v250 offset:10240
v_mfma_f32_16x16x32_bf16 a[136:139], v[236:239], v[152:155], a[136:139]
buffer_store_dwordx4 v[92:95], v252, s[20:23], s42 offen offset:3072 sc1
v_accvgpr_read_b32 v220, a124
v_mfma_f32_16x16x32_bf16 a[140:143], v[232:235], v[140:143], a[140:143]
v_accvgpr_read_b32 v221, a125
v_accvgpr_read_b32 v222, a126
v_mfma_f32_16x16x32_bf16 a[140:143], v[236:239], v[156:159], a[140:143]
s_waitcnt lgkmcnt(4)
v_accvgpr_read_b32 v223, a127
v_mfma_f32_16x16x32_bf16 a[128:131], v[240:243], v[160:163], a[128:131]
ds_read_b64_tr_b16 v[232:233], v250 offset:40960
ds_read_b64_tr_b16 v[234:235], v250 offset:43008
v_mfma_f32_16x16x32_bf16 a[128:131], v[244:247], v[176:179], a[128:131]
v_cvt_pk_bf16_f32 v126, v220, v221
v_cvt_pk_bf16_f32 v127, v222, v223
v_mfma_f32_16x16x32_bf16 a[132:135], v[240:243], v[164:167], a[132:135]
buffer_store_dwordx4 v[124:127], v252, s[20:23], s43 offen offset:3072 sc1
v_mfma_f32_16x16x32_bf16 a[132:135], v[244:247], v[180:183], a[132:135]
v_mfma_f32_16x16x32_bf16 a[136:139], v[240:243], v[168:171], a[136:139]
ds_read_b64_tr_b16 v[236:237], v250 offset:57344
ds_read_b64_tr_b16 v[238:239], v250 offset:59392
v_mfma_f32_16x16x32_bf16 a[136:139], v[244:247], v[184:187], a[136:139]
v_mfma_f32_16x16x32_bf16 a[140:143], v[240:243], v[172:175], a[140:143]
v_mfma_f32_16x16x32_bf16 a[140:143], v[244:247], v[188:191], a[140:143]
s_waitcnt lgkmcnt(4)
v_mfma_f32_16x16x32_bf16 a[128:131], v[224:227], v[0:3], a[128:131]
ds_read_b64_tr_b16 v[240:241], v13 offset:8192
ds_read_b64_tr_b16 v[242:243], v13 offset:10240
v_mfma_f32_16x16x32_bf16 a[132:135], v[224:227], v[32:35], a[132:135]
v_mfma_f32_16x16x32_bf16 a[136:139], v[224:227], v[64:67], a[136:139]
v_mfma_f32_16x16x32_bf16 a[140:143], v[224:227], v[96:99], a[140:143]
v_mfma_f32_16x16x32_bf16 a[144:147], v[228:231], v[0:3], a[144:147]
ds_read_b64_tr_b16 v[244:245], v13 offset:24576
ds_read_b64_tr_b16 v[246:247], v13 offset:26624
v_mfma_f32_16x16x32_bf16 a[148:151], v[228:231], v[32:35], a[148:151]
v_accvgpr_read_b32 v192, a128
v_accvgpr_read_b32 v193, a129
v_mfma_f32_16x16x32_bf16 a[152:155], v[228:231], v[64:67], a[152:155]
v_accvgpr_read_b32 v194, a130
v_accvgpr_read_b32 v195, a131
v_mfma_f32_16x16x32_bf16 a[156:159], v[228:231], v[96:99], a[156:159]
s_waitcnt lgkmcnt(4)
v_cvt_pk_bf16_f32 v16, v192, v193
v_mfma_f32_16x16x32_bf16 a[144:147], v[232:235], v[4:7], a[144:147]
ds_read_b64_tr_b16 v[224:225], v13 offset:40960
ds_read_b64_tr_b16 v[226:227], v13 offset:43008
v_mfma_f32_16x16x32_bf16 a[144:147], v[236:239], v[8:11], a[144:147]
v_cvt_pk_bf16_f32 v17, v194, v195
v_accvgpr_read_b32 v200, a132
v_mfma_f32_16x16x32_bf16 a[148:151], v[232:235], v[36:39], a[148:151]
v_accvgpr_read_b32 v201, a133
v_accvgpr_read_b32 v202, a134
v_mfma_f32_16x16x32_bf16 a[148:151], v[236:239], v[40:43], a[148:151]
v_accvgpr_read_b32 v203, a135
v_cvt_pk_bf16_f32 v48, v200, v201
v_mfma_f32_16x16x32_bf16 a[152:155], v[232:235], v[68:71], a[152:155]
ds_read_b64_tr_b16 v[228:229], v13 offset:57344
ds_read_b64_tr_b16 v[230:231], v13 offset:59392
v_mfma_f32_16x16x32_bf16 a[152:155], v[236:239], v[72:75], a[152:155]
v_cvt_pk_bf16_f32 v49, v202, v203
v_accvgpr_read_b32 v208, a136
v_mfma_f32_16x16x32_bf16 a[156:159], v[232:235], v[100:103], a[156:159]
v_accvgpr_read_b32 v209, a137
v_accvgpr_read_b32 v210, a138
v_mfma_f32_16x16x32_bf16 a[156:159], v[236:239], v[104:107], a[156:159]
s_waitcnt lgkmcnt(4)
v_accvgpr_read_b32 v211, a139
v_mfma_f32_16x16x32_bf16 a[144:147], v[240:243], v[128:131], a[144:147]
ds_read_b64_tr_b16 v[232:233], v249 offset:41472
ds_read_b64_tr_b16 v[234:235], v249 offset:43520
v_mfma_f32_16x16x32_bf16 a[144:147], v[244:247], v[144:147], a[144:147]
v_cvt_pk_bf16_f32 v80, v208, v209
v_cvt_pk_bf16_f32 v81, v210, v211
v_mfma_f32_16x16x32_bf16 a[148:151], v[240:243], v[132:135], a[148:151]
v_accvgpr_read_b32 v216, a140
v_accvgpr_read_b32 v217, a141
v_mfma_f32_16x16x32_bf16 a[148:151], v[244:247], v[148:151], a[148:151]
v_accvgpr_read_b32 v218, a142
v_accvgpr_read_b32 v219, a143
v_mfma_f32_16x16x32_bf16 a[152:155], v[240:243], v[136:139], a[152:155]
ds_read_b64_tr_b16 v[236:237], v249 offset:57856
ds_read_b64_tr_b16 v[238:239], v249 offset:59904
v_mfma_f32_16x16x32_bf16 a[152:155], v[244:247], v[152:155], a[152:155]
v_cvt_pk_bf16_f32 v112, v216, v217
v_cvt_pk_bf16_f32 v113, v218, v219
v_mfma_f32_16x16x32_bf16 a[156:159], v[240:243], v[140:143], a[156:159]
v_mfma_f32_16x16x32_bf16 a[156:159], v[244:247], v[156:159], a[156:159]
s_waitcnt lgkmcnt(4)
v_mfma_f32_16x16x32_bf16 a[144:147], v[224:227], v[160:163], a[144:147]
ds_read_b64_tr_b16 v[240:241], v12 offset:8704
ds_read_b64_tr_b16 v[242:243], v12 offset:10752
v_mfma_f32_16x16x32_bf16 a[144:147], v[228:231], v[176:179], a[144:147]
v_mfma_f32_16x16x32_bf16 a[148:151], v[224:227], v[164:167], a[148:151]
v_mfma_f32_16x16x32_bf16 a[148:151], v[228:231], v[180:183], a[148:151]
v_mfma_f32_16x16x32_bf16 a[152:155], v[224:227], v[168:171], a[152:155]
ds_read_b64_tr_b16 v[244:245], v12 offset:25088
ds_read_b64_tr_b16 v[246:247], v12 offset:27136
v_mfma_f32_16x16x32_bf16 a[152:155], v[228:231], v[184:187], a[152:155]
v_mfma_f32_16x16x32_bf16 a[156:159], v[224:227], v[172:175], a[156:159]
s_nop 0
v_accvgpr_read_b32 v196, a144
v_accvgpr_read_b32 v197, a145
v_mfma_f32_16x16x32_bf16 a[156:159], v[228:231], v[188:191], a[156:159]
s_waitcnt lgkmcnt(4)
v_accvgpr_read_b32 v198, a146
v_mfma_f32_16x16x32_bf16 a[160:163], v[232:235], v[4:7], a[160:163]
ds_read_b64_tr_b16 v[224:225], v12 offset:41472
ds_read_b64_tr_b16 v[226:227], v12 offset:43520
v_mfma_f32_16x16x32_bf16 a[160:163], v[236:239], v[8:11], a[160:163]
v_accvgpr_read_b32 v199, a147
v_cvt_pk_bf16_f32 v18, v196, v197
v_mfma_f32_16x16x32_bf16 a[164:167], v[232:235], v[36:39], a[164:167]
v_cvt_pk_bf16_f32 v19, v198, v199
buffer_store_dwordx4 v[16:19], v252, s[20:23], s44 offen offset:0 sc1
v_mfma_f32_16x16x32_bf16 a[164:167], v[236:239], v[40:43], a[164:167]
v_accvgpr_read_b32 v204, a148
v_accvgpr_read_b32 v205, a149
v_mfma_f32_16x16x32_bf16 a[168:171], v[232:235], v[68:71], a[168:171]
ds_read_b64_tr_b16 v[228:229], v12 offset:57856
ds_read_b64_tr_b16 v[230:231], v12 offset:59904
v_mfma_f32_16x16x32_bf16 a[168:171], v[236:239], v[72:75], a[168:171]
v_accvgpr_read_b32 v206, a150
v_accvgpr_read_b32 v207, a151
v_mfma_f32_16x16x32_bf16 a[172:175], v[232:235], v[100:103], a[172:175]
v_cvt_pk_bf16_f32 v50, v204, v205
v_cvt_pk_bf16_f32 v51, v206, v207
v_mfma_f32_16x16x32_bf16 a[172:175], v[236:239], v[104:107], a[172:175]
s_waitcnt lgkmcnt(4)
buffer_store_dwordx4 v[48:51], v252, s[20:23], s45 offen offset:0 sc1
v_mfma_f32_16x16x32_bf16 a[160:163], v[240:243], v[128:131], a[160:163]
ds_read_b64_tr_b16 v[232:233], v249 offset:8704
ds_read_b64_tr_b16 v[234:235], v249 offset:10752
v_mfma_f32_16x16x32_bf16 a[160:163], v[244:247], v[144:147], a[160:163]
v_accvgpr_read_b32 v212, a152
v_accvgpr_read_b32 v213, a153
v_mfma_f32_16x16x32_bf16 a[164:167], v[240:243], v[132:135], a[164:167]
v_accvgpr_read_b32 v214, a154
v_accvgpr_read_b32 v215, a155
v_mfma_f32_16x16x32_bf16 a[164:167], v[244:247], v[148:151], a[164:167]
v_cvt_pk_bf16_f32 v82, v212, v213
v_cvt_pk_bf16_f32 v83, v214, v215
v_mfma_f32_16x16x32_bf16 a[168:171], v[240:243], v[136:139], a[168:171]
ds_read_b64_tr_b16 v[236:237], v250 offset:8704
ds_read_b64_tr_b16 v[238:239], v250 offset:10752
v_mfma_f32_16x16x32_bf16 a[168:171], v[244:247], v[152:155], a[168:171]
buffer_store_dwordx4 v[80:83], v252, s[20:23], s46 offen offset:0 sc1
v_accvgpr_read_b32 v220, a156
v_mfma_f32_16x16x32_bf16 a[172:175], v[240:243], v[140:143], a[172:175]
v_accvgpr_read_b32 v221, a157
v_accvgpr_read_b32 v222, a158
v_mfma_f32_16x16x32_bf16 a[172:175], v[244:247], v[156:159], a[172:175]
s_waitcnt lgkmcnt(4)
v_accvgpr_read_b32 v223, a159
v_mfma_f32_16x16x32_bf16 a[160:163], v[224:227], v[160:163], a[160:163]
ds_read_b64_tr_b16 v[240:241], v250 offset:41472
ds_read_b64_tr_b16 v[242:243], v250 offset:43520
v_mfma_f32_16x16x32_bf16 a[160:163], v[228:231], v[176:179], a[160:163]
v_cvt_pk_bf16_f32 v114, v220, v221
v_cvt_pk_bf16_f32 v115, v222, v223
v_mfma_f32_16x16x32_bf16 a[164:167], v[224:227], v[164:167], a[164:167]
buffer_store_dwordx4 v[112:115], v252, s[20:23], s47 offen offset:0 sc1
v_mfma_f32_16x16x32_bf16 a[164:167], v[228:231], v[180:183], a[164:167]
v_mfma_f32_16x16x32_bf16 a[168:171], v[224:227], v[168:171], a[168:171]
ds_read_b64_tr_b16 v[244:245], v250 offset:57856
ds_read_b64_tr_b16 v[246:247], v250 offset:59904
v_mfma_f32_16x16x32_bf16 a[168:171], v[228:231], v[184:187], a[168:171]
v_mfma_f32_16x16x32_bf16 a[172:175], v[224:227], v[172:175], a[172:175]
v_mfma_f32_16x16x32_bf16 a[172:175], v[228:231], v[188:191], a[172:175]
s_waitcnt lgkmcnt(4)
v_mfma_f32_16x16x32_bf16 a[160:163], v[232:235], v[0:3], a[160:163]
ds_read_b64_tr_b16 v[224:225], v13 offset:8704
ds_read_b64_tr_b16 v[226:227], v13 offset:10752
v_mfma_f32_16x16x32_bf16 a[164:167], v[232:235], v[32:35], a[164:167]
v_mfma_f32_16x16x32_bf16 a[168:171], v[232:235], v[64:67], a[168:171]
v_mfma_f32_16x16x32_bf16 a[172:175], v[232:235], v[96:99], a[172:175]
v_mfma_f32_16x16x32_bf16 a[176:179], v[236:239], v[0:3], a[176:179]
ds_read_b64_tr_b16 v[228:229], v13 offset:25088
ds_read_b64_tr_b16 v[230:231], v13 offset:27136
v_mfma_f32_16x16x32_bf16 a[180:183], v[236:239], v[32:35], a[180:183]
v_accvgpr_read_b32 v192, a160
v_accvgpr_read_b32 v193, a161
v_mfma_f32_16x16x32_bf16 a[184:187], v[236:239], v[64:67], a[184:187]
v_accvgpr_read_b32 v194, a162
v_accvgpr_read_b32 v195, a163
v_mfma_f32_16x16x32_bf16 a[188:191], v[236:239], v[96:99], a[188:191]
s_waitcnt lgkmcnt(4)
v_cvt_pk_bf16_f32 v20, v192, v193
v_mfma_f32_16x16x32_bf16 a[176:179], v[240:243], v[4:7], a[176:179]
ds_read_b64_tr_b16 v[232:233], v13 offset:41472
ds_read_b64_tr_b16 v[234:235], v13 offset:43520
v_mfma_f32_16x16x32_bf16 a[176:179], v[244:247], v[8:11], a[176:179]
v_cvt_pk_bf16_f32 v21, v194, v195
v_accvgpr_read_b32 v200, a164
v_mfma_f32_16x16x32_bf16 a[180:183], v[240:243], v[36:39], a[180:183]
v_accvgpr_read_b32 v201, a165
v_accvgpr_read_b32 v202, a166
v_mfma_f32_16x16x32_bf16 a[180:183], v[244:247], v[40:43], a[180:183]
v_accvgpr_read_b32 v203, a167
v_cvt_pk_bf16_f32 v52, v200, v201
v_mfma_f32_16x16x32_bf16 a[184:187], v[240:243], v[68:71], a[184:187]
ds_read_b64_tr_b16 v[236:237], v13 offset:57856
ds_read_b64_tr_b16 v[238:239], v13 offset:59904
v_mfma_f32_16x16x32_bf16 a[184:187], v[244:247], v[72:75], a[184:187]
v_cvt_pk_bf16_f32 v53, v202, v203
v_accvgpr_read_b32 v208, a168
v_mfma_f32_16x16x32_bf16 a[188:191], v[240:243], v[100:103], a[188:191]
v_accvgpr_read_b32 v209, a169
v_accvgpr_read_b32 v210, a170
v_mfma_f32_16x16x32_bf16 a[188:191], v[244:247], v[104:107], a[188:191]
s_waitcnt lgkmcnt(4)
v_accvgpr_read_b32 v211, a171
v_mfma_f32_16x16x32_bf16 a[176:179], v[224:227], v[128:131], a[176:179]
ds_read_b64_tr_b16 v[240:241], v249 offset:45056
ds_read_b64_tr_b16 v[242:243], v249 offset:47104
v_mfma_f32_16x16x32_bf16 a[176:179], v[228:231], v[144:147], a[176:179]
v_cvt_pk_bf16_f32 v84, v208, v209
v_cvt_pk_bf16_f32 v85, v210, v211
v_mfma_f32_16x16x32_bf16 a[180:183], v[224:227], v[132:135], a[180:183]
v_accvgpr_read_b32 v216, a172
v_accvgpr_read_b32 v217, a173
v_mfma_f32_16x16x32_bf16 a[180:183], v[228:231], v[148:151], a[180:183]
v_accvgpr_read_b32 v218, a174
v_accvgpr_read_b32 v219, a175
v_mfma_f32_16x16x32_bf16 a[184:187], v[224:227], v[136:139], a[184:187]
ds_read_b64_tr_b16 v[244:245], v249 offset:61440
ds_read_b64_tr_b16 v[246:247], v249 offset:63488
v_mfma_f32_16x16x32_bf16 a[184:187], v[228:231], v[152:155], a[184:187]
v_cvt_pk_bf16_f32 v116, v216, v217
v_cvt_pk_bf16_f32 v117, v218, v219
v_mfma_f32_16x16x32_bf16 a[188:191], v[224:227], v[140:143], a[188:191]
v_mfma_f32_16x16x32_bf16 a[188:191], v[228:231], v[156:159], a[188:191]
s_waitcnt lgkmcnt(4)
v_mfma_f32_16x16x32_bf16 a[176:179], v[232:235], v[160:163], a[176:179]
ds_read_b64_tr_b16 v[224:225], v12 offset:12288
ds_read_b64_tr_b16 v[226:227], v12 offset:14336
v_mfma_f32_16x16x32_bf16 a[176:179], v[236:239], v[176:179], a[176:179]
v_mfma_f32_16x16x32_bf16 a[180:183], v[232:235], v[164:167], a[180:183]
v_mfma_f32_16x16x32_bf16 a[180:183], v[236:239], v[180:183], a[180:183]
v_mfma_f32_16x16x32_bf16 a[184:187], v[232:235], v[168:171], a[184:187]
ds_read_b64_tr_b16 v[228:229], v12 offset:28672
ds_read_b64_tr_b16 v[230:231], v12 offset:30720
v_mfma_f32_16x16x32_bf16 a[184:187], v[236:239], v[184:187], a[184:187]
v_mfma_f32_16x16x32_bf16 a[188:191], v[232:235], v[172:175], a[188:191]
s_nop 0
v_accvgpr_read_b32 v196, a176
v_accvgpr_read_b32 v197, a177
v_mfma_f32_16x16x32_bf16 a[188:191], v[236:239], v[188:191], a[188:191]
s_waitcnt lgkmcnt(4)
v_accvgpr_read_b32 v198, a178
v_mfma_f32_16x16x32_bf16 a[192:195], v[240:243], v[4:7], a[192:195]
ds_read_b64_tr_b16 v[232:233], v12 offset:45056
ds_read_b64_tr_b16 v[234:235], v12 offset:47104
v_mfma_f32_16x16x32_bf16 a[192:195], v[244:247], v[8:11], a[192:195]
v_accvgpr_read_b32 v199, a179
v_cvt_pk_bf16_f32 v22, v196, v197
v_mfma_f32_16x16x32_bf16 a[196:199], v[240:243], v[36:39], a[196:199]
v_cvt_pk_bf16_f32 v23, v198, v199
buffer_store_dwordx4 v[20:23], v252, s[20:23], s44 offen offset:1024 sc1
v_mfma_f32_16x16x32_bf16 a[196:199], v[244:247], v[40:43], a[196:199]
v_accvgpr_read_b32 v204, a180
v_accvgpr_read_b32 v205, a181
v_mfma_f32_16x16x32_bf16 a[200:203], v[240:243], v[68:71], a[200:203]
ds_read_b64_tr_b16 v[236:237], v12 offset:61440
ds_read_b64_tr_b16 v[238:239], v12 offset:63488
v_mfma_f32_16x16x32_bf16 a[200:203], v[244:247], v[72:75], a[200:203]
v_accvgpr_read_b32 v206, a182
v_accvgpr_read_b32 v207, a183
v_mfma_f32_16x16x32_bf16 a[204:207], v[240:243], v[100:103], a[204:207]
v_cvt_pk_bf16_f32 v54, v204, v205
v_cvt_pk_bf16_f32 v55, v206, v207
v_mfma_f32_16x16x32_bf16 a[204:207], v[244:247], v[104:107], a[204:207]
s_waitcnt lgkmcnt(4)
buffer_store_dwordx4 v[52:55], v252, s[20:23], s45 offen offset:1024 sc1
v_mfma_f32_16x16x32_bf16 a[192:195], v[224:227], v[128:131], a[192:195]
ds_read_b64_tr_b16 v[240:241], v249 offset:12288
ds_read_b64_tr_b16 v[242:243], v249 offset:14336
v_mfma_f32_16x16x32_bf16 a[192:195], v[228:231], v[144:147], a[192:195]
v_accvgpr_read_b32 v212, a184
v_accvgpr_read_b32 v213, a185
v_mfma_f32_16x16x32_bf16 a[196:199], v[224:227], v[132:135], a[196:199]
v_accvgpr_read_b32 v214, a186
v_accvgpr_read_b32 v215, a187
v_mfma_f32_16x16x32_bf16 a[196:199], v[228:231], v[148:151], a[196:199]
v_cvt_pk_bf16_f32 v86, v212, v213
v_cvt_pk_bf16_f32 v87, v214, v215
v_mfma_f32_16x16x32_bf16 a[200:203], v[224:227], v[136:139], a[200:203]
ds_read_b64_tr_b16 v[244:245], v250 offset:12288
ds_read_b64_tr_b16 v[246:247], v250 offset:14336
v_mfma_f32_16x16x32_bf16 a[200:203], v[228:231], v[152:155], a[200:203]
buffer_store_dwordx4 v[84:87], v252, s[20:23], s46 offen offset:1024 sc1
v_accvgpr_read_b32 v220, a188
v_mfma_f32_16x16x32_bf16 a[204:207], v[224:227], v[140:143], a[204:207]
v_accvgpr_read_b32 v221, a189
v_accvgpr_read_b32 v222, a190
v_mfma_f32_16x16x32_bf16 a[204:207], v[228:231], v[156:159], a[204:207]
s_waitcnt lgkmcnt(4)
v_accvgpr_read_b32 v223, a191
v_mfma_f32_16x16x32_bf16 a[192:195], v[232:235], v[160:163], a[192:195]
ds_read_b64_tr_b16 v[224:225], v250 offset:45056
ds_read_b64_tr_b16 v[226:227], v250 offset:47104
v_mfma_f32_16x16x32_bf16 a[192:195], v[236:239], v[176:179], a[192:195]
v_cvt_pk_bf16_f32 v118, v220, v221
v_cvt_pk_bf16_f32 v119, v222, v223
v_mfma_f32_16x16x32_bf16 a[196:199], v[232:235], v[164:167], a[196:199]
buffer_store_dwordx4 v[116:119], v252, s[20:23], s47 offen offset:1024 sc1
v_mfma_f32_16x16x32_bf16 a[196:199], v[236:239], v[180:183], a[196:199]
v_mfma_f32_16x16x32_bf16 a[200:203], v[232:235], v[168:171], a[200:203]
ds_read_b64_tr_b16 v[228:229], v250 offset:61440
ds_read_b64_tr_b16 v[230:231], v250 offset:63488
v_mfma_f32_16x16x32_bf16 a[200:203], v[236:239], v[184:187], a[200:203]
v_mfma_f32_16x16x32_bf16 a[204:207], v[232:235], v[172:175], a[204:207]
v_mfma_f32_16x16x32_bf16 a[204:207], v[236:239], v[188:191], a[204:207]
s_waitcnt lgkmcnt(4)
v_mfma_f32_16x16x32_bf16 a[192:195], v[240:243], v[0:3], a[192:195]
ds_read_b64_tr_b16 v[232:233], v13 offset:12288
ds_read_b64_tr_b16 v[234:235], v13 offset:14336
v_mfma_f32_16x16x32_bf16 a[196:199], v[240:243], v[32:35], a[196:199]
v_mfma_f32_16x16x32_bf16 a[200:203], v[240:243], v[64:67], a[200:203]
v_mfma_f32_16x16x32_bf16 a[204:207], v[240:243], v[96:99], a[204:207]
v_mfma_f32_16x16x32_bf16 a[208:211], v[244:247], v[0:3], a[208:211]
ds_read_b64_tr_b16 v[236:237], v13 offset:28672
ds_read_b64_tr_b16 v[238:239], v13 offset:30720
v_mfma_f32_16x16x32_bf16 a[212:215], v[244:247], v[32:35], a[212:215]
v_accvgpr_read_b32 v192, a192
v_accvgpr_read_b32 v193, a193
v_mfma_f32_16x16x32_bf16 a[216:219], v[244:247], v[64:67], a[216:219]
v_accvgpr_read_b32 v194, a194
v_accvgpr_read_b32 v195, a195
v_mfma_f32_16x16x32_bf16 a[220:223], v[244:247], v[96:99], a[220:223]
s_waitcnt lgkmcnt(4)
v_cvt_pk_bf16_f32 v24, v192, v193
v_mfma_f32_16x16x32_bf16 a[208:211], v[224:227], v[4:7], a[208:211]
ds_read_b64_tr_b16 v[240:241], v13 offset:45056
ds_read_b64_tr_b16 v[242:243], v13 offset:47104
v_mfma_f32_16x16x32_bf16 a[208:211], v[228:231], v[8:11], a[208:211]
v_cvt_pk_bf16_f32 v25, v194, v195
v_accvgpr_read_b32 v200, a196
v_mfma_f32_16x16x32_bf16 a[212:215], v[224:227], v[36:39], a[212:215]
v_accvgpr_read_b32 v201, a197
v_accvgpr_read_b32 v202, a198
v_mfma_f32_16x16x32_bf16 a[212:215], v[228:231], v[40:43], a[212:215]
v_accvgpr_read_b32 v203, a199
v_cvt_pk_bf16_f32 v56, v200, v201
v_mfma_f32_16x16x32_bf16 a[216:219], v[224:227], v[68:71], a[216:219]
ds_read_b64_tr_b16 v[244:245], v13 offset:61440
ds_read_b64_tr_b16 v[246:247], v13 offset:63488
v_mfma_f32_16x16x32_bf16 a[216:219], v[228:231], v[72:75], a[216:219]
v_cvt_pk_bf16_f32 v57, v202, v203
v_accvgpr_read_b32 v208, a200
v_mfma_f32_16x16x32_bf16 a[220:223], v[224:227], v[100:103], a[220:223]
v_accvgpr_read_b32 v209, a201
v_accvgpr_read_b32 v210, a202
v_mfma_f32_16x16x32_bf16 a[220:223], v[228:231], v[104:107], a[220:223]
s_waitcnt lgkmcnt(4)
v_accvgpr_read_b32 v211, a203
v_mfma_f32_16x16x32_bf16 a[208:211], v[232:235], v[128:131], a[208:211]
ds_read_b64_tr_b16 v[224:225], v249 offset:45568
ds_read_b64_tr_b16 v[226:227], v249 offset:47616
v_mfma_f32_16x16x32_bf16 a[208:211], v[236:239], v[144:147], a[208:211]
v_cvt_pk_bf16_f32 v88, v208, v209
v_cvt_pk_bf16_f32 v89, v210, v211
v_mfma_f32_16x16x32_bf16 a[212:215], v[232:235], v[132:135], a[212:215]
v_accvgpr_read_b32 v216, a204
v_accvgpr_read_b32 v217, a205
v_mfma_f32_16x16x32_bf16 a[212:215], v[236:239], v[148:151], a[212:215]
v_accvgpr_read_b32 v218, a206
v_accvgpr_read_b32 v219, a207
v_mfma_f32_16x16x32_bf16 a[216:219], v[232:235], v[136:139], a[216:219]
ds_read_b64_tr_b16 v[228:229], v249 offset:61952
ds_read_b64_tr_b16 v[230:231], v249 offset:64000
v_mfma_f32_16x16x32_bf16 a[216:219], v[236:239], v[152:155], a[216:219]
v_cvt_pk_bf16_f32 v120, v216, v217
v_cvt_pk_bf16_f32 v121, v218, v219
v_mfma_f32_16x16x32_bf16 a[220:223], v[232:235], v[140:143], a[220:223]
v_mfma_f32_16x16x32_bf16 a[220:223], v[236:239], v[156:159], a[220:223]
s_waitcnt lgkmcnt(4)
v_mfma_f32_16x16x32_bf16 a[208:211], v[240:243], v[160:163], a[208:211]
ds_read_b64_tr_b16 v[232:233], v12 offset:12800
ds_read_b64_tr_b16 v[234:235], v12 offset:14848
v_mfma_f32_16x16x32_bf16 a[208:211], v[244:247], v[176:179], a[208:211]
v_mfma_f32_16x16x32_bf16 a[212:215], v[240:243], v[164:167], a[212:215]
v_mfma_f32_16x16x32_bf16 a[212:215], v[244:247], v[180:183], a[212:215]
v_mfma_f32_16x16x32_bf16 a[216:219], v[240:243], v[168:171], a[216:219]
ds_read_b64_tr_b16 v[236:237], v12 offset:29184
ds_read_b64_tr_b16 v[238:239], v12 offset:31232
v_mfma_f32_16x16x32_bf16 a[216:219], v[244:247], v[184:187], a[216:219]
v_mfma_f32_16x16x32_bf16 a[220:223], v[240:243], v[172:175], a[220:223]
s_nop 0
v_accvgpr_read_b32 v196, a208
v_accvgpr_read_b32 v197, a209
v_mfma_f32_16x16x32_bf16 a[220:223], v[244:247], v[188:191], a[220:223]
s_waitcnt lgkmcnt(4)
v_accvgpr_read_b32 v198, a210
v_mfma_f32_16x16x32_bf16 a[224:227], v[224:227], v[4:7], a[224:227]
ds_read_b64_tr_b16 v[240:241], v12 offset:45568
ds_read_b64_tr_b16 v[242:243], v12 offset:47616
v_mfma_f32_16x16x32_bf16 a[224:227], v[228:231], v[8:11], a[224:227]
v_accvgpr_read_b32 v199, a211
v_cvt_pk_bf16_f32 v26, v196, v197
v_mfma_f32_16x16x32_bf16 a[228:231], v[224:227], v[36:39], a[228:231]
v_cvt_pk_bf16_f32 v27, v198, v199
buffer_store_dwordx4 v[24:27], v252, s[20:23], s44 offen offset:2048 sc1
v_mfma_f32_16x16x32_bf16 a[228:231], v[228:231], v[40:43], a[228:231]
v_accvgpr_read_b32 v204, a212
v_accvgpr_read_b32 v205, a213
v_mfma_f32_16x16x32_bf16 a[232:235], v[224:227], v[68:71], a[232:235]
ds_read_b64_tr_b16 v[244:245], v12 offset:61952
ds_read_b64_tr_b16 v[246:247], v12 offset:64000
v_mfma_f32_16x16x32_bf16 a[232:235], v[228:231], v[72:75], a[232:235]
v_accvgpr_read_b32 v206, a214
v_accvgpr_read_b32 v207, a215
v_mfma_f32_16x16x32_bf16 a[236:239], v[224:227], v[100:103], a[236:239]
v_cvt_pk_bf16_f32 v58, v204, v205
v_cvt_pk_bf16_f32 v59, v206, v207
v_mfma_f32_16x16x32_bf16 a[236:239], v[228:231], v[104:107], a[236:239]
s_waitcnt lgkmcnt(4)
buffer_store_dwordx4 v[56:59], v252, s[20:23], s45 offen offset:2048 sc1
v_mfma_f32_16x16x32_bf16 a[224:227], v[232:235], v[128:131], a[224:227]
ds_read_b64_tr_b16 v[224:225], v249 offset:12800
ds_read_b64_tr_b16 v[226:227], v249 offset:14848
v_mfma_f32_16x16x32_bf16 a[224:227], v[236:239], v[144:147], a[224:227]
v_accvgpr_read_b32 v212, a216
v_accvgpr_read_b32 v213, a217
v_mfma_f32_16x16x32_bf16 a[228:231], v[232:235], v[132:135], a[228:231]
v_accvgpr_read_b32 v214, a218
v_accvgpr_read_b32 v215, a219
v_mfma_f32_16x16x32_bf16 a[228:231], v[236:239], v[148:151], a[228:231]
v_cvt_pk_bf16_f32 v90, v212, v213
v_cvt_pk_bf16_f32 v91, v214, v215
v_mfma_f32_16x16x32_bf16 a[232:235], v[232:235], v[136:139], a[232:235]
ds_read_b64_tr_b16 v[228:229], v250 offset:12800
ds_read_b64_tr_b16 v[230:231], v250 offset:14848
v_mfma_f32_16x16x32_bf16 a[232:235], v[236:239], v[152:155], a[232:235]
buffer_store_dwordx4 v[88:91], v252, s[20:23], s46 offen offset:2048 sc1
v_accvgpr_read_b32 v220, a220
v_mfma_f32_16x16x32_bf16 a[236:239], v[232:235], v[140:143], a[236:239]
v_accvgpr_read_b32 v221, a221
v_accvgpr_read_b32 v222, a222
v_mfma_f32_16x16x32_bf16 a[236:239], v[236:239], v[156:159], a[236:239]
s_waitcnt lgkmcnt(4)
v_accvgpr_read_b32 v223, a223
v_mfma_f32_16x16x32_bf16 a[224:227], v[240:243], v[160:163], a[224:227]
ds_read_b64_tr_b16 v[232:233], v250 offset:45568
ds_read_b64_tr_b16 v[234:235], v250 offset:47616
v_mfma_f32_16x16x32_bf16 a[224:227], v[244:247], v[176:179], a[224:227]
v_cvt_pk_bf16_f32 v122, v220, v221
v_cvt_pk_bf16_f32 v123, v222, v223
v_mfma_f32_16x16x32_bf16 a[228:231], v[240:243], v[164:167], a[228:231]
buffer_store_dwordx4 v[120:123], v252, s[20:23], s47 offen offset:2048 sc1
v_mfma_f32_16x16x32_bf16 a[228:231], v[244:247], v[180:183], a[228:231]
v_mfma_f32_16x16x32_bf16 a[232:235], v[240:243], v[168:171], a[232:235]
ds_read_b64_tr_b16 v[236:237], v250 offset:61952
ds_read_b64_tr_b16 v[238:239], v250 offset:64000
v_mfma_f32_16x16x32_bf16 a[232:235], v[244:247], v[184:187], a[232:235]
v_mfma_f32_16x16x32_bf16 a[236:239], v[240:243], v[172:175], a[236:239]
v_mfma_f32_16x16x32_bf16 a[236:239], v[244:247], v[188:191], a[236:239]
s_waitcnt lgkmcnt(4)
v_mfma_f32_16x16x32_bf16 a[224:227], v[224:227], v[0:3], a[224:227]
ds_read_b64_tr_b16 v[240:241], v13 offset:12800
ds_read_b64_tr_b16 v[242:243], v13 offset:14848
v_mfma_f32_16x16x32_bf16 a[228:231], v[224:227], v[32:35], a[228:231]
v_mfma_f32_16x16x32_bf16 a[232:235], v[224:227], v[64:67], a[232:235]
v_mfma_f32_16x16x32_bf16 a[236:239], v[224:227], v[96:99], a[236:239]
v_mfma_f32_16x16x32_bf16 a[240:243], v[228:231], v[0:3], a[240:243]
ds_read_b64_tr_b16 v[244:245], v13 offset:29184
ds_read_b64_tr_b16 v[246:247], v13 offset:31232
v_mfma_f32_16x16x32_bf16 a[244:247], v[228:231], v[32:35], a[244:247]
v_accvgpr_read_b32 v192, a224
v_accvgpr_read_b32 v193, a225
v_mfma_f32_16x16x32_bf16 a[248:251], v[228:231], v[64:67], a[248:251]
v_accvgpr_read_b32 v194, a226
v_accvgpr_read_b32 v195, a227
v_mfma_f32_16x16x32_bf16 a[252:255], v[228:231], v[96:99], a[252:255]
s_waitcnt lgkmcnt(4)
v_cvt_pk_bf16_f32 v28, v192, v193
v_mfma_f32_16x16x32_bf16 a[240:243], v[232:235], v[4:7], a[240:243]
ds_read_b64_tr_b16 v[224:225], v13 offset:45568
ds_read_b64_tr_b16 v[226:227], v13 offset:47616
v_mfma_f32_16x16x32_bf16 a[240:243], v[236:239], v[8:11], a[240:243]
v_cvt_pk_bf16_f32 v29, v194, v195
v_accvgpr_read_b32 v200, a228
v_mfma_f32_16x16x32_bf16 a[244:247], v[232:235], v[36:39], a[244:247]
v_accvgpr_read_b32 v201, a229
v_accvgpr_read_b32 v202, a230
v_mfma_f32_16x16x32_bf16 a[244:247], v[236:239], v[40:43], a[244:247]
v_accvgpr_read_b32 v203, a231
v_cvt_pk_bf16_f32 v60, v200, v201
v_mfma_f32_16x16x32_bf16 a[248:251], v[232:235], v[68:71], a[248:251]
ds_read_b64_tr_b16 v[228:229], v13 offset:61952
ds_read_b64_tr_b16 v[230:231], v13 offset:64000
v_mfma_f32_16x16x32_bf16 a[248:251], v[236:239], v[72:75], a[248:251]
v_cvt_pk_bf16_f32 v61, v202, v203
v_accvgpr_read_b32 v208, a232
v_mfma_f32_16x16x32_bf16 a[252:255], v[232:235], v[100:103], a[252:255]
v_accvgpr_read_b32 v209, a233
v_accvgpr_read_b32 v210, a234
v_mfma_f32_16x16x32_bf16 a[252:255], v[236:239], v[104:107], a[252:255]
s_waitcnt lgkmcnt(4)
v_accvgpr_read_b32 v211, a235
v_mfma_f32_16x16x32_bf16 a[240:243], v[240:243], v[128:131], a[240:243]
v_cvt_pk_bf16_f32 v92, v208, v209
v_cvt_pk_bf16_f32 v93, v210, v211
v_mfma_f32_16x16x32_bf16 a[240:243], v[244:247], v[144:147], a[240:243]
v_accvgpr_read_b32 v216, a236
v_accvgpr_read_b32 v217, a237
v_mfma_f32_16x16x32_bf16 a[244:247], v[240:243], v[132:135], a[244:247]
v_accvgpr_read_b32 v218, a238
v_accvgpr_read_b32 v219, a239
v_mfma_f32_16x16x32_bf16 a[244:247], v[244:247], v[148:151], a[244:247]
v_cvt_pk_bf16_f32 v124, v216, v217
v_cvt_pk_bf16_f32 v125, v218, v219
v_mfma_f32_16x16x32_bf16 a[248:251], v[240:243], v[136:139], a[248:251]
v_mfma_f32_16x16x32_bf16 a[248:251], v[244:247], v[152:155], a[248:251]
v_mfma_f32_16x16x32_bf16 a[252:255], v[240:243], v[140:143], a[252:255]
v_mfma_f32_16x16x32_bf16 a[252:255], v[244:247], v[156:159], a[252:255]
s_waitcnt lgkmcnt(0)
v_mfma_f32_16x16x32_bf16 a[240:243], v[224:227], v[160:163], a[240:243]
v_mfma_f32_16x16x32_bf16 a[240:243], v[228:231], v[176:179], a[240:243]
v_mfma_f32_16x16x32_bf16 a[244:247], v[224:227], v[164:167], a[244:247]
v_mfma_f32_16x16x32_bf16 a[244:247], v[228:231], v[180:183], a[244:247]
v_mfma_f32_16x16x32_bf16 a[248:251], v[224:227], v[168:171], a[248:251]
v_mfma_f32_16x16x32_bf16 a[248:251], v[228:231], v[184:187], a[248:251]
v_mfma_f32_16x16x32_bf16 a[252:255], v[224:227], v[172:175], a[252:255]
s_nop 2
v_accvgpr_read_b32 v196, a240
v_accvgpr_read_b32 v197, a241
v_accvgpr_read_b32 v198, a242
v_accvgpr_read_b32 v199, a243
v_mfma_f32_16x16x32_bf16 a[252:255], v[228:231], v[188:191], a[252:255]
v_cvt_pk_bf16_f32 v30, v196, v197
v_cvt_pk_bf16_f32 v31, v198, v199
buffer_store_dwordx4 v[28:31], v252, s[20:23], s44 offen offset:3072 sc1
v_accvgpr_read_b32 v204, a244
v_accvgpr_read_b32 v205, a245
v_accvgpr_read_b32 v206, a246
v_accvgpr_read_b32 v207, a247
v_cvt_pk_bf16_f32 v62, v204, v205
v_cvt_pk_bf16_f32 v63, v206, v207
buffer_store_dwordx4 v[60:63], v252, s[20:23], s45 offen offset:3072 sc1
v_accvgpr_read_b32 v212, a248
v_accvgpr_read_b32 v213, a249
v_accvgpr_read_b32 v214, a250
v_accvgpr_read_b32 v215, a251
v_cvt_pk_bf16_f32 v94, v212, v213
v_cvt_pk_bf16_f32 v95, v214, v215
buffer_store_dwordx4 v[92:95], v252, s[20:23], s46 offen offset:3072 sc1
v_accvgpr_read_b32 v220, a252
v_accvgpr_read_b32 v221, a253
v_accvgpr_read_b32 v222, a254
v_accvgpr_read_b32 v223, a255
v_cvt_pk_bf16_f32 v126, v220, v221
v_cvt_pk_bf16_f32 v127, v222, v223
buffer_store_dwordx4 v[124:127], v252, s[20:23], s47 offen offset:3072 sc1
s_branch L2_chk
L2_chk:
LC_start:
s_cmp_lg_u64 vcc, 0
s_cselect_b32 s98, 1, 0
LC_again:
s_lshl_b32 s48, s38, 7
s_lshl_b32 s49, s38, 7
s_lshl_b32 s50, s38, 7
s_mov_b32 s51, s37
s_cmp_eq_u32 s37, 5
s_cselect_b32 s14, 1, 0
s_cselect_b32 s52, 0x7fff0000, s52
s_cselect_b32 s53, 0x7fff0000, s53
s_cselect_b32 s54, 0x7fff0000, s54
s_cmp_eq_u32 s34, 0
s_cselect_b32 s15, 0x6c00000, s52
s_cselect_b32 s15, s15, 0x7fff0000
LC_common:
s_nop 0
s_bfe_u32 s3, s2, 0x30003
s_lshl_b32 s13, s34, 4
s_or_b32 s13, s13, s3
s_lshl_b32 s13, s13, 11
s_lshr_b32 s101, s3, 1
s_xor_b32 s101, s101, s34
s_lshl_b32 s101, s101, 10
s_add_u32 s101, s101, s100
s_cmp_eq_u32 s14, 1
s_cselect_b32 s13, 0x7fff0000, s13
s_add_u32 s28, s4, 0x7000000
s_addc_u32 s29, s5, 0
s_mov_b32 s30, 0x4e2000
s_mov_b32 s31, 0x00020000
s_lshl_b32 s33, s34, 7
v_bfe_u32 v5, v252, 4, 3
v_lshrrev_b32 v6, 8, v252
v_xor_b32 v5, v5, v6
v_lshrrev_b32 v6, 7, v252
v_lshl_add_u32 v6, v6, 9, s33
v_lshl_add_u32 v5, v5, 4, v6
v_xor_b32 v6, 64, v5
v_add_u32 v6, 0x1000, v6
s_cmp_ge_u32 s99, 60
s_cbranch_scc0 LC_side
LC_sideok:
s_add_u32 m0, s101, 0
s_nop 0
buffer_load_dwordx4 v5, s[28:31], s52 offen sc1 lds
s_add_u32 m0, s101, 4096
s_nop 0
buffer_load_dwordx4 v6, s[28:31], s52 offen sc1 lds
s_add_u32 m0, s101, 8192
s_nop 0
buffer_load_dwordx4 v5, s[28:31], s53 offen sc1 lds
s_add_u32 m0, s101, 12288
s_nop 0
buffer_load_dwordx4 v6, s[28:31], s53 offen sc1 lds
s_add_u32 m0, s101, 16384
s_nop 0
buffer_load_dwordx4 v5, s[28:31], s54 offen sc1 lds
s_add_u32 m0, s101, 20480
s_nop 0
buffer_load_dwordx4 v6, s[28:31], s54 offen sc1 lds
s_xor_b32 s33, s13, 0x0
buffer_load_dwordx4 a[0:3], v252, s[56:59], s33 offen offset:0
buffer_load_dwordx4 a[4:7], v252, s[56:59], s33 offen offset:1024
s_xor_b32 s35, s13, 0x4000
buffer_load_dwordx4 a[64:67], v252, s[56:59], s35 offen offset:0
buffer_load_dwordx4 a[68:71], v252, s[56:59], s35 offen offset:1024
s_xor_b32 s39, s13, 0x800
buffer_load_dwordx4 a[8:11], v252, s[56:59], s39 offen offset:0
buffer_load_dwordx4 a[12:15], v252, s[56:59], s39 offen offset:1024
s_xor_b32 s32, s13, 0x4800
buffer_load_dwordx4 a[72:75], v252, s[56:59], s32 offen offset:0
buffer_load_dwordx4 a[76:79], v252, s[56:59], s32 offen offset:1024
s_lshl_b32 s32, s34, 2
s_add_u32 s32, s32, s100
s_and_b32 s33, s98, 1
v_mov_b32 v42, s32
v_mov_b32 v43, s33
ds_write_b32 v42, v43 offset:24576
v_lshrrev_b32 v0, 4, v252
v_and_b32 v2, 15, v0
v_lshrrev_b32 v3, 4, v0
s_add_u32 s8, s6, 0x0
s_addc_u32 s9, s7, 0
s_mov_b32 s10, 0x4e2000
s_mov_b32 s11, 0x00020000
s_lshl_b32 s55, s34, 13
s_add_u32 s55, s55, 0x21000
s_lshl_b32 s33, s34, 7
v_bfe_u32 v9, v252, 4, 3
v_lshrrev_b32 v1, 7, v252
v_xor_b32 v9, v9, v1
v_lshl_add_u32 v1, v1, 9, s33
v_lshl_add_u32 v9, v9, 4, v1
s_and_b32 s72, s100, 0x8000
s_lshl_b32 s73, s34, 11
s_add_u32 s73, s73, 0xe000
s_xor_b32 s73, s73, s72
v_mov_b32 v4, 0x7fff0000
v_cmp_eq_u32 vcc, 0, v3
v_mov_b32 v1, s52
s_nop 0
v_cndmask_b32 v4, v4, v1, vcc
v_cmp_eq_u32 vcc, 1, v3
v_mov_b32 v1, s53
s_nop 0
v_cndmask_b32 v4, v4, v1, vcc
v_cmp_eq_u32 vcc, 2, v3
v_mov_b32 v1, s54
s_nop 0
v_cndmask_b32 v4, v4, v1, vcc
v_lshl_add_u32 v4, v2, 9, v4
v_lshrrev_b32 v7, 3, v4
s_add_u32 s20, s4, 0x2000000
s_addc_u32 s21, s5, 0
s_mov_b32 s22, 0x22e4000
s_mov_b32 s23, 0x00020000
s_add_u32 s40, s18, 0x0
s_addc_u32 s41, s19, 0
s_mov_b32 s42, 0x4e2000
s_mov_b32 s43, 0x00020000
s_add_u32 s60, s4, 0x7c00000
s_addc_u32 s61, s5, 0
s_mov_b32 s12, 0xffff0000
v_mov_b32 v40, s48
s_lshl_b32 s33, s34, 11
v_add_u32 v10, s33, v252
s_lshl_b32 s32, s3, 10
v_xor_b32 v38, s32, v10
s_xor_b32 s32, s72, 0x8000
v_add_u32 v38, s32, v38
v_add_u32 v15, s32, v252
v_xor_b32 v39, 0x400, v38
v_lshrrev_b32 v1, 1, v2
v_xor_b32 v1, v1, v3
v_lshrrev_b32 v11, 3, v2
v_lshlrev_b32 v11, 12, v11
v_lshl_add_u32 v11, v1, 4, v11
v_and_b32 v1, 7, v2
v_lshl_add_u32 v11, v1, 7, v11
s_and_b32 s32, s3, 1
s_lshl_b32 s32, s32, 6
v_xor_b32 v11, s32, v11
v_add_u32 v11, s100, v11
v_xor_b32 v12, 64, v11
s_lshl_b32 s33, s34, 12
s_add_u32 s33, s33, 0x18000
s_xor_b32 s33, s33, s72
v_lshl_add_u32 v13, v0, 6, s33
s_lshl_b32 s32, s51, 2
s_add_u32 s33, s33, s32
v_lshl_add_u32 v14, v2, 6, s33
v_xor_b32 v1, v1, v3
v_lshlrev_b32 v1, 4, v1
v_lshl_add_u32 v1, v2, 7, v1
v_add_u32 v32, s55, v1
v_xor_b32 v33, 64, v32
v_add_u32 v35, s73, v1
v_xor_b32 v36, 64, v35
v_add_u32 v34, s55, v252
v_add_u32 v37, s73, v252
s_lshl_b32 s32, s34, 11
s_xor_b32 s33, s72, 0x1b000
s_cmp_lt_u32 s34, 2
s_cselect_b32 s33, 0x20000, s33
s_cselect_b32 s35, 13, 12
s_add_u32 s32, s32, s33
s_mul_i32 s33, s51, 3
s_add_u32 s39, s33, 0
s_and_b32 s39, s39, 3
s_lshl_b32 s39, s39, s35
s_add_u32 s39, s39, s32
v_add_u32 v44, s39, v252
s_add_u32 s39, s33, 1
s_and_b32 s39, s39, 3
s_lshl_b32 s39, s39, s35
s_add_u32 s39, s39, s32
v_add_u32 v45, s39, v252
s_add_u32 s39, s33, 2
s_and_b32 s39, s39, 3
s_lshl_b32 s39, s39, s35
s_add_u32 s39, s39, s32
v_add_u32 v46, s39, v252
s_add_u32 s32, s51, 1
s_sub_u32 s33, s32, 6
s_cselect_b32 s32, s32, s33
s_mul_i32 s44, s32, 0x600000
s_add_u32 s32, s51, 2
s_sub_u32 s33, s32, 6
s_cselect_b32 s32, s32, s33
s_mul_i32 s45, s32, 0x600000
s_add_u32 s32, s51, 3
s_sub_u32 s33, s32, 6
s_cselect_b32 s32, s32, s33
s_mul_i32 s46, s32, 0x600000
s_add_u32 s32, s51, 4
s_sub_u32 s33, s32, 6
s_cselect_b32 s32, s32, s33
s_mul_i32 s47, s32, 0x600000
v_mov_b32 v41, 1
v_and_b32 v42, 3, v0
v_lshl_add_u32 v42, v42, 2, s100
s_lshl_b32 s33, s34, 12
s_sub_u32 s33, s33, s72
s_cmp_lt_u32 s98, 2
s_cselect_b32 s33, s33, 0x100000
v_add_u32 v1, s33, v252
v_add_u32 v1, 0x1c000, v1
s_waitcnt vmcnt(14)
s_waitcnt lgkmcnt(0)
s_barrier
ds_read_b32 v43, v42 offset:24576
ds_write_b128 v1, v[16:19] offset:0
ds_write_b128 v1, v[20:23] offset:1024
ds_write_b128 v1, v[24:27] offset:2048
ds_write_b128 v1, v[28:31] offset:3072
s_waitcnt lgkmcnt(4)
v_cmp_ne_u32 vcc, 0, v43
s_cbranch_vccnz LC_slow
s_mov_b64 exec, 1
buffer_atomic_add v41, v40, s[56:59], s15 offen
s_mov_b64 exec, -1
s_cmp_eq_u32 s14, 1
s_cbranch_scc1 L2_fin
s_add_u32 s32, s51, 5
s_sub_u32 s33, s32, 6
s_cselect_b32 s32, s32, s33
s_mul_i32 s15, s32, 0x600000
s_add_u32 m0, s73, 0
s_add_u32 s33, s54, 0
buffer_load_dwordx4 v9, s[8:11], s33 offen lds
s_add_u32 m0, s73, 1024
s_add_u32 s35, s54, 4096
buffer_load_dwordx4 v9, s[8:11], s35 offen lds
s_xor_b32 s39, s13, 0x1000
buffer_load_dwordx4 a[16:19], v252, s[56:59], s39 offen offset:0
buffer_load_dwordx4 a[20:23], v252, s[56:59], s39 offen offset:1024
s_xor_b32 s32, s13, 0x5000
buffer_load_dwordx4 a[80:83], v252, s[56:59], s32 offen offset:0
buffer_load_dwordx4 a[84:87], v252, s[56:59], s32 offen offset:1024
s_xor_b32 s33, s13, 0x1800
buffer_load_dwordx4 a[24:27], v252, s[56:59], s33 offen offset:0
buffer_load_dwordx4 a[28:31], v252, s[56:59], s33 offen offset:1024
s_xor_b32 s35, s13, 0x5800
buffer_load_dwordx4 a[88:91], v252, s[56:59], s35 offen offset:0
buffer_load_dwordx4 a[92:95], v252, s[56:59], s35 offen offset:1024
s_xor_b32 s39, s13, 0x2000
buffer_load_dwordx4 a[32:35], v252, s[56:59], s39 offen offset:0
buffer_load_dwordx4 a[36:39], v252, s[56:59], s39 offen offset:1024
ds_read_b128 v[52:55], v32 offset:0
ds_read_b128 v[60:63], v33 offset:0
s_waitcnt lgkmcnt(1)
v_lshlrev_b32 v48, 16, v52
v_and_b32 v49, s12, v52
v_lshlrev_b32 v50, 16, v53
v_and_b32 v51, s12, v53
v_lshlrev_b32 v52, 16, v54
v_and_b32 v53, s12, v54
v_lshlrev_b32 v54, 16, v55
v_and_b32 v55, s12, v55
s_waitcnt lgkmcnt(0)
v_lshlrev_b32 v56, 16, v60
v_and_b32 v57, s12, v60
v_lshlrev_b32 v58, 16, v61
v_and_b32 v59, s12, v61
v_lshlrev_b32 v60, 16, v62
v_and_b32 v61, s12, v62
v_lshlrev_b32 v62, 16, v63
v_and_b32 v63, s12, v63
ds_read_b128 v[68:71], v32 offset:2048
ds_read_b128 v[76:79], v33 offset:2048
s_waitcnt lgkmcnt(1)
v_lshlrev_b32 v64, 16, v68
v_and_b32 v65, s12, v68
v_lshlrev_b32 v66, 16, v69
v_and_b32 v67, s12, v69
v_lshlrev_b32 v68, 16, v70
v_and_b32 v69, s12, v70
v_lshlrev_b32 v70, 16, v71
v_and_b32 v71, s12, v71
s_waitcnt lgkmcnt(0)
v_lshlrev_b32 v72, 16, v76
v_and_b32 v73, s12, v76
v_lshlrev_b32 v74, 16, v77
v_and_b32 v75, s12, v77
v_lshlrev_b32 v76, 16, v78
v_and_b32 v77, s12, v78
v_lshlrev_b32 v78, 16, v79
v_and_b32 v79, s12, v79
s_waitcnt vmcnt(11)
s_xor_b32 s32, s13, 0x6000
buffer_load_dwordx4 a[96:99], v252, s[56:59], s32 offen offset:0
s_waitcnt vmcnt(11)
buffer_load_dwordx4 a[100:103], v252, s[56:59], s32 offen offset:1024
s_waitcnt vmcnt(11)
s_xor_b32 s33, s13, 0x2800
buffer_load_dwordx4 a[40:43], v252, s[56:59], s33 offen offset:0
s_waitcnt vmcnt(11)
buffer_load_dwordx4 a[44:47], v252, s[56:59], s33 offen offset:1024
s_waitcnt vmcnt(11)
s_xor_b32 s35, s13, 0x6800
buffer_load_dwordx4 a[104:107], v252, s[56:59], s35 offen offset:0
s_waitcnt vmcnt(11)
buffer_load_dwordx4 a[108:111], v252, s[56:59], s35 offen offset:1024
s_waitcnt vmcnt(11)
s_mov_b32 s70, 0
s_atomic_add s70, s[60:61], s48 glc
s_waitcnt vmcnt(10)
s_xor_b32 s39, s13, 0x3000
buffer_load_dwordx4 a[48:51], v252, s[56:59], s39 offen offset:0
s_waitcnt vmcnt(10)
buffer_load_dwordx4 a[52:55], v252, s[56:59], s39 offen offset:1024
s_waitcnt vmcnt(10)
s_xor_b32 s32, s13, 0x7000
buffer_load_dwordx4 a[112:115], v252, s[56:59], s32 offen offset:0
s_waitcnt vmcnt(10)
buffer_load_dwordx4 a[116:119], v252, s[56:59], s32 offen offset:1024
s_waitcnt vmcnt(10)
s_xor_b32 s33, s13, 0x3800
buffer_load_dwordx4 a[56:59], v252, s[56:59], s33 offen offset:0
s_waitcnt vmcnt(10)
buffer_load_dwordx4 a[60:63], v252, s[56:59], s33 offen offset:1024
s_waitcnt vmcnt(10)
s_xor_b32 s35, s13, 0x7800
buffer_load_dwordx4 a[120:123], v252, s[56:59], s35 offen offset:0
s_waitcnt vmcnt(10)
buffer_load_dwordx4 a[124:127], v252, s[56:59], s35 offen offset:1024
s_waitcnt lgkmcnt(0)
s_cmp_lt_u32 s70, 6
s_cbranch_scc1 LC_poll
s_cmp_ge_u32 s98, 2
s_cbranch_scc1 LC_poll
LC_got:
buffer_load_dwordx4 v[156:159], v7, s[24:27], 0 offen offset:0 sc1
buffer_load_dwordx4 v[160:163], v7, s[24:27], 0 offen offset:16 sc1
buffer_load_dwordx4 v[164:167], v7, s[24:27], 0 offen offset:32 sc1
s_add_u32 s39, s52, s44
buffer_load_dwordx4 v[168:171], v10, s[20:23], s39 offen offset:0 sc1
s_add_u32 s32, s52, s45
buffer_load_dwordx4 v[172:175], v10, s[20:23], s32 offen offset:0 sc1
s_add_u32 s33, s52, s46
buffer_load_dwordx4 v[176:179], v10, s[20:23], s33 offen offset:0 sc1
s_add_u32 s35, s52, s47
buffer_load_dwordx4 v[180:183], v10, s[20:23], s35 offen offset:0 sc1
s_add_u32 s39, s52, s15
buffer_load_dwordx4 v[184:187], v10, s[20:23], s39 offen offset:0 sc1
s_add_u32 s32, s52, s44
buffer_load_dwordx4 v[188:191], v10, s[20:23], s32 offen offset:1024 sc1
s_add_u32 s33, s52, s45
buffer_load_dwordx4 v[192:195], v10, s[20:23], s33 offen offset:1024 sc1
s_add_u32 s35, s52, s46
buffer_load_dwordx4 v[196:199], v10, s[20:23], s35 offen offset:1024 sc1
s_add_u32 s39, s52, s47
buffer_load_dwordx4 v[200:203], v10, s[20:23], s39 offen offset:1024 sc1
s_add_u32 s32, s52, s15
buffer_load_dwordx4 v[204:207], v10, s[20:23], s32 offen offset:1024 sc1
s_xor_b32 s33, s13, 0x20000
buffer_load_dwordx4 a[128:131], v252, s[56:59], s33 offen offset:0
s_barrier
ds_read_b128 v[132:135], v11 offset:0
ds_read_b128 v[136:139], v11 offset:8192
ds_read_b128 v[140:143], v11 offset:16384
ds_read_b128 v[144:147], v12 offset:0
ds_read_b128 v[148:151], v12 offset:8192
s_waitcnt vmcnt(24)
s_waitcnt vmcnt(23)
s_waitcnt vmcnt(22)
s_waitcnt vmcnt(21)
s_waitcnt vmcnt(20)
s_waitcnt vmcnt(19)
s_waitcnt vmcnt(18)
s_waitcnt vmcnt(17)
s_waitcnt vmcnt(16)
s_waitcnt vmcnt(15)
s_waitcnt vmcnt(14)
s_waitcnt lgkmcnt(4)
v_mfma_f32_16x16x32_bf16 v[48:51], a[0:3], v[132:135], v[48:51]
ds_read_b128 v[152:155], v12 offset:16384
v_mfma_f32_16x16x32_bf16 v[52:55], a[4:7], v[132:135], v[52:55]
v_mfma_f32_16x16x32_bf16 v[56:59], a[64:67], v[132:135], v[56:59]
v_mfma_f32_16x16x32_bf16 v[60:63], a[68:71], v[132:135], v[60:63]
s_waitcnt lgkmcnt(4)
v_mfma_f32_16x16x32_bf16 v[64:67], a[0:3], v[136:139], v[64:67]
ds_read_b128 v[132:135], v11 offset:1024
v_mfma_f32_16x16x32_bf16 v[68:71], a[4:7], v[136:139], v[68:71]
v_mfma_f32_16x16x32_bf16 v[72:75], a[64:67], v[136:139], v[72:75]
v_mfma_f32_16x16x32_bf16 v[76:79], a[68:71], v[136:139], v[76:79]
ds_read_b128 v[84:87], v35 offset:0
ds_read_b128 v[92:95], v36 offset:0
s_waitcnt lgkmcnt(1)
v_lshlrev_b32 v80, 16, v84
v_and_b32 v81, s12, v84
v_lshlrev_b32 v82, 16, v85
v_and_b32 v83, s12, v85
v_lshlrev_b32 v84, 16, v86
v_and_b32 v85, s12, v86
v_lshlrev_b32 v86, 16, v87
v_and_b32 v87, s12, v87
s_waitcnt lgkmcnt(0)
v_lshlrev_b32 v88, 16, v92
v_and_b32 v89, s12, v92
v_lshlrev_b32 v90, 16, v93
v_and_b32 v91, s12, v93
v_lshlrev_b32 v92, 16, v94
v_and_b32 v93, s12, v94
v_lshlrev_b32 v94, 16, v95
v_and_b32 v95, s12, v95
v_mfma_f32_16x16x32_bf16 v[80:83], a[0:3], v[140:143], v[80:83]
ds_read_b128 v[136:139], v11 offset:9216
v_mfma_f32_16x16x32_bf16 v[84:87], a[4:7], v[140:143], v[84:87]
v_mfma_f32_16x16x32_bf16 v[88:91], a[64:67], v[140:143], v[88:91]
v_mfma_f32_16x16x32_bf16 v[92:95], a[68:71], v[140:143], v[92:95]
v_mfma_f32_16x16x32_bf16 v[48:51], a[8:11], v[144:147], v[48:51]
ds_read_b128 v[140:143], v11 offset:17408
v_mfma_f32_16x16x32_bf16 v[52:55], a[12:15], v[144:147], v[52:55]
v_mfma_f32_16x16x32_bf16 v[56:59], a[72:75], v[144:147], v[56:59]
v_mfma_f32_16x16x32_bf16 v[60:63], a[76:79], v[144:147], v[60:63]
v_mfma_f32_16x16x32_bf16 v[64:67], a[8:11], v[148:151], v[64:67]
ds_read_b128 v[144:147], v12 offset:1024
v_mfma_f32_16x16x32_bf16 v[68:71], a[12:15], v[148:151], v[68:71]
v_mfma_f32_16x16x32_bf16 v[72:75], a[72:75], v[148:151], v[72:75]
v_mfma_f32_16x16x32_bf16 v[76:79], a[76:79], v[148:151], v[76:79]
v_mfma_f32_16x16x32_bf16 v[80:83], a[8:11], v[152:155], v[80:83]
ds_read_b128 v[148:151], v12 offset:9216
v_mfma_f32_16x16x32_bf16 v[84:87], a[12:15], v[152:155], v[84:87]
v_mfma_f32_16x16x32_bf16 v[88:91], a[72:75], v[152:155], v[88:91]
v_mfma_f32_16x16x32_bf16 v[92:95], a[76:79], v[152:155], v[92:95]
v_mfma_f32_16x16x32_bf16 v[48:51], a[16:19], v[132:135], v[48:51]
ds_read_b128 v[152:155], v12 offset:17408
v_mfma_f32_16x16x32_bf16 v[52:55], a[20:23], v[132:135], v[52:55]
v_mfma_f32_16x16x32_bf16 v[56:59], a[80:83], v[132:135], v[56:59]
v_mfma_f32_16x16x32_bf16 v[60:63], a[84:87], v[132:135], v[60:63]
s_waitcnt lgkmcnt(4)
v_mfma_f32_16x16x32_bf16 v[64:67], a[16:19], v[136:139], v[64:67]
ds_read_b128 v[132:135], v11 offset:2048
v_mfma_f32_16x16x32_bf16 v[68:71], a[20:23], v[136:139], v[68:71]
v_mfma_f32_16x16x32_bf16 v[72:75], a[80:83], v[136:139], v[72:75]
v_mfma_f32_16x16x32_bf16 v[76:79], a[84:87], v[136:139], v[76:79]
s_waitcnt lgkmcnt(4)
v_mfma_f32_16x16x32_bf16 v[80:83], a[16:19], v[140:143], v[80:83]
ds_read_b128 v[136:139], v11 offset:10240
v_mfma_f32_16x16x32_bf16 v[84:87], a[20:23], v[140:143], v[84:87]
v_mfma_f32_16x16x32_bf16 v[88:91], a[80:83], v[140:143], v[88:91]
v_mfma_f32_16x16x32_bf16 v[92:95], a[84:87], v[140:143], v[92:95]
s_waitcnt lgkmcnt(4)
v_mfma_f32_16x16x32_bf16 v[48:51], a[24:27], v[144:147], v[48:51]
ds_read_b128 v[140:143], v11 offset:18432
v_mfma_f32_16x16x32_bf16 v[52:55], a[28:31], v[144:147], v[52:55]
v_mfma_f32_16x16x32_bf16 v[56:59], a[88:91], v[144:147], v[56:59]
v_mfma_f32_16x16x32_bf16 v[60:63], a[92:95], v[144:147], v[60:63]
s_waitcnt lgkmcnt(4)
v_mfma_f32_16x16x32_bf16 v[64:67], a[24:27], v[148:151], v[64:67]
ds_read_b128 v[144:147], v12 offset:2048
v_mfma_f32_16x16x32_bf16 v[68:71], a[28:31], v[148:151], v[68:71]
v_mfma_f32_16x16x32_bf16 v[72:75], a[88:91], v[148:151], v[72:75]
v_mfma_f32_16x16x32_bf16 v[76:79], a[92:95], v[148:151], v[76:79]
s_waitcnt lgkmcnt(4)
v_mfma_f32_16x16x32_bf16 v[80:83], a[24:27], v[152:155], v[80:83]
ds_read_b128 v[148:151], v12 offset:10240
v_mfma_f32_16x16x32_bf16 v[84:87], a[28:31], v[152:155], v[84:87]
v_mfma_f32_16x16x32_bf16 v[88:91], a[88:91], v[152:155], v[88:91]
v_mfma_f32_16x16x32_bf16 v[92:95], a[92:95], v[152:155], v[92:95]
s_waitcnt lgkmcnt(4)
v_mfma_f32_16x16x32_bf16 v[48:51], a[32:35], v[132:135], v[48:51]
ds_read_b128 v[152:155], v12 offset:18432
v_mfma_f32_16x16x32_bf16 v[52:55], a[36:39], v[132:135], v[52:55]
v_mfma_f32_16x16x32_bf16 v[56:59], a[96:99], v[132:135], v[56:59]
v_mfma_f32_16x16x32_bf16 v[60:63], a[100:103], v[132:135], v[60:63]
s_waitcnt lgkmcnt(4)
v_mfma_f32_16x16x32_bf16 v[64:67], a[32:35], v[136:139], v[64:67]
ds_read_b128 v[132:135], v11 offset:3072
v_mfma_f32_16x16x32_bf16 v[68:71], a[36:39], v[136:139], v[68:71]
v_mfma_f32_16x16x32_bf16 v[72:75], a[96:99], v[136:139], v[72:75]
v_mfma_f32_16x16x32_bf16 v[76:79], a[100:103], v[136:139], v[76:79]
s_waitcnt lgkmcnt(4)
v_mfma_f32_16x16x32_bf16 v[80:83], a[32:35], v[140:143], v[80:83]
ds_read_b128 v[136:139], v11 offset:11264
v_mfma_f32_16x16x32_bf16 v[84:87], a[36:39], v[140:143], v[84:87]
v_mfma_f32_16x16x32_bf16 v[88:91], a[96:99], v[140:143], v[88:91]
v_mfma_f32_16x16x32_bf16 v[92:95], a[100:103], v[140:143], v[92:95]
s_waitcnt lgkmcnt(4)
v_mfma_f32_16x16x32_bf16 v[48:51], a[40:43], v[144:147], v[48:51]
ds_read_b128 v[140:143], v11 offset:19456
v_mfma_f32_16x16x32_bf16 v[52:55], a[44:47], v[144:147], v[52:55]
v_mfma_f32_16x16x32_bf16 v[56:59], a[104:107], v[144:147], v[56:59]
v_mfma_f32_16x16x32_bf16 v[60:63], a[108:111], v[144:147], v[60:63]
s_waitcnt lgkmcnt(4)
v_mfma_f32_16x16x32_bf16 v[64:67], a[40:43], v[148:151], v[64:67]
ds_read_b128 v[144:147], v12 offset:3072
v_mfma_f32_16x16x32_bf16 v[68:71], a[44:47], v[148:151], v[68:71]
v_mfma_f32_16x16x32_bf16 v[72:75], a[104:107], v[148:151], v[72:75]
v_mfma_f32_16x16x32_bf16 v[76:79], a[108:111], v[148:151], v[76:79]
s_waitcnt lgkmcnt(4)
v_mfma_f32_16x16x32_bf16 v[80:83], a[40:43], v[152:155], v[80:83]
ds_read_b128 v[148:151], v12 offset:11264
v_mfma_f32_16x16x32_bf16 v[84:87], a[44:47], v[152:155], v[84:87]
v_mfma_f32_16x16x32_bf16 v[88:91], a[104:107], v[152:155], v[88:91]
v_mfma_f32_16x16x32_bf16 v[92:95], a[108:111], v[152:155], v[92:95]
s_waitcnt lgkmcnt(4)
v_mfma_f32_16x16x32_bf16 v[48:51], a[48:51], v[132:135], v[48:51]
ds_read_b128 v[152:155], v12 offset:19456
v_mfma_f32_16x16x32_bf16 v[52:55], a[52:55], v[132:135], v[52:55]
v_mfma_f32_16x16x32_bf16 v[56:59], a[112:115], v[132:135], v[56:59]
v_mfma_f32_16x16x32_bf16 v[60:63], a[116:119], v[132:135], v[60:63]
s_waitcnt lgkmcnt(4)
v_mfma_f32_16x16x32_bf16 v[64:67], a[48:51], v[136:139], v[64:67]
v_mfma_f32_16x16x32_bf16 v[68:71], a[52:55], v[136:139], v[68:71]
v_mfma_f32_16x16x32_bf16 v[72:75], a[112:115], v[136:139], v[72:75]
v_mfma_f32_16x16x32_bf16 v[76:79], a[116:119], v[136:139], v[76:79]
s_waitcnt lgkmcnt(3)
v_mfma_f32_16x16x32_bf16 v[80:83], a[48:51], v[140:143], v[80:83]
v_mfma_f32_16x16x32_bf16 v[84:87], a[52:55], v[140:143], v[84:87]
v_mfma_f32_16x16x32_bf16 v[88:91], a[112:115], v[140:143], v[88:91]
v_mfma_f32_16x16x32_bf16 v[92:95], a[116:119], v[140:143], v[92:95]
s_waitcnt lgkmcnt(2)
v_mfma_f32_16x16x32_bf16 v[48:51], a[56:59], v[144:147], v[48:51]
v_mfma_f32_16x16x32_bf16 v[52:55], a[60:63], v[144:147], v[52:55]
v_mfma_f32_16x16x32_bf16 v[56:59], a[120:123], v[144:147], v[56:59]
v_mfma_f32_16x16x32_bf16 v[60:63], a[124:127], v[144:147], v[60:63]
s_waitcnt lgkmcnt(1)
v_mfma_f32_16x16x32_bf16 v[64:67], a[56:59], v[148:151], v[64:67]
v_mfma_f32_16x16x32_bf16 v[68:71], a[60:63], v[148:151], v[68:71]
v_mfma_f32_16x16x32_bf16 v[72:75], a[120:123], v[148:151], v[72:75]
v_mfma_f32_16x16x32_bf16 v[76:79], a[124:127], v[148:151], v[76:79]
s_waitcnt lgkmcnt(0)
v_mfma_f32_16x16x32_bf16 v[80:83], a[56:59], v[152:155], v[80:83]
v_mfma_f32_16x16x32_bf16 v[84:87], a[60:63], v[152:155], v[84:87]
v_mfma_f32_16x16x32_bf16 v[88:91], a[120:123], v[152:155], v[88:91]
v_mfma_f32_16x16x32_bf16 v[92:95], a[124:127], v[152:155], v[92:95]
s_waitcnt vmcnt(13)
buffer_load_dwordx4 a[132:135], v252, s[56:59], s33 offen offset:1024
s_waitcnt vmcnt(13)
s_xor_b32 s35, s13, 0x24000
buffer_load_dwordx4 a[192:195], v252, s[56:59], s35 offen offset:0
s_waitcnt vmcnt(13)
buffer_load_dwordx4 a[196:199], v252, s[56:59], s35 offen offset:1024
v_max3_f32 v1, v156, v158, v160
v_max3_f32 v117, v162, v164, v166
v_max_f32 v1, v1, v117
v_sub_f32 v156, v156, v1
v_sub_f32 v158, v158, v1
v_sub_f32 v160, v160, v1
v_sub_f32 v162, v162, v1
v_sub_f32 v164, v164, v1
v_sub_f32 v166, v166, v1
v_exp_f32 v156, v156
v_exp_f32 v158, v158
v_exp_f32 v160, v160
v_exp_f32 v162, v162
v_exp_f32 v164, v164
v_exp_f32 v166, v166
s_nop 0
v_mul_f32 v1, v156, v157
v_fmac_f32 v1, v158, v159
v_fmac_f32 v1, v160, v161
v_fmac_f32 v1, v162, v163
v_fmac_f32 v1, v164, v165
v_fmac_f32 v1, v166, v167
v_rcp_f32 v1, v1
s_nop 0
v_mul_f32 v108, v156, v1
v_mul_f32 v109, v158, v1
v_mul_f32 v110, v160, v1
v_mul_f32 v111, v162, v1
v_mul_f32 v112, v164, v1
v_mul_f32 v113, v166, v1
v_mul_f32 v114, v156, v1
v_mul_f32 v115, v158, v1
ds_write_b128 v13, v[108:111]
ds_write_b128 v13, v[112:115] offset:16
ds_write_b64 v13, v[110:111] offset:32
ds_write_b64 v13, v[112:113] offset:40
ds_read2_b32 v[100:101], v14 offset0:1 offset1:2
ds_read2_b32 v[102:103], v14 offset0:3 offset1:4
ds_read2_b32 v[104:105], v14 offset0:5 offset1:6
v_add_u32 v14, 0x400, v14
s_waitcnt vmcnt(13)
s_xor_b32 s39, s13, 0x20800
buffer_load_dwordx4 a[136:139], v252, s[56:59], s39 offen offset:0
ds_read_b128 v[96:99], v44 offset:0
s_waitcnt lgkmcnt(1)
v_lshlrev_b32 v118, 16, v168
v_and_b32 v119, s12, v168
v_mul_f32 v108, v118, v100
v_mul_f32 v109, v119, v100
v_lshlrev_b32 v120, 16, v169
v_and_b32 v121, s12, v169
v_mul_f32 v110, v120, v100
v_mul_f32 v111, v121, v100
v_lshlrev_b32 v122, 16, v170
v_and_b32 v123, s12, v170
v_mul_f32 v112, v122, v100
v_mul_f32 v113, v123, v100
v_lshlrev_b32 v116, 16, v171
v_and_b32 v117, s12, v171
v_mul_f32 v114, v116, v100
v_mul_f32 v115, v117, v100
s_waitcnt vmcnt(13)
buffer_load_dwordx4 a[140:143], v252, s[56:59], s39 offen offset:1024
v_lshlrev_b32 v118, 16, v172
v_and_b32 v119, s12, v172
v_fmac_f32 v108, v118, v101
v_fmac_f32 v109, v119, v101
v_lshlrev_b32 v120, 16, v173
v_and_b32 v121, s12, v173
v_fmac_f32 v110, v120, v101
v_fmac_f32 v111, v121, v101
v_lshlrev_b32 v122, 16, v174
v_and_b32 v123, s12, v174
v_fmac_f32 v112, v122, v101
v_fmac_f32 v113, v123, v101
v_lshlrev_b32 v116, 16, v175
v_and_b32 v117, s12, v175
v_fmac_f32 v114, v116, v101
v_fmac_f32 v115, v117, v101
s_waitcnt lgkmcnt(0)
v_lshlrev_b32 v118, 16, v96
v_and_b32 v119, s12, v96
v_fmac_f32 v108, v118, v105
v_fmac_f32 v109, v119, v105
v_lshlrev_b32 v120, 16, v97
v_and_b32 v121, s12, v97
v_fmac_f32 v110, v120, v105
v_fmac_f32 v111, v121, v105
v_lshlrev_b32 v122, 16, v98
v_and_b32 v123, s12, v98
v_fmac_f32 v112, v122, v105
v_fmac_f32 v113, v123, v105
v_lshlrev_b32 v116, 16, v99
v_and_b32 v117, s12, v99
v_fmac_f32 v114, v116, v105
v_fmac_f32 v115, v117, v105
s_waitcnt vmcnt(13)
s_xor_b32 s32, s13, 0x24800
buffer_load_dwordx4 a[200:203], v252, s[56:59], s32 offen offset:0
v_lshlrev_b32 v118, 16, v176
v_and_b32 v119, s12, v176
v_fmac_f32 v108, v118, v102
v_fmac_f32 v109, v119, v102
v_lshlrev_b32 v120, 16, v177
v_and_b32 v121, s12, v177
v_fmac_f32 v110, v120, v102
v_fmac_f32 v111, v121, v102
v_lshlrev_b32 v122, 16, v178
v_and_b32 v123, s12, v178
v_fmac_f32 v112, v122, v102
v_fmac_f32 v113, v123, v102
v_lshlrev_b32 v116, 16, v179
v_and_b32 v117, s12, v179
v_fmac_f32 v114, v116, v102
v_fmac_f32 v115, v117, v102
s_waitcnt vmcnt(13)
buffer_load_dwordx4 a[204:207], v252, s[56:59], s32 offen offset:1024
v_lshlrev_b32 v118, 16, v180
v_and_b32 v119, s12, v180
v_fmac_f32 v108, v118, v103
v_fmac_f32 v109, v119, v103
v_lshlrev_b32 v120, 16, v181
v_and_b32 v121, s12, v181
v_fmac_f32 v110, v120, v103
v_fmac_f32 v111, v121, v103
v_lshlrev_b32 v122, 16, v182
v_and_b32 v123, s12, v182
v_fmac_f32 v112, v122, v103
v_fmac_f32 v113, v123, v103
v_lshlrev_b32 v116, 16, v183
v_and_b32 v117, s12, v183
v_fmac_f32 v114, v116, v103
v_fmac_f32 v115, v117, v103
s_waitcnt vmcnt(13)
s_add_u32 s33, s53, s44
buffer_load_dwordx4 v[208:211], v10, s[20:23], s33 offen offset:0 sc1
v_lshlrev_b32 v118, 16, v184
v_and_b32 v119, s12, v184
v_fmac_f32 v108, v118, v104
v_fmac_f32 v109, v119, v104
v_lshlrev_b32 v120, 16, v185
v_and_b32 v121, s12, v185
v_fmac_f32 v110, v120, v104
v_fmac_f32 v111, v121, v104
v_lshlrev_b32 v122, 16, v186
v_and_b32 v123, s12, v186
v_fmac_f32 v112, v122, v104
v_fmac_f32 v113, v123, v104
v_lshlrev_b32 v116, 16, v187
v_and_b32 v117, s12, v187
v_fmac_f32 v114, v116, v104
v_fmac_f32 v115, v117, v104
v_cvt_pk_bf16_f32 v116, v108, v109
v_cvt_pk_bf16_f32 v117, v110, v111
v_cvt_pk_bf16_f32 v118, v112, v113
v_cvt_pk_bf16_f32 v119, v114, v115
ds_write_b128 v38, v[116:119] offset:0
s_waitcnt vmcnt(13)
s_xor_b32 s35, s13, 0x21000
buffer_load_dwordx4 a[144:147], v252, s[56:59], s35 offen offset:0
ds_read_b128 v[96:99], v44 offset:1024
v_lshlrev_b32 v118, 16, v188
v_and_b32 v119, s12, v188
v_mul_f32 v108, v118, v100
v_mul_f32 v109, v119, v100
v_lshlrev_b32 v120, 16, v189
v_and_b32 v121, s12, v189
v_mul_f32 v110, v120, v100
v_mul_f32 v111, v121, v100
v_lshlrev_b32 v122, 16, v190
v_and_b32 v123, s12, v190
v_mul_f32 v112, v122, v100
v_mul_f32 v113, v123, v100
v_lshlrev_b32 v116, 16, v191
v_and_b32 v117, s12, v191
v_mul_f32 v114, v116, v100
v_mul_f32 v115, v117, v100
s_waitcnt vmcnt(13)
buffer_load_dwordx4 a[148:151], v252, s[56:59], s35 offen offset:1024
v_lshlrev_b32 v118, 16, v192
v_and_b32 v119, s12, v192
v_fmac_f32 v108, v118, v101
v_fmac_f32 v109, v119, v101
v_lshlrev_b32 v120, 16, v193
v_and_b32 v121, s12, v193
v_fmac_f32 v110, v120, v101
v_fmac_f32 v111, v121, v101
v_lshlrev_b32 v122, 16, v194
v_and_b32 v123, s12, v194
v_fmac_f32 v112, v122, v101
v_fmac_f32 v113, v123, v101
v_lshlrev_b32 v116, 16, v195
v_and_b32 v117, s12, v195
v_fmac_f32 v114, v116, v101
v_fmac_f32 v115, v117, v101
s_waitcnt lgkmcnt(0)
v_lshlrev_b32 v118, 16, v96
v_and_b32 v119, s12, v96
v_fmac_f32 v108, v118, v105
v_fmac_f32 v109, v119, v105
v_lshlrev_b32 v120, 16, v97
v_and_b32 v121, s12, v97
v_fmac_f32 v110, v120, v105
v_fmac_f32 v111, v121, v105
v_lshlrev_b32 v122, 16, v98
v_and_b32 v123, s12, v98
v_fmac_f32 v112, v122, v105
v_fmac_f32 v113, v123, v105
v_lshlrev_b32 v116, 16, v99
v_and_b32 v117, s12, v99
v_fmac_f32 v114, v116, v105
v_fmac_f32 v115, v117, v105
s_waitcnt vmcnt(13)
s_add_u32 s39, s53, s45
buffer_load_dwordx4 v[212:215], v10, s[20:23], s39 offen offset:0 sc1
v_lshlrev_b32 v118, 16, v196
v_and_b32 v119, s12, v196
v_fmac_f32 v108, v118, v102
v_fmac_f32 v109, v119, v102
v_lshlrev_b32 v120, 16, v197
v_and_b32 v121, s12, v197
v_fmac_f32 v110, v120, v102
v_fmac_f32 v111, v121, v102
v_lshlrev_b32 v122, 16, v198
v_and_b32 v123, s12, v198
v_fmac_f32 v112, v122, v102
v_fmac_f32 v113, v123, v102
v_lshlrev_b32 v116, 16, v199
v_and_b32 v117, s12, v199
v_fmac_f32 v114, v116, v102
v_fmac_f32 v115, v117, v102
s_waitcnt vmcnt(13)
s_xor_b32 s32, s13, 0x25000
buffer_load_dwordx4 a[208:211], v252, s[56:59], s32 offen offset:0
v_lshlrev_b32 v118, 16, v200
v_and_b32 v119, s12, v200
v_fmac_f32 v108, v118, v103
v_fmac_f32 v109, v119, v103
v_lshlrev_b32 v120, 16, v201
v_and_b32 v121, s12, v201
v_fmac_f32 v110, v120, v103
v_fmac_f32 v111, v121, v103
v_lshlrev_b32 v122, 16, v202
v_and_b32 v123, s12, v202
v_fmac_f32 v112, v122, v103
v_fmac_f32 v113, v123, v103
v_lshlrev_b32 v116, 16, v203
v_and_b32 v117, s12, v203
v_fmac_f32 v114, v116, v103
v_fmac_f32 v115, v117, v103
s_waitcnt vmcnt(13)
buffer_load_dwordx4 a[212:215], v252, s[56:59], s32 offen offset:1024
v_lshlrev_b32 v118, 16, v204
v_and_b32 v119, s12, v204
v_fmac_f32 v108, v118, v104
v_fmac_f32 v109, v119, v104
v_lshlrev_b32 v120, 16, v205
v_and_b32 v121, s12, v205
v_fmac_f32 v110, v120, v104
v_fmac_f32 v111, v121, v104
v_lshlrev_b32 v122, 16, v206
v_and_b32 v123, s12, v206
v_fmac_f32 v112, v122, v104
v_fmac_f32 v113, v123, v104
v_lshlrev_b32 v116, 16, v207
v_and_b32 v117, s12, v207
v_fmac_f32 v114, v116, v104
v_fmac_f32 v115, v117, v104
ds_read2_b32 v[100:101], v14 offset0:1 offset1:2
ds_read2_b32 v[102:103], v14 offset0:3 offset1:4
ds_read2_b32 v[104:105], v14 offset0:5 offset1:6
v_add_u32 v14, 0x400, v14
v_cvt_pk_bf16_f32 v116, v108, v109
v_cvt_pk_bf16_f32 v117, v110, v111
v_cvt_pk_bf16_f32 v118, v112, v113
v_cvt_pk_bf16_f32 v119, v114, v115
ds_write_b128 v39, v[116:119] offset:0
s_waitcnt vmcnt(13)
s_add_u32 s33, s53, s46
buffer_load_dwordx4 v[216:219], v10, s[20:23], s33 offen offset:0 sc1
s_waitcnt vmcnt(13)
s_xor_b32 s35, s13, 0x21800
buffer_load_dwordx4 a[152:155], v252, s[56:59], s35 offen offset:0
s_waitcnt vmcnt(13)
buffer_load_dwordx4 a[156:159], v252, s[56:59], s35 offen offset:1024
s_waitcnt vmcnt(13)
s_add_u32 s39, s53, s47
buffer_load_dwordx4 v[220:223], v10, s[20:23], s39 offen offset:0 sc1
s_waitcnt vmcnt(13)
s_xor_b32 s32, s13, 0x25800
buffer_load_dwordx4 a[216:219], v252, s[56:59], s32 offen offset:0
s_waitcnt vmcnt(13)
buffer_load_dwordx4 a[220:223], v252, s[56:59], s32 offen offset:1024
s_waitcnt vmcnt(13)
s_add_u32 s33, s53, s15
buffer_load_dwordx4 v[224:227], v10, s[20:23], s33 offen offset:0 sc1
s_waitcnt vmcnt(13)
s_xor_b32 s35, s13, 0x22000
buffer_load_dwordx4 a[160:163], v252, s[56:59], s35 offen offset:0
s_waitcnt lgkmcnt(0)
s_barrier
ds_read_b128 v[132:135], v15 offset:0
ds_read_b128 v[136:139], v15 offset:1024
ds_read_b128 v[140:143], v15 offset:2048
ds_read_b128 v[144:147], v15 offset:3072
ds_read_b128 v[148:151], v15 offset:4096
s_waitcnt lgkmcnt(4)
v_mfma_f32_16x16x32_bf16 v[48:51], a[128:131], v[132:135], v[48:51]
ds_read_b128 v[152:155], v15 offset:5120
v_mfma_f32_16x16x32_bf16 v[52:55], a[132:135], v[132:135], v[52:55]
v_mfma_f32_16x16x32_bf16 v[56:59], a[192:195], v[132:135], v[56:59]
v_mfma_f32_16x16x32_bf16 v[60:63], a[196:199], v[132:135], v[60:63]
s_waitcnt vmcnt(13)
buffer_load_dwordx4 a[164:167], v252, s[56:59], s35 offen offset:1024
s_waitcnt lgkmcnt(4)
v_mfma_f32_16x16x32_bf16 v[48:51], a[136:139], v[136:139], v[48:51]
ds_read_b128 v[132:135], v15 offset:6144
ds_read_b128 v[96:99], v45 offset:0
v_lshlrev_b32 v118, 16, v208
v_and_b32 v119, s12, v208
v_mfma_f32_16x16x32_bf16 v[52:55], a[140:143], v[136:139], v[52:55]
v_mul_f32 v108, v118, v100
v_mul_f32 v109, v119, v100
v_lshlrev_b32 v120, 16, v209
v_mfma_f32_16x16x32_bf16 v[56:59], a[200:203], v[136:139], v[56:59]
v_and_b32 v121, s12, v209
v_mul_f32 v110, v120, v100
v_mul_f32 v111, v121, v100
v_mfma_f32_16x16x32_bf16 v[60:63], a[204:207], v[136:139], v[60:63]
v_lshlrev_b32 v122, 16, v210
v_and_b32 v123, s12, v210
v_mul_f32 v112, v122, v100
v_mul_f32 v113, v123, v100
v_lshlrev_b32 v116, 16, v211
v_and_b32 v117, s12, v211
v_mul_f32 v114, v116, v100
v_mul_f32 v115, v117, v100
s_waitcnt vmcnt(13)
s_add_u32 s39, s53, s44
buffer_load_dwordx4 v[228:231], v10, s[20:23], s39 offen offset:1024 sc1
s_waitcnt vmcnt(13)
s_xor_b32 s32, s13, 0x26000
buffer_load_dwordx4 a[224:227], v252, s[56:59], s32 offen offset:0
s_waitcnt vmcnt(13)
buffer_load_dwordx4 a[228:231], v252, s[56:59], s32 offen offset:1024
v_lshlrev_b32 v118, 16, v212
v_and_b32 v119, s12, v212
v_fmac_f32 v108, v118, v101
v_fmac_f32 v109, v119, v101
v_lshlrev_b32 v120, 16, v213
v_and_b32 v121, s12, v213
v_fmac_f32 v110, v120, v101
v_fmac_f32 v111, v121, v101
v_lshlrev_b32 v122, 16, v214
v_and_b32 v123, s12, v214
v_fmac_f32 v112, v122, v101
v_fmac_f32 v113, v123, v101
v_lshlrev_b32 v116, 16, v215
v_and_b32 v117, s12, v215
v_fmac_f32 v114, v116, v101
v_fmac_f32 v115, v117, v101
s_waitcnt lgkmcnt(0)
v_lshlrev_b32 v118, 16, v96
v_and_b32 v119, s12, v96
v_fmac_f32 v108, v118, v105
v_fmac_f32 v109, v119, v105
v_lshlrev_b32 v120, 16, v97
v_and_b32 v121, s12, v97
v_fmac_f32 v110, v120, v105
v_fmac_f32 v111, v121, v105
v_lshlrev_b32 v122, 16, v98
v_and_b32 v123, s12, v98
v_fmac_f32 v112, v122, v105
v_fmac_f32 v113, v123, v105
v_lshlrev_b32 v116, 16, v99
v_and_b32 v117, s12, v99
v_fmac_f32 v114, v116, v105
v_fmac_f32 v115, v117, v105
s_waitcnt vmcnt(13)
s_add_u32 s33, s53, s45
buffer_load_dwordx4 v[232:235], v10, s[20:23], s33 offen offset:1024 sc1
s_waitcnt vmcnt(13)
s_xor_b32 s35, s13, 0x22800
buffer_load_dwordx4 a[168:171], v252, s[56:59], s35 offen offset:0
v_mfma_f32_16x16x32_bf16 v[48:51], a[144:147], v[140:143], v[48:51]
v_mfma_f32_16x16x32_bf16 v[52:55], a[148:151], v[140:143], v[52:55]
v_mfma_f32_16x16x32_bf16 v[56:59], a[208:211], v[140:143], v[56:59]
v_mfma_f32_16x16x32_bf16 v[60:63], a[212:215], v[140:143], v[60:63]
s_waitcnt vmcnt(13)
buffer_load_dwordx4 a[172:175], v252, s[56:59], s35 offen offset:1024
v_lshlrev_b32 v118, 16, v216
v_and_b32 v119, s12, v216
v_fmac_f32 v108, v118, v102
v_fmac_f32 v109, v119, v102
v_lshlrev_b32 v120, 16, v217
v_and_b32 v121, s12, v217
v_fmac_f32 v110, v120, v102
v_fmac_f32 v111, v121, v102
v_lshlrev_b32 v122, 16, v218
v_and_b32 v123, s12, v218
v_fmac_f32 v112, v122, v102
v_fmac_f32 v113, v123, v102
v_lshlrev_b32 v116, 16, v219
v_and_b32 v117, s12, v219
v_fmac_f32 v114, v116, v102
v_fmac_f32 v115, v117, v102
s_waitcnt vmcnt(13)
s_add_u32 s39, s53, s46
buffer_load_dwordx4 v[236:239], v10, s[20:23], s39 offen offset:1024 sc1
s_waitcnt vmcnt(13)
s_xor_b32 s32, s13, 0x26800
buffer_load_dwordx4 a[232:235], v252, s[56:59], s32 offen offset:0
s_waitcnt vmcnt(13)
buffer_load_dwordx4 a[236:239], v252, s[56:59], s32 offen offset:1024
v_lshlrev_b32 v118, 16, v220
v_and_b32 v119, s12, v220
v_fmac_f32 v108, v118, v103
v_fmac_f32 v109, v119, v103
v_lshlrev_b32 v120, 16, v221
v_and_b32 v121, s12, v221
v_fmac_f32 v110, v120, v103
v_fmac_f32 v111, v121, v103
v_lshlrev_b32 v122, 16, v222
v_and_b32 v123, s12, v222
v_fmac_f32 v112, v122, v103
v_fmac_f32 v113, v123, v103
v_lshlrev_b32 v116, 16, v223
v_and_b32 v117, s12, v223
v_fmac_f32 v114, v116, v103
v_fmac_f32 v115, v117, v103
s_waitcnt vmcnt(13)
s_add_u32 s33, s53, s47
buffer_load_dwordx4 v[240:243], v10, s[20:23], s33 offen offset:1024 sc1
s_waitcnt vmcnt(13)
s_xor_b32 s35, s13, 0x23000
buffer_load_dwordx4 a[176:179], v252, s[56:59], s35 offen offset:0
v_mfma_f32_16x16x32_bf16 v[48:51], a[152:155], v[144:147], v[48:51]
v_mfma_f32_16x16x32_bf16 v[52:55], a[156:159], v[144:147], v[52:55]
v_mfma_f32_16x16x32_bf16 v[56:59], a[216:219], v[144:147], v[56:59]
v_mfma_f32_16x16x32_bf16 v[60:63], a[220:223], v[144:147], v[60:63]
s_waitcnt vmcnt(13)
buffer_load_dwordx4 a[180:183], v252, s[56:59], s35 offen offset:1024
v_lshlrev_b32 v118, 16, v224
v_and_b32 v119, s12, v224
v_fmac_f32 v108, v118, v104
v_fmac_f32 v109, v119, v104
v_lshlrev_b32 v120, 16, v225
v_and_b32 v121, s12, v225
v_fmac_f32 v110, v120, v104
v_fmac_f32 v111, v121, v104
v_lshlrev_b32 v122, 16, v226
v_and_b32 v123, s12, v226
v_fmac_f32 v112, v122, v104
v_fmac_f32 v113, v123, v104
v_lshlrev_b32 v116, 16, v227
v_and_b32 v117, s12, v227
v_fmac_f32 v114, v116, v104
v_fmac_f32 v115, v117, v104
v_cvt_pk_bf16_f32 v116, v108, v109
v_cvt_pk_bf16_f32 v117, v110, v111
v_cvt_pk_bf16_f32 v118, v112, v113
v_cvt_pk_bf16_f32 v119, v114, v115
ds_write_b128 v38, v[116:119] offset:8192
s_waitcnt vmcnt(13)
s_add_u32 s39, s53, s15
buffer_load_dwordx4 v[244:247], v10, s[20:23], s39 offen offset:1024 sc1
s_waitcnt vmcnt(13)
s_xor_b32 s32, s13, 0x27000
buffer_load_dwordx4 a[240:243], v252, s[56:59], s32 offen offset:0
s_waitcnt vmcnt(13)
buffer_load_dwordx4 a[244:247], v252, s[56:59], s32 offen offset:1024
ds_read_b128 v[96:99], v45 offset:1024
v_lshlrev_b32 v118, 16, v228
v_and_b32 v119, s12, v228
v_mul_f32 v108, v118, v100
v_mul_f32 v109, v119, v100
v_lshlrev_b32 v120, 16, v229
v_and_b32 v121, s12, v229
v_mul_f32 v110, v120, v100
v_mul_f32 v111, v121, v100
v_lshlrev_b32 v122, 16, v230
v_and_b32 v123, s12, v230
v_mul_f32 v112, v122, v100
v_mul_f32 v113, v123, v100
v_lshlrev_b32 v116, 16, v231
v_and_b32 v117, s12, v231
v_mul_f32 v114, v116, v100
v_mul_f32 v115, v117, v100
s_waitcnt vmcnt(13)
s_xor_b32 s33, s13, 0x23800
buffer_load_dwordx4 a[184:187], v252, s[56:59], s33 offen offset:0
s_waitcnt vmcnt(13)
buffer_load_dwordx4 a[188:191], v252, s[56:59], s33 offen offset:1024
v_mfma_f32_16x16x32_bf16 v[48:51], a[160:163], v[148:151], v[48:51]
v_mfma_f32_16x16x32_bf16 v[52:55], a[164:167], v[148:151], v[52:55]
v_mfma_f32_16x16x32_bf16 v[56:59], a[224:227], v[148:151], v[56:59]
v_mfma_f32_16x16x32_bf16 v[60:63], a[228:231], v[148:151], v[60:63]
s_waitcnt vmcnt(13)
s_xor_b32 s35, s13, 0x27800
buffer_load_dwordx4 a[248:251], v252, s[56:59], s35 offen offset:0
v_lshlrev_b32 v118, 16, v232
v_and_b32 v119, s12, v232
v_fmac_f32 v108, v118, v101
v_fmac_f32 v109, v119, v101
v_lshlrev_b32 v120, 16, v233
v_and_b32 v121, s12, v233
v_fmac_f32 v110, v120, v101
v_fmac_f32 v111, v121, v101
v_lshlrev_b32 v122, 16, v234
v_and_b32 v123, s12, v234
v_fmac_f32 v112, v122, v101
v_fmac_f32 v113, v123, v101
v_lshlrev_b32 v116, 16, v235
v_and_b32 v117, s12, v235
v_fmac_f32 v114, v116, v101
v_fmac_f32 v115, v117, v101
s_waitcnt lgkmcnt(0)
v_lshlrev_b32 v118, 16, v96
v_and_b32 v119, s12, v96
v_fmac_f32 v108, v118, v105
v_fmac_f32 v109, v119, v105
v_lshlrev_b32 v120, 16, v97
v_and_b32 v121, s12, v97
v_fmac_f32 v110, v120, v105
v_fmac_f32 v111, v121, v105
v_lshlrev_b32 v122, 16, v98
v_and_b32 v123, s12, v98
v_fmac_f32 v112, v122, v105
v_fmac_f32 v113, v123, v105
v_lshlrev_b32 v116, 16, v99
v_and_b32 v117, s12, v99
v_fmac_f32 v114, v116, v105
v_fmac_f32 v115, v117, v105
s_waitcnt vmcnt(13)
buffer_load_dwordx4 a[252:255], v252, s[56:59], s35 offen offset:1024
s_waitcnt vmcnt(13)
s_add_u32 s39, s54, s44
buffer_load_dwordx4 v[156:159], v10, s[20:23], s39 offen offset:0 sc1
s_waitcnt vmcnt(13)
s_add_u32 s32, s54, s45
buffer_load_dwordx4 v[160:163], v10, s[20:23], s32 offen offset:0 sc1
v_lshlrev_b32 v118, 16, v236
v_and_b32 v119, s12, v236
v_fmac_f32 v108, v118, v102
v_fmac_f32 v109, v119, v102
v_lshlrev_b32 v120, 16, v237
v_and_b32 v121, s12, v237
v_fmac_f32 v110, v120, v102
v_fmac_f32 v111, v121, v102
v_lshlrev_b32 v122, 16, v238
v_and_b32 v123, s12, v238
v_fmac_f32 v112, v122, v102
v_fmac_f32 v113, v123, v102
v_lshlrev_b32 v116, 16, v239
v_and_b32 v117, s12, v239
v_fmac_f32 v114, v116, v102
v_fmac_f32 v115, v117, v102
s_waitcnt vmcnt(13)
s_add_u32 s33, s54, s46
buffer_load_dwordx4 v[164:167], v10, s[20:23], s33 offen offset:0 sc1
s_waitcnt vmcnt(13)
s_add_u32 s35, s54, s47
buffer_load_dwordx4 v[168:171], v10, s[20:23], s35 offen offset:0 sc1
v_mfma_f32_16x16x32_bf16 v[48:51], a[168:171], v[152:155], v[48:51]
v_mfma_f32_16x16x32_bf16 v[52:55], a[172:175], v[152:155], v[52:55]
v_mfma_f32_16x16x32_bf16 v[56:59], a[232:235], v[152:155], v[56:59]
v_mfma_f32_16x16x32_bf16 v[60:63], a[236:239], v[152:155], v[60:63]
s_waitcnt vmcnt(13)
s_add_u32 s39, s54, s15
buffer_load_dwordx4 v[172:175], v10, s[20:23], s39 offen offset:0 sc1
v_lshlrev_b32 v118, 16, v240
v_and_b32 v119, s12, v240
v_fmac_f32 v108, v118, v103
v_fmac_f32 v109, v119, v103
v_lshlrev_b32 v120, 16, v241
v_and_b32 v121, s12, v241
v_fmac_f32 v110, v120, v103
v_fmac_f32 v111, v121, v103
v_lshlrev_b32 v122, 16, v242
v_and_b32 v123, s12, v242
v_fmac_f32 v112, v122, v103
v_fmac_f32 v113, v123, v103
v_lshlrev_b32 v116, 16, v243
v_and_b32 v117, s12, v243
v_fmac_f32 v114, v116, v103
v_fmac_f32 v115, v117, v103
s_waitcnt vmcnt(13)
s_add_u32 s32, s54, s44
buffer_load_dwordx4 v[176:179], v10, s[20:23], s32 offen offset:1024 sc1
s_waitcnt vmcnt(13)
s_add_u32 s33, s54, s45
buffer_load_dwordx4 v[180:183], v10, s[20:23], s33 offen offset:1024 sc1
s_waitcnt vmcnt(13)
s_add_u32 s35, s54, s46
buffer_load_dwordx4 v[184:187], v10, s[20:23], s35 offen offset:1024 sc1
v_lshlrev_b32 v118, 16, v244
v_and_b32 v119, s12, v244
v_fmac_f32 v108, v118, v104
v_fmac_f32 v109, v119, v104
v_lshlrev_b32 v120, 16, v245
v_and_b32 v121, s12, v245
v_fmac_f32 v110, v120, v104
v_fmac_f32 v111, v121, v104
v_lshlrev_b32 v122, 16, v246
v_and_b32 v123, s12, v246
v_fmac_f32 v112, v122, v104
v_fmac_f32 v113, v123, v104
v_lshlrev_b32 v116, 16, v247
v_and_b32 v117, s12, v247
v_fmac_f32 v114, v116, v104
v_fmac_f32 v115, v117, v104
ds_read2_b32 v[100:101], v14 offset0:1 offset1:2
ds_read2_b32 v[102:103], v14 offset0:3 offset1:4
ds_read2_b32 v[104:105], v14 offset0:5 offset1:6
v_cvt_pk_bf16_f32 v116, v108, v109
v_cvt_pk_bf16_f32 v117, v110, v111
v_cvt_pk_bf16_f32 v118, v112, v113
v_cvt_pk_bf16_f32 v119, v114, v115
ds_write_b128 v39, v[116:119] offset:8192
s_waitcnt vmcnt(13)
s_add_u32 s39, s54, s47
buffer_load_dwordx4 v[188:191], v10, s[20:23], s39 offen offset:1024 sc1
s_waitcnt vmcnt(13)
s_add_u32 s32, s54, s15
buffer_load_dwordx4 v[192:195], v10, s[20:23], s32 offen offset:1024 sc1
v_mfma_f32_16x16x32_bf16 v[48:51], a[176:179], v[132:135], v[48:51]
v_mfma_f32_16x16x32_bf16 v[52:55], a[180:183], v[132:135], v[52:55]
v_mfma_f32_16x16x32_bf16 v[56:59], a[240:243], v[132:135], v[56:59]
v_mfma_f32_16x16x32_bf16 v[60:63], a[244:247], v[132:135], v[60:63]
s_waitcnt vmcnt(13)
s_waitcnt vmcnt(12)
s_waitcnt vmcnt(11)
s_waitcnt vmcnt(10)
s_waitcnt lgkmcnt(0)
s_barrier
ds_read_b128 v[136:139], v15 offset:7168
ds_read_b128 v[140:143], v15 offset:8192
ds_read_b128 v[144:147], v15 offset:9216
ds_read_b128 v[148:151], v15 offset:10240
ds_read_b128 v[152:155], v15 offset:11264
s_waitcnt lgkmcnt(4)
v_mfma_f32_16x16x32_bf16 v[48:51], a[184:187], v[136:139], v[48:51]
ds_read_b128 v[132:135], v15 offset:12288
v_mfma_f32_16x16x32_bf16 v[52:55], a[188:191], v[136:139], v[52:55]
v_mfma_f32_16x16x32_bf16 v[56:59], a[248:251], v[136:139], v[56:59]
v_mfma_f32_16x16x32_bf16 v[60:63], a[252:255], v[136:139], v[60:63]
s_waitcnt lgkmcnt(4)
v_mfma_f32_16x16x32_bf16 v[64:67], a[128:131], v[140:143], v[64:67]
ds_read_b128 v[136:139], v15 offset:13312
v_mfma_f32_16x16x32_bf16 v[68:71], a[132:135], v[140:143], v[68:71]
v_mfma_f32_16x16x32_bf16 v[72:75], a[192:195], v[140:143], v[72:75]
v_mfma_f32_16x16x32_bf16 v[76:79], a[196:199], v[140:143], v[76:79]
v_cvt_pk_bf16_f32 v48, v48, v49
v_cvt_pk_bf16_f32 v49, v50, v51
v_cvt_pk_bf16_f32 v50, v52, v53
v_cvt_pk_bf16_f32 v51, v54, v55
ds_write_b128 v32, v[48:51] offset:0
v_cvt_pk_bf16_f32 v56, v56, v57
v_cvt_pk_bf16_f32 v57, v58, v59
v_cvt_pk_bf16_f32 v58, v60, v61
v_cvt_pk_bf16_f32 v59, v62, v63
ds_write_b128 v33, v[56:59] offset:0
ds_read_b128 v[52:55], v34 offset:0
ds_read_b128 v[60:63], v34 offset:1024
s_waitcnt lgkmcnt(8)
v_mfma_f32_16x16x32_bf16 v[64:67], a[136:139], v[144:147], v[64:67]
ds_read_b128 v[140:143], v15 offset:14336
v_mfma_f32_16x16x32_bf16 v[68:71], a[140:143], v[144:147], v[68:71]
v_mfma_f32_16x16x32_bf16 v[72:75], a[200:203], v[144:147], v[72:75]
v_mfma_f32_16x16x32_bf16 v[76:79], a[204:207], v[144:147], v[76:79]
s_waitcnt lgkmcnt(8)
v_mfma_f32_16x16x32_bf16 v[64:67], a[144:147], v[148:151], v[64:67]
ds_read_b128 v[144:147], v15 offset:15360
v_mfma_f32_16x16x32_bf16 v[68:71], a[148:151], v[148:151], v[68:71]
v_mfma_f32_16x16x32_bf16 v[72:75], a[208:211], v[148:151], v[72:75]
v_mfma_f32_16x16x32_bf16 v[76:79], a[212:215], v[148:151], v[76:79]
s_waitcnt lgkmcnt(8)
v_mfma_f32_16x16x32_bf16 v[64:67], a[152:155], v[152:155], v[64:67]
v_mfma_f32_16x16x32_bf16 v[68:71], a[156:159], v[152:155], v[68:71]
v_mfma_f32_16x16x32_bf16 v[72:75], a[216:219], v[152:155], v[72:75]
v_mfma_f32_16x16x32_bf16 v[76:79], a[220:223], v[152:155], v[76:79]
s_waitcnt lgkmcnt(7)
v_mfma_f32_16x16x32_bf16 v[64:67], a[160:163], v[132:135], v[64:67]
v_mfma_f32_16x16x32_bf16 v[68:71], a[164:167], v[132:135], v[68:71]
v_mfma_f32_16x16x32_bf16 v[72:75], a[224:227], v[132:135], v[72:75]
v_mfma_f32_16x16x32_bf16 v[76:79], a[228:231], v[132:135], v[76:79]
s_waitcnt lgkmcnt(6)
v_mfma_f32_16x16x32_bf16 v[64:67], a[168:171], v[136:139], v[64:67]
v_mfma_f32_16x16x32_bf16 v[68:71], a[172:175], v[136:139], v[68:71]
v_mfma_f32_16x16x32_bf16 v[72:75], a[232:235], v[136:139], v[72:75]
v_mfma_f32_16x16x32_bf16 v[76:79], a[236:239], v[136:139], v[76:79]
s_waitcnt lgkmcnt(1)
v_mfma_f32_16x16x32_bf16 v[64:67], a[176:179], v[140:143], v[64:67]
v_mfma_f32_16x16x32_bf16 v[68:71], a[180:183], v[140:143], v[68:71]
v_mfma_f32_16x16x32_bf16 v[72:75], a[240:243], v[140:143], v[72:75]
v_mfma_f32_16x16x32_bf16 v[76:79], a[244:247], v[140:143], v[76:79]
s_waitcnt lgkmcnt(0)
v_mfma_f32_16x16x32_bf16 v[64:67], a[184:187], v[144:147], v[64:67]
v_mfma_f32_16x16x32_bf16 v[68:71], a[188:191], v[144:147], v[68:71]
v_mfma_f32_16x16x32_bf16 v[72:75], a[248:251], v[144:147], v[72:75]
v_mfma_f32_16x16x32_bf16 v[76:79], a[252:255], v[144:147], v[76:79]
s_waitcnt vmcnt(9)
s_add_u32 s33, s52, 0
buffer_store_dwordx4 v[52:55], v9, s[40:43], s33 offen sc1
s_add_u32 s35, s52, 4096
buffer_store_dwordx4 v[60:63], v9, s[40:43], s35 offen sc1
v_cvt_pk_bf16_f32 v64, v64, v65
v_cvt_pk_bf16_f32 v65, v66, v67
v_cvt_pk_bf16_f32 v66, v68, v69
v_cvt_pk_bf16_f32 v67, v70, v71
ds_write_b128 v32, v[64:67] offset:2048
v_cvt_pk_bf16_f32 v72, v72, v73
v_cvt_pk_bf16_f32 v73, v74, v75
v_cvt_pk_bf16_f32 v74, v76, v77
v_cvt_pk_bf16_f32 v75, v78, v79
ds_write_b128 v33, v[72:75] offset:2048
ds_read_b128 v[68:71], v34 offset:2048
ds_read_b128 v[76:79], v34 offset:3072
ds_read_b128 v[96:99], v46 offset:0
v_lshlrev_b32 v118, 16, v156
v_and_b32 v119, s12, v156
v_mul_f32 v108, v118, v100
v_mul_f32 v109, v119, v100
v_lshlrev_b32 v120, 16, v157
v_and_b32 v121, s12, v157
v_mul_f32 v110, v120, v100
v_mul_f32 v111, v121, v100
v_lshlrev_b32 v122, 16, v158
v_and_b32 v123, s12, v158
v_mul_f32 v112, v122, v100
v_mul_f32 v113, v123, v100
v_lshlrev_b32 v116, 16, v159
v_and_b32 v117, s12, v159
v_mul_f32 v114, v116, v100
v_mul_f32 v115, v117, v100
s_waitcnt vmcnt(10)
s_add_u32 s39, s53, 0
s_waitcnt lgkmcnt(2)
buffer_store_dwordx4 v[68:71], v9, s[40:43], s39 offen sc1
s_add_u32 s32, s53, 4096
s_waitcnt lgkmcnt(1)
buffer_store_dwordx4 v[76:79], v9, s[40:43], s32 offen sc1
v_lshlrev_b32 v118, 16, v160
v_and_b32 v119, s12, v160
v_fmac_f32 v108, v118, v101
v_fmac_f32 v109, v119, v101
v_lshlrev_b32 v120, 16, v161
v_and_b32 v121, s12, v161
v_fmac_f32 v110, v120, v101
v_fmac_f32 v111, v121, v101
v_lshlrev_b32 v122, 16, v162
v_and_b32 v123, s12, v162
v_fmac_f32 v112, v122, v101
v_fmac_f32 v113, v123, v101
v_lshlrev_b32 v116, 16, v163
v_and_b32 v117, s12, v163
v_fmac_f32 v114, v116, v101
v_fmac_f32 v115, v117, v101
s_waitcnt lgkmcnt(0)
v_lshlrev_b32 v118, 16, v96
v_and_b32 v119, s12, v96
v_fmac_f32 v108, v118, v105
v_fmac_f32 v109, v119, v105
v_lshlrev_b32 v120, 16, v97
v_and_b32 v121, s12, v97
v_fmac_f32 v110, v120, v105
v_fmac_f32 v111, v121, v105
v_lshlrev_b32 v122, 16, v98
v_and_b32 v123, s12, v98
v_fmac_f32 v112, v122, v105
v_fmac_f32 v113, v123, v105
v_lshlrev_b32 v116, 16, v99
v_and_b32 v117, s12, v99
v_fmac_f32 v114, v116, v105
v_fmac_f32 v115, v117, v105
s_waitcnt vmcnt(11)
v_lshlrev_b32 v118, 16, v164
v_and_b32 v119, s12, v164
v_fmac_f32 v108, v118, v102
v_fmac_f32 v109, v119, v102
v_lshlrev_b32 v120, 16, v165
v_and_b32 v121, s12, v165
v_fmac_f32 v110, v120, v102
v_fmac_f32 v111, v121, v102
v_lshlrev_b32 v122, 16, v166
v_and_b32 v123, s12, v166
v_fmac_f32 v112, v122, v102
v_fmac_f32 v113, v123, v102
v_lshlrev_b32 v116, 16, v167
v_and_b32 v117, s12, v167
v_fmac_f32 v114, v116, v102
v_fmac_f32 v115, v117, v102
s_waitcnt vmcnt(10)
v_lshlrev_b32 v118, 16, v168
v_and_b32 v119, s12, v168
v_fmac_f32 v108, v118, v103
v_fmac_f32 v109, v119, v103
v_lshlrev_b32 v120, 16, v169
v_and_b32 v121, s12, v169
v_fmac_f32 v110, v120, v103
v_fmac_f32 v111, v121, v103
v_lshlrev_b32 v122, 16, v170
v_and_b32 v123, s12, v170
v_fmac_f32 v112, v122, v103
v_fmac_f32 v113, v123, v103
v_lshlrev_b32 v116, 16, v171
v_and_b32 v117, s12, v171
v_fmac_f32 v114, v116, v103
v_fmac_f32 v115, v117, v103
s_waitcnt vmcnt(9)
v_lshlrev_b32 v118, 16, v172
v_and_b32 v119, s12, v172
v_fmac_f32 v108, v118, v104
v_fmac_f32 v109, v119, v104
v_lshlrev_b32 v120, 16, v173
v_and_b32 v121, s12, v173
v_fmac_f32 v110, v120, v104
v_fmac_f32 v111, v121, v104
v_lshlrev_b32 v122, 16, v174
v_and_b32 v123, s12, v174
v_fmac_f32 v112, v122, v104
v_fmac_f32 v113, v123, v104
v_lshlrev_b32 v116, 16, v175
v_and_b32 v117, s12, v175
v_fmac_f32 v114, v116, v104
v_fmac_f32 v115, v117, v104
v_cvt_pk_bf16_f32 v116, v108, v109
v_cvt_pk_bf16_f32 v117, v110, v111
v_cvt_pk_bf16_f32 v118, v112, v113
v_cvt_pk_bf16_f32 v119, v114, v115
ds_write_b128 v38, v[116:119] offset:16384
s_waitcnt vmcnt(8)
ds_read_b128 v[96:99], v46 offset:1024
v_lshlrev_b32 v118, 16, v176
v_and_b32 v119, s12, v176
v_mul_f32 v108, v118, v100
v_mul_f32 v109, v119, v100
v_lshlrev_b32 v120, 16, v177
v_and_b32 v121, s12, v177
v_mul_f32 v110, v120, v100
v_mul_f32 v111, v121, v100
v_lshlrev_b32 v122, 16, v178
v_and_b32 v123, s12, v178
v_mul_f32 v112, v122, v100
v_mul_f32 v113, v123, v100
v_lshlrev_b32 v116, 16, v179
v_and_b32 v117, s12, v179
v_mul_f32 v114, v116, v100
v_mul_f32 v115, v117, v100
s_waitcnt vmcnt(7)
v_lshlrev_b32 v118, 16, v180
v_and_b32 v119, s12, v180
v_fmac_f32 v108, v118, v101
v_fmac_f32 v109, v119, v101
v_lshlrev_b32 v120, 16, v181
v_and_b32 v121, s12, v181
v_fmac_f32 v110, v120, v101
v_fmac_f32 v111, v121, v101
v_lshlrev_b32 v122, 16, v182
v_and_b32 v123, s12, v182
v_fmac_f32 v112, v122, v101
v_fmac_f32 v113, v123, v101
v_lshlrev_b32 v116, 16, v183
v_and_b32 v117, s12, v183
v_fmac_f32 v114, v116, v101
v_fmac_f32 v115, v117, v101
s_waitcnt lgkmcnt(0)
v_lshlrev_b32 v118, 16, v96
v_and_b32 v119, s12, v96
v_fmac_f32 v108, v118, v105
v_fmac_f32 v109, v119, v105
v_lshlrev_b32 v120, 16, v97
v_and_b32 v121, s12, v97
v_fmac_f32 v110, v120, v105
v_fmac_f32 v111, v121, v105
v_lshlrev_b32 v122, 16, v98
v_and_b32 v123, s12, v98
v_fmac_f32 v112, v122, v105
v_fmac_f32 v113, v123, v105
v_lshlrev_b32 v116, 16, v99
v_and_b32 v117, s12, v99
v_fmac_f32 v114, v116, v105
v_fmac_f32 v115, v117, v105
s_waitcnt vmcnt(6)
v_lshlrev_b32 v118, 16, v184
v_and_b32 v119, s12, v184
v_fmac_f32 v108, v118, v102
v_fmac_f32 v109, v119, v102
v_lshlrev_b32 v120, 16, v185
v_and_b32 v121, s12, v185
v_fmac_f32 v110, v120, v102
v_fmac_f32 v111, v121, v102
v_lshlrev_b32 v122, 16, v186
v_and_b32 v123, s12, v186
v_fmac_f32 v112, v122, v102
v_fmac_f32 v113, v123, v102
v_lshlrev_b32 v116, 16, v187
v_and_b32 v117, s12, v187
v_fmac_f32 v114, v116, v102
v_fmac_f32 v115, v117, v102
s_waitcnt vmcnt(5)
v_lshlrev_b32 v118, 16, v188
v_and_b32 v119, s12, v188
v_fmac_f32 v108, v118, v103
v_fmac_f32 v109, v119, v103
v_lshlrev_b32 v120, 16, v189
v_and_b32 v121, s12, v189
v_fmac_f32 v110, v120, v103
v_fmac_f32 v111, v121, v103
v_lshlrev_b32 v122, 16, v190
v_and_b32 v123, s12, v190
v_fmac_f32 v112, v122, v103
v_fmac_f32 v113, v123, v103
v_lshlrev_b32 v116, 16, v191
v_and_b32 v117, s12, v191
v_fmac_f32 v114, v116, v103
v_fmac_f32 v115, v117, v103
s_waitcnt vmcnt(4)
v_lshlrev_b32 v118, 16, v192
v_and_b32 v119, s12, v192
v_fmac_f32 v108, v118, v104
v_fmac_f32 v109, v119, v104
v_lshlrev_b32 v120, 16, v193
v_and_b32 v121, s12, v193
v_fmac_f32 v110, v120, v104
v_fmac_f32 v111, v121, v104
v_lshlrev_b32 v122, 16, v194
v_and_b32 v123, s12, v194
v_fmac_f32 v112, v122, v104
v_fmac_f32 v113, v123, v104
v_lshlrev_b32 v116, 16, v195
v_and_b32 v117, s12, v195
v_fmac_f32 v114, v116, v104
v_fmac_f32 v115, v117, v104
v_cvt_pk_bf16_f32 v116, v108, v109
v_cvt_pk_bf16_f32 v117, v110, v111
v_cvt_pk_bf16_f32 v118, v112, v113
v_cvt_pk_bf16_f32 v119, v114, v115
ds_write_b128 v39, v[116:119] offset:16384
s_waitcnt lgkmcnt(0)
s_barrier
ds_read_b128 v[148:151], v15 offset:16384
ds_read_b128 v[152:155], v15 offset:17408
ds_read_b128 v[132:135], v15 offset:18432
ds_read_b128 v[136:139], v15 offset:19456
ds_read_b128 v[140:143], v15 offset:20480
s_waitcnt lgkmcnt(4)
v_mfma_f32_16x16x32_bf16 v[80:83], a[128:131], v[148:151], v[80:83]
ds_read_b128 v[144:147], v15 offset:21504
v_mfma_f32_16x16x32_bf16 v[84:87], a[132:135], v[148:151], v[84:87]
v_mfma_f32_16x16x32_bf16 v[88:91], a[192:195], v[148:151], v[88:91]
v_mfma_f32_16x16x32_bf16 v[92:95], a[196:199], v[148:151], v[92:95]
s_waitcnt lgkmcnt(4)
v_mfma_f32_16x16x32_bf16 v[80:83], a[136:139], v[152:155], v[80:83]
ds_read_b128 v[148:151], v15 offset:22528
v_mfma_f32_16x16x32_bf16 v[84:87], a[140:143], v[152:155], v[84:87]
v_mfma_f32_16x16x32_bf16 v[88:91], a[200:203], v[152:155], v[88:91]
v_mfma_f32_16x16x32_bf16 v[92:95], a[204:207], v[152:155], v[92:95]
s_waitcnt lgkmcnt(4)
v_mfma_f32_16x16x32_bf16 v[80:83], a[144:147], v[132:135], v[80:83]
ds_read_b128 v[152:155], v15 offset:23552
v_mfma_f32_16x16x32_bf16 v[84:87], a[148:151], v[132:135], v[84:87]
v_mfma_f32_16x16x32_bf16 v[88:91], a[208:211], v[132:135], v[88:91]
v_mfma_f32_16x16x32_bf16 v[92:95], a[212:215], v[132:135], v[92:95]
s_waitcnt lgkmcnt(4)
v_mfma_f32_16x16x32_bf16 v[80:83], a[152:155], v[136:139], v[80:83]
v_mfma_f32_16x16x32_bf16 v[84:87], a[156:159], v[136:139], v[84:87]
v_mfma_f32_16x16x32_bf16 v[88:91], a[216:219], v[136:139], v[88:91]
v_mfma_f32_16x16x32_bf16 v[92:95], a[220:223], v[136:139], v[92:95]
s_waitcnt lgkmcnt(3)
v_mfma_f32_16x16x32_bf16 v[80:83], a[160:163], v[140:143], v[80:83]
v_mfma_f32_16x16x32_bf16 v[84:87], a[164:167], v[140:143], v[84:87]
v_mfma_f32_16x16x32_bf16 v[88:91], a[224:227], v[140:143], v[88:91]
v_mfma_f32_16x16x32_bf16 v[92:95], a[228:231], v[140:143], v[92:95]
s_waitcnt lgkmcnt(2)
v_mfma_f32_16x16x32_bf16 v[80:83], a[168:171], v[144:147], v[80:83]
v_mfma_f32_16x16x32_bf16 v[84:87], a[172:175], v[144:147], v[84:87]
v_mfma_f32_16x16x32_bf16 v[88:91], a[232:235], v[144:147], v[88:91]
v_mfma_f32_16x16x32_bf16 v[92:95], a[236:239], v[144:147], v[92:95]
s_waitcnt lgkmcnt(1)
v_mfma_f32_16x16x32_bf16 v[80:83], a[176:179], v[148:151], v[80:83]
v_mfma_f32_16x16x32_bf16 v[84:87], a[180:183], v[148:151], v[84:87]
v_mfma_f32_16x16x32_bf16 v[88:91], a[240:243], v[148:151], v[88:91]
v_mfma_f32_16x16x32_bf16 v[92:95], a[244:247], v[148:151], v[92:95]
s_waitcnt lgkmcnt(0)
v_mfma_f32_16x16x32_bf16 v[80:83], a[184:187], v[152:155], v[80:83]
v_mfma_f32_16x16x32_bf16 v[84:87], a[188:191], v[152:155], v[84:87]
v_mfma_f32_16x16x32_bf16 v[88:91], a[248:251], v[152:155], v[88:91]
v_mfma_f32_16x16x32_bf16 v[92:95], a[252:255], v[152:155], v[92:95]
s_nop 4
v_cvt_pk_bf16_f32 v80, v80, v81
v_cvt_pk_bf16_f32 v81, v82, v83
v_cvt_pk_bf16_f32 v82, v84, v85
v_cvt_pk_bf16_f32 v83, v86, v87
ds_write_b128 v35, v[80:83] offset:0
v_cvt_pk_bf16_f32 v88, v88, v89
v_cvt_pk_bf16_f32 v89, v90, v91
v_cvt_pk_bf16_f32 v90, v92, v93
v_cvt_pk_bf16_f32 v91, v94, v95
ds_write_b128 v36, v[88:91] offset:0
ds_read_b128 v[84:87], v37 offset:0
ds_read_b128 v[92:95], v37 offset:1024
s_add_u32 s33, s54, 0
s_waitcnt lgkmcnt(1)
buffer_store_dwordx4 v[84:87], v9, s[40:43], s33 offen sc1
s_add_u32 s35, s54, 4096
s_waitcnt lgkmcnt(0)
buffer_store_dwordx4 v[92:95], v9, s[40:43], s35 offen sc1
s_branch L2_fin
LC_poll:
s_mov_b32 s36, 0
s_cmp_lt_u32 s98, 2
s_cselect_b32 s33, 0xfff, -1
s_cselect_b32 s35, 6, 0x6
LC_poll2:
s_mov_b32 s70, 0
s_atomic_add s70, s[60:61], s48 glc
s_cmp_lt_u32 s2, 240
s_cbranch_scc1 LC_poll3
s_mov_b32 s71, 0
s_atomic_add s71, s[60:61], s49 glc
s_mov_b32 s72, 0
s_atomic_add s72, s[60:61], s50 glc
s_waitcnt lgkmcnt(0)
s_min_u32 s70, s70, s71
s_min_u32 s70, s70, s72
LC_poll3:
s_waitcnt lgkmcnt(0)
s_and_b32 s70, s70, s33
s_cmp_ge_u32 s70, s35
s_cbranch_scc1 LC_poll4
s_sleep 2
s_add_u32 s36, s36, 1
s_cmp_gt_u32 s36, 0x40000
s_cbranch_scc0 LC_poll2
LC_poll4:
s_cmp_lt_u32 s98, 2
s_cbranch_scc1 LC_got
s_mul_i32 s33, s51, 0x600000
v_readfirstlane_b32 s32, v44
s_add_u32 s35, s33, s52
s_mov_b32 m0, s32
s_nop 0
buffer_load_dwordx4 v10, s[20:23], s35 offen offset:0 sc1 lds
buffer_load_dwordx4 v10, s[20:23], s35 offen offset:1024 sc1 lds
v_readfirstlane_b32 s32, v45
s_add_u32 s35, s33, s53
s_mov_b32 m0, s32
s_nop 0
buffer_load_dwordx4 v10, s[20:23], s35 offen offset:0 sc1 lds
buffer_load_dwordx4 v10, s[20:23], s35 offen offset:1024 sc1 lds
v_readfirstlane_b32 s32, v46
s_add_u32 s35, s33, s54
s_mov_b32 m0, s32
s_nop 0
buffer_load_dwordx4 v10, s[20:23], s35 offen offset:0 sc1 lds
buffer_load_dwordx4 v10, s[20:23], s35 offen offset:1024 sc1 lds
s_waitcnt vmcnt(0)
s_branch LC_got
LC_side:
s_cmp_eq_u32 s14, 1
s_cbranch_scc1 LC_sideok
s_cmp_lt_u32 s2, 240
s_cbranch_scc1 LC_side1
s_barrier
LC_side1:
s_mov_b32 s36, 0
s_mov_b32 s33, 0x6c01400
LC_side2:
buffer_load_dword v1, off, s[56:59], s33 sc1
s_waitcnt vmcnt(0)
v_readfirstlane_b32 s99, v1
s_add_u32 s36, s36, 1
s_cmp_gt_u32 s36, 0x40000
s_cbranch_scc1 LC_side3
s_cmp_ge_u32 s99, 60
s_cbranch_scc1 LC_side3
s_sleep 8
s_branch LC_side2
LC_side3:
s_cmp_lt_u32 s98, 2
s_cbranch_scc1 LC_sideok
s_add_u32 s8, s6, 0x0
s_addc_u32 s9, s7, 0
s_mov_b32 s10, 0x4e2000
s_mov_b32 s11, 0x00020000
s_lshl_b32 s55, s34, 13
s_add_u32 s55, s55, 0x21000
s_lshl_b32 s33, s34, 7
v_bfe_u32 v9, v252, 4, 3
v_lshrrev_b32 v1, 7, v252
v_xor_b32 v9, v9, v1
v_lshl_add_u32 v1, v1, 9, s33
v_lshl_add_u32 v9, v9, 4, v1
s_add_u32 m0, s55, 0
s_add_u32 s39, s52, 0
buffer_load_dwordx4 v9, s[8:11], s39 offen lds
s_add_u32 m0, s55, 1024
s_add_u32 s32, s52, 4096
buffer_load_dwordx4 v9, s[8:11], s32 offen lds
s_add_u32 m0, s55, 2048
s_add_u32 s33, s53, 0
buffer_load_dwordx4 v9, s[8:11], s33 offen lds
s_add_u32 m0, s55, 3072
s_add_u32 s35, s53, 4096
buffer_load_dwordx4 v9, s[8:11], s35 offen lds
s_waitcnt vmcnt(0)
s_branch LC_sideok
LC_slow:
s_waitcnt vmcnt(0) lgkmcnt(0)
s_barrier
s_mov_b32 s50, 0xe1a06800
s_mov_b32 s51, 0x4e608d04
s_mul_i32 s39, s37, 9
s_lshr_b64 s[50:51], s[50:51], s39
s_and_b32 s39, s50, 0x1ff
s_bfe_u32 s49, s50, 0x90009
s_sub_u32 s29, s49, s39
s_lshl_b32 s50, s37, 2
s_lshr_b32 s59, 0x766666, s50
s_and_b32 s59, s59, 15
s_sub_u32 s31, s29, s59
s_lshr_b32 s31, s31, 1
s_sub_u32 s31, s31, 1
s_lshl_b32 s39, s39, 14
s_lshl_b32 s49, s49, 14
s_add_u32 s28, s39, 0x4000
s_cmp_eq_u32 s37, 5
s_cselect_b32 s33, 0xff800000, 0
s_mov_b32 s32, 0xffff
s_add_u32 s12, s4, 0x6800000
s_addc_u32 s13, s5, 0
s_mov_b32 s14, s49
s_mov_b32 s15, 0x00020000
s_add_u32 s8, s4, 0x0
s_addc_u32 s9, s5, 0
s_mov_b32 s10, 0x4e4000
s_mov_b32 s11, 0x00020000
s_mul_i32 s35, s37, 0x600000
s_add_u32 s20, s4, 0x2000000
s_addc_u32 s21, s5, 0
s_add_u32 s20, s20, s35
s_addc_u32 s21, s21, 0
s_mov_b32 s22, 0x4e4000
s_mov_b32 s23, 0x00020000
s_add_u32 s24, s4, 0x6000000
s_addc_u32 s25, s5, 0
s_mov_b32 s26, 0x9c800
s_mov_b32 s27, 0x00020000
s_lshl_b32 s35, s38, 4
s_lshl_b32 s41, s34, 2
s_add_u32 s35, s35, s41
s_lshl_b32 s40, s35, 13
s_lshl_b32 s48, s35, 10
s_lshl_b32 s35, s37, 3
s_add_u32 s48, s48, s35
v_bfe_u32 v248, v252, 4, 3
v_lshlrev_b32 v248, 6, v248
v_bfe_u32 v253, v252, 7, 1
v_lshl_or_b32 v248, v253, 10, v248
v_bfe_u32 v253, v252, 8, 2
v_lshl_or_b32 v248, v253, 4, v248
v_bfe_u32 v253, v252, 6, 1
v_lshlrev_b32 v253, 5, v253
v_xor_b32 v248, v248, v253
v_and_b32 v249, 0x1c0, v252
v_bfe_u32 v253, v252, 9, 1
v_lshl_or_b32 v249, v253, 10, v249
v_bfe_u32 v253, v252, 8, 1
v_lshl_or_b32 v249, v253, 5, v249
v_bfe_u32 v253, v252, 4, 2
v_lshl_or_b32 v249, v253, 3, v249
v_xor_b32 v250, 32, v249
v_and_b32 v251, 0xfffffe7f, v251
s_mul_i32 s36, s34, 0xa000
s_mov_b32 s56, s36
s_add_u32 s57, s56, 32768
s_mov_b32 s55, 4
v_bfe_i32 v188, v252, 8, 1
LS_q:
s_add_u32 s44, s40, 4096
buffer_load_dwordx4 v[0:3], v252, s[8:11], s40 offen offset:0
buffer_load_dwordx4 v[4:7], v252, s[8:11], s40 offen offset:1024
buffer_load_dwordx4 v[8:11], v252, s[8:11], s40 offen offset:2048
buffer_load_dwordx4 v[12:15], v252, s[8:11], s40 offen offset:3072
buffer_load_dwordx4 v[16:19], v252, s[8:11], s44 offen offset:0
buffer_load_dwordx4 v[20:23], v252, s[8:11], s44 offen offset:1024
buffer_load_dwordx4 v[24:27], v252, s[8:11], s44 offen offset:2048
buffer_load_dwordx4 v[28:31], v252, s[8:11], s44 offen offset:3072
s_mov_b32 s53, s56
s_mov_b32 s58, s39
s_add_u32 m0, s53, 0
s_add_u32 s54, s58, 0
buffer_load_dwordx4 v251, s[12:15], s54 offen offset:0 lds
buffer_load_dwordx4 v251, s[12:15], s54 offen offset:1024 lds
buffer_load_dwordx4 v251, s[12:15], s54 offen offset:2048 lds
buffer_load_dwordx4 v251, s[12:15], s54 offen offset:3072 lds
s_add_u32 m0, s53, 4096
s_add_u32 s54, s58, 128
buffer_load_dwordx4 v251, s[12:15], s54 offen offset:0 lds
buffer_load_dwordx4 v251, s[12:15], s54 offen offset:1024 lds
buffer_load_dwordx4 v251, s[12:15], s54 offen offset:2048 lds
buffer_load_dwordx4 v251, s[12:15], s54 offen offset:3072 lds
s_add_u32 m0, s53, 8192
s_add_u32 s54, s58, 256
buffer_load_dwordx4 v251, s[12:15], s54 offen offset:0 lds
buffer_load_dwordx4 v251, s[12:15], s54 offen offset:1024 lds
buffer_load_dwordx4 v251, s[12:15], s54 offen offset:2048 lds
buffer_load_dwordx4 v251, s[12:15], s54 offen offset:3072 lds
s_add_u32 m0, s53, 12288
s_add_u32 s54, s58, 384
buffer_load_dwordx4 v251, s[12:15], s54 offen offset:0 lds
buffer_load_dwordx4 v251, s[12:15], s54 offen offset:1024 lds
buffer_load_dwordx4 v251, s[12:15], s54 offen offset:2048 lds
buffer_load_dwordx4 v251, s[12:15], s54 offen offset:3072 lds
s_add_u32 s53, s53, 0x4000
s_cmp_eq_u32 s53, s57
s_cselect_b32 s53, s56, s53
s_add_u32 s58, s58, 0x4000
s_mov_b32 s51, s29
s_mov_b32 s52, s56
v_mov_b32 v172, 0xff800000
v_accvgpr_write_b32 a0, 0
v_accvgpr_write_b32 a1, 0
v_accvgpr_write_b32 a2, 0
v_accvgpr_write_b32 a3, 0
v_accvgpr_write_b32 a4, 0
v_accvgpr_write_b32 a5, 0
v_accvgpr_write_b32 a6, 0
v_accvgpr_write_b32 a7, 0
v_accvgpr_write_b32 a8, 0
v_accvgpr_write_b32 a9, 0
v_accvgpr_write_b32 a10, 0
v_accvgpr_write_b32 a11, 0
v_accvgpr_write_b32 a12, 0
v_accvgpr_write_b32 a13, 0
v_accvgpr_write_b32 a14, 0
v_accvgpr_write_b32 a15, 0
v_accvgpr_write_b32 a16, 0
v_accvgpr_write_b32 a17, 0
v_accvgpr_write_b32 a18, 0
v_accvgpr_write_b32 a19, 0
v_accvgpr_write_b32 a20, 0
v_accvgpr_write_b32 a21, 0
v_accvgpr_write_b32 a22, 0
v_accvgpr_write_b32 a23, 0
v_accvgpr_write_b32 a24, 0
v_accvgpr_write_b32 a25, 0
v_accvgpr_write_b32 a26, 0
v_accvgpr_write_b32 a27, 0
v_accvgpr_write_b32 a28, 0
v_accvgpr_write_b32 a29, 0
v_accvgpr_write_b32 a30, 0
v_accvgpr_write_b32 a31, 0
v_accvgpr_write_b32 a32, 0
v_accvgpr_write_b32 a33, 0
v_accvgpr_write_b32 a34, 0
v_accvgpr_write_b32 a35, 0
v_accvgpr_write_b32 a36, 0
v_accvgpr_write_b32 a37, 0
v_accvgpr_write_b32 a38, 0
v_accvgpr_write_b32 a39, 0
v_accvgpr_write_b32 a40, 0
v_accvgpr_write_b32 a41, 0
v_accvgpr_write_b32 a42, 0
v_accvgpr_write_b32 a43, 0
v_accvgpr_write_b32 a44, 0
v_accvgpr_write_b32 a45, 0
v_accvgpr_write_b32 a46, 0
v_accvgpr_write_b32 a47, 0
v_accvgpr_write_b32 a48, 0
v_accvgpr_write_b32 a49, 0
v_accvgpr_write_b32 a50, 0
v_accvgpr_write_b32 a51, 0
v_accvgpr_write_b32 a52, 0
v_accvgpr_write_b32 a53, 0
v_accvgpr_write_b32 a54, 0
v_accvgpr_write_b32 a55, 0
v_accvgpr_write_b32 a56, 0
v_accvgpr_write_b32 a57, 0
v_accvgpr_write_b32 a58, 0
v_accvgpr_write_b32 a59, 0
v_accvgpr_write_b32 a60, 0
v_accvgpr_write_b32 a61, 0
v_accvgpr_write_b32 a62, 0
v_accvgpr_write_b32 a63, 0
LS_loop:
s_add_u32 m0, s53, 0
s_add_u32 s54, s58, 0
buffer_load_dwordx4 v251, s[12:15], s54 offen offset:0 lds
buffer_load_dwordx4 v251, s[12:15], s54 offen offset:1024 lds
buffer_load_dwordx4 v251, s[12:15], s54 offen offset:2048 lds
buffer_load_dwordx4 v251, s[12:15], s54 offen offset:3072 lds
s_add_u32 m0, s53, 4096
s_add_u32 s54, s58, 128
buffer_load_dwordx4 v251, s[12:15], s54 offen offset:0 lds
buffer_load_dwordx4 v251, s[12:15], s54 offen offset:1024 lds
buffer_load_dwordx4 v251, s[12:15], s54 offen offset:2048 lds
buffer_load_dwordx4 v251, s[12:15], s54 offen offset:3072 lds
s_add_u32 m0, s53, 8192
s_add_u32 s54, s58, 256
buffer_load_dwordx4 v251, s[12:15], s54 offen offset:0 lds
buffer_load_dwordx4 v251, s[12:15], s54 offen offset:1024 lds
buffer_load_dwordx4 v251, s[12:15], s54 offen offset:2048 lds
buffer_load_dwordx4 v251, s[12:15], s54 offen offset:3072 lds
s_add_u32 m0, s53, 12288
s_add_u32 s54, s58, 384
buffer_load_dwordx4 v251, s[12:15], s54 offen offset:0 lds
buffer_load_dwordx4 v251, s[12:15], s54 offen offset:1024 lds
buffer_load_dwordx4 v251, s[12:15], s54 offen offset:2048 lds
buffer_load_dwordx4 v251, s[12:15], s54 offen offset:3072 lds
s_add_u32 s53, s53, 0x4000
s_cmp_eq_u32 s53, s57
s_cselect_b32 s53, s56, s53
s_add_u32 s58, s58, 0x4000
v_add_u32 v177, s52, v248
v_add_u32 v178, s52, v249
v_add_u32 v179, s52, v250
s_add_u32 s52, s52, 0x4000
s_cmp_eq_u32 s52, s57
s_cselect_b32 s52, s56, s52
s_cmp_eq_u32 s51, 1
s_cselect_b32 s54, s33, 0
v_and_b32 v192, s54, v188
v_and_b32 v193, s54, v188
v_and_b32 v194, s54, v188
v_and_b32 v195, s54, v188
s_waitcnt vmcnt(16)
ds_read_b128 v[32:35], v177 offset:0
ds_read_b128 v[64:67], v177 offset:2048
ds_read_b128 v[36:39], v177 offset:512
ds_read_b128 v[68:71], v177 offset:2560
ds_read_b128 v[40:43], v177 offset:4096
ds_read_b128 v[72:75], v177 offset:6144
ds_read_b128 v[44:47], v177 offset:4608
ds_read_b128 v[76:79], v177 offset:6656
ds_read_b128 v[48:51], v177 offset:8192
ds_read_b128 v[80:83], v177 offset:10240
ds_read_b128 v[52:55], v177 offset:8704
ds_read_b128 v[84:87], v177 offset:10752
ds_read_b128 v[56:59], v177 offset:12288
ds_read_b128 v[88:91], v177 offset:14336
ds_read_b128 v[60:63], v177 offset:12800
ds_read_b128 v[92:95], v177 offset:14848
s_waitcnt lgkmcnt(14)
v_mfma_f32_16x16x32_bf16 v[160:163], v[32:35], v[0:3], v[192:195]
v_mfma_f32_16x16x32_bf16 v[164:167], v[64:67], v[0:3], v[192:195]
s_waitcnt lgkmcnt(12)
v_mfma_f32_16x16x32_bf16 v[160:163], v[36:39], v[4:7], v[160:163]
v_mfma_f32_16x16x32_bf16 v[164:167], v[68:71], v[4:7], v[164:167]
s_waitcnt lgkmcnt(10)
v_mfma_f32_16x16x32_bf16 v[160:163], v[40:43], v[8:11], v[160:163]
v_mfma_f32_16x16x32_bf16 v[164:167], v[72:75], v[8:11], v[164:167]
s_waitcnt lgkmcnt(8)
v_mfma_f32_16x16x32_bf16 v[160:163], v[44:47], v[12:15], v[160:163]
v_mfma_f32_16x16x32_bf16 v[164:167], v[76:79], v[12:15], v[164:167]
s_waitcnt lgkmcnt(6)
v_mfma_f32_16x16x32_bf16 v[160:163], v[48:51], v[16:19], v[160:163]
v_mfma_f32_16x16x32_bf16 v[164:167], v[80:83], v[16:19], v[164:167]
s_waitcnt lgkmcnt(4)
v_mfma_f32_16x16x32_bf16 v[160:163], v[52:55], v[20:23], v[160:163]
v_mfma_f32_16x16x32_bf16 v[164:167], v[84:87], v[20:23], v[164:167]
s_waitcnt lgkmcnt(2)
v_mfma_f32_16x16x32_bf16 v[160:163], v[56:59], v[24:27], v[160:163]
v_mfma_f32_16x16x32_bf16 v[164:167], v[88:91], v[24:27], v[164:167]
s_waitcnt lgkmcnt(0)
v_mfma_f32_16x16x32_bf16 v[160:163], v[60:63], v[28:31], v[160:163]
v_mfma_f32_16x16x32_bf16 v[164:167], v[92:95], v[28:31], v[164:167]
ds_read_b64_tr_b16 v[96:97], v178 offset:0
ds_read_b64_tr_b16 v[98:99], v178 offset:2048
ds_read_b64_tr_b16 v[100:101], v179 offset:0
ds_read_b64_tr_b16 v[102:103], v179 offset:2048
ds_read_b64_tr_b16 v[104:105], v178 offset:512
ds_read_b64_tr_b16 v[106:107], v178 offset:2560
ds_read_b64_tr_b16 v[108:109], v179 offset:512
ds_read_b64_tr_b16 v[110:111], v179 offset:2560
ds_read_b64_tr_b16 v[112:113], v178 offset:4096
ds_read_b64_tr_b16 v[114:115], v178 offset:6144
ds_read_b64_tr_b16 v[116:117], v179 offset:4096
ds_read_b64_tr_b16 v[118:119], v179 offset:6144
ds_read_b64_tr_b16 v[120:121], v178 offset:4608
ds_read_b64_tr_b16 v[122:123], v178 offset:6656
ds_read_b64_tr_b16 v[124:125], v179 offset:4608
ds_read_b64_tr_b16 v[126:127], v179 offset:6656
ds_read_b64_tr_b16 v[128:129], v178 offset:8192
ds_read_b64_tr_b16 v[130:131], v178 offset:10240
ds_read_b64_tr_b16 v[132:133], v179 offset:8192
ds_read_b64_tr_b16 v[134:135], v179 offset:10240
ds_read_b64_tr_b16 v[136:137], v178 offset:8704
ds_read_b64_tr_b16 v[138:139], v178 offset:10752
ds_read_b64_tr_b16 v[140:141], v179 offset:8704
ds_read_b64_tr_b16 v[142:143], v179 offset:10752
ds_read_b64_tr_b16 v[144:145], v178 offset:12288
ds_read_b64_tr_b16 v[146:147], v178 offset:14336
ds_read_b64_tr_b16 v[148:149], v179 offset:12288
ds_read_b64_tr_b16 v[150:151], v179 offset:14336
ds_read_b64_tr_b16 v[152:153], v178 offset:12800
ds_read_b64_tr_b16 v[154:155], v178 offset:14848
ds_read_b64_tr_b16 v[156:157], v179 offset:12800
ds_read_b64_tr_b16 v[158:159], v179 offset:14848
s_nop 7
v_max3_f32 v175, v160, v161, v162
v_max3_f32 v175, v175, v163, v164
v_max3_f32 v175, v175, v165, v166
v_max3_f32 v175, v175, v167, v172
v_mov_b32 v176, v175
s_nop 1
v_permlane32_swap_b32 v175, v176
s_nop 1
v_max_f32 v175, v175, v176
v_mov_b32 v176, v175
s_nop 1
v_permlane16_swap_b32 v175, v176
s_nop 1
v_max_f32 v175, v175, v176
v_sub_f32 v174, v172, v175
v_exp_f32 v174, v174
v_mov_b32 v172, v175
v_sub_f32 v160, v160, v172
v_sub_f32 v161, v161, v172
v_sub_f32 v162, v162, v172
v_sub_f32 v163, v163, v172
v_sub_f32 v164, v164, v172
v_sub_f32 v165, v165, v172
v_sub_f32 v166, v166, v172
v_sub_f32 v167, v167, v172
v_exp_f32 v160, v160
v_exp_f32 v161, v161
v_exp_f32 v162, v162
v_exp_f32 v163, v163
v_exp_f32 v164, v164
v_exp_f32 v165, v165
v_exp_f32 v166, v166
v_exp_f32 v167, v167
v_cmp_neq_f32 vcc, 1.0, v174
v_cvt_pk_bf16_f32 v168, v160, v161
v_cvt_pk_bf16_f32 v169, v162, v163
v_cvt_pk_bf16_f32 v170, v164, v165
v_cvt_pk_bf16_f32 v171, v166, v167
s_cbranch_vccz LS_nors
v_accvgpr_read_b32 v180, a0
v_accvgpr_read_b32 v181, a1
v_accvgpr_read_b32 v182, a2
v_accvgpr_read_b32 v183, a3
v_accvgpr_read_b32 v184, a4
v_accvgpr_read_b32 v185, a5
v_accvgpr_read_b32 v186, a6
v_accvgpr_read_b32 v187, a7
v_mul_f32 v180, v180, v174
v_mul_f32 v181, v181, v174
v_mul_f32 v182, v182, v174
v_mul_f32 v183, v183, v174
v_mul_f32 v184, v184, v174
v_mul_f32 v185, v185, v174
v_mul_f32 v186, v186, v174
v_mul_f32 v187, v187, v174
v_accvgpr_write_b32 a0, v180
v_accvgpr_write_b32 a1, v181
v_accvgpr_write_b32 a2, v182
v_accvgpr_write_b32 a3, v183
v_accvgpr_write_b32 a4, v184
v_accvgpr_write_b32 a5, v185
v_accvgpr_write_b32 a6, v186
v_accvgpr_write_b32 a7, v187
v_accvgpr_read_b32 v180, a8
v_accvgpr_read_b32 v181, a9
v_accvgpr_read_b32 v182, a10
v_accvgpr_read_b32 v183, a11
v_accvgpr_read_b32 v184, a12
v_accvgpr_read_b32 v185, a13
v_accvgpr_read_b32 v186, a14
v_accvgpr_read_b32 v187, a15
v_mul_f32 v180, v180, v174
v_mul_f32 v181, v181, v174
v_mul_f32 v182, v182, v174
v_mul_f32 v183, v183, v174
v_mul_f32 v184, v184, v174
v_mul_f32 v185, v185, v174
v_mul_f32 v186, v186, v174
v_mul_f32 v187, v187, v174
v_accvgpr_write_b32 a8, v180
v_accvgpr_write_b32 a9, v181
v_accvgpr_write_b32 a10, v182
v_accvgpr_write_b32 a11, v183
v_accvgpr_write_b32 a12, v184
v_accvgpr_write_b32 a13, v185
v_accvgpr_write_b32 a14, v186
v_accvgpr_write_b32 a15, v187
v_accvgpr_read_b32 v180, a16
v_accvgpr_read_b32 v181, a17
v_accvgpr_read_b32 v182, a18
v_accvgpr_read_b32 v183, a19
v_accvgpr_read_b32 v184, a20
v_accvgpr_read_b32 v185, a21
v_accvgpr_read_b32 v186, a22
v_accvgpr_read_b32 v187, a23
v_mul_f32 v180, v180, v174
v_mul_f32 v181, v181, v174
v_mul_f32 v182, v182, v174
v_mul_f32 v183, v183, v174
v_mul_f32 v184, v184, v174
v_mul_f32 v185, v185, v174
v_mul_f32 v186, v186, v174
v_mul_f32 v187, v187, v174
v_accvgpr_write_b32 a16, v180
v_accvgpr_write_b32 a17, v181
v_accvgpr_write_b32 a18, v182
v_accvgpr_write_b32 a19, v183
v_accvgpr_write_b32 a20, v184
v_accvgpr_write_b32 a21, v185
v_accvgpr_write_b32 a22, v186
v_accvgpr_write_b32 a23, v187
v_accvgpr_read_b32 v180, a24
v_accvgpr_read_b32 v181, a25
v_accvgpr_read_b32 v182, a26
v_accvgpr_read_b32 v183, a27
v_accvgpr_read_b32 v184, a28
v_accvgpr_read_b32 v185, a29
v_accvgpr_read_b32 v186, a30
v_accvgpr_read_b32 v187, a31
v_mul_f32 v180, v180, v174
v_mul_f32 v181, v181, v174
v_mul_f32 v182, v182, v174
v_mul_f32 v183, v183, v174
v_mul_f32 v184, v184, v174
v_mul_f32 v185, v185, v174
v_mul_f32 v186, v186, v174
v_mul_f32 v187, v187, v174
v_accvgpr_write_b32 a24, v180
v_accvgpr_write_b32 a25, v181
v_accvgpr_write_b32 a26, v182
v_accvgpr_write_b32 a27, v183
v_accvgpr_write_b32 a28, v184
v_accvgpr_write_b32 a29, v185
v_accvgpr_write_b32 a30, v186
v_accvgpr_write_b32 a31, v187
v_accvgpr_read_b32 v180, a32
v_accvgpr_read_b32 v181, a33
v_accvgpr_read_b32 v182, a34
v_accvgpr_read_b32 v183, a35
v_accvgpr_read_b32 v184, a36
v_accvgpr_read_b32 v185, a37
v_accvgpr_read_b32 v186, a38
v_accvgpr_read_b32 v187, a39
v_mul_f32 v180, v180, v174
v_mul_f32 v181, v181, v174
v_mul_f32 v182, v182, v174
v_mul_f32 v183, v183, v174
v_mul_f32 v184, v184, v174
v_mul_f32 v185, v185, v174
v_mul_f32 v186, v186, v174
v_mul_f32 v187, v187, v174
v_accvgpr_write_b32 a32, v180
v_accvgpr_write_b32 a33, v181
v_accvgpr_write_b32 a34, v182
v_accvgpr_write_b32 a35, v183
v_accvgpr_write_b32 a36, v184
v_accvgpr_write_b32 a37, v185
v_accvgpr_write_b32 a38, v186
v_accvgpr_write_b32 a39, v187
v_accvgpr_read_b32 v180, a40
v_accvgpr_read_b32 v181, a41
v_accvgpr_read_b32 v182, a42
v_accvgpr_read_b32 v183, a43
v_accvgpr_read_b32 v184, a44
v_accvgpr_read_b32 v185, a45
v_accvgpr_read_b32 v186, a46
v_accvgpr_read_b32 v187, a47
v_mul_f32 v180, v180, v174
v_mul_f32 v181, v181, v174
v_mul_f32 v182, v182, v174
v_mul_f32 v183, v183, v174
v_mul_f32 v184, v184, v174
v_mul_f32 v185, v185, v174
v_mul_f32 v186, v186, v174
v_mul_f32 v187, v187, v174
v_accvgpr_write_b32 a40, v180
v_accvgpr_write_b32 a41, v181
v_accvgpr_write_b32 a42, v182
v_accvgpr_write_b32 a43, v183
v_accvgpr_write_b32 a44, v184
v_accvgpr_write_b32 a45, v185
v_accvgpr_write_b32 a46, v186
v_accvgpr_write_b32 a47, v187
v_accvgpr_read_b32 v180, a48
v_accvgpr_read_b32 v181, a49
v_accvgpr_read_b32 v182, a50
v_accvgpr_read_b32 v183, a51
v_accvgpr_read_b32 v184, a52
v_accvgpr_read_b32 v185, a53
v_accvgpr_read_b32 v186, a54
v_accvgpr_read_b32 v187, a55
v_mul_f32 v180, v180, v174
v_mul_f32 v181, v181, v174
v_mul_f32 v182, v182, v174
v_mul_f32 v183, v183, v174
v_mul_f32 v184, v184, v174
v_mul_f32 v185, v185, v174
v_mul_f32 v186, v186, v174
v_mul_f32 v187, v187, v174
v_accvgpr_write_b32 a48, v180
v_accvgpr_write_b32 a49, v181
v_accvgpr_write_b32 a50, v182
v_accvgpr_write_b32 a51, v183
v_accvgpr_write_b32 a52, v184
v_accvgpr_write_b32 a53, v185
v_accvgpr_write_b32 a54, v186
v_accvgpr_write_b32 a55, v187
v_accvgpr_read_b32 v180, a56
v_accvgpr_read_b32 v181, a57
v_accvgpr_read_b32 v182, a58
v_accvgpr_read_b32 v183, a59
v_accvgpr_read_b32 v184, a60
v_accvgpr_read_b32 v185, a61
v_accvgpr_read_b32 v186, a62
v_accvgpr_read_b32 v187, a63
v_mul_f32 v180, v180, v174
v_mul_f32 v181, v181, v174
v_mul_f32 v182, v182, v174
v_mul_f32 v183, v183, v174
v_mul_f32 v184, v184, v174
v_mul_f32 v185, v185, v174
v_mul_f32 v186, v186, v174
v_mul_f32 v187, v187, v174
v_accvgpr_write_b32 a56, v180
v_accvgpr_write_b32 a57, v181
v_accvgpr_write_b32 a58, v182
v_accvgpr_write_b32 a59, v183
v_accvgpr_write_b32 a60, v184
v_accvgpr_write_b32 a61, v185
v_accvgpr_write_b32 a62, v186
v_accvgpr_write_b32 a63, v187
LS_nors:
s_waitcnt lgkmcnt(0)
s_nop 1
v_mfma_f32_16x16x32_bf16 a[0:3], v[96:99], v[168:171], a[0:3]
v_mfma_f32_16x16x32_bf16 a[4:7], v[100:103], v[168:171], a[4:7]
v_mfma_f32_16x16x32_bf16 a[8:11], v[104:107], v[168:171], a[8:11]
v_mfma_f32_16x16x32_bf16 a[12:15], v[108:111], v[168:171], a[12:15]
v_mfma_f32_16x16x32_bf16 a[16:19], v[112:115], v[168:171], a[16:19]
v_mfma_f32_16x16x32_bf16 a[20:23], v[116:119], v[168:171], a[20:23]
v_mfma_f32_16x16x32_bf16 a[24:27], v[120:123], v[168:171], a[24:27]
v_mfma_f32_16x16x32_bf16 a[28:31], v[124:127], v[168:171], a[28:31]
v_mfma_f32_16x16x32_bf16 a[32:35], v[128:131], v[168:171], a[32:35]
v_mfma_f32_16x16x32_bf16 a[36:39], v[132:135], v[168:171], a[36:39]
v_mfma_f32_16x16x32_bf16 a[40:43], v[136:139], v[168:171], a[40:43]
v_mfma_f32_16x16x32_bf16 a[44:47], v[140:143], v[168:171], a[44:47]
v_mfma_f32_16x16x32_bf16 a[48:51], v[144:147], v[168:171], a[48:51]
v_mfma_f32_16x16x32_bf16 a[52:55], v[148:151], v[168:171], a[52:55]
v_mfma_f32_16x16x32_bf16 a[56:59], v[152:155], v[168:171], a[56:59]
v_mfma_f32_16x16x32_bf16 a[60:63], v[156:159], v[168:171], a[60:63]
s_sub_u32 s51, s51, 1
s_cmp_lg_u32 s51, 0
s_cbranch_scc1 LS_loop
s_nop 15
v_accvgpr_read_b32 v173, a0
v_accvgpr_read_b32 v180, a0
v_accvgpr_read_b32 v181, a1
v_accvgpr_read_b32 v182, a2
v_accvgpr_read_b32 v183, a3
v_accvgpr_read_b32 v184, a4
v_accvgpr_read_b32 v185, a5
v_accvgpr_read_b32 v186, a6
v_accvgpr_read_b32 v187, a7
v_cvt_pk_bf16_f32 v32, v180, v181
v_cvt_pk_bf16_f32 v33, v182, v183
v_cvt_pk_bf16_f32 v34, v184, v185
v_cvt_pk_bf16_f32 v35, v186, v187
buffer_store_dwordx4 v[32:35], v252, s[20:23], s40 offen offset:0 sc1
v_accvgpr_read_b32 v180, a8
v_accvgpr_read_b32 v181, a9
v_accvgpr_read_b32 v182, a10
v_accvgpr_read_b32 v183, a11
v_accvgpr_read_b32 v184, a12
v_accvgpr_read_b32 v185, a13
v_accvgpr_read_b32 v186, a14
v_accvgpr_read_b32 v187, a15
v_cvt_pk_bf16_f32 v36, v180, v181
v_cvt_pk_bf16_f32 v37, v182, v183
v_cvt_pk_bf16_f32 v38, v184, v185
v_cvt_pk_bf16_f32 v39, v186, v187
buffer_store_dwordx4 v[36:39], v252, s[20:23], s40 offen offset:1024 sc1
v_accvgpr_read_b32 v180, a16
v_accvgpr_read_b32 v181, a17
v_accvgpr_read_b32 v182, a18
v_accvgpr_read_b32 v183, a19
v_accvgpr_read_b32 v184, a20
v_accvgpr_read_b32 v185, a21
v_accvgpr_read_b32 v186, a22
v_accvgpr_read_b32 v187, a23
v_cvt_pk_bf16_f32 v40, v180, v181
v_cvt_pk_bf16_f32 v41, v182, v183
v_cvt_pk_bf16_f32 v42, v184, v185
v_cvt_pk_bf16_f32 v43, v186, v187
buffer_store_dwordx4 v[40:43], v252, s[20:23], s40 offen offset:2048 sc1
v_accvgpr_read_b32 v180, a24
v_accvgpr_read_b32 v181, a25
v_accvgpr_read_b32 v182, a26
v_accvgpr_read_b32 v183, a27
v_accvgpr_read_b32 v184, a28
v_accvgpr_read_b32 v185, a29
v_accvgpr_read_b32 v186, a30
v_accvgpr_read_b32 v187, a31
v_cvt_pk_bf16_f32 v44, v180, v181
v_cvt_pk_bf16_f32 v45, v182, v183
v_cvt_pk_bf16_f32 v46, v184, v185
v_cvt_pk_bf16_f32 v47, v186, v187
buffer_store_dwordx4 v[44:47], v252, s[20:23], s40 offen offset:3072 sc1
v_accvgpr_read_b32 v180, a32
v_accvgpr_read_b32 v181, a33
v_accvgpr_read_b32 v182, a34
v_accvgpr_read_b32 v183, a35
v_accvgpr_read_b32 v184, a36
v_accvgpr_read_b32 v185, a37
v_accvgpr_read_b32 v186, a38
v_accvgpr_read_b32 v187, a39
v_cvt_pk_bf16_f32 v48, v180, v181
v_cvt_pk_bf16_f32 v49, v182, v183
v_cvt_pk_bf16_f32 v50, v184, v185
v_cvt_pk_bf16_f32 v51, v186, v187
buffer_store_dwordx4 v[48:51], v252, s[20:23], s44 offen offset:0 sc1
v_accvgpr_read_b32 v180, a40
v_accvgpr_read_b32 v181, a41
v_accvgpr_read_b32 v182, a42
v_accvgpr_read_b32 v183, a43
v_accvgpr_read_b32 v184, a44
v_accvgpr_read_b32 v185, a45
v_accvgpr_read_b32 v186, a46
v_accvgpr_read_b32 v187, a47
v_cvt_pk_bf16_f32 v52, v180, v181
v_cvt_pk_bf16_f32 v53, v182, v183
v_cvt_pk_bf16_f32 v54, v184, v185
v_cvt_pk_bf16_f32 v55, v186, v187
buffer_store_dwordx4 v[52:55], v252, s[20:23], s44 offen offset:1024 sc1
v_accvgpr_read_b32 v180, a48
v_accvgpr_read_b32 v181, a49
v_accvgpr_read_b32 v182, a50
v_accvgpr_read_b32 v183, a51
v_accvgpr_read_b32 v184, a52
v_accvgpr_read_b32 v185, a53
v_accvgpr_read_b32 v186, a54
v_accvgpr_read_b32 v187, a55
v_cvt_pk_bf16_f32 v56, v180, v181
v_cvt_pk_bf16_f32 v57, v182, v183
v_cvt_pk_bf16_f32 v58, v184, v185
v_cvt_pk_bf16_f32 v59, v186, v187
buffer_store_dwordx4 v[56:59], v252, s[20:23], s44 offen offset:2048 sc1
v_accvgpr_read_b32 v180, a56
v_accvgpr_read_b32 v181, a57
v_accvgpr_read_b32 v182, a58
v_accvgpr_read_b32 v183, a59
v_accvgpr_read_b32 v184, a60
v_accvgpr_read_b32 v185, a61
v_accvgpr_read_b32 v186, a62
v_accvgpr_read_b32 v187, a63
v_cvt_pk_bf16_f32 v60, v180, v181
v_cvt_pk_bf16_f32 v61, v182, v183
v_cvt_pk_bf16_f32 v62, v184, v185
v_cvt_pk_bf16_f32 v63, v186, v187
buffer_store_dwordx4 v[60:63], v252, s[20:23], s44 offen offset:3072 sc1
v_lshlrev_b32 v175, 2, v252
s_mov_b64 exec, 0xffff
buffer_store_dwordx2 v[172:173], v175, s[24:27], s48 offen sc1
s_mov_b64 exec, -1
s_waitcnt vmcnt(0)
s_add_u32 s40, s40, 8192
s_add_u32 s48, s48, 1024
s_sub_u32 s55, s55, 1
s_cmp_lg_u32 s55, 0
s_cbranch_scc1 LS_q
s_barrier
s_add_u32 s56, s4, 0x1000000
s_addc_u32 s57, s5, 0
s_mov_b32 s58, 0x6c02000
s_mov_b32 s59, 0x00020000
s_mul_i32 s35, s37, 3
s_and_b32 s36, s35, 3
s_lshl_b32 s36, s36, 2
s_lshr_b32 s52, s35, 2
s_add_u32 s36, s36, s52
s_lshl_b32 s52, s38, 4
s_add_u32 s52, s52, s36
s_lshl_b32 s52, s52, 13
s_add_u32 s35, s35, 1
s_and_b32 s36, s35, 3
s_lshl_b32 s36, s36, 2
s_lshr_b32 s53, s35, 2
s_add_u32 s36, s36, s53
s_lshl_b32 s53, s38, 4
s_add_u32 s53, s53, s36
s_lshl_b32 s53, s53, 13
s_add_u32 s35, s35, 1
s_and_b32 s36, s35, 3
s_lshl_b32 s36, s36, 2
s_lshr_b32 s54, s35, 2
s_add_u32 s36, s36, s54
s_lshl_b32 s54, s38, 4
s_add_u32 s54, s54, s36
s_lshl_b32 s54, s54, 13
s_mov_b32 s99, 0
s_mov_b32 s98, 2
s_branch LC_again
LT_disp:
s_cmp_eq_u32 s34, 0
s_cbranch_scc1 LT_start
s_mov_b32 s41, s34
s_mul_i32 s40, s34, 6
s_add_u32 s40, s40, s37
s_add_u32 s40, s40, 42
s_cmp_lt_u32 s40, 60
s_cbranch_scc1 LE_common
s_branch L2_end
LT_start:
s_waitcnt lgkmcnt(0)
s_add_u32 s12, s4, 0x6800000
s_addc_u32 s13, s5, 0
s_mov_b32 s14, s49
s_mov_b32 s15, 0x00020000
s_add_u32 s8, s4, 0x0
s_addc_u32 s9, s5, 0
s_mov_b32 s10, 0x4e4000
s_mov_b32 s11, 0x00020000
s_mul_i32 s35, s37, 0x600000
s_add_u32 s20, s4, 0x2000000
s_addc_u32 s21, s5, 0
s_add_u32 s20, s20, s35
s_addc_u32 s21, s21, 0
s_mov_b32 s22, 0x4e4000
s_mov_b32 s23, 0x00020000
s_add_u32 s24, s4, 0x6000000
s_addc_u32 s25, s5, 0
s_mov_b32 s26, 0x9c800
s_mov_b32 s27, 0x00020000
s_lshl_b32 s35, s38, 4
s_lshl_b32 s41, s34, 2
s_add_u32 s35, s35, s41
s_lshl_b32 s40, s35, 13
s_lshl_b32 s48, s35, 10
s_lshl_b32 s35, s37, 3
s_add_u32 s48, s48, s35
v_bfe_u32 v248, v252, 4, 3
v_lshlrev_b32 v248, 6, v248
v_bfe_u32 v253, v252, 7, 1
v_lshl_or_b32 v248, v253, 10, v248
v_bfe_u32 v253, v252, 8, 2
v_lshl_or_b32 v248, v253, 4, v248
v_bfe_u32 v253, v252, 6, 1
v_lshlrev_b32 v253, 5, v253
v_xor_b32 v248, v248, v253
v_and_b32 v249, 0x1c0, v252
v_bfe_u32 v253, v252, 9, 1
v_lshl_or_b32 v249, v253, 10, v249
v_bfe_u32 v253, v252, 8, 1
v_lshl_or_b32 v249, v253, 5, v249
v_bfe_u32 v253, v252, 4, 2
v_lshl_or_b32 v249, v253, 3, v249
v_xor_b32 v250, 32, v249
s_mov_b32 s56, 90112
s_add_u32 s57, s56, 65536
s_mov_b32 s55, 1
v_bfe_i32 v188, v252, 8, 1
LT_q:
s_add_u32 s44, s40, 4096
buffer_load_dwordx4 v[0:3], v252, s[8:11], s40 offen offset:0
buffer_load_dwordx4 v[4:7], v252, s[8:11], s40 offen offset:1024
buffer_load_dwordx4 v[8:11], v252, s[8:11], s40 offen offset:2048
buffer_load_dwordx4 v[12:15], v252, s[8:11], s40 offen offset:3072
buffer_load_dwordx4 v[16:19], v252, s[8:11], s44 offen offset:0
buffer_load_dwordx4 v[20:23], v252, s[8:11], s44 offen offset:1024
buffer_load_dwordx4 v[24:27], v252, s[8:11], s44 offen offset:2048
buffer_load_dwordx4 v[28:31], v252, s[8:11], s44 offen offset:3072
s_mov_b32 s53, s56
s_mov_b32 s58, s39
s_add_u32 m0, s53, 0
s_add_u32 s54, s58, 0
buffer_load_dwordx4 v251, s[12:15], s54 offen offset:0 lds
buffer_load_dwordx4 v251, s[12:15], s54 offen offset:1024 lds
buffer_load_dwordx4 v251, s[12:15], s54 offen offset:2048 lds
buffer_load_dwordx4 v251, s[12:15], s54 offen offset:3072 lds
s_add_u32 m0, s53, 4096
s_add_u32 s54, s58, 128
buffer_load_dwordx4 v251, s[12:15], s54 offen offset:0 lds
buffer_load_dwordx4 v251, s[12:15], s54 offen offset:1024 lds
buffer_load_dwordx4 v251, s[12:15], s54 offen offset:2048 lds
buffer_load_dwordx4 v251, s[12:15], s54 offen offset:3072 lds
s_add_u32 m0, s53, 8192
s_add_u32 s54, s58, 256
buffer_load_dwordx4 v251, s[12:15], s54 offen offset:0 lds
buffer_load_dwordx4 v251, s[12:15], s54 offen offset:1024 lds
buffer_load_dwordx4 v251, s[12:15], s54 offen offset:2048 lds
buffer_load_dwordx4 v251, s[12:15], s54 offen offset:3072 lds
s_add_u32 m0, s53, 12288
s_add_u32 s54, s58, 384
buffer_load_dwordx4 v251, s[12:15], s54 offen offset:0 lds
buffer_load_dwordx4 v251, s[12:15], s54 offen offset:1024 lds
buffer_load_dwordx4 v251, s[12:15], s54 offen offset:2048 lds
buffer_load_dwordx4 v251, s[12:15], s54 offen offset:3072 lds
s_add_u32 s53, s53, 0x4000
s_cmp_eq_u32 s53, s57
s_cselect_b32 s53, s56, s53
s_add_u32 s58, s58, 0x4000
s_add_u32 m0, s53, 0
s_add_u32 s54, s58, 0
buffer_load_dwordx4 v251, s[12:15], s54 offen offset:0 lds
buffer_load_dwordx4 v251, s[12:15], s54 offen offset:1024 lds
buffer_load_dwordx4 v251, s[12:15], s54 offen offset:2048 lds
buffer_load_dwordx4 v251, s[12:15], s54 offen offset:3072 lds
s_add_u32 m0, s53, 4096
s_add_u32 s54, s58, 128
buffer_load_dwordx4 v251, s[12:15], s54 offen offset:0 lds
buffer_load_dwordx4 v251, s[12:15], s54 offen offset:1024 lds
buffer_load_dwordx4 v251, s[12:15], s54 offen offset:2048 lds
buffer_load_dwordx4 v251, s[12:15], s54 offen offset:3072 lds
s_add_u32 m0, s53, 8192
s_add_u32 s54, s58, 256
buffer_load_dwordx4 v251, s[12:15], s54 offen offset:0 lds
buffer_load_dwordx4 v251, s[12:15], s54 offen offset:1024 lds
buffer_load_dwordx4 v251, s[12:15], s54 offen offset:2048 lds
buffer_load_dwordx4 v251, s[12:15], s54 offen offset:3072 lds
s_add_u32 m0, s53, 12288
s_add_u32 s54, s58, 384
buffer_load_dwordx4 v251, s[12:15], s54 offen offset:0 lds
buffer_load_dwordx4 v251, s[12:15], s54 offen offset:1024 lds
buffer_load_dwordx4 v251, s[12:15], s54 offen offset:2048 lds
buffer_load_dwordx4 v251, s[12:15], s54 offen offset:3072 lds
s_add_u32 s53, s53, 0x4000
s_cmp_eq_u32 s53, s57
s_cselect_b32 s53, s56, s53
s_add_u32 s58, s58, 0x4000
s_add_u32 m0, s53, 0
s_add_u32 s54, s58, 0
buffer_load_dwordx4 v251, s[12:15], s54 offen offset:0 lds
buffer_load_dwordx4 v251, s[12:15], s54 offen offset:1024 lds
buffer_load_dwordx4 v251, s[12:15], s54 offen offset:2048 lds
buffer_load_dwordx4 v251, s[12:15], s54 offen offset:3072 lds
s_add_u32 m0, s53, 4096
s_add_u32 s54, s58, 128
buffer_load_dwordx4 v251, s[12:15], s54 offen offset:0 lds
buffer_load_dwordx4 v251, s[12:15], s54 offen offset:1024 lds
buffer_load_dwordx4 v251, s[12:15], s54 offen offset:2048 lds
buffer_load_dwordx4 v251, s[12:15], s54 offen offset:3072 lds
s_add_u32 m0, s53, 8192
s_add_u32 s54, s58, 256
buffer_load_dwordx4 v251, s[12:15], s54 offen offset:0 lds
buffer_load_dwordx4 v251, s[12:15], s54 offen offset:1024 lds
buffer_load_dwordx4 v251, s[12:15], s54 offen offset:2048 lds
buffer_load_dwordx4 v251, s[12:15], s54 offen offset:3072 lds
s_add_u32 m0, s53, 12288
s_add_u32 s54, s58, 384
buffer_load_dwordx4 v251, s[12:15], s54 offen offset:0 lds
buffer_load_dwordx4 v251, s[12:15], s54 offen offset:1024 lds
buffer_load_dwordx4 v251, s[12:15], s54 offen offset:2048 lds
buffer_load_dwordx4 v251, s[12:15], s54 offen offset:3072 lds
s_add_u32 s53, s53, 0x4000
s_cmp_eq_u32 s53, s57
s_cselect_b32 s53, s56, s53
s_add_u32 s58, s58, 0x4000
s_mov_b32 s51, s29
s_mov_b32 s52, s56
v_mov_b32 v172, 0xff800000
v_accvgpr_write_b32 a0, 0
v_accvgpr_write_b32 a1, 0
v_accvgpr_write_b32 a2, 0
v_accvgpr_write_b32 a3, 0
v_accvgpr_write_b32 a4, 0
v_accvgpr_write_b32 a5, 0
v_accvgpr_write_b32 a6, 0
v_accvgpr_write_b32 a7, 0
v_accvgpr_write_b32 a8, 0
v_accvgpr_write_b32 a9, 0
v_accvgpr_write_b32 a10, 0
v_accvgpr_write_b32 a11, 0
v_accvgpr_write_b32 a12, 0
v_accvgpr_write_b32 a13, 0
v_accvgpr_write_b32 a14, 0
v_accvgpr_write_b32 a15, 0
v_accvgpr_write_b32 a16, 0
v_accvgpr_write_b32 a17, 0
v_accvgpr_write_b32 a18, 0
v_accvgpr_write_b32 a19, 0
v_accvgpr_write_b32 a20, 0
v_accvgpr_write_b32 a21, 0
v_accvgpr_write_b32 a22, 0
v_accvgpr_write_b32 a23, 0
v_accvgpr_write_b32 a24, 0
v_accvgpr_write_b32 a25, 0
v_accvgpr_write_b32 a26, 0
v_accvgpr_write_b32 a27, 0
v_accvgpr_write_b32 a28, 0
v_accvgpr_write_b32 a29, 0
v_accvgpr_write_b32 a30, 0
v_accvgpr_write_b32 a31, 0
v_accvgpr_write_b32 a32, 0
v_accvgpr_write_b32 a33, 0
v_accvgpr_write_b32 a34, 0
v_accvgpr_write_b32 a35, 0
v_accvgpr_write_b32 a36, 0
v_accvgpr_write_b32 a37, 0
v_accvgpr_write_b32 a38, 0
v_accvgpr_write_b32 a39, 0
v_accvgpr_write_b32 a40, 0
v_accvgpr_write_b32 a41, 0
v_accvgpr_write_b32 a42, 0
v_accvgpr_write_b32 a43, 0
v_accvgpr_write_b32 a44, 0
v_accvgpr_write_b32 a45, 0
v_accvgpr_write_b32 a46, 0
v_accvgpr_write_b32 a47, 0
v_accvgpr_write_b32 a48, 0
v_accvgpr_write_b32 a49, 0
v_accvgpr_write_b32 a50, 0
v_accvgpr_write_b32 a51, 0
v_accvgpr_write_b32 a52, 0
v_accvgpr_write_b32 a53, 0
v_accvgpr_write_b32 a54, 0
v_accvgpr_write_b32 a55, 0
v_accvgpr_write_b32 a56, 0
v_accvgpr_write_b32 a57, 0
v_accvgpr_write_b32 a58, 0
v_accvgpr_write_b32 a59, 0
v_accvgpr_write_b32 a60, 0
v_accvgpr_write_b32 a61, 0
v_accvgpr_write_b32 a62, 0
v_accvgpr_write_b32 a63, 0
LT_loop:
s_add_u32 m0, s53, 0
s_add_u32 s54, s58, 0
buffer_load_dwordx4 v251, s[12:15], s54 offen offset:0 lds
buffer_load_dwordx4 v251, s[12:15], s54 offen offset:1024 lds
buffer_load_dwordx4 v251, s[12:15], s54 offen offset:2048 lds
buffer_load_dwordx4 v251, s[12:15], s54 offen offset:3072 lds
s_add_u32 m0, s53, 4096
s_add_u32 s54, s58, 128
buffer_load_dwordx4 v251, s[12:15], s54 offen offset:0 lds
buffer_load_dwordx4 v251, s[12:15], s54 offen offset:1024 lds
buffer_load_dwordx4 v251, s[12:15], s54 offen offset:2048 lds
buffer_load_dwordx4 v251, s[12:15], s54 offen offset:3072 lds
s_add_u32 m0, s53, 8192
s_add_u32 s54, s58, 256
buffer_load_dwordx4 v251, s[12:15], s54 offen offset:0 lds
buffer_load_dwordx4 v251, s[12:15], s54 offen offset:1024 lds
buffer_load_dwordx4 v251, s[12:15], s54 offen offset:2048 lds
buffer_load_dwordx4 v251, s[12:15], s54 offen offset:3072 lds
s_add_u32 m0, s53, 12288
s_add_u32 s54, s58, 384
buffer_load_dwordx4 v251, s[12:15], s54 offen offset:0 lds
buffer_load_dwordx4 v251, s[12:15], s54 offen offset:1024 lds
buffer_load_dwordx4 v251, s[12:15], s54 offen offset:2048 lds
buffer_load_dwordx4 v251, s[12:15], s54 offen offset:3072 lds
s_add_u32 s53, s53, 0x4000
s_cmp_eq_u32 s53, s57
s_cselect_b32 s53, s56, s53
s_add_u32 s58, s58, 0x4000
v_add_u32 v177, s52, v248
v_add_u32 v178, s52, v249
v_add_u32 v179, s52, v250
s_add_u32 s52, s52, 0x4000
s_cmp_eq_u32 s52, s57
s_cselect_b32 s52, s56, s52
s_cmp_eq_u32 s51, 1
s_cselect_b32 s54, s33, 0
v_and_b32 v192, s54, v188
v_and_b32 v193, s54, v188
v_and_b32 v194, s54, v188
v_and_b32 v195, s54, v188
s_waitcnt vmcnt(48)
ds_read_b128 v[32:35], v177 offset:0
ds_read_b128 v[64:67], v177 offset:2048
ds_read_b128 v[36:39], v177 offset:512
ds_read_b128 v[68:71], v177 offset:2560
ds_read_b128 v[40:43], v177 offset:4096
ds_read_b128 v[72:75], v177 offset:6144
ds_read_b128 v[44:47], v177 offset:4608
ds_read_b128 v[76:79], v177 offset:6656
ds_read_b128 v[48:51], v177 offset:8192
ds_read_b128 v[80:83], v177 offset:10240
ds_read_b128 v[52:55], v177 offset:8704
ds_read_b128 v[84:87], v177 offset:10752
ds_read_b128 v[56:59], v177 offset:12288
ds_read_b128 v[88:91], v177 offset:14336
ds_read_b128 v[60:63], v177 offset:12800
ds_read_b128 v[92:95], v177 offset:14848
s_waitcnt lgkmcnt(14)
v_mfma_f32_16x16x32_bf16 v[160:163], v[32:35], v[0:3], v[192:195]
v_mfma_f32_16x16x32_bf16 v[164:167], v[64:67], v[0:3], v[192:195]
s_waitcnt lgkmcnt(12)
v_mfma_f32_16x16x32_bf16 v[160:163], v[36:39], v[4:7], v[160:163]
v_mfma_f32_16x16x32_bf16 v[164:167], v[68:71], v[4:7], v[164:167]
s_waitcnt lgkmcnt(10)
v_mfma_f32_16x16x32_bf16 v[160:163], v[40:43], v[8:11], v[160:163]
v_mfma_f32_16x16x32_bf16 v[164:167], v[72:75], v[8:11], v[164:167]
s_waitcnt lgkmcnt(8)
v_mfma_f32_16x16x32_bf16 v[160:163], v[44:47], v[12:15], v[160:163]
v_mfma_f32_16x16x32_bf16 v[164:167], v[76:79], v[12:15], v[164:167]
s_waitcnt lgkmcnt(6)
v_mfma_f32_16x16x32_bf16 v[160:163], v[48:51], v[16:19], v[160:163]
v_mfma_f32_16x16x32_bf16 v[164:167], v[80:83], v[16:19], v[164:167]
s_waitcnt lgkmcnt(4)
v_mfma_f32_16x16x32_bf16 v[160:163], v[52:55], v[20:23], v[160:163]
v_mfma_f32_16x16x32_bf16 v[164:167], v[84:87], v[20:23], v[164:167]
s_waitcnt lgkmcnt(2)
v_mfma_f32_16x16x32_bf16 v[160:163], v[56:59], v[24:27], v[160:163]
v_mfma_f32_16x16x32_bf16 v[164:167], v[88:91], v[24:27], v[164:167]
s_waitcnt lgkmcnt(0)
v_mfma_f32_16x16x32_bf16 v[160:163], v[60:63], v[28:31], v[160:163]
v_mfma_f32_16x16x32_bf16 v[164:167], v[92:95], v[28:31], v[164:167]
ds_read_b64_tr_b16 v[96:97], v178 offset:0
ds_read_b64_tr_b16 v[98:99], v178 offset:2048
ds_read_b64_tr_b16 v[100:101], v179 offset:0
ds_read_b64_tr_b16 v[102:103], v179 offset:2048
ds_read_b64_tr_b16 v[104:105], v178 offset:512
ds_read_b64_tr_b16 v[106:107], v178 offset:2560
ds_read_b64_tr_b16 v[108:109], v179 offset:512
ds_read_b64_tr_b16 v[110:111], v179 offset:2560
ds_read_b64_tr_b16 v[112:113], v178 offset:4096
ds_read_b64_tr_b16 v[114:115], v178 offset:6144
ds_read_b64_tr_b16 v[116:117], v179 offset:4096
ds_read_b64_tr_b16 v[118:119], v179 offset:6144
ds_read_b64_tr_b16 v[120:121], v178 offset:4608
ds_read_b64_tr_b16 v[122:123], v178 offset:6656
ds_read_b64_tr_b16 v[124:125], v179 offset:4608
ds_read_b64_tr_b16 v[126:127], v179 offset:6656
ds_read_b64_tr_b16 v[128:129], v178 offset:8192
ds_read_b64_tr_b16 v[130:131], v178 offset:10240
ds_read_b64_tr_b16 v[132:133], v179 offset:8192
ds_read_b64_tr_b16 v[134:135], v179 offset:10240
ds_read_b64_tr_b16 v[136:137], v178 offset:8704
ds_read_b64_tr_b16 v[138:139], v178 offset:10752
ds_read_b64_tr_b16 v[140:141], v179 offset:8704
ds_read_b64_tr_b16 v[142:143], v179 offset:10752
ds_read_b64_tr_b16 v[144:145], v178 offset:12288
ds_read_b64_tr_b16 v[146:147], v178 offset:14336
ds_read_b64_tr_b16 v[148:149], v179 offset:12288
ds_read_b64_tr_b16 v[150:151], v179 offset:14336
ds_read_b64_tr_b16 v[152:153], v178 offset:12800
ds_read_b64_tr_b16 v[154:155], v178 offset:14848
ds_read_b64_tr_b16 v[156:157], v179 offset:12800
ds_read_b64_tr_b16 v[158:159], v179 offset:14848
s_nop 7
v_max3_f32 v175, v160, v161, v162
v_max3_f32 v175, v175, v163, v164
v_max3_f32 v175, v175, v165, v166
v_max3_f32 v175, v175, v167, v172
v_mov_b32 v176, v175
s_nop 1
v_permlane32_swap_b32 v175, v176
s_nop 1
v_max_f32 v175, v175, v176
v_mov_b32 v176, v175
s_nop 1
v_permlane16_swap_b32 v175, v176
s_nop 1
v_max_f32 v175, v175, v176
v_sub_f32 v174, v172, v175
v_exp_f32 v174, v174
v_mov_b32 v172, v175
v_sub_f32 v160, v160, v172
v_sub_f32 v161, v161, v172
v_sub_f32 v162, v162, v172
v_sub_f32 v163, v163, v172
v_sub_f32 v164, v164, v172
v_sub_f32 v165, v165, v172
v_sub_f32 v166, v166, v172
v_sub_f32 v167, v167, v172
v_exp_f32 v160, v160
v_exp_f32 v161, v161
v_exp_f32 v162, v162
v_exp_f32 v163, v163
v_exp_f32 v164, v164
v_exp_f32 v165, v165
v_exp_f32 v166, v166
v_exp_f32 v167, v167
v_cmp_neq_f32 vcc, 1.0, v174
v_cvt_pk_bf16_f32 v168, v160, v161
v_cvt_pk_bf16_f32 v169, v162, v163
v_cvt_pk_bf16_f32 v170, v164, v165
v_cvt_pk_bf16_f32 v171, v166, v167
s_cbranch_vccz LT_nors
v_accvgpr_read_b32 v180, a0
v_accvgpr_read_b32 v181, a1
v_accvgpr_read_b32 v182, a2
v_accvgpr_read_b32 v183, a3
v_accvgpr_read_b32 v184, a4
v_accvgpr_read_b32 v185, a5
v_accvgpr_read_b32 v186, a6
v_accvgpr_read_b32 v187, a7
v_mul_f32 v180, v180, v174
v_mul_f32 v181, v181, v174
v_mul_f32 v182, v182, v174
v_mul_f32 v183, v183, v174
v_mul_f32 v184, v184, v174
v_mul_f32 v185, v185, v174
v_mul_f32 v186, v186, v174
v_mul_f32 v187, v187, v174
v_accvgpr_write_b32 a0, v180
v_accvgpr_write_b32 a1, v181
v_accvgpr_write_b32 a2, v182
v_accvgpr_write_b32 a3, v183
v_accvgpr_write_b32 a4, v184
v_accvgpr_write_b32 a5, v185
v_accvgpr_write_b32 a6, v186
v_accvgpr_write_b32 a7, v187
v_accvgpr_read_b32 v180, a8
v_accvgpr_read_b32 v181, a9
v_accvgpr_read_b32 v182, a10
v_accvgpr_read_b32 v183, a11
v_accvgpr_read_b32 v184, a12
v_accvgpr_read_b32 v185, a13
v_accvgpr_read_b32 v186, a14
v_accvgpr_read_b32 v187, a15
v_mul_f32 v180, v180, v174
v_mul_f32 v181, v181, v174
v_mul_f32 v182, v182, v174
v_mul_f32 v183, v183, v174
v_mul_f32 v184, v184, v174
v_mul_f32 v185, v185, v174
v_mul_f32 v186, v186, v174
v_mul_f32 v187, v187, v174
v_accvgpr_write_b32 a8, v180
v_accvgpr_write_b32 a9, v181
v_accvgpr_write_b32 a10, v182
v_accvgpr_write_b32 a11, v183
v_accvgpr_write_b32 a12, v184
v_accvgpr_write_b32 a13, v185
v_accvgpr_write_b32 a14, v186
v_accvgpr_write_b32 a15, v187
v_accvgpr_read_b32 v180, a16
v_accvgpr_read_b32 v181, a17
v_accvgpr_read_b32 v182, a18
v_accvgpr_read_b32 v183, a19
v_accvgpr_read_b32 v184, a20
v_accvgpr_read_b32 v185, a21
v_accvgpr_read_b32 v186, a22
v_accvgpr_read_b32 v187, a23
v_mul_f32 v180, v180, v174
v_mul_f32 v181, v181, v174
v_mul_f32 v182, v182, v174
v_mul_f32 v183, v183, v174
v_mul_f32 v184, v184, v174
v_mul_f32 v185, v185, v174
v_mul_f32 v186, v186, v174
v_mul_f32 v187, v187, v174
v_accvgpr_write_b32 a16, v180
v_accvgpr_write_b32 a17, v181
v_accvgpr_write_b32 a18, v182
v_accvgpr_write_b32 a19, v183
v_accvgpr_write_b32 a20, v184
v_accvgpr_write_b32 a21, v185
v_accvgpr_write_b32 a22, v186
v_accvgpr_write_b32 a23, v187
v_accvgpr_read_b32 v180, a24
v_accvgpr_read_b32 v181, a25
v_accvgpr_read_b32 v182, a26
v_accvgpr_read_b32 v183, a27
v_accvgpr_read_b32 v184, a28
v_accvgpr_read_b32 v185, a29
v_accvgpr_read_b32 v186, a30
v_accvgpr_read_b32 v187, a31
v_mul_f32 v180, v180, v174
v_mul_f32 v181, v181, v174
v_mul_f32 v182, v182, v174
v_mul_f32 v183, v183, v174
v_mul_f32 v184, v184, v174
v_mul_f32 v185, v185, v174
v_mul_f32 v186, v186, v174
v_mul_f32 v187, v187, v174
v_accvgpr_write_b32 a24, v180
v_accvgpr_write_b32 a25, v181
v_accvgpr_write_b32 a26, v182
v_accvgpr_write_b32 a27, v183
v_accvgpr_write_b32 a28, v184
v_accvgpr_write_b32 a29, v185
v_accvgpr_write_b32 a30, v186
v_accvgpr_write_b32 a31, v187
v_accvgpr_read_b32 v180, a32
v_accvgpr_read_b32 v181, a33
v_accvgpr_read_b32 v182, a34
v_accvgpr_read_b32 v183, a35
v_accvgpr_read_b32 v184, a36
v_accvgpr_read_b32 v185, a37
v_accvgpr_read_b32 v186, a38
v_accvgpr_read_b32 v187, a39
v_mul_f32 v180, v180, v174
v_mul_f32 v181, v181, v174
v_mul_f32 v182, v182, v174
v_mul_f32 v183, v183, v174
v_mul_f32 v184, v184, v174
v_mul_f32 v185, v185, v174
v_mul_f32 v186, v186, v174
v_mul_f32 v187, v187, v174
v_accvgpr_write_b32 a32, v180
v_accvgpr_write_b32 a33, v181
v_accvgpr_write_b32 a34, v182
v_accvgpr_write_b32 a35, v183
v_accvgpr_write_b32 a36, v184
v_accvgpr_write_b32 a37, v185
v_accvgpr_write_b32 a38, v186
v_accvgpr_write_b32 a39, v187
v_accvgpr_read_b32 v180, a40
v_accvgpr_read_b32 v181, a41
v_accvgpr_read_b32 v182, a42
v_accvgpr_read_b32 v183, a43
v_accvgpr_read_b32 v184, a44
v_accvgpr_read_b32 v185, a45
v_accvgpr_read_b32 v186, a46
v_accvgpr_read_b32 v187, a47
v_mul_f32 v180, v180, v174
v_mul_f32 v181, v181, v174
v_mul_f32 v182, v182, v174
v_mul_f32 v183, v183, v174
v_mul_f32 v184, v184, v174
v_mul_f32 v185, v185, v174
v_mul_f32 v186, v186, v174
v_mul_f32 v187, v187, v174
v_accvgpr_write_b32 a40, v180
v_accvgpr_write_b32 a41, v181
v_accvgpr_write_b32 a42, v182
v_accvgpr_write_b32 a43, v183
v_accvgpr_write_b32 a44, v184
v_accvgpr_write_b32 a45, v185
v_accvgpr_write_b32 a46, v186
v_accvgpr_write_b32 a47, v187
v_accvgpr_read_b32 v180, a48
v_accvgpr_read_b32 v181, a49
v_accvgpr_read_b32 v182, a50
v_accvgpr_read_b32 v183, a51
v_accvgpr_read_b32 v184, a52
v_accvgpr_read_b32 v185, a53
v_accvgpr_read_b32 v186, a54
v_accvgpr_read_b32 v187, a55
v_mul_f32 v180, v180, v174
v_mul_f32 v181, v181, v174
v_mul_f32 v182, v182, v174
v_mul_f32 v183, v183, v174
v_mul_f32 v184, v184, v174
v_mul_f32 v185, v185, v174
v_mul_f32 v186, v186, v174
v_mul_f32 v187, v187, v174
v_accvgpr_write_b32 a48, v180
v_accvgpr_write_b32 a49, v181
v_accvgpr_write_b32 a50, v182
v_accvgpr_write_b32 a51, v183
v_accvgpr_write_b32 a52, v184
v_accvgpr_write_b32 a53, v185
v_accvgpr_write_b32 a54, v186
v_accvgpr_write_b32 a55, v187
v_accvgpr_read_b32 v180, a56
v_accvgpr_read_b32 v181, a57
v_accvgpr_read_b32 v182, a58
v_accvgpr_read_b32 v183, a59
v_accvgpr_read_b32 v184, a60
v_accvgpr_read_b32 v185, a61
v_accvgpr_read_b32 v186, a62
v_accvgpr_read_b32 v187, a63
v_mul_f32 v180, v180, v174
v_mul_f32 v181, v181, v174
v_mul_f32 v182, v182, v174
v_mul_f32 v183, v183, v174
v_mul_f32 v184, v184, v174
v_mul_f32 v185, v185, v174
v_mul_f32 v186, v186, v174
v_mul_f32 v187, v187, v174
v_accvgpr_write_b32 a56, v180
v_accvgpr_write_b32 a57, v181
v_accvgpr_write_b32 a58, v182
v_accvgpr_write_b32 a59, v183
v_accvgpr_write_b32 a60, v184
v_accvgpr_write_b32 a61, v185
v_accvgpr_write_b32 a62, v186
v_accvgpr_write_b32 a63, v187
LT_nors:
s_waitcnt lgkmcnt(0)
s_nop 1
v_mfma_f32_16x16x32_bf16 a[0:3], v[96:99], v[168:171], a[0:3]
v_mfma_f32_16x16x32_bf16 a[4:7], v[100:103], v[168:171], a[4:7]
v_mfma_f32_16x16x32_bf16 a[8:11], v[104:107], v[168:171], a[8:11]
v_mfma_f32_16x16x32_bf16 a[12:15], v[108:111], v[168:171], a[12:15]
v_mfma_f32_16x16x32_bf16 a[16:19], v[112:115], v[168:171], a[16:19]
v_mfma_f32_16x16x32_bf16 a[20:23], v[116:119], v[168:171], a[20:23]
v_mfma_f32_16x16x32_bf16 a[24:27], v[120:123], v[168:171], a[24:27]
v_mfma_f32_16x16x32_bf16 a[28:31], v[124:127], v[168:171], a[28:31]
v_mfma_f32_16x16x32_bf16 a[32:35], v[128:131], v[168:171], a[32:35]
v_mfma_f32_16x16x32_bf16 a[36:39], v[132:135], v[168:171], a[36:39]
v_mfma_f32_16x16x32_bf16 a[40:43], v[136:139], v[168:171], a[40:43]
v_mfma_f32_16x16x32_bf16 a[44:47], v[140:143], v[168:171], a[44:47]
v_mfma_f32_16x16x32_bf16 a[48:51], v[144:147], v[168:171], a[48:51]
v_mfma_f32_16x16x32_bf16 a[52:55], v[148:151], v[168:171], a[52:55]
v_mfma_f32_16x16x32_bf16 a[56:59], v[152:155], v[168:171], a[56:59]
v_mfma_f32_16x16x32_bf16 a[60:63], v[156:159], v[168:171], a[60:63]
s_sub_u32 s51, s51, 1
s_cmp_lg_u32 s51, 0
s_cbranch_scc1 LT_loop
s_nop 15
v_accvgpr_read_b32 v173, a0
v_accvgpr_read_b32 v180, a0
v_accvgpr_read_b32 v181, a1
v_accvgpr_read_b32 v182, a2
v_accvgpr_read_b32 v183, a3
v_accvgpr_read_b32 v184, a4
v_accvgpr_read_b32 v185, a5
v_accvgpr_read_b32 v186, a6
v_accvgpr_read_b32 v187, a7
v_cvt_pk_bf16_f32 v32, v180, v181
v_cvt_pk_bf16_f32 v33, v182, v183
v_cvt_pk_bf16_f32 v34, v184, v185
v_cvt_pk_bf16_f32 v35, v186, v187
buffer_store_dwordx4 v[32:35], v252, s[20:23], s40 offen offset:0 sc1
v_accvgpr_read_b32 v180, a8
v_accvgpr_read_b32 v181, a9
v_accvgpr_read_b32 v182, a10
v_accvgpr_read_b32 v183, a11
v_accvgpr_read_b32 v184, a12
v_accvgpr_read_b32 v185, a13
v_accvgpr_read_b32 v186, a14
v_accvgpr_read_b32 v187, a15
v_cvt_pk_bf16_f32 v36, v180, v181
v_cvt_pk_bf16_f32 v37, v182, v183
v_cvt_pk_bf16_f32 v38, v184, v185
v_cvt_pk_bf16_f32 v39, v186, v187
buffer_store_dwordx4 v[36:39], v252, s[20:23], s40 offen offset:1024 sc1
v_accvgpr_read_b32 v180, a16
v_accvgpr_read_b32 v181, a17
v_accvgpr_read_b32 v182, a18
v_accvgpr_read_b32 v183, a19
v_accvgpr_read_b32 v184, a20
v_accvgpr_read_b32 v185, a21
v_accvgpr_read_b32 v186, a22
v_accvgpr_read_b32 v187, a23
v_cvt_pk_bf16_f32 v40, v180, v181
v_cvt_pk_bf16_f32 v41, v182, v183
v_cvt_pk_bf16_f32 v42, v184, v185
v_cvt_pk_bf16_f32 v43, v186, v187
buffer_store_dwordx4 v[40:43], v252, s[20:23], s40 offen offset:2048 sc1
v_accvgpr_read_b32 v180, a24
v_accvgpr_read_b32 v181, a25
v_accvgpr_read_b32 v182, a26
v_accvgpr_read_b32 v183, a27
v_accvgpr_read_b32 v184, a28
v_accvgpr_read_b32 v185, a29
v_accvgpr_read_b32 v186, a30
v_accvgpr_read_b32 v187, a31
v_cvt_pk_bf16_f32 v44, v180, v181
v_cvt_pk_bf16_f32 v45, v182, v183
v_cvt_pk_bf16_f32 v46, v184, v185
v_cvt_pk_bf16_f32 v47, v186, v187
buffer_store_dwordx4 v[44:47], v252, s[20:23], s40 offen offset:3072 sc1
v_accvgpr_read_b32 v180, a32
v_accvgpr_read_b32 v181, a33
v_accvgpr_read_b32 v182, a34
v_accvgpr_read_b32 v183, a35
v_accvgpr_read_b32 v184, a36
v_accvgpr_read_b32 v185, a37
v_accvgpr_read_b32 v186, a38
v_accvgpr_read_b32 v187, a39
v_cvt_pk_bf16_f32 v48, v180, v181
v_cvt_pk_bf16_f32 v49, v182, v183
v_cvt_pk_bf16_f32 v50, v184, v185
v_cvt_pk_bf16_f32 v51, v186, v187
buffer_store_dwordx4 v[48:51], v252, s[20:23], s44 offen offset:0 sc1
v_accvgpr_read_b32 v180, a40
v_accvgpr_read_b32 v181, a41
v_accvgpr_read_b32 v182, a42
v_accvgpr_read_b32 v183, a43
v_accvgpr_read_b32 v184, a44
v_accvgpr_read_b32 v185, a45
v_accvgpr_read_b32 v186, a46
v_accvgpr_read_b32 v187, a47
v_cvt_pk_bf16_f32 v52, v180, v181
v_cvt_pk_bf16_f32 v53, v182, v183
v_cvt_pk_bf16_f32 v54, v184, v185
v_cvt_pk_bf16_f32 v55, v186, v187
buffer_store_dwordx4 v[52:55], v252, s[20:23], s44 offen offset:1024 sc1
v_accvgpr_read_b32 v180, a48
v_accvgpr_read_b32 v181, a49
v_accvgpr_read_b32 v182, a50
v_accvgpr_read_b32 v183, a51
v_accvgpr_read_b32 v184, a52
v_accvgpr_read_b32 v185, a53
v_accvgpr_read_b32 v186, a54
v_accvgpr_read_b32 v187, a55
v_cvt_pk_bf16_f32 v56, v180, v181
v_cvt_pk_bf16_f32 v57, v182, v183
v_cvt_pk_bf16_f32 v58, v184, v185
v_cvt_pk_bf16_f32 v59, v186, v187
buffer_store_dwordx4 v[56:59], v252, s[20:23], s44 offen offset:2048 sc1
v_accvgpr_read_b32 v180, a56
v_accvgpr_read_b32 v181, a57
v_accvgpr_read_b32 v182, a58
v_accvgpr_read_b32 v183, a59
v_accvgpr_read_b32 v184, a60
v_accvgpr_read_b32 v185, a61
v_accvgpr_read_b32 v186, a62
v_accvgpr_read_b32 v187, a63
v_cvt_pk_bf16_f32 v60, v180, v181
v_cvt_pk_bf16_f32 v61, v182, v183
v_cvt_pk_bf16_f32 v62, v184, v185
v_cvt_pk_bf16_f32 v63, v186, v187
buffer_store_dwordx4 v[60:63], v252, s[20:23], s44 offen offset:3072 sc1
v_lshlrev_b32 v175, 2, v252
s_mov_b64 exec, 0xffff
buffer_store_dwordx2 v[172:173], v175, s[24:27], s48 offen sc1
s_mov_b64 exec, -1
s_waitcnt vmcnt(0)
s_add_u32 s40, s40, 8192
s_add_u32 s48, s48, 1024
s_sub_u32 s55, s55, 1
s_cmp_lg_u32 s55, 0
s_cbranch_scc1 LT_q
s_add_u32 s52, s4, 0x7c00000
s_addc_u32 s53, s5, 0
s_mov_b32 s54, 0x2000
s_mov_b32 s55, 0x00020000
v_mov_b32 v1, 4992
v_mov_b32 v2, 1
s_mov_b64 exec, 1
s_waitcnt vmcnt(0)
buffer_atomic_add v2, v1, s[52:55], 0 offen
s_mov_b64 exec, -1
s_branch L2_fin
LE_start:
s_cmp_ge_u32 s37, 32
s_cbranch_scc1 L2_end
v_lshrrev_b32 v1, 6, v0
s_sub_u32 s37, s37, 30
s_lshl_b32 s35, s35, 1
v_readfirstlane_b32 s41, v1
s_add_u32 s35, s35, s37
s_mul_i32 s35, s35, 3
s_add_u32 s40, s35, s41
s_cmp_ge_u32 s41, 3
s_cbranch_scc1 LC_help
LE_common:
v_and_b32 v1, 63, v0
s_mul_i32 s58, s40, 167
s_mov_b32 s59, 167
s_mov_b32 s42, 0
s_mov_b32 s49, 512
v_lshrrev_b32 v33, 1, v1
v_and_b32 v34, 1, v1
v_mul_u32_u24 v6, 0x5000, v33
v_lshl_add_u32 v6, v34, 4, v6
v_lshlrev_b32 v33, 2, v33
s_mul_i32 s50, s40, 655360
s_mul_i32 s48, s40, 128
s_waitcnt lgkmcnt(0)
s_add_u32 s8, s4, 0x7800000
s_addc_u32 s9, s5, 0
s_mov_b32 s10, 0x2000
s_mov_b32 s11, 0x00020000
s_add_u32 s12, s4, 0x8000000
s_addc_u32 s13, s5, 0
s_mov_b32 s14, 0x2800000
s_mov_b32 s15, 0x00020000
buffer_load_dword v4, v33, s[8:11], s48 offen
buffer_load_dwordx4 v[192:195], v6, s[12:15], s50 offen offset:0
buffer_load_dwordx4 v[196:199], v6, s[12:15], s50 offen offset:32
buffer_load_dwordx4 v[200:203], v6, s[12:15], s50 offen offset:64
buffer_load_dwordx4 v[204:207], v6, s[12:15], s50 offen offset:96
buffer_load_dwordx4 v[208:211], v6, s[12:15], s50 offen offset:128
buffer_load_dwordx4 v[212:215], v6, s[12:15], s50 offen offset:160
buffer_load_dwordx4 v[216:219], v6, s[12:15], s50 offen offset:192
buffer_load_dwordx4 v[220:223], v6, s[12:15], s50 offen offset:224
buffer_load_dwordx4 v[224:227], v6, s[12:15], s50 offen offset:256
buffer_load_dwordx4 v[228:231], v6, s[12:15], s50 offen offset:288
buffer_load_dwordx4 v[232:235], v6, s[12:15], s50 offen offset:320
buffer_load_dwordx4 v[236:239], v6, s[12:15], s50 offen offset:352
buffer_load_dwordx4 v[240:243], v6, s[12:15], s50 offen offset:384
buffer_load_dwordx4 v[244:247], v6, s[12:15], s50 offen offset:416
buffer_load_dwordx4 v[248:251], v6, s[12:15], s50 offen offset:448
buffer_load_dwordx4 v[252:255], v6, s[12:15], s50 offen offset:480
s_add_u32 s16, s16, 0x0
s_addc_u32 s17, s17, 0
s_mov_b32 s18, 0x4e20
s_mov_b32 s19, 0x00020000
v_lshlrev_b32 v35, 1, v1
s_lshl_b32 s48, s58, 1
buffer_load_ushort v76, v35, s[16:19], s48 offen offset:0
buffer_load_ushort v77, v35, s[16:19], s48 offen offset:128
buffer_load_ushort v78, v35, s[16:19], s48 offen offset:256
s_add_u32 s16, s4, 0x6800000
s_addc_u32 s17, s5, 0
s_mov_b32 s18, 0x4e2000
s_mov_b32 s19, 0x00020000
s_add_u32 s20, s4, 0x7000000
s_addc_u32 s21, s5, 0
s_mov_b32 s22, 0x4e2000
s_mov_b32 s23, 0x00020000
v_lshlrev_b32 v5, 2, v34
v_and_b32 v2, 15, v1
v_lshrrev_b32 v3, 4, v1
v_mov_b32 v16, 1
v_mov_b32 v17, 4
v_and_b32 v33, 1, v2
v_lshlrev_b32 v33, 4, v33
v_lshlrev_b32 v33, v33, v16
v_mul_u32_u24 v33, 0x3f80, v33
v_lshrrev_b32 v34, 1, v2
v_cmp_eq_u32 vcc, 0, v34
s_nop 1
v_cndmask_b32 v40, 0, v33, vcc
v_cmp_eq_u32 vcc, 1, v34
s_nop 1
v_cndmask_b32 v41, 0, v33, vcc
v_cmp_eq_u32 vcc, 2, v34
s_nop 1
v_cndmask_b32 v42, 0, v33, vcc
v_cmp_eq_u32 vcc, 3, v34
s_nop 1
v_cndmask_b32 v43, 0, v33, vcc
v_cmp_eq_u32 vcc, 4, v34
s_nop 1
v_cndmask_b32 v44, 0, v33, vcc
v_cmp_eq_u32 vcc, 5, v34
s_nop 1
v_cndmask_b32 v45, 0, v33, vcc
v_cmp_eq_u32 vcc, 6, v34
s_nop 1
v_cndmask_b32 v46, 0, v33, vcc
v_cmp_eq_u32 vcc, 7, v34
s_nop 1
v_cndmask_b32 v47, 0, v33, vcc
v_lshlrev_b32 v39, 5, v2
v_lshl_add_u32 v39, v3, 3, v39
v_lshlrev_b32 v2, 4, v2
s_mul_i32 s48, s41, 21504
s_add_u32 s48, s48, 4096
v_mov_b32 v36, s48
v_lshl_add_u32 v38, v3, 2, v36
s_lshl_b32 s36, s41, 10
v_mov_b32 v7, s36
v_lshlrev_b32 v35, 4, v1
v_add_u32 v68, s48, v35
v_add_u32 v35, s36, v35
v_lshlrev_b32 v33, 2, v1
v_mov_b32 v72, 0xffff
v_mov_b32 v73, 0xffff
v_mov_b32 v74, 0xffff
v_mov_b32 v75, 0xffff
s_sub_u32 s36, s59, 0
v_cmp_gt_u32 vcc, s36, v33
v_mov_b32 v48, 0
s_nop 0
v_cndmask_b32 v18, 0, v16, vcc
s_sub_u32 s36, s59, 1
v_cmp_gt_u32 vcc, s36, v33
v_mov_b32 v49, 0
s_nop 0
v_cndmask_b32 v19, 0, v16, vcc
s_sub_u32 s36, s59, 2
v_cmp_gt_u32 vcc, s36, v33
v_mov_b32 v50, 0
s_nop 0
v_cndmask_b32 v20, 0, v16, vcc
s_sub_u32 s36, s59, 3
v_cmp_gt_u32 vcc, s36, v33
v_mov_b32 v51, 0
s_nop 0
v_cndmask_b32 v21, 0, v16, vcc
LE_pass:
ds_write_b128 v35, v[48:51]
ds_write_b128 v68, v[72:75] offset:0
ds_write_b128 v68, v[72:75] offset:1024
ds_write_b128 v68, v[72:75] offset:2048
ds_write_b128 v68, v[72:75] offset:3072
ds_write_b128 v68, v[72:75] offset:4096
ds_write_b128 v68, v[72:75] offset:5120
ds_write_b128 v68, v[72:75] offset:6144
ds_write_b128 v68, v[72:75] offset:7168
ds_write_b128 v68, v[72:75] offset:8192
ds_write_b128 v68, v[72:75] offset:9216
ds_write_b128 v68, v[72:75] offset:10240
ds_write_b128 v68, v[72:75] offset:11264
ds_write_b128 v68, v[72:75] offset:12288
ds_write_b128 v68, v[72:75] offset:13312
ds_write_b128 v68, v[72:75] offset:14336
ds_write_b128 v68, v[72:75] offset:15360
ds_write_b128 v68, v[72:75] offset:16384
ds_write_b128 v68, v[72:75] offset:17408
ds_write_b128 v68, v[72:75] offset:18432
ds_write_b128 v68, v[72:75] offset:19456
v_lshl_add_u32 v32, v1, 2, v36
ds_write_b32 v32, v48 offset:20480
s_waitcnt vmcnt(19)
v_sub_u32 v32, v4, v5
s_waitcnt vmcnt(15)
v_cmpx_lt_i32 vcc, 0, v32
s_cbranch_execz LE_c
v_mad_u32_u16 v128, v192, 1, v7 op_sel:[1,0,0,0]
ds_add_u32 v128, v16
v_cmpx_lt_i32 vcc, 1, v32
v_mad_u32_u16 v129, v193, 1, v7 op_sel:[1,0,0,0]
ds_add_u32 v129, v16
v_cmpx_lt_i32 vcc, 2, v32
v_mad_u32_u16 v130, v194, 1, v7 op_sel:[1,0,0,0]
ds_add_u32 v130, v16
v_cmpx_lt_i32 vcc, 3, v32
v_mad_u32_u16 v131, v195, 1, v7 op_sel:[1,0,0,0]
ds_add_u32 v131, v16
s_waitcnt vmcnt(14)
v_cmpx_lt_i32 vcc, 8, v32
s_cbranch_execz LE_c
v_mad_u32_u16 v132, v196, 1, v7 op_sel:[1,0,0,0]
ds_add_u32 v132, v16
v_cmpx_lt_i32 vcc, 9, v32
v_mad_u32_u16 v133, v197, 1, v7 op_sel:[1,0,0,0]
ds_add_u32 v133, v16
v_cmpx_lt_i32 vcc, 10, v32
v_mad_u32_u16 v134, v198, 1, v7 op_sel:[1,0,0,0]
ds_add_u32 v134, v16
v_cmpx_lt_i32 vcc, 11, v32
v_mad_u32_u16 v135, v199, 1, v7 op_sel:[1,0,0,0]
ds_add_u32 v135, v16
s_waitcnt vmcnt(13)
v_cmpx_lt_i32 vcc, 16, v32
s_cbranch_execz LE_c
v_mad_u32_u16 v136, v200, 1, v7 op_sel:[1,0,0,0]
ds_add_u32 v136, v16
v_cmpx_lt_i32 vcc, 17, v32
v_mad_u32_u16 v137, v201, 1, v7 op_sel:[1,0,0,0]
ds_add_u32 v137, v16
v_cmpx_lt_i32 vcc, 18, v32
v_mad_u32_u16 v138, v202, 1, v7 op_sel:[1,0,0,0]
ds_add_u32 v138, v16
v_cmpx_lt_i32 vcc, 19, v32
v_mad_u32_u16 v139, v203, 1, v7 op_sel:[1,0,0,0]
ds_add_u32 v139, v16
s_waitcnt vmcnt(12)
v_cmpx_lt_i32 vcc, 24, v32
s_cbranch_execz LE_c
v_mad_u32_u16 v140, v204, 1, v7 op_sel:[1,0,0,0]
ds_add_u32 v140, v16
v_cmpx_lt_i32 vcc, 25, v32
v_mad_u32_u16 v141, v205, 1, v7 op_sel:[1,0,0,0]
ds_add_u32 v141, v16
v_cmpx_lt_i32 vcc, 26, v32
v_mad_u32_u16 v142, v206, 1, v7 op_sel:[1,0,0,0]
ds_add_u32 v142, v16
v_cmpx_lt_i32 vcc, 27, v32
v_mad_u32_u16 v143, v207, 1, v7 op_sel:[1,0,0,0]
ds_add_u32 v143, v16
s_waitcnt vmcnt(11)
v_cmpx_lt_i32 vcc, 32, v32
s_cbranch_execz LE_c
v_mad_u32_u16 v144, v208, 1, v7 op_sel:[1,0,0,0]
ds_add_u32 v144, v16
v_cmpx_lt_i32 vcc, 33, v32
v_mad_u32_u16 v145, v209, 1, v7 op_sel:[1,0,0,0]
ds_add_u32 v145, v16
v_cmpx_lt_i32 vcc, 34, v32
v_mad_u32_u16 v146, v210, 1, v7 op_sel:[1,0,0,0]
ds_add_u32 v146, v16
v_cmpx_lt_i32 vcc, 35, v32
v_mad_u32_u16 v147, v211, 1, v7 op_sel:[1,0,0,0]
ds_add_u32 v147, v16
s_waitcnt vmcnt(10)
v_cmpx_lt_i32 vcc, 40, v32
s_cbranch_execz LE_c
v_mad_u32_u16 v148, v212, 1, v7 op_sel:[1,0,0,0]
ds_add_u32 v148, v16
v_cmpx_lt_i32 vcc, 41, v32
v_mad_u32_u16 v149, v213, 1, v7 op_sel:[1,0,0,0]
ds_add_u32 v149, v16
v_cmpx_lt_i32 vcc, 42, v32
v_mad_u32_u16 v150, v214, 1, v7 op_sel:[1,0,0,0]
ds_add_u32 v150, v16
v_cmpx_lt_i32 vcc, 43, v32
v_mad_u32_u16 v151, v215, 1, v7 op_sel:[1,0,0,0]
ds_add_u32 v151, v16
s_waitcnt vmcnt(9)
v_cmpx_lt_i32 vcc, 48, v32
s_cbranch_execz LE_c
v_mad_u32_u16 v152, v216, 1, v7 op_sel:[1,0,0,0]
ds_add_u32 v152, v16
v_cmpx_lt_i32 vcc, 49, v32
v_mad_u32_u16 v153, v217, 1, v7 op_sel:[1,0,0,0]
ds_add_u32 v153, v16
v_cmpx_lt_i32 vcc, 50, v32
v_mad_u32_u16 v154, v218, 1, v7 op_sel:[1,0,0,0]
ds_add_u32 v154, v16
v_cmpx_lt_i32 vcc, 51, v32
v_mad_u32_u16 v155, v219, 1, v7 op_sel:[1,0,0,0]
ds_add_u32 v155, v16
s_waitcnt vmcnt(8)
v_cmpx_lt_i32 vcc, 56, v32
s_cbranch_execz LE_c
v_mad_u32_u16 v156, v220, 1, v7 op_sel:[1,0,0,0]
ds_add_u32 v156, v16
v_cmpx_lt_i32 vcc, 57, v32
v_mad_u32_u16 v157, v221, 1, v7 op_sel:[1,0,0,0]
ds_add_u32 v157, v16
v_cmpx_lt_i32 vcc, 58, v32
v_mad_u32_u16 v158, v222, 1, v7 op_sel:[1,0,0,0]
ds_add_u32 v158, v16
v_cmpx_lt_i32 vcc, 59, v32
v_mad_u32_u16 v159, v223, 1, v7 op_sel:[1,0,0,0]
ds_add_u32 v159, v16
s_waitcnt vmcnt(7)
v_cmpx_lt_i32 vcc, 64, v32
s_cbranch_execz LE_c
v_mad_u32_u16 v160, v224, 1, v7 op_sel:[1,0,0,0]
ds_add_u32 v160, v16
v_cmpx_lt_i32 vcc, 65, v32
v_mad_u32_u16 v161, v225, 1, v7 op_sel:[1,0,0,0]
ds_add_u32 v161, v16
v_cmpx_lt_i32 vcc, 66, v32
v_mad_u32_u16 v162, v226, 1, v7 op_sel:[1,0,0,0]
ds_add_u32 v162, v16
v_cmpx_lt_i32 vcc, 67, v32
v_mad_u32_u16 v163, v227, 1, v7 op_sel:[1,0,0,0]
ds_add_u32 v163, v16
s_waitcnt vmcnt(6)
v_cmpx_lt_i32 vcc, 72, v32
s_cbranch_execz LE_c
v_mad_u32_u16 v164, v228, 1, v7 op_sel:[1,0,0,0]
ds_add_u32 v164, v16
v_cmpx_lt_i32 vcc, 73, v32
v_mad_u32_u16 v165, v229, 1, v7 op_sel:[1,0,0,0]
ds_add_u32 v165, v16
v_cmpx_lt_i32 vcc, 74, v32
v_mad_u32_u16 v166, v230, 1, v7 op_sel:[1,0,0,0]
ds_add_u32 v166, v16
v_cmpx_lt_i32 vcc, 75, v32
v_mad_u32_u16 v167, v231, 1, v7 op_sel:[1,0,0,0]
ds_add_u32 v167, v16
s_waitcnt vmcnt(5)
v_cmpx_lt_i32 vcc, 80, v32
s_cbranch_execz LE_c
v_mad_u32_u16 v168, v232, 1, v7 op_sel:[1,0,0,0]
ds_add_u32 v168, v16
v_cmpx_lt_i32 vcc, 81, v32
v_mad_u32_u16 v169, v233, 1, v7 op_sel:[1,0,0,0]
ds_add_u32 v169, v16
v_cmpx_lt_i32 vcc, 82, v32
v_mad_u32_u16 v170, v234, 1, v7 op_sel:[1,0,0,0]
ds_add_u32 v170, v16
v_cmpx_lt_i32 vcc, 83, v32
v_mad_u32_u16 v171, v235, 1, v7 op_sel:[1,0,0,0]
ds_add_u32 v171, v16
s_waitcnt vmcnt(4)
v_cmpx_lt_i32 vcc, 88, v32
s_cbranch_execz LE_c
v_mad_u32_u16 v172, v236, 1, v7 op_sel:[1,0,0,0]
ds_add_u32 v172, v16
v_cmpx_lt_i32 vcc, 89, v32
v_mad_u32_u16 v173, v237, 1, v7 op_sel:[1,0,0,0]
ds_add_u32 v173, v16
v_cmpx_lt_i32 vcc, 90, v32
v_mad_u32_u16 v174, v238, 1, v7 op_sel:[1,0,0,0]
ds_add_u32 v174, v16
v_cmpx_lt_i32 vcc, 91, v32
v_mad_u32_u16 v175, v239, 1, v7 op_sel:[1,0,0,0]
ds_add_u32 v175, v16
s_waitcnt vmcnt(3)
v_cmpx_lt_i32 vcc, 96, v32
s_cbranch_execz LE_c
v_mad_u32_u16 v176, v240, 1, v7 op_sel:[1,0,0,0]
ds_add_u32 v176, v16
v_cmpx_lt_i32 vcc, 97, v32
v_mad_u32_u16 v177, v241, 1, v7 op_sel:[1,0,0,0]
ds_add_u32 v177, v16
v_cmpx_lt_i32 vcc, 98, v32
v_mad_u32_u16 v178, v242, 1, v7 op_sel:[1,0,0,0]
ds_add_u32 v178, v16
v_cmpx_lt_i32 vcc, 99, v32
v_mad_u32_u16 v179, v243, 1, v7 op_sel:[1,0,0,0]
ds_add_u32 v179, v16
s_waitcnt vmcnt(2)
v_cmpx_lt_i32 vcc, 104, v32
s_cbranch_execz LE_c
v_mad_u32_u16 v180, v244, 1, v7 op_sel:[1,0,0,0]
ds_add_u32 v180, v16
v_cmpx_lt_i32 vcc, 105, v32
v_mad_u32_u16 v181, v245, 1, v7 op_sel:[1,0,0,0]
ds_add_u32 v181, v16
v_cmpx_lt_i32 vcc, 106, v32
v_mad_u32_u16 v182, v246, 1, v7 op_sel:[1,0,0,0]
ds_add_u32 v182, v16
v_cmpx_lt_i32 vcc, 107, v32
v_mad_u32_u16 v183, v247, 1, v7 op_sel:[1,0,0,0]
ds_add_u32 v183, v16
s_waitcnt vmcnt(1)
v_cmpx_lt_i32 vcc, 112, v32
s_cbranch_execz LE_c
v_mad_u32_u16 v184, v248, 1, v7 op_sel:[1,0,0,0]
ds_add_u32 v184, v16
v_cmpx_lt_i32 vcc, 113, v32
v_mad_u32_u16 v185, v249, 1, v7 op_sel:[1,0,0,0]
ds_add_u32 v185, v16
v_cmpx_lt_i32 vcc, 114, v32
v_mad_u32_u16 v186, v250, 1, v7 op_sel:[1,0,0,0]
ds_add_u32 v186, v16
v_cmpx_lt_i32 vcc, 115, v32
v_mad_u32_u16 v187, v251, 1, v7 op_sel:[1,0,0,0]
ds_add_u32 v187, v16
s_waitcnt vmcnt(0)
v_cmpx_lt_i32 vcc, 120, v32
s_cbranch_execz LE_c
v_mad_u32_u16 v188, v252, 1, v7 op_sel:[1,0,0,0]
ds_add_u32 v188, v16
v_cmpx_lt_i32 vcc, 121, v32
v_mad_u32_u16 v189, v253, 1, v7 op_sel:[1,0,0,0]
ds_add_u32 v189, v16
v_cmpx_lt_i32 vcc, 122, v32
v_mad_u32_u16 v190, v254, 1, v7 op_sel:[1,0,0,0]
ds_add_u32 v190, v16
v_cmpx_lt_i32 vcc, 123, v32
v_mad_u32_u16 v191, v255, 1, v7 op_sel:[1,0,0,0]
ds_add_u32 v191, v16
LE_c:
s_mov_b64 exec, -1
ds_read_b128 v[24:27], v35
s_waitcnt lgkmcnt(0)
v_add_u32 v24, 3, v24
v_lshrrev_b32 v24, 2, v24
v_max_u32 v24, v24, v18
v_add_u32 v25, 3, v25
v_lshrrev_b32 v25, 2, v25
v_max_u32 v25, v25, v19
v_add_u32 v26, 3, v26
v_lshrrev_b32 v26, 2, v26
v_max_u32 v26, v26, v20
v_add_u32 v27, 3, v27
v_lshrrev_b32 v27, 2, v27
v_max_u32 v27, v27, v21
v_add_u32 v33, v24, v25
v_add3_u32 v33, v33, v26, v27
v_mov_b32 v64, v33
s_nop 1
v_add_u32_dpp v64, v64, v64 row_shr:1 row_mask:0xf bank_mask:0xf
s_nop 1
v_add_u32_dpp v64, v64, v64 row_shr:2 row_mask:0xf bank_mask:0xf
s_nop 1
v_add_u32_dpp v64, v64, v64 row_shr:4 row_mask:0xf bank_mask:0xf
s_nop 1
v_add_u32_dpp v64, v64, v64 row_shr:8 row_mask:0xf bank_mask:0xf
s_nop 1
v_add_u32_dpp v64, v64, v64 row_bcast:15 row_mask:0xa bank_mask:0xf
s_nop 1
v_add_u32_dpp v64, v64, v64 row_bcast:31 row_mask:0xc bank_mask:0xf
s_nop 1
v_readlane_b32 s44, v64, 63
v_sub_u32 v28, v64, v33
v_add_u32 v29, v28, v24
v_add_u32 v30, v29, v25
v_add_u32 v31, v30, v26
v_add3_u32 v33, v28, v24, -1
v_lshlrev_b32 v34, v33, v18
v_lshrrev_b32 v33, 5, v33
v_lshl_add_u32 v33, v33, 2, v36
ds_or_b32 v33, v34 offset:20480
v_lshl_add_u32 v28, v28, 4, v36
v_add3_u32 v33, v29, v25, -1
v_lshlrev_b32 v34, v33, v19
v_lshrrev_b32 v33, 5, v33
v_lshl_add_u32 v33, v33, 2, v36
ds_or_b32 v33, v34 offset:20480
v_lshl_add_u32 v29, v29, 4, v36
v_add3_u32 v33, v30, v26, -1
v_lshlrev_b32 v34, v33, v20
v_lshrrev_b32 v33, 5, v33
v_lshl_add_u32 v33, v33, 2, v36
ds_or_b32 v33, v34 offset:20480
v_lshl_add_u32 v30, v30, 4, v36
v_add3_u32 v33, v31, v27, -1
v_lshlrev_b32 v34, v33, v21
v_lshrrev_b32 v33, 5, v33
v_lshl_add_u32 v33, v33, 2, v36
ds_or_b32 v33, v34 offset:20480
v_lshl_add_u32 v31, v31, 4, v36
ds_write_b128 v35, v[28:31]
s_add_u32 s44, s44, 31
s_lshr_b32 s44, s44, 5
v_cmpx_lt_i32 vcc, 0, v32
s_cbranch_execz LE_p
ds_add_rtn_u32 v128, v128, v17
v_cmpx_lt_i32 vcc, 1, v32
ds_add_rtn_u32 v129, v129, v17
v_cmpx_lt_i32 vcc, 2, v32
ds_add_rtn_u32 v130, v130, v17
v_cmpx_lt_i32 vcc, 3, v32
ds_add_rtn_u32 v131, v131, v17
v_cmpx_lt_i32 vcc, 8, v32
s_cbranch_execz LE_p
ds_add_rtn_u32 v132, v132, v17
v_cmpx_lt_i32 vcc, 9, v32
ds_add_rtn_u32 v133, v133, v17
v_cmpx_lt_i32 vcc, 10, v32
ds_add_rtn_u32 v134, v134, v17
v_cmpx_lt_i32 vcc, 11, v32
ds_add_rtn_u32 v135, v135, v17
v_cmpx_lt_i32 vcc, 16, v32
s_cbranch_execz LE_p
ds_add_rtn_u32 v136, v136, v17
v_cmpx_lt_i32 vcc, 17, v32
ds_add_rtn_u32 v137, v137, v17
v_cmpx_lt_i32 vcc, 18, v32
ds_add_rtn_u32 v138, v138, v17
v_cmpx_lt_i32 vcc, 19, v32
ds_add_rtn_u32 v139, v139, v17
v_cmpx_lt_i32 vcc, 24, v32
s_cbranch_execz LE_p
ds_add_rtn_u32 v140, v140, v17
v_cmpx_lt_i32 vcc, 25, v32
ds_add_rtn_u32 v141, v141, v17
v_cmpx_lt_i32 vcc, 26, v32
ds_add_rtn_u32 v142, v142, v17
v_cmpx_lt_i32 vcc, 27, v32
ds_add_rtn_u32 v143, v143, v17
v_cmpx_lt_i32 vcc, 32, v32
s_cbranch_execz LE_p
ds_add_rtn_u32 v144, v144, v17
v_cmpx_lt_i32 vcc, 33, v32
ds_add_rtn_u32 v145, v145, v17
v_cmpx_lt_i32 vcc, 34, v32
ds_add_rtn_u32 v146, v146, v17
v_cmpx_lt_i32 vcc, 35, v32
ds_add_rtn_u32 v147, v147, v17
v_cmpx_lt_i32 vcc, 40, v32
s_cbranch_execz LE_p
ds_add_rtn_u32 v148, v148, v17
v_cmpx_lt_i32 vcc, 41, v32
ds_add_rtn_u32 v149, v149, v17
v_cmpx_lt_i32 vcc, 42, v32
ds_add_rtn_u32 v150, v150, v17
v_cmpx_lt_i32 vcc, 43, v32
ds_add_rtn_u32 v151, v151, v17
v_cmpx_lt_i32 vcc, 48, v32
s_cbranch_execz LE_p
ds_add_rtn_u32 v152, v152, v17
v_cmpx_lt_i32 vcc, 49, v32
ds_add_rtn_u32 v153, v153, v17
v_cmpx_lt_i32 vcc, 50, v32
ds_add_rtn_u32 v154, v154, v17
v_cmpx_lt_i32 vcc, 51, v32
ds_add_rtn_u32 v155, v155, v17
v_cmpx_lt_i32 vcc, 56, v32
s_cbranch_execz LE_p
ds_add_rtn_u32 v156, v156, v17
v_cmpx_lt_i32 vcc, 57, v32
ds_add_rtn_u32 v157, v157, v17
v_cmpx_lt_i32 vcc, 58, v32
ds_add_rtn_u32 v158, v158, v17
v_cmpx_lt_i32 vcc, 59, v32
ds_add_rtn_u32 v159, v159, v17
v_cmpx_lt_i32 vcc, 64, v32
s_cbranch_execz LE_p
ds_add_rtn_u32 v160, v160, v17
v_cmpx_lt_i32 vcc, 65, v32
ds_add_rtn_u32 v161, v161, v17
v_cmpx_lt_i32 vcc, 66, v32
ds_add_rtn_u32 v162, v162, v17
v_cmpx_lt_i32 vcc, 67, v32
ds_add_rtn_u32 v163, v163, v17
v_cmpx_lt_i32 vcc, 72, v32
s_cbranch_execz LE_p
ds_add_rtn_u32 v164, v164, v17
v_cmpx_lt_i32 vcc, 73, v32
ds_add_rtn_u32 v165, v165, v17
v_cmpx_lt_i32 vcc, 74, v32
ds_add_rtn_u32 v166, v166, v17
v_cmpx_lt_i32 vcc, 75, v32
ds_add_rtn_u32 v167, v167, v17
v_cmpx_lt_i32 vcc, 80, v32
s_cbranch_execz LE_p
ds_add_rtn_u32 v168, v168, v17
v_cmpx_lt_i32 vcc, 81, v32
ds_add_rtn_u32 v169, v169, v17
v_cmpx_lt_i32 vcc, 82, v32
ds_add_rtn_u32 v170, v170, v17
v_cmpx_lt_i32 vcc, 83, v32
ds_add_rtn_u32 v171, v171, v17
v_cmpx_lt_i32 vcc, 88, v32
s_cbranch_execz LE_p
ds_add_rtn_u32 v172, v172, v17
v_cmpx_lt_i32 vcc, 89, v32
ds_add_rtn_u32 v173, v173, v17
v_cmpx_lt_i32 vcc, 90, v32
ds_add_rtn_u32 v174, v174, v17
v_cmpx_lt_i32 vcc, 91, v32
ds_add_rtn_u32 v175, v175, v17
v_cmpx_lt_i32 vcc, 96, v32
s_cbranch_execz LE_p
ds_add_rtn_u32 v176, v176, v17
v_cmpx_lt_i32 vcc, 97, v32
ds_add_rtn_u32 v177, v177, v17
v_cmpx_lt_i32 vcc, 98, v32
ds_add_rtn_u32 v178, v178, v17
v_cmpx_lt_i32 vcc, 99, v32
ds_add_rtn_u32 v179, v179, v17
v_cmpx_lt_i32 vcc, 104, v32
s_cbranch_execz LE_p
ds_add_rtn_u32 v180, v180, v17
v_cmpx_lt_i32 vcc, 105, v32
ds_add_rtn_u32 v181, v181, v17
v_cmpx_lt_i32 vcc, 106, v32
ds_add_rtn_u32 v182, v182, v17
v_cmpx_lt_i32 vcc, 107, v32
ds_add_rtn_u32 v183, v183, v17
v_cmpx_lt_i32 vcc, 112, v32
s_cbranch_execz LE_p
ds_add_rtn_u32 v184, v184, v17
v_cmpx_lt_i32 vcc, 113, v32
ds_add_rtn_u32 v185, v185, v17
v_cmpx_lt_i32 vcc, 114, v32
ds_add_rtn_u32 v186, v186, v17
v_cmpx_lt_i32 vcc, 115, v32
ds_add_rtn_u32 v187, v187, v17
v_cmpx_lt_i32 vcc, 120, v32
s_cbranch_execz LE_p
ds_add_rtn_u32 v188, v188, v17
v_cmpx_lt_i32 vcc, 121, v32
ds_add_rtn_u32 v189, v189, v17
v_cmpx_lt_i32 vcc, 122, v32
ds_add_rtn_u32 v190, v190, v17
v_cmpx_lt_i32 vcc, 123, v32
ds_add_rtn_u32 v191, v191, v17
LE_p:
s_mov_b64 exec, -1
v_lshl_add_u32 v33, v1, 2, v36
ds_read_b32 v37, v33 offset:20480
s_waitcnt lgkmcnt(0)
v_cmpx_lt_i32 vcc, 0, v32
s_cbranch_execz LE_w
ds_write_b32 v128, v192
v_cmpx_lt_i32 vcc, 1, v32
ds_write_b32 v129, v193
v_cmpx_lt_i32 vcc, 2, v32
ds_write_b32 v130, v194
v_cmpx_lt_i32 vcc, 3, v32
ds_write_b32 v131, v195
v_cmpx_lt_i32 vcc, 8, v32
s_cbranch_execz LE_w
ds_write_b32 v132, v196
v_cmpx_lt_i32 vcc, 9, v32
ds_write_b32 v133, v197
v_cmpx_lt_i32 vcc, 10, v32
ds_write_b32 v134, v198
v_cmpx_lt_i32 vcc, 11, v32
ds_write_b32 v135, v199
v_cmpx_lt_i32 vcc, 16, v32
s_cbranch_execz LE_w
ds_write_b32 v136, v200
v_cmpx_lt_i32 vcc, 17, v32
ds_write_b32 v137, v201
v_cmpx_lt_i32 vcc, 18, v32
ds_write_b32 v138, v202
v_cmpx_lt_i32 vcc, 19, v32
ds_write_b32 v139, v203
v_cmpx_lt_i32 vcc, 24, v32
s_cbranch_execz LE_w
ds_write_b32 v140, v204
v_cmpx_lt_i32 vcc, 25, v32
ds_write_b32 v141, v205
v_cmpx_lt_i32 vcc, 26, v32
ds_write_b32 v142, v206
v_cmpx_lt_i32 vcc, 27, v32
ds_write_b32 v143, v207
v_cmpx_lt_i32 vcc, 32, v32
s_cbranch_execz LE_w
ds_write_b32 v144, v208
v_cmpx_lt_i32 vcc, 33, v32
ds_write_b32 v145, v209
v_cmpx_lt_i32 vcc, 34, v32
ds_write_b32 v146, v210
v_cmpx_lt_i32 vcc, 35, v32
ds_write_b32 v147, v211
v_cmpx_lt_i32 vcc, 40, v32
s_cbranch_execz LE_w
ds_write_b32 v148, v212
v_cmpx_lt_i32 vcc, 41, v32
ds_write_b32 v149, v213
v_cmpx_lt_i32 vcc, 42, v32
ds_write_b32 v150, v214
v_cmpx_lt_i32 vcc, 43, v32
ds_write_b32 v151, v215
v_cmpx_lt_i32 vcc, 48, v32
s_cbranch_execz LE_w
ds_write_b32 v152, v216
v_cmpx_lt_i32 vcc, 49, v32
ds_write_b32 v153, v217
v_cmpx_lt_i32 vcc, 50, v32
ds_write_b32 v154, v218
v_cmpx_lt_i32 vcc, 51, v32
ds_write_b32 v155, v219
v_cmpx_lt_i32 vcc, 56, v32
s_cbranch_execz LE_w
ds_write_b32 v156, v220
v_cmpx_lt_i32 vcc, 57, v32
ds_write_b32 v157, v221
v_cmpx_lt_i32 vcc, 58, v32
ds_write_b32 v158, v222
v_cmpx_lt_i32 vcc, 59, v32
ds_write_b32 v159, v223
v_cmpx_lt_i32 vcc, 64, v32
s_cbranch_execz LE_w
ds_write_b32 v160, v224
v_cmpx_lt_i32 vcc, 65, v32
ds_write_b32 v161, v225
v_cmpx_lt_i32 vcc, 66, v32
ds_write_b32 v162, v226
v_cmpx_lt_i32 vcc, 67, v32
ds_write_b32 v163, v227
v_cmpx_lt_i32 vcc, 72, v32
s_cbranch_execz LE_w
ds_write_b32 v164, v228
v_cmpx_lt_i32 vcc, 73, v32
ds_write_b32 v165, v229
v_cmpx_lt_i32 vcc, 74, v32
ds_write_b32 v166, v230
v_cmpx_lt_i32 vcc, 75, v32
ds_write_b32 v167, v231
v_cmpx_lt_i32 vcc, 80, v32
s_cbranch_execz LE_w
ds_write_b32 v168, v232
v_cmpx_lt_i32 vcc, 81, v32
ds_write_b32 v169, v233
v_cmpx_lt_i32 vcc, 82, v32
ds_write_b32 v170, v234
v_cmpx_lt_i32 vcc, 83, v32
ds_write_b32 v171, v235
v_cmpx_lt_i32 vcc, 88, v32
s_cbranch_execz LE_w
ds_write_b32 v172, v236
v_cmpx_lt_i32 vcc, 89, v32
ds_write_b32 v173, v237
v_cmpx_lt_i32 vcc, 90, v32
ds_write_b32 v174, v238
v_cmpx_lt_i32 vcc, 91, v32
ds_write_b32 v175, v239
v_cmpx_lt_i32 vcc, 96, v32
s_cbranch_execz LE_w
ds_write_b32 v176, v240
v_cmpx_lt_i32 vcc, 97, v32
ds_write_b32 v177, v241
v_cmpx_lt_i32 vcc, 98, v32
ds_write_b32 v178, v242
v_cmpx_lt_i32 vcc, 99, v32
ds_write_b32 v179, v243
v_cmpx_lt_i32 vcc, 104, v32
s_cbranch_execz LE_w
ds_write_b32 v180, v244
v_cmpx_lt_i32 vcc, 105, v32
ds_write_b32 v181, v245
v_cmpx_lt_i32 vcc, 106, v32
ds_write_b32 v182, v246
v_cmpx_lt_i32 vcc, 107, v32
ds_write_b32 v183, v247
v_cmpx_lt_i32 vcc, 112, v32
s_cbranch_execz LE_w
ds_write_b32 v184, v248
v_cmpx_lt_i32 vcc, 113, v32
ds_write_b32 v185, v249
v_cmpx_lt_i32 vcc, 114, v32
ds_write_b32 v186, v250
v_cmpx_lt_i32 vcc, 115, v32
ds_write_b32 v187, v251
v_cmpx_lt_i32 vcc, 120, v32
s_cbranch_execz LE_w
ds_write_b32 v188, v252
v_cmpx_lt_i32 vcc, 121, v32
ds_write_b32 v189, v253
v_cmpx_lt_i32 vcc, 122, v32
ds_write_b32 v190, v254
v_cmpx_lt_i32 vcc, 123, v32
ds_write_b32 v191, v255
LE_w:
s_mov_b64 exec, -1
s_waitcnt vmcnt(0)
s_mov_b32 s51, 0
v_lshlrev_b32 v80, 16, v76
v_lshlrev_b32 v81, 16, v77
v_lshlrev_b32 v82, 16, v78
v_mov_b32 v34, v38
ds_read2_b32 v[52:53], v34 offset0:0 offset1:4
ds_read2_b32 v[54:55], v34 offset0:8 offset1:12
s_waitcnt lgkmcnt(0)
ds_read2_b32 v[56:57], v34 offset0:16 offset1:20
ds_read2_b32 v[58:59], v34 offset0:24 offset1:28
v_mad_u32_u16 v60, v52, s49, v2
v_mad_u32_u16 v61, v53, s49, v2
v_mad_u32_u16 v62, v54, s49, v2
v_mad_u32_u16 v63, v55, s49, v2
buffer_load_dwordx4 a[0:3], v60, s[16:19], 0 offen
buffer_load_dwordx4 a[4:7], v60, s[16:19], 0 offen offset:256
buffer_load_dwordx4 a[8:11], v61, s[16:19], 0 offen
buffer_load_dwordx4 a[12:15], v61, s[16:19], 0 offen offset:256
buffer_load_dwordx4 a[16:19], v62, s[16:19], 0 offen
buffer_load_dwordx4 a[20:23], v62, s[16:19], 0 offen offset:256
buffer_load_dwordx4 a[24:27], v63, s[16:19], 0 offen
buffer_load_dwordx4 a[28:31], v63, s[16:19], 0 offen offset:256
s_waitcnt lgkmcnt(0)
ds_read2_b32 v[52:53], v34 offset0:32 offset1:36
ds_read2_b32 v[54:55], v34 offset0:40 offset1:44
v_mad_u32_u16 v60, v56, s49, v2
v_mad_u32_u16 v61, v57, s49, v2
v_mad_u32_u16 v62, v58, s49, v2
v_mad_u32_u16 v63, v59, s49, v2
buffer_load_dwordx4 a[32:35], v60, s[16:19], 0 offen
buffer_load_dwordx4 a[36:39], v60, s[16:19], 0 offen offset:256
buffer_load_dwordx4 a[40:43], v61, s[16:19], 0 offen
buffer_load_dwordx4 a[44:47], v61, s[16:19], 0 offen offset:256
buffer_load_dwordx4 a[48:51], v62, s[16:19], 0 offen
buffer_load_dwordx4 a[52:55], v62, s[16:19], 0 offen offset:256
buffer_load_dwordx4 a[56:59], v63, s[16:19], 0 offen
buffer_load_dwordx4 a[60:63], v63, s[16:19], 0 offen offset:256
s_waitcnt lgkmcnt(0)
ds_read2_b32 v[56:57], v34 offset0:48 offset1:52
ds_read2_b32 v[58:59], v34 offset0:56 offset1:60
v_mad_u32_u16 v60, v52, s49, v2
v_mad_u32_u16 v61, v53, s49, v2
v_mad_u32_u16 v62, v54, s49, v2
v_mad_u32_u16 v63, v55, s49, v2
buffer_load_dwordx4 a[64:67], v60, s[16:19], 0 offen
buffer_load_dwordx4 a[68:71], v60, s[16:19], 0 offen offset:256
buffer_load_dwordx4 a[72:75], v61, s[16:19], 0 offen
buffer_load_dwordx4 a[76:79], v61, s[16:19], 0 offen offset:256
buffer_load_dwordx4 a[80:83], v62, s[16:19], 0 offen
buffer_load_dwordx4 a[84:87], v62, s[16:19], 0 offen offset:256
buffer_load_dwordx4 a[88:91], v63, s[16:19], 0 offen
buffer_load_dwordx4 a[92:95], v63, s[16:19], 0 offen offset:256
s_waitcnt lgkmcnt(0)
ds_read2_b32 v[52:53], v34 offset0:64 offset1:68
ds_read2_b32 v[54:55], v34 offset0:72 offset1:76
v_mad_u32_u16 v60, v56, s49, v2
v_mad_u32_u16 v61, v57, s49, v2
v_mad_u32_u16 v62, v58, s49, v2
v_mad_u32_u16 v63, v59, s49, v2
buffer_load_dwordx4 a[96:99], v60, s[16:19], 0 offen
buffer_load_dwordx4 a[100:103], v60, s[16:19], 0 offen offset:256
buffer_load_dwordx4 a[104:107], v61, s[16:19], 0 offen
buffer_load_dwordx4 a[108:111], v61, s[16:19], 0 offen offset:256
buffer_load_dwordx4 a[112:115], v62, s[16:19], 0 offen
buffer_load_dwordx4 a[116:119], v62, s[16:19], 0 offen offset:256
buffer_load_dwordx4 a[120:123], v63, s[16:19], 0 offen
buffer_load_dwordx4 a[124:127], v63, s[16:19], 0 offen offset:256
s_waitcnt lgkmcnt(0)
ds_read2_b32 v[56:57], v34 offset0:80 offset1:84
ds_read2_b32 v[58:59], v34 offset0:88 offset1:92
v_mad_u32_u16 v60, v52, s49, v2
v_mad_u32_u16 v61, v53, s49, v2
v_mad_u32_u16 v62, v54, s49, v2
v_mad_u32_u16 v63, v55, s49, v2
buffer_load_dwordx4 a[128:131], v60, s[16:19], 0 offen
buffer_load_dwordx4 a[132:135], v60, s[16:19], 0 offen offset:256
buffer_load_dwordx4 a[136:139], v61, s[16:19], 0 offen
buffer_load_dwordx4 a[140:143], v61, s[16:19], 0 offen offset:256
buffer_load_dwordx4 a[144:147], v62, s[16:19], 0 offen
buffer_load_dwordx4 a[148:151], v62, s[16:19], 0 offen offset:256
buffer_load_dwordx4 a[152:155], v63, s[16:19], 0 offen
buffer_load_dwordx4 a[156:159], v63, s[16:19], 0 offen offset:256
s_waitcnt lgkmcnt(0)
ds_read2_b32 v[52:53], v34 offset0:96 offset1:100
ds_read2_b32 v[54:55], v34 offset0:104 offset1:108
v_mad_u32_u16 v60, v56, s49, v2
v_mad_u32_u16 v61, v57, s49, v2
v_mad_u32_u16 v62, v58, s49, v2
v_mad_u32_u16 v63, v59, s49, v2
buffer_load_dwordx4 a[160:163], v60, s[16:19], 0 offen
buffer_load_dwordx4 a[164:167], v60, s[16:19], 0 offen offset:256
buffer_load_dwordx4 a[168:171], v61, s[16:19], 0 offen
buffer_load_dwordx4 a[172:175], v61, s[16:19], 0 offen offset:256
buffer_load_dwordx4 a[176:179], v62, s[16:19], 0 offen
buffer_load_dwordx4 a[180:183], v62, s[16:19], 0 offen offset:256
buffer_load_dwordx4 a[184:187], v63, s[16:19], 0 offen
buffer_load_dwordx4 a[188:191], v63, s[16:19], 0 offen offset:256
s_waitcnt lgkmcnt(0)
ds_read2_b32 v[56:57], v34 offset0:112 offset1:116
ds_read2_b32 v[58:59], v34 offset0:120 offset1:124
v_mad_u32_u16 v60, v52, s49, v2
v_mad_u32_u16 v61, v53, s49, v2
v_mad_u32_u16 v62, v54, s49, v2
v_mad_u32_u16 v63, v55, s49, v2
buffer_load_dwordx4 a[192:195], v60, s[16:19], 0 offen
buffer_load_dwordx4 a[196:199], v60, s[16:19], 0 offen offset:256
buffer_load_dwordx4 a[200:203], v61, s[16:19], 0 offen
buffer_load_dwordx4 a[204:207], v61, s[16:19], 0 offen offset:256
buffer_load_dwordx4 a[208:211], v62, s[16:19], 0 offen
buffer_load_dwordx4 a[212:215], v62, s[16:19], 0 offen offset:256
buffer_load_dwordx4 a[216:219], v63, s[16:19], 0 offen
buffer_load_dwordx4 a[220:223], v63, s[16:19], 0 offen offset:256
s_waitcnt lgkmcnt(0)
ds_read2_b32 v[52:53], v34 offset0:128 offset1:132
ds_read2_b32 v[54:55], v34 offset0:136 offset1:140
v_mad_u32_u16 v60, v56, s49, v2
v_mad_u32_u16 v61, v57, s49, v2
v_mad_u32_u16 v62, v58, s49, v2
v_mad_u32_u16 v63, v59, s49, v2
buffer_load_dwordx4 a[224:227], v60, s[16:19], 0 offen
buffer_load_dwordx4 a[228:231], v60, s[16:19], 0 offen offset:256
buffer_load_dwordx4 a[232:235], v61, s[16:19], 0 offen
buffer_load_dwordx4 a[236:239], v61, s[16:19], 0 offen offset:256
buffer_load_dwordx4 a[240:243], v62, s[16:19], 0 offen
buffer_load_dwordx4 a[244:247], v62, s[16:19], 0 offen offset:256
buffer_load_dwordx4 a[248:251], v63, s[16:19], 0 offen
buffer_load_dwordx4 a[252:255], v63, s[16:19], 0 offen offset:256
v_add_u32 v34, 512, v34
s_mov_b32 s45, 0
s_lshl_b32 s47, s58, 9
LE_loop:
v_readlane_b32 s46, v37, s45
s_add_u32 s45, s45, 1
s_waitcnt vmcnt(56)
v_mfma_f32_16x16x32_bf16 v[48:51], a[0:3], v[40:43], v[48:51]
v_mfma_f32_16x16x32_bf16 v[48:51], a[4:7], v[44:47], v[48:51]
s_bitcmp1_b32 s46, 0
s_cbranch_scc0 LE_nf0
v_readlane_b32 s57, v80, s51
s_add_u32 s51, s51, 1
s_and_b32 s51, s51, 63
s_cbranch_scc1 LE_dg0
v_mov_b32 v80, v81
v_mov_b32 v81, v82
LE_dg0:
s_nop 3
v_mul_f32 v48, s57, v48
v_mul_f32 v49, s57, v49
v_mul_f32 v50, s57, v50
v_mul_f32 v51, s57, v51
s_cmp_eq_u32 s42, 0
s_cbranch_scc1 LE_fl0
buffer_load_dwordx2 v[66:67], v39, s[20:23], s47 offen sc1
s_waitcnt vmcnt(0)
v_lshlrev_b32 v64, 16, v66
v_and_b32 v65, 0xffff0000, v66
v_add_f32 v48, v48, v64
v_add_f32 v49, v49, v65
v_lshlrev_b32 v64, 16, v67
v_and_b32 v65, 0xffff0000, v67
v_add_f32 v50, v50, v64
v_add_f32 v51, v51, v65
LE_fl0:
v_cvt_pk_bf16_f32 v64, v48, v49
v_cvt_pk_bf16_f32 v65, v50, v51
v_mov_b32 v48, 0
v_mov_b32 v49, 0
v_mov_b32 v50, 0
v_mov_b32 v51, 0
buffer_store_dwordx2 v[64:65], v39, s[20:23], s47 offen sc1
s_add_u32 s47, s47, 512
LE_nf0:
v_mfma_f32_16x16x32_bf16 v[48:51], a[8:11], v[40:43], v[48:51]
v_mfma_f32_16x16x32_bf16 v[48:51], a[12:15], v[44:47], v[48:51]
s_bitcmp1_b32 s46, 1
s_cbranch_scc0 LE_nf1
v_readlane_b32 s57, v80, s51
s_add_u32 s51, s51, 1
s_and_b32 s51, s51, 63
s_cbranch_scc1 LE_dg1
v_mov_b32 v80, v81
v_mov_b32 v81, v82
LE_dg1:
s_nop 3
v_mul_f32 v48, s57, v48
v_mul_f32 v49, s57, v49
v_mul_f32 v50, s57, v50
v_mul_f32 v51, s57, v51
s_cmp_eq_u32 s42, 0
s_cbranch_scc1 LE_fl1
buffer_load_dwordx2 v[66:67], v39, s[20:23], s47 offen sc1
s_waitcnt vmcnt(0)
v_lshlrev_b32 v64, 16, v66
v_and_b32 v65, 0xffff0000, v66
v_add_f32 v48, v48, v64
v_add_f32 v49, v49, v65
v_lshlrev_b32 v64, 16, v67
v_and_b32 v65, 0xffff0000, v67
v_add_f32 v50, v50, v64
v_add_f32 v51, v51, v65
LE_fl1:
v_cvt_pk_bf16_f32 v64, v48, v49
v_cvt_pk_bf16_f32 v65, v50, v51
v_mov_b32 v48, 0
v_mov_b32 v49, 0
v_mov_b32 v50, 0
v_mov_b32 v51, 0
buffer_store_dwordx2 v[64:65], v39, s[20:23], s47 offen sc1
s_add_u32 s47, s47, 512
LE_nf1:
v_mfma_f32_16x16x32_bf16 v[48:51], a[16:19], v[40:43], v[48:51]
v_mfma_f32_16x16x32_bf16 v[48:51], a[20:23], v[44:47], v[48:51]
s_bitcmp1_b32 s46, 2
s_cbranch_scc0 LE_nf2
v_readlane_b32 s57, v80, s51
s_add_u32 s51, s51, 1
s_and_b32 s51, s51, 63
s_cbranch_scc1 LE_dg2
v_mov_b32 v80, v81
v_mov_b32 v81, v82
LE_dg2:
s_nop 3
v_mul_f32 v48, s57, v48
v_mul_f32 v49, s57, v49
v_mul_f32 v50, s57, v50
v_mul_f32 v51, s57, v51
s_cmp_eq_u32 s42, 0
s_cbranch_scc1 LE_fl2
buffer_load_dwordx2 v[66:67], v39, s[20:23], s47 offen sc1
s_waitcnt vmcnt(0)
v_lshlrev_b32 v64, 16, v66
v_and_b32 v65, 0xffff0000, v66
v_add_f32 v48, v48, v64
v_add_f32 v49, v49, v65
v_lshlrev_b32 v64, 16, v67
v_and_b32 v65, 0xffff0000, v67
v_add_f32 v50, v50, v64
v_add_f32 v51, v51, v65
LE_fl2:
v_cvt_pk_bf16_f32 v64, v48, v49
v_cvt_pk_bf16_f32 v65, v50, v51
v_mov_b32 v48, 0
v_mov_b32 v49, 0
v_mov_b32 v50, 0
v_mov_b32 v51, 0
buffer_store_dwordx2 v[64:65], v39, s[20:23], s47 offen sc1
s_add_u32 s47, s47, 512
LE_nf2:
v_mfma_f32_16x16x32_bf16 v[48:51], a[24:27], v[40:43], v[48:51]
v_mfma_f32_16x16x32_bf16 v[48:51], a[28:31], v[44:47], v[48:51]
s_bitcmp1_b32 s46, 3
s_cbranch_scc0 LE_nf3
v_readlane_b32 s57, v80, s51
s_add_u32 s51, s51, 1
s_and_b32 s51, s51, 63
s_cbranch_scc1 LE_dg3
v_mov_b32 v80, v81
v_mov_b32 v81, v82
LE_dg3:
s_nop 3
v_mul_f32 v48, s57, v48
v_mul_f32 v49, s57, v49
v_mul_f32 v50, s57, v50
v_mul_f32 v51, s57, v51
s_cmp_eq_u32 s42, 0
s_cbranch_scc1 LE_fl3
buffer_load_dwordx2 v[66:67], v39, s[20:23], s47 offen sc1
s_waitcnt vmcnt(0)
v_lshlrev_b32 v64, 16, v66
v_and_b32 v65, 0xffff0000, v66
v_add_f32 v48, v48, v64
v_add_f32 v49, v49, v65
v_lshlrev_b32 v64, 16, v67
v_and_b32 v65, 0xffff0000, v67
v_add_f32 v50, v50, v64
v_add_f32 v51, v51, v65
LE_fl3:
v_cvt_pk_bf16_f32 v64, v48, v49
v_cvt_pk_bf16_f32 v65, v50, v51
v_mov_b32 v48, 0
v_mov_b32 v49, 0
v_mov_b32 v50, 0
v_mov_b32 v51, 0
buffer_store_dwordx2 v[64:65], v39, s[20:23], s47 offen sc1
s_add_u32 s47, s47, 512
LE_nf3:
s_waitcnt lgkmcnt(0)
ds_read2_b32 v[56:57], v34 offset0:16 offset1:20
ds_read2_b32 v[58:59], v34 offset0:24 offset1:28
v_mad_u32_u16 v60, v52, s49, v2
v_mad_u32_u16 v61, v53, s49, v2
v_mad_u32_u16 v62, v54, s49, v2
v_mad_u32_u16 v63, v55, s49, v2
buffer_load_dwordx4 a[0:3], v60, s[16:19], 0 offen
buffer_load_dwordx4 a[4:7], v60, s[16:19], 0 offen offset:256
buffer_load_dwordx4 a[8:11], v61, s[16:19], 0 offen
buffer_load_dwordx4 a[12:15], v61, s[16:19], 0 offen offset:256
buffer_load_dwordx4 a[16:19], v62, s[16:19], 0 offen
buffer_load_dwordx4 a[20:23], v62, s[16:19], 0 offen offset:256
buffer_load_dwordx4 a[24:27], v63, s[16:19], 0 offen
buffer_load_dwordx4 a[28:31], v63, s[16:19], 0 offen offset:256
s_waitcnt vmcnt(56)
v_mfma_f32_16x16x32_bf16 v[48:51], a[32:35], v[40:43], v[48:51]
v_mfma_f32_16x16x32_bf16 v[48:51], a[36:39], v[44:47], v[48:51]
s_bitcmp1_b32 s46, 4
s_cbranch_scc0 LE_nf4
v_readlane_b32 s57, v80, s51
s_add_u32 s51, s51, 1
s_and_b32 s51, s51, 63
s_cbranch_scc1 LE_dg4
v_mov_b32 v80, v81
v_mov_b32 v81, v82
LE_dg4:
s_nop 3
v_mul_f32 v48, s57, v48
v_mul_f32 v49, s57, v49
v_mul_f32 v50, s57, v50
v_mul_f32 v51, s57, v51
s_cmp_eq_u32 s42, 0
s_cbranch_scc1 LE_fl4
buffer_load_dwordx2 v[66:67], v39, s[20:23], s47 offen sc1
s_waitcnt vmcnt(0)
v_lshlrev_b32 v64, 16, v66
v_and_b32 v65, 0xffff0000, v66
v_add_f32 v48, v48, v64
v_add_f32 v49, v49, v65
v_lshlrev_b32 v64, 16, v67
v_and_b32 v65, 0xffff0000, v67
v_add_f32 v50, v50, v64
v_add_f32 v51, v51, v65
LE_fl4:
v_cvt_pk_bf16_f32 v64, v48, v49
v_cvt_pk_bf16_f32 v65, v50, v51
v_mov_b32 v48, 0
v_mov_b32 v49, 0
v_mov_b32 v50, 0
v_mov_b32 v51, 0
buffer_store_dwordx2 v[64:65], v39, s[20:23], s47 offen sc1
s_add_u32 s47, s47, 512
LE_nf4:
v_mfma_f32_16x16x32_bf16 v[48:51], a[40:43], v[40:43], v[48:51]
v_mfma_f32_16x16x32_bf16 v[48:51], a[44:47], v[44:47], v[48:51]
s_bitcmp1_b32 s46, 5
s_cbranch_scc0 LE_nf5
v_readlane_b32 s57, v80, s51
s_add_u32 s51, s51, 1
s_and_b32 s51, s51, 63
s_cbranch_scc1 LE_dg5
v_mov_b32 v80, v81
v_mov_b32 v81, v82
LE_dg5:
s_nop 3
v_mul_f32 v48, s57, v48
v_mul_f32 v49, s57, v49
v_mul_f32 v50, s57, v50
v_mul_f32 v51, s57, v51
s_cmp_eq_u32 s42, 0
s_cbranch_scc1 LE_fl5
buffer_load_dwordx2 v[66:67], v39, s[20:23], s47 offen sc1
s_waitcnt vmcnt(0)
v_lshlrev_b32 v64, 16, v66
v_and_b32 v65, 0xffff0000, v66
v_add_f32 v48, v48, v64
v_add_f32 v49, v49, v65
v_lshlrev_b32 v64, 16, v67
v_and_b32 v65, 0xffff0000, v67
v_add_f32 v50, v50, v64
v_add_f32 v51, v51, v65
LE_fl5:
v_cvt_pk_bf16_f32 v64, v48, v49
v_cvt_pk_bf16_f32 v65, v50, v51
v_mov_b32 v48, 0
v_mov_b32 v49, 0
v_mov_b32 v50, 0
v_mov_b32 v51, 0
buffer_store_dwordx2 v[64:65], v39, s[20:23], s47 offen sc1
s_add_u32 s47, s47, 512
LE_nf5:
v_mfma_f32_16x16x32_bf16 v[48:51], a[48:51], v[40:43], v[48:51]
v_mfma_f32_16x16x32_bf16 v[48:51], a[52:55], v[44:47], v[48:51]
s_bitcmp1_b32 s46, 6
s_cbranch_scc0 LE_nf6
v_readlane_b32 s57, v80, s51
s_add_u32 s51, s51, 1
s_and_b32 s51, s51, 63
s_cbranch_scc1 LE_dg6
v_mov_b32 v80, v81
v_mov_b32 v81, v82
LE_dg6:
s_nop 3
v_mul_f32 v48, s57, v48
v_mul_f32 v49, s57, v49
v_mul_f32 v50, s57, v50
v_mul_f32 v51, s57, v51
s_cmp_eq_u32 s42, 0
s_cbranch_scc1 LE_fl6
buffer_load_dwordx2 v[66:67], v39, s[20:23], s47 offen sc1
s_waitcnt vmcnt(0)
v_lshlrev_b32 v64, 16, v66
v_and_b32 v65, 0xffff0000, v66
v_add_f32 v48, v48, v64
v_add_f32 v49, v49, v65
v_lshlrev_b32 v64, 16, v67
v_and_b32 v65, 0xffff0000, v67
v_add_f32 v50, v50, v64
v_add_f32 v51, v51, v65
LE_fl6:
v_cvt_pk_bf16_f32 v64, v48, v49
v_cvt_pk_bf16_f32 v65, v50, v51
v_mov_b32 v48, 0
v_mov_b32 v49, 0
v_mov_b32 v50, 0
v_mov_b32 v51, 0
buffer_store_dwordx2 v[64:65], v39, s[20:23], s47 offen sc1
s_add_u32 s47, s47, 512
LE_nf6:
v_mfma_f32_16x16x32_bf16 v[48:51], a[56:59], v[40:43], v[48:51]
v_mfma_f32_16x16x32_bf16 v[48:51], a[60:63], v[44:47], v[48:51]
s_bitcmp1_b32 s46, 7
s_cbranch_scc0 LE_nf7
v_readlane_b32 s57, v80, s51
s_add_u32 s51, s51, 1
s_and_b32 s51, s51, 63
s_cbranch_scc1 LE_dg7
v_mov_b32 v80, v81
v_mov_b32 v81, v82
LE_dg7:
s_nop 3
v_mul_f32 v48, s57, v48
v_mul_f32 v49, s57, v49
v_mul_f32 v50, s57, v50
v_mul_f32 v51, s57, v51
s_cmp_eq_u32 s42, 0
s_cbranch_scc1 LE_fl7
buffer_load_dwordx2 v[66:67], v39, s[20:23], s47 offen sc1
s_waitcnt vmcnt(0)
v_lshlrev_b32 v64, 16, v66
v_and_b32 v65, 0xffff0000, v66
v_add_f32 v48, v48, v64
v_add_f32 v49, v49, v65
v_lshlrev_b32 v64, 16, v67
v_and_b32 v65, 0xffff0000, v67
v_add_f32 v50, v50, v64
v_add_f32 v51, v51, v65
LE_fl7:
v_cvt_pk_bf16_f32 v64, v48, v49
v_cvt_pk_bf16_f32 v65, v50, v51
v_mov_b32 v48, 0
v_mov_b32 v49, 0
v_mov_b32 v50, 0
v_mov_b32 v51, 0
buffer_store_dwordx2 v[64:65], v39, s[20:23], s47 offen sc1
s_add_u32 s47, s47, 512
LE_nf7:
s_waitcnt lgkmcnt(0)
ds_read2_b32 v[52:53], v34 offset0:32 offset1:36
ds_read2_b32 v[54:55], v34 offset0:40 offset1:44
v_mad_u32_u16 v60, v56, s49, v2
v_mad_u32_u16 v61, v57, s49, v2
v_mad_u32_u16 v62, v58, s49, v2
v_mad_u32_u16 v63, v59, s49, v2
buffer_load_dwordx4 a[32:35], v60, s[16:19], 0 offen
buffer_load_dwordx4 a[36:39], v60, s[16:19], 0 offen offset:256
buffer_load_dwordx4 a[40:43], v61, s[16:19], 0 offen
buffer_load_dwordx4 a[44:47], v61, s[16:19], 0 offen offset:256
buffer_load_dwordx4 a[48:51], v62, s[16:19], 0 offen
buffer_load_dwordx4 a[52:55], v62, s[16:19], 0 offen offset:256
buffer_load_dwordx4 a[56:59], v63, s[16:19], 0 offen
buffer_load_dwordx4 a[60:63], v63, s[16:19], 0 offen offset:256
s_waitcnt vmcnt(56)
v_mfma_f32_16x16x32_bf16 v[48:51], a[64:67], v[40:43], v[48:51]
v_mfma_f32_16x16x32_bf16 v[48:51], a[68:71], v[44:47], v[48:51]
s_bitcmp1_b32 s46, 8
s_cbranch_scc0 LE_nf8
v_readlane_b32 s57, v80, s51
s_add_u32 s51, s51, 1
s_and_b32 s51, s51, 63
s_cbranch_scc1 LE_dg8
v_mov_b32 v80, v81
v_mov_b32 v81, v82
LE_dg8:
s_nop 3
v_mul_f32 v48, s57, v48
v_mul_f32 v49, s57, v49
v_mul_f32 v50, s57, v50
v_mul_f32 v51, s57, v51
s_cmp_eq_u32 s42, 0
s_cbranch_scc1 LE_fl8
buffer_load_dwordx2 v[66:67], v39, s[20:23], s47 offen sc1
s_waitcnt vmcnt(0)
v_lshlrev_b32 v64, 16, v66
v_and_b32 v65, 0xffff0000, v66
v_add_f32 v48, v48, v64
v_add_f32 v49, v49, v65
v_lshlrev_b32 v64, 16, v67
v_and_b32 v65, 0xffff0000, v67
v_add_f32 v50, v50, v64
v_add_f32 v51, v51, v65
LE_fl8:
v_cvt_pk_bf16_f32 v64, v48, v49
v_cvt_pk_bf16_f32 v65, v50, v51
v_mov_b32 v48, 0
v_mov_b32 v49, 0
v_mov_b32 v50, 0
v_mov_b32 v51, 0
buffer_store_dwordx2 v[64:65], v39, s[20:23], s47 offen sc1
s_add_u32 s47, s47, 512
LE_nf8:
v_mfma_f32_16x16x32_bf16 v[48:51], a[72:75], v[40:43], v[48:51]
v_mfma_f32_16x16x32_bf16 v[48:51], a[76:79], v[44:47], v[48:51]
s_bitcmp1_b32 s46, 9
s_cbranch_scc0 LE_nf9
v_readlane_b32 s57, v80, s51
s_add_u32 s51, s51, 1
s_and_b32 s51, s51, 63
s_cbranch_scc1 LE_dg9
v_mov_b32 v80, v81
v_mov_b32 v81, v82
LE_dg9:
s_nop 3
v_mul_f32 v48, s57, v48
v_mul_f32 v49, s57, v49
v_mul_f32 v50, s57, v50
v_mul_f32 v51, s57, v51
s_cmp_eq_u32 s42, 0
s_cbranch_scc1 LE_fl9
buffer_load_dwordx2 v[66:67], v39, s[20:23], s47 offen sc1
s_waitcnt vmcnt(0)
v_lshlrev_b32 v64, 16, v66
v_and_b32 v65, 0xffff0000, v66
v_add_f32 v48, v48, v64
v_add_f32 v49, v49, v65
v_lshlrev_b32 v64, 16, v67
v_and_b32 v65, 0xffff0000, v67
v_add_f32 v50, v50, v64
v_add_f32 v51, v51, v65
LE_fl9:
v_cvt_pk_bf16_f32 v64, v48, v49
v_cvt_pk_bf16_f32 v65, v50, v51
v_mov_b32 v48, 0
v_mov_b32 v49, 0
v_mov_b32 v50, 0
v_mov_b32 v51, 0
buffer_store_dwordx2 v[64:65], v39, s[20:23], s47 offen sc1
s_add_u32 s47, s47, 512
LE_nf9:
v_mfma_f32_16x16x32_bf16 v[48:51], a[80:83], v[40:43], v[48:51]
v_mfma_f32_16x16x32_bf16 v[48:51], a[84:87], v[44:47], v[48:51]
s_bitcmp1_b32 s46, 10
s_cbranch_scc0 LE_nf10
v_readlane_b32 s57, v80, s51
s_add_u32 s51, s51, 1
s_and_b32 s51, s51, 63
s_cbranch_scc1 LE_dg10
v_mov_b32 v80, v81
v_mov_b32 v81, v82
LE_dg10:
s_nop 3
v_mul_f32 v48, s57, v48
v_mul_f32 v49, s57, v49
v_mul_f32 v50, s57, v50
v_mul_f32 v51, s57, v51
s_cmp_eq_u32 s42, 0
s_cbranch_scc1 LE_fl10
buffer_load_dwordx2 v[66:67], v39, s[20:23], s47 offen sc1
s_waitcnt vmcnt(0)
v_lshlrev_b32 v64, 16, v66
v_and_b32 v65, 0xffff0000, v66
v_add_f32 v48, v48, v64
v_add_f32 v49, v49, v65
v_lshlrev_b32 v64, 16, v67
v_and_b32 v65, 0xffff0000, v67
v_add_f32 v50, v50, v64
v_add_f32 v51, v51, v65
LE_fl10:
v_cvt_pk_bf16_f32 v64, v48, v49
v_cvt_pk_bf16_f32 v65, v50, v51
v_mov_b32 v48, 0
v_mov_b32 v49, 0
v_mov_b32 v50, 0
v_mov_b32 v51, 0
buffer_store_dwordx2 v[64:65], v39, s[20:23], s47 offen sc1
s_add_u32 s47, s47, 512
LE_nf10:
v_mfma_f32_16x16x32_bf16 v[48:51], a[88:91], v[40:43], v[48:51]
v_mfma_f32_16x16x32_bf16 v[48:51], a[92:95], v[44:47], v[48:51]
s_bitcmp1_b32 s46, 11
s_cbranch_scc0 LE_nf11
v_readlane_b32 s57, v80, s51
s_add_u32 s51, s51, 1
s_and_b32 s51, s51, 63
s_cbranch_scc1 LE_dg11
v_mov_b32 v80, v81
v_mov_b32 v81, v82
LE_dg11:
s_nop 3
v_mul_f32 v48, s57, v48
v_mul_f32 v49, s57, v49
v_mul_f32 v50, s57, v50
v_mul_f32 v51, s57, v51
s_cmp_eq_u32 s42, 0
s_cbranch_scc1 LE_fl11
buffer_load_dwordx2 v[66:67], v39, s[20:23], s47 offen sc1
s_waitcnt vmcnt(0)
v_lshlrev_b32 v64, 16, v66
v_and_b32 v65, 0xffff0000, v66
v_add_f32 v48, v48, v64
v_add_f32 v49, v49, v65
v_lshlrev_b32 v64, 16, v67
v_and_b32 v65, 0xffff0000, v67
v_add_f32 v50, v50, v64
v_add_f32 v51, v51, v65
LE_fl11:
v_cvt_pk_bf16_f32 v64, v48, v49
v_cvt_pk_bf16_f32 v65, v50, v51
v_mov_b32 v48, 0
v_mov_b32 v49, 0
v_mov_b32 v50, 0
v_mov_b32 v51, 0
buffer_store_dwordx2 v[64:65], v39, s[20:23], s47 offen sc1
s_add_u32 s47, s47, 512
LE_nf11:
s_waitcnt lgkmcnt(0)
ds_read2_b32 v[56:57], v34 offset0:48 offset1:52
ds_read2_b32 v[58:59], v34 offset0:56 offset1:60
v_mad_u32_u16 v60, v52, s49, v2
v_mad_u32_u16 v61, v53, s49, v2
v_mad_u32_u16 v62, v54, s49, v2
v_mad_u32_u16 v63, v55, s49, v2
buffer_load_dwordx4 a[64:67], v60, s[16:19], 0 offen
buffer_load_dwordx4 a[68:71], v60, s[16:19], 0 offen offset:256
buffer_load_dwordx4 a[72:75], v61, s[16:19], 0 offen
buffer_load_dwordx4 a[76:79], v61, s[16:19], 0 offen offset:256
buffer_load_dwordx4 a[80:83], v62, s[16:19], 0 offen
buffer_load_dwordx4 a[84:87], v62, s[16:19], 0 offen offset:256
buffer_load_dwordx4 a[88:91], v63, s[16:19], 0 offen
buffer_load_dwordx4 a[92:95], v63, s[16:19], 0 offen offset:256
s_waitcnt vmcnt(56)
v_mfma_f32_16x16x32_bf16 v[48:51], a[96:99], v[40:43], v[48:51]
v_mfma_f32_16x16x32_bf16 v[48:51], a[100:103], v[44:47], v[48:51]
s_bitcmp1_b32 s46, 12
s_cbranch_scc0 LE_nf12
v_readlane_b32 s57, v80, s51
s_add_u32 s51, s51, 1
s_and_b32 s51, s51, 63
s_cbranch_scc1 LE_dg12
v_mov_b32 v80, v81
v_mov_b32 v81, v82
LE_dg12:
s_nop 3
v_mul_f32 v48, s57, v48
v_mul_f32 v49, s57, v49
v_mul_f32 v50, s57, v50
v_mul_f32 v51, s57, v51
s_cmp_eq_u32 s42, 0
s_cbranch_scc1 LE_fl12
buffer_load_dwordx2 v[66:67], v39, s[20:23], s47 offen sc1
s_waitcnt vmcnt(0)
v_lshlrev_b32 v64, 16, v66
v_and_b32 v65, 0xffff0000, v66
v_add_f32 v48, v48, v64
v_add_f32 v49, v49, v65
v_lshlrev_b32 v64, 16, v67
v_and_b32 v65, 0xffff0000, v67
v_add_f32 v50, v50, v64
v_add_f32 v51, v51, v65
LE_fl12:
v_cvt_pk_bf16_f32 v64, v48, v49
v_cvt_pk_bf16_f32 v65, v50, v51
v_mov_b32 v48, 0
v_mov_b32 v49, 0
v_mov_b32 v50, 0
v_mov_b32 v51, 0
buffer_store_dwordx2 v[64:65], v39, s[20:23], s47 offen sc1
s_add_u32 s47, s47, 512
LE_nf12:
v_mfma_f32_16x16x32_bf16 v[48:51], a[104:107], v[40:43], v[48:51]
v_mfma_f32_16x16x32_bf16 v[48:51], a[108:111], v[44:47], v[48:51]
s_bitcmp1_b32 s46, 13
s_cbranch_scc0 LE_nf13
v_readlane_b32 s57, v80, s51
s_add_u32 s51, s51, 1
s_and_b32 s51, s51, 63
s_cbranch_scc1 LE_dg13
v_mov_b32 v80, v81
v_mov_b32 v81, v82
LE_dg13:
s_nop 3
v_mul_f32 v48, s57, v48
v_mul_f32 v49, s57, v49
v_mul_f32 v50, s57, v50
v_mul_f32 v51, s57, v51
s_cmp_eq_u32 s42, 0
s_cbranch_scc1 LE_fl13
buffer_load_dwordx2 v[66:67], v39, s[20:23], s47 offen sc1
s_waitcnt vmcnt(0)
v_lshlrev_b32 v64, 16, v66
v_and_b32 v65, 0xffff0000, v66
v_add_f32 v48, v48, v64
v_add_f32 v49, v49, v65
v_lshlrev_b32 v64, 16, v67
v_and_b32 v65, 0xffff0000, v67
v_add_f32 v50, v50, v64
v_add_f32 v51, v51, v65
LE_fl13:
v_cvt_pk_bf16_f32 v64, v48, v49
v_cvt_pk_bf16_f32 v65, v50, v51
v_mov_b32 v48, 0
v_mov_b32 v49, 0
v_mov_b32 v50, 0
v_mov_b32 v51, 0
buffer_store_dwordx2 v[64:65], v39, s[20:23], s47 offen sc1
s_add_u32 s47, s47, 512
LE_nf13:
v_mfma_f32_16x16x32_bf16 v[48:51], a[112:115], v[40:43], v[48:51]
v_mfma_f32_16x16x32_bf16 v[48:51], a[116:119], v[44:47], v[48:51]
s_bitcmp1_b32 s46, 14
s_cbranch_scc0 LE_nf14
v_readlane_b32 s57, v80, s51
s_add_u32 s51, s51, 1
s_and_b32 s51, s51, 63
s_cbranch_scc1 LE_dg14
v_mov_b32 v80, v81
v_mov_b32 v81, v82
LE_dg14:
s_nop 3
v_mul_f32 v48, s57, v48
v_mul_f32 v49, s57, v49
v_mul_f32 v50, s57, v50
v_mul_f32 v51, s57, v51
s_cmp_eq_u32 s42, 0
s_cbranch_scc1 LE_fl14
buffer_load_dwordx2 v[66:67], v39, s[20:23], s47 offen sc1
s_waitcnt vmcnt(0)
v_lshlrev_b32 v64, 16, v66
v_and_b32 v65, 0xffff0000, v66
v_add_f32 v48, v48, v64
v_add_f32 v49, v49, v65
v_lshlrev_b32 v64, 16, v67
v_and_b32 v65, 0xffff0000, v67
v_add_f32 v50, v50, v64
v_add_f32 v51, v51, v65
LE_fl14:
v_cvt_pk_bf16_f32 v64, v48, v49
v_cvt_pk_bf16_f32 v65, v50, v51
v_mov_b32 v48, 0
v_mov_b32 v49, 0
v_mov_b32 v50, 0
v_mov_b32 v51, 0
buffer_store_dwordx2 v[64:65], v39, s[20:23], s47 offen sc1
s_add_u32 s47, s47, 512
LE_nf14:
v_mfma_f32_16x16x32_bf16 v[48:51], a[120:123], v[40:43], v[48:51]
v_mfma_f32_16x16x32_bf16 v[48:51], a[124:127], v[44:47], v[48:51]
s_bitcmp1_b32 s46, 15
s_cbranch_scc0 LE_nf15
v_readlane_b32 s57, v80, s51
s_add_u32 s51, s51, 1
s_and_b32 s51, s51, 63
s_cbranch_scc1 LE_dg15
v_mov_b32 v80, v81
v_mov_b32 v81, v82
LE_dg15:
s_nop 3
v_mul_f32 v48, s57, v48
v_mul_f32 v49, s57, v49
v_mul_f32 v50, s57, v50
v_mul_f32 v51, s57, v51
s_cmp_eq_u32 s42, 0
s_cbranch_scc1 LE_fl15
buffer_load_dwordx2 v[66:67], v39, s[20:23], s47 offen sc1
s_waitcnt vmcnt(0)
v_lshlrev_b32 v64, 16, v66
v_and_b32 v65, 0xffff0000, v66
v_add_f32 v48, v48, v64
v_add_f32 v49, v49, v65
v_lshlrev_b32 v64, 16, v67
v_and_b32 v65, 0xffff0000, v67
v_add_f32 v50, v50, v64
v_add_f32 v51, v51, v65
LE_fl15:
v_cvt_pk_bf16_f32 v64, v48, v49
v_cvt_pk_bf16_f32 v65, v50, v51
v_mov_b32 v48, 0
v_mov_b32 v49, 0
v_mov_b32 v50, 0
v_mov_b32 v51, 0
buffer_store_dwordx2 v[64:65], v39, s[20:23], s47 offen sc1
s_add_u32 s47, s47, 512
LE_nf15:
s_waitcnt lgkmcnt(0)
ds_read2_b32 v[52:53], v34 offset0:64 offset1:68
ds_read2_b32 v[54:55], v34 offset0:72 offset1:76
v_mad_u32_u16 v60, v56, s49, v2
v_mad_u32_u16 v61, v57, s49, v2
v_mad_u32_u16 v62, v58, s49, v2
v_mad_u32_u16 v63, v59, s49, v2
buffer_load_dwordx4 a[96:99], v60, s[16:19], 0 offen
buffer_load_dwordx4 a[100:103], v60, s[16:19], 0 offen offset:256
buffer_load_dwordx4 a[104:107], v61, s[16:19], 0 offen
buffer_load_dwordx4 a[108:111], v61, s[16:19], 0 offen offset:256
buffer_load_dwordx4 a[112:115], v62, s[16:19], 0 offen
buffer_load_dwordx4 a[116:119], v62, s[16:19], 0 offen offset:256
buffer_load_dwordx4 a[120:123], v63, s[16:19], 0 offen
buffer_load_dwordx4 a[124:127], v63, s[16:19], 0 offen offset:256
s_waitcnt vmcnt(56)
v_mfma_f32_16x16x32_bf16 v[48:51], a[128:131], v[40:43], v[48:51]
v_mfma_f32_16x16x32_bf16 v[48:51], a[132:135], v[44:47], v[48:51]
s_bitcmp1_b32 s46, 16
s_cbranch_scc0 LE_nf16
v_readlane_b32 s57, v80, s51
s_add_u32 s51, s51, 1
s_and_b32 s51, s51, 63
s_cbranch_scc1 LE_dg16
v_mov_b32 v80, v81
v_mov_b32 v81, v82
LE_dg16:
s_nop 3
v_mul_f32 v48, s57, v48
v_mul_f32 v49, s57, v49
v_mul_f32 v50, s57, v50
v_mul_f32 v51, s57, v51
s_cmp_eq_u32 s42, 0
s_cbranch_scc1 LE_fl16
buffer_load_dwordx2 v[66:67], v39, s[20:23], s47 offen sc1
s_waitcnt vmcnt(0)
v_lshlrev_b32 v64, 16, v66
v_and_b32 v65, 0xffff0000, v66
v_add_f32 v48, v48, v64
v_add_f32 v49, v49, v65
v_lshlrev_b32 v64, 16, v67
v_and_b32 v65, 0xffff0000, v67
v_add_f32 v50, v50, v64
v_add_f32 v51, v51, v65
LE_fl16:
v_cvt_pk_bf16_f32 v64, v48, v49
v_cvt_pk_bf16_f32 v65, v50, v51
v_mov_b32 v48, 0
v_mov_b32 v49, 0
v_mov_b32 v50, 0
v_mov_b32 v51, 0
buffer_store_dwordx2 v[64:65], v39, s[20:23], s47 offen sc1
s_add_u32 s47, s47, 512
LE_nf16:
v_mfma_f32_16x16x32_bf16 v[48:51], a[136:139], v[40:43], v[48:51]
v_mfma_f32_16x16x32_bf16 v[48:51], a[140:143], v[44:47], v[48:51]
s_bitcmp1_b32 s46, 17
s_cbranch_scc0 LE_nf17
v_readlane_b32 s57, v80, s51
s_add_u32 s51, s51, 1
s_and_b32 s51, s51, 63
s_cbranch_scc1 LE_dg17
v_mov_b32 v80, v81
v_mov_b32 v81, v82
LE_dg17:
s_nop 3
v_mul_f32 v48, s57, v48
v_mul_f32 v49, s57, v49
v_mul_f32 v50, s57, v50
v_mul_f32 v51, s57, v51
s_cmp_eq_u32 s42, 0
s_cbranch_scc1 LE_fl17
buffer_load_dwordx2 v[66:67], v39, s[20:23], s47 offen sc1
s_waitcnt vmcnt(0)
v_lshlrev_b32 v64, 16, v66
v_and_b32 v65, 0xffff0000, v66
v_add_f32 v48, v48, v64
v_add_f32 v49, v49, v65
v_lshlrev_b32 v64, 16, v67
v_and_b32 v65, 0xffff0000, v67
v_add_f32 v50, v50, v64
v_add_f32 v51, v51, v65
LE_fl17:
v_cvt_pk_bf16_f32 v64, v48, v49
v_cvt_pk_bf16_f32 v65, v50, v51
v_mov_b32 v48, 0
v_mov_b32 v49, 0
v_mov_b32 v50, 0
v_mov_b32 v51, 0
buffer_store_dwordx2 v[64:65], v39, s[20:23], s47 offen sc1
s_add_u32 s47, s47, 512
LE_nf17:
v_mfma_f32_16x16x32_bf16 v[48:51], a[144:147], v[40:43], v[48:51]
v_mfma_f32_16x16x32_bf16 v[48:51], a[148:151], v[44:47], v[48:51]
s_bitcmp1_b32 s46, 18
s_cbranch_scc0 LE_nf18
v_readlane_b32 s57, v80, s51
s_add_u32 s51, s51, 1
s_and_b32 s51, s51, 63
s_cbranch_scc1 LE_dg18
v_mov_b32 v80, v81
v_mov_b32 v81, v82
LE_dg18:
s_nop 3
v_mul_f32 v48, s57, v48
v_mul_f32 v49, s57, v49
v_mul_f32 v50, s57, v50
v_mul_f32 v51, s57, v51
s_cmp_eq_u32 s42, 0
s_cbranch_scc1 LE_fl18
buffer_load_dwordx2 v[66:67], v39, s[20:23], s47 offen sc1
s_waitcnt vmcnt(0)
v_lshlrev_b32 v64, 16, v66
v_and_b32 v65, 0xffff0000, v66
v_add_f32 v48, v48, v64
v_add_f32 v49, v49, v65
v_lshlrev_b32 v64, 16, v67
v_and_b32 v65, 0xffff0000, v67
v_add_f32 v50, v50, v64
v_add_f32 v51, v51, v65
LE_fl18:
v_cvt_pk_bf16_f32 v64, v48, v49
v_cvt_pk_bf16_f32 v65, v50, v51
v_mov_b32 v48, 0
v_mov_b32 v49, 0
v_mov_b32 v50, 0
v_mov_b32 v51, 0
buffer_store_dwordx2 v[64:65], v39, s[20:23], s47 offen sc1
s_add_u32 s47, s47, 512
LE_nf18:
v_mfma_f32_16x16x32_bf16 v[48:51], a[152:155], v[40:43], v[48:51]
v_mfma_f32_16x16x32_bf16 v[48:51], a[156:159], v[44:47], v[48:51]
s_bitcmp1_b32 s46, 19
s_cbranch_scc0 LE_nf19
v_readlane_b32 s57, v80, s51
s_add_u32 s51, s51, 1
s_and_b32 s51, s51, 63
s_cbranch_scc1 LE_dg19
v_mov_b32 v80, v81
v_mov_b32 v81, v82
LE_dg19:
s_nop 3
v_mul_f32 v48, s57, v48
v_mul_f32 v49, s57, v49
v_mul_f32 v50, s57, v50
v_mul_f32 v51, s57, v51
s_cmp_eq_u32 s42, 0
s_cbranch_scc1 LE_fl19
buffer_load_dwordx2 v[66:67], v39, s[20:23], s47 offen sc1
s_waitcnt vmcnt(0)
v_lshlrev_b32 v64, 16, v66
v_and_b32 v65, 0xffff0000, v66
v_add_f32 v48, v48, v64
v_add_f32 v49, v49, v65
v_lshlrev_b32 v64, 16, v67
v_and_b32 v65, 0xffff0000, v67
v_add_f32 v50, v50, v64
v_add_f32 v51, v51, v65
LE_fl19:
v_cvt_pk_bf16_f32 v64, v48, v49
v_cvt_pk_bf16_f32 v65, v50, v51
v_mov_b32 v48, 0
v_mov_b32 v49, 0
v_mov_b32 v50, 0
v_mov_b32 v51, 0
buffer_store_dwordx2 v[64:65], v39, s[20:23], s47 offen sc1
s_add_u32 s47, s47, 512
LE_nf19:
s_waitcnt lgkmcnt(0)
ds_read2_b32 v[56:57], v34 offset0:80 offset1:84
ds_read2_b32 v[58:59], v34 offset0:88 offset1:92
v_mad_u32_u16 v60, v52, s49, v2
v_mad_u32_u16 v61, v53, s49, v2
v_mad_u32_u16 v62, v54, s49, v2
v_mad_u32_u16 v63, v55, s49, v2
buffer_load_dwordx4 a[128:131], v60, s[16:19], 0 offen
buffer_load_dwordx4 a[132:135], v60, s[16:19], 0 offen offset:256
buffer_load_dwordx4 a[136:139], v61, s[16:19], 0 offen
buffer_load_dwordx4 a[140:143], v61, s[16:19], 0 offen offset:256
buffer_load_dwordx4 a[144:147], v62, s[16:19], 0 offen
buffer_load_dwordx4 a[148:151], v62, s[16:19], 0 offen offset:256
buffer_load_dwordx4 a[152:155], v63, s[16:19], 0 offen
buffer_load_dwordx4 a[156:159], v63, s[16:19], 0 offen offset:256
s_waitcnt vmcnt(56)
v_mfma_f32_16x16x32_bf16 v[48:51], a[160:163], v[40:43], v[48:51]
v_mfma_f32_16x16x32_bf16 v[48:51], a[164:167], v[44:47], v[48:51]
s_bitcmp1_b32 s46, 20
s_cbranch_scc0 LE_nf20
v_readlane_b32 s57, v80, s51
s_add_u32 s51, s51, 1
s_and_b32 s51, s51, 63
s_cbranch_scc1 LE_dg20
v_mov_b32 v80, v81
v_mov_b32 v81, v82
LE_dg20:
s_nop 3
v_mul_f32 v48, s57, v48
v_mul_f32 v49, s57, v49
v_mul_f32 v50, s57, v50
v_mul_f32 v51, s57, v51
s_cmp_eq_u32 s42, 0
s_cbranch_scc1 LE_fl20
buffer_load_dwordx2 v[66:67], v39, s[20:23], s47 offen sc1
s_waitcnt vmcnt(0)
v_lshlrev_b32 v64, 16, v66
v_and_b32 v65, 0xffff0000, v66
v_add_f32 v48, v48, v64
v_add_f32 v49, v49, v65
v_lshlrev_b32 v64, 16, v67
v_and_b32 v65, 0xffff0000, v67
v_add_f32 v50, v50, v64
v_add_f32 v51, v51, v65
LE_fl20:
v_cvt_pk_bf16_f32 v64, v48, v49
v_cvt_pk_bf16_f32 v65, v50, v51
v_mov_b32 v48, 0
v_mov_b32 v49, 0
v_mov_b32 v50, 0
v_mov_b32 v51, 0
buffer_store_dwordx2 v[64:65], v39, s[20:23], s47 offen sc1
s_add_u32 s47, s47, 512
LE_nf20:
v_mfma_f32_16x16x32_bf16 v[48:51], a[168:171], v[40:43], v[48:51]
v_mfma_f32_16x16x32_bf16 v[48:51], a[172:175], v[44:47], v[48:51]
s_bitcmp1_b32 s46, 21
s_cbranch_scc0 LE_nf21
v_readlane_b32 s57, v80, s51
s_add_u32 s51, s51, 1
s_and_b32 s51, s51, 63
s_cbranch_scc1 LE_dg21
v_mov_b32 v80, v81
v_mov_b32 v81, v82
LE_dg21:
s_nop 3
v_mul_f32 v48, s57, v48
v_mul_f32 v49, s57, v49
v_mul_f32 v50, s57, v50
v_mul_f32 v51, s57, v51
s_cmp_eq_u32 s42, 0
s_cbranch_scc1 LE_fl21
buffer_load_dwordx2 v[66:67], v39, s[20:23], s47 offen sc1
s_waitcnt vmcnt(0)
v_lshlrev_b32 v64, 16, v66
v_and_b32 v65, 0xffff0000, v66
v_add_f32 v48, v48, v64
v_add_f32 v49, v49, v65
v_lshlrev_b32 v64, 16, v67
v_and_b32 v65, 0xffff0000, v67
v_add_f32 v50, v50, v64
v_add_f32 v51, v51, v65
LE_fl21:
v_cvt_pk_bf16_f32 v64, v48, v49
v_cvt_pk_bf16_f32 v65, v50, v51
v_mov_b32 v48, 0
v_mov_b32 v49, 0
v_mov_b32 v50, 0
v_mov_b32 v51, 0
buffer_store_dwordx2 v[64:65], v39, s[20:23], s47 offen sc1
s_add_u32 s47, s47, 512
LE_nf21:
v_mfma_f32_16x16x32_bf16 v[48:51], a[176:179], v[40:43], v[48:51]
v_mfma_f32_16x16x32_bf16 v[48:51], a[180:183], v[44:47], v[48:51]
s_bitcmp1_b32 s46, 22
s_cbranch_scc0 LE_nf22
v_readlane_b32 s57, v80, s51
s_add_u32 s51, s51, 1
s_and_b32 s51, s51, 63
s_cbranch_scc1 LE_dg22
v_mov_b32 v80, v81
v_mov_b32 v81, v82
LE_dg22:
s_nop 3
v_mul_f32 v48, s57, v48
v_mul_f32 v49, s57, v49
v_mul_f32 v50, s57, v50
v_mul_f32 v51, s57, v51
s_cmp_eq_u32 s42, 0
s_cbranch_scc1 LE_fl22
buffer_load_dwordx2 v[66:67], v39, s[20:23], s47 offen sc1
s_waitcnt vmcnt(0)
v_lshlrev_b32 v64, 16, v66
v_and_b32 v65, 0xffff0000, v66
v_add_f32 v48, v48, v64
v_add_f32 v49, v49, v65
v_lshlrev_b32 v64, 16, v67
v_and_b32 v65, 0xffff0000, v67
v_add_f32 v50, v50, v64
v_add_f32 v51, v51, v65
LE_fl22:
v_cvt_pk_bf16_f32 v64, v48, v49
v_cvt_pk_bf16_f32 v65, v50, v51
v_mov_b32 v48, 0
v_mov_b32 v49, 0
v_mov_b32 v50, 0
v_mov_b32 v51, 0
buffer_store_dwordx2 v[64:65], v39, s[20:23], s47 offen sc1
s_add_u32 s47, s47, 512
LE_nf22:
v_mfma_f32_16x16x32_bf16 v[48:51], a[184:187], v[40:43], v[48:51]
v_mfma_f32_16x16x32_bf16 v[48:51], a[188:191], v[44:47], v[48:51]
s_bitcmp1_b32 s46, 23
s_cbranch_scc0 LE_nf23
v_readlane_b32 s57, v80, s51
s_add_u32 s51, s51, 1
s_and_b32 s51, s51, 63
s_cbranch_scc1 LE_dg23
v_mov_b32 v80, v81
v_mov_b32 v81, v82
LE_dg23:
s_nop 3
v_mul_f32 v48, s57, v48
v_mul_f32 v49, s57, v49
v_mul_f32 v50, s57, v50
v_mul_f32 v51, s57, v51
s_cmp_eq_u32 s42, 0
s_cbranch_scc1 LE_fl23
buffer_load_dwordx2 v[66:67], v39, s[20:23], s47 offen sc1
s_waitcnt vmcnt(0)
v_lshlrev_b32 v64, 16, v66
v_and_b32 v65, 0xffff0000, v66
v_add_f32 v48, v48, v64
v_add_f32 v49, v49, v65
v_lshlrev_b32 v64, 16, v67
v_and_b32 v65, 0xffff0000, v67
v_add_f32 v50, v50, v64
v_add_f32 v51, v51, v65
LE_fl23:
v_cvt_pk_bf16_f32 v64, v48, v49
v_cvt_pk_bf16_f32 v65, v50, v51
v_mov_b32 v48, 0
v_mov_b32 v49, 0
v_mov_b32 v50, 0
v_mov_b32 v51, 0
buffer_store_dwordx2 v[64:65], v39, s[20:23], s47 offen sc1
s_add_u32 s47, s47, 512
LE_nf23:
s_waitcnt lgkmcnt(0)
ds_read2_b32 v[52:53], v34 offset0:96 offset1:100
ds_read2_b32 v[54:55], v34 offset0:104 offset1:108
v_mad_u32_u16 v60, v56, s49, v2
v_mad_u32_u16 v61, v57, s49, v2
v_mad_u32_u16 v62, v58, s49, v2
v_mad_u32_u16 v63, v59, s49, v2
buffer_load_dwordx4 a[160:163], v60, s[16:19], 0 offen
buffer_load_dwordx4 a[164:167], v60, s[16:19], 0 offen offset:256
buffer_load_dwordx4 a[168:171], v61, s[16:19], 0 offen
buffer_load_dwordx4 a[172:175], v61, s[16:19], 0 offen offset:256
buffer_load_dwordx4 a[176:179], v62, s[16:19], 0 offen
buffer_load_dwordx4 a[180:183], v62, s[16:19], 0 offen offset:256
buffer_load_dwordx4 a[184:187], v63, s[16:19], 0 offen
buffer_load_dwordx4 a[188:191], v63, s[16:19], 0 offen offset:256
s_waitcnt vmcnt(56)
v_mfma_f32_16x16x32_bf16 v[48:51], a[192:195], v[40:43], v[48:51]
v_mfma_f32_16x16x32_bf16 v[48:51], a[196:199], v[44:47], v[48:51]
s_bitcmp1_b32 s46, 24
s_cbranch_scc0 LE_nf24
v_readlane_b32 s57, v80, s51
s_add_u32 s51, s51, 1
s_and_b32 s51, s51, 63
s_cbranch_scc1 LE_dg24
v_mov_b32 v80, v81
v_mov_b32 v81, v82
LE_dg24:
s_nop 3
v_mul_f32 v48, s57, v48
v_mul_f32 v49, s57, v49
v_mul_f32 v50, s57, v50
v_mul_f32 v51, s57, v51
s_cmp_eq_u32 s42, 0
s_cbranch_scc1 LE_fl24
buffer_load_dwordx2 v[66:67], v39, s[20:23], s47 offen sc1
s_waitcnt vmcnt(0)
v_lshlrev_b32 v64, 16, v66
v_and_b32 v65, 0xffff0000, v66
v_add_f32 v48, v48, v64
v_add_f32 v49, v49, v65
v_lshlrev_b32 v64, 16, v67
v_and_b32 v65, 0xffff0000, v67
v_add_f32 v50, v50, v64
v_add_f32 v51, v51, v65
LE_fl24:
v_cvt_pk_bf16_f32 v64, v48, v49
v_cvt_pk_bf16_f32 v65, v50, v51
v_mov_b32 v48, 0
v_mov_b32 v49, 0
v_mov_b32 v50, 0
v_mov_b32 v51, 0
buffer_store_dwordx2 v[64:65], v39, s[20:23], s47 offen sc1
s_add_u32 s47, s47, 512
LE_nf24:
v_mfma_f32_16x16x32_bf16 v[48:51], a[200:203], v[40:43], v[48:51]
v_mfma_f32_16x16x32_bf16 v[48:51], a[204:207], v[44:47], v[48:51]
s_bitcmp1_b32 s46, 25
s_cbranch_scc0 LE_nf25
v_readlane_b32 s57, v80, s51
s_add_u32 s51, s51, 1
s_and_b32 s51, s51, 63
s_cbranch_scc1 LE_dg25
v_mov_b32 v80, v81
v_mov_b32 v81, v82
LE_dg25:
s_nop 3
v_mul_f32 v48, s57, v48
v_mul_f32 v49, s57, v49
v_mul_f32 v50, s57, v50
v_mul_f32 v51, s57, v51
s_cmp_eq_u32 s42, 0
s_cbranch_scc1 LE_fl25
buffer_load_dwordx2 v[66:67], v39, s[20:23], s47 offen sc1
s_waitcnt vmcnt(0)
v_lshlrev_b32 v64, 16, v66
v_and_b32 v65, 0xffff0000, v66
v_add_f32 v48, v48, v64
v_add_f32 v49, v49, v65
v_lshlrev_b32 v64, 16, v67
v_and_b32 v65, 0xffff0000, v67
v_add_f32 v50, v50, v64
v_add_f32 v51, v51, v65
LE_fl25:
v_cvt_pk_bf16_f32 v64, v48, v49
v_cvt_pk_bf16_f32 v65, v50, v51
v_mov_b32 v48, 0
v_mov_b32 v49, 0
v_mov_b32 v50, 0
v_mov_b32 v51, 0
buffer_store_dwordx2 v[64:65], v39, s[20:23], s47 offen sc1
s_add_u32 s47, s47, 512
LE_nf25:
v_mfma_f32_16x16x32_bf16 v[48:51], a[208:211], v[40:43], v[48:51]
v_mfma_f32_16x16x32_bf16 v[48:51], a[212:215], v[44:47], v[48:51]
s_bitcmp1_b32 s46, 26
s_cbranch_scc0 LE_nf26
v_readlane_b32 s57, v80, s51
s_add_u32 s51, s51, 1
s_and_b32 s51, s51, 63
s_cbranch_scc1 LE_dg26
v_mov_b32 v80, v81
v_mov_b32 v81, v82
LE_dg26:
s_nop 3
v_mul_f32 v48, s57, v48
v_mul_f32 v49, s57, v49
v_mul_f32 v50, s57, v50
v_mul_f32 v51, s57, v51
s_cmp_eq_u32 s42, 0
s_cbranch_scc1 LE_fl26
buffer_load_dwordx2 v[66:67], v39, s[20:23], s47 offen sc1
s_waitcnt vmcnt(0)
v_lshlrev_b32 v64, 16, v66
v_and_b32 v65, 0xffff0000, v66
v_add_f32 v48, v48, v64
v_add_f32 v49, v49, v65
v_lshlrev_b32 v64, 16, v67
v_and_b32 v65, 0xffff0000, v67
v_add_f32 v50, v50, v64
v_add_f32 v51, v51, v65
LE_fl26:
v_cvt_pk_bf16_f32 v64, v48, v49
v_cvt_pk_bf16_f32 v65, v50, v51
v_mov_b32 v48, 0
v_mov_b32 v49, 0
v_mov_b32 v50, 0
v_mov_b32 v51, 0
buffer_store_dwordx2 v[64:65], v39, s[20:23], s47 offen sc1
s_add_u32 s47, s47, 512
LE_nf26:
v_mfma_f32_16x16x32_bf16 v[48:51], a[216:219], v[40:43], v[48:51]
v_mfma_f32_16x16x32_bf16 v[48:51], a[220:223], v[44:47], v[48:51]
s_bitcmp1_b32 s46, 27
s_cbranch_scc0 LE_nf27
v_readlane_b32 s57, v80, s51
s_add_u32 s51, s51, 1
s_and_b32 s51, s51, 63
s_cbranch_scc1 LE_dg27
v_mov_b32 v80, v81
v_mov_b32 v81, v82
LE_dg27:
s_nop 3
v_mul_f32 v48, s57, v48
v_mul_f32 v49, s57, v49
v_mul_f32 v50, s57, v50
v_mul_f32 v51, s57, v51
s_cmp_eq_u32 s42, 0
s_cbranch_scc1 LE_fl27
buffer_load_dwordx2 v[66:67], v39, s[20:23], s47 offen sc1
s_waitcnt vmcnt(0)
v_lshlrev_b32 v64, 16, v66
v_and_b32 v65, 0xffff0000, v66
v_add_f32 v48, v48, v64
v_add_f32 v49, v49, v65
v_lshlrev_b32 v64, 16, v67
v_and_b32 v65, 0xffff0000, v67
v_add_f32 v50, v50, v64
v_add_f32 v51, v51, v65
LE_fl27:
v_cvt_pk_bf16_f32 v64, v48, v49
v_cvt_pk_bf16_f32 v65, v50, v51
v_mov_b32 v48, 0
v_mov_b32 v49, 0
v_mov_b32 v50, 0
v_mov_b32 v51, 0
buffer_store_dwordx2 v[64:65], v39, s[20:23], s47 offen sc1
s_add_u32 s47, s47, 512
LE_nf27:
s_waitcnt lgkmcnt(0)
ds_read2_b32 v[56:57], v34 offset0:112 offset1:116
ds_read2_b32 v[58:59], v34 offset0:120 offset1:124
v_mad_u32_u16 v60, v52, s49, v2
v_mad_u32_u16 v61, v53, s49, v2
v_mad_u32_u16 v62, v54, s49, v2
v_mad_u32_u16 v63, v55, s49, v2
buffer_load_dwordx4 a[192:195], v60, s[16:19], 0 offen
buffer_load_dwordx4 a[196:199], v60, s[16:19], 0 offen offset:256
buffer_load_dwordx4 a[200:203], v61, s[16:19], 0 offen
buffer_load_dwordx4 a[204:207], v61, s[16:19], 0 offen offset:256
buffer_load_dwordx4 a[208:211], v62, s[16:19], 0 offen
buffer_load_dwordx4 a[212:215], v62, s[16:19], 0 offen offset:256
buffer_load_dwordx4 a[216:219], v63, s[16:19], 0 offen
buffer_load_dwordx4 a[220:223], v63, s[16:19], 0 offen offset:256
s_waitcnt vmcnt(56)
v_mfma_f32_16x16x32_bf16 v[48:51], a[224:227], v[40:43], v[48:51]
v_mfma_f32_16x16x32_bf16 v[48:51], a[228:231], v[44:47], v[48:51]
s_bitcmp1_b32 s46, 28
s_cbranch_scc0 LE_nf28
v_readlane_b32 s57, v80, s51
s_add_u32 s51, s51, 1
s_and_b32 s51, s51, 63
s_cbranch_scc1 LE_dg28
v_mov_b32 v80, v81
v_mov_b32 v81, v82
LE_dg28:
s_nop 3
v_mul_f32 v48, s57, v48
v_mul_f32 v49, s57, v49
v_mul_f32 v50, s57, v50
v_mul_f32 v51, s57, v51
s_cmp_eq_u32 s42, 0
s_cbranch_scc1 LE_fl28
buffer_load_dwordx2 v[66:67], v39, s[20:23], s47 offen sc1
s_waitcnt vmcnt(0)
v_lshlrev_b32 v64, 16, v66
v_and_b32 v65, 0xffff0000, v66
v_add_f32 v48, v48, v64
v_add_f32 v49, v49, v65
v_lshlrev_b32 v64, 16, v67
v_and_b32 v65, 0xffff0000, v67
v_add_f32 v50, v50, v64
v_add_f32 v51, v51, v65
LE_fl28:
v_cvt_pk_bf16_f32 v64, v48, v49
v_cvt_pk_bf16_f32 v65, v50, v51
v_mov_b32 v48, 0
v_mov_b32 v49, 0
v_mov_b32 v50, 0
v_mov_b32 v51, 0
buffer_store_dwordx2 v[64:65], v39, s[20:23], s47 offen sc1
s_add_u32 s47, s47, 512
LE_nf28:
v_mfma_f32_16x16x32_bf16 v[48:51], a[232:235], v[40:43], v[48:51]
v_mfma_f32_16x16x32_bf16 v[48:51], a[236:239], v[44:47], v[48:51]
s_bitcmp1_b32 s46, 29
s_cbranch_scc0 LE_nf29
v_readlane_b32 s57, v80, s51
s_add_u32 s51, s51, 1
s_and_b32 s51, s51, 63
s_cbranch_scc1 LE_dg29
v_mov_b32 v80, v81
v_mov_b32 v81, v82
LE_dg29:
s_nop 3
v_mul_f32 v48, s57, v48
v_mul_f32 v49, s57, v49
v_mul_f32 v50, s57, v50
v_mul_f32 v51, s57, v51
s_cmp_eq_u32 s42, 0
s_cbranch_scc1 LE_fl29
buffer_load_dwordx2 v[66:67], v39, s[20:23], s47 offen sc1
s_waitcnt vmcnt(0)
v_lshlrev_b32 v64, 16, v66
v_and_b32 v65, 0xffff0000, v66
v_add_f32 v48, v48, v64
v_add_f32 v49, v49, v65
v_lshlrev_b32 v64, 16, v67
v_and_b32 v65, 0xffff0000, v67
v_add_f32 v50, v50, v64
v_add_f32 v51, v51, v65
LE_fl29:
v_cvt_pk_bf16_f32 v64, v48, v49
v_cvt_pk_bf16_f32 v65, v50, v51
v_mov_b32 v48, 0
v_mov_b32 v49, 0
v_mov_b32 v50, 0
v_mov_b32 v51, 0
buffer_store_dwordx2 v[64:65], v39, s[20:23], s47 offen sc1
s_add_u32 s47, s47, 512
LE_nf29:
v_mfma_f32_16x16x32_bf16 v[48:51], a[240:243], v[40:43], v[48:51]
v_mfma_f32_16x16x32_bf16 v[48:51], a[244:247], v[44:47], v[48:51]
s_bitcmp1_b32 s46, 30
s_cbranch_scc0 LE_nf30
v_readlane_b32 s57, v80, s51
s_add_u32 s51, s51, 1
s_and_b32 s51, s51, 63
s_cbranch_scc1 LE_dg30
v_mov_b32 v80, v81
v_mov_b32 v81, v82
LE_dg30:
s_nop 3
v_mul_f32 v48, s57, v48
v_mul_f32 v49, s57, v49
v_mul_f32 v50, s57, v50
v_mul_f32 v51, s57, v51
s_cmp_eq_u32 s42, 0
s_cbranch_scc1 LE_fl30
buffer_load_dwordx2 v[66:67], v39, s[20:23], s47 offen sc1
s_waitcnt vmcnt(0)
v_lshlrev_b32 v64, 16, v66
v_and_b32 v65, 0xffff0000, v66
v_add_f32 v48, v48, v64
v_add_f32 v49, v49, v65
v_lshlrev_b32 v64, 16, v67
v_and_b32 v65, 0xffff0000, v67
v_add_f32 v50, v50, v64
v_add_f32 v51, v51, v65
LE_fl30:
v_cvt_pk_bf16_f32 v64, v48, v49
v_cvt_pk_bf16_f32 v65, v50, v51
v_mov_b32 v48, 0
v_mov_b32 v49, 0
v_mov_b32 v50, 0
v_mov_b32 v51, 0
buffer_store_dwordx2 v[64:65], v39, s[20:23], s47 offen sc1
s_add_u32 s47, s47, 512
LE_nf30:
v_mfma_f32_16x16x32_bf16 v[48:51], a[248:251], v[40:43], v[48:51]
v_mfma_f32_16x16x32_bf16 v[48:51], a[252:255], v[44:47], v[48:51]
s_bitcmp1_b32 s46, 31
s_cbranch_scc0 LE_nf31
v_readlane_b32 s57, v80, s51
s_add_u32 s51, s51, 1
s_and_b32 s51, s51, 63
s_cbranch_scc1 LE_dg31
v_mov_b32 v80, v81
v_mov_b32 v81, v82
LE_dg31:
s_nop 3
v_mul_f32 v48, s57, v48
v_mul_f32 v49, s57, v49
v_mul_f32 v50, s57, v50
v_mul_f32 v51, s57, v51
s_cmp_eq_u32 s42, 0
s_cbranch_scc1 LE_fl31
buffer_load_dwordx2 v[66:67], v39, s[20:23], s47 offen sc1
s_waitcnt vmcnt(0)
v_lshlrev_b32 v64, 16, v66
v_and_b32 v65, 0xffff0000, v66
v_add_f32 v48, v48, v64
v_add_f32 v49, v49, v65
v_lshlrev_b32 v64, 16, v67
v_and_b32 v65, 0xffff0000, v67
v_add_f32 v50, v50, v64
v_add_f32 v51, v51, v65
LE_fl31:
v_cvt_pk_bf16_f32 v64, v48, v49
v_cvt_pk_bf16_f32 v65, v50, v51
v_mov_b32 v48, 0
v_mov_b32 v49, 0
v_mov_b32 v50, 0
v_mov_b32 v51, 0
buffer_store_dwordx2 v[64:65], v39, s[20:23], s47 offen sc1
s_add_u32 s47, s47, 512
LE_nf31:
s_waitcnt lgkmcnt(0)
ds_read2_b32 v[52:53], v34 offset0:128 offset1:132
ds_read2_b32 v[54:55], v34 offset0:136 offset1:140
v_mad_u32_u16 v60, v56, s49, v2
v_mad_u32_u16 v61, v57, s49, v2
v_mad_u32_u16 v62, v58, s49, v2
v_mad_u32_u16 v63, v59, s49, v2
buffer_load_dwordx4 a[224:227], v60, s[16:19], 0 offen
buffer_load_dwordx4 a[228:231], v60, s[16:19], 0 offen offset:256
buffer_load_dwordx4 a[232:235], v61, s[16:19], 0 offen
buffer_load_dwordx4 a[236:239], v61, s[16:19], 0 offen offset:256
buffer_load_dwordx4 a[240:243], v62, s[16:19], 0 offen
buffer_load_dwordx4 a[244:247], v62, s[16:19], 0 offen offset:256
buffer_load_dwordx4 a[248:251], v63, s[16:19], 0 offen
buffer_load_dwordx4 a[252:255], v63, s[16:19], 0 offen offset:256
v_add_u32 v34, 512, v34
s_cmp_lt_u32 s45, s44
s_cbranch_scc1 LE_loop
s_add_u32 s42, s42, 1
s_mul_i32 s43, s42, 128
v_cmp_lt_u32 vcc, s43, v4
s_cbranch_vccz LE_done
s_cmp_ge_u32 s42, 40
s_cbranch_scc1 LE_done
s_waitcnt vmcnt(0) lgkmcnt(0)
s_add_u32 s50, s50, 512
v_add_u32 v5, 0x80, v5
buffer_load_dwordx4 v[192:195], v6, s[12:15], s50 offen offset:0
buffer_load_dwordx4 v[196:199], v6, s[12:15], s50 offen offset:32
buffer_load_dwordx4 v[200:203], v6, s[12:15], s50 offen offset:64
buffer_load_dwordx4 v[204:207], v6, s[12:15], s50 offen offset:96
buffer_load_dwordx4 v[208:211], v6, s[12:15], s50 offen offset:128
buffer_load_dwordx4 v[212:215], v6, s[12:15], s50 offen offset:160
buffer_load_dwordx4 v[216:219], v6, s[12:15], s50 offen offset:192
buffer_load_dwordx4 v[220:223], v6, s[12:15], s50 offen offset:224
buffer_load_dwordx4 v[224:227], v6, s[12:15], s50 offen offset:256
buffer_load_dwordx4 v[228:231], v6, s[12:15], s50 offen offset:288
buffer_load_dwordx4 v[232:235], v6, s[12:15], s50 offen offset:320
buffer_load_dwordx4 v[236:239], v6, s[12:15], s50 offen offset:352
buffer_load_dwordx4 v[240:243], v6, s[12:15], s50 offen offset:384
buffer_load_dwordx4 v[244:247], v6, s[12:15], s50 offen offset:416
buffer_load_dwordx4 v[248:251], v6, s[12:15], s50 offen offset:448
buffer_load_dwordx4 v[252:255], v6, s[12:15], s50 offen offset:480
s_branch LE_pass
LE_done:
s_add_u32 s52, s4, 0x7c00000
s_addc_u32 s53, s5, 0
s_mov_b32 s54, 0x2000
s_mov_b32 s55, 0x00020000
v_mov_b32 v20, 5120
v_mov_b32 v21, 1
s_mov_b64 exec, 1
s_waitcnt vmcnt(0)
buffer_atomic_add v21, v20, s[52:55], 0 offen
s_mov_b64 exec, -1
s_getpc_b64 s[52:53]
LE_pc:
s_sub_u32 s52, s52, LE_pc-L2_tails
s_subb_u32 s53, s53, 0
s_mov_b32 s54, LT_disp-L2_tails
s_mov_b32 s55, 0x00020000
s_mov_b64 exec, -1
v_lshlrev_b32 v30, 7, v1
s_mov_b32 s56, 0x0
buffer_load_dword v32, v30, s[52:55], s56 offen
s_mov_b32 s56, 0x2000
buffer_load_dword v33, v30, s[52:55], s56 offen
s_mov_b32 s56, 0x4000
buffer_load_dword v34, v30, s[52:55], s56 offen
s_mov_b32 s56, 0x6000
buffer_load_dword v35, v30, s[52:55], s56 offen
s_mov_b32 s56, 0x8000
buffer_load_dword v36, v30, s[52:55], s56 offen
s_mov_b32 s56, 0xa000
buffer_load_dword v37, v30, s[52:55], s56 offen
s_mov_b32 s56, 0xc000
buffer_load_dword v38, v30, s[52:55], s56 offen
s_cmp_ge_u32 s2, 240
s_cbranch_scc1 LC_help
s_branch L2_end
LC_help:
s_waitcnt vmcnt(0)
s_mov_b32 s100, 0
s_load_dwordx2 s[6:7], s[0:1], 0
s_load_dwordx2 s[18:19], s[0:1], 72
s_mov_b32 s34, s41
v_mbcnt_lo_u32_b32 v252, -1, 0
v_mbcnt_hi_u32_b32 v252, -1, v252
v_lshlrev_b32 v252, 4, v252
s_and_b32 s32, s2, 7
s_mul_i32 s32, s32, 5
s_bfe_u32 s33, s2, 0x10003
s_mul_i32 s35, s33, 3
s_add_u32 s32, s32, s35
s_add_u32 s35, s32, 0
s_lshl_b32 s48, s35, 7
s_lshl_b32 s52, s35, 17
s_add_u32 s52, s52, 122880
s_add_u32 s35, s32, 1
s_lshl_b32 s49, s35, 7
s_lshl_b32 s53, s35, 17
s_add_u32 s53, s53, 122880
s_add_u32 s35, s32, 2
s_lshl_b32 s50, s35, 7
s_lshl_b32 s54, s35, 17
s_add_u32 s54, s54, 122880
s_cmp_eq_u32 s49, 4992
s_cselect_b32 s53, 5111808, s53
s_cmp_eq_u32 s33, 1
s_cselect_b32 s54, 0x7fff0000, s54
s_cselect_b32 s50, s48, s50
s_mov_b32 s15, 0x7fff0000
s_mov_b32 s14, 0
s_mov_b32 s99, 0
s_mov_b32 s51, 0
s_mov_b32 s98, 2
s_waitcnt lgkmcnt(0)
s_add_u32 s24, s4, 0x6000000
s_addc_u32 s25, s5, 0
s_mov_b32 s26, 0x9c800
s_mov_b32 s27, 0x00020000
s_add_u32 s56, s4, 0x1000000
s_addc_u32 s57, s5, 0
s_mov_b32 s58, 0x6c02000
s_mov_b32 s59, 0x00020000
s_branch LC_common
L2_fin:
L2_end:
s_endpgm
.section .rodata,"a"
.p2align 6
.amdhsa_kernel k1_kernel
  .amdhsa_next_free_vgpr 256
  .amdhsa_next_free_sgpr 102
  .amdhsa_accum_offset 256
  .amdhsa_group_segment_fixed_size 0
  .amdhsa_kernarg_size 96
  .amdhsa_user_sgpr_count 2
  .amdhsa_user_sgpr_kernarg_segment_ptr 1
  .amdhsa_system_sgpr_workgroup_id_x 1
.end_amdhsa_kernel
.p2align 6
.amdhsa_kernel k2_kernel
  .amdhsa_next_free_vgpr 512
  .amdhsa_next_free_sgpr 102
  .amdhsa_accum_offset 256
  .amdhsa_group_segment_fixed_size 0
  .amdhsa_kernarg_size 96
  .amdhsa_user_sgpr_count 2
  .amdhsa_user_sgpr_kernarg_segment_ptr 1
  .amdhsa_system_sgpr_workgroup_id_x 1
.end_amdhsa_kernel
```

```asm
; @launch kernel=k1_kernel grid=(249,1,1) block=(512,1,1) lds=163840
; @launch kernel=k2_kernel grid=(256,1,1) block=(256,1,1) lds=163840
.amdgcn_target "amdgcn-amd-amdhsa--gfx950"
.text
.globl k1_kernel
.p2align 8
.type k1_kernel,@function
k1_kernel:
s_getpc_b64 s[56:57]
s_load_dwordx16 s[16:31], s[0:1], 0
s_load_dwordx8 s[32:39], s[0:1], 64
s_cmp_ge_u32 s2, 249
s_cbranch_scc1 L1_end
v_lshrrev_b32 v1, 6, v0
v_and_b32 v2, 63, v0
s_lshr_b32 s3, s2, 3
v_readfirstlane_b32 s60, v1
s_mul_i32 s5, s3, 8
s_add_u32 s5, s5, s60
s_and_b32 s56, s56, 0xffffff00
s_mov_b32 s58, L2_end-k1_kernel
s_mov_b32 s59, 0x00020000
s_and_b32 s6, s5, 15
s_lshl_b32 s6, s6, 13
v_lshlrev_b32 v10, 7, v2
buffer_load_dword v255, v10, s[56:59], s6 offen
v_and_b32 v3, 15, v2
v_lshrrev_b32 v4, 4, v2
s_and_b32 s62, s3, 7
s_sub_u32 s4, s2, 40
s_cmp_lt_u32 s2, 40
s_cbranch_scc1 L1_notq
s_mov_b32 s61, 0
v_lshlrev_b32 v16, 4, v2
s_mul_i32 s63, s60, 6144
s_mul_i32 s6, s4, 24576
s_mul_i32 s7, s60, 3072
s_add_u32 s64, s6, s7
s_add_u32 s65, s64, 4096
s_lshl_b32 s7, s60, 6
v_lshrrev_b32 v5, 2, v2
v_and_b32 v6, 3, v2
v_lshrrev_b32 v7, 5, v2
v_lshlrev_b32 v7, 1, v7
v_xor_b32 v6, v6, v7
v_lshl_add_u32 v5, v5, 9, s7
v_lshl_add_u32 v17, v6, 4, v5
v_add_u32 v18, 0x1c00, v17
s_xor_b32 s6, s62, 0
s_lshl_b32 s66, s6, 14
s_xor_b32 s6, s62, 1
s_lshl_b32 s67, s6, 14
s_xor_b32 s6, s62, 2
s_lshl_b32 s68, s6, 14
s_xor_b32 s6, s62, 3
s_lshl_b32 s69, s6, 14
s_xor_b32 s6, s62, 4
s_lshl_b32 s70, s6, 14
s_xor_b32 s6, s62, 5
s_lshl_b32 s71, s6, 14
s_xor_b32 s6, s62, 6
s_lshl_b32 s72, s6, 14
s_xor_b32 s6, s62, 7
s_lshl_b32 s73, s6, 14
s_waitcnt lgkmcnt(0)
s_add_u32 s40, s16, 0x0
s_addc_u32 s41, s17, 0
s_mov_b32 s42, 0x4e2000
s_mov_b32 s43, 0x00020000
s_add_u32 s44, s26, 0x0
s_addc_u32 s45, s27, 0
s_mov_b32 s46, 0x20000
s_mov_b32 s47, 0x00020000
buffer_load_dwordx4 v[40:43], v16, s[40:43], s64 offen offset:0
buffer_load_dwordx4 v[44:47], v16, s[40:43], s64 offen offset:1024
buffer_load_dwordx4 v[48:51], v16, s[40:43], s64 offen offset:2048
s_add_u32 m0, s63, 0x0
s_nop 0
buffer_load_dwordx4 v17, s[44:47], s66 offen offset:0 lds
buffer_load_dwordx4 v18, s[44:47], s66 offen offset:1024 lds
s_add_u32 m0, s63, 0x800
s_nop 0
buffer_load_dwordx4 v17, s[44:47], s67 offen offset:0 lds
buffer_load_dwordx4 v18, s[44:47], s67 offen offset:1024 lds
v_bfe_u32 v5, v2, 2, 3
v_xor_b32 v5, s62, v5
v_and_b32 v6, 3, v2
v_lshlrev_b32 v7, 10, v5
v_lshl_add_u32 v7, v6, 8, v7
v_add_u32 v7, 0xc000, v7
v_and_b32 v5, 1, v5
v_lshl_or_b32 v6, v5, 2, v6
v_lshrrev_b32 v5, 5, v2
s_mul_i32 s6, s60, 6
v_add3_u32 v8, v5, s6, 0
v_lshrrev_b32 v9, 4, v8
v_lshl_add_u32 v9, v9, 13, v7
v_and_b32 v8, 15, v8
v_xor_b32 v8, v8, v6
v_lshl_add_u32 v36, v8, 4, v9
v_add3_u32 v8, v5, s6, 2
v_lshrrev_b32 v9, 4, v8
v_lshl_add_u32 v9, v9, 13, v7
v_and_b32 v8, 15, v8
v_xor_b32 v8, v8, v6
v_lshl_add_u32 v37, v8, 4, v9
v_add3_u32 v8, v5, s6, 4
v_lshrrev_b32 v9, 4, v8
v_lshl_add_u32 v9, v9, 13, v7
v_and_b32 v8, 15, v8
v_xor_b32 v8, v8, v6
v_lshl_add_u32 v38, v8, 4, v9
v_xor_b32 v5, v3, v4
v_lshlrev_b32 v5, 4, v5
v_lshl_add_u32 v5, v4, 8, v5
v_add_u32 v31, 0xc000, v5
v_xor_b32 v32, 64, v31
v_lshrrev_b32 v5, 2, v3
v_and_b32 v6, 3, v3
v_and_b32 v7, 1, v4
v_lshlrev_b32 v7, 1, v7
v_lshl_add_u32 v8, v4, 3, v5
v_lshlrev_b32 v8, 6, v8
v_add_u32 v8, s63, v8
v_and_b32 v9, 1, v6
v_lshl_add_u32 v8, v9, 3, v8
v_lshrrev_b32 v6, 1, v6
v_xor_b32 v6, v6, v7
v_xor_b32 v9, 0, v6
v_lshl_add_u32 v25, v9, 4, v8
v_xor_b32 v9, 2, v6
v_lshl_add_u32 v26, v9, 4, v8
v_lshrrev_b32 v5, 3, v2
v_and_b32 v6, 7, v2
v_lshrrev_b32 v7, 1, v5
v_xor_b32 v6, v6, v7
v_and_b32 v7, 4, v5
v_add_u32 v5, v5, v7
s_mul_i32 s6, s60, 16384
v_lshl_add_u32 v5, v5, 9, s6
v_lshl_add_u32 v21, v6, 4, v5
v_xor_b32 v6, 4, v6
v_lshl_add_u32 v22, v6, 4, v5
v_add_u32 v22, 0x1c00, v22
s_lshr_b32 s7, s62, 1
s_xor_b32 s6, s7, 0
s_lshl_b32 s74, s6, 7
s_add_u32 s75, s74, 2048
s_xor_b32 s6, s7, 1
s_lshl_b32 s76, s6, 7
s_add_u32 s77, s76, 2048
s_xor_b32 s6, s7, 2
s_lshl_b32 s78, s6, 7
s_add_u32 s79, s78, 2048
s_xor_b32 s6, s7, 3
s_lshl_b32 s80, s6, 7
s_add_u32 s81, s80, 2048
s_and_b32 s6, s62, 1
s_lshl_b32 s6, s6, 2
v_lshrrev_b32 v5, 1, v3
v_xor_b32 v5, v5, v4
v_xor_b32 v5, s6, v5
v_lshl_add_u32 v6, v3, 7, s63
v_lshl_add_u32 v29, v5, 4, v6
v_xor_b32 v30, 64, v29
s_mul_i32 s6, s60, 1
s_xor_b32 s6, s6, s62
s_lshl_b32 s6, s6, 10
s_add_u32 s6, s6, 0x12000
v_lshrrev_b32 v5, 1, v4
v_and_b32 v6, 1, v4
v_lshl_add_u32 v5, v5, 8, s6
v_lshl_add_u32 v5, v6, 3, v5
v_lshl_add_u32 v33, v3, 4, v5
v_xor_b32 v34, 0x400, v33
v_add_u32 v35, 0x12000, v16
s_mul_i32 s6, s4, 24576
s_mul_i32 s7, s60, 1024
s_add_u32 s82, s6, s7
s_add_u32 s83, s82, 8192
s_add_u32 s84, s82, 16384
s_mov_b32 s86, 0x3db8aa3b
s_mov_b32 s87, 0x3db8aa3b
s_mov_b32 s88, 0x3727c5ac
s_mov_b32 s89, 0x3b800000
s_mov_b32 s90, 0xffff0000
s_add_u32 s48, s28, 0x0
s_addc_u32 s49, s29, 0
s_mov_b32 s50, 0x20000
s_mov_b32 s51, 0x00020000
s_add_u32 s52, s38, 0x0
s_addc_u32 s53, s39, 0
s_mov_b32 s54, 0x4e4000
s_mov_b32 s55, 0x00020000
s_add_u32 s56, s38, 0x6800000
s_addc_u32 s57, s39, 0
s_mov_b32 s58, 0x4e4000
s_mov_b32 s59, 0x00020000
v_lshlrev_b32 v11, 4, v4
s_lshr_b32 s8, s66, 8
buffer_load_dwordx4 v[172:175], v11, s[48:51], s8 offen
s_lshr_b32 s8, s67, 8
buffer_load_dwordx4 v[176:179], v11, s[48:51], s8 offen
s_lshr_b32 s8, s68, 8
buffer_load_dwordx4 v[180:183], v11, s[48:51], s8 offen
s_lshr_b32 s8, s69, 8
buffer_load_dwordx4 v[184:187], v11, s[48:51], s8 offen
s_lshr_b32 s8, s70, 8
buffer_load_dwordx4 v[188:191], v11, s[48:51], s8 offen
s_lshr_b32 s8, s71, 8
buffer_load_dwordx4 v[192:195], v11, s[48:51], s8 offen
s_lshr_b32 s8, s72, 8
buffer_load_dwordx4 v[196:199], v11, s[48:51], s8 offen
s_lshr_b32 s8, s73, 8
buffer_load_dwordx4 v[200:203], v11, s[48:51], s8 offen
s_waitcnt vmcnt(14)
v_lshlrev_b32 v76, 16, v40
v_and_b32 v77, s90, v40
v_lshlrev_b32 v78, 16, v41
v_and_b32 v79, s90, v41
v_lshlrev_b32 v80, 16, v42
v_and_b32 v81, s90, v42
v_lshlrev_b32 v82, 16, v43
v_and_b32 v83, s90, v43
v_pk_add_f32 v[100:101], v[76:77], v[78:79]
v_pk_mul_f32 v[102:103], v[76:77], v[76:77]
v_pk_add_f32 v[40:41], v[80:81], v[82:83]
v_pk_fma_f32 v[102:103], v[78:79], v[78:79], v[102:103]
v_pk_add_f32 v[100:101], v[100:101], v[40:41]
v_pk_fma_f32 v[102:103], v[80:81], v[80:81], v[102:103]
v_add_f32 v100, v100, v101
v_pk_fma_f32 v[102:103], v[82:83], v[82:83], v[102:103]
v_add_f32 v102, v102, v103
s_waitcnt vmcnt(13)
v_lshlrev_b32 v84, 16, v44
v_and_b32 v85, s90, v44
v_lshlrev_b32 v86, 16, v45
v_and_b32 v87, s90, v45
v_lshlrev_b32 v88, 16, v46
v_and_b32 v89, s90, v46
v_lshlrev_b32 v90, 16, v47
v_and_b32 v91, s90, v47
v_pk_add_f32 v[104:105], v[84:85], v[86:87]
v_pk_mul_f32 v[106:107], v[84:85], v[84:85]
v_pk_add_f32 v[44:45], v[88:89], v[90:91]
v_pk_fma_f32 v[106:107], v[86:87], v[86:87], v[106:107]
v_pk_add_f32 v[104:105], v[104:105], v[44:45]
v_pk_fma_f32 v[106:107], v[88:89], v[88:89], v[106:107]
v_add_f32 v104, v104, v105
v_pk_fma_f32 v[106:107], v[90:91], v[90:91], v[106:107]
v_add_f32 v106, v106, v107
s_waitcnt vmcnt(12)
v_lshlrev_b32 v92, 16, v48
v_and_b32 v93, s90, v48
v_lshlrev_b32 v94, 16, v49
v_and_b32 v95, s90, v49
v_lshlrev_b32 v96, 16, v50
v_and_b32 v97, s90, v50
v_lshlrev_b32 v98, 16, v51
v_and_b32 v99, s90, v51
v_pk_add_f32 v[108:109], v[92:93], v[94:95]
v_pk_mul_f32 v[110:111], v[92:93], v[92:93]
v_pk_add_f32 v[48:49], v[96:97], v[98:99]
v_pk_fma_f32 v[110:111], v[94:95], v[94:95], v[110:111]
v_pk_add_f32 v[108:109], v[108:109], v[48:49]
v_pk_fma_f32 v[110:111], v[96:97], v[96:97], v[110:111]
v_add_f32 v108, v108, v109
v_pk_fma_f32 v[110:111], v[98:99], v[98:99], v[110:111]
v_add_f32 v110, v110, v111
v_permlane16_swap_b32 v100, v102
v_permlane16_swap_b32 v104, v106
v_permlane16_swap_b32 v108, v110
v_add_f32 v100, v100, v102
v_add_f32 v104, v104, v106
v_add_f32 v108, v108, v110
v_add_f32_dpp v101, v100, v100 row_ror:8 row_mask:0xf bank_mask:0x3
v_add_f32_dpp v101, v104, v104 row_ror:8 row_mask:0xf bank_mask:0xc
v_add_f32_dpp v109, v108, v108 row_ror:8 row_mask:0xf bank_mask:0xf
s_nop 0
v_add_f32_dpp v102, v101, v101 row_half_mirror row_mask:0xf bank_mask:0x5
v_add_f32_dpp v102, v109, v109 row_half_mirror row_mask:0xf bank_mask:0xa
s_nop 1
v_add_f32_dpp v102, v102, v102 quad_perm:[1,0,3,2] row_mask:0xf bank_mask:0xf
s_nop 1
v_add_f32_dpp v102, v102, v102 quad_perm:[2,3,0,1] row_mask:0xf bank_mask:0xf
v_mov_b32 v103, v102
s_nop 1
v_permlane16_swap_b32 v103, v102
v_mul_f32 v103, s89, v103
v_mul_f32 v102, s89, v102
v_fma_f32 v102, -v103, v103, v102
v_max_f32 v102, 0, v102
v_cvt_pk_bf16_f32 v102, v102, v102
v_and_b32 v102, s90, v102
v_add_f32 v102, s88, v102
v_cvt_pk_bf16_f32 v102, v102, v102
v_and_b32 v102, s90, v102
v_sqrt_f32 v102, v102
s_nop 0
v_cvt_pk_bf16_f32 v102, v102, v102
v_and_b32 v102, s90, v102
v_rcp_f32 v102, v102
s_nop 0
v_mul_f32 v103, -v103, v102
s_nop 1
v_mov_b64_dpp v[100:101], v[102:103] row_newbcast:0 row_mask:0xf bank_mask:0xf
v_mov_b64_dpp v[104:105], v[102:103] row_newbcast:8 row_mask:0xf bank_mask:0xf
v_mov_b64_dpp v[108:109], v[102:103] row_newbcast:4 row_mask:0xf bank_mask:0xf
v_fma_f32 v76, v76, v100, v101
v_fma_f32 v77, v77, v100, v101
v_fma_f32 v78, v78, v100, v101
v_fma_f32 v79, v79, v100, v101
v_fma_f32 v80, v80, v100, v101
v_fma_f32 v81, v81, v100, v101
v_fma_f32 v82, v82, v100, v101
v_fma_f32 v83, v83, v100, v101
v_cvt_pk_bf16_f32 v40, v76, v77
v_cvt_pk_bf16_f32 v41, v78, v79
v_cvt_pk_bf16_f32 v42, v80, v81
v_cvt_pk_bf16_f32 v43, v82, v83
ds_write_b128 v36, v[40:43]
v_fma_f32 v84, v84, v104, v105
v_fma_f32 v85, v85, v104, v105
v_fma_f32 v86, v86, v104, v105
v_fma_f32 v87, v87, v104, v105
v_fma_f32 v88, v88, v104, v105
v_fma_f32 v89, v89, v104, v105
v_fma_f32 v90, v90, v104, v105
v_fma_f32 v91, v91, v104, v105
v_cvt_pk_bf16_f32 v44, v84, v85
v_cvt_pk_bf16_f32 v45, v86, v87
v_cvt_pk_bf16_f32 v46, v88, v89
v_cvt_pk_bf16_f32 v47, v90, v91
ds_write_b128 v37, v[44:47]
v_fma_f32 v92, v92, v108, v109
v_fma_f32 v93, v93, v108, v109
v_fma_f32 v94, v94, v108, v109
v_fma_f32 v95, v95, v108, v109
v_fma_f32 v96, v96, v108, v109
v_fma_f32 v97, v97, v108, v109
v_fma_f32 v98, v98, v108, v109
v_fma_f32 v99, v99, v108, v109
v_cvt_pk_bf16_f32 v48, v92, v93
v_cvt_pk_bf16_f32 v49, v94, v95
v_cvt_pk_bf16_f32 v50, v96, v97
v_cvt_pk_bf16_f32 v51, v98, v99
ds_write_b128 v38, v[48:51]
s_add_u32 m0, s63, 0x1000
s_nop 0
buffer_load_dwordx4 v17, s[44:47], s68 offen offset:0 lds
buffer_load_dwordx4 v18, s[44:47], s68 offen offset:1024 lds
s_waitcnt vmcnt(12)
ds_read_b64_tr_b16 v[100:101], v25 offset:0
ds_read_b64_tr_b16 v[102:103], v25 offset:256
ds_read_b64_tr_b16 v[104:105], v26 offset:0
ds_read_b64_tr_b16 v[106:107], v26 offset:256
s_waitcnt lgkmcnt(4)
s_barrier
ds_read_b128 v[124:127], v31 offset:0
ds_read_b128 v[128:131], v31 offset:8192
ds_read_b128 v[132:135], v31 offset:16384
ds_read_b128 v[136:139], v32 offset:1024
s_waitcnt vmcnt(10)
ds_read_b64_tr_b16 v[108:109], v25 offset:2048
ds_read_b64_tr_b16 v[110:111], v25 offset:2304
s_waitcnt lgkmcnt(5)
v_mfma_f32_16x16x32_bf16 v[52:55], v[100:103], v[124:127], 0
ds_read_b128 v[140:143], v32 offset:9216
s_waitcnt lgkmcnt(5)
v_mfma_f32_16x16x32_bf16 v[56:59], v[100:103], v[128:131], 0
ds_read_b128 v[144:147], v32 offset:17408
s_waitcnt lgkmcnt(5)
v_mfma_f32_16x16x32_bf16 v[60:63], v[100:103], v[132:135], 0
ds_read_b64_tr_b16 v[112:113], v26 offset:2048
ds_read_b64_tr_b16 v[114:115], v26 offset:2304
v_mfma_f32_16x16x32_bf16 v[64:67], v[104:107], v[124:127], 0
s_add_u32 m0, s63, 0x0
s_nop 0
buffer_load_dwordx4 v17, s[44:47], s69 offen offset:0 lds
buffer_load_dwordx4 v18, s[44:47], s69 offen offset:1024 lds
v_mfma_f32_16x16x32_bf16 v[68:71], v[104:107], v[128:131], 0
v_and_b32 v5, 31, v2
v_lshrrev_b32 v6, 5, v2
v_mfma_f32_16x16x32_bf16 v[72:75], v[104:107], v[132:135], 0
ds_read_b128 v[148:151], v31 offset:2048
s_waitcnt vmcnt(2)
ds_read_b64_tr_b16 v[116:117], v25 offset:4096
ds_read_b64_tr_b16 v[118:119], v25 offset:4352
s_waitcnt lgkmcnt(7)
v_mfma_f32_16x16x32_bf16 v[52:55], v[108:111], v[136:139], v[52:55]
ds_read_b128 v[152:155], v31 offset:10240
s_lshr_b32 s6, s64, 9
s_waitcnt lgkmcnt(7)
v_mfma_f32_16x16x32_bf16 v[56:59], v[108:111], v[140:143], v[56:59]
ds_read_b128 v[156:159], v31 offset:18432
v_cmp_eq_u32 vcc, 0, v5
s_waitcnt lgkmcnt(7)
v_mfma_f32_16x16x32_bf16 v[60:63], v[108:111], v[144:147], v[60:63]
ds_read_b64_tr_b16 v[120:121], v26 offset:4096
ds_read_b64_tr_b16 v[122:123], v26 offset:4352
s_waitcnt lgkmcnt(7)
v_mfma_f32_16x16x32_bf16 v[64:67], v[112:115], v[136:139], v[64:67]
s_add_u32 m0, s63, 0x800
s_nop 0
buffer_load_dwordx4 v17, s[44:47], s70 offen offset:0 lds
buffer_load_dwordx4 v18, s[44:47], s70 offen offset:1024 lds
v_mfma_f32_16x16x32_bf16 v[68:71], v[112:115], v[140:143], v[68:71]
s_sub_u32 s6, 10000, s6
v_mov_b32 v7, 0x7fffffff
v_mfma_f32_16x16x32_bf16 v[72:75], v[112:115], v[144:147], v[72:75]
ds_read_b128 v[160:163], v32 offset:3072
s_waitcnt vmcnt(2)
ds_read_b64_tr_b16 v[100:101], v25 offset:0
ds_read_b64_tr_b16 v[102:103], v25 offset:256
s_waitcnt lgkmcnt(7)
v_mfma_f32_16x16x32_bf16 v[52:55], v[116:119], v[148:151], v[52:55]
ds_read_b128 v[164:167], v32 offset:11264
v_cndmask_b32 v6, v7, v6, vcc
s_waitcnt lgkmcnt(7)
v_mfma_f32_16x16x32_bf16 v[56:59], v[116:119], v[152:155], v[56:59]
ds_read_b128 v[168:171], v32 offset:19456
v_cmp_gt_i32 vcc, s6, v6
s_waitcnt lgkmcnt(7)
v_mfma_f32_16x16x32_bf16 v[60:63], v[116:119], v[156:159], v[60:63]
ds_read_b64_tr_b16 v[104:105], v26 offset:0
ds_read_b64_tr_b16 v[106:107], v26 offset:256
s_waitcnt lgkmcnt(7)
v_mfma_f32_16x16x32_bf16 v[64:67], v[120:123], v[148:151], v[64:67]
s_add_u32 m0, s63, 0x1000
s_nop 0
buffer_load_dwordx4 v17, s[44:47], s71 offen offset:0 lds
buffer_load_dwordx4 v18, s[44:47], s71 offen offset:1024 lds
v_mfma_f32_16x16x32_bf16 v[68:71], v[120:123], v[152:155], v[68:71]
v_and_b32 v5, s90, v40
v_or_b32 v5, 0x3f80, v5
v_mfma_f32_16x16x32_bf16 v[72:75], v[120:123], v[156:159], v[72:75]
ds_read_b128 v[124:127], v31 offset:4096
s_waitcnt vmcnt(2)
ds_read_b64_tr_b16 v[108:109], v25 offset:2048
ds_read_b64_tr_b16 v[110:111], v25 offset:2304
s_waitcnt lgkmcnt(7)
v_mfma_f32_16x16x32_bf16 v[52:55], v[100:103], v[160:163], v[52:55]
ds_read_b128 v[128:131], v31 offset:12288
s_sub_u32 s6, s6, 2
s_waitcnt lgkmcnt(7)
v_mfma_f32_16x16x32_bf16 v[56:59], v[100:103], v[164:167], v[56:59]
ds_read_b128 v[132:135], v31 offset:20480
v_cndmask_b32 v40, v40, v5, vcc
s_waitcnt lgkmcnt(7)
v_mfma_f32_16x16x32_bf16 v[60:63], v[100:103], v[168:171], v[60:63]
ds_read_b64_tr_b16 v[112:113], v26 offset:2048
ds_read_b64_tr_b16 v[114:115], v26 offset:2304
s_waitcnt lgkmcnt(7)
v_mfma_f32_16x16x32_bf16 v[64:67], v[104:107], v[160:163], v[64:67]
s_add_u32 m0, s63, 0x0
s_nop 0
buffer_load_dwordx4 v17, s[44:47], s72 offen offset:0 lds
buffer_load_dwordx4 v18, s[44:47], s72 offen offset:1024 lds
v_mfma_f32_16x16x32_bf16 v[68:71], v[104:107], v[164:167], v[68:71]
v_cmp_gt_i32 vcc, s6, v6
v_and_b32 v5, s90, v44
v_mfma_f32_16x16x32_bf16 v[72:75], v[104:107], v[168:171], v[72:75]
ds_read_b128 v[136:139], v32 offset:5120
s_waitcnt vmcnt(2)
ds_read_b64_tr_b16 v[116:117], v25 offset:4096
ds_read_b64_tr_b16 v[118:119], v25 offset:4352
s_waitcnt lgkmcnt(7)
v_mfma_f32_16x16x32_bf16 v[52:55], v[108:111], v[124:127], v[52:55]
ds_read_b128 v[140:143], v32 offset:13312
v_or_b32 v5, 0x3f80, v5
s_waitcnt lgkmcnt(7)
v_mfma_f32_16x16x32_bf16 v[56:59], v[108:111], v[128:131], v[56:59]
ds_read_b128 v[144:147], v32 offset:21504
s_sub_u32 s6, s6, 2
s_waitcnt lgkmcnt(7)
v_mfma_f32_16x16x32_bf16 v[60:63], v[108:111], v[132:135], v[60:63]
ds_read_b64_tr_b16 v[120:121], v26 offset:4096
ds_read_b64_tr_b16 v[122:123], v26 offset:4352
s_waitcnt lgkmcnt(7)
v_mfma_f32_16x16x32_bf16 v[64:67], v[112:115], v[124:127], v[64:67]
s_add_u32 m0, s63, 0x800
s_nop 0
buffer_load_dwordx4 v17, s[44:47], s73 offen offset:0 lds
buffer_load_dwordx4 v18, s[44:47], s73 offen offset:1024 lds
v_mfma_f32_16x16x32_bf16 v[68:71], v[112:115], v[128:131], v[68:71]
v_cndmask_b32 v44, v44, v5, vcc
v_cmp_gt_i32 vcc, s6, v6
v_mfma_f32_16x16x32_bf16 v[72:75], v[112:115], v[132:135], v[72:75]
ds_read_b128 v[148:151], v31 offset:6144
s_waitcnt vmcnt(2)
ds_read_b64_tr_b16 v[100:101], v25 offset:0
ds_read_b64_tr_b16 v[102:103], v25 offset:256
s_waitcnt lgkmcnt(7)
v_mfma_f32_16x16x32_bf16 v[52:55], v[116:119], v[136:139], v[52:55]
ds_read_b128 v[152:155], v31 offset:14336
v_and_b32 v5, s90, v48
s_waitcnt lgkmcnt(7)
v_mfma_f32_16x16x32_bf16 v[56:59], v[116:119], v[140:143], v[56:59]
ds_read_b128 v[156:159], v31 offset:22528
v_or_b32 v5, 0x3f80, v5
s_waitcnt lgkmcnt(7)
v_mfma_f32_16x16x32_bf16 v[60:63], v[116:119], v[144:147], v[60:63]
ds_read_b64_tr_b16 v[104:105], v26 offset:0
ds_read_b64_tr_b16 v[106:107], v26 offset:256
s_waitcnt lgkmcnt(7)
v_mfma_f32_16x16x32_bf16 v[64:67], v[120:123], v[136:139], v[64:67]
s_add_u32 m0, s63, 0x1000
s_nop 0
buffer_load_dwordx4 v21, s[48:51], s74 offen offset:0 lds
buffer_load_dwordx4 v22, s[48:51], s74 offen offset:1024 lds
v_mfma_f32_16x16x32_bf16 v[68:71], v[120:123], v[140:143], v[68:71]
s_sub_u32 s6, s6, 2
v_cndmask_b32 v48, v48, v5, vcc
v_mfma_f32_16x16x32_bf16 v[72:75], v[120:123], v[144:147], v[72:75]
ds_read_b128 v[160:163], v32 offset:7168
s_waitcnt vmcnt(2)
ds_read_b64_tr_b16 v[108:109], v25 offset:2048
ds_read_b64_tr_b16 v[110:111], v25 offset:2304
s_waitcnt lgkmcnt(7)
v_mfma_f32_16x16x32_bf16 v[52:55], v[100:103], v[148:151], v[52:55]
ds_read_b128 v[164:167], v32 offset:15360
s_waitcnt lgkmcnt(7)
v_mfma_f32_16x16x32_bf16 v[56:59], v[100:103], v[152:155], v[56:59]
ds_read_b128 v[168:171], v32 offset:23552
s_waitcnt lgkmcnt(7)
v_mfma_f32_16x16x32_bf16 v[60:63], v[100:103], v[156:159], v[60:63]
ds_read_b64_tr_b16 v[112:113], v26 offset:2048
ds_read_b64_tr_b16 v[114:115], v26 offset:2304
s_waitcnt lgkmcnt(7)
v_mfma_f32_16x16x32_bf16 v[64:67], v[104:107], v[148:151], v[64:67]
s_add_u32 m0, s63, 0x0
s_nop 0
buffer_load_dwordx4 v21, s[48:51], s75 offen offset:0 lds
buffer_load_dwordx4 v22, s[48:51], s75 offen offset:1024 lds
v_mfma_f32_16x16x32_bf16 v[68:71], v[104:107], v[152:155], v[68:71]
v_mfma_f32_16x16x32_bf16 v[72:75], v[104:107], v[156:159], v[72:75]
s_waitcnt lgkmcnt(4)
v_mfma_f32_16x16x32_bf16 v[52:55], v[108:111], v[160:163], v[52:55]
s_waitcnt lgkmcnt(3)
v_mfma_f32_16x16x32_bf16 v[56:59], v[108:111], v[164:167], v[56:59]
s_waitcnt lgkmcnt(2)
v_mfma_f32_16x16x32_bf16 v[60:63], v[108:111], v[168:171], v[60:63]
s_waitcnt lgkmcnt(0)
v_mfma_f32_16x16x32_bf16 v[64:67], v[112:115], v[160:163], v[64:67]
s_nop 1
v_cvt_pk_bf16_f32 v52, v52, v53
v_cvt_pk_bf16_f32 v53, v54, v55
ds_write_b64 v33, v[52:53] offset:0
s_add_u32 m0, s63, 0x800
s_nop 0
buffer_load_dwordx4 v21, s[48:51], s76 offen offset:0 lds
buffer_load_dwordx4 v22, s[48:51], s76 offen offset:1024 lds
v_mfma_f32_16x16x32_bf16 v[68:71], v[112:115], v[164:167], v[68:71]
v_cvt_pk_bf16_f32 v56, v56, v57
v_cvt_pk_bf16_f32 v57, v58, v59
ds_write_b64 v33, v[56:57] offset:8192
v_mfma_f32_16x16x32_bf16 v[72:75], v[112:115], v[168:171], v[72:75]
v_cvt_pk_bf16_f32 v60, v60, v61
v_cvt_pk_bf16_f32 v61, v62, v63
ds_write_b64 v33, v[60:61] offset:16384
v_cvt_pk_bf16_f32 v64, v64, v65
v_cvt_pk_bf16_f32 v65, v66, v67
ds_write_b64 v33, v[64:65] offset:512
v_cvt_pk_bf16_f32 v68, v68, v69
v_cvt_pk_bf16_f32 v69, v70, v71
ds_write_b64 v33, v[68:69] offset:8704
v_cvt_pk_bf16_f32 v72, v72, v73
v_cvt_pk_bf16_f32 v73, v74, v75
ds_write_b64 v33, v[72:73] offset:16896
s_waitcnt vmcnt(4)
ds_read_b128 v[116:119], v29 offset:4096
ds_read_b128 v[120:123], v30 offset:4096
s_waitcnt lgkmcnt(2)
s_barrier
ds_read_b128 v[124:127], v35 offset:0
ds_read_b128 v[128:131], v35 offset:8192
ds_read_b128 v[132:135], v35 offset:16384
ds_read_b128 v[136:139], v35 offset:1024
s_waitcnt lgkmcnt(3)
v_mfma_f32_16x16x32_bf16 v[76:79], v[116:119], v[124:127], 0
ds_read_b128 v[140:143], v35 offset:9216
s_waitcnt lgkmcnt(3)
v_mfma_f32_16x16x32_bf16 v[84:87], v[116:119], v[128:131], 0
ds_read_b128 v[144:147], v35 offset:17408
s_waitcnt lgkmcnt(3)
v_mfma_f32_16x16x32_bf16 v[92:95], v[116:119], v[132:135], 0
v_mfma_f32_16x16x32_bf16 v[204:207], v[172:175], v[124:127], 0
v_mfma_f32_16x16x32_bf16 v[208:211], v[172:175], v[128:131], 0
v_mfma_f32_16x16x32_bf16 v[212:215], v[172:175], v[132:135], 0
s_waitcnt vmcnt(2)
ds_read_b128 v[100:103], v29 offset:0
s_waitcnt lgkmcnt(3)
v_mfma_f32_16x16x32_bf16 v[76:79], v[120:123], v[136:139], v[76:79]
s_add_u32 m0, s63, 0x1000
s_nop 0
buffer_load_dwordx4 v21, s[48:51], s77 offen offset:0 lds
buffer_load_dwordx4 v22, s[48:51], s77 offen offset:1024 lds
s_waitcnt lgkmcnt(2)
v_mfma_f32_16x16x32_bf16 v[84:87], v[120:123], v[140:143], v[84:87]
s_waitcnt lgkmcnt(1)
v_mfma_f32_16x16x32_bf16 v[92:95], v[120:123], v[144:147], v[92:95]
ds_read_b128 v[104:107], v30 offset:0
v_mfma_f32_16x16x32_bf16 v[204:207], v[176:179], v[136:139], v[204:207]
v_mfma_f32_16x16x32_bf16 v[208:211], v[176:179], v[140:143], v[208:211]
v_mfma_f32_16x16x32_bf16 v[212:215], v[176:179], v[144:147], v[212:215]
ds_read_b128 v[148:151], v35 offset:2048
s_waitcnt vmcnt(2)
ds_read_b128 v[108:111], v29 offset:2048
s_waitcnt lgkmcnt(3)
v_mfma_f32_16x16x32_bf16 v[80:83], v[100:103], v[124:127], 0
ds_read_b128 v[152:155], v35 offset:10240
v_mfma_f32_16x16x32_bf16 v[88:91], v[100:103], v[128:131], 0
ds_read_b128 v[156:159], v35 offset:18432
v_mfma_f32_16x16x32_bf16 v[96:99], v[100:103], v[132:135], 0
s_waitcnt lgkmcnt(4)
v_mfma_f32_16x16x32_bf16 v[80:83], v[104:107], v[136:139], v[80:83]
s_add_u32 m0, s63, 0x0
s_nop 0
buffer_load_dwordx4 v21, s[48:51], s78 offen offset:0 lds
buffer_load_dwordx4 v22, s[48:51], s78 offen offset:1024 lds
v_mfma_f32_16x16x32_bf16 v[88:91], v[104:107], v[140:143], v[88:91]
v_mfma_f32_16x16x32_bf16 v[96:99], v[104:107], v[144:147], v[96:99]
ds_read_b128 v[160:163], v35 offset:3072
ds_read_b128 v[112:115], v30 offset:2048
s_waitcnt lgkmcnt(4)
v_mfma_f32_16x16x32_bf16 v[76:79], v[108:111], v[148:151], v[76:79]
ds_read_b128 v[164:167], v35 offset:11264
s_waitcnt lgkmcnt(4)
v_mfma_f32_16x16x32_bf16 v[84:87], v[108:111], v[152:155], v[84:87]
ds_read_b128 v[168:171], v35 offset:19456
s_waitcnt lgkmcnt(4)
v_mfma_f32_16x16x32_bf16 v[92:95], v[108:111], v[156:159], v[92:95]
v_mfma_f32_16x16x32_bf16 v[204:207], v[180:183], v[148:151], v[204:207]
v_mfma_f32_16x16x32_bf16 v[208:211], v[180:183], v[152:155], v[208:211]
v_mfma_f32_16x16x32_bf16 v[212:215], v[180:183], v[156:159], v[212:215]
s_waitcnt vmcnt(2)
ds_read_b128 v[116:119], v29 offset:4096
s_waitcnt lgkmcnt(3)
v_mfma_f32_16x16x32_bf16 v[76:79], v[112:115], v[160:163], v[76:79]
s_add_u32 m0, s63, 0x800
s_nop 0
buffer_load_dwordx4 v21, s[48:51], s79 offen offset:0 lds
buffer_load_dwordx4 v22, s[48:51], s79 offen offset:1024 lds
s_waitcnt lgkmcnt(2)
v_mfma_f32_16x16x32_bf16 v[84:87], v[112:115], v[164:167], v[84:87]
s_waitcnt lgkmcnt(1)
v_mfma_f32_16x16x32_bf16 v[92:95], v[112:115], v[168:171], v[92:95]
ds_read_b128 v[120:123], v30 offset:4096
v_mfma_f32_16x16x32_bf16 v[204:207], v[184:187], v[160:163], v[204:207]
v_mfma_f32_16x16x32_bf16 v[208:211], v[184:187], v[164:167], v[208:211]
v_mfma_f32_16x16x32_bf16 v[212:215], v[184:187], v[168:171], v[212:215]
ds_read_b128 v[124:127], v35 offset:4096
s_waitcnt vmcnt(2)
ds_read_b128 v[100:103], v29 offset:0
s_waitcnt lgkmcnt(3)
v_mfma_f32_16x16x32_bf16 v[80:83], v[116:119], v[148:151], v[80:83]
ds_read_b128 v[128:131], v35 offset:12288
v_mfma_f32_16x16x32_bf16 v[88:91], v[116:119], v[152:155], v[88:91]
ds_read_b128 v[132:135], v35 offset:20480
v_mfma_f32_16x16x32_bf16 v[96:99], v[116:119], v[156:159], v[96:99]
s_waitcnt lgkmcnt(4)
v_mfma_f32_16x16x32_bf16 v[80:83], v[120:123], v[160:163], v[80:83]
s_add_u32 m0, s63, 0x1000
s_nop 0
buffer_load_dwordx4 v21, s[48:51], s80 offen offset:0 lds
buffer_load_dwordx4 v22, s[48:51], s80 offen offset:1024 lds
v_mfma_f32_16x16x32_bf16 v[88:91], v[120:123], v[164:167], v[88:91]
v_mfma_f32_16x16x32_bf16 v[96:99], v[120:123], v[168:171], v[96:99]
ds_read_b128 v[136:139], v35 offset:5120
ds_read_b128 v[104:107], v30 offset:0
s_waitcnt lgkmcnt(4)
v_mfma_f32_16x16x32_bf16 v[76:79], v[100:103], v[124:127], v[76:79]
ds_read_b128 v[140:143], v35 offset:13312
s_waitcnt lgkmcnt(4)
v_mfma_f32_16x16x32_bf16 v[84:87], v[100:103], v[128:131], v[84:87]
ds_read_b128 v[144:147], v35 offset:21504
s_waitcnt lgkmcnt(4)
v_mfma_f32_16x16x32_bf16 v[92:95], v[100:103], v[132:135], v[92:95]
v_mfma_f32_16x16x32_bf16 v[204:207], v[188:191], v[124:127], v[204:207]
v_mfma_f32_16x16x32_bf16 v[208:211], v[188:191], v[128:131], v[208:211]
v_mfma_f32_16x16x32_bf16 v[212:215], v[188:191], v[132:135], v[212:215]
s_waitcnt vmcnt(2)
ds_read_b128 v[108:111], v29 offset:2048
s_waitcnt lgkmcnt(3)
v_mfma_f32_16x16x32_bf16 v[76:79], v[104:107], v[136:139], v[76:79]
s_add_u32 m0, s63, 0x0
s_nop 0
buffer_load_dwordx4 v21, s[48:51], s81 offen offset:0 lds
buffer_load_dwordx4 v22, s[48:51], s81 offen offset:1024 lds
s_waitcnt lgkmcnt(2)
v_mfma_f32_16x16x32_bf16 v[84:87], v[104:107], v[140:143], v[84:87]
buffer_store_dwordx4 v[40:43], v16, s[56:59], s64 offen offset:0 sc1
buffer_store_dwordx4 v[44:47], v16, s[56:59], s64 offen offset:1024 sc1
s_waitcnt lgkmcnt(1)
v_mfma_f32_16x16x32_bf16 v[92:95], v[104:107], v[144:147], v[92:95]
ds_read_b128 v[112:115], v30 offset:2048
buffer_store_dwordx4 v[48:51], v16, s[56:59], s64 offen offset:2048 sc1
v_mfma_f32_16x16x32_bf16 v[204:207], v[192:195], v[136:139], v[204:207]
v_mfma_f32_16x16x32_bf16 v[208:211], v[192:195], v[140:143], v[208:211]
v_mfma_f32_16x16x32_bf16 v[212:215], v[192:195], v[144:147], v[212:215]
ds_read_b128 v[148:151], v35 offset:6144
s_waitcnt vmcnt(5)
ds_read_b128 v[116:119], v29 offset:4096
s_waitcnt lgkmcnt(3)
v_mfma_f32_16x16x32_bf16 v[80:83], v[108:111], v[124:127], v[80:83]
ds_read_b128 v[152:155], v35 offset:14336
v_mfma_f32_16x16x32_bf16 v[88:91], v[108:111], v[128:131], v[88:91]
ds_read_b128 v[156:159], v35 offset:22528
v_mfma_f32_16x16x32_bf16 v[96:99], v[108:111], v[132:135], v[96:99]
s_waitcnt lgkmcnt(4)
v_mfma_f32_16x16x32_bf16 v[80:83], v[112:115], v[136:139], v[80:83]
v_mfma_f32_16x16x32_bf16 v[88:91], v[112:115], v[140:143], v[88:91]
v_mfma_f32_16x16x32_bf16 v[96:99], v[112:115], v[144:147], v[96:99]
ds_read_b128 v[160:163], v35 offset:7168
ds_read_b128 v[120:123], v30 offset:4096
s_waitcnt lgkmcnt(4)
v_mfma_f32_16x16x32_bf16 v[76:79], v[116:119], v[148:151], v[76:79]
ds_read_b128 v[164:167], v35 offset:15360
s_waitcnt lgkmcnt(4)
v_mfma_f32_16x16x32_bf16 v[84:87], v[116:119], v[152:155], v[84:87]
ds_read_b128 v[168:171], v35 offset:23552
s_waitcnt lgkmcnt(4)
v_mfma_f32_16x16x32_bf16 v[92:95], v[116:119], v[156:159], v[92:95]
v_mfma_f32_16x16x32_bf16 v[204:207], v[196:199], v[148:151], v[204:207]
v_mfma_f32_16x16x32_bf16 v[208:211], v[196:199], v[152:155], v[208:211]
v_mfma_f32_16x16x32_bf16 v[212:215], v[196:199], v[156:159], v[212:215]
s_waitcnt vmcnt(3)
ds_read_b128 v[100:103], v29 offset:0
s_waitcnt lgkmcnt(3)
v_mfma_f32_16x16x32_bf16 v[76:79], v[120:123], v[160:163], v[76:79]
s_waitcnt lgkmcnt(2)
v_mfma_f32_16x16x32_bf16 v[84:87], v[120:123], v[164:167], v[84:87]
s_waitcnt lgkmcnt(1)
v_mfma_f32_16x16x32_bf16 v[92:95], v[120:123], v[168:171], v[92:95]
ds_read_b128 v[104:107], v30 offset:0
v_mfma_f32_16x16x32_bf16 v[204:207], v[200:203], v[160:163], v[204:207]
v_mfma_f32_16x16x32_bf16 v[208:211], v[200:203], v[164:167], v[208:211]
v_mfma_f32_16x16x32_bf16 v[212:215], v[200:203], v[168:171], v[212:215]
s_waitcnt lgkmcnt(1)
v_mfma_f32_16x16x32_bf16 v[80:83], v[100:103], v[148:151], v[80:83]
s_nop 3
v_mul_f32 v204, -v204, s86
v_mfma_f32_16x16x32_bf16 v[88:91], v[100:103], v[152:155], v[88:91]
v_mul_f32 v208, -v208, s86
v_mfma_f32_16x16x32_bf16 v[96:99], v[100:103], v[156:159], v[96:99]
v_mul_f32 v212, -v212, s86
s_waitcnt lgkmcnt(0)
v_mfma_f32_16x16x32_bf16 v[80:83], v[104:107], v[160:163], v[80:83]
v_mfma_f32_16x16x32_bf16 v[88:91], v[104:107], v[164:167], v[88:91]
v_mfma_f32_16x16x32_bf16 v[96:99], v[104:107], v[168:171], v[96:99]
v_fma_f32 v76, v76, s86, v204
v_fma_f32 v77, v77, s86, v204
v_fma_f32 v78, v78, s86, v204
v_fma_f32 v79, v79, s86, v204
s_nop 1
v_fma_f32 v80, v80, s86, v204
v_fma_f32 v81, v81, s86, v204
v_fma_f32 v82, v82, s86, v204
v_fma_f32 v83, v83, s86, v204
v_cvt_pk_bf16_f32 v76, v76, v77
v_cvt_pk_bf16_f32 v77, v78, v79
v_cvt_pk_bf16_f32 v78, v80, v81
v_cvt_pk_bf16_f32 v79, v82, v83
buffer_store_dwordx4 v[76:79], v16, s[52:55], s82 offen offset:0 sc1
v_fma_f32 v84, v84, s86, v208
v_fma_f32 v85, v85, s86, v208
v_fma_f32 v86, v86, s86, v208
v_fma_f32 v87, v87, s86, v208
v_fma_f32 v88, v88, s86, v208
v_fma_f32 v89, v89, s86, v208
v_fma_f32 v90, v90, s86, v208
v_fma_f32 v91, v91, s86, v208
v_cvt_pk_bf16_f32 v84, v84, v85
v_cvt_pk_bf16_f32 v85, v86, v87
v_cvt_pk_bf16_f32 v86, v88, v89
v_cvt_pk_bf16_f32 v87, v90, v91
buffer_store_dwordx4 v[84:87], v16, s[52:55], s83 offen offset:0 sc1
v_fma_f32 v92, v92, s86, v212
v_fma_f32 v93, v93, s86, v212
v_fma_f32 v94, v94, s86, v212
v_fma_f32 v95, v95, s86, v212
v_fma_f32 v96, v96, s86, v212
v_fma_f32 v97, v97, s86, v212
v_fma_f32 v98, v98, s86, v212
v_fma_f32 v99, v99, s86, v212
v_cvt_pk_bf16_f32 v92, v92, v93
v_cvt_pk_bf16_f32 v93, v94, v95
v_cvt_pk_bf16_f32 v94, v96, v97
v_cvt_pk_bf16_f32 v95, v98, v99
buffer_store_dwordx4 v[92:95], v16, s[52:55], s84 offen offset:0 sc1
s_branch L1_fin
L1_notq:
s_sub_u32 s4, s2, 32
s_cmp_lt_u32 s2, 32
s_cbranch_scc1 L1_edge
s_mov_b32 s61, 1
v_lshlrev_b32 v16, 4, v2
s_mul_i32 s63, s60, 6144
s_and_b32 s6, s4, 3
s_lshl_b32 s6, s6, 6
s_mul_i32 s7, s60, 8
s_add_u32 s6, s6, s7
v_lshrrev_b32 v5, 5, v2
v_and_b32 v6, 31, v2
v_lshlrev_b32 v6, 4, v6
v_mov_b32 v176, v6
s_cmp_ge_u32 s4, 4
s_cselect_b64 vcc, -1, 0
v_add3_u32 v7, v5, s6, 0
v_and_b32 v8, 0x80, v7
v_bfe_u32 v9, v7, 2, 1
v_lshl_or_b32 v8, v9, 6, v8
v_bfe_u32 v9, v7, 4, 1
v_lshl_or_b32 v8, v9, 5, v8
v_and_b32 v9, 3, v7
v_lshl_or_b32 v8, v9, 3, v8
v_bfe_u32 v9, v7, 5, 2
v_lshl_or_b32 v8, v9, 1, v8
v_bfe_u32 v9, v7, 3, 1
v_or_b32 v8, v9, v8
v_cndmask_b32 v8, v8, v7, vcc
v_lshl_add_u32 v40, v8, 9, v6
v_add3_u32 v7, v5, s6, 2
v_and_b32 v8, 0x80, v7
v_bfe_u32 v9, v7, 2, 1
v_lshl_or_b32 v8, v9, 6, v8
v_bfe_u32 v9, v7, 4, 1
v_lshl_or_b32 v8, v9, 5, v8
v_and_b32 v9, 3, v7
v_lshl_or_b32 v8, v9, 3, v8
v_bfe_u32 v9, v7, 5, 2
v_lshl_or_b32 v8, v9, 1, v8
v_bfe_u32 v9, v7, 3, 1
v_or_b32 v8, v9, v8
v_cndmask_b32 v8, v8, v7, vcc
v_lshl_add_u32 v44, v8, 9, v6
v_add3_u32 v7, v5, s6, 4
v_and_b32 v8, 0x80, v7
v_bfe_u32 v9, v7, 2, 1
v_lshl_or_b32 v8, v9, 6, v8
v_bfe_u32 v9, v7, 4, 1
v_lshl_or_b32 v8, v9, 5, v8
v_and_b32 v9, 3, v7
v_lshl_or_b32 v8, v9, 3, v8
v_bfe_u32 v9, v7, 5, 2
v_lshl_or_b32 v8, v9, 1, v8
v_bfe_u32 v9, v7, 3, 1
v_or_b32 v8, v9, v8
v_cndmask_b32 v8, v8, v7, vcc
v_lshl_add_u32 v48, v8, 9, v6
v_add3_u32 v7, v5, s6, 6
v_and_b32 v8, 0x80, v7
v_bfe_u32 v9, v7, 2, 1
v_lshl_or_b32 v8, v9, 6, v8
v_bfe_u32 v9, v7, 4, 1
v_lshl_or_b32 v8, v9, 5, v8
v_and_b32 v9, 3, v7
v_lshl_or_b32 v8, v9, 3, v8
v_bfe_u32 v9, v7, 5, 2
v_lshl_or_b32 v8, v9, 1, v8
v_bfe_u32 v9, v7, 3, 1
v_or_b32 v8, v9, v8
v_cndmask_b32 v8, v8, v7, vcc
v_lshl_add_u32 v52, v8, 9, v6
s_lshl_b32 s7, s60, 6
v_lshrrev_b32 v5, 2, v2
v_and_b32 v6, 3, v2
v_lshrrev_b32 v7, 5, v2
v_lshlrev_b32 v7, 1, v7
v_xor_b32 v6, v6, v7
v_lshl_add_u32 v5, v5, 9, s7
v_lshl_add_u32 v17, v6, 4, v5
v_add_u32 v18, 0x1c00, v17
s_xor_b32 s6, s62, 0
s_lshl_b32 s66, s6, 14
s_xor_b32 s6, s62, 1
s_lshl_b32 s67, s6, 14
s_xor_b32 s6, s62, 2
s_lshl_b32 s68, s6, 14
s_xor_b32 s6, s62, 3
s_lshl_b32 s69, s6, 14
s_xor_b32 s6, s62, 4
s_lshl_b32 s70, s6, 14
s_xor_b32 s6, s62, 5
s_lshl_b32 s71, s6, 14
s_xor_b32 s6, s62, 6
s_lshl_b32 s72, s6, 14
s_xor_b32 s6, s62, 7
s_lshl_b32 s73, s6, 14
s_waitcnt lgkmcnt(0)
s_cmp_ge_u32 s4, 4
s_cselect_b32 s6, s30, s24
s_cselect_b32 s7, s31, s25
s_add_u32 s40, s6, 0x0
s_addc_u32 s41, s7, 0
s_mov_b32 s42, 0x20000
s_mov_b32 s43, 0x00020000
s_add_u32 s44, s32, 0x0
s_addc_u32 s45, s33, 0
s_mov_b32 s46, 0x20000
s_mov_b32 s47, 0x00020000
buffer_load_dwordx4 v[40:43], v40, s[40:43], 0 offen
buffer_load_dwordx4 v[44:47], v44, s[40:43], 0 offen
buffer_load_dwordx4 v[48:51], v48, s[40:43], 0 offen
buffer_load_dwordx4 v[52:55], v52, s[40:43], 0 offen
buffer_load_dwordx4 v[176:179], v176, s[40:43], 0 offen
s_add_u32 m0, s63, 0x0
s_nop 0
buffer_load_dwordx4 v17, s[44:47], s66 offen offset:0 lds
buffer_load_dwordx4 v18, s[44:47], s66 offen offset:1024 lds
s_add_u32 m0, s63, 0x800
s_nop 0
buffer_load_dwordx4 v17, s[44:47], s67 offen offset:0 lds
buffer_load_dwordx4 v18, s[44:47], s67 offen offset:1024 lds
v_bfe_u32 v5, v2, 2, 3
v_xor_b32 v5, s62, v5
v_and_b32 v6, 3, v2
v_lshlrev_b32 v7, 10, v5
v_lshl_add_u32 v7, v6, 8, v7
v_add_u32 v7, 0xc000, v7
v_and_b32 v5, 1, v5
v_lshl_or_b32 v6, v5, 2, v6
v_lshrrev_b32 v5, 5, v2
s_mul_i32 s6, s60, 8
v_add3_u32 v8, v5, s6, 0
v_lshrrev_b32 v9, 4, v8
v_lshl_add_u32 v9, v9, 13, v7
v_and_b32 v8, 15, v8
v_xor_b32 v8, v8, v6
v_lshl_add_u32 v36, v8, 4, v9
v_add3_u32 v8, v5, s6, 2
v_lshrrev_b32 v9, 4, v8
v_lshl_add_u32 v9, v9, 13, v7
v_and_b32 v8, 15, v8
v_xor_b32 v8, v8, v6
v_lshl_add_u32 v37, v8, 4, v9
v_add3_u32 v8, v5, s6, 4
v_lshrrev_b32 v9, 4, v8
v_lshl_add_u32 v9, v9, 13, v7
v_and_b32 v8, 15, v8
v_xor_b32 v8, v8, v6
v_lshl_add_u32 v38, v8, 4, v9
v_add3_u32 v8, v5, s6, 6
v_lshrrev_b32 v9, 4, v8
v_lshl_add_u32 v9, v9, 13, v7
v_and_b32 v8, 15, v8
v_xor_b32 v8, v8, v6
v_lshl_add_u32 v39, v8, 4, v9
v_xor_b32 v5, v3, v4
v_lshlrev_b32 v5, 4, v5
v_lshl_add_u32 v5, v4, 8, v5
v_add_u32 v31, 0xc000, v5
v_xor_b32 v32, 64, v31
v_lshrrev_b32 v5, 2, v3
v_and_b32 v6, 3, v3
v_and_b32 v7, 1, v4
v_lshlrev_b32 v7, 1, v7
v_lshl_add_u32 v8, v4, 3, v5
v_lshlrev_b32 v8, 6, v8
v_add_u32 v8, s63, v8
v_xor_b32 v6, v6, v7
v_xor_b32 v9, 0, v6
v_lshl_add_u32 v25, v9, 4, v8
v_add_u32 v26, 8, v25
s_lshr_b32 s6, s4, 2
s_lshl_b32 s6, s6, 17
s_and_b32 s7, s4, 3
s_lshl_b32 s7, s7, 12
s_add_u32 s6, s6, s7
s_mul_i32 s7, s60, 16384
s_add_u32 s82, s6, s7
s_add_u32 s83, s82, 16384
s_add_u32 s52, s38, 0x1000000
s_addc_u32 s53, s39, 0
s_mov_b32 s54, 0x40000
s_mov_b32 s55, 0x00020000
s_mov_b32 s90, 0xffff0000
s_waitcnt vmcnt(4)
v_lshlrev_b32 v180, 16, v176
v_and_b32 v181, s90, v176
v_lshlrev_b32 v182, 16, v177
v_and_b32 v183, s90, v177
v_lshlrev_b32 v184, 16, v178
v_and_b32 v185, s90, v178
v_lshlrev_b32 v186, 16, v179
v_and_b32 v187, s90, v179
v_lshlrev_b32 v176, 16, v40
v_and_b32 v177, s90, v40
v_sub_f32 v176, v176, v180
v_sub_f32 v177, v177, v181
v_cvt_pk_bf16_f32 v40, v176, v177
v_lshlrev_b32 v176, 16, v41
v_and_b32 v177, s90, v41
v_sub_f32 v176, v176, v182
v_sub_f32 v177, v177, v183
v_cvt_pk_bf16_f32 v41, v176, v177
v_lshlrev_b32 v176, 16, v42
v_and_b32 v177, s90, v42
v_sub_f32 v176, v176, v184
v_sub_f32 v177, v177, v185
v_cvt_pk_bf16_f32 v42, v176, v177
v_lshlrev_b32 v176, 16, v43
v_and_b32 v177, s90, v43
v_sub_f32 v176, v176, v186
v_sub_f32 v177, v177, v187
v_cvt_pk_bf16_f32 v43, v176, v177
v_lshlrev_b32 v176, 16, v44
v_and_b32 v177, s90, v44
v_sub_f32 v176, v176, v180
v_sub_f32 v177, v177, v181
v_cvt_pk_bf16_f32 v44, v176, v177
v_lshlrev_b32 v176, 16, v45
v_and_b32 v177, s90, v45
v_sub_f32 v176, v176, v182
v_sub_f32 v177, v177, v183
v_cvt_pk_bf16_f32 v45, v176, v177
v_lshlrev_b32 v176, 16, v46
v_and_b32 v177, s90, v46
v_sub_f32 v176, v176, v184
v_sub_f32 v177, v177, v185
v_cvt_pk_bf16_f32 v46, v176, v177
v_lshlrev_b32 v176, 16, v47
v_and_b32 v177, s90, v47
v_sub_f32 v176, v176, v186
v_sub_f32 v177, v177, v187
v_cvt_pk_bf16_f32 v47, v176, v177
v_lshlrev_b32 v176, 16, v48
v_and_b32 v177, s90, v48
v_sub_f32 v176, v176, v180
v_sub_f32 v177, v177, v181
v_cvt_pk_bf16_f32 v48, v176, v177
v_lshlrev_b32 v176, 16, v49
v_and_b32 v177, s90, v49
v_sub_f32 v176, v176, v182
v_sub_f32 v177, v177, v183
v_cvt_pk_bf16_f32 v49, v176, v177
v_lshlrev_b32 v176, 16, v50
v_and_b32 v177, s90, v50
v_sub_f32 v176, v176, v184
v_sub_f32 v177, v177, v185
v_cvt_pk_bf16_f32 v50, v176, v177
v_lshlrev_b32 v176, 16, v51
v_and_b32 v177, s90, v51
v_sub_f32 v176, v176, v186
v_sub_f32 v177, v177, v187
v_cvt_pk_bf16_f32 v51, v176, v177
v_lshlrev_b32 v176, 16, v52
v_and_b32 v177, s90, v52
v_sub_f32 v176, v176, v180
v_sub_f32 v177, v177, v181
v_cvt_pk_bf16_f32 v52, v176, v177
v_lshlrev_b32 v176, 16, v53
v_and_b32 v177, s90, v53
v_sub_f32 v176, v176, v182
v_sub_f32 v177, v177, v183
v_cvt_pk_bf16_f32 v53, v176, v177
v_lshlrev_b32 v176, 16, v54
v_and_b32 v177, s90, v54
v_sub_f32 v176, v176, v184
v_sub_f32 v177, v177, v185
v_cvt_pk_bf16_f32 v54, v176, v177
v_lshlrev_b32 v176, 16, v55
v_and_b32 v177, s90, v55
v_sub_f32 v176, v176, v186
v_sub_f32 v177, v177, v187
v_cvt_pk_bf16_f32 v55, v176, v177
ds_write_b128 v36, v[40:43]
ds_write_b128 v37, v[44:47]
ds_write_b128 v38, v[48:51]
ds_write_b128 v39, v[52:55]
s_add_u32 m0, s63, 0x1000
s_nop 0
buffer_load_dwordx4 v17, s[44:47], s68 offen offset:0 lds
buffer_load_dwordx4 v18, s[44:47], s68 offen offset:1024 lds
s_waitcnt vmcnt(4)
ds_read_b64_tr_b16 v[88:89], v25 offset:0
ds_read_b64_tr_b16 v[90:91], v25 offset:256
ds_read_b64_tr_b16 v[92:93], v26 offset:0
ds_read_b64_tr_b16 v[94:95], v26 offset:256
s_waitcnt lgkmcnt(4)
s_barrier
ds_read_b128 v[112:115], v31 offset:0
ds_read_b128 v[116:119], v31 offset:8192
ds_read_b128 v[120:123], v31 offset:16384
ds_read_b128 v[124:127], v31 offset:24576
ds_read_b128 v[128:131], v32 offset:1024
s_waitcnt vmcnt(2)
ds_read_b64_tr_b16 v[96:97], v25 offset:2048
ds_read_b64_tr_b16 v[98:99], v25 offset:2304
s_waitcnt lgkmcnt(6)
v_mfma_f32_16x16x32_bf16 v[56:59], v[112:115], v[88:91], 0
ds_read_b128 v[132:135], v32 offset:9216
s_waitcnt lgkmcnt(6)
v_mfma_f32_16x16x32_bf16 v[60:63], v[116:119], v[88:91], 0
ds_read_b128 v[136:139], v32 offset:17408
s_waitcnt lgkmcnt(6)
v_mfma_f32_16x16x32_bf16 v[64:67], v[120:123], v[88:91], 0
ds_read_b128 v[140:143], v32 offset:25600
s_waitcnt lgkmcnt(6)
v_mfma_f32_16x16x32_bf16 v[68:71], v[124:127], v[88:91], 0
ds_read_b64_tr_b16 v[100:101], v26 offset:2048
ds_read_b64_tr_b16 v[102:103], v26 offset:2304
v_mfma_f32_16x16x32_bf16 v[72:75], v[112:115], v[92:95], 0
s_add_u32 m0, s63, 0x0
s_nop 0
buffer_load_dwordx4 v17, s[44:47], s69 offen offset:0 lds
buffer_load_dwordx4 v18, s[44:47], s69 offen offset:1024 lds
v_mfma_f32_16x16x32_bf16 v[76:79], v[116:119], v[92:95], 0
v_mfma_f32_16x16x32_bf16 v[80:83], v[120:123], v[92:95], 0
v_mfma_f32_16x16x32_bf16 v[84:87], v[124:127], v[92:95], 0
ds_read_b128 v[144:147], v31 offset:2048
s_waitcnt vmcnt(2)
ds_read_b64_tr_b16 v[104:105], v25 offset:4096
ds_read_b64_tr_b16 v[106:107], v25 offset:4352
s_waitcnt lgkmcnt(8)
v_mfma_f32_16x16x32_bf16 v[56:59], v[128:131], v[96:99], v[56:59]
ds_read_b128 v[148:151], v31 offset:10240
s_waitcnt lgkmcnt(8)
v_mfma_f32_16x16x32_bf16 v[60:63], v[132:135], v[96:99], v[60:63]
ds_read_b128 v[152:155], v31 offset:18432
s_waitcnt lgkmcnt(8)
v_mfma_f32_16x16x32_bf16 v[64:67], v[136:139], v[96:99], v[64:67]
ds_read_b128 v[156:159], v31 offset:26624
s_waitcnt lgkmcnt(8)
v_mfma_f32_16x16x32_bf16 v[68:71], v[140:143], v[96:99], v[68:71]
ds_read_b64_tr_b16 v[108:109], v26 offset:4096
ds_read_b64_tr_b16 v[110:111], v26 offset:4352
s_waitcnt lgkmcnt(8)
v_mfma_f32_16x16x32_bf16 v[72:75], v[128:131], v[100:103], v[72:75]
s_add_u32 m0, s63, 0x800
s_nop 0
buffer_load_dwordx4 v17, s[44:47], s70 offen offset:0 lds
buffer_load_dwordx4 v18, s[44:47], s70 offen offset:1024 lds
v_mfma_f32_16x16x32_bf16 v[76:79], v[132:135], v[100:103], v[76:79]
v_mfma_f32_16x16x32_bf16 v[80:83], v[136:139], v[100:103], v[80:83]
v_mfma_f32_16x16x32_bf16 v[84:87], v[140:143], v[100:103], v[84:87]
ds_read_b128 v[160:163], v32 offset:3072
s_waitcnt vmcnt(2)
ds_read_b64_tr_b16 v[88:89], v25 offset:0
ds_read_b64_tr_b16 v[90:91], v25 offset:256
s_waitcnt lgkmcnt(8)
v_mfma_f32_16x16x32_bf16 v[56:59], v[144:147], v[104:107], v[56:59]
ds_read_b128 v[164:167], v32 offset:11264
s_waitcnt lgkmcnt(8)
v_mfma_f32_16x16x32_bf16 v[60:63], v[148:151], v[104:107], v[60:63]
ds_read_b128 v[168:171], v32 offset:19456
s_waitcnt lgkmcnt(8)
v_mfma_f32_16x16x32_bf16 v[64:67], v[152:155], v[104:107], v[64:67]
ds_read_b128 v[172:175], v32 offset:27648
s_waitcnt lgkmcnt(8)
v_mfma_f32_16x16x32_bf16 v[68:71], v[156:159], v[104:107], v[68:71]
ds_read_b64_tr_b16 v[92:93], v26 offset:0
ds_read_b64_tr_b16 v[94:95], v26 offset:256
s_waitcnt lgkmcnt(8)
v_mfma_f32_16x16x32_bf16 v[72:75], v[144:147], v[108:111], v[72:75]
s_add_u32 m0, s63, 0x1000
s_nop 0
buffer_load_dwordx4 v17, s[44:47], s71 offen offset:0 lds
buffer_load_dwordx4 v18, s[44:47], s71 offen offset:1024 lds
v_mfma_f32_16x16x32_bf16 v[76:79], v[148:151], v[108:111], v[76:79]
v_mfma_f32_16x16x32_bf16 v[80:83], v[152:155], v[108:111], v[80:83]
v_mfma_f32_16x16x32_bf16 v[84:87], v[156:159], v[108:111], v[84:87]
ds_read_b128 v[112:115], v31 offset:4096
s_waitcnt vmcnt(2)
ds_read_b64_tr_b16 v[96:97], v25 offset:2048
ds_read_b64_tr_b16 v[98:99], v25 offset:2304
s_waitcnt lgkmcnt(8)
v_mfma_f32_16x16x32_bf16 v[56:59], v[160:163], v[88:91], v[56:59]
ds_read_b128 v[116:119], v31 offset:12288
s_waitcnt lgkmcnt(8)
v_mfma_f32_16x16x32_bf16 v[60:63], v[164:167], v[88:91], v[60:63]
ds_read_b128 v[120:123], v31 offset:20480
s_waitcnt lgkmcnt(8)
v_mfma_f32_16x16x32_bf16 v[64:67], v[168:171], v[88:91], v[64:67]
ds_read_b128 v[124:127], v31 offset:28672
s_waitcnt lgkmcnt(8)
v_mfma_f32_16x16x32_bf16 v[68:71], v[172:175], v[88:91], v[68:71]
ds_read_b64_tr_b16 v[100:101], v26 offset:2048
ds_read_b64_tr_b16 v[102:103], v26 offset:2304
s_waitcnt lgkmcnt(8)
v_mfma_f32_16x16x32_bf16 v[72:75], v[160:163], v[92:95], v[72:75]
s_add_u32 m0, s63, 0x0
s_nop 0
buffer_load_dwordx4 v17, s[44:47], s72 offen offset:0 lds
buffer_load_dwordx4 v18, s[44:47], s72 offen offset:1024 lds
v_mfma_f32_16x16x32_bf16 v[76:79], v[164:167], v[92:95], v[76:79]
v_mfma_f32_16x16x32_bf16 v[80:83], v[168:171], v[92:95], v[80:83]
v_mfma_f32_16x16x32_bf16 v[84:87], v[172:175], v[92:95], v[84:87]
ds_read_b128 v[128:131], v32 offset:5120
s_waitcnt vmcnt(2)
ds_read_b64_tr_b16 v[104:105], v25 offset:4096
ds_read_b64_tr_b16 v[106:107], v25 offset:4352
s_waitcnt lgkmcnt(8)
v_mfma_f32_16x16x32_bf16 v[56:59], v[112:115], v[96:99], v[56:59]
ds_read_b128 v[132:135], v32 offset:13312
s_waitcnt lgkmcnt(8)
v_mfma_f32_16x16x32_bf16 v[60:63], v[116:119], v[96:99], v[60:63]
ds_read_b128 v[136:139], v32 offset:21504
s_waitcnt lgkmcnt(8)
v_mfma_f32_16x16x32_bf16 v[64:67], v[120:123], v[96:99], v[64:67]
ds_read_b128 v[140:143], v32 offset:29696
s_waitcnt lgkmcnt(8)
v_mfma_f32_16x16x32_bf16 v[68:71], v[124:127], v[96:99], v[68:71]
ds_read_b64_tr_b16 v[108:109], v26 offset:4096
ds_read_b64_tr_b16 v[110:111], v26 offset:4352
s_waitcnt lgkmcnt(8)
v_mfma_f32_16x16x32_bf16 v[72:75], v[112:115], v[100:103], v[72:75]
s_add_u32 m0, s63, 0x800
s_nop 0
buffer_load_dwordx4 v17, s[44:47], s73 offen offset:0 lds
buffer_load_dwordx4 v18, s[44:47], s73 offen offset:1024 lds
v_mfma_f32_16x16x32_bf16 v[76:79], v[116:119], v[100:103], v[76:79]
v_mfma_f32_16x16x32_bf16 v[80:83], v[120:123], v[100:103], v[80:83]
v_mfma_f32_16x16x32_bf16 v[84:87], v[124:127], v[100:103], v[84:87]
ds_read_b128 v[144:147], v31 offset:6144
s_waitcnt vmcnt(2)
ds_read_b64_tr_b16 v[88:89], v25 offset:0
ds_read_b64_tr_b16 v[90:91], v25 offset:256
s_waitcnt lgkmcnt(8)
v_mfma_f32_16x16x32_bf16 v[56:59], v[128:131], v[104:107], v[56:59]
ds_read_b128 v[148:151], v31 offset:14336
s_waitcnt lgkmcnt(8)
v_mfma_f32_16x16x32_bf16 v[60:63], v[132:135], v[104:107], v[60:63]
ds_read_b128 v[152:155], v31 offset:22528
s_waitcnt lgkmcnt(8)
v_mfma_f32_16x16x32_bf16 v[64:67], v[136:139], v[104:107], v[64:67]
ds_read_b128 v[156:159], v31 offset:30720
s_waitcnt lgkmcnt(8)
v_mfma_f32_16x16x32_bf16 v[68:71], v[140:143], v[104:107], v[68:71]
ds_read_b64_tr_b16 v[92:93], v26 offset:0
ds_read_b64_tr_b16 v[94:95], v26 offset:256
s_waitcnt lgkmcnt(8)
v_mfma_f32_16x16x32_bf16 v[72:75], v[128:131], v[108:111], v[72:75]
v_mfma_f32_16x16x32_bf16 v[76:79], v[132:135], v[108:111], v[76:79]
v_mfma_f32_16x16x32_bf16 v[80:83], v[136:139], v[108:111], v[80:83]
v_mfma_f32_16x16x32_bf16 v[84:87], v[140:143], v[108:111], v[84:87]
ds_read_b128 v[160:163], v32 offset:7168
s_waitcnt vmcnt(0)
ds_read_b64_tr_b16 v[96:97], v25 offset:2048
ds_read_b64_tr_b16 v[98:99], v25 offset:2304
s_waitcnt lgkmcnt(8)
v_mfma_f32_16x16x32_bf16 v[56:59], v[144:147], v[88:91], v[56:59]
ds_read_b128 v[164:167], v32 offset:15360
s_waitcnt lgkmcnt(8)
v_mfma_f32_16x16x32_bf16 v[60:63], v[148:151], v[88:91], v[60:63]
ds_read_b128 v[168:171], v32 offset:23552
s_waitcnt lgkmcnt(8)
v_mfma_f32_16x16x32_bf16 v[64:67], v[152:155], v[88:91], v[64:67]
ds_read_b128 v[172:175], v32 offset:31744
s_waitcnt lgkmcnt(8)
v_mfma_f32_16x16x32_bf16 v[68:71], v[156:159], v[88:91], v[68:71]
ds_read_b64_tr_b16 v[100:101], v26 offset:2048
ds_read_b64_tr_b16 v[102:103], v26 offset:2304
s_waitcnt lgkmcnt(8)
v_mfma_f32_16x16x32_bf16 v[72:75], v[144:147], v[92:95], v[72:75]
v_mfma_f32_16x16x32_bf16 v[76:79], v[148:151], v[92:95], v[76:79]
v_mfma_f32_16x16x32_bf16 v[80:83], v[152:155], v[92:95], v[80:83]
v_mfma_f32_16x16x32_bf16 v[84:87], v[156:159], v[92:95], v[84:87]
s_waitcnt lgkmcnt(5)
v_mfma_f32_16x16x32_bf16 v[56:59], v[160:163], v[96:99], v[56:59]
s_waitcnt lgkmcnt(4)
v_mfma_f32_16x16x32_bf16 v[60:63], v[164:167], v[96:99], v[60:63]
s_waitcnt lgkmcnt(3)
v_mfma_f32_16x16x32_bf16 v[64:67], v[168:171], v[96:99], v[64:67]
s_waitcnt lgkmcnt(2)
v_mfma_f32_16x16x32_bf16 v[68:71], v[172:175], v[96:99], v[68:71]
s_waitcnt lgkmcnt(0)
v_mfma_f32_16x16x32_bf16 v[72:75], v[160:163], v[100:103], v[72:75]
v_cvt_pk_bf16_f32 v56, v56, v57
v_cvt_pk_bf16_f32 v57, v58, v59
v_cvt_pk_bf16_f32 v58, v60, v61
v_cvt_pk_bf16_f32 v59, v62, v63
buffer_store_dwordx4 v[56:59], v16, s[52:55], s82 offen offset:0 sc1
v_mfma_f32_16x16x32_bf16 v[76:79], v[164:167], v[100:103], v[76:79]
v_mfma_f32_16x16x32_bf16 v[80:83], v[168:171], v[100:103], v[80:83]
v_cvt_pk_bf16_f32 v64, v64, v65
v_cvt_pk_bf16_f32 v65, v66, v67
v_cvt_pk_bf16_f32 v66, v68, v69
v_cvt_pk_bf16_f32 v67, v70, v71
buffer_store_dwordx4 v[64:67], v16, s[52:55], s82 offen offset:2048 sc1
v_mfma_f32_16x16x32_bf16 v[84:87], v[172:175], v[100:103], v[84:87]
v_cvt_pk_bf16_f32 v72, v72, v73
v_cvt_pk_bf16_f32 v73, v74, v75
v_cvt_pk_bf16_f32 v74, v76, v77
v_cvt_pk_bf16_f32 v75, v78, v79
buffer_store_dwordx4 v[72:75], v16, s[52:55], s82 offen offset:1024 sc1
v_cvt_pk_bf16_f32 v80, v80, v81
v_cvt_pk_bf16_f32 v81, v82, v83
s_nop 0
v_cvt_pk_bf16_f32 v82, v84, v85
v_cvt_pk_bf16_f32 v83, v86, v87
buffer_store_dwordx4 v[80:83], v16, s[52:55], s82 offen offset:3072 sc1
s_branch L1_fin
L1_edge:
s_mov_b32 s61, 4
s_mov_b32 s4, s2
s_mul_i32 s6, s4, 20000
v_lshlrev_b32 v5, 4, v0
v_lshlrev_b32 v6, 2, v2
v_add_u32 v6, 0x10000, v6
v_mov_b32 v7, 0
ds_write_b32 v6, v7
s_mov_b32 s66, 0
s_mov_b32 s67, 8192
s_mov_b32 s68, 16384
s_waitcnt lgkmcnt(0)
s_add_u32 s56, s38, 0x7c00000
s_addc_u32 s57, s39, 0
s_mov_b32 s58, 0x2000
s_mov_b32 s59, 0x00020000
s_cmp_eq_u32 s4, 0
s_cselect_b32 s9, 0, 0x7fff0000
v_mov_b32 v8, 0
v_mov_b32 v9, 0
v_mov_b32 v10, 0
v_mov_b32 v11, 0
buffer_store_dwordx4 v[8:11], v5, s[56:59], s9 offen
s_add_u32 s40, s20, 0x0
s_addc_u32 s41, s21, 0
s_add_u32 s40, s40, s6
s_addc_u32 s41, s41, 0
s_mov_b32 s42, 0x4e20
s_mov_b32 s43, 0x00020000
s_add_u32 s44, s18, 0x0
s_addc_u32 s45, s19, 0
s_add_u32 s44, s44, s6
s_addc_u32 s45, s45, 0
s_mov_b32 s46, 0x4e20
s_mov_b32 s47, 0x00020000
buffer_load_dwordx4 v[16:19], v5, s[40:43], s66 offen
buffer_load_dwordx4 v[20:23], v5, s[40:43], s67 offen
buffer_load_dwordx4 v[24:27], v5, s[40:43], s68 offen
buffer_load_dwordx4 v[28:31], v5, s[44:47], s66 offen
buffer_load_dwordx4 v[32:35], v5, s[44:47], s67 offen
buffer_load_dwordx4 v[36:39], v5, s[44:47], s68 offen
s_add_u32 s48, s38, 0x8000000
s_addc_u32 s49, s39, 0
s_mov_b32 s50, 0x2800000
s_mov_b32 s51, 0x00020000
s_add_u32 s52, s38, 0x7800000
s_addc_u32 s53, s39, 0
s_mov_b32 s54, 0x2000
s_mov_b32 s55, 0x00020000
s_mov_b32 s9, 6279
s_mov_b32 s10, 4294967129
s_mov_b32 s11, 0x10000
v_mov_b32 v7, 1
v_cmp_gt_u32 vcc, 0xe2, v0
s_mov_b64 s[12:13], vcc
s_barrier
s_waitcnt vmcnt(5)
v_mul_u32_u24 v40, s9, v16
v_lshrrev_b32 v40, 20, v40
v_lshl_add_u32 v52, v40, 2, s11
ds_add_rtn_u32 v52, v52, v7
v_mad_i32_i24 v16, v40, s10, v16
v_mul_u32_u24 v41, s9, v17
v_lshrrev_b32 v41, 20, v41
v_lshl_add_u32 v53, v41, 2, s11
ds_add_rtn_u32 v53, v53, v7
v_mad_i32_i24 v17, v41, s10, v17
v_mul_u32_u24 v42, s9, v18
v_lshrrev_b32 v42, 20, v42
v_lshl_add_u32 v54, v42, 2, s11
ds_add_rtn_u32 v54, v54, v7
v_mad_i32_i24 v18, v42, s10, v18
v_mul_u32_u24 v43, s9, v19
v_lshrrev_b32 v43, 20, v43
v_lshl_add_u32 v55, v43, 2, s11
ds_add_rtn_u32 v55, v55, v7
v_mad_i32_i24 v19, v43, s10, v19
s_waitcnt vmcnt(4)
v_mul_u32_u24 v44, s9, v20
v_lshrrev_b32 v44, 20, v44
v_lshl_add_u32 v56, v44, 2, s11
ds_add_rtn_u32 v56, v56, v7
v_mad_i32_i24 v20, v44, s10, v20
v_mul_u32_u24 v45, s9, v21
v_lshrrev_b32 v45, 20, v45
v_lshl_add_u32 v57, v45, 2, s11
ds_add_rtn_u32 v57, v57, v7
v_mad_i32_i24 v21, v45, s10, v21
v_mul_u32_u24 v46, s9, v22
v_lshrrev_b32 v46, 20, v46
v_lshl_add_u32 v58, v46, 2, s11
ds_add_rtn_u32 v58, v58, v7
v_mad_i32_i24 v22, v46, s10, v22
v_mul_u32_u24 v47, s9, v23
v_lshrrev_b32 v47, 20, v47
v_lshl_add_u32 v59, v47, 2, s11
ds_add_rtn_u32 v59, v59, v7
v_mad_i32_i24 v23, v47, s10, v23
s_waitcnt vmcnt(3)
s_mov_b64 exec, s[12:13]
v_mul_u32_u24 v48, s9, v24
v_lshrrev_b32 v48, 20, v48
v_lshl_add_u32 v60, v48, 2, s11
ds_add_rtn_u32 v60, v60, v7
v_mad_i32_i24 v24, v48, s10, v24
v_mul_u32_u24 v49, s9, v25
v_lshrrev_b32 v49, 20, v49
v_lshl_add_u32 v61, v49, 2, s11
ds_add_rtn_u32 v61, v61, v7
v_mad_i32_i24 v25, v49, s10, v25
v_mul_u32_u24 v50, s9, v26
v_lshrrev_b32 v50, 20, v50
v_lshl_add_u32 v62, v50, 2, s11
ds_add_rtn_u32 v62, v62, v7
v_mad_i32_i24 v26, v50, s10, v26
v_mul_u32_u24 v51, s9, v27
v_lshrrev_b32 v51, 20, v51
v_lshl_add_u32 v63, v51, 2, s11
ds_add_rtn_u32 v63, v63, v7
v_mad_i32_i24 v27, v51, s10, v27
s_mov_b64 exec, -1
s_waitcnt vmcnt(2) lgkmcnt(4)
v_and_b32 v8, 0x7f, v52
v_lshl_or_b32 v28, v16, 18, v28
v_lshlrev_b32 v8, 2, v8
v_lshl_add_u32 v8, v40, 9, v8
ds_write_b32 v8, v28
v_and_b32 v8, 0x7f, v53
v_lshl_or_b32 v29, v17, 18, v29
v_lshlrev_b32 v8, 2, v8
v_lshl_add_u32 v8, v41, 9, v8
ds_write_b32 v8, v29
v_and_b32 v8, 0x7f, v54
v_lshl_or_b32 v30, v18, 18, v30
v_lshlrev_b32 v8, 2, v8
v_lshl_add_u32 v8, v42, 9, v8
ds_write_b32 v8, v30
v_and_b32 v8, 0x7f, v55
v_lshl_or_b32 v31, v19, 18, v31
v_lshlrev_b32 v8, 2, v8
v_lshl_add_u32 v8, v43, 9, v8
ds_write_b32 v8, v31
s_waitcnt vmcnt(1) lgkmcnt(4)
v_and_b32 v8, 0x7f, v56
v_lshl_or_b32 v32, v20, 18, v32
v_lshlrev_b32 v8, 2, v8
v_lshl_add_u32 v8, v44, 9, v8
ds_write_b32 v8, v32
v_and_b32 v8, 0x7f, v57
v_lshl_or_b32 v33, v21, 18, v33
v_lshlrev_b32 v8, 2, v8
v_lshl_add_u32 v8, v45, 9, v8
ds_write_b32 v8, v33
v_and_b32 v8, 0x7f, v58
v_lshl_or_b32 v34, v22, 18, v34
v_lshlrev_b32 v8, 2, v8
v_lshl_add_u32 v8, v46, 9, v8
ds_write_b32 v8, v34
v_and_b32 v8, 0x7f, v59
v_lshl_or_b32 v35, v23, 18, v35
v_lshlrev_b32 v8, 2, v8
v_lshl_add_u32 v8, v47, 9, v8
ds_write_b32 v8, v35
s_waitcnt vmcnt(0) lgkmcnt(8)
s_mov_b64 exec, s[12:13]
v_and_b32 v8, 0x7f, v60
v_lshl_or_b32 v36, v24, 18, v36
v_lshlrev_b32 v8, 2, v8
v_lshl_add_u32 v8, v48, 9, v8
ds_write_b32 v8, v36
v_and_b32 v8, 0x7f, v61
v_lshl_or_b32 v37, v25, 18, v37
v_lshlrev_b32 v8, 2, v8
v_lshl_add_u32 v8, v49, 9, v8
ds_write_b32 v8, v37
v_and_b32 v8, 0x7f, v62
v_lshl_or_b32 v38, v26, 18, v38
v_lshlrev_b32 v8, 2, v8
v_lshl_add_u32 v8, v50, 9, v8
ds_write_b32 v8, v38
v_and_b32 v8, 0x7f, v63
v_lshl_or_b32 v39, v27, 18, v39
v_lshlrev_b32 v8, 2, v8
v_lshl_add_u32 v8, v51, 9, v8
ds_write_b32 v8, v39
s_mov_b64 exec, -1
s_waitcnt lgkmcnt(0)
s_barrier
ds_read_b32 v8, v6
s_mul_i32 s6, s60, 4096
v_lshlrev_b32 v10, 4, v2
v_add_u32 v9, s6, v10
ds_read_b128 v[64:67], v9 offset:0
ds_read_b128 v[68:71], v9 offset:1024
ds_read_b128 v[72:75], v9 offset:2048
ds_read_b128 v[76:79], v9 offset:3072
v_lshrrev_b32 v11, 5, v2
v_mul_u32_u24 v11, 0x9fe00, v11
v_add_u32 v10, v10, v11
s_mul_i32 s6, s60, 5242880
s_mul_i32 s7, s4, 20480
s_add_u32 s6, s6, s7
v_lshlrev_b32 v9, 7, v2
s_lshl_b32 s8, s4, 2
s_cmp_eq_u32 s60, 0
s_cselect_b32 s8, s8, 0x7fff0000
s_waitcnt lgkmcnt(4)
buffer_store_dword v8, v9, s[52:55], s8 offen sc1
v_cmp_lt_u32 vcc, 0x80, v8
s_cbranch_vccnz L1_eslow
s_waitcnt lgkmcnt(3)
buffer_store_dwordx4 v[64:67], v10, s[48:51], s6 offen sc1
s_add_u32 s6, s6, 1310720
s_waitcnt lgkmcnt(2)
buffer_store_dwordx4 v[68:71], v10, s[48:51], s6 offen sc1
s_add_u32 s6, s6, 1310720
s_waitcnt lgkmcnt(1)
buffer_store_dwordx4 v[72:75], v10, s[48:51], s6 offen sc1
s_add_u32 s6, s6, 1310720
s_waitcnt lgkmcnt(0)
buffer_store_dwordx4 v[76:79], v10, s[48:51], s6 offen sc1
s_add_u32 s6, s6, 1310720
s_branch L1_fin
L1_eslow:
s_mov_b32 s9, 655360
v_mul_u32_u24 v40, s9, v40
v_lshl_add_u32 v40, v52, 2, v40
v_mul_u32_u24 v41, s9, v41
v_lshl_add_u32 v41, v53, 2, v41
v_mul_u32_u24 v42, s9, v42
v_lshl_add_u32 v42, v54, 2, v42
v_mul_u32_u24 v43, s9, v43
v_lshl_add_u32 v43, v55, 2, v43
v_mul_u32_u24 v44, s9, v44
v_lshl_add_u32 v44, v56, 2, v44
v_mul_u32_u24 v45, s9, v45
v_lshl_add_u32 v45, v57, 2, v45
v_mul_u32_u24 v46, s9, v46
v_lshl_add_u32 v46, v58, 2, v46
v_mul_u32_u24 v47, s9, v47
v_lshl_add_u32 v47, v59, 2, v47
v_mul_u32_u24 v48, s9, v48
v_lshl_add_u32 v48, v60, 2, v48
v_mul_u32_u24 v49, s9, v49
v_lshl_add_u32 v49, v61, 2, v49
v_mul_u32_u24 v50, s9, v50
v_lshl_add_u32 v50, v62, 2, v50
v_mul_u32_u24 v51, s9, v51
v_lshl_add_u32 v51, v63, 2, v51
buffer_store_dword v28, v40, s[48:51], s7 offen
buffer_store_dword v29, v41, s[48:51], s7 offen
buffer_store_dword v30, v42, s[48:51], s7 offen
buffer_store_dword v31, v43, s[48:51], s7 offen
buffer_store_dword v32, v44, s[48:51], s7 offen
buffer_store_dword v33, v45, s[48:51], s7 offen
buffer_store_dword v34, v46, s[48:51], s7 offen
buffer_store_dword v35, v47, s[48:51], s7 offen
s_mov_b64 exec, s[12:13]
buffer_store_dword v36, v48, s[48:51], s7 offen
buffer_store_dword v37, v49, s[48:51], s7 offen
buffer_store_dword v38, v50, s[48:51], s7 offen
buffer_store_dword v39, v51, s[48:51], s7 offen
s_mov_b64 exec, -1
L1_fin:
L1_end:
s_endpgm
.globl k2_kernel
.p2align 8
.type k2_kernel,@function
k2_kernel:
s_load_dwordx2 s[4:5], s[0:1], 88
s_load_dwordx2 s[6:7], s[0:1], 0
s_load_dwordx2 s[16:17], s[0:1], 24
s_load_dwordx2 s[18:19], s[0:1], 72
s_and_b32 s35, s2, 7
s_lshr_b32 s37, s2, 3
s_cmp_ge_u32 s37, 30
s_cbranch_scc1 LE_start
s_mul_i32 s38, s37, 52
s_lshr_b32 s38, s38, 8
s_mul_i32 s39, s38, 5
s_sub_u32 s39, s37, s39
s_mov_b32 s37, s38
s_mul_i32 s38, s35, 5
s_add_u32 s38, s38, s39
v_lshrrev_b32 v1, 6, v0
v_and_b32 v252, 63, v0
v_lshlrev_b32 v252, 4, v252
v_readfirstlane_b32 s34, v1
s_mov_b32 s50, 0xe1a06800
s_mov_b32 s51, 0x4e608d04
s_mul_i32 s39, s37, 9
s_lshr_b64 s[50:51], s[50:51], s39
s_and_b32 s39, s50, 0x1ff
s_bfe_u32 s49, s50, 0x90009
s_sub_u32 s29, s49, s39
s_lshl_b32 s50, s37, 2
s_lshr_b32 s59, 0x766666, s50
s_and_b32 s59, s59, 15
s_sub_u32 s31, s29, s59
s_lshr_b32 s31, s31, 1
s_sub_u32 s31, s31, 1
s_lshl_b32 s39, s39, 14
s_lshl_b32 s49, s49, 14
s_add_u32 s28, s39, 0x4000
s_cmp_eq_u32 s37, 5
s_cselect_b32 s33, 0xff800000, 0
s_mov_b32 s32, 0xffff
v_and_b32 v2, 63, v0
v_bfe_u32 v3, v2, 3, 2
v_bfe_u32 v4, v2, 2, 1
v_lshlrev_b32 v251, 12, v3
v_lshl_or_b32 v251, v4, 9, v251
v_lshl_or_b32 v251, v1, 7, v251
v_lshrrev_b32 v4, 5, v2
v_lshl_or_b32 v251, v4, 6, v251
v_and_b32 v3, 2, v3
v_and_b32 v4, 3, v2
v_xor_b32 v3, v3, v4
v_lshl_or_b32 v251, v3, 4, v251
s_cmp_eq_u32 s38, 39
s_cbranch_scc1 LT_disp
s_lshl_b32 s30, s34, 12
s_mov_b32 m0, s30
s_waitcnt lgkmcnt(0)
s_add_u32 s12, s4, 0x6800000
s_addc_u32 s13, s5, 0
s_mov_b32 s14, s49
s_mov_b32 s15, 0x00020000
buffer_load_dwordx4 v251, s[12:15], s39 offen offset:0 lds
buffer_load_dwordx4 v251, s[12:15], s39 offen offset:1024 lds
buffer_load_dwordx4 v251, s[12:15], s39 offen offset:2048 lds
buffer_load_dwordx4 v251, s[12:15], s39 offen offset:3072 lds
s_add_u32 m0, s30, 0x4000
s_nop 0
buffer_load_dwordx4 v251, s[12:15], s28 offen offset:0 lds
buffer_load_dwordx4 v251, s[12:15], s28 offen offset:1024 lds
s_add_u32 s8, s4, 0x0
s_addc_u32 s9, s5, 0
s_mov_b32 s10, 0x4e4000
s_mov_b32 s11, 0x00020000
s_mul_i32 s35, s37, 0x600000
s_add_u32 s20, s4, 0x2000000
s_addc_u32 s21, s5, 0
s_add_u32 s20, s20, s35
s_addc_u32 s21, s21, 0
s_mov_b32 s22, 0x4e4000
s_mov_b32 s23, 0x00020000
s_add_u32 s24, s4, 0x6000000
s_addc_u32 s25, s5, 0
s_mov_b32 s26, 0x9c800
s_mov_b32 s27, 0x00020000
s_lshl_b32 s35, s38, 4
s_lshl_b32 s41, s34, 2
s_add_u32 s35, s35, s41
s_mul_i32 s41, s37, 3
s_sub_u32 s42, s34, s41
s_and_b32 s42, s42, 3
s_add_u32 s41, s41, s42
s_lshr_b32 s41, s41, 2
s_cmp_eq_u32 s37, 5
s_cselect_b32 s42, 3, s42
s_cmp_lt_u32 s42, 3
s_cselect_b32 s41, s41, 0
s_cselect_b32 s50, 1, 0
s_add_u32 s35, s35, s41
s_lshl_b32 s40, s35, 13
s_lshl_b32 s48, s35, 10
s_lshl_b32 s35, s37, 3
s_add_u32 s48, s48, s35
s_xor_b32 s41, s40, 8192
s_xor_b32 s42, s40, 16384
s_xor_b32 s43, s40, 24576
s_add_u32 s44, s40, 4096
s_add_u32 s45, s41, 4096
s_add_u32 s46, s42, 4096
s_add_u32 s47, s43, 4096
s_mul_i32 s35, s37, 3
s_and_b32 s36, s35, 3
s_lshl_b32 s36, s36, 2
s_lshr_b32 s52, s35, 2
s_add_u32 s36, s36, s52
s_lshl_b32 s52, s38, 4
s_add_u32 s52, s52, s36
s_lshl_b32 s52, s52, 13
s_add_u32 s35, s35, 1
s_and_b32 s36, s35, 3
s_lshl_b32 s36, s36, 2
s_lshr_b32 s53, s35, 2
s_add_u32 s36, s36, s53
s_lshl_b32 s53, s38, 4
s_add_u32 s53, s53, s36
s_lshl_b32 s53, s53, 13
s_add_u32 s35, s35, 1
s_and_b32 s36, s35, 3
s_lshl_b32 s36, s36, 2
s_lshr_b32 s54, s35, 2
s_add_u32 s36, s36, s54
s_lshl_b32 s54, s38, 4
s_add_u32 s54, s54, s36
s_lshl_b32 s54, s54, 13
v_mov_b32 v208, 0
v_mov_b32 v209, 0
v_mov_b32 v210, 0
v_mov_b32 v211, 0
buffer_load_dwordx4 v[0:3], v252, s[8:11], s40 offen offset:0
buffer_load_dwordx4 v[32:35], v252, s[8:11], s41 offen offset:0
v_mfma_f32_32x32x16_bf16 a[0:15], v[208:211], v[208:211], 0
buffer_load_dwordx4 v[64:67], v252, s[8:11], s42 offen offset:0
v_mfma_f32_32x32x16_bf16 a[16:31], v[208:211], v[208:211], 0
buffer_load_dwordx4 v[96:99], v252, s[8:11], s43 offen offset:0
buffer_load_dwordx4 v[4:7], v252, s[8:11], s40 offen offset:1024
v_mfma_f32_32x32x16_bf16 a[32:47], v[208:211], v[208:211], 0
buffer_load_dwordx4 v[36:39], v252, s[8:11], s41 offen offset:1024
v_mfma_f32_32x32x16_bf16 a[48:63], v[208:211], v[208:211], 0
buffer_load_dwordx4 v[68:71], v252, s[8:11], s42 offen offset:1024
buffer_load_dwordx4 v[100:103], v252, s[8:11], s43 offen offset:1024
v_mfma_f32_32x32x16_bf16 a[64:79], v[208:211], v[208:211], 0
buffer_load_dwordx4 v[8:11], v252, s[8:11], s40 offen offset:2048
v_mfma_f32_32x32x16_bf16 a[80:95], v[208:211], v[208:211], 0
buffer_load_dwordx4 v[40:43], v252, s[8:11], s41 offen offset:2048
buffer_load_dwordx4 v[72:75], v252, s[8:11], s42 offen offset:2048
v_mfma_f32_32x32x16_bf16 a[96:111], v[208:211], v[208:211], 0
buffer_load_dwordx4 v[104:107], v252, s[8:11], s43 offen offset:2048
v_mfma_f32_32x32x16_bf16 a[112:127], v[208:211], v[208:211], 0
buffer_load_dwordx4 v[12:15], v252, s[8:11], s40 offen offset:3072
buffer_load_dwordx4 v[44:47], v252, s[8:11], s41 offen offset:3072
v_mfma_f32_32x32x16_bf16 a[128:143], v[208:211], v[208:211], 0
buffer_load_dwordx4 v[76:79], v252, s[8:11], s42 offen offset:3072
v_mfma_f32_32x32x16_bf16 a[144:159], v[208:211], v[208:211], 0
buffer_load_dwordx4 v[108:111], v252, s[8:11], s43 offen offset:3072
buffer_load_dwordx4 v[16:19], v252, s[8:11], s44 offen offset:0
v_mfma_f32_32x32x16_bf16 a[160:175], v[208:211], v[208:211], 0
buffer_load_dwordx4 v[48:51], v252, s[8:11], s45 offen offset:0
v_mfma_f32_32x32x16_bf16 a[176:191], v[208:211], v[208:211], 0
buffer_load_dwordx4 v[80:83], v252, s[8:11], s46 offen offset:0
buffer_load_dwordx4 v[112:115], v252, s[8:11], s47 offen offset:0
v_mfma_f32_32x32x16_bf16 a[192:207], v[208:211], v[208:211], 0
buffer_load_dwordx4 v[20:23], v252, s[8:11], s44 offen offset:1024
v_mfma_f32_32x32x16_bf16 a[208:223], v[208:211], v[208:211], 0
buffer_load_dwordx4 v[52:55], v252, s[8:11], s45 offen offset:1024
buffer_load_dwordx4 v[84:87], v252, s[8:11], s46 offen offset:1024
v_mfma_f32_32x32x16_bf16 a[224:239], v[208:211], v[208:211], 0
buffer_load_dwordx4 v[116:119], v252, s[8:11], s47 offen offset:1024
v_mfma_f32_32x32x16_bf16 a[240:255], v[208:211], v[208:211], 0
v_bfe_u32 v248, v252, 4, 3
v_lshlrev_b32 v248, 6, v248
v_bfe_u32 v253, v252, 7, 1
v_lshl_or_b32 v248, v253, 10, v248
v_bfe_u32 v253, v252, 8, 2
v_lshl_or_b32 v248, v253, 4, v248
v_bfe_u32 v253, v252, 6, 1
v_lshlrev_b32 v253, 5, v253
v_xor_b32 v248, v248, v253
v_and_b32 v249, 0x1c0, v252
v_bfe_u32 v253, v252, 9, 1
v_lshl_or_b32 v249, v253, 10, v249
v_bfe_u32 v253, v252, 8, 1
v_lshl_or_b32 v249, v253, 5, v249
v_bfe_u32 v253, v252, 4, 2
v_lshl_or_b32 v249, v253, 3, v249
v_xor_b32 v250, 32, v249
s_waitcnt vmcnt(24)
s_barrier
ds_read_b128 v[224:227], v248 offset:0
ds_read_b128 v[228:231], v248 offset:512
ds_read_b128 v[232:235], v248 offset:2048
ds_read_b128 v[236:239], v248 offset:2560
s_waitcnt lgkmcnt(2)
s_waitcnt vmcnt(16)
v_mfma_f32_16x16x32_bf16 v[160:163], v[224:227], v[0:3], 0
ds_read_b128 v[240:243], v248 offset:16384
v_mfma_f32_16x16x32_bf16 v[160:163], v[228:231], v[4:7], v[160:163]
buffer_load_dwordx4 v[24:27], v252, s[8:11], s44 offen offset:2048
v_mfma_f32_16x16x32_bf16 v[164:167], v[224:227], v[32:35], 0
v_mfma_f32_16x16x32_bf16 v[164:167], v[228:231], v[36:39], v[164:167]
buffer_load_dwordx4 v[56:59], v252, s[8:11], s45 offen offset:2048
v_mfma_f32_16x16x32_bf16 v[168:171], v[224:227], v[64:67], 0
ds_read_b128 v[244:247], v248 offset:16896
v_mfma_f32_16x16x32_bf16 v[168:171], v[228:231], v[68:71], v[168:171]
buffer_load_dwordx4 v[88:91], v252, s[8:11], s46 offen offset:2048
v_mfma_f32_16x16x32_bf16 v[172:175], v[224:227], v[96:99], 0
v_mfma_f32_16x16x32_bf16 v[172:175], v[228:231], v[100:103], v[172:175]
s_waitcnt lgkmcnt(2)
buffer_load_dwordx4 v[120:123], v252, s[8:11], s47 offen offset:2048
v_mfma_f32_16x16x32_bf16 v[176:179], v[232:235], v[0:3], 0
ds_read_b128 v[224:227], v248 offset:4096
v_mfma_f32_16x16x32_bf16 v[176:179], v[236:239], v[4:7], v[176:179]
buffer_load_dwordx4 v[28:31], v252, s[8:11], s44 offen offset:3072
v_mfma_f32_16x16x32_bf16 v[180:183], v[232:235], v[32:35], 0
v_mfma_f32_16x16x32_bf16 v[180:183], v[236:239], v[36:39], v[180:183]
buffer_load_dwordx4 v[60:63], v252, s[8:11], s45 offen offset:3072
v_mfma_f32_16x16x32_bf16 v[184:187], v[232:235], v[64:67], 0
ds_read_b128 v[228:231], v248 offset:4608
v_mfma_f32_16x16x32_bf16 v[184:187], v[236:239], v[68:71], v[184:187]
buffer_load_dwordx4 v[92:95], v252, s[8:11], s46 offen offset:3072
v_mfma_f32_16x16x32_bf16 v[188:191], v[232:235], v[96:99], 0
v_mfma_f32_16x16x32_bf16 v[188:191], v[236:239], v[100:103], v[188:191]
s_waitcnt lgkmcnt(2)
buffer_load_dwordx4 v[124:127], v252, s[8:11], s47 offen offset:3072
v_mfma_f32_16x16x32_bf16 v[192:195], v[240:243], v[0:3], 0
ds_read_b128 v[232:235], v248 offset:6144
v_mfma_f32_16x16x32_bf16 v[192:195], v[244:247], v[4:7], v[192:195]
v_mfma_f32_16x16x32_bf16 v[196:199], v[240:243], v[32:35], 0
v_mfma_f32_16x16x32_bf16 v[196:199], v[244:247], v[36:39], v[196:199]
v_mfma_f32_16x16x32_bf16 v[200:203], v[240:243], v[64:67], 0
ds_read_b128 v[236:239], v248 offset:6656
v_mfma_f32_16x16x32_bf16 v[200:203], v[244:247], v[68:71], v[200:203]
v_mfma_f32_16x16x32_bf16 v[204:207], v[240:243], v[96:99], 0
v_mfma_f32_16x16x32_bf16 v[204:207], v[244:247], v[100:103], v[204:207]
s_waitcnt lgkmcnt(2)
s_waitcnt vmcnt(16)
v_mfma_f32_16x16x32_bf16 v[160:163], v[224:227], v[8:11], v[160:163]
ds_read_b128 v[240:243], v248 offset:20480
v_mfma_f32_16x16x32_bf16 v[160:163], v[228:231], v[12:15], v[160:163]
buffer_load_dwordx4 v251, s[12:15], s28 offen offset:2048 lds
v_mfma_f32_16x16x32_bf16 v[164:167], v[224:227], v[40:43], v[164:167]
v_mfma_f32_16x16x32_bf16 v[164:167], v[228:231], v[44:47], v[164:167]
buffer_load_dwordx4 v251, s[12:15], s28 offen offset:3072 lds
v_mfma_f32_16x16x32_bf16 v[168:171], v[224:227], v[72:75], v[168:171]
ds_read_b128 v[244:247], v248 offset:20992
v_mfma_f32_16x16x32_bf16 v[168:171], v[228:231], v[76:79], v[168:171]
s_add_u32 s28, s28, 0x4000
s_add_u32 m0, s30, 0x8000
s_nop 0
v_mfma_f32_16x16x32_bf16 v[172:175], v[224:227], v[104:107], v[172:175]
v_mfma_f32_16x16x32_bf16 v[172:175], v[228:231], v[108:111], v[172:175]
s_waitcnt lgkmcnt(2)
buffer_load_dwordx4 v251, s[12:15], s28 offen offset:0 lds
v_mfma_f32_16x16x32_bf16 v[176:179], v[232:235], v[8:11], v[176:179]
ds_read_b128 v[224:227], v248 offset:8192
v_mfma_f32_16x16x32_bf16 v[176:179], v[236:239], v[12:15], v[176:179]
buffer_load_dwordx4 v251, s[12:15], s28 offen offset:1024 lds
v_mfma_f32_16x16x32_bf16 v[180:183], v[232:235], v[40:43], v[180:183]
v_mfma_f32_16x16x32_bf16 v[180:183], v[236:239], v[44:47], v[180:183]
buffer_load_dwordx4 v251, s[12:15], s28 offen offset:2048 lds
v_mfma_f32_16x16x32_bf16 v[184:187], v[232:235], v[72:75], v[184:187]
ds_read_b128 v[228:231], v248 offset:8704
v_mfma_f32_16x16x32_bf16 v[184:187], v[236:239], v[76:79], v[184:187]
buffer_load_dwordx4 v251, s[12:15], s28 offen offset:3072 lds
v_mfma_f32_16x16x32_bf16 v[188:191], v[232:235], v[104:107], v[188:191]
v_mfma_f32_16x16x32_bf16 v[188:191], v[236:239], v[108:111], v[188:191]
s_waitcnt lgkmcnt(2)
v_mfma_f32_16x16x32_bf16 v[192:195], v[240:243], v[8:11], v[192:195]
ds_read_b128 v[232:235], v248 offset:10240
v_mfma_f32_16x16x32_bf16 v[192:195], v[244:247], v[12:15], v[192:195]
v_mfma_f32_16x16x32_bf16 v[196:199], v[240:243], v[40:43], v[196:199]
v_mfma_f32_16x16x32_bf16 v[196:199], v[244:247], v[44:47], v[196:199]
v_mfma_f32_16x16x32_bf16 v[200:203], v[240:243], v[72:75], v[200:203]
ds_read_b128 v[236:239], v248 offset:10752
v_mfma_f32_16x16x32_bf16 v[200:203], v[244:247], v[76:79], v[200:203]
v_mfma_f32_16x16x32_bf16 v[204:207], v[240:243], v[104:107], v[204:207]
v_mfma_f32_16x16x32_bf16 v[204:207], v[244:247], v[108:111], v[204:207]
s_waitcnt lgkmcnt(2)
s_waitcnt vmcnt(14)
v_mfma_f32_16x16x32_bf16 v[160:163], v[224:227], v[16:19], v[160:163]
ds_read_b128 v[240:243], v248 offset:24576
v_mfma_f32_16x16x32_bf16 v[160:163], v[228:231], v[20:23], v[160:163]
s_add_u32 s28, s28, 0x4000
s_add_u32 m0, s30, 0xc000
s_nop 0
v_mfma_f32_16x16x32_bf16 v[164:167], v[224:227], v[48:51], v[164:167]
v_mfma_f32_16x16x32_bf16 v[164:167], v[228:231], v[52:55], v[164:167]
buffer_load_dwordx4 v251, s[12:15], s28 offen offset:0 lds
v_mfma_f32_16x16x32_bf16 v[168:171], v[224:227], v[80:83], v[168:171]
ds_read_b128 v[244:247], v248 offset:25088
v_mfma_f32_16x16x32_bf16 v[168:171], v[228:231], v[84:87], v[168:171]
buffer_load_dwordx4 v251, s[12:15], s28 offen offset:1024 lds
v_mfma_f32_16x16x32_bf16 v[172:175], v[224:227], v[112:115], v[172:175]
v_mfma_f32_16x16x32_bf16 v[172:175], v[228:231], v[116:119], v[172:175]
s_waitcnt lgkmcnt(2)
buffer_load_dwordx4 v251, s[12:15], s28 offen offset:2048 lds
v_mfma_f32_16x16x32_bf16 v[176:179], v[232:235], v[16:19], v[176:179]
ds_read_b128 v[224:227], v248 offset:12288
v_mfma_f32_16x16x32_bf16 v[176:179], v[236:239], v[20:23], v[176:179]
buffer_load_dwordx4 v251, s[12:15], s28 offen offset:3072 lds
v_mfma_f32_16x16x32_bf16 v[180:183], v[232:235], v[48:51], v[180:183]
v_mfma_f32_16x16x32_bf16 v[180:183], v[236:239], v[52:55], v[180:183]
v_mfma_f32_16x16x32_bf16 v[184:187], v[232:235], v[80:83], v[184:187]
ds_read_b128 v[228:231], v248 offset:12800
v_mfma_f32_16x16x32_bf16 v[184:187], v[236:239], v[84:87], v[184:187]
v_mfma_f32_16x16x32_bf16 v[188:191], v[232:235], v[112:115], v[188:191]
v_mfma_f32_16x16x32_bf16 v[188:191], v[236:239], v[116:119], v[188:191]
s_waitcnt lgkmcnt(2)
v_mfma_f32_16x16x32_bf16 v[192:195], v[240:243], v[16:19], v[192:195]
ds_read_b128 v[232:235], v248 offset:14336
v_mfma_f32_16x16x32_bf16 v[192:195], v[244:247], v[20:23], v[192:195]
v_mfma_f32_16x16x32_bf16 v[196:199], v[240:243], v[48:51], v[196:199]
v_mfma_f32_16x16x32_bf16 v[196:199], v[244:247], v[52:55], v[196:199]
v_mfma_f32_16x16x32_bf16 v[200:203], v[240:243], v[80:83], v[200:203]
ds_read_b128 v[236:239], v248 offset:14848
v_mfma_f32_16x16x32_bf16 v[200:203], v[244:247], v[84:87], v[200:203]
v_mfma_f32_16x16x32_bf16 v[204:207], v[240:243], v[112:115], v[204:207]
v_mfma_f32_16x16x32_bf16 v[204:207], v[244:247], v[116:119], v[204:207]
s_waitcnt lgkmcnt(2)
s_waitcnt vmcnt(10)
v_mfma_f32_16x16x32_bf16 v[160:163], v[224:227], v[24:27], v[160:163]
ds_read_b128 v[240:243], v248 offset:28672
v_mfma_f32_16x16x32_bf16 v[160:163], v[228:231], v[28:31], v[160:163]
s_add_u32 s28, s28, 0x4000
s_add_u32 m0, s30, 0x10000
s_nop 0
v_mfma_f32_16x16x32_bf16 v[164:167], v[224:227], v[56:59], v[164:167]
v_mfma_f32_16x16x32_bf16 v[164:167], v[228:231], v[60:63], v[164:167]
buffer_load_dwordx4 v251, s[12:15], s28 offen offset:0 lds
v_mfma_f32_16x16x32_bf16 v[168:171], v[224:227], v[88:91], v[168:171]
ds_read_b128 v[244:247], v248 offset:29184
v_mfma_f32_16x16x32_bf16 v[168:171], v[228:231], v[92:95], v[168:171]
buffer_load_dwordx4 v251, s[12:15], s28 offen offset:1024 lds
v_mfma_f32_16x16x32_bf16 v[172:175], v[224:227], v[120:123], v[172:175]
v_mfma_f32_16x16x32_bf16 v[172:175], v[228:231], v[124:127], v[172:175]
s_waitcnt lgkmcnt(2)
buffer_load_dwordx4 v251, s[12:15], s28 offen offset:2048 lds
v_mfma_f32_16x16x32_bf16 v[176:179], v[232:235], v[24:27], v[176:179]
v_mfma_f32_16x16x32_bf16 v[176:179], v[236:239], v[28:31], v[176:179]
buffer_load_dwordx4 v251, s[12:15], s28 offen offset:3072 lds
v_mfma_f32_16x16x32_bf16 v[180:183], v[232:235], v[56:59], v[180:183]
v_mfma_f32_16x16x32_bf16 v[180:183], v[236:239], v[60:63], v[180:183]
v_mfma_f32_16x16x32_bf16 v[184:187], v[232:235], v[88:91], v[184:187]
v_mfma_f32_16x16x32_bf16 v[184:187], v[236:239], v[92:95], v[184:187]
v_mfma_f32_16x16x32_bf16 v[188:191], v[232:235], v[120:123], v[188:191]
v_mfma_f32_16x16x32_bf16 v[188:191], v[236:239], v[124:127], v[188:191]
s_waitcnt lgkmcnt(0)
v_mfma_f32_16x16x32_bf16 v[192:195], v[240:243], v[24:27], v[192:195]
v_mfma_f32_16x16x32_bf16 v[192:195], v[244:247], v[28:31], v[192:195]
v_mfma_f32_16x16x32_bf16 v[196:199], v[240:243], v[56:59], v[196:199]
v_mfma_f32_16x16x32_bf16 v[196:199], v[244:247], v[60:63], v[196:199]
v_mfma_f32_16x16x32_bf16 v[200:203], v[240:243], v[88:91], v[200:203]
v_mfma_f32_16x16x32_bf16 v[200:203], v[244:247], v[92:95], v[200:203]
v_mfma_f32_16x16x32_bf16 v[204:207], v[240:243], v[120:123], v[204:207]
v_mfma_f32_16x16x32_bf16 v[204:207], v[244:247], v[124:127], v[204:207]
s_nop 3
v_max3_f32 v224, v160, v161, v162
v_max3_f32 v225, v164, v165, v166
v_max3_f32 v226, v168, v169, v170
v_max3_f32 v227, v172, v173, v174
v_max3_f32 v224, v224, v163, v176
v_max3_f32 v225, v225, v167, v180
v_max3_f32 v226, v226, v171, v184
v_max3_f32 v227, v227, v175, v188
v_max3_f32 v224, v224, v177, v178
v_max3_f32 v225, v225, v181, v182
v_max3_f32 v226, v226, v185, v186
v_max3_f32 v227, v227, v189, v190
v_max_f32 v224, v224, v179
v_max_f32 v225, v225, v183
v_max_f32 v226, v226, v187
v_max_f32 v227, v227, v191
s_add_u32 s28, s28, 0x4000
s_xor_b32 s30, s30, 0x10000
v_mov_b32 v228, v224
v_mov_b32 v229, v225
v_mov_b32 v230, v226
v_mov_b32 v231, v227
v_permlane32_swap_b32 v224, v228
v_permlane32_swap_b32 v225, v229
v_permlane32_swap_b32 v226, v230
v_permlane32_swap_b32 v227, v231
v_max_f32 v224, v224, v228
v_max_f32 v225, v225, v229
v_max_f32 v226, v226, v230
v_max_f32 v227, v227, v231
v_mov_b32 v228, v224
v_mov_b32 v229, v225
v_mov_b32 v230, v226
v_mov_b32 v231, v227
v_permlane16_swap_b32 v224, v228
v_permlane16_swap_b32 v225, v229
v_permlane16_swap_b32 v226, v230
v_permlane16_swap_b32 v227, v231
v_max_f32 v224, v224, v228
v_max_f32 v225, v225, v229
v_max_f32 v226, v226, v230
v_max_f32 v227, v227, v231
s_waitcnt vmcnt(8)
s_barrier
ds_read_b128 v[232:235], v248 offset:18432
ds_read_b128 v[236:239], v248 offset:18944
ds_read_b128 v[240:243], v248 offset:22528
ds_read_b128 v[244:247], v248 offset:23040
v_cvt_pk_bf16_f32 v228, -v224, -v224
v_cvt_pk_bf16_f32 v229, -v225, -v225
v_cvt_pk_bf16_f32 v230, -v226, -v226
v_cvt_pk_bf16_f32 v231, -v227, -v227
v_lshlrev_b32 v253, 2, v252
v_lshlrev_b32 v147, 16, v228
v_lshlrev_b32 v151, 16, v229
v_lshlrev_b32 v155, 16, v230
v_lshlrev_b32 v159, 16, v231
s_mov_b64 exec, 0xffff
v_bfi_b32 v0, s32, v228, v0
v_bfi_b32 v32, s32, v229, v32
v_bfi_b32 v64, s32, v230, v64
v_bfi_b32 v96, s32, v231, v96
v_xor_b32 v224, 0x80000000, v147
v_xor_b32 v225, 0x80000000, v151
v_xor_b32 v226, 0x80000000, v155
v_xor_b32 v227, 0x80000000, v159
s_xor_b32 s35, s48, 0
buffer_store_dword v224, v253, s[24:27], s35 offen offset:0 sc1
s_xor_b32 s35, s48, 1024
buffer_store_dword v225, v253, s[24:27], s35 offen offset:0 sc1
s_xor_b32 s35, s48, 2048
buffer_store_dword v226, v253, s[24:27], s35 offen offset:0 sc1
s_xor_b32 s35, s48, 3072
buffer_store_dword v227, v253, s[24:27], s35 offen offset:0 sc1
s_mov_b64 exec, -1
s_waitcnt lgkmcnt(2)
v_mfma_f32_16x16x32_bf16 v[208:211], v[232:235], v[0:3], 0
ds_read_b128 v[224:227], v248 offset:26624
v_add_f32 v192, v192, v147
v_add_f32 v193, v193, v147
v_add_f32 v194, v194, v147
v_mfma_f32_16x16x32_bf16 v[208:211], v[236:239], v[4:7], v[208:211]
v_add_f32 v195, v195, v147
v_exp_f32 v192, v192
v_mfma_f32_16x16x32_bf16 v[212:215], v[232:235], v[32:35], 0
v_exp_f32 v193, v193
v_exp_f32 v194, v194
v_mfma_f32_16x16x32_bf16 v[212:215], v[236:239], v[36:39], v[212:215]
v_exp_f32 v195, v195
v_add_f32 v196, v196, v151
v_add_f32 v197, v197, v151
v_mfma_f32_16x16x32_bf16 v[216:219], v[232:235], v[64:67], 0
ds_read_b128 v[228:231], v248 offset:27136
v_cvt_pk_bf16_f32 v144, v192, v193
v_cvt_pk_bf16_f32 v145, v194, v195
v_add_f32 v198, v198, v151
v_mfma_f32_16x16x32_bf16 v[216:219], v[236:239], v[68:71], v[216:219]
v_add_f32 v199, v199, v151
v_exp_f32 v196, v196
v_mfma_f32_16x16x32_bf16 v[220:223], v[232:235], v[96:99], 0
v_exp_f32 v197, v197
v_exp_f32 v198, v198
v_mfma_f32_16x16x32_bf16 v[220:223], v[236:239], v[100:103], v[220:223]
s_waitcnt lgkmcnt(2)
v_exp_f32 v199, v199
v_cvt_pk_bf16_f32 v148, v196, v197
v_mfma_f32_16x16x32_bf16 v[208:211], v[240:243], v[8:11], v[208:211]
ds_read_b128 v[232:235], v248 offset:30720
v_cvt_pk_bf16_f32 v149, v198, v199
v_add_f32 v200, v200, v155
v_add_f32 v201, v201, v155
v_mfma_f32_16x16x32_bf16 v[208:211], v[244:247], v[12:15], v[208:211]
v_add_f32 v202, v202, v155
v_add_f32 v203, v203, v155
v_exp_f32 v200, v200
v_mfma_f32_16x16x32_bf16 v[212:215], v[240:243], v[40:43], v[212:215]
v_exp_f32 v201, v201
v_exp_f32 v202, v202
v_mfma_f32_16x16x32_bf16 v[212:215], v[244:247], v[44:47], v[212:215]
v_exp_f32 v203, v203
v_add_f32 v204, v204, v159
v_add_f32 v205, v205, v159
v_mfma_f32_16x16x32_bf16 v[216:219], v[240:243], v[72:75], v[216:219]
ds_read_b128 v[236:239], v248 offset:31232
v_cvt_pk_bf16_f32 v152, v200, v201
v_cvt_pk_bf16_f32 v153, v202, v203
v_add_f32 v206, v206, v159
v_mfma_f32_16x16x32_bf16 v[216:219], v[244:247], v[76:79], v[216:219]
v_add_f32 v207, v207, v159
v_exp_f32 v204, v204
v_mfma_f32_16x16x32_bf16 v[220:223], v[240:243], v[104:107], v[220:223]
v_exp_f32 v205, v205
v_exp_f32 v206, v206
v_mfma_f32_16x16x32_bf16 v[220:223], v[244:247], v[108:111], v[220:223]
s_waitcnt lgkmcnt(2)
v_exp_f32 v207, v207
v_cvt_pk_bf16_f32 v156, v204, v205
v_mfma_f32_16x16x32_bf16 v[208:211], v[224:227], v[16:19], v[208:211]
ds_read_b128 v[240:243], v248 offset:32768
v_cvt_pk_bf16_f32 v157, v206, v207
v_add_f32 v160, v160, v147
v_add_f32 v161, v161, v147
v_mfma_f32_16x16x32_bf16 v[208:211], v[228:231], v[20:23], v[208:211]
v_add_f32 v162, v162, v147
v_add_f32 v163, v163, v147
v_exp_f32 v160, v160
v_mfma_f32_16x16x32_bf16 v[212:215], v[224:227], v[48:51], v[212:215]
v_exp_f32 v161, v161
v_exp_f32 v162, v162
v_mfma_f32_16x16x32_bf16 v[212:215], v[228:231], v[52:55], v[212:215]
v_exp_f32 v163, v163
v_add_f32 v164, v164, v151
v_add_f32 v165, v165, v151
v_mfma_f32_16x16x32_bf16 v[216:219], v[224:227], v[80:83], v[216:219]
ds_read_b128 v[244:247], v248 offset:33280
v_cvt_pk_bf16_f32 v128, v160, v161
v_cvt_pk_bf16_f32 v129, v162, v163
v_add_f32 v166, v166, v151
v_mfma_f32_16x16x32_bf16 v[216:219], v[228:231], v[84:87], v[216:219]
v_add_f32 v167, v167, v151
v_exp_f32 v164, v164
v_mfma_f32_16x16x32_bf16 v[220:223], v[224:227], v[112:115], v[220:223]
v_exp_f32 v165, v165
v_exp_f32 v166, v166
v_mfma_f32_16x16x32_bf16 v[220:223], v[228:231], v[116:119], v[220:223]
s_waitcnt lgkmcnt(2)
v_exp_f32 v167, v167
v_cvt_pk_bf16_f32 v132, v164, v165
v_mfma_f32_16x16x32_bf16 v[208:211], v[232:235], v[24:27], v[208:211]
ds_read_b128 v[224:227], v248 offset:36864
v_cvt_pk_bf16_f32 v133, v166, v167
v_add_f32 v168, v168, v155
v_add_f32 v169, v169, v155
v_mfma_f32_16x16x32_bf16 v[208:211], v[236:239], v[28:31], v[208:211]
v_add_f32 v170, v170, v155
v_add_f32 v171, v171, v155
v_exp_f32 v168, v168
v_mfma_f32_16x16x32_bf16 v[212:215], v[232:235], v[56:59], v[212:215]
v_exp_f32 v169, v169
v_exp_f32 v170, v170
v_mfma_f32_16x16x32_bf16 v[212:215], v[236:239], v[60:63], v[212:215]
v_exp_f32 v171, v171
v_add_f32 v172, v172, v159
v_add_f32 v173, v173, v159
v_mfma_f32_16x16x32_bf16 v[216:219], v[232:235], v[88:91], v[216:219]
ds_read_b128 v[228:231], v248 offset:37376
v_cvt_pk_bf16_f32 v136, v168, v169
v_cvt_pk_bf16_f32 v137, v170, v171
v_add_f32 v174, v174, v159
v_mfma_f32_16x16x32_bf16 v[216:219], v[236:239], v[92:95], v[216:219]
v_add_f32 v175, v175, v159
v_exp_f32 v172, v172
v_mfma_f32_16x16x32_bf16 v[220:223], v[232:235], v[120:123], v[220:223]
v_exp_f32 v173, v173
v_exp_f32 v174, v174
v_mfma_f32_16x16x32_bf16 v[220:223], v[236:239], v[124:127], v[220:223]
s_waitcnt lgkmcnt(2)
v_exp_f32 v175, v175
v_cvt_pk_bf16_f32 v140, v172, v173
v_mfma_f32_16x16x32_bf16 v[192:195], v[240:243], v[0:3], 0
ds_read_b128 v[232:235], v248 offset:40960
v_cvt_pk_bf16_f32 v141, v174, v175
v_add_f32 v176, v176, v147
v_add_f32 v177, v177, v147
v_mfma_f32_16x16x32_bf16 v[192:195], v[244:247], v[4:7], v[192:195]
v_add_f32 v178, v178, v147
v_add_f32 v179, v179, v147
v_exp_f32 v176, v176
v_mfma_f32_16x16x32_bf16 v[196:199], v[240:243], v[32:35], 0
v_exp_f32 v177, v177
v_exp_f32 v178, v178
v_mfma_f32_16x16x32_bf16 v[196:199], v[244:247], v[36:39], v[196:199]
v_exp_f32 v179, v179
v_add_f32 v180, v180, v151
v_add_f32 v181, v181, v151
v_mfma_f32_16x16x32_bf16 v[200:203], v[240:243], v[64:67], 0
ds_read_b128 v[236:239], v248 offset:41472
v_cvt_pk_bf16_f32 v130, v176, v177
v_cvt_pk_bf16_f32 v131, v178, v179
v_add_f32 v182, v182, v151
v_mfma_f32_16x16x32_bf16 v[200:203], v[244:247], v[68:71], v[200:203]
v_add_f32 v183, v183, v151
v_exp_f32 v180, v180
v_mfma_f32_16x16x32_bf16 v[204:207], v[240:243], v[96:99], 0
v_exp_f32 v181, v181
v_exp_f32 v182, v182
v_mfma_f32_16x16x32_bf16 v[204:207], v[244:247], v[100:103], v[204:207]
s_waitcnt lgkmcnt(2)
v_exp_f32 v183, v183
v_cvt_pk_bf16_f32 v134, v180, v181
v_mfma_f32_16x16x32_bf16 v[192:195], v[224:227], v[8:11], v[192:195]
ds_read_b128 v[240:243], v248 offset:45056
v_cvt_pk_bf16_f32 v135, v182, v183
v_add_f32 v184, v184, v155
v_add_f32 v185, v185, v155
v_mfma_f32_16x16x32_bf16 v[192:195], v[228:231], v[12:15], v[192:195]
v_add_f32 v186, v186, v155
v_add_f32 v187, v187, v155
v_exp_f32 v184, v184
v_mfma_f32_16x16x32_bf16 v[196:199], v[224:227], v[40:43], v[196:199]
v_exp_f32 v185, v185
v_exp_f32 v186, v186
v_mfma_f32_16x16x32_bf16 v[196:199], v[228:231], v[44:47], v[196:199]
v_exp_f32 v187, v187
v_add_f32 v188, v188, v159
v_add_f32 v189, v189, v159
v_mfma_f32_16x16x32_bf16 v[200:203], v[224:227], v[72:75], v[200:203]
ds_read_b128 v[244:247], v248 offset:45568
v_cvt_pk_bf16_f32 v138, v184, v185
v_cvt_pk_bf16_f32 v139, v186, v187
v_add_f32 v190, v190, v159
v_mfma_f32_16x16x32_bf16 v[200:203], v[228:231], v[76:79], v[200:203]
v_add_f32 v191, v191, v159
v_exp_f32 v188, v188
v_mfma_f32_16x16x32_bf16 v[204:207], v[224:227], v[104:107], v[204:207]
v_exp_f32 v189, v189
v_exp_f32 v190, v190
v_mfma_f32_16x16x32_bf16 v[204:207], v[228:231], v[108:111], v[204:207]
s_waitcnt lgkmcnt(2)
v_exp_f32 v191, v191
v_cvt_pk_bf16_f32 v142, v188, v189
v_mfma_f32_16x16x32_bf16 v[192:195], v[232:235], v[16:19], v[192:195]
ds_read_b64_tr_b16 v[224:225], v249 offset:0
v_cvt_pk_bf16_f32 v143, v190, v191
v_exp_f32 v208, v208
v_mfma_f32_16x16x32_bf16 v[192:195], v[236:239], v[20:23], v[192:195]
v_exp_f32 v209, v209
v_exp_f32 v210, v210
v_mfma_f32_16x16x32_bf16 v[196:199], v[232:235], v[48:51], v[196:199]
ds_read_b64_tr_b16 v[226:227], v249 offset:2048
v_exp_f32 v211, v211
v_cvt_pk_bf16_f32 v146, v208, v209
v_mfma_f32_16x16x32_bf16 v[196:199], v[236:239], v[52:55], v[196:199]
v_cvt_pk_bf16_f32 v147, v210, v211
v_exp_f32 v212, v212
v_mfma_f32_16x16x32_bf16 v[200:203], v[232:235], v[80:83], v[200:203]
ds_read_b64_tr_b16 v[228:229], v249 offset:16384
v_exp_f32 v213, v213
v_mfma_f32_16x16x32_bf16 v[200:203], v[236:239], v[84:87], v[200:203]
v_exp_f32 v214, v214
v_exp_f32 v215, v215
v_mfma_f32_16x16x32_bf16 v[204:207], v[232:235], v[112:115], v[204:207]
ds_read_b64_tr_b16 v[230:231], v249 offset:18432
v_cvt_pk_bf16_f32 v150, v212, v213
v_cvt_pk_bf16_f32 v151, v214, v215
v_mfma_f32_16x16x32_bf16 v[204:207], v[236:239], v[116:119], v[204:207]
s_waitcnt lgkmcnt(4)
v_exp_f32 v216, v216
v_mfma_f32_16x16x32_bf16 v[192:195], v[240:243], v[24:27], v[192:195]
ds_read_b64_tr_b16 v[232:233], v250 offset:0
v_exp_f32 v217, v217
v_mfma_f32_16x16x32_bf16 v[192:195], v[244:247], v[28:31], v[192:195]
v_exp_f32 v218, v218
v_exp_f32 v219, v219
v_mfma_f32_16x16x32_bf16 v[196:199], v[240:243], v[56:59], v[196:199]
ds_read_b64_tr_b16 v[234:235], v250 offset:2048
v_cvt_pk_bf16_f32 v154, v216, v217
v_cvt_pk_bf16_f32 v155, v218, v219
v_mfma_f32_16x16x32_bf16 v[196:199], v[244:247], v[60:63], v[196:199]
v_exp_f32 v220, v220
v_exp_f32 v221, v221
v_mfma_f32_16x16x32_bf16 v[200:203], v[240:243], v[88:91], v[200:203]
ds_read_b64_tr_b16 v[236:237], v250 offset:16384
v_exp_f32 v222, v222
v_cvt_pk_bf16_f32 v158, v220, v221
v_mfma_f32_16x16x32_bf16 v[200:203], v[244:247], v[92:95], v[200:203]
v_exp_f32 v223, v223
v_mfma_f32_16x16x32_bf16 v[204:207], v[240:243], v[120:123], v[204:207]
ds_read_b64_tr_b16 v[238:239], v250 offset:18432
v_cvt_pk_bf16_f32 v159, v222, v223
v_mfma_f32_16x16x32_bf16 v[204:207], v[244:247], v[124:127], v[204:207]
s_cmp_eq_u32 s50, 1
s_cselect_b32 s40, 0x7fff0000, s40
s_cselect_b32 s44, 0x7fff0000, s44
.p2align 6
L2_loop:
s_waitcnt lgkmcnt(4)
v_mfma_f32_16x16x32_bf16 a[0:3], v[224:227], v[128:131], a[0:3]
ds_read_b64_tr_b16 v[240:241], v249 offset:512
v_mfma_f32_16x16x32_bf16 a[0:3], v[228:231], v[144:147], a[0:3]
v_mfma_f32_16x16x32_bf16 a[4:7], v[224:227], v[132:135], a[4:7]
ds_read_b64_tr_b16 v[242:243], v249 offset:2560
v_mfma_f32_16x16x32_bf16 a[4:7], v[228:231], v[148:151], a[4:7]
v_exp_f32 v192, v192
v_mfma_f32_16x16x32_bf16 a[8:11], v[224:227], v[136:139], a[8:11]
ds_read_b64_tr_b16 v[244:245], v249 offset:16896
v_mfma_f32_16x16x32_bf16 a[8:11], v[228:231], v[152:155], a[8:11]
v_exp_f32 v193, v193
v_mfma_f32_16x16x32_bf16 a[12:15], v[224:227], v[140:143], a[12:15]
ds_read_b64_tr_b16 v[246:247], v249 offset:18944
v_cvt_pk_bf16_f32 v160, v192, v193
v_mfma_f32_16x16x32_bf16 a[12:15], v[228:231], v[156:159], a[12:15]
s_waitcnt lgkmcnt(4)
v_mfma_f32_16x16x32_bf16 a[16:19], v[232:235], v[128:131], a[16:19]
ds_read_b64_tr_b16 v[176:177], v250 offset:512
v_mfma_f32_16x16x32_bf16 a[16:19], v[236:239], v[144:147], a[16:19]
v_exp_f32 v194, v194
v_mfma_f32_16x16x32_bf16 a[20:23], v[232:235], v[132:135], a[20:23]
ds_read_b64_tr_b16 v[178:179], v250 offset:2560
v_mfma_f32_16x16x32_bf16 a[20:23], v[236:239], v[148:151], a[20:23]
v_exp_f32 v195, v195
v_mfma_f32_16x16x32_bf16 a[24:27], v[232:235], v[136:139], a[24:27]
ds_read_b64_tr_b16 v[180:181], v250 offset:16896
v_cvt_pk_bf16_f32 v161, v194, v195
v_mfma_f32_16x16x32_bf16 a[24:27], v[236:239], v[152:155], a[24:27]
v_exp_f32 v196, v196
v_mfma_f32_16x16x32_bf16 a[28:31], v[232:235], v[140:143], a[28:31]
ds_read_b64_tr_b16 v[182:183], v250 offset:18944
v_mfma_f32_16x16x32_bf16 a[28:31], v[236:239], v[156:159], a[28:31]
s_waitcnt lgkmcnt(4)
v_mfma_f32_16x16x32_bf16 a[32:35], v[240:243], v[128:131], a[32:35]
ds_read_b128 v[224:227], v248 offset:34816
v_mfma_f32_16x16x32_bf16 a[32:35], v[244:247], v[144:147], a[32:35]
v_exp_f32 v197, v197
v_mfma_f32_16x16x32_bf16 a[36:39], v[240:243], v[132:135], a[36:39]
v_exp_f32 v198, v198
v_mfma_f32_16x16x32_bf16 a[36:39], v[244:247], v[148:151], a[36:39]
v_exp_f32 v199, v199
v_mfma_f32_16x16x32_bf16 a[40:43], v[240:243], v[136:139], a[40:43]
ds_read_b128 v[228:231], v248 offset:35328
v_cvt_pk_bf16_f32 v164, v196, v197
v_mfma_f32_16x16x32_bf16 a[40:43], v[244:247], v[152:155], a[40:43]
v_cvt_pk_bf16_f32 v165, v198, v199
v_mfma_f32_16x16x32_bf16 a[44:47], v[240:243], v[140:143], a[44:47]
v_exp_f32 v200, v200
v_mfma_f32_16x16x32_bf16 a[44:47], v[244:247], v[156:159], a[44:47]
s_waitcnt lgkmcnt(2)
v_mfma_f32_16x16x32_bf16 a[48:51], v[176:179], v[128:131], a[48:51]
ds_read_b128 v[232:235], v248 offset:38912
v_mfma_f32_16x16x32_bf16 a[48:51], v[180:183], v[144:147], a[48:51]
v_exp_f32 v201, v201
v_mfma_f32_16x16x32_bf16 a[52:55], v[176:179], v[132:135], a[52:55]
v_exp_f32 v202, v202
v_mfma_f32_16x16x32_bf16 a[52:55], v[180:183], v[148:151], a[52:55]
v_exp_f32 v203, v203
v_mfma_f32_16x16x32_bf16 a[56:59], v[176:179], v[136:139], a[56:59]
ds_read_b128 v[236:239], v248 offset:39424
v_cvt_pk_bf16_f32 v168, v200, v201
v_mfma_f32_16x16x32_bf16 a[56:59], v[180:183], v[152:155], a[56:59]
v_cvt_pk_bf16_f32 v169, v202, v203
v_mfma_f32_16x16x32_bf16 a[60:63], v[176:179], v[140:143], a[60:63]
v_exp_f32 v204, v204
v_mfma_f32_16x16x32_bf16 a[60:63], v[180:183], v[156:159], a[60:63]
s_waitcnt lgkmcnt(2)
v_mfma_f32_16x16x32_bf16 v[208:211], v[224:227], v[0:3], 0
ds_read_b128 v[240:243], v248 offset:43008
v_mfma_f32_16x16x32_bf16 v[208:211], v[228:231], v[4:7], v[208:211]
v_exp_f32 v205, v205
v_mfma_f32_16x16x32_bf16 v[212:215], v[224:227], v[32:35], 0
v_exp_f32 v206, v206
v_mfma_f32_16x16x32_bf16 v[212:215], v[228:231], v[36:39], v[212:215]
v_exp_f32 v207, v207
v_mfma_f32_16x16x32_bf16 v[216:219], v[224:227], v[64:67], 0
ds_read_b128 v[244:247], v248 offset:43520
v_cvt_pk_bf16_f32 v172, v204, v205
v_mfma_f32_16x16x32_bf16 v[216:219], v[228:231], v[68:71], v[216:219]
v_cvt_pk_bf16_f32 v173, v206, v207
v_mfma_f32_16x16x32_bf16 v[220:223], v[224:227], v[96:99], 0
v_mfma_f32_16x16x32_bf16 v[220:223], v[228:231], v[100:103], v[220:223]
s_waitcnt lgkmcnt(2)
v_mfma_f32_16x16x32_bf16 v[208:211], v[232:235], v[8:11], v[208:211]
ds_read_b128 v[176:179], v248 offset:47104
v_mfma_f32_16x16x32_bf16 v[208:211], v[236:239], v[12:15], v[208:211]
v_mfma_f32_16x16x32_bf16 v[212:215], v[232:235], v[40:43], v[212:215]
v_mfma_f32_16x16x32_bf16 v[212:215], v[236:239], v[44:47], v[212:215]
v_mfma_f32_16x16x32_bf16 v[216:219], v[232:235], v[72:75], v[216:219]
ds_read_b128 v[180:183], v248 offset:47616
v_mfma_f32_16x16x32_bf16 v[216:219], v[236:239], v[76:79], v[216:219]
v_mfma_f32_16x16x32_bf16 v[220:223], v[232:235], v[104:107], v[220:223]
v_mfma_f32_16x16x32_bf16 v[220:223], v[236:239], v[108:111], v[220:223]
s_waitcnt lgkmcnt(2)
v_mfma_f32_16x16x32_bf16 v[208:211], v[240:243], v[16:19], v[208:211]
ds_read_b64_tr_b16 v[224:225], v249 offset:4096
v_mfma_f32_16x16x32_bf16 v[208:211], v[244:247], v[20:23], v[208:211]
v_mfma_f32_16x16x32_bf16 v[212:215], v[240:243], v[48:51], v[212:215]
ds_read_b64_tr_b16 v[226:227], v249 offset:6144
v_mfma_f32_16x16x32_bf16 v[212:215], v[244:247], v[52:55], v[212:215]
v_mfma_f32_16x16x32_bf16 v[216:219], v[240:243], v[80:83], v[216:219]
ds_read_b64_tr_b16 v[228:229], v249 offset:20480
v_mfma_f32_16x16x32_bf16 v[216:219], v[244:247], v[84:87], v[216:219]
v_mfma_f32_16x16x32_bf16 v[220:223], v[240:243], v[112:115], v[220:223]
ds_read_b64_tr_b16 v[230:231], v249 offset:22528
v_mfma_f32_16x16x32_bf16 v[220:223], v[244:247], v[116:119], v[220:223]
s_waitcnt lgkmcnt(4)
v_mfma_f32_16x16x32_bf16 v[208:211], v[176:179], v[24:27], v[208:211]
ds_read_b64_tr_b16 v[232:233], v250 offset:4096
v_mfma_f32_16x16x32_bf16 v[208:211], v[180:183], v[28:31], v[208:211]
v_mfma_f32_16x16x32_bf16 v[212:215], v[176:179], v[56:59], v[212:215]
ds_read_b64_tr_b16 v[234:235], v250 offset:6144
v_mfma_f32_16x16x32_bf16 v[212:215], v[180:183], v[60:63], v[212:215]
v_mfma_f32_16x16x32_bf16 v[216:219], v[176:179], v[88:91], v[216:219]
ds_read_b64_tr_b16 v[236:237], v250 offset:20480
v_mfma_f32_16x16x32_bf16 v[216:219], v[180:183], v[92:95], v[216:219]
v_mfma_f32_16x16x32_bf16 v[220:223], v[176:179], v[120:123], v[220:223]
ds_read_b64_tr_b16 v[238:239], v250 offset:22528
v_mfma_f32_16x16x32_bf16 v[220:223], v[180:183], v[124:127], v[220:223]
s_waitcnt lgkmcnt(4)
v_mfma_f32_16x16x32_bf16 a[64:67], v[224:227], v[128:131], a[64:67]
ds_read_b64_tr_b16 v[240:241], v249 offset:4608
v_mfma_f32_16x16x32_bf16 a[64:67], v[228:231], v[144:147], a[64:67]
v_mfma_f32_16x16x32_bf16 a[68:71], v[224:227], v[132:135], a[68:71]
ds_read_b64_tr_b16 v[242:243], v249 offset:6656
v_mfma_f32_16x16x32_bf16 a[68:71], v[228:231], v[148:151], a[68:71]
v_exp_f32 v208, v208
v_mfma_f32_16x16x32_bf16 a[72:75], v[224:227], v[136:139], a[72:75]
ds_read_b64_tr_b16 v[244:245], v249 offset:20992
v_mfma_f32_16x16x32_bf16 a[72:75], v[228:231], v[152:155], a[72:75]
v_exp_f32 v209, v209
v_mfma_f32_16x16x32_bf16 a[76:79], v[224:227], v[140:143], a[76:79]
ds_read_b64_tr_b16 v[246:247], v249 offset:23040
v_cvt_pk_bf16_f32 v162, v208, v209
v_mfma_f32_16x16x32_bf16 a[76:79], v[228:231], v[156:159], a[76:79]
s_waitcnt lgkmcnt(4)
s_waitcnt vmcnt(0)
s_barrier
s_add_u32 m0, s30, 0x4000
v_mfma_f32_16x16x32_bf16 a[80:83], v[232:235], v[128:131], a[80:83]
ds_read_b64_tr_b16 v[224:225], v250 offset:4608
v_mfma_f32_16x16x32_bf16 a[80:83], v[236:239], v[144:147], a[80:83]
buffer_load_dwordx4 v251, s[12:15], s28 offen offset:0 lds
v_mfma_f32_16x16x32_bf16 a[84:87], v[232:235], v[132:135], a[84:87]
ds_read_b64_tr_b16 v[226:227], v250 offset:6656
v_mfma_f32_16x16x32_bf16 a[84:87], v[236:239], v[148:151], a[84:87]
v_exp_f32 v210, v210
v_mfma_f32_16x16x32_bf16 a[88:91], v[232:235], v[136:139], a[88:91]
ds_read_b64_tr_b16 v[228:229], v250 offset:20992
v_mfma_f32_16x16x32_bf16 a[88:91], v[236:239], v[152:155], a[88:91]
v_exp_f32 v211, v211
v_mfma_f32_16x16x32_bf16 a[92:95], v[232:235], v[140:143], a[92:95]
ds_read_b64_tr_b16 v[230:231], v250 offset:23040
v_cvt_pk_bf16_f32 v163, v210, v211
v_mfma_f32_16x16x32_bf16 a[92:95], v[236:239], v[156:159], a[92:95]
s_waitcnt lgkmcnt(4)
v_mfma_f32_16x16x32_bf16 a[96:99], v[240:243], v[128:131], a[96:99]
ds_read_b128 v[232:235], v248 offset:49152
v_mfma_f32_16x16x32_bf16 a[96:99], v[244:247], v[144:147], a[96:99]
buffer_load_dwordx4 v251, s[12:15], s28 offen offset:1024 lds
v_mfma_f32_16x16x32_bf16 a[100:103], v[240:243], v[132:135], a[100:103]
v_exp_f32 v212, v212
v_mfma_f32_16x16x32_bf16 a[100:103], v[244:247], v[148:151], a[100:103]
v_exp_f32 v213, v213
v_mfma_f32_16x16x32_bf16 a[104:107], v[240:243], v[136:139], a[104:107]
ds_read_b128 v[236:239], v248 offset:49664
v_cvt_pk_bf16_f32 v166, v212, v213
v_mfma_f32_16x16x32_bf16 a[104:107], v[244:247], v[152:155], a[104:107]
v_exp_f32 v214, v214
v_mfma_f32_16x16x32_bf16 a[108:111], v[240:243], v[140:143], a[108:111]
v_exp_f32 v215, v215
v_mfma_f32_16x16x32_bf16 a[108:111], v[244:247], v[156:159], a[108:111]
s_waitcnt lgkmcnt(2)
v_cvt_pk_bf16_f32 v167, v214, v215
v_mfma_f32_16x16x32_bf16 a[112:115], v[224:227], v[128:131], a[112:115]
ds_read_b128 v[240:243], v248 offset:53248
v_mfma_f32_16x16x32_bf16 a[112:115], v[228:231], v[144:147], a[112:115]
buffer_load_dwordx4 v251, s[12:15], s28 offen offset:2048 lds
v_mfma_f32_16x16x32_bf16 a[116:119], v[224:227], v[132:135], a[116:119]
v_exp_f32 v216, v216
v_mfma_f32_16x16x32_bf16 a[116:119], v[228:231], v[148:151], a[116:119]
v_exp_f32 v217, v217
v_mfma_f32_16x16x32_bf16 a[120:123], v[224:227], v[136:139], a[120:123]
ds_read_b128 v[244:247], v248 offset:53760
v_cvt_pk_bf16_f32 v170, v216, v217
v_mfma_f32_16x16x32_bf16 a[120:123], v[228:231], v[152:155], a[120:123]
v_exp_f32 v218, v218
v_mfma_f32_16x16x32_bf16 a[124:127], v[224:227], v[140:143], a[124:127]
v_exp_f32 v219, v219
v_mfma_f32_16x16x32_bf16 a[124:127], v[228:231], v[156:159], a[124:127]
s_waitcnt lgkmcnt(2)
v_cvt_pk_bf16_f32 v171, v218, v219
v_mfma_f32_16x16x32_bf16 v[192:195], v[232:235], v[0:3], 0
ds_read_b128 v[224:227], v248 offset:57344
v_mfma_f32_16x16x32_bf16 v[192:195], v[236:239], v[4:7], v[192:195]
buffer_load_dwordx4 v251, s[12:15], s28 offen offset:3072 lds
v_mfma_f32_16x16x32_bf16 v[196:199], v[232:235], v[32:35], 0
v_exp_f32 v220, v220
v_mfma_f32_16x16x32_bf16 v[196:199], v[236:239], v[36:39], v[196:199]
s_add_u32 s28, s28, 0x4000
v_mfma_f32_16x16x32_bf16 v[200:203], v[232:235], v[64:67], 0
ds_read_b128 v[228:231], v248 offset:57856
v_mfma_f32_16x16x32_bf16 v[200:203], v[236:239], v[68:71], v[200:203]
v_exp_f32 v221, v221
v_mfma_f32_16x16x32_bf16 v[204:207], v[232:235], v[96:99], 0
v_exp_f32 v222, v222
v_mfma_f32_16x16x32_bf16 v[204:207], v[236:239], v[100:103], v[204:207]
s_waitcnt lgkmcnt(2)
s_add_u32 m0, s30, 0x8000
v_mfma_f32_16x16x32_bf16 v[192:195], v[240:243], v[8:11], v[192:195]
ds_read_b128 v[232:235], v248 offset:61440
v_cvt_pk_bf16_f32 v174, v220, v221
v_mfma_f32_16x16x32_bf16 v[192:195], v[244:247], v[12:15], v[192:195]
buffer_load_dwordx4 v251, s[12:15], s28 offen offset:0 lds
v_mfma_f32_16x16x32_bf16 v[196:199], v[240:243], v[40:43], v[196:199]
v_exp_f32 v223, v223
v_mfma_f32_16x16x32_bf16 v[196:199], v[244:247], v[44:47], v[196:199]
v_mfma_f32_16x16x32_bf16 v[200:203], v[240:243], v[72:75], v[200:203]
ds_read_b128 v[236:239], v248 offset:61952
v_cvt_pk_bf16_f32 v175, v222, v223
v_mfma_f32_16x16x32_bf16 v[200:203], v[244:247], v[76:79], v[200:203]
v_mfma_f32_16x16x32_bf16 v[204:207], v[240:243], v[104:107], v[204:207]
v_mfma_f32_16x16x32_bf16 v[204:207], v[244:247], v[108:111], v[204:207]
s_waitcnt lgkmcnt(2)
v_mfma_f32_16x16x32_bf16 v[192:195], v[224:227], v[16:19], v[192:195]
ds_read_b64_tr_b16 v[240:241], v249 offset:8192
v_mfma_f32_16x16x32_bf16 v[192:195], v[228:231], v[20:23], v[192:195]
buffer_load_dwordx4 v251, s[12:15], s28 offen offset:1024 lds
v_mfma_f32_16x16x32_bf16 v[196:199], v[224:227], v[48:51], v[196:199]
ds_read_b64_tr_b16 v[242:243], v249 offset:10240
v_mfma_f32_16x16x32_bf16 v[196:199], v[228:231], v[52:55], v[196:199]
v_mfma_f32_16x16x32_bf16 v[200:203], v[224:227], v[80:83], v[200:203]
ds_read_b64_tr_b16 v[244:245], v249 offset:24576
v_mfma_f32_16x16x32_bf16 v[200:203], v[228:231], v[84:87], v[200:203]
v_mfma_f32_16x16x32_bf16 v[204:207], v[224:227], v[112:115], v[204:207]
ds_read_b64_tr_b16 v[246:247], v249 offset:26624
v_mfma_f32_16x16x32_bf16 v[204:207], v[228:231], v[116:119], v[204:207]
s_waitcnt lgkmcnt(4)
v_mfma_f32_16x16x32_bf16 v[192:195], v[232:235], v[24:27], v[192:195]
ds_read_b64_tr_b16 v[224:225], v250 offset:8192
v_mfma_f32_16x16x32_bf16 v[192:195], v[236:239], v[28:31], v[192:195]
buffer_load_dwordx4 v251, s[12:15], s28 offen offset:2048 lds
v_mfma_f32_16x16x32_bf16 v[196:199], v[232:235], v[56:59], v[196:199]
ds_read_b64_tr_b16 v[226:227], v250 offset:10240
v_mfma_f32_16x16x32_bf16 v[196:199], v[236:239], v[60:63], v[196:199]
v_mfma_f32_16x16x32_bf16 v[200:203], v[232:235], v[88:91], v[200:203]
ds_read_b64_tr_b16 v[228:229], v250 offset:24576
v_mfma_f32_16x16x32_bf16 v[200:203], v[236:239], v[92:95], v[200:203]
v_mfma_f32_16x16x32_bf16 v[204:207], v[232:235], v[120:123], v[204:207]
ds_read_b64_tr_b16 v[230:231], v250 offset:26624
v_mfma_f32_16x16x32_bf16 v[204:207], v[236:239], v[124:127], v[204:207]
s_waitcnt lgkmcnt(4)
v_mfma_f32_16x16x32_bf16 a[128:131], v[240:243], v[128:131], a[128:131]
ds_read_b64_tr_b16 v[232:233], v249 offset:8704
v_mfma_f32_16x16x32_bf16 a[128:131], v[244:247], v[144:147], a[128:131]
buffer_load_dwordx4 v251, s[12:15], s28 offen offset:3072 lds
v_mfma_f32_16x16x32_bf16 a[132:135], v[240:243], v[132:135], a[132:135]
ds_read_b64_tr_b16 v[234:235], v249 offset:10752
v_mfma_f32_16x16x32_bf16 a[132:135], v[244:247], v[148:151], a[132:135]
s_add_u32 s28, s28, 0x4000
v_mfma_f32_16x16x32_bf16 a[136:139], v[240:243], v[136:139], a[136:139]
ds_read_b64_tr_b16 v[236:237], v249 offset:25088
v_mfma_f32_16x16x32_bf16 a[136:139], v[244:247], v[152:155], a[136:139]
v_exp_f32 v192, v192
v_mfma_f32_16x16x32_bf16 a[140:143], v[240:243], v[140:143], a[140:143]
ds_read_b64_tr_b16 v[238:239], v249 offset:27136
v_mfma_f32_16x16x32_bf16 a[140:143], v[244:247], v[156:159], a[140:143]
s_waitcnt lgkmcnt(4)
v_mfma_f32_16x16x32_bf16 a[144:147], v[224:227], v[128:131], a[144:147]
ds_read_b64_tr_b16 v[240:241], v250 offset:8704
v_mfma_f32_16x16x32_bf16 a[144:147], v[228:231], v[144:147], a[144:147]
v_exp_f32 v193, v193
v_mfma_f32_16x16x32_bf16 a[148:151], v[224:227], v[132:135], a[148:151]
ds_read_b64_tr_b16 v[242:243], v250 offset:10752
v_cvt_pk_bf16_f32 v176, v192, v193
v_mfma_f32_16x16x32_bf16 a[148:151], v[228:231], v[148:151], a[148:151]
v_exp_f32 v194, v194
v_mfma_f32_16x16x32_bf16 a[152:155], v[224:227], v[136:139], a[152:155]
ds_read_b64_tr_b16 v[244:245], v250 offset:25088
v_mfma_f32_16x16x32_bf16 a[152:155], v[228:231], v[152:155], a[152:155]
v_exp_f32 v195, v195
v_mfma_f32_16x16x32_bf16 a[156:159], v[224:227], v[140:143], a[156:159]
ds_read_b64_tr_b16 v[246:247], v250 offset:27136
v_cvt_pk_bf16_f32 v177, v194, v195
v_mfma_f32_16x16x32_bf16 a[156:159], v[228:231], v[156:159], a[156:159]
s_waitcnt lgkmcnt(4)
v_mfma_f32_16x16x32_bf16 a[160:163], v[232:235], v[128:131], a[160:163]
ds_read_b128 v[224:227], v248 offset:51200
v_mfma_f32_16x16x32_bf16 a[160:163], v[236:239], v[144:147], a[160:163]
v_exp_f32 v196, v196
v_mfma_f32_16x16x32_bf16 a[164:167], v[232:235], v[132:135], a[164:167]
v_exp_f32 v197, v197
v_mfma_f32_16x16x32_bf16 a[164:167], v[236:239], v[148:151], a[164:167]
v_exp_f32 v198, v198
v_mfma_f32_16x16x32_bf16 a[168:171], v[232:235], v[136:139], a[168:171]
ds_read_b128 v[228:231], v248 offset:51712
v_cvt_pk_bf16_f32 v180, v196, v197
v_mfma_f32_16x16x32_bf16 a[168:171], v[236:239], v[152:155], a[168:171]
v_exp_f32 v199, v199
v_mfma_f32_16x16x32_bf16 a[172:175], v[232:235], v[140:143], a[172:175]
v_exp_f32 v200, v200
v_mfma_f32_16x16x32_bf16 a[172:175], v[236:239], v[156:159], a[172:175]
s_waitcnt lgkmcnt(2)
v_cvt_pk_bf16_f32 v181, v198, v199
v_mfma_f32_16x16x32_bf16 a[176:179], v[240:243], v[128:131], a[176:179]
ds_read_b128 v[232:235], v248 offset:55296
v_mfma_f32_16x16x32_bf16 a[176:179], v[244:247], v[144:147], a[176:179]
v_exp_f32 v201, v201
v_mfma_f32_16x16x32_bf16 a[180:183], v[240:243], v[132:135], a[180:183]
v_exp_f32 v202, v202
v_mfma_f32_16x16x32_bf16 a[180:183], v[244:247], v[148:151], a[180:183]
v_exp_f32 v203, v203
v_mfma_f32_16x16x32_bf16 a[184:187], v[240:243], v[136:139], a[184:187]
ds_read_b128 v[236:239], v248 offset:55808
v_cvt_pk_bf16_f32 v184, v200, v201
v_mfma_f32_16x16x32_bf16 a[184:187], v[244:247], v[152:155], a[184:187]
v_cvt_pk_bf16_f32 v185, v202, v203
v_mfma_f32_16x16x32_bf16 a[188:191], v[240:243], v[140:143], a[188:191]
v_exp_f32 v204, v204
v_mfma_f32_16x16x32_bf16 a[188:191], v[244:247], v[156:159], a[188:191]
s_waitcnt lgkmcnt(2)
v_mfma_f32_16x16x32_bf16 v[208:211], v[224:227], v[0:3], 0
ds_read_b128 v[240:243], v248 offset:59392
v_mfma_f32_16x16x32_bf16 v[208:211], v[228:231], v[4:7], v[208:211]
v_exp_f32 v205, v205
v_mfma_f32_16x16x32_bf16 v[212:215], v[224:227], v[32:35], 0
v_exp_f32 v206, v206
v_mfma_f32_16x16x32_bf16 v[212:215], v[228:231], v[36:39], v[212:215]
v_exp_f32 v207, v207
v_mfma_f32_16x16x32_bf16 v[216:219], v[224:227], v[64:67], 0
ds_read_b128 v[244:247], v248 offset:59904
v_cvt_pk_bf16_f32 v188, v204, v205
v_mfma_f32_16x16x32_bf16 v[216:219], v[228:231], v[68:71], v[216:219]
v_cvt_pk_bf16_f32 v189, v206, v207
v_mfma_f32_16x16x32_bf16 v[220:223], v[224:227], v[96:99], 0
v_mfma_f32_16x16x32_bf16 v[220:223], v[228:231], v[100:103], v[220:223]
s_waitcnt lgkmcnt(2)
v_mfma_f32_16x16x32_bf16 v[208:211], v[232:235], v[8:11], v[208:211]
ds_read_b128 v[224:227], v248 offset:63488
v_mfma_f32_16x16x32_bf16 v[208:211], v[236:239], v[12:15], v[208:211]
v_mfma_f32_16x16x32_bf16 v[212:215], v[232:235], v[40:43], v[212:215]
v_mfma_f32_16x16x32_bf16 v[212:215], v[236:239], v[44:47], v[212:215]
v_mfma_f32_16x16x32_bf16 v[216:219], v[232:235], v[72:75], v[216:219]
ds_read_b128 v[228:231], v248 offset:64000
v_mfma_f32_16x16x32_bf16 v[216:219], v[236:239], v[76:79], v[216:219]
v_mfma_f32_16x16x32_bf16 v[220:223], v[232:235], v[104:107], v[220:223]
v_mfma_f32_16x16x32_bf16 v[220:223], v[236:239], v[108:111], v[220:223]
s_waitcnt lgkmcnt(2)
v_mfma_f32_16x16x32_bf16 v[208:211], v[240:243], v[16:19], v[208:211]
ds_read_b64_tr_b16 v[232:233], v249 offset:12288
v_mfma_f32_16x16x32_bf16 v[208:211], v[244:247], v[20:23], v[208:211]
v_mfma_f32_16x16x32_bf16 v[212:215], v[240:243], v[48:51], v[212:215]
ds_read_b64_tr_b16 v[234:235], v249 offset:14336
v_mfma_f32_16x16x32_bf16 v[212:215], v[244:247], v[52:55], v[212:215]
v_mfma_f32_16x16x32_bf16 v[216:219], v[240:243], v[80:83], v[216:219]
ds_read_b64_tr_b16 v[236:237], v249 offset:28672
v_mfma_f32_16x16x32_bf16 v[216:219], v[244:247], v[84:87], v[216:219]
v_mfma_f32_16x16x32_bf16 v[220:223], v[240:243], v[112:115], v[220:223]
ds_read_b64_tr_b16 v[238:239], v249 offset:30720
v_mfma_f32_16x16x32_bf16 v[220:223], v[244:247], v[116:119], v[220:223]
s_waitcnt lgkmcnt(4)
v_mfma_f32_16x16x32_bf16 v[208:211], v[224:227], v[24:27], v[208:211]
ds_read_b64_tr_b16 v[240:241], v250 offset:12288
v_mfma_f32_16x16x32_bf16 v[208:211], v[228:231], v[28:31], v[208:211]
v_mfma_f32_16x16x32_bf16 v[212:215], v[224:227], v[56:59], v[212:215]
ds_read_b64_tr_b16 v[242:243], v250 offset:14336
v_mfma_f32_16x16x32_bf16 v[212:215], v[228:231], v[60:63], v[212:215]
v_mfma_f32_16x16x32_bf16 v[216:219], v[224:227], v[88:91], v[216:219]
ds_read_b64_tr_b16 v[244:245], v250 offset:28672
v_mfma_f32_16x16x32_bf16 v[216:219], v[228:231], v[92:95], v[216:219]
v_mfma_f32_16x16x32_bf16 v[220:223], v[224:227], v[120:123], v[220:223]
ds_read_b64_tr_b16 v[246:247], v250 offset:30720
v_xor_b32 v248, 0x10000, v248
v_mfma_f32_16x16x32_bf16 v[220:223], v[228:231], v[124:127], v[220:223]
s_waitcnt lgkmcnt(4)
v_mfma_f32_16x16x32_bf16 a[192:195], v[232:235], v[128:131], a[192:195]
ds_read_b64_tr_b16 v[224:225], v249 offset:12800
v_mfma_f32_16x16x32_bf16 a[192:195], v[236:239], v[144:147], a[192:195]
v_mfma_f32_16x16x32_bf16 a[196:199], v[232:235], v[132:135], a[196:199]
ds_read_b64_tr_b16 v[226:227], v249 offset:14848
v_mfma_f32_16x16x32_bf16 a[196:199], v[236:239], v[148:151], a[196:199]
v_exp_f32 v208, v208
v_mfma_f32_16x16x32_bf16 a[200:203], v[232:235], v[136:139], a[200:203]
ds_read_b64_tr_b16 v[228:229], v249 offset:29184
v_mfma_f32_16x16x32_bf16 a[200:203], v[236:239], v[152:155], a[200:203]
v_exp_f32 v209, v209
v_mfma_f32_16x16x32_bf16 a[204:207], v[232:235], v[140:143], a[204:207]
ds_read_b64_tr_b16 v[230:231], v249 offset:31232
v_cvt_pk_bf16_f32 v178, v208, v209
v_mfma_f32_16x16x32_bf16 a[204:207], v[236:239], v[156:159], a[204:207]
s_waitcnt lgkmcnt(4)
v_mfma_f32_16x16x32_bf16 a[208:211], v[240:243], v[128:131], a[208:211]
ds_read_b64_tr_b16 v[232:233], v250 offset:12800
v_mfma_f32_16x16x32_bf16 a[208:211], v[244:247], v[144:147], a[208:211]
v_exp_f32 v210, v210
v_mfma_f32_16x16x32_bf16 a[212:215], v[240:243], v[132:135], a[212:215]
ds_read_b64_tr_b16 v[234:235], v250 offset:14848
v_mfma_f32_16x16x32_bf16 a[212:215], v[244:247], v[148:151], a[212:215]
v_exp_f32 v211, v211
v_mfma_f32_16x16x32_bf16 a[216:219], v[240:243], v[136:139], a[216:219]
ds_read_b64_tr_b16 v[236:237], v250 offset:29184
v_cvt_pk_bf16_f32 v179, v210, v211
v_mfma_f32_16x16x32_bf16 a[216:219], v[244:247], v[152:155], a[216:219]
v_exp_f32 v212, v212
v_mfma_f32_16x16x32_bf16 a[220:223], v[240:243], v[140:143], a[220:223]
ds_read_b64_tr_b16 v[238:239], v250 offset:31232
v_mfma_f32_16x16x32_bf16 a[220:223], v[244:247], v[156:159], a[220:223]
s_waitcnt lgkmcnt(4)
v_mfma_f32_16x16x32_bf16 a[224:227], v[224:227], v[128:131], a[224:227]
ds_read_b128 v[240:243], v248 offset:0
v_mfma_f32_16x16x32_bf16 a[224:227], v[228:231], v[144:147], a[224:227]
v_exp_f32 v213, v213
v_mfma_f32_16x16x32_bf16 a[228:231], v[224:227], v[132:135], a[228:231]
v_exp_f32 v214, v214
v_mfma_f32_16x16x32_bf16 a[228:231], v[228:231], v[148:151], a[228:231]
v_exp_f32 v215, v215
v_mfma_f32_16x16x32_bf16 a[232:235], v[224:227], v[136:139], a[232:235]
ds_read_b128 v[244:247], v248 offset:512
v_cvt_pk_bf16_f32 v182, v212, v213
v_mfma_f32_16x16x32_bf16 a[232:235], v[228:231], v[152:155], a[232:235]
v_cvt_pk_bf16_f32 v183, v214, v215
v_mfma_f32_16x16x32_bf16 a[236:239], v[224:227], v[140:143], a[236:239]
v_exp_f32 v216, v216
v_mfma_f32_16x16x32_bf16 a[236:239], v[228:231], v[156:159], a[236:239]
s_waitcnt lgkmcnt(2)
v_mfma_f32_16x16x32_bf16 a[240:243], v[232:235], v[128:131], a[240:243]
ds_read_b128 v[224:227], v248 offset:4096
v_mfma_f32_16x16x32_bf16 a[240:243], v[236:239], v[144:147], a[240:243]
v_exp_f32 v217, v217
v_mfma_f32_16x16x32_bf16 a[244:247], v[232:235], v[132:135], a[244:247]
v_exp_f32 v218, v218
v_mfma_f32_16x16x32_bf16 a[244:247], v[236:239], v[148:151], a[244:247]
v_exp_f32 v219, v219
v_mfma_f32_16x16x32_bf16 a[248:251], v[232:235], v[136:139], a[248:251]
ds_read_b128 v[228:231], v248 offset:4608
v_cvt_pk_bf16_f32 v186, v216, v217
v_mfma_f32_16x16x32_bf16 a[248:251], v[236:239], v[152:155], a[248:251]
v_cvt_pk_bf16_f32 v187, v218, v219
v_mfma_f32_16x16x32_bf16 a[252:255], v[232:235], v[140:143], a[252:255]
v_exp_f32 v220, v220
v_mfma_f32_16x16x32_bf16 a[252:255], v[236:239], v[156:159], a[252:255]
s_waitcnt lgkmcnt(2)
v_mfma_f32_16x16x32_bf16 v[192:195], v[240:243], v[0:3], 0
ds_read_b128 v[232:235], v248 offset:8192
v_mfma_f32_16x16x32_bf16 v[192:195], v[244:247], v[4:7], v[192:195]
v_exp_f32 v221, v221
v_mfma_f32_16x16x32_bf16 v[196:199], v[240:243], v[32:35], 0
v_exp_f32 v222, v222
v_mfma_f32_16x16x32_bf16 v[196:199], v[244:247], v[36:39], v[196:199]
v_exp_f32 v223, v223
v_mfma_f32_16x16x32_bf16 v[200:203], v[240:243], v[64:67], 0
ds_read_b128 v[236:239], v248 offset:8704
v_cvt_pk_bf16_f32 v190, v220, v221
v_mfma_f32_16x16x32_bf16 v[200:203], v[244:247], v[68:71], v[200:203]
v_cvt_pk_bf16_f32 v191, v222, v223
v_mfma_f32_16x16x32_bf16 v[204:207], v[240:243], v[96:99], 0
v_mfma_f32_16x16x32_bf16 v[204:207], v[244:247], v[100:103], v[204:207]
s_waitcnt lgkmcnt(2)
v_mfma_f32_16x16x32_bf16 v[192:195], v[224:227], v[8:11], v[192:195]
ds_read_b128 v[240:243], v248 offset:12288
v_mfma_f32_16x16x32_bf16 v[192:195], v[228:231], v[12:15], v[192:195]
v_mfma_f32_16x16x32_bf16 v[196:199], v[224:227], v[40:43], v[196:199]
v_mfma_f32_16x16x32_bf16 v[196:199], v[228:231], v[44:47], v[196:199]
v_mfma_f32_16x16x32_bf16 v[200:203], v[224:227], v[72:75], v[200:203]
ds_read_b128 v[244:247], v248 offset:12800
v_mfma_f32_16x16x32_bf16 v[200:203], v[228:231], v[76:79], v[200:203]
v_mfma_f32_16x16x32_bf16 v[204:207], v[224:227], v[104:107], v[204:207]
v_mfma_f32_16x16x32_bf16 v[204:207], v[228:231], v[108:111], v[204:207]
s_waitcnt lgkmcnt(2)
v_mfma_f32_16x16x32_bf16 v[192:195], v[232:235], v[16:19], v[192:195]
ds_read_b64_tr_b16 v[224:225], v249 offset:32768
v_mfma_f32_16x16x32_bf16 v[192:195], v[236:239], v[20:23], v[192:195]
v_mfma_f32_16x16x32_bf16 v[196:199], v[232:235], v[48:51], v[196:199]
ds_read_b64_tr_b16 v[226:227], v249 offset:34816
v_mfma_f32_16x16x32_bf16 v[196:199], v[236:239], v[52:55], v[196:199]
v_mfma_f32_16x16x32_bf16 v[200:203], v[232:235], v[80:83], v[200:203]
ds_read_b64_tr_b16 v[228:229], v249 offset:49152
v_mfma_f32_16x16x32_bf16 v[200:203], v[236:239], v[84:87], v[200:203]
v_mfma_f32_16x16x32_bf16 v[204:207], v[232:235], v[112:115], v[204:207]
ds_read_b64_tr_b16 v[230:231], v249 offset:51200
v_mfma_f32_16x16x32_bf16 v[204:207], v[236:239], v[116:119], v[204:207]
s_waitcnt lgkmcnt(4)
v_mfma_f32_16x16x32_bf16 v[192:195], v[240:243], v[24:27], v[192:195]
ds_read_b64_tr_b16 v[232:233], v250 offset:32768
v_mfma_f32_16x16x32_bf16 v[192:195], v[244:247], v[28:31], v[192:195]
v_mfma_f32_16x16x32_bf16 v[196:199], v[240:243], v[56:59], v[196:199]
ds_read_b64_tr_b16 v[234:235], v250 offset:34816
v_mfma_f32_16x16x32_bf16 v[196:199], v[244:247], v[60:63], v[196:199]
v_mfma_f32_16x16x32_bf16 v[200:203], v[240:243], v[88:91], v[200:203]
ds_read_b64_tr_b16 v[236:237], v250 offset:49152
v_mfma_f32_16x16x32_bf16 v[200:203], v[244:247], v[92:95], v[200:203]
s_sub_u32 s31, s31, 1
v_mfma_f32_16x16x32_bf16 v[204:207], v[240:243], v[120:123], v[204:207]
ds_read_b64_tr_b16 v[238:239], v250 offset:51200
v_mfma_f32_16x16x32_bf16 v[204:207], v[244:247], v[124:127], v[204:207]
s_cbranch_scc1 L2_tail_1
s_waitcnt lgkmcnt(4)
v_mfma_f32_16x16x32_bf16 a[0:3], v[224:227], v[160:163], a[0:3]
ds_read_b64_tr_b16 v[240:241], v249 offset:33280
v_mfma_f32_16x16x32_bf16 a[0:3], v[228:231], v[176:179], a[0:3]
v_mfma_f32_16x16x32_bf16 a[4:7], v[224:227], v[164:167], a[4:7]
ds_read_b64_tr_b16 v[242:243], v249 offset:35328
v_mfma_f32_16x16x32_bf16 a[4:7], v[228:231], v[180:183], a[4:7]
v_exp_f32 v192, v192
v_mfma_f32_16x16x32_bf16 a[8:11], v[224:227], v[168:171], a[8:11]
ds_read_b64_tr_b16 v[244:245], v249 offset:49664
v_mfma_f32_16x16x32_bf16 a[8:11], v[228:231], v[184:187], a[8:11]
v_exp_f32 v193, v193
v_mfma_f32_16x16x32_bf16 a[12:15], v[224:227], v[172:175], a[12:15]
ds_read_b64_tr_b16 v[246:247], v249 offset:51712
v_cvt_pk_bf16_f32 v128, v192, v193
v_mfma_f32_16x16x32_bf16 a[12:15], v[228:231], v[188:191], a[12:15]
s_waitcnt lgkmcnt(4)
v_mfma_f32_16x16x32_bf16 a[16:19], v[232:235], v[160:163], a[16:19]
ds_read_b64_tr_b16 v[144:145], v250 offset:33280
v_mfma_f32_16x16x32_bf16 a[16:19], v[236:239], v[176:179], a[16:19]
v_exp_f32 v194, v194
v_mfma_f32_16x16x32_bf16 a[20:23], v[232:235], v[164:167], a[20:23]
ds_read_b64_tr_b16 v[146:147], v250 offset:35328
v_mfma_f32_16x16x32_bf16 a[20:23], v[236:239], v[180:183], a[20:23]
v_exp_f32 v195, v195
v_mfma_f32_16x16x32_bf16 a[24:27], v[232:235], v[168:171], a[24:27]
ds_read_b64_tr_b16 v[148:149], v250 offset:49664
v_cvt_pk_bf16_f32 v129, v194, v195
v_mfma_f32_16x16x32_bf16 a[24:27], v[236:239], v[184:187], a[24:27]
v_exp_f32 v196, v196
v_mfma_f32_16x16x32_bf16 a[28:31], v[232:235], v[172:175], a[28:31]
ds_read_b64_tr_b16 v[150:151], v250 offset:51712
v_mfma_f32_16x16x32_bf16 a[28:31], v[236:239], v[188:191], a[28:31]
s_waitcnt lgkmcnt(4)
v_mfma_f32_16x16x32_bf16 a[32:35], v[240:243], v[160:163], a[32:35]
ds_read_b128 v[224:227], v248 offset:2048
v_mfma_f32_16x16x32_bf16 a[32:35], v[244:247], v[176:179], a[32:35]
v_exp_f32 v197, v197
v_mfma_f32_16x16x32_bf16 a[36:39], v[240:243], v[164:167], a[36:39]
v_exp_f32 v198, v198
v_mfma_f32_16x16x32_bf16 a[36:39], v[244:247], v[180:183], a[36:39]
v_exp_f32 v199, v199
v_mfma_f32_16x16x32_bf16 a[40:43], v[240:243], v[168:171], a[40:43]
ds_read_b128 v[228:231], v248 offset:2560
v_cvt_pk_bf16_f32 v132, v196, v197
v_mfma_f32_16x16x32_bf16 a[40:43], v[244:247], v[184:187], a[40:43]
v_cvt_pk_bf16_f32 v133, v198, v199
v_mfma_f32_16x16x32_bf16 a[44:47], v[240:243], v[172:175], a[44:47]
v_exp_f32 v200, v200
v_mfma_f32_16x16x32_bf16 a[44:47], v[244:247], v[188:191], a[44:47]
s_waitcnt lgkmcnt(2)
v_mfma_f32_16x16x32_bf16 a[48:51], v[144:147], v[160:163], a[48:51]
ds_read_b128 v[232:235], v248 offset:6144
v_mfma_f32_16x16x32_bf16 a[48:51], v[148:151], v[176:179], a[48:51]
v_exp_f32 v201, v201
v_mfma_f32_16x16x32_bf16 a[52:55], v[144:147], v[164:167], a[52:55]
v_exp_f32 v202, v202
v_mfma_f32_16x16x32_bf16 a[52:55], v[148:151], v[180:183], a[52:55]
v_exp_f32 v203, v203
v_mfma_f32_16x16x32_bf16 a[56:59], v[144:147], v[168:171], a[56:59]
ds_read_b128 v[236:239], v248 offset:6656
v_cvt_pk_bf16_f32 v136, v200, v201
v_mfma_f32_16x16x32_bf16 a[56:59], v[148:151], v[184:187], a[56:59]
v_cvt_pk_bf16_f32 v137, v202, v203
v_mfma_f32_16x16x32_bf16 a[60:63], v[144:147], v[172:175], a[60:63]
v_exp_f32 v204, v204
v_mfma_f32_16x16x32_bf16 a[60:63], v[148:151], v[188:191], a[60:63]
s_waitcnt lgkmcnt(2)
v_mfma_f32_16x16x32_bf16 v[208:211], v[224:227], v[0:3], 0
ds_read_b128 v[240:243], v248 offset:10240
v_mfma_f32_16x16x32_bf16 v[208:211], v[228:231], v[4:7], v[208:211]
v_exp_f32 v205, v205
v_mfma_f32_16x16x32_bf16 v[212:215], v[224:227], v[32:35], 0
v_exp_f32 v206, v206
v_mfma_f32_16x16x32_bf16 v[212:215], v[228:231], v[36:39], v[212:215]
v_exp_f32 v207, v207
v_mfma_f32_16x16x32_bf16 v[216:219], v[224:227], v[64:67], 0
ds_read_b128 v[244:247], v248 offset:10752
v_cvt_pk_bf16_f32 v140, v204, v205
v_mfma_f32_16x16x32_bf16 v[216:219], v[228:231], v[68:71], v[216:219]
v_cvt_pk_bf16_f32 v141, v206, v207
v_mfma_f32_16x16x32_bf16 v[220:223], v[224:227], v[96:99], 0
v_mfma_f32_16x16x32_bf16 v[220:223], v[228:231], v[100:103], v[220:223]
s_waitcnt lgkmcnt(2)
v_mfma_f32_16x16x32_bf16 v[208:211], v[232:235], v[8:11], v[208:211]
ds_read_b128 v[144:147], v248 offset:14336
v_mfma_f32_16x16x32_bf16 v[208:211], v[236:239], v[12:15], v[208:211]
v_mfma_f32_16x16x32_bf16 v[212:215], v[232:235], v[40:43], v[212:215]
v_mfma_f32_16x16x32_bf16 v[212:215], v[236:239], v[44:47], v[212:215]
v_mfma_f32_16x16x32_bf16 v[216:219], v[232:235], v[72:75], v[216:219]
ds_read_b128 v[148:151], v248 offset:14848
v_mfma_f32_16x16x32_bf16 v[216:219], v[236:239], v[76:79], v[216:219]
v_mfma_f32_16x16x32_bf16 v[220:223], v[232:235], v[104:107], v[220:223]
v_mfma_f32_16x16x32_bf16 v[220:223], v[236:239], v[108:111], v[220:223]
s_waitcnt lgkmcnt(2)
v_mfma_f32_16x16x32_bf16 v[208:211], v[240:243], v[16:19], v[208:211]
ds_read_b64_tr_b16 v[224:225], v249 offset:36864
v_mfma_f32_16x16x32_bf16 v[208:211], v[244:247], v[20:23], v[208:211]
v_mfma_f32_16x16x32_bf16 v[212:215], v[240:243], v[48:51], v[212:215]
ds_read_b64_tr_b16 v[226:227], v249 offset:38912
v_mfma_f32_16x16x32_bf16 v[212:215], v[244:247], v[52:55], v[212:215]
v_mfma_f32_16x16x32_bf16 v[216:219], v[240:243], v[80:83], v[216:219]
ds_read_b64_tr_b16 v[228:229], v249 offset:53248
v_mfma_f32_16x16x32_bf16 v[216:219], v[244:247], v[84:87], v[216:219]
v_mfma_f32_16x16x32_bf16 v[220:223], v[240:243], v[112:115], v[220:223]
ds_read_b64_tr_b16 v[230:231], v249 offset:55296
v_mfma_f32_16x16x32_bf16 v[220:223], v[244:247], v[116:119], v[220:223]
s_waitcnt lgkmcnt(4)
v_mfma_f32_16x16x32_bf16 v[208:211], v[144:147], v[24:27], v[208:211]
ds_read_b64_tr_b16 v[232:233], v250 offset:36864
v_mfma_f32_16x16x32_bf16 v[208:211], v[148:151], v[28:31], v[208:211]
v_mfma_f32_16x16x32_bf16 v[212:215], v[144:147], v[56:59], v[212:215]
ds_read_b64_tr_b16 v[234:235], v250 offset:38912
v_mfma_f32_16x16x32_bf16 v[212:215], v[148:151], v[60:63], v[212:215]
v_mfma_f32_16x16x32_bf16 v[216:219], v[144:147], v[88:91], v[216:219]
ds_read_b64_tr_b16 v[236:237], v250 offset:53248
v_mfma_f32_16x16x32_bf16 v[216:219], v[148:151], v[92:95], v[216:219]
v_mfma_f32_16x16x32_bf16 v[220:223], v[144:147], v[120:123], v[220:223]
ds_read_b64_tr_b16 v[238:239], v250 offset:55296
v_mfma_f32_16x16x32_bf16 v[220:223], v[148:151], v[124:127], v[220:223]
s_waitcnt lgkmcnt(4)
v_mfma_f32_16x16x32_bf16 a[64:67], v[224:227], v[160:163], a[64:67]
ds_read_b64_tr_b16 v[240:241], v249 offset:37376
v_mfma_f32_16x16x32_bf16 a[64:67], v[228:231], v[176:179], a[64:67]
v_mfma_f32_16x16x32_bf16 a[68:71], v[224:227], v[164:167], a[68:71]
ds_read_b64_tr_b16 v[242:243], v249 offset:39424
v_mfma_f32_16x16x32_bf16 a[68:71], v[228:231], v[180:183], a[68:71]
v_exp_f32 v208, v208
v_mfma_f32_16x16x32_bf16 a[72:75], v[224:227], v[168:171], a[72:75]
ds_read_b64_tr_b16 v[244:245], v249 offset:53760
v_mfma_f32_16x16x32_bf16 a[72:75], v[228:231], v[184:187], a[72:75]
v_exp_f32 v209, v209
v_mfma_f32_16x16x32_bf16 a[76:79], v[224:227], v[172:175], a[76:79]
ds_read_b64_tr_b16 v[246:247], v249 offset:55808
v_cvt_pk_bf16_f32 v130, v208, v209
v_mfma_f32_16x16x32_bf16 a[76:79], v[228:231], v[188:191], a[76:79]
s_waitcnt lgkmcnt(4)
s_waitcnt vmcnt(0)
s_barrier
s_add_u32 m0, s30, 0xc000
v_mfma_f32_16x16x32_bf16 a[80:83], v[232:235], v[160:163], a[80:83]
ds_read_b64_tr_b16 v[224:225], v250 offset:37376
v_mfma_f32_16x16x32_bf16 a[80:83], v[236:239], v[176:179], a[80:83]
buffer_load_dwordx4 v251, s[12:15], s28 offen offset:0 lds
v_mfma_f32_16x16x32_bf16 a[84:87], v[232:235], v[164:167], a[84:87]
ds_read_b64_tr_b16 v[226:227], v250 offset:39424
v_mfma_f32_16x16x32_bf16 a[84:87], v[236:239], v[180:183], a[84:87]
v_exp_f32 v210, v210
v_mfma_f32_16x16x32_bf16 a[88:91], v[232:235], v[168:171], a[88:91]
ds_read_b64_tr_b16 v[228:229], v250 offset:53760
v_mfma_f32_16x16x32_bf16 a[88:91], v[236:239], v[184:187], a[88:91]
v_exp_f32 v211, v211
v_mfma_f32_16x16x32_bf16 a[92:95], v[232:235], v[172:175], a[92:95]
ds_read_b64_tr_b16 v[230:231], v250 offset:55808
v_cvt_pk_bf16_f32 v131, v210, v211
v_mfma_f32_16x16x32_bf16 a[92:95], v[236:239], v[188:191], a[92:95]
s_waitcnt lgkmcnt(4)
v_mfma_f32_16x16x32_bf16 a[96:99], v[240:243], v[160:163], a[96:99]
ds_read_b128 v[232:235], v248 offset:16384
v_mfma_f32_16x16x32_bf16 a[96:99], v[244:247], v[176:179], a[96:99]
buffer_load_dwordx4 v251, s[12:15], s28 offen offset:1024 lds
v_mfma_f32_16x16x32_bf16 a[100:103], v[240:243], v[164:167], a[100:103]
v_exp_f32 v212, v212
v_mfma_f32_16x16x32_bf16 a[100:103], v[244:247], v[180:183], a[100:103]
v_exp_f32 v213, v213
v_mfma_f32_16x16x32_bf16 a[104:107], v[240:243], v[168:171], a[104:107]
ds_read_b128 v[236:239], v248 offset:16896
v_cvt_pk_bf16_f32 v134, v212, v213
v_mfma_f32_16x16x32_bf16 a[104:107], v[244:247], v[184:187], a[104:107]
v_exp_f32 v214, v214
v_mfma_f32_16x16x32_bf16 a[108:111], v[240:243], v[172:175], a[108:111]
v_exp_f32 v215, v215
v_mfma_f32_16x16x32_bf16 a[108:111], v[244:247], v[188:191], a[108:111]
s_waitcnt lgkmcnt(2)
v_cvt_pk_bf16_f32 v135, v214, v215
v_mfma_f32_16x16x32_bf16 a[112:115], v[224:227], v[160:163], a[112:115]
ds_read_b128 v[240:243], v248 offset:20480
v_mfma_f32_16x16x32_bf16 a[112:115], v[228:231], v[176:179], a[112:115]
buffer_load_dwordx4 v251, s[12:15], s28 offen offset:2048 lds
v_mfma_f32_16x16x32_bf16 a[116:119], v[224:227], v[164:167], a[116:119]
v_exp_f32 v216, v216
v_mfma_f32_16x16x32_bf16 a[116:119], v[228:231], v[180:183], a[116:119]
v_exp_f32 v217, v217
v_mfma_f32_16x16x32_bf16 a[120:123], v[224:227], v[168:171], a[120:123]
ds_read_b128 v[244:247], v248 offset:20992
v_cvt_pk_bf16_f32 v138, v216, v217
v_mfma_f32_16x16x32_bf16 a[120:123], v[228:231], v[184:187], a[120:123]
v_exp_f32 v218, v218
v_mfma_f32_16x16x32_bf16 a[124:127], v[224:227], v[172:175], a[124:127]
v_exp_f32 v219, v219
v_mfma_f32_16x16x32_bf16 a[124:127], v[228:231], v[188:191], a[124:127]
s_waitcnt lgkmcnt(2)
v_cvt_pk_bf16_f32 v139, v218, v219
v_mfma_f32_16x16x32_bf16 v[192:195], v[232:235], v[0:3], 0
ds_read_b128 v[224:227], v248 offset:24576
v_mfma_f32_16x16x32_bf16 v[192:195], v[236:239], v[4:7], v[192:195]
buffer_load_dwordx4 v251, s[12:15], s28 offen offset:3072 lds
v_mfma_f32_16x16x32_bf16 v[196:199], v[232:235], v[32:35], 0
s_xor_b32 s30, s30, 0x10000
v_mfma_f32_16x16x32_bf16 v[196:199], v[236:239], v[36:39], v[196:199]
s_add_u32 s28, s28, 0x4000
v_mfma_f32_16x16x32_bf16 v[200:203], v[232:235], v[64:67], 0
ds_read_b128 v[228:231], v248 offset:25088
v_mfma_f32_16x16x32_bf16 v[200:203], v[236:239], v[68:71], v[200:203]
v_exp_f32 v220, v220
v_mfma_f32_16x16x32_bf16 v[204:207], v[232:235], v[96:99], 0
v_exp_f32 v221, v221
v_mfma_f32_16x16x32_bf16 v[204:207], v[236:239], v[100:103], v[204:207]
s_waitcnt lgkmcnt(2)
s_add_u32 m0, s30, 0x0
v_mfma_f32_16x16x32_bf16 v[192:195], v[240:243], v[8:11], v[192:195]
ds_read_b128 v[232:235], v248 offset:28672
v_cvt_pk_bf16_f32 v142, v220, v221
v_mfma_f32_16x16x32_bf16 v[192:195], v[244:247], v[12:15], v[192:195]
buffer_load_dwordx4 v251, s[12:15], s28 offen offset:0 lds
v_mfma_f32_16x16x32_bf16 v[196:199], v[240:243], v[40:43], v[196:199]
v_exp_f32 v222, v222
v_mfma_f32_16x16x32_bf16 v[196:199], v[244:247], v[44:47], v[196:199]
v_exp_f32 v223, v223
v_mfma_f32_16x16x32_bf16 v[200:203], v[240:243], v[72:75], v[200:203]
ds_read_b128 v[236:239], v248 offset:29184
v_cvt_pk_bf16_f32 v143, v222, v223
v_mfma_f32_16x16x32_bf16 v[200:203], v[244:247], v[76:79], v[200:203]
v_mfma_f32_16x16x32_bf16 v[204:207], v[240:243], v[104:107], v[204:207]
v_mfma_f32_16x16x32_bf16 v[204:207], v[244:247], v[108:111], v[204:207]
s_waitcnt lgkmcnt(2)
v_mfma_f32_16x16x32_bf16 v[192:195], v[224:227], v[16:19], v[192:195]
ds_read_b64_tr_b16 v[240:241], v249 offset:40960
v_mfma_f32_16x16x32_bf16 v[192:195], v[228:231], v[20:23], v[192:195]
buffer_load_dwordx4 v251, s[12:15], s28 offen offset:1024 lds
v_mfma_f32_16x16x32_bf16 v[196:199], v[224:227], v[48:51], v[196:199]
ds_read_b64_tr_b16 v[242:243], v249 offset:43008
v_mfma_f32_16x16x32_bf16 v[196:199], v[228:231], v[52:55], v[196:199]
v_mfma_f32_16x16x32_bf16 v[200:203], v[224:227], v[80:83], v[200:203]
ds_read_b64_tr_b16 v[244:245], v249 offset:57344
v_mfma_f32_16x16x32_bf16 v[200:203], v[228:231], v[84:87], v[200:203]
v_mfma_f32_16x16x32_bf16 v[204:207], v[224:227], v[112:115], v[204:207]
ds_read_b64_tr_b16 v[246:247], v249 offset:59392
v_mfma_f32_16x16x32_bf16 v[204:207], v[228:231], v[116:119], v[204:207]
s_waitcnt lgkmcnt(4)
v_mfma_f32_16x16x32_bf16 v[192:195], v[232:235], v[24:27], v[192:195]
ds_read_b64_tr_b16 v[224:225], v250 offset:40960
v_mfma_f32_16x16x32_bf16 v[192:195], v[236:239], v[28:31], v[192:195]
buffer_load_dwordx4 v251, s[12:15], s28 offen offset:2048 lds
v_mfma_f32_16x16x32_bf16 v[196:199], v[232:235], v[56:59], v[196:199]
ds_read_b64_tr_b16 v[226:227], v250 offset:43008
v_mfma_f32_16x16x32_bf16 v[196:199], v[236:239], v[60:63], v[196:199]
v_mfma_f32_16x16x32_bf16 v[200:203], v[232:235], v[88:91], v[200:203]
ds_read_b64_tr_b16 v[228:229], v250 offset:57344
v_mfma_f32_16x16x32_bf16 v[200:203], v[236:239], v[92:95], v[200:203]
v_mfma_f32_16x16x32_bf16 v[204:207], v[232:235], v[120:123], v[204:207]
ds_read_b64_tr_b16 v[230:231], v250 offset:59392
v_mfma_f32_16x16x32_bf16 v[204:207], v[236:239], v[124:127], v[204:207]
s_waitcnt lgkmcnt(4)
v_mfma_f32_16x16x32_bf16 a[128:131], v[240:243], v[160:163], a[128:131]
ds_read_b64_tr_b16 v[232:233], v249 offset:41472
v_mfma_f32_16x16x32_bf16 a[128:131], v[244:247], v[176:179], a[128:131]
buffer_load_dwordx4 v251, s[12:15], s28 offen offset:3072 lds
v_mfma_f32_16x16x32_bf16 a[132:135], v[240:243], v[164:167], a[132:135]
ds_read_b64_tr_b16 v[234:235], v249 offset:43520
v_mfma_f32_16x16x32_bf16 a[132:135], v[244:247], v[180:183], a[132:135]
s_add_u32 s28, s28, 0x4000
v_mfma_f32_16x16x32_bf16 a[136:139], v[240:243], v[168:171], a[136:139]
ds_read_b64_tr_b16 v[236:237], v249 offset:57856
v_mfma_f32_16x16x32_bf16 a[136:139], v[244:247], v[184:187], a[136:139]
v_exp_f32 v192, v192
v_mfma_f32_16x16x32_bf16 a[140:143], v[240:243], v[172:175], a[140:143]
ds_read_b64_tr_b16 v[238:239], v249 offset:59904
v_mfma_f32_16x16x32_bf16 a[140:143], v[244:247], v[188:191], a[140:143]
s_waitcnt lgkmcnt(4)
v_mfma_f32_16x16x32_bf16 a[144:147], v[224:227], v[160:163], a[144:147]
ds_read_b64_tr_b16 v[240:241], v250 offset:41472
v_mfma_f32_16x16x32_bf16 a[144:147], v[228:231], v[176:179], a[144:147]
v_exp_f32 v193, v193
v_mfma_f32_16x16x32_bf16 a[148:151], v[224:227], v[164:167], a[148:151]
ds_read_b64_tr_b16 v[242:243], v250 offset:43520
v_cvt_pk_bf16_f32 v144, v192, v193
v_mfma_f32_16x16x32_bf16 a[148:151], v[228:231], v[180:183], a[148:151]
v_exp_f32 v194, v194
v_mfma_f32_16x16x32_bf16 a[152:155], v[224:227], v[168:171], a[152:155]
ds_read_b64_tr_b16 v[244:245], v250 offset:57856
v_mfma_f32_16x16x32_bf16 a[152:155], v[228:231], v[184:187], a[152:155]
v_exp_f32 v195, v195
v_mfma_f32_16x16x32_bf16 a[156:159], v[224:227], v[172:175], a[156:159]
ds_read_b64_tr_b16 v[246:247], v250 offset:59904
v_cvt_pk_bf16_f32 v145, v194, v195
v_mfma_f32_16x16x32_bf16 a[156:159], v[228:231], v[188:191], a[156:159]
s_waitcnt lgkmcnt(4)
v_mfma_f32_16x16x32_bf16 a[160:163], v[232:235], v[160:163], a[160:163]
ds_read_b128 v[224:227], v248 offset:18432
v_mfma_f32_16x16x32_bf16 a[160:163], v[236:239], v[176:179], a[160:163]
v_exp_f32 v196, v196
v_mfma_f32_16x16x32_bf16 a[164:167], v[232:235], v[164:167], a[164:167]
v_exp_f32 v197, v197
v_mfma_f32_16x16x32_bf16 a[164:167], v[236:239], v[180:183], a[164:167]
v_exp_f32 v198, v198
v_mfma_f32_16x16x32_bf16 a[168:171], v[232:235], v[168:171], a[168:171]
ds_read_b128 v[228:231], v248 offset:18944
v_cvt_pk_bf16_f32 v148, v196, v197
v_mfma_f32_16x16x32_bf16 a[168:171], v[236:239], v[184:187], a[168:171]
v_exp_f32 v199, v199
v_mfma_f32_16x16x32_bf16 a[172:175], v[232:235], v[172:175], a[172:175]
v_exp_f32 v200, v200
v_mfma_f32_16x16x32_bf16 a[172:175], v[236:239], v[188:191], a[172:175]
s_waitcnt lgkmcnt(2)
v_cvt_pk_bf16_f32 v149, v198, v199
v_mfma_f32_16x16x32_bf16 a[176:179], v[240:243], v[160:163], a[176:179]
ds_read_b128 v[232:235], v248 offset:22528
v_mfma_f32_16x16x32_bf16 a[176:179], v[244:247], v[176:179], a[176:179]
v_exp_f32 v201, v201
v_mfma_f32_16x16x32_bf16 a[180:183], v[240:243], v[164:167], a[180:183]
v_exp_f32 v202, v202
v_mfma_f32_16x16x32_bf16 a[180:183], v[244:247], v[180:183], a[180:183]
v_exp_f32 v203, v203
v_mfma_f32_16x16x32_bf16 a[184:187], v[240:243], v[168:171], a[184:187]
ds_read_b128 v[236:239], v248 offset:23040
v_cvt_pk_bf16_f32 v152, v200, v201
v_mfma_f32_16x16x32_bf16 a[184:187], v[244:247], v[184:187], a[184:187]
v_cvt_pk_bf16_f32 v153, v202, v203
v_mfma_f32_16x16x32_bf16 a[188:191], v[240:243], v[172:175], a[188:191]
v_exp_f32 v204, v204
v_mfma_f32_16x16x32_bf16 a[188:191], v[244:247], v[188:191], a[188:191]
s_waitcnt lgkmcnt(2)
v_mfma_f32_16x16x32_bf16 v[208:211], v[224:227], v[0:3], 0
ds_read_b128 v[240:243], v248 offset:26624
v_mfma_f32_16x16x32_bf16 v[208:211], v[228:231], v[4:7], v[208:211]
v_exp_f32 v205, v205
v_mfma_f32_16x16x32_bf16 v[212:215], v[224:227], v[32:35], 0
v_exp_f32 v206, v206
v_mfma_f32_16x16x32_bf16 v[212:215], v[228:231], v[36:39], v[212:215]
v_exp_f32 v207, v207
v_mfma_f32_16x16x32_bf16 v[216:219], v[224:227], v[64:67], 0
ds_read_b128 v[244:247], v248 offset:27136
v_cvt_pk_bf16_f32 v156, v204, v205
v_mfma_f32_16x16x32_bf16 v[216:219], v[228:231], v[68:71], v[216:219]
v_cvt_pk_bf16_f32 v157, v206, v207
v_mfma_f32_16x16x32_bf16 v[220:223], v[224:227], v[96:99], 0
v_mfma_f32_16x16x32_bf16 v[220:223], v[228:231], v[100:103], v[220:223]
s_waitcnt lgkmcnt(2)
v_mfma_f32_16x16x32_bf16 v[208:211], v[232:235], v[8:11], v[208:211]
ds_read_b128 v[224:227], v248 offset:30720
v_mfma_f32_16x16x32_bf16 v[208:211], v[236:239], v[12:15], v[208:211]
v_mfma_f32_16x16x32_bf16 v[212:215], v[232:235], v[40:43], v[212:215]
v_mfma_f32_16x16x32_bf16 v[212:215], v[236:239], v[44:47], v[212:215]
v_mfma_f32_16x16x32_bf16 v[216:219], v[232:235], v[72:75], v[216:219]
ds_read_b128 v[228:231], v248 offset:31232
v_mfma_f32_16x16x32_bf16 v[216:219], v[236:239], v[76:79], v[216:219]
v_mfma_f32_16x16x32_bf16 v[220:223], v[232:235], v[104:107], v[220:223]
v_mfma_f32_16x16x32_bf16 v[220:223], v[236:239], v[108:111], v[220:223]
s_waitcnt lgkmcnt(2)
v_mfma_f32_16x16x32_bf16 v[208:211], v[240:243], v[16:19], v[208:211]
ds_read_b64_tr_b16 v[232:233], v249 offset:45056
v_mfma_f32_16x16x32_bf16 v[208:211], v[244:247], v[20:23], v[208:211]
v_mfma_f32_16x16x32_bf16 v[212:215], v[240:243], v[48:51], v[212:215]
ds_read_b64_tr_b16 v[234:235], v249 offset:47104
v_mfma_f32_16x16x32_bf16 v[212:215], v[244:247], v[52:55], v[212:215]
v_mfma_f32_16x16x32_bf16 v[216:219], v[240:243], v[80:83], v[216:219]
ds_read_b64_tr_b16 v[236:237], v249 offset:61440
v_mfma_f32_16x16x32_bf16 v[216:219], v[244:247], v[84:87], v[216:219]
v_mfma_f32_16x16x32_bf16 v[220:223], v[240:243], v[112:115], v[220:223]
ds_read_b64_tr_b16 v[238:239], v249 offset:63488
v_mfma_f32_16x16x32_bf16 v[220:223], v[244:247], v[116:119], v[220:223]
s_waitcnt lgkmcnt(4)
v_mfma_f32_16x16x32_bf16 v[208:211], v[224:227], v[24:27], v[208:211]
ds_read_b64_tr_b16 v[240:241], v250 offset:45056
v_mfma_f32_16x16x32_bf16 v[208:211], v[228:231], v[28:31], v[208:211]
v_mfma_f32_16x16x32_bf16 v[212:215], v[224:227], v[56:59], v[212:215]
ds_read_b64_tr_b16 v[242:243], v250 offset:47104
v_mfma_f32_16x16x32_bf16 v[212:215], v[228:231], v[60:63], v[212:215]
v_mfma_f32_16x16x32_bf16 v[216:219], v[224:227], v[88:91], v[216:219]
ds_read_b64_tr_b16 v[244:245], v250 offset:61440
v_mfma_f32_16x16x32_bf16 v[216:219], v[228:231], v[92:95], v[216:219]
v_mfma_f32_16x16x32_bf16 v[220:223], v[224:227], v[120:123], v[220:223]
ds_read_b64_tr_b16 v[246:247], v250 offset:63488
v_mfma_f32_16x16x32_bf16 v[220:223], v[228:231], v[124:127], v[220:223]
s_waitcnt lgkmcnt(4)
v_mfma_f32_16x16x32_bf16 a[192:195], v[232:235], v[160:163], a[192:195]
ds_read_b64_tr_b16 v[224:225], v249 offset:45568
v_mfma_f32_16x16x32_bf16 a[192:195], v[236:239], v[176:179], a[192:195]
v_mfma_f32_16x16x32_bf16 a[196:199], v[232:235], v[164:167], a[196:199]
ds_read_b64_tr_b16 v[226:227], v249 offset:47616
v_mfma_f32_16x16x32_bf16 a[196:199], v[236:239], v[180:183], a[196:199]
v_exp_f32 v208, v208
v_mfma_f32_16x16x32_bf16 a[200:203], v[232:235], v[168:171], a[200:203]
ds_read_b64_tr_b16 v[228:229], v249 offset:61952
v_mfma_f32_16x16x32_bf16 a[200:203], v[236:239], v[184:187], a[200:203]
v_exp_f32 v209, v209
v_mfma_f32_16x16x32_bf16 a[204:207], v[232:235], v[172:175], a[204:207]
ds_read_b64_tr_b16 v[230:231], v249 offset:64000
v_cvt_pk_bf16_f32 v146, v208, v209
v_mfma_f32_16x16x32_bf16 a[204:207], v[236:239], v[188:191], a[204:207]
s_waitcnt lgkmcnt(4)
v_mfma_f32_16x16x32_bf16 a[208:211], v[240:243], v[160:163], a[208:211]
ds_read_b64_tr_b16 v[232:233], v250 offset:45568
v_mfma_f32_16x16x32_bf16 a[208:211], v[244:247], v[176:179], a[208:211]
v_exp_f32 v210, v210
v_mfma_f32_16x16x32_bf16 a[212:215], v[240:243], v[164:167], a[212:215]
ds_read_b64_tr_b16 v[234:235], v250 offset:47616
v_mfma_f32_16x16x32_bf16 a[212:215], v[244:247], v[180:183], a[212:215]
v_exp_f32 v211, v211
v_mfma_f32_16x16x32_bf16 a[216:219], v[240:243], v[168:171], a[216:219]
ds_read_b64_tr_b16 v[236:237], v250 offset:61952
v_cvt_pk_bf16_f32 v147, v210, v211
v_mfma_f32_16x16x32_bf16 a[216:219], v[244:247], v[184:187], a[216:219]
v_exp_f32 v212, v212
v_mfma_f32_16x16x32_bf16 a[220:223], v[240:243], v[172:175], a[220:223]
ds_read_b64_tr_b16 v[238:239], v250 offset:64000
v_mfma_f32_16x16x32_bf16 a[220:223], v[244:247], v[188:191], a[220:223]
s_waitcnt lgkmcnt(4)
v_mfma_f32_16x16x32_bf16 a[224:227], v[224:227], v[160:163], a[224:227]
ds_read_b128 v[240:243], v248 offset:32768
v_mfma_f32_16x16x32_bf16 a[224:227], v[228:231], v[176:179], a[224:227]
v_exp_f32 v213, v213
v_mfma_f32_16x16x32_bf16 a[228:231], v[224:227], v[164:167], a[228:231]
v_exp_f32 v214, v214
v_mfma_f32_16x16x32_bf16 a[228:231], v[228:231], v[180:183], a[228:231]
v_exp_f32 v215, v215
v_mfma_f32_16x16x32_bf16 a[232:235], v[224:227], v[168:171], a[232:235]
ds_read_b128 v[244:247], v248 offset:33280
v_cvt_pk_bf16_f32 v150, v212, v213
v_mfma_f32_16x16x32_bf16 a[232:235], v[228:231], v[184:187], a[232:235]
v_cvt_pk_bf16_f32 v151, v214, v215
v_mfma_f32_16x16x32_bf16 a[236:239], v[224:227], v[172:175], a[236:239]
v_exp_f32 v216, v216
v_mfma_f32_16x16x32_bf16 a[236:239], v[228:231], v[188:191], a[236:239]
s_waitcnt lgkmcnt(2)
v_mfma_f32_16x16x32_bf16 a[240:243], v[232:235], v[160:163], a[240:243]
ds_read_b128 v[224:227], v248 offset:36864
v_mfma_f32_16x16x32_bf16 a[240:243], v[236:239], v[176:179], a[240:243]
v_exp_f32 v217, v217
v_mfma_f32_16x16x32_bf16 a[244:247], v[232:235], v[164:167], a[244:247]
v_exp_f32 v218, v218
v_mfma_f32_16x16x32_bf16 a[244:247], v[236:239], v[180:183], a[244:247]
v_exp_f32 v219, v219
v_mfma_f32_16x16x32_bf16 a[248:251], v[232:235], v[168:171], a[248:251]
ds_read_b128 v[228:231], v248 offset:37376
v_cvt_pk_bf16_f32 v154, v216, v217
v_mfma_f32_16x16x32_bf16 a[248:251], v[236:239], v[184:187], a[248:251]
v_cvt_pk_bf16_f32 v155, v218, v219
v_mfma_f32_16x16x32_bf16 a[252:255], v[232:235], v[172:175], a[252:255]
v_exp_f32 v220, v220
v_mfma_f32_16x16x32_bf16 a[252:255], v[236:239], v[188:191], a[252:255]
s_waitcnt lgkmcnt(2)
v_mfma_f32_16x16x32_bf16 v[192:195], v[240:243], v[0:3], 0
ds_read_b128 v[232:235], v248 offset:40960
v_mfma_f32_16x16x32_bf16 v[192:195], v[244:247], v[4:7], v[192:195]
v_xor_b32 v249, 0x10000, v249
v_mfma_f32_16x16x32_bf16 v[196:199], v[240:243], v[32:35], 0
v_exp_f32 v221, v221
v_mfma_f32_16x16x32_bf16 v[196:199], v[244:247], v[36:39], v[196:199]
v_xor_b32 v250, 0x10000, v250
v_cvt_pk_bf16_f32 v158, v220, v221
v_mfma_f32_16x16x32_bf16 v[200:203], v[240:243], v[64:67], 0
ds_read_b128 v[236:239], v248 offset:41472
v_mfma_f32_16x16x32_bf16 v[200:203], v[244:247], v[68:71], v[200:203]
v_exp_f32 v222, v222
v_mfma_f32_16x16x32_bf16 v[204:207], v[240:243], v[96:99], 0
v_exp_f32 v223, v223
v_mfma_f32_16x16x32_bf16 v[204:207], v[244:247], v[100:103], v[204:207]
s_waitcnt lgkmcnt(2)
v_cvt_pk_bf16_f32 v159, v222, v223
v_mfma_f32_16x16x32_bf16 v[192:195], v[224:227], v[8:11], v[192:195]
ds_read_b128 v[240:243], v248 offset:45056
v_mfma_f32_16x16x32_bf16 v[192:195], v[228:231], v[12:15], v[192:195]
v_mfma_f32_16x16x32_bf16 v[196:199], v[224:227], v[40:43], v[196:199]
v_mfma_f32_16x16x32_bf16 v[196:199], v[228:231], v[44:47], v[196:199]
v_mfma_f32_16x16x32_bf16 v[200:203], v[224:227], v[72:75], v[200:203]
ds_read_b128 v[244:247], v248 offset:45568
v_mfma_f32_16x16x32_bf16 v[200:203], v[228:231], v[76:79], v[200:203]
v_mfma_f32_16x16x32_bf16 v[204:207], v[224:227], v[104:107], v[204:207]
v_mfma_f32_16x16x32_bf16 v[204:207], v[228:231], v[108:111], v[204:207]
s_waitcnt lgkmcnt(2)
v_mfma_f32_16x16x32_bf16 v[192:195], v[232:235], v[16:19], v[192:195]
ds_read_b64_tr_b16 v[224:225], v249 offset:0
v_mfma_f32_16x16x32_bf16 v[192:195], v[236:239], v[20:23], v[192:195]
v_mfma_f32_16x16x32_bf16 v[196:199], v[232:235], v[48:51], v[196:199]
ds_read_b64_tr_b16 v[226:227], v249 offset:2048
v_mfma_f32_16x16x32_bf16 v[196:199], v[236:239], v[52:55], v[196:199]
v_mfma_f32_16x16x32_bf16 v[200:203], v[232:235], v[80:83], v[200:203]
ds_read_b64_tr_b16 v[228:229], v249 offset:16384
v_mfma_f32_16x16x32_bf16 v[200:203], v[236:239], v[84:87], v[200:203]
v_mfma_f32_16x16x32_bf16 v[204:207], v[232:235], v[112:115], v[204:207]
ds_read_b64_tr_b16 v[230:231], v249 offset:18432
v_mfma_f32_16x16x32_bf16 v[204:207], v[236:239], v[116:119], v[204:207]
s_waitcnt lgkmcnt(4)
v_mfma_f32_16x16x32_bf16 v[192:195], v[240:243], v[24:27], v[192:195]
ds_read_b64_tr_b16 v[232:233], v250 offset:0
v_mfma_f32_16x16x32_bf16 v[192:195], v[244:247], v[28:31], v[192:195]
v_mfma_f32_16x16x32_bf16 v[196:199], v[240:243], v[56:59], v[196:199]
ds_read_b64_tr_b16 v[234:235], v250 offset:2048
v_mfma_f32_16x16x32_bf16 v[196:199], v[244:247], v[60:63], v[196:199]
v_mfma_f32_16x16x32_bf16 v[200:203], v[240:243], v[88:91], v[200:203]
ds_read_b64_tr_b16 v[236:237], v250 offset:16384
v_mfma_f32_16x16x32_bf16 v[200:203], v[244:247], v[92:95], v[200:203]
s_sub_u32 s31, s31, 1
v_mfma_f32_16x16x32_bf16 v[204:207], v[240:243], v[120:123], v[204:207]
ds_read_b64_tr_b16 v[238:239], v250 offset:18432
v_mfma_f32_16x16x32_bf16 v[204:207], v[244:247], v[124:127], v[204:207]
s_cbranch_scc0 L2_loop
L2_tails:
L2_tail_1:
s_cmp_eq_u32 s59, 7
s_cbranch_scc1 L2_tail_1_7
L2_tail_1_6:
s_waitcnt lgkmcnt(4)
v_mfma_f32_16x16x32_bf16 a[0:3], v[224:227], v[160:163], a[0:3]
ds_read_b128 v[240:243], v248 offset:2048
v_mfma_f32_16x16x32_bf16 a[0:3], v[228:231], v[176:179], a[0:3]
s_lshl_b32 s36, s34, 13
v_mfma_f32_16x16x32_bf16 a[4:7], v[224:227], v[164:167], a[4:7]
s_add_u32 s56, s4, 0x1000000
s_addc_u32 s57, s5, 0
v_mfma_f32_16x16x32_bf16 a[4:7], v[228:231], v[180:183], a[4:7]
s_add_u32 s36, s36, 0x20000
s_mov_b32 s58, 0x6c02000
v_mfma_f32_16x16x32_bf16 a[8:11], v[224:227], v[168:171], a[8:11]
ds_read_b128 v[244:247], v248 offset:2560
s_mov_b32 s59, 0x00020000
v_mfma_f32_16x16x32_bf16 a[8:11], v[228:231], v[184:187], a[8:11]
v_add_u32 v255, s36, v252
s_lshr_b32 s35, s2, 1
v_mfma_f32_16x16x32_bf16 a[12:15], v[224:227], v[172:175], a[12:15]
s_and_b32 s35, s35, 28
s_add_u32 s35, s35, s34
v_mfma_f32_16x16x32_bf16 a[12:15], v[228:231], v[188:191], a[12:15]
s_waitcnt lgkmcnt(2)
s_lshl_b32 s35, s35, 13
v_mfma_f32_16x16x32_bf16 a[16:19], v[232:235], v[160:163], a[16:19]
ds_read_b128 v[224:227], v248 offset:6144
v_lshlrev_b32 v253, 3, v252
v_mfma_f32_16x16x32_bf16 a[16:19], v[236:239], v[176:179], a[16:19]
buffer_load_dword v253, v253, s[56:59], s35 offen
ds_write_b128 v255, v[160:163] offset:0
v_mfma_f32_16x16x32_bf16 a[20:23], v[232:235], v[164:167], a[20:23]
v_exp_f32 v192, v192
v_mfma_f32_16x16x32_bf16 a[20:23], v[236:239], v[180:183], a[20:23]
v_exp_f32 v193, v193
v_mfma_f32_16x16x32_bf16 a[24:27], v[232:235], v[168:171], a[24:27]
ds_read_b128 v[228:231], v248 offset:6656
v_cvt_pk_bf16_f32 v128, v192, v193
v_mfma_f32_16x16x32_bf16 a[24:27], v[236:239], v[184:187], a[24:27]
v_exp_f32 v194, v194
v_mfma_f32_16x16x32_bf16 a[28:31], v[232:235], v[172:175], a[28:31]
v_exp_f32 v195, v195
v_mfma_f32_16x16x32_bf16 a[28:31], v[236:239], v[188:191], a[28:31]
s_waitcnt lgkmcnt(3)
v_cvt_pk_bf16_f32 v129, v194, v195
v_mfma_f32_16x16x32_bf16 v[208:211], v[240:243], v[0:3], 0
ds_read_b128 v[232:235], v248 offset:10240
ds_write_b128 v255, v[164:167] offset:1024
v_mfma_f32_16x16x32_bf16 v[208:211], v[244:247], v[4:7], v[208:211]
v_exp_f32 v196, v196
v_mfma_f32_16x16x32_bf16 v[212:215], v[240:243], v[32:35], 0
v_exp_f32 v197, v197
v_mfma_f32_16x16x32_bf16 v[212:215], v[244:247], v[36:39], v[212:215]
v_exp_f32 v198, v198
v_mfma_f32_16x16x32_bf16 v[216:219], v[240:243], v[64:67], 0
ds_read_b128 v[236:239], v248 offset:10752
v_cvt_pk_bf16_f32 v132, v196, v197
v_mfma_f32_16x16x32_bf16 v[216:219], v[244:247], v[68:71], v[216:219]
v_exp_f32 v199, v199
v_mfma_f32_16x16x32_bf16 v[220:223], v[240:243], v[96:99], 0
v_exp_f32 v200, v200
v_mfma_f32_16x16x32_bf16 v[220:223], v[244:247], v[100:103], v[220:223]
s_waitcnt lgkmcnt(3)
v_cvt_pk_bf16_f32 v133, v198, v199
v_mfma_f32_16x16x32_bf16 v[208:211], v[224:227], v[8:11], v[208:211]
ds_read_b128 v[240:243], v248 offset:14336
ds_write_b128 v255, v[168:171] offset:2048
v_mfma_f32_16x16x32_bf16 v[208:211], v[228:231], v[12:15], v[208:211]
v_exp_f32 v201, v201
v_mfma_f32_16x16x32_bf16 v[212:215], v[224:227], v[40:43], v[212:215]
v_exp_f32 v202, v202
v_mfma_f32_16x16x32_bf16 v[212:215], v[228:231], v[44:47], v[212:215]
v_exp_f32 v203, v203
v_mfma_f32_16x16x32_bf16 v[216:219], v[224:227], v[72:75], v[216:219]
ds_read_b128 v[244:247], v248 offset:14848
v_cvt_pk_bf16_f32 v136, v200, v201
v_mfma_f32_16x16x32_bf16 v[216:219], v[228:231], v[76:79], v[216:219]
v_cvt_pk_bf16_f32 v137, v202, v203
ds_write_b128 v255, v[172:175] offset:3072
v_mfma_f32_16x16x32_bf16 v[220:223], v[224:227], v[104:107], v[220:223]
v_exp_f32 v204, v204
v_mfma_f32_16x16x32_bf16 v[220:223], v[228:231], v[108:111], v[220:223]
s_waitcnt lgkmcnt(4)
s_waitcnt vmcnt(1)
s_barrier
v_mfma_f32_16x16x32_bf16 v[208:211], v[232:235], v[16:19], v[208:211]
ds_read_b128 v[224:227], v248 offset:16384
s_add_u32 m0, s30, 0xc000
v_mfma_f32_16x16x32_bf16 v[208:211], v[236:239], v[20:23], v[208:211]
s_and_b32 s100, s30, 0x10000
buffer_load_dwordx4 v251, s[12:15], s28 offen offset:0 lds
v_mfma_f32_16x16x32_bf16 v[212:215], v[232:235], v[48:51], v[212:215]
s_xor_b32 s100, s100, 0x10000
v_mfma_f32_16x16x32_bf16 v[212:215], v[236:239], v[52:55], v[212:215]
v_exp_f32 v205, v205
v_mfma_f32_16x16x32_bf16 v[216:219], v[232:235], v[80:83], v[216:219]
ds_read_b128 v[228:231], v248 offset:16896
v_cvt_pk_bf16_f32 v140, v204, v205
v_mfma_f32_16x16x32_bf16 v[216:219], v[236:239], v[84:87], v[216:219]
v_exp_f32 v206, v206
v_mfma_f32_16x16x32_bf16 v[220:223], v[232:235], v[112:115], v[220:223]
v_exp_f32 v207, v207
v_mfma_f32_16x16x32_bf16 v[220:223], v[236:239], v[116:119], v[220:223]
s_waitcnt lgkmcnt(3)
v_cvt_pk_bf16_f32 v141, v206, v207
v_mfma_f32_16x16x32_bf16 v[208:211], v[240:243], v[24:27], v[208:211]
ds_read_b128 v[232:235], v248 offset:20480
buffer_load_dwordx4 v251, s[12:15], s28 offen offset:1024 lds
v_mfma_f32_16x16x32_bf16 v[208:211], v[244:247], v[28:31], v[208:211]
v_mfma_f32_16x16x32_bf16 v[212:215], v[240:243], v[56:59], v[212:215]
buffer_load_dwordx4 v251, s[12:15], s28 offen offset:2048 lds
v_mfma_f32_16x16x32_bf16 v[212:215], v[244:247], v[60:63], v[212:215]
v_mfma_f32_16x16x32_bf16 v[216:219], v[240:243], v[88:91], v[216:219]
ds_read_b128 v[236:239], v248 offset:20992
buffer_load_dwordx4 v251, s[12:15], s28 offen offset:3072 lds
v_mfma_f32_16x16x32_bf16 v[216:219], v[244:247], v[92:95], v[216:219]
v_mfma_f32_16x16x32_bf16 v[220:223], v[240:243], v[120:123], v[220:223]
s_add_u32 s28, s28, 0x4000
v_mfma_f32_16x16x32_bf16 v[220:223], v[244:247], v[124:127], v[220:223]
s_waitcnt lgkmcnt(2)
v_mfma_f32_16x16x32_bf16 v[192:195], v[224:227], v[0:3], 0
ds_read_b128 v[240:243], v248 offset:24576
v_mfma_f32_16x16x32_bf16 v[192:195], v[228:231], v[4:7], v[192:195]
v_exp_f32 v208, v208
v_mfma_f32_16x16x32_bf16 v[196:199], v[224:227], v[32:35], 0
v_exp_f32 v209, v209
v_mfma_f32_16x16x32_bf16 v[196:199], v[228:231], v[36:39], v[196:199]
v_exp_f32 v210, v210
v_mfma_f32_16x16x32_bf16 v[200:203], v[224:227], v[64:67], 0
ds_read_b128 v[244:247], v248 offset:25088
v_cvt_pk_bf16_f32 v130, v208, v209
v_mfma_f32_16x16x32_bf16 v[200:203], v[228:231], v[68:71], v[200:203]
v_exp_f32 v211, v211
v_mfma_f32_16x16x32_bf16 v[204:207], v[224:227], v[96:99], 0
v_exp_f32 v212, v212
v_mfma_f32_16x16x32_bf16 v[204:207], v[228:231], v[100:103], v[204:207]
s_waitcnt lgkmcnt(2)
v_cvt_pk_bf16_f32 v131, v210, v211
v_mfma_f32_16x16x32_bf16 v[192:195], v[232:235], v[8:11], v[192:195]
ds_read_b128 v[224:227], v248 offset:28672
v_mfma_f32_16x16x32_bf16 v[192:195], v[236:239], v[12:15], v[192:195]
v_exp_f32 v213, v213
v_mfma_f32_16x16x32_bf16 v[196:199], v[232:235], v[40:43], v[196:199]
v_exp_f32 v214, v214
v_mfma_f32_16x16x32_bf16 v[196:199], v[236:239], v[44:47], v[196:199]
v_exp_f32 v215, v215
v_mfma_f32_16x16x32_bf16 v[200:203], v[232:235], v[72:75], v[200:203]
ds_read_b128 v[228:231], v248 offset:29184
v_cvt_pk_bf16_f32 v134, v212, v213
v_mfma_f32_16x16x32_bf16 v[200:203], v[236:239], v[76:79], v[200:203]
v_cvt_pk_bf16_f32 v135, v214, v215
v_mfma_f32_16x16x32_bf16 v[204:207], v[232:235], v[104:107], v[204:207]
v_exp_f32 v216, v216
v_mfma_f32_16x16x32_bf16 v[204:207], v[236:239], v[108:111], v[204:207]
s_waitcnt lgkmcnt(2)
v_mfma_f32_16x16x32_bf16 v[192:195], v[240:243], v[16:19], v[192:195]
ds_read_b128 v[232:235], v248 offset:18432
v_mfma_f32_16x16x32_bf16 v[192:195], v[244:247], v[20:23], v[192:195]
v_exp_f32 v217, v217
v_mfma_f32_16x16x32_bf16 v[196:199], v[240:243], v[48:51], v[196:199]
v_exp_f32 v218, v218
v_mfma_f32_16x16x32_bf16 v[196:199], v[244:247], v[52:55], v[196:199]
v_exp_f32 v219, v219
v_mfma_f32_16x16x32_bf16 v[200:203], v[240:243], v[80:83], v[200:203]
ds_read_b128 v[236:239], v248 offset:18944
v_cvt_pk_bf16_f32 v138, v216, v217
v_mfma_f32_16x16x32_bf16 v[200:203], v[244:247], v[84:87], v[200:203]
v_cvt_pk_bf16_f32 v139, v218, v219
v_mfma_f32_16x16x32_bf16 v[204:207], v[240:243], v[112:115], v[204:207]
v_exp_f32 v220, v220
v_mfma_f32_16x16x32_bf16 v[204:207], v[244:247], v[116:119], v[204:207]
s_waitcnt lgkmcnt(2)
v_mfma_f32_16x16x32_bf16 v[192:195], v[224:227], v[24:27], v[192:195]
ds_read_b128 v[240:243], v248 offset:22528
v_mfma_f32_16x16x32_bf16 v[192:195], v[228:231], v[28:31], v[192:195]
v_exp_f32 v221, v221
v_mfma_f32_16x16x32_bf16 v[196:199], v[224:227], v[56:59], v[196:199]
v_exp_f32 v222, v222
v_mfma_f32_16x16x32_bf16 v[196:199], v[228:231], v[60:63], v[196:199]
v_exp_f32 v223, v223
v_mfma_f32_16x16x32_bf16 v[200:203], v[224:227], v[88:91], v[200:203]
ds_read_b128 v[244:247], v248 offset:23040
v_cvt_pk_bf16_f32 v142, v220, v221
v_mfma_f32_16x16x32_bf16 v[200:203], v[228:231], v[92:95], v[200:203]
v_cvt_pk_bf16_f32 v143, v222, v223
v_mfma_f32_16x16x32_bf16 v[204:207], v[224:227], v[120:123], v[204:207]
v_mfma_f32_16x16x32_bf16 v[204:207], v[228:231], v[124:127], v[204:207]
s_waitcnt lgkmcnt(2)
v_mfma_f32_16x16x32_bf16 v[208:211], v[232:235], v[0:3], 0
ds_read_b128 v[224:227], v248 offset:26624
v_mfma_f32_16x16x32_bf16 v[208:211], v[236:239], v[4:7], v[208:211]
v_exp_f32 v192, v192
v_mfma_f32_16x16x32_bf16 v[212:215], v[232:235], v[32:35], 0
v_exp_f32 v193, v193
v_mfma_f32_16x16x32_bf16 v[212:215], v[236:239], v[36:39], v[212:215]
v_exp_f32 v194, v194
v_mfma_f32_16x16x32_bf16 v[216:219], v[232:235], v[64:67], 0
ds_read_b128 v[228:231], v248 offset:27136
v_cvt_pk_bf16_f32 v144, v192, v193
v_mfma_f32_16x16x32_bf16 v[216:219], v[236:239], v[68:71], v[216:219]
v_exp_f32 v195, v195
v_mfma_f32_16x16x32_bf16 v[220:223], v[232:235], v[96:99], 0
v_exp_f32 v196, v196
v_mfma_f32_16x16x32_bf16 v[220:223], v[236:239], v[100:103], v[220:223]
s_waitcnt lgkmcnt(2)
v_cvt_pk_bf16_f32 v145, v194, v195
v_mfma_f32_16x16x32_bf16 v[208:211], v[240:243], v[8:11], v[208:211]
ds_read_b128 v[232:235], v248 offset:30720
v_mfma_f32_16x16x32_bf16 v[208:211], v[244:247], v[12:15], v[208:211]
v_exp_f32 v197, v197
v_mfma_f32_16x16x32_bf16 v[212:215], v[240:243], v[40:43], v[212:215]
v_exp_f32 v198, v198
v_mfma_f32_16x16x32_bf16 v[212:215], v[244:247], v[44:47], v[212:215]
v_exp_f32 v199, v199
v_mfma_f32_16x16x32_bf16 v[216:219], v[240:243], v[72:75], v[216:219]
ds_read_b128 v[236:239], v248 offset:31232
v_cvt_pk_bf16_f32 v148, v196, v197
v_mfma_f32_16x16x32_bf16 v[216:219], v[244:247], v[76:79], v[216:219]
v_cvt_pk_bf16_f32 v149, v198, v199
v_mfma_f32_16x16x32_bf16 v[220:223], v[240:243], v[104:107], v[220:223]
v_exp_f32 v200, v200
v_mfma_f32_16x16x32_bf16 v[220:223], v[244:247], v[108:111], v[220:223]
s_waitcnt lgkmcnt(2)
v_mfma_f32_16x16x32_bf16 v[208:211], v[224:227], v[16:19], v[208:211]
ds_read_b128 v[240:243], v248 offset:32768
v_mfma_f32_16x16x32_bf16 v[208:211], v[228:231], v[20:23], v[208:211]
v_exp_f32 v201, v201
v_mfma_f32_16x16x32_bf16 v[212:215], v[224:227], v[48:51], v[212:215]
v_exp_f32 v202, v202
v_mfma_f32_16x16x32_bf16 v[212:215], v[228:231], v[52:55], v[212:215]
v_exp_f32 v203, v203
v_mfma_f32_16x16x32_bf16 v[216:219], v[224:227], v[80:83], v[216:219]
ds_read_b128 v[244:247], v248 offset:33280
v_cvt_pk_bf16_f32 v152, v200, v201
v_mfma_f32_16x16x32_bf16 v[216:219], v[228:231], v[84:87], v[216:219]
v_cvt_pk_bf16_f32 v153, v202, v203
v_mfma_f32_16x16x32_bf16 v[220:223], v[224:227], v[112:115], v[220:223]
v_exp_f32 v204, v204
v_mfma_f32_16x16x32_bf16 v[220:223], v[228:231], v[116:119], v[220:223]
s_waitcnt lgkmcnt(2)
v_mfma_f32_16x16x32_bf16 v[208:211], v[232:235], v[24:27], v[208:211]
ds_read_b128 v[224:227], v248 offset:36864
v_mfma_f32_16x16x32_bf16 v[208:211], v[236:239], v[28:31], v[208:211]
v_exp_f32 v205, v205
v_mfma_f32_16x16x32_bf16 v[212:215], v[232:235], v[56:59], v[212:215]
v_exp_f32 v206, v206
v_mfma_f32_16x16x32_bf16 v[212:215], v[236:239], v[60:63], v[212:215]
v_exp_f32 v207, v207
v_mfma_f32_16x16x32_bf16 v[216:219], v[232:235], v[88:91], v[216:219]
ds_read_b128 v[228:231], v248 offset:37376
v_cvt_pk_bf16_f32 v156, v204, v205
v_mfma_f32_16x16x32_bf16 v[216:219], v[236:239], v[92:95], v[216:219]
v_cvt_pk_bf16_f32 v157, v206, v207
v_mfma_f32_16x16x32_bf16 v[220:223], v[232:235], v[120:123], v[220:223]
v_mfma_f32_16x16x32_bf16 v[220:223], v[236:239], v[124:127], v[220:223]
s_waitcnt lgkmcnt(2)
v_mfma_f32_16x16x32_bf16 v[192:195], v[240:243], v[0:3], 0
ds_read_b128 v[232:235], v248 offset:40960
v_mfma_f32_16x16x32_bf16 v[192:195], v[244:247], v[4:7], v[192:195]
v_exp_f32 v208, v208
v_mfma_f32_16x16x32_bf16 v[196:199], v[240:243], v[32:35], 0
v_exp_f32 v209, v209
v_mfma_f32_16x16x32_bf16 v[196:199], v[244:247], v[36:39], v[196:199]
v_exp_f32 v210, v210
v_mfma_f32_16x16x32_bf16 v[200:203], v[240:243], v[64:67], 0
ds_read_b128 v[236:239], v248 offset:41472
v_cvt_pk_bf16_f32 v146, v208, v209
v_mfma_f32_16x16x32_bf16 v[200:203], v[244:247], v[68:71], v[200:203]
v_exp_f32 v211, v211
v_mfma_f32_16x16x32_bf16 v[204:207], v[240:243], v[96:99], 0
v_exp_f32 v212, v212
v_mfma_f32_16x16x32_bf16 v[204:207], v[244:247], v[100:103], v[204:207]
s_waitcnt lgkmcnt(2)
v_cvt_pk_bf16_f32 v147, v210, v211
v_mfma_f32_16x16x32_bf16 v[192:195], v[224:227], v[8:11], v[192:195]
ds_read_b128 v[240:243], v248 offset:45056
v_mfma_f32_16x16x32_bf16 v[192:195], v[228:231], v[12:15], v[192:195]
v_exp_f32 v213, v213
v_mfma_f32_16x16x32_bf16 v[196:199], v[224:227], v[40:43], v[196:199]
v_exp_f32 v214, v214
v_mfma_f32_16x16x32_bf16 v[196:199], v[228:231], v[44:47], v[196:199]
v_exp_f32 v215, v215
v_mfma_f32_16x16x32_bf16 v[200:203], v[224:227], v[72:75], v[200:203]
ds_read_b128 v[244:247], v248 offset:45568
v_cvt_pk_bf16_f32 v150, v212, v213
v_mfma_f32_16x16x32_bf16 v[200:203], v[228:231], v[76:79], v[200:203]
v_cvt_pk_bf16_f32 v151, v214, v215
v_mfma_f32_16x16x32_bf16 v[204:207], v[224:227], v[104:107], v[204:207]
v_exp_f32 v216, v216
v_mfma_f32_16x16x32_bf16 v[204:207], v[228:231], v[108:111], v[204:207]
s_waitcnt lgkmcnt(2)
v_mfma_f32_16x16x32_bf16 v[192:195], v[232:235], v[16:19], v[192:195]
ds_read_b128 v[224:227], v248 offset:34816
v_mfma_f32_16x16x32_bf16 v[192:195], v[236:239], v[20:23], v[192:195]
v_exp_f32 v217, v217
v_mfma_f32_16x16x32_bf16 v[196:199], v[232:235], v[48:51], v[196:199]
v_exp_f32 v218, v218
v_mfma_f32_16x16x32_bf16 v[196:199], v[236:239], v[52:55], v[196:199]
v_exp_f32 v219, v219
v_mfma_f32_16x16x32_bf16 v[200:203], v[232:235], v[80:83], v[200:203]
ds_read_b128 v[228:231], v248 offset:35328
v_cvt_pk_bf16_f32 v154, v216, v217
v_mfma_f32_16x16x32_bf16 v[200:203], v[236:239], v[84:87], v[200:203]
v_cvt_pk_bf16_f32 v155, v218, v219
v_mfma_f32_16x16x32_bf16 v[204:207], v[232:235], v[112:115], v[204:207]
v_exp_f32 v220, v220
v_mfma_f32_16x16x32_bf16 v[204:207], v[236:239], v[116:119], v[204:207]
s_waitcnt lgkmcnt(2)
v_mfma_f32_16x16x32_bf16 v[192:195], v[240:243], v[24:27], v[192:195]
ds_read_b128 v[232:235], v248 offset:38912
v_mfma_f32_16x16x32_bf16 v[192:195], v[244:247], v[28:31], v[192:195]
v_exp_f32 v221, v221
v_mfma_f32_16x16x32_bf16 v[196:199], v[240:243], v[56:59], v[196:199]
v_exp_f32 v222, v222
v_mfma_f32_16x16x32_bf16 v[196:199], v[244:247], v[60:63], v[196:199]
v_exp_f32 v223, v223
v_mfma_f32_16x16x32_bf16 v[200:203], v[240:243], v[88:91], v[200:203]
ds_read_b128 v[236:239], v248 offset:39424
v_cvt_pk_bf16_f32 v158, v220, v221
v_mfma_f32_16x16x32_bf16 v[200:203], v[244:247], v[92:95], v[200:203]
v_cvt_pk_bf16_f32 v159, v222, v223
v_mfma_f32_16x16x32_bf16 v[204:207], v[240:243], v[120:123], v[204:207]
v_mfma_f32_16x16x32_bf16 v[204:207], v[244:247], v[124:127], v[204:207]
s_waitcnt lgkmcnt(2)
v_mfma_f32_16x16x32_bf16 v[208:211], v[224:227], v[0:3], 0
ds_read_b128 v[240:243], v248 offset:43008
v_mfma_f32_16x16x32_bf16 v[208:211], v[228:231], v[4:7], v[208:211]
v_exp_f32 v192, v192
v_mfma_f32_16x16x32_bf16 v[212:215], v[224:227], v[32:35], 0
v_exp_f32 v193, v193
v_mfma_f32_16x16x32_bf16 v[212:215], v[228:231], v[36:39], v[212:215]
v_exp_f32 v194, v194
v_mfma_f32_16x16x32_bf16 v[216:219], v[224:227], v[64:67], 0
ds_read_b128 v[244:247], v248 offset:43520
v_cvt_pk_bf16_f32 v160, v192, v193
v_mfma_f32_16x16x32_bf16 v[216:219], v[228:231], v[68:71], v[216:219]
v_exp_f32 v195, v195
v_mfma_f32_16x16x32_bf16 v[220:223], v[224:227], v[96:99], 0
v_exp_f32 v196, v196
v_mfma_f32_16x16x32_bf16 v[220:223], v[228:231], v[100:103], v[220:223]
s_waitcnt lgkmcnt(2)
v_cvt_pk_bf16_f32 v161, v194, v195
v_mfma_f32_16x16x32_bf16 v[208:211], v[232:235], v[8:11], v[208:211]
ds_read_b128 v[224:227], v248 offset:47104
v_mfma_f32_16x16x32_bf16 v[208:211], v[236:239], v[12:15], v[208:211]
v_exp_f32 v197, v197
v_mfma_f32_16x16x32_bf16 v[212:215], v[232:235], v[40:43], v[212:215]
v_exp_f32 v198, v198
v_mfma_f32_16x16x32_bf16 v[212:215], v[236:239], v[44:47], v[212:215]
v_exp_f32 v199, v199
v_mfma_f32_16x16x32_bf16 v[216:219], v[232:235], v[72:75], v[216:219]
ds_read_b128 v[228:231], v248 offset:47616
v_cvt_pk_bf16_f32 v164, v196, v197
v_mfma_f32_16x16x32_bf16 v[216:219], v[236:239], v[76:79], v[216:219]
v_cvt_pk_bf16_f32 v165, v198, v199
v_mfma_f32_16x16x32_bf16 v[220:223], v[232:235], v[104:107], v[220:223]
v_exp_f32 v200, v200
v_mfma_f32_16x16x32_bf16 v[220:223], v[236:239], v[108:111], v[220:223]
s_waitcnt lgkmcnt(2)
s_waitcnt vmcnt(0)
s_barrier
v_mfma_f32_16x16x32_bf16 v[208:211], v[240:243], v[16:19], v[208:211]
ds_read_b128 v[232:235], v248 offset:49152
s_add_u32 s8, s6, 0x0
s_addc_u32 s9, s7, 0
v_mfma_f32_16x16x32_bf16 v[208:211], v[244:247], v[20:23], v[208:211]
v_exp_f32 v201, v201
s_mov_b32 s10, 0x4e2000
v_mfma_f32_16x16x32_bf16 v[212:215], v[240:243], v[48:51], v[212:215]
v_exp_f32 v202, v202
s_mov_b32 s11, 0x00020000
v_mfma_f32_16x16x32_bf16 v[212:215], v[244:247], v[52:55], v[212:215]
v_exp_f32 v203, v203
s_lshl_b32 s55, s34, 13
v_mfma_f32_16x16x32_bf16 v[216:219], v[240:243], v[80:83], v[216:219]
ds_read_b128 v[236:239], v248 offset:49664
v_cvt_pk_bf16_f32 v168, v200, v201
s_add_u32 s55, s55, 0x21000
v_mfma_f32_16x16x32_bf16 v[216:219], v[244:247], v[84:87], v[216:219]
v_cvt_pk_bf16_f32 v169, v202, v203
s_lshl_b32 s36, s34, 7
v_bfe_u32 v253, v252, 4, 3
v_mfma_f32_16x16x32_bf16 v[220:223], v[240:243], v[112:115], v[220:223]
v_exp_f32 v204, v204
v_lshrrev_b32 v254, 7, v252
v_mfma_f32_16x16x32_bf16 v[220:223], v[244:247], v[116:119], v[220:223]
s_waitcnt lgkmcnt(2)
v_xor_b32 v253, v253, v254
v_lshl_add_u32 v254, v254, 9, s36
v_mfma_f32_16x16x32_bf16 v[208:211], v[224:227], v[24:27], v[208:211]
ds_read_b128 v[240:243], v248 offset:53248
v_lshl_add_u32 v253, v253, 4, v254
s_add_u32 m0, s55, 0
v_mfma_f32_16x16x32_bf16 v[208:211], v[228:231], v[28:31], v[208:211]
v_exp_f32 v205, v205
s_add_u32 s35, s52, 0
v_mfma_f32_16x16x32_bf16 v[212:215], v[224:227], v[56:59], v[212:215]
v_exp_f32 v206, v206
buffer_load_dwordx4 v253, s[8:11], s35 offen lds
v_mfma_f32_16x16x32_bf16 v[212:215], v[228:231], v[60:63], v[212:215]
v_exp_f32 v207, v207
s_add_u32 m0, s55, 1024
v_mfma_f32_16x16x32_bf16 v[216:219], v[224:227], v[88:91], v[216:219]
ds_read_b128 v[244:247], v248 offset:53760
v_cvt_pk_bf16_f32 v172, v204, v205
s_add_u32 s35, s52, 4096
v_mfma_f32_16x16x32_bf16 v[216:219], v[228:231], v[92:95], v[216:219]
v_cvt_pk_bf16_f32 v173, v206, v207
buffer_load_dwordx4 v253, s[8:11], s35 offen lds
s_add_u32 m0, s55, 2048
v_mfma_f32_16x16x32_bf16 v[220:223], v[224:227], v[120:123], v[220:223]
s_add_u32 s35, s53, 0
buffer_load_dwordx4 v253, s[8:11], s35 offen lds
s_add_u32 m0, s55, 3072
v_mfma_f32_16x16x32_bf16 v[220:223], v[228:231], v[124:127], v[220:223]
s_waitcnt lgkmcnt(2)
s_add_u32 s35, s53, 4096
buffer_load_dwordx4 v253, s[8:11], s35 offen lds
v_mfma_f32_16x16x32_bf16 v[192:195], v[232:235], v[0:3], 0
ds_read_b128 v[224:227], v248 offset:57344
v_mfma_f32_16x16x32_bf16 v[192:195], v[236:239], v[4:7], v[192:195]
v_exp_f32 v208, v208
v_mfma_f32_16x16x32_bf16 v[196:199], v[232:235], v[32:35], 0
v_exp_f32 v209, v209
v_mfma_f32_16x16x32_bf16 v[196:199], v[236:239], v[36:39], v[196:199]
v_exp_f32 v210, v210
v_mfma_f32_16x16x32_bf16 v[200:203], v[232:235], v[64:67], 0
ds_read_b128 v[228:231], v248 offset:57856
v_cvt_pk_bf16_f32 v162, v208, v209
v_mfma_f32_16x16x32_bf16 v[200:203], v[236:239], v[68:71], v[200:203]
v_exp_f32 v211, v211
v_mfma_f32_16x16x32_bf16 v[204:207], v[232:235], v[96:99], 0
v_exp_f32 v212, v212
v_mfma_f32_16x16x32_bf16 v[204:207], v[236:239], v[100:103], v[204:207]
s_waitcnt lgkmcnt(2)
v_cvt_pk_bf16_f32 v163, v210, v211
v_mfma_f32_16x16x32_bf16 v[192:195], v[240:243], v[8:11], v[192:195]
ds_read_b128 v[232:235], v248 offset:61440
v_mfma_f32_16x16x32_bf16 v[192:195], v[244:247], v[12:15], v[192:195]
v_exp_f32 v213, v213
v_mfma_f32_16x16x32_bf16 v[196:199], v[240:243], v[40:43], v[196:199]
v_exp_f32 v214, v214
v_mfma_f32_16x16x32_bf16 v[196:199], v[244:247], v[44:47], v[196:199]
v_exp_f32 v215, v215
v_mfma_f32_16x16x32_bf16 v[200:203], v[240:243], v[72:75], v[200:203]
ds_read_b128 v[236:239], v248 offset:61952
v_cvt_pk_bf16_f32 v166, v212, v213
v_mfma_f32_16x16x32_bf16 v[200:203], v[244:247], v[76:79], v[200:203]
v_cvt_pk_bf16_f32 v167, v214, v215
v_mfma_f32_16x16x32_bf16 v[204:207], v[240:243], v[104:107], v[204:207]
v_exp_f32 v216, v216
v_mfma_f32_16x16x32_bf16 v[204:207], v[244:247], v[108:111], v[204:207]
s_waitcnt lgkmcnt(2)
v_mfma_f32_16x16x32_bf16 v[192:195], v[224:227], v[16:19], v[192:195]
ds_read_b128 v[240:243], v248 offset:51200
v_mfma_f32_16x16x32_bf16 v[192:195], v[228:231], v[20:23], v[192:195]
v_exp_f32 v217, v217
v_mfma_f32_16x16x32_bf16 v[196:199], v[224:227], v[48:51], v[196:199]
v_exp_f32 v218, v218
v_mfma_f32_16x16x32_bf16 v[196:199], v[228:231], v[52:55], v[196:199]
v_exp_f32 v219, v219
v_mfma_f32_16x16x32_bf16 v[200:203], v[224:227], v[80:83], v[200:203]
ds_read_b128 v[244:247], v248 offset:51712
v_cvt_pk_bf16_f32 v170, v216, v217
v_mfma_f32_16x16x32_bf16 v[200:203], v[228:231], v[84:87], v[200:203]
v_cvt_pk_bf16_f32 v171, v218, v219
v_mfma_f32_16x16x32_bf16 v[204:207], v[224:227], v[112:115], v[204:207]
v_exp_f32 v220, v220
v_mfma_f32_16x16x32_bf16 v[204:207], v[228:231], v[116:119], v[204:207]
s_waitcnt lgkmcnt(2)
v_mfma_f32_16x16x32_bf16 v[192:195], v[232:235], v[24:27], v[192:195]
ds_read_b128 v[224:227], v248 offset:55296
v_mfma_f32_16x16x32_bf16 v[192:195], v[236:239], v[28:31], v[192:195]
v_exp_f32 v221, v221
v_mfma_f32_16x16x32_bf16 v[196:199], v[232:235], v[56:59], v[196:199]
v_exp_f32 v222, v222
v_mfma_f32_16x16x32_bf16 v[196:199], v[236:239], v[60:63], v[196:199]
v_exp_f32 v223, v223
v_mfma_f32_16x16x32_bf16 v[200:203], v[232:235], v[88:91], v[200:203]
ds_read_b128 v[228:231], v248 offset:55808
v_cvt_pk_bf16_f32 v174, v220, v221
v_mfma_f32_16x16x32_bf16 v[200:203], v[236:239], v[92:95], v[200:203]
v_cvt_pk_bf16_f32 v175, v222, v223
v_mfma_f32_16x16x32_bf16 v[204:207], v[232:235], v[120:123], v[204:207]
v_mfma_f32_16x16x32_bf16 v[204:207], v[236:239], v[124:127], v[204:207]
s_waitcnt lgkmcnt(2)
v_mfma_f32_16x16x32_bf16 v[208:211], v[240:243], v[0:3], 0
ds_read_b128 v[232:235], v248 offset:59392
v_mfma_f32_16x16x32_bf16 v[208:211], v[244:247], v[4:7], v[208:211]
v_exp_f32 v192, v192
v_mfma_f32_16x16x32_bf16 v[212:215], v[240:243], v[32:35], 0
v_exp_f32 v193, v193
v_mfma_f32_16x16x32_bf16 v[212:215], v[244:247], v[36:39], v[212:215]
v_exp_f32 v194, v194
v_mfma_f32_16x16x32_bf16 v[216:219], v[240:243], v[64:67], 0
ds_read_b128 v[236:239], v248 offset:59904
v_cvt_pk_bf16_f32 v0, v192, v193
v_mfma_f32_16x16x32_bf16 v[216:219], v[244:247], v[68:71], v[216:219]
v_exp_f32 v195, v195
v_mfma_f32_16x16x32_bf16 v[220:223], v[240:243], v[96:99], 0
v_exp_f32 v196, v196
v_mfma_f32_16x16x32_bf16 v[220:223], v[244:247], v[100:103], v[220:223]
s_waitcnt lgkmcnt(2)
v_cvt_pk_bf16_f32 v1, v194, v195
v_mfma_f32_16x16x32_bf16 v[208:211], v[224:227], v[8:11], v[208:211]
ds_read_b128 v[240:243], v248 offset:63488
v_mfma_f32_16x16x32_bf16 v[208:211], v[228:231], v[12:15], v[208:211]
v_exp_f32 v197, v197
v_mfma_f32_16x16x32_bf16 v[212:215], v[224:227], v[40:43], v[212:215]
ds_read_b128 v[4:7], v255 offset:0
ds_read_b128 v[36:39], v255 offset:1024
v_mfma_f32_16x16x32_bf16 v[212:215], v[228:231], v[44:47], v[212:215]
v_exp_f32 v198, v198
v_mfma_f32_16x16x32_bf16 v[216:219], v[224:227], v[72:75], v[216:219]
ds_read_b128 v[244:247], v248 offset:64000
v_xor_b32 v12, 0x10000, v249
v_mfma_f32_16x16x32_bf16 v[216:219], v[228:231], v[76:79], v[216:219]
v_xor_b32 v13, 0x10000, v250
v_cvt_pk_bf16_f32 v32, v196, v197
v_mfma_f32_16x16x32_bf16 v[220:223], v[224:227], v[104:107], v[220:223]
ds_read_b128 v[68:71], v255 offset:2048
ds_read_b128 v[100:103], v255 offset:3072
v_mfma_f32_16x16x32_bf16 v[220:223], v[228:231], v[108:111], v[220:223]
s_waitcnt lgkmcnt(6)
v_mfma_f32_16x16x32_bf16 v[208:211], v[232:235], v[16:19], v[208:211]
ds_read_b64_tr_b16 v[224:225], v12 offset:0
ds_read_b64_tr_b16 v[226:227], v12 offset:2048
v_mfma_f32_16x16x32_bf16 v[208:211], v[236:239], v[20:23], v[208:211]
v_exp_f32 v199, v199
v_mfma_f32_16x16x32_bf16 v[212:215], v[232:235], v[48:51], v[212:215]
v_cvt_pk_bf16_f32 v33, v198, v199
v_mfma_f32_16x16x32_bf16 v[212:215], v[236:239], v[52:55], v[212:215]
v_exp_f32 v200, v200
v_mfma_f32_16x16x32_bf16 v[216:219], v[232:235], v[80:83], v[216:219]
ds_read_b64_tr_b16 v[228:229], v12 offset:16384
ds_read_b64_tr_b16 v[230:231], v12 offset:18432
v_mfma_f32_16x16x32_bf16 v[216:219], v[236:239], v[84:87], v[216:219]
v_exp_f32 v201, v201
v_mfma_f32_16x16x32_bf16 v[220:223], v[232:235], v[112:115], v[220:223]
v_exp_f32 v202, v202
v_mfma_f32_16x16x32_bf16 v[220:223], v[236:239], v[116:119], v[220:223]
s_waitcnt lgkmcnt(6)
v_cvt_pk_bf16_f32 v64, v200, v201
v_mfma_f32_16x16x32_bf16 v[208:211], v[240:243], v[24:27], v[208:211]
ds_read_b64_tr_b16 v[232:233], v13 offset:0
ds_read_b64_tr_b16 v[234:235], v13 offset:2048
v_mfma_f32_16x16x32_bf16 v[208:211], v[244:247], v[28:31], v[208:211]
v_exp_f32 v203, v203
v_mfma_f32_16x16x32_bf16 v[212:215], v[240:243], v[56:59], v[212:215]
v_cvt_pk_bf16_f32 v65, v202, v203
v_mfma_f32_16x16x32_bf16 v[212:215], v[244:247], v[60:63], v[212:215]
v_exp_f32 v204, v204
v_mfma_f32_16x16x32_bf16 v[216:219], v[240:243], v[88:91], v[216:219]
ds_read_b64_tr_b16 v[236:237], v13 offset:16384
ds_read_b64_tr_b16 v[238:239], v13 offset:18432
v_mfma_f32_16x16x32_bf16 v[216:219], v[244:247], v[92:95], v[216:219]
v_exp_f32 v205, v205
v_mfma_f32_16x16x32_bf16 v[220:223], v[240:243], v[120:123], v[220:223]
v_exp_f32 v206, v206
v_mfma_f32_16x16x32_bf16 v[220:223], v[244:247], v[124:127], v[220:223]
s_waitcnt lgkmcnt(4)
v_mfma_f32_16x16x32_bf16 a[0:3], v[224:227], v[128:131], a[0:3]
ds_read_b64_tr_b16 v[240:241], v249 offset:33280
ds_read_b64_tr_b16 v[242:243], v249 offset:35328
v_mfma_f32_16x16x32_bf16 a[0:3], v[228:231], v[144:147], a[0:3]
v_exp_f32 v207, v207
v_mfma_f32_16x16x32_bf16 a[4:7], v[224:227], v[132:135], a[4:7]
v_cvt_pk_bf16_f32 v96, v204, v205
v_cvt_pk_bf16_f32 v97, v206, v207
v_mfma_f32_16x16x32_bf16 a[4:7], v[228:231], v[148:151], a[4:7]
v_exp_f32 v208, v208
v_mfma_f32_16x16x32_bf16 a[8:11], v[224:227], v[136:139], a[8:11]
ds_read_b64_tr_b16 v[244:245], v249 offset:49664
ds_read_b64_tr_b16 v[246:247], v249 offset:51712
v_mfma_f32_16x16x32_bf16 a[8:11], v[228:231], v[152:155], a[8:11]
v_exp_f32 v209, v209
v_mfma_f32_16x16x32_bf16 a[12:15], v[224:227], v[140:143], a[12:15]
v_exp_f32 v210, v210
v_mfma_f32_16x16x32_bf16 a[12:15], v[228:231], v[156:159], a[12:15]
s_waitcnt lgkmcnt(4)
v_cvt_pk_bf16_f32 v2, v208, v209
v_mfma_f32_16x16x32_bf16 a[16:19], v[232:235], v[128:131], a[16:19]
ds_read_b64_tr_b16 v[224:225], v12 offset:512
ds_read_b64_tr_b16 v[226:227], v12 offset:2560
v_mfma_f32_16x16x32_bf16 a[16:19], v[236:239], v[144:147], a[16:19]
v_exp_f32 v211, v211
v_mfma_f32_16x16x32_bf16 a[20:23], v[232:235], v[132:135], a[20:23]
v_cvt_pk_bf16_f32 v3, v210, v211
v_mfma_f32_16x16x32_bf16 a[20:23], v[236:239], v[148:151], a[20:23]
v_exp_f32 v212, v212
v_mfma_f32_16x16x32_bf16 a[24:27], v[232:235], v[136:139], a[24:27]
ds_read_b64_tr_b16 v[228:229], v12 offset:16896
ds_read_b64_tr_b16 v[230:231], v12 offset:18944
v_mfma_f32_16x16x32_bf16 a[24:27], v[236:239], v[152:155], a[24:27]
v_exp_f32 v213, v213
v_mfma_f32_16x16x32_bf16 a[28:31], v[232:235], v[140:143], a[28:31]
v_exp_f32 v214, v214
v_mfma_f32_16x16x32_bf16 a[28:31], v[236:239], v[156:159], a[28:31]
s_waitcnt lgkmcnt(4)
v_cvt_pk_bf16_f32 v34, v212, v213
v_mfma_f32_16x16x32_bf16 a[32:35], v[240:243], v[4:7], a[32:35]
ds_read_b64_tr_b16 v[232:233], v250 offset:33280
ds_read_b64_tr_b16 v[234:235], v250 offset:35328
v_mfma_f32_16x16x32_bf16 a[32:35], v[244:247], v[176:179], a[32:35]
v_exp_f32 v215, v215
v_mfma_f32_16x16x32_bf16 a[36:39], v[240:243], v[36:39], a[36:39]
v_cvt_pk_bf16_f32 v35, v214, v215
v_mfma_f32_16x16x32_bf16 a[36:39], v[244:247], v[180:183], a[36:39]
v_exp_f32 v216, v216
v_mfma_f32_16x16x32_bf16 a[40:43], v[240:243], v[68:71], a[40:43]
ds_read_b64_tr_b16 v[236:237], v250 offset:49664
ds_read_b64_tr_b16 v[238:239], v250 offset:51712
v_mfma_f32_16x16x32_bf16 a[40:43], v[244:247], v[184:187], a[40:43]
v_exp_f32 v217, v217
v_mfma_f32_16x16x32_bf16 a[44:47], v[240:243], v[100:103], a[44:47]
v_exp_f32 v218, v218
v_mfma_f32_16x16x32_bf16 a[44:47], v[244:247], v[188:191], a[44:47]
s_waitcnt lgkmcnt(4)
v_cvt_pk_bf16_f32 v66, v216, v217
v_mfma_f32_16x16x32_bf16 a[32:35], v[224:227], v[128:131], a[32:35]
ds_read_b64_tr_b16 v[240:241], v12 offset:32768
ds_read_b64_tr_b16 v[242:243], v12 offset:34816
v_mfma_f32_16x16x32_bf16 a[32:35], v[228:231], v[144:147], a[32:35]
v_exp_f32 v219, v219
v_mfma_f32_16x16x32_bf16 a[36:39], v[224:227], v[132:135], a[36:39]
v_cvt_pk_bf16_f32 v67, v218, v219
v_mfma_f32_16x16x32_bf16 a[36:39], v[228:231], v[148:151], a[36:39]
v_exp_f32 v220, v220
v_mfma_f32_16x16x32_bf16 a[40:43], v[224:227], v[136:139], a[40:43]
ds_read_b64_tr_b16 v[244:245], v12 offset:49152
ds_read_b64_tr_b16 v[246:247], v12 offset:51200
v_mfma_f32_16x16x32_bf16 a[40:43], v[228:231], v[152:155], a[40:43]
v_exp_f32 v221, v221
v_mfma_f32_16x16x32_bf16 a[44:47], v[224:227], v[140:143], a[44:47]
v_exp_f32 v222, v222
v_mfma_f32_16x16x32_bf16 a[44:47], v[228:231], v[156:159], a[44:47]
s_waitcnt lgkmcnt(4)
v_cvt_pk_bf16_f32 v98, v220, v221
v_mfma_f32_16x16x32_bf16 a[48:51], v[232:235], v[4:7], a[48:51]
ds_read_b64_tr_b16 v[224:225], v13 offset:32768
ds_read_b64_tr_b16 v[226:227], v13 offset:34816
v_mfma_f32_16x16x32_bf16 a[48:51], v[236:239], v[176:179], a[48:51]
v_exp_f32 v223, v223
v_mfma_f32_16x16x32_bf16 a[52:55], v[232:235], v[36:39], a[52:55]
v_cvt_pk_bf16_f32 v99, v222, v223
v_mfma_f32_16x16x32_bf16 a[52:55], v[236:239], v[180:183], a[52:55]
v_mfma_f32_16x16x32_bf16 a[56:59], v[232:235], v[68:71], a[56:59]
ds_read_b64_tr_b16 v[228:229], v13 offset:49152
ds_read_b64_tr_b16 v[230:231], v13 offset:51200
v_mfma_f32_16x16x32_bf16 a[56:59], v[236:239], v[184:187], a[56:59]
v_mfma_f32_16x16x32_bf16 a[60:63], v[232:235], v[100:103], a[60:63]
v_mfma_f32_16x16x32_bf16 a[60:63], v[236:239], v[188:191], a[60:63]
s_waitcnt lgkmcnt(4)
v_mfma_f32_16x16x32_bf16 a[0:3], v[240:243], v[160:163], a[0:3]
ds_read_b64_tr_b16 v[232:233], v12 offset:33280
ds_read_b64_tr_b16 v[234:235], v12 offset:35328
v_mfma_f32_16x16x32_bf16 a[0:3], v[244:247], v[0:3], a[0:3]
v_mfma_f32_16x16x32_bf16 a[4:7], v[240:243], v[164:167], a[4:7]
v_mfma_f32_16x16x32_bf16 a[4:7], v[244:247], v[32:35], a[4:7]
v_mfma_f32_16x16x32_bf16 a[8:11], v[240:243], v[168:171], a[8:11]
ds_read_b64_tr_b16 v[236:237], v12 offset:49664
ds_read_b64_tr_b16 v[238:239], v12 offset:51712
v_mfma_f32_16x16x32_bf16 a[8:11], v[244:247], v[64:67], a[8:11]
v_mfma_f32_16x16x32_bf16 a[12:15], v[240:243], v[172:175], a[12:15]
v_mfma_f32_16x16x32_bf16 a[12:15], v[244:247], v[96:99], a[12:15]
s_waitcnt lgkmcnt(4)
v_mfma_f32_16x16x32_bf16 a[16:19], v[224:227], v[160:163], a[16:19]
ds_read_b64_tr_b16 v[240:241], v13 offset:512
ds_read_b64_tr_b16 v[242:243], v13 offset:2560
v_mfma_f32_16x16x32_bf16 a[16:19], v[228:231], v[0:3], a[16:19]
v_mfma_f32_16x16x32_bf16 a[20:23], v[224:227], v[164:167], a[20:23]
v_mfma_f32_16x16x32_bf16 a[20:23], v[228:231], v[32:35], a[20:23]
v_mfma_f32_16x16x32_bf16 a[24:27], v[224:227], v[168:171], a[24:27]
ds_read_b64_tr_b16 v[244:245], v13 offset:16896
ds_read_b64_tr_b16 v[246:247], v13 offset:18944
v_accvgpr_read_b32 v192, a0
v_mfma_f32_16x16x32_bf16 a[24:27], v[228:231], v[64:67], a[24:27]
v_accvgpr_read_b32 v193, a4
v_accvgpr_read_b32 v194, a8
v_accvgpr_read_b32 v195, a12
v_mfma_f32_16x16x32_bf16 a[28:31], v[224:227], v[172:175], a[28:31]
v_lshlrev_b32 v253, 2, v252
v_subrev_u32 v196, 0x0d800000, v192
v_subrev_u32 v197, 0x0d800000, v193
v_mfma_f32_16x16x32_bf16 a[28:31], v[228:231], v[96:99], a[28:31]
s_waitcnt lgkmcnt(4)
v_subrev_u32 v198, 0x0d800000, v194
v_subrev_u32 v199, 0x0d800000, v195
v_mfma_f32_16x16x32_bf16 a[32:35], v[232:235], v[160:163], a[32:35]
ds_read_b64_tr_b16 v[224:225], v13 offset:33280
ds_read_b64_tr_b16 v[226:227], v13 offset:35328
v_max3_u32 v254, v196, v197, v198
v_mfma_f32_16x16x32_bf16 a[32:35], v[236:239], v[0:3], a[32:35]
v_max_u32 v254, v254, v199
v_mfma_f32_16x16x32_bf16 a[36:39], v[232:235], v[164:167], a[36:39]
s_mov_b64 exec, 0xffff
s_xor_b32 s35, s48, 0
buffer_store_dword v192, v253, s[24:27], s35 offen offset:4 sc1
s_xor_b32 s35, s48, 1024
buffer_store_dword v193, v253, s[24:27], s35 offen offset:4 sc1
s_xor_b32 s35, s48, 2048
buffer_store_dword v194, v253, s[24:27], s35 offen offset:4 sc1
s_xor_b32 s35, s48, 3072
buffer_store_dword v195, v253, s[24:27], s35 offen offset:4 sc1
v_cmp_le_u32 vcc, 0x64000000, v254
s_mov_b64 exec, -1
v_mfma_f32_16x16x32_bf16 a[36:39], v[236:239], v[32:35], a[36:39]
v_accvgpr_read_b32 v192, a0
v_accvgpr_read_b32 v193, a1
v_mfma_f32_16x16x32_bf16 a[40:43], v[232:235], v[168:171], a[40:43]
ds_read_b64_tr_b16 v[228:229], v13 offset:49664
ds_read_b64_tr_b16 v[230:231], v13 offset:51712
v_mfma_f32_16x16x32_bf16 a[40:43], v[236:239], v[64:67], a[40:43]
v_accvgpr_read_b32 v194, a2
v_accvgpr_read_b32 v195, a3
v_mfma_f32_16x16x32_bf16 a[44:47], v[232:235], v[172:175], a[44:47]
v_cvt_pk_bf16_f32 v16, v192, v193
v_cvt_pk_bf16_f32 v17, v194, v195
v_mfma_f32_16x16x32_bf16 a[44:47], v[236:239], v[96:99], a[44:47]
s_waitcnt lgkmcnt(4)
v_accvgpr_read_b32 v200, a4
v_mfma_f32_16x16x32_bf16 a[48:51], v[240:243], v[128:131], a[48:51]
ds_read_b64_tr_b16 v[232:233], v249 offset:36864
ds_read_b64_tr_b16 v[234:235], v249 offset:38912
v_mfma_f32_16x16x32_bf16 a[48:51], v[244:247], v[144:147], a[48:51]
v_accvgpr_read_b32 v201, a5
v_accvgpr_read_b32 v202, a6
v_mfma_f32_16x16x32_bf16 a[52:55], v[240:243], v[132:135], a[52:55]
v_accvgpr_read_b32 v203, a7
v_cvt_pk_bf16_f32 v48, v200, v201
v_mfma_f32_16x16x32_bf16 a[52:55], v[244:247], v[148:151], a[52:55]
v_cvt_pk_bf16_f32 v49, v202, v203
v_accvgpr_read_b32 v208, a8
v_mfma_f32_16x16x32_bf16 a[56:59], v[240:243], v[136:139], a[56:59]
ds_read_b64_tr_b16 v[236:237], v249 offset:53248
ds_read_b64_tr_b16 v[238:239], v249 offset:55296
v_mfma_f32_16x16x32_bf16 a[56:59], v[244:247], v[152:155], a[56:59]
v_accvgpr_read_b32 v209, a9
v_accvgpr_read_b32 v210, a10
v_mfma_f32_16x16x32_bf16 a[60:63], v[240:243], v[140:143], a[60:63]
v_accvgpr_read_b32 v211, a11
v_cvt_pk_bf16_f32 v80, v208, v209
v_mfma_f32_16x16x32_bf16 a[60:63], v[244:247], v[156:159], a[60:63]
s_waitcnt lgkmcnt(4)
v_cvt_pk_bf16_f32 v81, v210, v211
v_mfma_f32_16x16x32_bf16 a[48:51], v[224:227], v[160:163], a[48:51]
ds_read_b64_tr_b16 v[240:241], v12 offset:4096
ds_read_b64_tr_b16 v[242:243], v12 offset:6144
v_mfma_f32_16x16x32_bf16 a[48:51], v[228:231], v[0:3], a[48:51]
v_accvgpr_read_b32 v216, a12
v_accvgpr_read_b32 v217, a13
v_mfma_f32_16x16x32_bf16 a[52:55], v[224:227], v[164:167], a[52:55]
v_accvgpr_read_b32 v218, a14
v_accvgpr_read_b32 v219, a15
v_mfma_f32_16x16x32_bf16 a[52:55], v[228:231], v[32:35], a[52:55]
v_cvt_pk_bf16_f32 v112, v216, v217
v_cvt_pk_bf16_f32 v113, v218, v219
v_mfma_f32_16x16x32_bf16 a[56:59], v[224:227], v[168:171], a[56:59]
ds_read_b64_tr_b16 v[244:245], v12 offset:20480
ds_read_b64_tr_b16 v[246:247], v12 offset:22528
v_mfma_f32_16x16x32_bf16 a[56:59], v[228:231], v[64:67], a[56:59]
v_accvgpr_read_b32 v196, a16
v_accvgpr_read_b32 v197, a17
v_mfma_f32_16x16x32_bf16 a[60:63], v[224:227], v[172:175], a[60:63]
v_accvgpr_read_b32 v198, a18
v_accvgpr_read_b32 v199, a19
v_mfma_f32_16x16x32_bf16 a[60:63], v[228:231], v[96:99], a[60:63]
s_waitcnt lgkmcnt(4)
v_cvt_pk_bf16_f32 v18, v196, v197
v_mfma_f32_16x16x32_bf16 a[64:67], v[232:235], v[4:7], a[64:67]
ds_read_b64_tr_b16 v[224:225], v12 offset:36864
ds_read_b64_tr_b16 v[226:227], v12 offset:38912
v_mfma_f32_16x16x32_bf16 a[64:67], v[236:239], v[176:179], a[64:67]
v_cvt_pk_bf16_f32 v19, v198, v199
buffer_store_dwordx4 v[16:19], v252, s[20:23], s40 offen offset:0 sc1
v_mfma_f32_16x16x32_bf16 a[68:71], v[232:235], v[36:39], a[68:71]
ds_write_b128 v255, v[16:19] offset:0
v_accvgpr_read_b32 v204, a20
v_mfma_f32_16x16x32_bf16 a[68:71], v[236:239], v[180:183], a[68:71]
v_accvgpr_read_b32 v205, a21
v_accvgpr_read_b32 v206, a22
v_mfma_f32_16x16x32_bf16 a[72:75], v[232:235], v[68:71], a[72:75]
ds_read_b64_tr_b16 v[228:229], v12 offset:53248
ds_read_b64_tr_b16 v[230:231], v12 offset:55296
v_mfma_f32_16x16x32_bf16 a[72:75], v[236:239], v[184:187], a[72:75]
v_accvgpr_read_b32 v207, a23
v_cvt_pk_bf16_f32 v50, v204, v205
v_mfma_f32_16x16x32_bf16 a[76:79], v[232:235], v[100:103], a[76:79]
v_cvt_pk_bf16_f32 v51, v206, v207
buffer_store_dwordx4 v[48:51], v252, s[20:23], s41 offen offset:0 sc1
v_mfma_f32_16x16x32_bf16 a[76:79], v[236:239], v[188:191], a[76:79]
s_waitcnt lgkmcnt(5)
v_accvgpr_read_b32 v212, a24
v_mfma_f32_16x16x32_bf16 a[64:67], v[240:243], v[128:131], a[64:67]
ds_read_b64_tr_b16 v[232:233], v250 offset:36864
ds_read_b64_tr_b16 v[234:235], v250 offset:38912
v_mfma_f32_16x16x32_bf16 a[64:67], v[244:247], v[144:147], a[64:67]
v_accvgpr_read_b32 v213, a25
v_accvgpr_read_b32 v214, a26
v_mfma_f32_16x16x32_bf16 a[68:71], v[240:243], v[132:135], a[68:71]
v_accvgpr_read_b32 v215, a27
v_cvt_pk_bf16_f32 v82, v212, v213
v_mfma_f32_16x16x32_bf16 a[68:71], v[244:247], v[148:151], a[68:71]
v_cvt_pk_bf16_f32 v83, v214, v215
buffer_store_dwordx4 v[80:83], v252, s[20:23], s42 offen offset:0 sc1
v_mfma_f32_16x16x32_bf16 a[72:75], v[240:243], v[136:139], a[72:75]
ds_read_b64_tr_b16 v[236:237], v250 offset:53248
ds_read_b64_tr_b16 v[238:239], v250 offset:55296
v_mfma_f32_16x16x32_bf16 a[72:75], v[244:247], v[152:155], a[72:75]
v_accvgpr_read_b32 v220, a28
v_accvgpr_read_b32 v221, a29
v_mfma_f32_16x16x32_bf16 a[76:79], v[240:243], v[140:143], a[76:79]
v_accvgpr_read_b32 v222, a30
v_accvgpr_read_b32 v223, a31
v_mfma_f32_16x16x32_bf16 a[76:79], v[244:247], v[156:159], a[76:79]
s_waitcnt lgkmcnt(4)
v_cvt_pk_bf16_f32 v114, v220, v221
v_mfma_f32_16x16x32_bf16 a[64:67], v[224:227], v[160:163], a[64:67]
ds_read_b64_tr_b16 v[240:241], v13 offset:4096
ds_read_b64_tr_b16 v[242:243], v13 offset:6144
v_mfma_f32_16x16x32_bf16 a[64:67], v[228:231], v[0:3], a[64:67]
v_cvt_pk_bf16_f32 v115, v222, v223
buffer_store_dwordx4 v[112:115], v252, s[20:23], s43 offen offset:0 sc1
v_mfma_f32_16x16x32_bf16 a[68:71], v[224:227], v[164:167], a[68:71]
v_accvgpr_read_b32 v192, a32
v_accvgpr_read_b32 v193, a33
v_mfma_f32_16x16x32_bf16 a[68:71], v[228:231], v[32:35], a[68:71]
v_accvgpr_read_b32 v194, a34
v_accvgpr_read_b32 v195, a35
v_mfma_f32_16x16x32_bf16 a[72:75], v[224:227], v[168:171], a[72:75]
ds_read_b64_tr_b16 v[244:245], v13 offset:20480
ds_read_b64_tr_b16 v[246:247], v13 offset:22528
v_mfma_f32_16x16x32_bf16 a[72:75], v[228:231], v[64:67], a[72:75]
v_cvt_pk_bf16_f32 v20, v192, v193
v_cvt_pk_bf16_f32 v21, v194, v195
v_mfma_f32_16x16x32_bf16 a[76:79], v[224:227], v[172:175], a[76:79]
v_accvgpr_read_b32 v200, a36
v_accvgpr_read_b32 v201, a37
v_mfma_f32_16x16x32_bf16 a[76:79], v[228:231], v[96:99], a[76:79]
s_waitcnt lgkmcnt(4)
v_accvgpr_read_b32 v202, a38
v_mfma_f32_16x16x32_bf16 a[80:83], v[232:235], v[4:7], a[80:83]
ds_read_b64_tr_b16 v[224:225], v13 offset:36864
ds_read_b64_tr_b16 v[226:227], v13 offset:38912
v_mfma_f32_16x16x32_bf16 a[80:83], v[236:239], v[176:179], a[80:83]
v_accvgpr_read_b32 v203, a39
v_cvt_pk_bf16_f32 v52, v200, v201
v_mfma_f32_16x16x32_bf16 a[84:87], v[232:235], v[36:39], a[84:87]
v_cvt_pk_bf16_f32 v53, v202, v203
v_accvgpr_read_b32 v208, a40
v_mfma_f32_16x16x32_bf16 a[84:87], v[236:239], v[180:183], a[84:87]
v_accvgpr_read_b32 v209, a41
v_accvgpr_read_b32 v210, a42
v_mfma_f32_16x16x32_bf16 a[88:91], v[232:235], v[68:71], a[88:91]
ds_read_b64_tr_b16 v[228:229], v13 offset:53248
ds_read_b64_tr_b16 v[230:231], v13 offset:55296
v_mfma_f32_16x16x32_bf16 a[88:91], v[236:239], v[184:187], a[88:91]
v_accvgpr_read_b32 v211, a43
v_cvt_pk_bf16_f32 v84, v208, v209
v_mfma_f32_16x16x32_bf16 a[92:95], v[232:235], v[100:103], a[92:95]
v_cvt_pk_bf16_f32 v85, v210, v211
v_accvgpr_read_b32 v216, a44
v_mfma_f32_16x16x32_bf16 a[92:95], v[236:239], v[188:191], a[92:95]
s_waitcnt lgkmcnt(4)
v_accvgpr_read_b32 v217, a45
v_mfma_f32_16x16x32_bf16 a[80:83], v[240:243], v[128:131], a[80:83]
ds_read_b64_tr_b16 v[232:233], v249 offset:37376
ds_read_b64_tr_b16 v[234:235], v249 offset:39424
v_mfma_f32_16x16x32_bf16 a[80:83], v[244:247], v[144:147], a[80:83]
v_accvgpr_read_b32 v218, a46
v_accvgpr_read_b32 v219, a47
v_mfma_f32_16x16x32_bf16 a[84:87], v[240:243], v[132:135], a[84:87]
v_cvt_pk_bf16_f32 v116, v216, v217
v_cvt_pk_bf16_f32 v117, v218, v219
v_mfma_f32_16x16x32_bf16 a[84:87], v[244:247], v[148:151], a[84:87]
v_accvgpr_read_b32 v196, a48
v_accvgpr_read_b32 v197, a49
v_mfma_f32_16x16x32_bf16 a[88:91], v[240:243], v[136:139], a[88:91]
ds_read_b64_tr_b16 v[236:237], v249 offset:53760
ds_read_b64_tr_b16 v[238:239], v249 offset:55808
v_mfma_f32_16x16x32_bf16 a[88:91], v[244:247], v[152:155], a[88:91]
v_accvgpr_read_b32 v198, a50
v_accvgpr_read_b32 v199, a51
v_mfma_f32_16x16x32_bf16 a[92:95], v[240:243], v[140:143], a[92:95]
v_cvt_pk_bf16_f32 v22, v196, v197
v_cvt_pk_bf16_f32 v23, v198, v199
v_mfma_f32_16x16x32_bf16 a[92:95], v[244:247], v[156:159], a[92:95]
s_waitcnt lgkmcnt(4)
buffer_store_dwordx4 v[20:23], v252, s[20:23], s40 offen offset:1024 sc1
v_mfma_f32_16x16x32_bf16 a[80:83], v[224:227], v[160:163], a[80:83]
ds_read_b64_tr_b16 v[240:241], v12 offset:4608
ds_read_b64_tr_b16 v[242:243], v12 offset:6656
v_mfma_f32_16x16x32_bf16 a[80:83], v[228:231], v[0:3], a[80:83]
ds_write_b128 v255, v[20:23] offset:1024
v_accvgpr_read_b32 v204, a52
v_mfma_f32_16x16x32_bf16 a[84:87], v[224:227], v[164:167], a[84:87]
v_accvgpr_read_b32 v205, a53
v_accvgpr_read_b32 v206, a54
v_mfma_f32_16x16x32_bf16 a[84:87], v[228:231], v[32:35], a[84:87]
v_accvgpr_read_b32 v207, a55
v_cvt_pk_bf16_f32 v54, v204, v205
v_mfma_f32_16x16x32_bf16 a[88:91], v[224:227], v[168:171], a[88:91]
ds_read_b64_tr_b16 v[244:245], v12 offset:20992
ds_read_b64_tr_b16 v[246:247], v12 offset:23040
v_mfma_f32_16x16x32_bf16 a[88:91], v[228:231], v[64:67], a[88:91]
v_cvt_pk_bf16_f32 v55, v206, v207
buffer_store_dwordx4 v[52:55], v252, s[20:23], s41 offen offset:1024 sc1
v_mfma_f32_16x16x32_bf16 a[92:95], v[224:227], v[172:175], a[92:95]
v_accvgpr_read_b32 v212, a56
v_accvgpr_read_b32 v213, a57
v_mfma_f32_16x16x32_bf16 a[92:95], v[228:231], v[96:99], a[92:95]
s_waitcnt lgkmcnt(5)
v_accvgpr_read_b32 v214, a58
v_mfma_f32_16x16x32_bf16 a[96:99], v[232:235], v[4:7], a[96:99]
ds_read_b64_tr_b16 v[224:225], v12 offset:37376
ds_read_b64_tr_b16 v[226:227], v12 offset:39424
v_mfma_f32_16x16x32_bf16 a[96:99], v[236:239], v[176:179], a[96:99]
v_accvgpr_read_b32 v215, a59
v_cvt_pk_bf16_f32 v86, v212, v213
v_mfma_f32_16x16x32_bf16 a[100:103], v[232:235], v[36:39], a[100:103]
v_cvt_pk_bf16_f32 v87, v214, v215
buffer_store_dwordx4 v[84:87], v252, s[20:23], s42 offen offset:1024 sc1
v_mfma_f32_16x16x32_bf16 a[100:103], v[236:239], v[180:183], a[100:103]
v_accvgpr_read_b32 v220, a60
v_accvgpr_read_b32 v221, a61
v_mfma_f32_16x16x32_bf16 a[104:107], v[232:235], v[68:71], a[104:107]
ds_read_b64_tr_b16 v[228:229], v12 offset:53760
ds_read_b64_tr_b16 v[230:231], v12 offset:55808
v_mfma_f32_16x16x32_bf16 a[104:107], v[236:239], v[184:187], a[104:107]
v_accvgpr_read_b32 v222, a62
v_accvgpr_read_b32 v223, a63
v_mfma_f32_16x16x32_bf16 a[108:111], v[232:235], v[100:103], a[108:111]
v_cvt_pk_bf16_f32 v118, v220, v221
v_cvt_pk_bf16_f32 v119, v222, v223
v_mfma_f32_16x16x32_bf16 a[108:111], v[236:239], v[188:191], a[108:111]
s_waitcnt lgkmcnt(4)
buffer_store_dwordx4 v[116:119], v252, s[20:23], s43 offen offset:1024 sc1
v_mfma_f32_16x16x32_bf16 a[96:99], v[240:243], v[128:131], a[96:99]
ds_read_b64_tr_b16 v[232:233], v250 offset:37376
ds_read_b64_tr_b16 v[234:235], v250 offset:39424
v_mfma_f32_16x16x32_bf16 a[96:99], v[244:247], v[144:147], a[96:99]
v_accvgpr_read_b32 v192, a64
v_accvgpr_read_b32 v193, a65
v_mfma_f32_16x16x32_bf16 a[100:103], v[240:243], v[132:135], a[100:103]
v_accvgpr_read_b32 v194, a66
v_accvgpr_read_b32 v195, a67
v_mfma_f32_16x16x32_bf16 a[100:103], v[244:247], v[148:151], a[100:103]
v_cvt_pk_bf16_f32 v24, v192, v193
v_cvt_pk_bf16_f32 v25, v194, v195
v_mfma_f32_16x16x32_bf16 a[104:107], v[240:243], v[136:139], a[104:107]
ds_read_b64_tr_b16 v[236:237], v250 offset:53760
ds_read_b64_tr_b16 v[238:239], v250 offset:55808
v_mfma_f32_16x16x32_bf16 a[104:107], v[244:247], v[152:155], a[104:107]
v_accvgpr_read_b32 v200, a68
v_accvgpr_read_b32 v201, a69
v_mfma_f32_16x16x32_bf16 a[108:111], v[240:243], v[140:143], a[108:111]
v_accvgpr_read_b32 v202, a70
v_accvgpr_read_b32 v203, a71
v_mfma_f32_16x16x32_bf16 a[108:111], v[244:247], v[156:159], a[108:111]
s_waitcnt lgkmcnt(4)
v_cvt_pk_bf16_f32 v56, v200, v201
v_mfma_f32_16x16x32_bf16 a[96:99], v[224:227], v[160:163], a[96:99]
ds_read_b64_tr_b16 v[240:241], v13 offset:4608
ds_read_b64_tr_b16 v[242:243], v13 offset:6656
v_mfma_f32_16x16x32_bf16 a[96:99], v[228:231], v[0:3], a[96:99]
v_cvt_pk_bf16_f32 v57, v202, v203
v_accvgpr_read_b32 v208, a72
v_mfma_f32_16x16x32_bf16 a[100:103], v[224:227], v[164:167], a[100:103]
v_accvgpr_read_b32 v209, a73
v_accvgpr_read_b32 v210, a74
v_mfma_f32_16x16x32_bf16 a[100:103], v[228:231], v[32:35], a[100:103]
v_accvgpr_read_b32 v211, a75
v_cvt_pk_bf16_f32 v88, v208, v209
v_mfma_f32_16x16x32_bf16 a[104:107], v[224:227], v[168:171], a[104:107]
ds_read_b64_tr_b16 v[244:245], v13 offset:20992
ds_read_b64_tr_b16 v[246:247], v13 offset:23040
v_mfma_f32_16x16x32_bf16 a[104:107], v[228:231], v[64:67], a[104:107]
v_cvt_pk_bf16_f32 v89, v210, v211
v_accvgpr_read_b32 v216, a76
v_mfma_f32_16x16x32_bf16 a[108:111], v[224:227], v[172:175], a[108:111]
v_accvgpr_read_b32 v217, a77
v_accvgpr_read_b32 v218, a78
v_mfma_f32_16x16x32_bf16 a[108:111], v[228:231], v[96:99], a[108:111]
s_waitcnt lgkmcnt(4)
v_accvgpr_read_b32 v219, a79
v_mfma_f32_16x16x32_bf16 a[112:115], v[232:235], v[4:7], a[112:115]
ds_read_b64_tr_b16 v[224:225], v13 offset:37376
ds_read_b64_tr_b16 v[226:227], v13 offset:39424
v_mfma_f32_16x16x32_bf16 a[112:115], v[236:239], v[176:179], a[112:115]
v_cvt_pk_bf16_f32 v120, v216, v217
v_cvt_pk_bf16_f32 v121, v218, v219
v_mfma_f32_16x16x32_bf16 a[116:119], v[232:235], v[36:39], a[116:119]
v_accvgpr_read_b32 v196, a80
v_accvgpr_read_b32 v197, a81
v_mfma_f32_16x16x32_bf16 a[116:119], v[236:239], v[180:183], a[116:119]
v_accvgpr_read_b32 v198, a82
v_accvgpr_read_b32 v199, a83
v_mfma_f32_16x16x32_bf16 a[120:123], v[232:235], v[68:71], a[120:123]
ds_read_b64_tr_b16 v[228:229], v13 offset:53760
ds_read_b64_tr_b16 v[230:231], v13 offset:55808
v_mfma_f32_16x16x32_bf16 a[120:123], v[236:239], v[184:187], a[120:123]
v_cvt_pk_bf16_f32 v26, v196, v197
v_cvt_pk_bf16_f32 v27, v198, v199
v_mfma_f32_16x16x32_bf16 a[124:127], v[232:235], v[100:103], a[124:127]
buffer_store_dwordx4 v[24:27], v252, s[20:23], s40 offen offset:2048 sc1
ds_write_b128 v255, v[24:27] offset:2048
v_mfma_f32_16x16x32_bf16 a[124:127], v[236:239], v[188:191], a[124:127]
s_waitcnt lgkmcnt(5)
v_accvgpr_read_b32 v204, a84
v_mfma_f32_16x16x32_bf16 a[112:115], v[240:243], v[128:131], a[112:115]
ds_read_b64_tr_b16 v[232:233], v249 offset:40960
ds_read_b64_tr_b16 v[234:235], v249 offset:43008
v_mfma_f32_16x16x32_bf16 a[112:115], v[244:247], v[144:147], a[112:115]
v_accvgpr_read_b32 v205, a85
v_accvgpr_read_b32 v206, a86
v_mfma_f32_16x16x32_bf16 a[116:119], v[240:243], v[132:135], a[116:119]
v_accvgpr_read_b32 v207, a87
v_cvt_pk_bf16_f32 v58, v204, v205
v_mfma_f32_16x16x32_bf16 a[116:119], v[244:247], v[148:151], a[116:119]
v_cvt_pk_bf16_f32 v59, v206, v207
buffer_store_dwordx4 v[56:59], v252, s[20:23], s41 offen offset:2048 sc1
v_mfma_f32_16x16x32_bf16 a[120:123], v[240:243], v[136:139], a[120:123]
ds_read_b64_tr_b16 v[236:237], v249 offset:57344
ds_read_b64_tr_b16 v[238:239], v249 offset:59392
v_mfma_f32_16x16x32_bf16 a[120:123], v[244:247], v[152:155], a[120:123]
v_accvgpr_read_b32 v212, a88
v_accvgpr_read_b32 v213, a89
v_mfma_f32_16x16x32_bf16 a[124:127], v[240:243], v[140:143], a[124:127]
v_accvgpr_read_b32 v214, a90
v_accvgpr_read_b32 v215, a91
v_mfma_f32_16x16x32_bf16 a[124:127], v[244:247], v[156:159], a[124:127]
s_waitcnt lgkmcnt(5)
v_cvt_pk_bf16_f32 v90, v212, v213
v_mfma_f32_16x16x32_bf16 a[112:115], v[224:227], v[160:163], a[112:115]
ds_read_b64_tr_b16 v[240:241], v12 offset:8192
ds_read_b64_tr_b16 v[242:243], v12 offset:10240
v_mfma_f32_16x16x32_bf16 a[112:115], v[228:231], v[0:3], a[112:115]
v_cvt_pk_bf16_f32 v91, v214, v215
buffer_store_dwordx4 v[88:91], v252, s[20:23], s42 offen offset:2048 sc1
v_mfma_f32_16x16x32_bf16 a[116:119], v[224:227], v[164:167], a[116:119]
v_accvgpr_read_b32 v220, a92
v_accvgpr_read_b32 v221, a93
v_mfma_f32_16x16x32_bf16 a[116:119], v[228:231], v[32:35], a[116:119]
v_accvgpr_read_b32 v222, a94
v_accvgpr_read_b32 v223, a95
v_mfma_f32_16x16x32_bf16 a[120:123], v[224:227], v[168:171], a[120:123]
ds_read_b64_tr_b16 v[244:245], v12 offset:24576
ds_read_b64_tr_b16 v[246:247], v12 offset:26624
v_mfma_f32_16x16x32_bf16 a[120:123], v[228:231], v[64:67], a[120:123]
v_cvt_pk_bf16_f32 v122, v220, v221
v_cvt_pk_bf16_f32 v123, v222, v223
v_mfma_f32_16x16x32_bf16 a[124:127], v[224:227], v[172:175], a[124:127]
buffer_store_dwordx4 v[120:123], v252, s[20:23], s43 offen offset:2048 sc1
v_accvgpr_read_b32 v192, a96
v_mfma_f32_16x16x32_bf16 a[124:127], v[228:231], v[96:99], a[124:127]
s_waitcnt lgkmcnt(4)
v_accvgpr_read_b32 v193, a97
v_mfma_f32_16x16x32_bf16 a[128:131], v[232:235], v[4:7], a[128:131]
ds_read_b64_tr_b16 v[224:225], v12 offset:40960
ds_read_b64_tr_b16 v[226:227], v12 offset:43008
v_mfma_f32_16x16x32_bf16 a[128:131], v[236:239], v[176:179], a[128:131]
v_accvgpr_read_b32 v194, a98
v_accvgpr_read_b32 v195, a99
v_mfma_f32_16x16x32_bf16 a[132:135], v[232:235], v[36:39], a[132:135]
v_cvt_pk_bf16_f32 v28, v192, v193
v_cvt_pk_bf16_f32 v29, v194, v195
v_mfma_f32_16x16x32_bf16 a[132:135], v[236:239], v[180:183], a[132:135]
v_accvgpr_read_b32 v200, a100
v_accvgpr_read_b32 v201, a101
v_mfma_f32_16x16x32_bf16 a[136:139], v[232:235], v[68:71], a[136:139]
ds_read_b64_tr_b16 v[228:229], v12 offset:57344
ds_read_b64_tr_b16 v[230:231], v12 offset:59392
v_mfma_f32_16x16x32_bf16 a[136:139], v[236:239], v[184:187], a[136:139]
v_accvgpr_read_b32 v202, a102
v_accvgpr_read_b32 v203, a103
v_mfma_f32_16x16x32_bf16 a[140:143], v[232:235], v[100:103], a[140:143]
v_cvt_pk_bf16_f32 v60, v200, v201
v_cvt_pk_bf16_f32 v61, v202, v203
v_mfma_f32_16x16x32_bf16 a[140:143], v[236:239], v[188:191], a[140:143]
s_waitcnt lgkmcnt(4)
v_accvgpr_read_b32 v208, a104
v_mfma_f32_16x16x32_bf16 a[128:131], v[240:243], v[128:131], a[128:131]
ds_read_b64_tr_b16 v[232:233], v250 offset:40960
ds_read_b64_tr_b16 v[234:235], v250 offset:43008
v_mfma_f32_16x16x32_bf16 a[128:131], v[244:247], v[144:147], a[128:131]
v_accvgpr_read_b32 v209, a105
v_accvgpr_read_b32 v210, a106
v_mfma_f32_16x16x32_bf16 a[132:135], v[240:243], v[132:135], a[132:135]
v_accvgpr_read_b32 v211, a107
v_cvt_pk_bf16_f32 v92, v208, v209
v_mfma_f32_16x16x32_bf16 a[132:135], v[244:247], v[148:151], a[132:135]
v_cvt_pk_bf16_f32 v93, v210, v211
v_accvgpr_read_b32 v216, a108
v_mfma_f32_16x16x32_bf16 a[136:139], v[240:243], v[136:139], a[136:139]
ds_read_b64_tr_b16 v[236:237], v250 offset:57344
ds_read_b64_tr_b16 v[238:239], v250 offset:59392
v_mfma_f32_16x16x32_bf16 a[136:139], v[244:247], v[152:155], a[136:139]
v_accvgpr_read_b32 v217, a109
v_accvgpr_read_b32 v218, a110
v_mfma_f32_16x16x32_bf16 a[140:143], v[240:243], v[140:143], a[140:143]
v_accvgpr_read_b32 v219, a111
v_cvt_pk_bf16_f32 v124, v216, v217
v_mfma_f32_16x16x32_bf16 a[140:143], v[244:247], v[156:159], a[140:143]
s_waitcnt lgkmcnt(4)
v_cvt_pk_bf16_f32 v125, v218, v219
v_mfma_f32_16x16x32_bf16 a[128:131], v[224:227], v[160:163], a[128:131]
ds_read_b64_tr_b16 v[240:241], v13 offset:8192
ds_read_b64_tr_b16 v[242:243], v13 offset:10240
v_mfma_f32_16x16x32_bf16 a[128:131], v[228:231], v[0:3], a[128:131]
v_accvgpr_read_b32 v196, a112
v_accvgpr_read_b32 v197, a113
v_mfma_f32_16x16x32_bf16 a[132:135], v[224:227], v[164:167], a[132:135]
v_accvgpr_read_b32 v198, a114
v_accvgpr_read_b32 v199, a115
v_mfma_f32_16x16x32_bf16 a[132:135], v[228:231], v[32:35], a[132:135]
v_cvt_pk_bf16_f32 v30, v196, v197
v_cvt_pk_bf16_f32 v31, v198, v199
v_mfma_f32_16x16x32_bf16 a[136:139], v[224:227], v[168:171], a[136:139]
ds_read_b64_tr_b16 v[244:245], v13 offset:24576
ds_read_b64_tr_b16 v[246:247], v13 offset:26624
v_mfma_f32_16x16x32_bf16 a[136:139], v[228:231], v[64:67], a[136:139]
buffer_store_dwordx4 v[28:31], v252, s[20:23], s40 offen offset:3072 sc1
ds_write_b128 v255, v[28:31] offset:3072
v_mfma_f32_16x16x32_bf16 a[140:143], v[224:227], v[172:175], a[140:143]
v_accvgpr_read_b32 v204, a116
v_accvgpr_read_b32 v205, a117
v_mfma_f32_16x16x32_bf16 a[140:143], v[228:231], v[96:99], a[140:143]
s_waitcnt lgkmcnt(5)
v_accvgpr_read_b32 v206, a118
v_mfma_f32_16x16x32_bf16 a[144:147], v[232:235], v[4:7], a[144:147]
ds_read_b64_tr_b16 v[224:225], v13 offset:40960
ds_read_b64_tr_b16 v[226:227], v13 offset:43008
v_mfma_f32_16x16x32_bf16 a[144:147], v[236:239], v[176:179], a[144:147]
v_accvgpr_read_b32 v207, a119
v_cvt_pk_bf16_f32 v62, v204, v205
v_mfma_f32_16x16x32_bf16 a[148:151], v[232:235], v[36:39], a[148:151]
v_cvt_pk_bf16_f32 v63, v206, v207
buffer_store_dwordx4 v[60:63], v252, s[20:23], s41 offen offset:3072 sc1
v_mfma_f32_16x16x32_bf16 a[148:151], v[236:239], v[180:183], a[148:151]
v_accvgpr_read_b32 v212, a120
v_accvgpr_read_b32 v213, a121
v_mfma_f32_16x16x32_bf16 a[152:155], v[232:235], v[68:71], a[152:155]
ds_read_b64_tr_b16 v[228:229], v13 offset:57344
ds_read_b64_tr_b16 v[230:231], v13 offset:59392
v_mfma_f32_16x16x32_bf16 a[152:155], v[236:239], v[184:187], a[152:155]
v_accvgpr_read_b32 v214, a122
v_accvgpr_read_b32 v215, a123
v_mfma_f32_16x16x32_bf16 a[156:159], v[232:235], v[100:103], a[156:159]
v_cvt_pk_bf16_f32 v94, v212, v213
v_cvt_pk_bf16_f32 v95, v214, v215
v_mfma_f32_16x16x32_bf16 a[156:159], v[236:239], v[188:191], a[156:159]
s_waitcnt lgkmcnt(5)
buffer_store_dwordx4 v[92:95], v252, s[20:23], s42 offen offset:3072 sc1
v_mfma_f32_16x16x32_bf16 a[144:147], v[240:243], v[128:131], a[144:147]
ds_read_b64_tr_b16 v[232:233], v249 offset:41472
ds_read_b64_tr_b16 v[234:235], v249 offset:43520
v_mfma_f32_16x16x32_bf16 a[144:147], v[244:247], v[144:147], a[144:147]
v_accvgpr_read_b32 v220, a124
v_accvgpr_read_b32 v221, a125
v_mfma_f32_16x16x32_bf16 a[148:151], v[240:243], v[132:135], a[148:151]
v_accvgpr_read_b32 v222, a126
v_accvgpr_read_b32 v223, a127
v_mfma_f32_16x16x32_bf16 a[148:151], v[244:247], v[148:151], a[148:151]
v_cvt_pk_bf16_f32 v126, v220, v221
v_cvt_pk_bf16_f32 v127, v222, v223
v_mfma_f32_16x16x32_bf16 a[152:155], v[240:243], v[136:139], a[152:155]
ds_read_b64_tr_b16 v[236:237], v249 offset:57856
ds_read_b64_tr_b16 v[238:239], v249 offset:59904
v_mfma_f32_16x16x32_bf16 a[152:155], v[244:247], v[152:155], a[152:155]
buffer_store_dwordx4 v[124:127], v252, s[20:23], s43 offen offset:3072 sc1
v_accvgpr_read_b32 v192, a128
v_mfma_f32_16x16x32_bf16 a[156:159], v[240:243], v[140:143], a[156:159]
v_accvgpr_read_b32 v193, a129
v_accvgpr_read_b32 v194, a130
v_mfma_f32_16x16x32_bf16 a[156:159], v[244:247], v[156:159], a[156:159]
s_waitcnt lgkmcnt(4)
v_accvgpr_read_b32 v195, a131
v_mfma_f32_16x16x32_bf16 a[144:147], v[224:227], v[160:163], a[144:147]
ds_read_b64_tr_b16 v[240:241], v12 offset:8704
ds_read_b64_tr_b16 v[242:243], v12 offset:10752
v_mfma_f32_16x16x32_bf16 a[144:147], v[228:231], v[0:3], a[144:147]
v_cvt_pk_bf16_f32 v16, v192, v193
v_cvt_pk_bf16_f32 v17, v194, v195
v_mfma_f32_16x16x32_bf16 a[148:151], v[224:227], v[164:167], a[148:151]
v_accvgpr_read_b32 v200, a132
v_accvgpr_read_b32 v201, a133
v_mfma_f32_16x16x32_bf16 a[148:151], v[228:231], v[32:35], a[148:151]
v_accvgpr_read_b32 v202, a134
v_accvgpr_read_b32 v203, a135
v_mfma_f32_16x16x32_bf16 a[152:155], v[224:227], v[168:171], a[152:155]
ds_read_b64_tr_b16 v[244:245], v12 offset:25088
ds_read_b64_tr_b16 v[246:247], v12 offset:27136
v_mfma_f32_16x16x32_bf16 a[152:155], v[228:231], v[64:67], a[152:155]
v_cvt_pk_bf16_f32 v48, v200, v201
v_cvt_pk_bf16_f32 v49, v202, v203
v_mfma_f32_16x16x32_bf16 a[156:159], v[224:227], v[172:175], a[156:159]
v_accvgpr_read_b32 v208, a136
v_accvgpr_read_b32 v209, a137
v_mfma_f32_16x16x32_bf16 a[156:159], v[228:231], v[96:99], a[156:159]
s_waitcnt lgkmcnt(4)
v_accvgpr_read_b32 v210, a138
v_mfma_f32_16x16x32_bf16 a[160:163], v[232:235], v[4:7], a[160:163]
ds_read_b64_tr_b16 v[224:225], v12 offset:41472
ds_read_b64_tr_b16 v[226:227], v12 offset:43520
v_mfma_f32_16x16x32_bf16 a[160:163], v[236:239], v[176:179], a[160:163]
v_accvgpr_read_b32 v211, a139
v_cvt_pk_bf16_f32 v80, v208, v209
v_mfma_f32_16x16x32_bf16 a[164:167], v[232:235], v[36:39], a[164:167]
v_cvt_pk_bf16_f32 v81, v210, v211
v_accvgpr_read_b32 v216, a140
v_mfma_f32_16x16x32_bf16 a[164:167], v[236:239], v[180:183], a[164:167]
v_accvgpr_read_b32 v217, a141
v_accvgpr_read_b32 v218, a142
v_mfma_f32_16x16x32_bf16 a[168:171], v[232:235], v[68:71], a[168:171]
ds_read_b64_tr_b16 v[228:229], v12 offset:57856
ds_read_b64_tr_b16 v[230:231], v12 offset:59904
v_mfma_f32_16x16x32_bf16 a[168:171], v[236:239], v[184:187], a[168:171]
v_accvgpr_read_b32 v219, a143
v_cvt_pk_bf16_f32 v112, v216, v217
v_mfma_f32_16x16x32_bf16 a[172:175], v[232:235], v[100:103], a[172:175]
v_cvt_pk_bf16_f32 v113, v218, v219
v_accvgpr_read_b32 v196, a144
v_mfma_f32_16x16x32_bf16 a[172:175], v[236:239], v[188:191], a[172:175]
s_waitcnt lgkmcnt(4)
v_accvgpr_read_b32 v197, a145
v_mfma_f32_16x16x32_bf16 a[160:163], v[240:243], v[128:131], a[160:163]
ds_read_b64_tr_b16 v[232:233], v250 offset:41472
ds_read_b64_tr_b16 v[234:235], v250 offset:43520
v_mfma_f32_16x16x32_bf16 a[160:163], v[244:247], v[144:147], a[160:163]
v_accvgpr_read_b32 v198, a146
v_accvgpr_read_b32 v199, a147
v_mfma_f32_16x16x32_bf16 a[164:167], v[240:243], v[132:135], a[164:167]
v_cvt_pk_bf16_f32 v18, v196, v197
v_cvt_pk_bf16_f32 v19, v198, v199
v_mfma_f32_16x16x32_bf16 a[164:167], v[244:247], v[148:151], a[164:167]
buffer_store_dwordx4 v[16:19], v252, s[20:23], s44 offen offset:0 sc1
v_accvgpr_read_b32 v204, a148
v_mfma_f32_16x16x32_bf16 a[168:171], v[240:243], v[136:139], a[168:171]
ds_read_b64_tr_b16 v[236:237], v250 offset:57856
ds_read_b64_tr_b16 v[238:239], v250 offset:59904
v_mfma_f32_16x16x32_bf16 a[168:171], v[244:247], v[152:155], a[168:171]
v_accvgpr_read_b32 v205, a149
v_accvgpr_read_b32 v206, a150
v_mfma_f32_16x16x32_bf16 a[172:175], v[240:243], v[140:143], a[172:175]
v_accvgpr_read_b32 v207, a151
v_cvt_pk_bf16_f32 v50, v204, v205
s_mov_b32 s33, 0x6c01400
v_mfma_f32_16x16x32_bf16 a[172:175], v[244:247], v[156:159], a[172:175]
s_waitcnt lgkmcnt(4)
v_cvt_pk_bf16_f32 v51, v206, v207
buffer_load_dword v254, off, s[56:59], s33 sc1
v_mfma_f32_16x16x32_bf16 a[160:163], v[224:227], v[160:163], a[160:163]
ds_read_b64_tr_b16 v[240:241], v13 offset:8704
ds_read_b64_tr_b16 v[242:243], v13 offset:10752
v_mfma_f32_16x16x32_bf16 a[160:163], v[228:231], v[0:3], a[160:163]
buffer_store_dwordx4 v[48:51], v252, s[20:23], s45 offen offset:0 sc1
v_accvgpr_read_b32 v212, a152
v_mfma_f32_16x16x32_bf16 a[164:167], v[224:227], v[164:167], a[164:167]
v_accvgpr_read_b32 v213, a153
v_accvgpr_read_b32 v214, a154
v_mfma_f32_16x16x32_bf16 a[164:167], v[228:231], v[32:35], a[164:167]
v_accvgpr_read_b32 v215, a155
v_cvt_pk_bf16_f32 v82, v212, v213
v_mfma_f32_16x16x32_bf16 a[168:171], v[224:227], v[168:171], a[168:171]
ds_read_b64_tr_b16 v[244:245], v13 offset:25088
ds_read_b64_tr_b16 v[246:247], v13 offset:27136
v_mfma_f32_16x16x32_bf16 a[168:171], v[228:231], v[64:67], a[168:171]
v_cvt_pk_bf16_f32 v83, v214, v215
buffer_store_dwordx4 v[80:83], v252, s[20:23], s46 offen offset:0 sc1
v_mfma_f32_16x16x32_bf16 a[172:175], v[224:227], v[172:175], a[172:175]
v_accvgpr_read_b32 v220, a156
v_accvgpr_read_b32 v221, a157
v_mfma_f32_16x16x32_bf16 a[172:175], v[228:231], v[96:99], a[172:175]
s_waitcnt lgkmcnt(4)
v_accvgpr_read_b32 v222, a158
v_mfma_f32_16x16x32_bf16 a[176:179], v[232:235], v[4:7], a[176:179]
ds_read_b64_tr_b16 v[224:225], v13 offset:41472
ds_read_b64_tr_b16 v[226:227], v13 offset:43520
v_mfma_f32_16x16x32_bf16 a[176:179], v[236:239], v[176:179], a[176:179]
v_accvgpr_read_b32 v223, a159
v_cvt_pk_bf16_f32 v114, v220, v221
v_mfma_f32_16x16x32_bf16 a[180:183], v[232:235], v[36:39], a[180:183]
v_cvt_pk_bf16_f32 v115, v222, v223
buffer_store_dwordx4 v[112:115], v252, s[20:23], s47 offen offset:0 sc1
v_mfma_f32_16x16x32_bf16 a[180:183], v[236:239], v[180:183], a[180:183]
v_accvgpr_read_b32 v192, a160
v_accvgpr_read_b32 v193, a161
v_mfma_f32_16x16x32_bf16 a[184:187], v[232:235], v[68:71], a[184:187]
ds_read_b64_tr_b16 v[228:229], v13 offset:57856
ds_read_b64_tr_b16 v[230:231], v13 offset:59904
v_mfma_f32_16x16x32_bf16 a[184:187], v[236:239], v[184:187], a[184:187]
v_accvgpr_read_b32 v194, a162
v_accvgpr_read_b32 v195, a163
v_mfma_f32_16x16x32_bf16 a[188:191], v[232:235], v[100:103], a[188:191]
v_cvt_pk_bf16_f32 v20, v192, v193
v_cvt_pk_bf16_f32 v21, v194, v195
v_mfma_f32_16x16x32_bf16 a[188:191], v[236:239], v[188:191], a[188:191]
s_waitcnt lgkmcnt(4)
v_accvgpr_read_b32 v200, a164
v_mfma_f32_16x16x32_bf16 a[176:179], v[240:243], v[128:131], a[176:179]
ds_read_b64_tr_b16 v[232:233], v249 offset:45056
ds_read_b64_tr_b16 v[234:235], v249 offset:47104
v_mfma_f32_16x16x32_bf16 a[176:179], v[244:247], v[144:147], a[176:179]
v_accvgpr_read_b32 v201, a165
v_accvgpr_read_b32 v202, a166
v_mfma_f32_16x16x32_bf16 a[180:183], v[240:243], v[132:135], a[180:183]
v_accvgpr_read_b32 v203, a167
v_cvt_pk_bf16_f32 v52, v200, v201
v_mfma_f32_16x16x32_bf16 a[180:183], v[244:247], v[148:151], a[180:183]
v_cvt_pk_bf16_f32 v53, v202, v203
v_accvgpr_read_b32 v208, a168
v_mfma_f32_16x16x32_bf16 a[184:187], v[240:243], v[136:139], a[184:187]
ds_read_b64_tr_b16 v[236:237], v249 offset:61440
ds_read_b64_tr_b16 v[238:239], v249 offset:63488
v_mfma_f32_16x16x32_bf16 a[184:187], v[244:247], v[152:155], a[184:187]
v_accvgpr_read_b32 v209, a169
v_accvgpr_read_b32 v210, a170
v_mfma_f32_16x16x32_bf16 a[188:191], v[240:243], v[140:143], a[188:191]
v_accvgpr_read_b32 v211, a171
v_cvt_pk_bf16_f32 v84, v208, v209
v_mfma_f32_16x16x32_bf16 a[188:191], v[244:247], v[156:159], a[188:191]
s_waitcnt lgkmcnt(4)
v_cvt_pk_bf16_f32 v85, v210, v211
v_mfma_f32_16x16x32_bf16 a[176:179], v[224:227], v[160:163], a[176:179]
ds_read_b64_tr_b16 v[240:241], v12 offset:12288
ds_read_b64_tr_b16 v[242:243], v12 offset:14336
v_mfma_f32_16x16x32_bf16 a[176:179], v[228:231], v[0:3], a[176:179]
v_accvgpr_read_b32 v216, a172
v_accvgpr_read_b32 v217, a173
v_mfma_f32_16x16x32_bf16 a[180:183], v[224:227], v[164:167], a[180:183]
v_accvgpr_read_b32 v218, a174
v_accvgpr_read_b32 v219, a175
v_mfma_f32_16x16x32_bf16 a[180:183], v[228:231], v[32:35], a[180:183]
v_cvt_pk_bf16_f32 v116, v216, v217
v_cvt_pk_bf16_f32 v117, v218, v219
v_mfma_f32_16x16x32_bf16 a[184:187], v[224:227], v[168:171], a[184:187]
ds_read_b64_tr_b16 v[244:245], v12 offset:28672
ds_read_b64_tr_b16 v[246:247], v12 offset:30720
v_mfma_f32_16x16x32_bf16 a[184:187], v[228:231], v[64:67], a[184:187]
v_mfma_f32_16x16x32_bf16 a[188:191], v[224:227], v[172:175], a[188:191]
v_accvgpr_read_b32 v196, a176
v_accvgpr_read_b32 v197, a177
v_mfma_f32_16x16x32_bf16 a[188:191], v[228:231], v[96:99], a[188:191]
s_waitcnt lgkmcnt(4)
v_accvgpr_read_b32 v198, a178
v_mfma_f32_16x16x32_bf16 a[192:195], v[232:235], v[4:7], a[192:195]
ds_read_b64_tr_b16 v[224:225], v12 offset:45056
ds_read_b64_tr_b16 v[226:227], v12 offset:47104
v_mfma_f32_16x16x32_bf16 a[192:195], v[236:239], v[176:179], a[192:195]
v_accvgpr_read_b32 v199, a179
v_cvt_pk_bf16_f32 v22, v196, v197
v_mfma_f32_16x16x32_bf16 a[196:199], v[232:235], v[36:39], a[196:199]
v_cvt_pk_bf16_f32 v23, v198, v199
buffer_store_dwordx4 v[20:23], v252, s[20:23], s44 offen offset:1024 sc1
v_mfma_f32_16x16x32_bf16 a[196:199], v[236:239], v[180:183], a[196:199]
v_accvgpr_read_b32 v204, a180
v_accvgpr_read_b32 v205, a181
v_mfma_f32_16x16x32_bf16 a[200:203], v[232:235], v[68:71], a[200:203]
ds_read_b64_tr_b16 v[228:229], v12 offset:61440
ds_read_b64_tr_b16 v[230:231], v12 offset:63488
v_mfma_f32_16x16x32_bf16 a[200:203], v[236:239], v[184:187], a[200:203]
v_accvgpr_read_b32 v206, a182
v_accvgpr_read_b32 v207, a183
v_mfma_f32_16x16x32_bf16 a[204:207], v[232:235], v[100:103], a[204:207]
v_cvt_pk_bf16_f32 v54, v204, v205
v_cvt_pk_bf16_f32 v55, v206, v207
v_mfma_f32_16x16x32_bf16 a[204:207], v[236:239], v[188:191], a[204:207]
s_waitcnt lgkmcnt(4)
buffer_store_dwordx4 v[52:55], v252, s[20:23], s45 offen offset:1024 sc1
v_mfma_f32_16x16x32_bf16 a[192:195], v[240:243], v[128:131], a[192:195]
ds_read_b64_tr_b16 v[232:233], v250 offset:45056
ds_read_b64_tr_b16 v[234:235], v250 offset:47104
v_mfma_f32_16x16x32_bf16 a[192:195], v[244:247], v[144:147], a[192:195]
v_accvgpr_read_b32 v212, a184
v_accvgpr_read_b32 v213, a185
v_mfma_f32_16x16x32_bf16 a[196:199], v[240:243], v[132:135], a[196:199]
v_accvgpr_read_b32 v214, a186
v_accvgpr_read_b32 v215, a187
v_mfma_f32_16x16x32_bf16 a[196:199], v[244:247], v[148:151], a[196:199]
v_cvt_pk_bf16_f32 v86, v212, v213
v_cvt_pk_bf16_f32 v87, v214, v215
v_mfma_f32_16x16x32_bf16 a[200:203], v[240:243], v[136:139], a[200:203]
ds_read_b64_tr_b16 v[236:237], v250 offset:61440
ds_read_b64_tr_b16 v[238:239], v250 offset:63488
v_mfma_f32_16x16x32_bf16 a[200:203], v[244:247], v[152:155], a[200:203]
buffer_store_dwordx4 v[84:87], v252, s[20:23], s46 offen offset:1024 sc1
v_accvgpr_read_b32 v220, a188
v_mfma_f32_16x16x32_bf16 a[204:207], v[240:243], v[140:143], a[204:207]
v_accvgpr_read_b32 v221, a189
v_accvgpr_read_b32 v222, a190
v_mfma_f32_16x16x32_bf16 a[204:207], v[244:247], v[156:159], a[204:207]
s_waitcnt lgkmcnt(4)
v_accvgpr_read_b32 v223, a191
v_mfma_f32_16x16x32_bf16 a[192:195], v[224:227], v[160:163], a[192:195]
ds_read_b64_tr_b16 v[240:241], v13 offset:12288
ds_read_b64_tr_b16 v[242:243], v13 offset:14336
v_mfma_f32_16x16x32_bf16 a[192:195], v[228:231], v[0:3], a[192:195]
v_cvt_pk_bf16_f32 v118, v220, v221
v_cvt_pk_bf16_f32 v119, v222, v223
v_mfma_f32_16x16x32_bf16 a[196:199], v[224:227], v[164:167], a[196:199]
buffer_store_dwordx4 v[116:119], v252, s[20:23], s47 offen offset:1024 sc1
v_mfma_f32_16x16x32_bf16 a[196:199], v[228:231], v[32:35], a[196:199]
v_mfma_f32_16x16x32_bf16 a[200:203], v[224:227], v[168:171], a[200:203]
ds_read_b64_tr_b16 v[244:245], v13 offset:28672
ds_read_b64_tr_b16 v[246:247], v13 offset:30720
v_mfma_f32_16x16x32_bf16 a[200:203], v[228:231], v[64:67], a[200:203]
v_mfma_f32_16x16x32_bf16 a[204:207], v[224:227], v[172:175], a[204:207]
v_accvgpr_read_b32 v192, a192
v_accvgpr_read_b32 v193, a193
v_mfma_f32_16x16x32_bf16 a[204:207], v[228:231], v[96:99], a[204:207]
s_waitcnt lgkmcnt(4)
v_accvgpr_read_b32 v194, a194
v_mfma_f32_16x16x32_bf16 a[208:211], v[232:235], v[4:7], a[208:211]
ds_read_b64_tr_b16 v[224:225], v13 offset:45056
ds_read_b64_tr_b16 v[226:227], v13 offset:47104
v_mfma_f32_16x16x32_bf16 a[208:211], v[236:239], v[176:179], a[208:211]
v_accvgpr_read_b32 v195, a195
v_cvt_pk_bf16_f32 v24, v192, v193
v_mfma_f32_16x16x32_bf16 a[212:215], v[232:235], v[36:39], a[212:215]
v_cvt_pk_bf16_f32 v25, v194, v195
v_accvgpr_read_b32 v200, a196
v_mfma_f32_16x16x32_bf16 a[212:215], v[236:239], v[180:183], a[212:215]
v_accvgpr_read_b32 v201, a197
v_accvgpr_read_b32 v202, a198
v_mfma_f32_16x16x32_bf16 a[216:219], v[232:235], v[68:71], a[216:219]
ds_read_b64_tr_b16 v[228:229], v13 offset:61440
ds_read_b64_tr_b16 v[230:231], v13 offset:63488
v_mfma_f32_16x16x32_bf16 a[216:219], v[236:239], v[184:187], a[216:219]
v_accvgpr_read_b32 v203, a199
v_cvt_pk_bf16_f32 v56, v200, v201
v_mfma_f32_16x16x32_bf16 a[220:223], v[232:235], v[100:103], a[220:223]
v_cvt_pk_bf16_f32 v57, v202, v203
v_accvgpr_read_b32 v208, a200
v_mfma_f32_16x16x32_bf16 a[220:223], v[236:239], v[188:191], a[220:223]
s_waitcnt lgkmcnt(4)
v_accvgpr_read_b32 v209, a201
v_mfma_f32_16x16x32_bf16 a[208:211], v[240:243], v[128:131], a[208:211]
ds_read_b64_tr_b16 v[232:233], v249 offset:45568
ds_read_b64_tr_b16 v[234:235], v249 offset:47616
v_mfma_f32_16x16x32_bf16 a[208:211], v[244:247], v[144:147], a[208:211]
v_accvgpr_read_b32 v210, a202
v_accvgpr_read_b32 v211, a203
v_mfma_f32_16x16x32_bf16 a[212:215], v[240:243], v[132:135], a[212:215]
v_cvt_pk_bf16_f32 v88, v208, v209
v_cvt_pk_bf16_f32 v89, v210, v211
v_mfma_f32_16x16x32_bf16 a[212:215], v[244:247], v[148:151], a[212:215]
v_accvgpr_read_b32 v216, a204
v_accvgpr_read_b32 v217, a205
v_mfma_f32_16x16x32_bf16 a[216:219], v[240:243], v[136:139], a[216:219]
ds_read_b64_tr_b16 v[236:237], v249 offset:61952
ds_read_b64_tr_b16 v[238:239], v249 offset:64000
v_mfma_f32_16x16x32_bf16 a[216:219], v[244:247], v[152:155], a[216:219]
v_accvgpr_read_b32 v218, a206
v_accvgpr_read_b32 v219, a207
v_mfma_f32_16x16x32_bf16 a[220:223], v[240:243], v[140:143], a[220:223]
v_cvt_pk_bf16_f32 v120, v216, v217
v_cvt_pk_bf16_f32 v121, v218, v219
v_mfma_f32_16x16x32_bf16 a[220:223], v[244:247], v[156:159], a[220:223]
s_waitcnt lgkmcnt(4)
v_mfma_f32_16x16x32_bf16 a[208:211], v[224:227], v[160:163], a[208:211]
ds_read_b64_tr_b16 v[240:241], v12 offset:12800
ds_read_b64_tr_b16 v[242:243], v12 offset:14848
v_mfma_f32_16x16x32_bf16 a[208:211], v[228:231], v[0:3], a[208:211]
v_mfma_f32_16x16x32_bf16 a[212:215], v[224:227], v[164:167], a[212:215]
v_mfma_f32_16x16x32_bf16 a[212:215], v[228:231], v[32:35], a[212:215]
v_mfma_f32_16x16x32_bf16 a[216:219], v[224:227], v[168:171], a[216:219]
ds_read_b64_tr_b16 v[244:245], v12 offset:29184
ds_read_b64_tr_b16 v[246:247], v12 offset:31232
v_mfma_f32_16x16x32_bf16 a[216:219], v[228:231], v[64:67], a[216:219]
v_mfma_f32_16x16x32_bf16 a[220:223], v[224:227], v[172:175], a[220:223]
s_nop 0
v_accvgpr_read_b32 v196, a208
v_accvgpr_read_b32 v197, a209
v_mfma_f32_16x16x32_bf16 a[220:223], v[228:231], v[96:99], a[220:223]
s_waitcnt lgkmcnt(4)
v_accvgpr_read_b32 v198, a210
v_mfma_f32_16x16x32_bf16 a[224:227], v[232:235], v[4:7], a[224:227]
ds_read_b64_tr_b16 v[224:225], v12 offset:45568
ds_read_b64_tr_b16 v[226:227], v12 offset:47616
v_mfma_f32_16x16x32_bf16 a[224:227], v[236:239], v[176:179], a[224:227]
v_accvgpr_read_b32 v199, a211
v_cvt_pk_bf16_f32 v26, v196, v197
v_mfma_f32_16x16x32_bf16 a[228:231], v[232:235], v[36:39], a[228:231]
v_cvt_pk_bf16_f32 v27, v198, v199
buffer_store_dwordx4 v[24:27], v252, s[20:23], s44 offen offset:2048 sc1
v_mfma_f32_16x16x32_bf16 a[228:231], v[236:239], v[180:183], a[228:231]
v_accvgpr_read_b32 v204, a212
v_accvgpr_read_b32 v205, a213
v_mfma_f32_16x16x32_bf16 a[232:235], v[232:235], v[68:71], a[232:235]
ds_read_b64_tr_b16 v[228:229], v12 offset:61952
ds_read_b64_tr_b16 v[230:231], v12 offset:64000
v_mfma_f32_16x16x32_bf16 a[232:235], v[236:239], v[184:187], a[232:235]
v_accvgpr_read_b32 v206, a214
v_accvgpr_read_b32 v207, a215
v_mfma_f32_16x16x32_bf16 a[236:239], v[232:235], v[100:103], a[236:239]
v_cvt_pk_bf16_f32 v58, v204, v205
v_cvt_pk_bf16_f32 v59, v206, v207
v_mfma_f32_16x16x32_bf16 a[236:239], v[236:239], v[188:191], a[236:239]
s_waitcnt lgkmcnt(4)
buffer_store_dwordx4 v[56:59], v252, s[20:23], s45 offen offset:2048 sc1
v_mfma_f32_16x16x32_bf16 a[224:227], v[240:243], v[128:131], a[224:227]
ds_read_b64_tr_b16 v[232:233], v250 offset:45568
ds_read_b64_tr_b16 v[234:235], v250 offset:47616
v_mfma_f32_16x16x32_bf16 a[224:227], v[244:247], v[144:147], a[224:227]
v_accvgpr_read_b32 v212, a216
v_accvgpr_read_b32 v213, a217
v_mfma_f32_16x16x32_bf16 a[228:231], v[240:243], v[132:135], a[228:231]
v_accvgpr_read_b32 v214, a218
v_accvgpr_read_b32 v215, a219
v_mfma_f32_16x16x32_bf16 a[228:231], v[244:247], v[148:151], a[228:231]
v_cvt_pk_bf16_f32 v90, v212, v213
v_cvt_pk_bf16_f32 v91, v214, v215
v_mfma_f32_16x16x32_bf16 a[232:235], v[240:243], v[136:139], a[232:235]
ds_read_b64_tr_b16 v[236:237], v250 offset:61952
ds_read_b64_tr_b16 v[238:239], v250 offset:64000
v_mfma_f32_16x16x32_bf16 a[232:235], v[244:247], v[152:155], a[232:235]
buffer_store_dwordx4 v[88:91], v252, s[20:23], s46 offen offset:2048 sc1
v_accvgpr_read_b32 v220, a220
v_mfma_f32_16x16x32_bf16 a[236:239], v[240:243], v[140:143], a[236:239]
v_accvgpr_read_b32 v221, a221
v_accvgpr_read_b32 v222, a222
v_mfma_f32_16x16x32_bf16 a[236:239], v[244:247], v[156:159], a[236:239]
s_waitcnt lgkmcnt(4)
v_accvgpr_read_b32 v223, a223
v_mfma_f32_16x16x32_bf16 a[224:227], v[224:227], v[160:163], a[224:227]
ds_read_b64_tr_b16 v[240:241], v13 offset:12800
ds_read_b64_tr_b16 v[242:243], v13 offset:14848
v_mfma_f32_16x16x32_bf16 a[224:227], v[228:231], v[0:3], a[224:227]
v_cvt_pk_bf16_f32 v122, v220, v221
v_cvt_pk_bf16_f32 v123, v222, v223
v_mfma_f32_16x16x32_bf16 a[228:231], v[224:227], v[164:167], a[228:231]
buffer_store_dwordx4 v[120:123], v252, s[20:23], s47 offen offset:2048 sc1
v_mfma_f32_16x16x32_bf16 a[228:231], v[228:231], v[32:35], a[228:231]
v_mfma_f32_16x16x32_bf16 a[232:235], v[224:227], v[168:171], a[232:235]
ds_read_b64_tr_b16 v[244:245], v13 offset:29184
ds_read_b64_tr_b16 v[246:247], v13 offset:31232
v_mfma_f32_16x16x32_bf16 a[232:235], v[228:231], v[64:67], a[232:235]
v_mfma_f32_16x16x32_bf16 a[236:239], v[224:227], v[172:175], a[236:239]
v_accvgpr_read_b32 v192, a224
v_accvgpr_read_b32 v193, a225
v_mfma_f32_16x16x32_bf16 a[236:239], v[228:231], v[96:99], a[236:239]
s_waitcnt lgkmcnt(4)
v_accvgpr_read_b32 v194, a226
v_mfma_f32_16x16x32_bf16 a[240:243], v[232:235], v[4:7], a[240:243]
ds_read_b64_tr_b16 v[224:225], v13 offset:45568
ds_read_b64_tr_b16 v[226:227], v13 offset:47616
v_mfma_f32_16x16x32_bf16 a[240:243], v[236:239], v[176:179], a[240:243]
v_accvgpr_read_b32 v195, a227
v_cvt_pk_bf16_f32 v28, v192, v193
v_mfma_f32_16x16x32_bf16 a[244:247], v[232:235], v[36:39], a[244:247]
v_cvt_pk_bf16_f32 v29, v194, v195
v_accvgpr_read_b32 v200, a228
v_mfma_f32_16x16x32_bf16 a[244:247], v[236:239], v[180:183], a[244:247]
v_accvgpr_read_b32 v201, a229
v_accvgpr_read_b32 v202, a230
v_mfma_f32_16x16x32_bf16 a[248:251], v[232:235], v[68:71], a[248:251]
ds_read_b64_tr_b16 v[228:229], v13 offset:61952
ds_read_b64_tr_b16 v[230:231], v13 offset:64000
v_mfma_f32_16x16x32_bf16 a[248:251], v[236:239], v[184:187], a[248:251]
v_accvgpr_read_b32 v203, a231
v_cvt_pk_bf16_f32 v60, v200, v201
v_mfma_f32_16x16x32_bf16 a[252:255], v[232:235], v[100:103], a[252:255]
v_cvt_pk_bf16_f32 v61, v202, v203
v_accvgpr_read_b32 v208, a232
v_mfma_f32_16x16x32_bf16 a[252:255], v[236:239], v[188:191], a[252:255]
s_waitcnt lgkmcnt(4)
v_accvgpr_read_b32 v209, a233
v_mfma_f32_16x16x32_bf16 a[240:243], v[240:243], v[128:131], a[240:243]
v_accvgpr_read_b32 v210, a234
v_accvgpr_read_b32 v211, a235
v_mfma_f32_16x16x32_bf16 a[240:243], v[244:247], v[144:147], a[240:243]
v_cvt_pk_bf16_f32 v92, v208, v209
v_cvt_pk_bf16_f32 v93, v210, v211
v_mfma_f32_16x16x32_bf16 a[244:247], v[240:243], v[132:135], a[244:247]
v_accvgpr_read_b32 v216, a236
v_accvgpr_read_b32 v217, a237
v_mfma_f32_16x16x32_bf16 a[244:247], v[244:247], v[148:151], a[244:247]
v_accvgpr_read_b32 v218, a238
v_accvgpr_read_b32 v219, a239
v_mfma_f32_16x16x32_bf16 a[248:251], v[240:243], v[136:139], a[248:251]
v_cvt_pk_bf16_f32 v124, v216, v217
v_cvt_pk_bf16_f32 v125, v218, v219
v_mfma_f32_16x16x32_bf16 a[248:251], v[244:247], v[152:155], a[248:251]
v_mfma_f32_16x16x32_bf16 a[252:255], v[240:243], v[140:143], a[252:255]
v_mfma_f32_16x16x32_bf16 a[252:255], v[244:247], v[156:159], a[252:255]
s_waitcnt lgkmcnt(0)
v_mfma_f32_16x16x32_bf16 a[240:243], v[224:227], v[160:163], a[240:243]
v_mfma_f32_16x16x32_bf16 a[240:243], v[228:231], v[0:3], a[240:243]
v_mfma_f32_16x16x32_bf16 a[244:247], v[224:227], v[164:167], a[244:247]
v_mfma_f32_16x16x32_bf16 a[244:247], v[228:231], v[32:35], a[244:247]
v_mfma_f32_16x16x32_bf16 a[248:251], v[224:227], v[168:171], a[248:251]
v_mfma_f32_16x16x32_bf16 a[248:251], v[228:231], v[64:67], a[248:251]
v_mfma_f32_16x16x32_bf16 a[252:255], v[224:227], v[172:175], a[252:255]
s_nop 2
v_accvgpr_read_b32 v196, a240
v_accvgpr_read_b32 v197, a241
v_accvgpr_read_b32 v198, a242
v_accvgpr_read_b32 v199, a243
v_mfma_f32_16x16x32_bf16 a[252:255], v[228:231], v[96:99], a[252:255]
v_cvt_pk_bf16_f32 v30, v196, v197
v_cvt_pk_bf16_f32 v31, v198, v199
buffer_store_dwordx4 v[28:31], v252, s[20:23], s44 offen offset:3072 sc1
v_accvgpr_read_b32 v204, a244
v_accvgpr_read_b32 v205, a245
v_accvgpr_read_b32 v206, a246
v_accvgpr_read_b32 v207, a247
v_cvt_pk_bf16_f32 v62, v204, v205
v_cvt_pk_bf16_f32 v63, v206, v207
buffer_store_dwordx4 v[60:63], v252, s[20:23], s45 offen offset:3072 sc1
v_accvgpr_read_b32 v212, a248
v_accvgpr_read_b32 v213, a249
v_accvgpr_read_b32 v214, a250
v_accvgpr_read_b32 v215, a251
v_cvt_pk_bf16_f32 v94, v212, v213
v_cvt_pk_bf16_f32 v95, v214, v215
buffer_store_dwordx4 v[92:95], v252, s[20:23], s46 offen offset:3072 sc1
v_accvgpr_read_b32 v220, a252
v_accvgpr_read_b32 v221, a253
v_accvgpr_read_b32 v222, a254
v_accvgpr_read_b32 v223, a255
v_cvt_pk_bf16_f32 v126, v220, v221
v_cvt_pk_bf16_f32 v127, v222, v223
buffer_store_dwordx4 v[124:127], v252, s[20:23], s47 offen offset:3072 sc1
s_waitcnt vmcnt(15)
v_readfirstlane_b32 s99, v254
s_branch L2_chk
L2_tail_1_7:
s_waitcnt lgkmcnt(4)
v_mfma_f32_16x16x32_bf16 a[0:3], v[224:227], v[160:163], a[0:3]
ds_read_b128 v[240:243], v248 offset:2048
v_mfma_f32_16x16x32_bf16 a[0:3], v[228:231], v[176:179], a[0:3]
s_lshl_b32 s36, s34, 13
v_mfma_f32_16x16x32_bf16 a[4:7], v[224:227], v[164:167], a[4:7]
s_add_u32 s56, s4, 0x1000000
s_addc_u32 s57, s5, 0
v_mfma_f32_16x16x32_bf16 a[4:7], v[228:231], v[180:183], a[4:7]
s_add_u32 s36, s36, 0x20000
s_mov_b32 s58, 0x6c02000
v_mfma_f32_16x16x32_bf16 a[8:11], v[224:227], v[168:171], a[8:11]
ds_read_b128 v[244:247], v248 offset:2560
s_mov_b32 s59, 0x00020000
v_mfma_f32_16x16x32_bf16 a[8:11], v[228:231], v[184:187], a[8:11]
v_add_u32 v255, s36, v252
s_lshr_b32 s35, s2, 1
v_mfma_f32_16x16x32_bf16 a[12:15], v[224:227], v[172:175], a[12:15]
s_and_b32 s35, s35, 28
s_add_u32 s35, s35, s34
v_mfma_f32_16x16x32_bf16 a[12:15], v[228:231], v[188:191], a[12:15]
s_waitcnt lgkmcnt(2)
s_lshl_b32 s35, s35, 13
v_mfma_f32_16x16x32_bf16 a[16:19], v[232:235], v[160:163], a[16:19]
ds_read_b128 v[224:227], v248 offset:6144
v_lshlrev_b32 v253, 3, v252
v_mfma_f32_16x16x32_bf16 a[16:19], v[236:239], v[176:179], a[16:19]
buffer_load_dword v253, v253, s[56:59], s35 offen
ds_write_b128 v255, v[160:163] offset:0
v_mfma_f32_16x16x32_bf16 a[20:23], v[232:235], v[164:167], a[20:23]
v_exp_f32 v192, v192
v_mfma_f32_16x16x32_bf16 a[20:23], v[236:239], v[180:183], a[20:23]
v_exp_f32 v193, v193
v_mfma_f32_16x16x32_bf16 a[24:27], v[232:235], v[168:171], a[24:27]
ds_read_b128 v[228:231], v248 offset:6656
v_cvt_pk_bf16_f32 v128, v192, v193
v_mfma_f32_16x16x32_bf16 a[24:27], v[236:239], v[184:187], a[24:27]
v_exp_f32 v194, v194
v_mfma_f32_16x16x32_bf16 a[28:31], v[232:235], v[172:175], a[28:31]
v_exp_f32 v195, v195
v_mfma_f32_16x16x32_bf16 a[28:31], v[236:239], v[188:191], a[28:31]
s_waitcnt lgkmcnt(3)
v_cvt_pk_bf16_f32 v129, v194, v195
v_mfma_f32_16x16x32_bf16 v[208:211], v[240:243], v[0:3], 0
ds_read_b128 v[232:235], v248 offset:10240
ds_write_b128 v255, v[164:167] offset:1024
v_mfma_f32_16x16x32_bf16 v[208:211], v[244:247], v[4:7], v[208:211]
v_exp_f32 v196, v196
v_mfma_f32_16x16x32_bf16 v[212:215], v[240:243], v[32:35], 0
v_exp_f32 v197, v197
v_mfma_f32_16x16x32_bf16 v[212:215], v[244:247], v[36:39], v[212:215]
v_exp_f32 v198, v198
v_mfma_f32_16x16x32_bf16 v[216:219], v[240:243], v[64:67], 0
ds_read_b128 v[236:239], v248 offset:10752
v_cvt_pk_bf16_f32 v132, v196, v197
v_mfma_f32_16x16x32_bf16 v[216:219], v[244:247], v[68:71], v[216:219]
v_exp_f32 v199, v199
v_mfma_f32_16x16x32_bf16 v[220:223], v[240:243], v[96:99], 0
v_exp_f32 v200, v200
v_mfma_f32_16x16x32_bf16 v[220:223], v[244:247], v[100:103], v[220:223]
s_waitcnt lgkmcnt(3)
v_cvt_pk_bf16_f32 v133, v198, v199
v_mfma_f32_16x16x32_bf16 v[208:211], v[224:227], v[8:11], v[208:211]
ds_read_b128 v[240:243], v248 offset:14336
ds_write_b128 v255, v[168:171] offset:2048
v_mfma_f32_16x16x32_bf16 v[208:211], v[228:231], v[12:15], v[208:211]
v_exp_f32 v201, v201
v_mfma_f32_16x16x32_bf16 v[212:215], v[224:227], v[40:43], v[212:215]
v_exp_f32 v202, v202
v_mfma_f32_16x16x32_bf16 v[212:215], v[228:231], v[44:47], v[212:215]
v_exp_f32 v203, v203
v_mfma_f32_16x16x32_bf16 v[216:219], v[224:227], v[72:75], v[216:219]
ds_read_b128 v[244:247], v248 offset:14848
v_cvt_pk_bf16_f32 v136, v200, v201
v_mfma_f32_16x16x32_bf16 v[216:219], v[228:231], v[76:79], v[216:219]
v_cvt_pk_bf16_f32 v137, v202, v203
ds_write_b128 v255, v[172:175] offset:3072
v_mfma_f32_16x16x32_bf16 v[220:223], v[224:227], v[104:107], v[220:223]
v_exp_f32 v204, v204
v_mfma_f32_16x16x32_bf16 v[220:223], v[228:231], v[108:111], v[220:223]
s_waitcnt lgkmcnt(4)
s_waitcnt vmcnt(1)
s_barrier
v_mfma_f32_16x16x32_bf16 v[208:211], v[232:235], v[16:19], v[208:211]
ds_read_b128 v[224:227], v248 offset:16384
s_add_u32 m0, s30, 0xc000
v_mfma_f32_16x16x32_bf16 v[208:211], v[236:239], v[20:23], v[208:211]
s_and_b32 s100, s30, 0x10000
buffer_load_dwordx4 v251, s[12:15], s28 offen offset:0 lds
v_mfma_f32_16x16x32_bf16 v[212:215], v[232:235], v[48:51], v[212:215]
s_xor_b32 s100, s100, 0x10000
ds_write_b128 v255, v[176:179] offset:4096
v_mfma_f32_16x16x32_bf16 v[212:215], v[236:239], v[52:55], v[212:215]
s_mov_b32 s99, 0
buffer_load_dwordx4 v251, s[12:15], s28 offen offset:1024 lds
v_mfma_f32_16x16x32_bf16 v[216:219], v[232:235], v[80:83], v[216:219]
ds_read_b128 v[228:231], v248 offset:16896
ds_write_b128 v255, v[180:183] offset:5120
v_mfma_f32_16x16x32_bf16 v[216:219], v[236:239], v[84:87], v[216:219]
v_exp_f32 v205, v205
v_mfma_f32_16x16x32_bf16 v[220:223], v[232:235], v[112:115], v[220:223]
v_exp_f32 v206, v206
v_mfma_f32_16x16x32_bf16 v[220:223], v[236:239], v[116:119], v[220:223]
s_waitcnt lgkmcnt(5)
v_cvt_pk_bf16_f32 v140, v204, v205
v_mfma_f32_16x16x32_bf16 v[208:211], v[240:243], v[24:27], v[208:211]
ds_read_b128 v[232:235], v248 offset:20480
buffer_load_dwordx4 v251, s[12:15], s28 offen offset:2048 lds
v_mfma_f32_16x16x32_bf16 v[208:211], v[244:247], v[28:31], v[208:211]
v_exp_f32 v207, v207
v_mfma_f32_16x16x32_bf16 v[212:215], v[240:243], v[56:59], v[212:215]
buffer_load_dwordx4 v251, s[12:15], s28 offen offset:3072 lds
ds_write_b128 v255, v[184:187] offset:6144
v_mfma_f32_16x16x32_bf16 v[212:215], v[244:247], v[60:63], v[212:215]
ds_write_b128 v255, v[188:191] offset:7168
v_mfma_f32_16x16x32_bf16 v[216:219], v[240:243], v[88:91], v[216:219]
ds_read_b128 v[236:239], v248 offset:20992
v_cvt_pk_bf16_f32 v141, v206, v207
v_mfma_f32_16x16x32_bf16 v[216:219], v[244:247], v[92:95], v[216:219]
s_add_u32 s28, s28, 0x4000
s_xor_b32 s30, s30, 0x10000
v_mfma_f32_16x16x32_bf16 v[220:223], v[240:243], v[120:123], v[220:223]
s_add_u32 m0, s30, 0x0
v_mfma_f32_16x16x32_bf16 v[220:223], v[244:247], v[124:127], v[220:223]
s_waitcnt lgkmcnt(5)
v_lshrrev_b32 v254, 1, v251
v_mfma_f32_16x16x32_bf16 v[192:195], v[224:227], v[0:3], 0
ds_read_b128 v[240:243], v248 offset:24576
v_and_b32 v254, 0x1800, v254
v_mfma_f32_16x16x32_bf16 v[192:195], v[228:231], v[4:7], v[192:195]
v_exp_f32 v208, v208
v_mfma_f32_16x16x32_bf16 v[196:199], v[224:227], v[32:35], 0
v_exp_f32 v209, v209
v_mfma_f32_16x16x32_bf16 v[196:199], v[228:231], v[36:39], v[196:199]
v_exp_f32 v210, v210
v_mfma_f32_16x16x32_bf16 v[200:203], v[224:227], v[64:67], 0
ds_read_b128 v[244:247], v248 offset:25088
v_cvt_pk_bf16_f32 v130, v208, v209
v_mfma_f32_16x16x32_bf16 v[200:203], v[228:231], v[68:71], v[200:203]
v_exp_f32 v211, v211
v_mfma_f32_16x16x32_bf16 v[204:207], v[224:227], v[96:99], 0
v_exp_f32 v212, v212
v_mfma_f32_16x16x32_bf16 v[204:207], v[228:231], v[100:103], v[204:207]
s_waitcnt lgkmcnt(2)
v_cvt_pk_bf16_f32 v131, v210, v211
v_mfma_f32_16x16x32_bf16 v[192:195], v[232:235], v[8:11], v[192:195]
ds_read_b128 v[224:227], v248 offset:28672
s_movk_i32 s35, 0x3ff
v_mfma_f32_16x16x32_bf16 v[192:195], v[236:239], v[12:15], v[192:195]
v_exp_f32 v213, v213
v_mfma_f32_16x16x32_bf16 v[196:199], v[232:235], v[40:43], v[196:199]
v_exp_f32 v214, v214
v_mfma_f32_16x16x32_bf16 v[196:199], v[236:239], v[44:47], v[196:199]
v_exp_f32 v215, v215
v_mfma_f32_16x16x32_bf16 v[200:203], v[232:235], v[72:75], v[200:203]
ds_read_b128 v[228:231], v248 offset:29184
v_cvt_pk_bf16_f32 v134, v212, v213
v_mfma_f32_16x16x32_bf16 v[200:203], v[236:239], v[76:79], v[200:203]
v_cvt_pk_bf16_f32 v135, v214, v215
v_and_or_b32 v254, v251, s35, v254
v_mfma_f32_16x16x32_bf16 v[204:207], v[232:235], v[104:107], v[204:207]
v_exp_f32 v216, v216
v_mfma_f32_16x16x32_bf16 v[204:207], v[236:239], v[108:111], v[204:207]
s_waitcnt lgkmcnt(2)
s_add_u32 s35, s28, 6144
v_mfma_f32_16x16x32_bf16 v[192:195], v[240:243], v[16:19], v[192:195]
ds_read_b128 v[232:235], v248 offset:18432
buffer_load_dwordx4 v254, s[12:15], s28 offen offset:0 lds
v_mfma_f32_16x16x32_bf16 v[192:195], v[244:247], v[20:23], v[192:195]
v_exp_f32 v217, v217
v_mfma_f32_16x16x32_bf16 v[196:199], v[240:243], v[48:51], v[196:199]
v_exp_f32 v218, v218
v_mfma_f32_16x16x32_bf16 v[196:199], v[244:247], v[52:55], v[196:199]
v_exp_f32 v219, v219
v_mfma_f32_16x16x32_bf16 v[200:203], v[240:243], v[80:83], v[200:203]
ds_read_b128 v[236:239], v248 offset:18944
v_cvt_pk_bf16_f32 v138, v216, v217
v_mfma_f32_16x16x32_bf16 v[200:203], v[244:247], v[84:87], v[200:203]
v_cvt_pk_bf16_f32 v139, v218, v219
buffer_load_dwordx4 v254, s[12:15], s28 offen offset:1024 lds
v_mfma_f32_16x16x32_bf16 v[204:207], v[240:243], v[112:115], v[204:207]
v_exp_f32 v220, v220
v_mfma_f32_16x16x32_bf16 v[204:207], v[244:247], v[116:119], v[204:207]
s_waitcnt lgkmcnt(2)
buffer_load_dwordx4 v254, s[12:15], s35 offen offset:2048 lds
v_mfma_f32_16x16x32_bf16 v[192:195], v[224:227], v[24:27], v[192:195]
ds_read_b128 v[240:243], v248 offset:22528
v_mfma_f32_16x16x32_bf16 v[192:195], v[228:231], v[28:31], v[192:195]
v_exp_f32 v221, v221
v_mfma_f32_16x16x32_bf16 v[196:199], v[224:227], v[56:59], v[196:199]
v_exp_f32 v222, v222
v_mfma_f32_16x16x32_bf16 v[196:199], v[228:231], v[60:63], v[196:199]
v_exp_f32 v223, v223
v_mfma_f32_16x16x32_bf16 v[200:203], v[224:227], v[88:91], v[200:203]
ds_read_b128 v[244:247], v248 offset:23040
v_cvt_pk_bf16_f32 v142, v220, v221
v_mfma_f32_16x16x32_bf16 v[200:203], v[228:231], v[92:95], v[200:203]
v_cvt_pk_bf16_f32 v143, v222, v223
buffer_load_dwordx4 v254, s[12:15], s35 offen offset:3072 lds
v_mfma_f32_16x16x32_bf16 v[204:207], v[224:227], v[120:123], v[204:207]
v_mfma_f32_16x16x32_bf16 v[204:207], v[228:231], v[124:127], v[204:207]
s_waitcnt lgkmcnt(2)
v_mfma_f32_16x16x32_bf16 v[208:211], v[232:235], v[0:3], 0
ds_read_b128 v[224:227], v248 offset:26624
v_mfma_f32_16x16x32_bf16 v[208:211], v[236:239], v[4:7], v[208:211]
v_exp_f32 v192, v192
v_mfma_f32_16x16x32_bf16 v[212:215], v[232:235], v[32:35], 0
v_exp_f32 v193, v193
v_mfma_f32_16x16x32_bf16 v[212:215], v[236:239], v[36:39], v[212:215]
v_exp_f32 v194, v194
v_mfma_f32_16x16x32_bf16 v[216:219], v[232:235], v[64:67], 0
ds_read_b128 v[228:231], v248 offset:27136
v_cvt_pk_bf16_f32 v144, v192, v193
v_mfma_f32_16x16x32_bf16 v[216:219], v[236:239], v[68:71], v[216:219]
v_exp_f32 v195, v195
v_mfma_f32_16x16x32_bf16 v[220:223], v[232:235], v[96:99], 0
v_exp_f32 v196, v196
v_mfma_f32_16x16x32_bf16 v[220:223], v[236:239], v[100:103], v[220:223]
s_waitcnt lgkmcnt(2)
v_cvt_pk_bf16_f32 v145, v194, v195
v_mfma_f32_16x16x32_bf16 v[208:211], v[240:243], v[8:11], v[208:211]
ds_read_b128 v[232:235], v248 offset:30720
v_mfma_f32_16x16x32_bf16 v[208:211], v[244:247], v[12:15], v[208:211]
v_exp_f32 v197, v197
v_mfma_f32_16x16x32_bf16 v[212:215], v[240:243], v[40:43], v[212:215]
v_exp_f32 v198, v198
v_mfma_f32_16x16x32_bf16 v[212:215], v[244:247], v[44:47], v[212:215]
v_exp_f32 v199, v199
v_mfma_f32_16x16x32_bf16 v[216:219], v[240:243], v[72:75], v[216:219]
ds_read_b128 v[236:239], v248 offset:31232
v_cvt_pk_bf16_f32 v148, v196, v197
v_mfma_f32_16x16x32_bf16 v[216:219], v[244:247], v[76:79], v[216:219]
v_cvt_pk_bf16_f32 v149, v198, v199
v_mfma_f32_16x16x32_bf16 v[220:223], v[240:243], v[104:107], v[220:223]
v_exp_f32 v200, v200
v_mfma_f32_16x16x32_bf16 v[220:223], v[244:247], v[108:111], v[220:223]
s_waitcnt lgkmcnt(2)
v_mfma_f32_16x16x32_bf16 v[208:211], v[224:227], v[16:19], v[208:211]
ds_read_b128 v[240:243], v248 offset:32768
v_mfma_f32_16x16x32_bf16 v[208:211], v[228:231], v[20:23], v[208:211]
v_exp_f32 v201, v201
v_mfma_f32_16x16x32_bf16 v[212:215], v[224:227], v[48:51], v[212:215]
v_exp_f32 v202, v202
v_mfma_f32_16x16x32_bf16 v[212:215], v[228:231], v[52:55], v[212:215]
v_exp_f32 v203, v203
v_mfma_f32_16x16x32_bf16 v[216:219], v[224:227], v[80:83], v[216:219]
ds_read_b128 v[244:247], v248 offset:33280
v_cvt_pk_bf16_f32 v152, v200, v201
v_mfma_f32_16x16x32_bf16 v[216:219], v[228:231], v[84:87], v[216:219]
v_cvt_pk_bf16_f32 v153, v202, v203
v_mfma_f32_16x16x32_bf16 v[220:223], v[224:227], v[112:115], v[220:223]
v_exp_f32 v204, v204
v_mfma_f32_16x16x32_bf16 v[220:223], v[228:231], v[116:119], v[220:223]
s_waitcnt lgkmcnt(2)
v_mfma_f32_16x16x32_bf16 v[208:211], v[232:235], v[24:27], v[208:211]
ds_read_b128 v[224:227], v248 offset:36864
v_mfma_f32_16x16x32_bf16 v[208:211], v[236:239], v[28:31], v[208:211]
v_exp_f32 v205, v205
v_mfma_f32_16x16x32_bf16 v[212:215], v[232:235], v[56:59], v[212:215]
v_exp_f32 v206, v206
v_mfma_f32_16x16x32_bf16 v[212:215], v[236:239], v[60:63], v[212:215]
v_exp_f32 v207, v207
v_mfma_f32_16x16x32_bf16 v[216:219], v[232:235], v[88:91], v[216:219]
ds_read_b128 v[228:231], v248 offset:37376
v_cvt_pk_bf16_f32 v156, v204, v205
v_mfma_f32_16x16x32_bf16 v[216:219], v[236:239], v[92:95], v[216:219]
v_cvt_pk_bf16_f32 v157, v206, v207
v_mfma_f32_16x16x32_bf16 v[220:223], v[232:235], v[120:123], v[220:223]
v_mfma_f32_16x16x32_bf16 v[220:223], v[236:239], v[124:127], v[220:223]
s_waitcnt lgkmcnt(2)
v_mfma_f32_16x16x32_bf16 v[192:195], v[240:243], v[0:3], 0
ds_read_b128 v[232:235], v248 offset:40960
v_mfma_f32_16x16x32_bf16 v[192:195], v[244:247], v[4:7], v[192:195]
v_exp_f32 v208, v208
v_mfma_f32_16x16x32_bf16 v[196:199], v[240:243], v[32:35], 0
v_exp_f32 v209, v209
v_mfma_f32_16x16x32_bf16 v[196:199], v[244:247], v[36:39], v[196:199]
v_exp_f32 v210, v210
v_mfma_f32_16x16x32_bf16 v[200:203], v[240:243], v[64:67], 0
ds_read_b128 v[236:239], v248 offset:41472
v_cvt_pk_bf16_f32 v146, v208, v209
v_mfma_f32_16x16x32_bf16 v[200:203], v[244:247], v[68:71], v[200:203]
v_exp_f32 v211, v211
v_mfma_f32_16x16x32_bf16 v[204:207], v[240:243], v[96:99], 0
v_exp_f32 v212, v212
v_mfma_f32_16x16x32_bf16 v[204:207], v[244:247], v[100:103], v[204:207]
s_waitcnt lgkmcnt(2)
v_cvt_pk_bf16_f32 v147, v210, v211
v_mfma_f32_16x16x32_bf16 v[192:195], v[224:227], v[8:11], v[192:195]
ds_read_b128 v[240:243], v248 offset:45056
v_mfma_f32_16x16x32_bf16 v[192:195], v[228:231], v[12:15], v[192:195]
v_exp_f32 v213, v213
v_mfma_f32_16x16x32_bf16 v[196:199], v[224:227], v[40:43], v[196:199]
v_exp_f32 v214, v214
v_mfma_f32_16x16x32_bf16 v[196:199], v[228:231], v[44:47], v[196:199]
v_exp_f32 v215, v215
v_mfma_f32_16x16x32_bf16 v[200:203], v[224:227], v[72:75], v[200:203]
ds_read_b128 v[244:247], v248 offset:45568
v_cvt_pk_bf16_f32 v150, v212, v213
v_mfma_f32_16x16x32_bf16 v[200:203], v[228:231], v[76:79], v[200:203]
v_cvt_pk_bf16_f32 v151, v214, v215
v_mfma_f32_16x16x32_bf16 v[204:207], v[224:227], v[104:107], v[204:207]
v_exp_f32 v216, v216
v_mfma_f32_16x16x32_bf16 v[204:207], v[228:231], v[108:111], v[204:207]
s_waitcnt lgkmcnt(2)
v_mfma_f32_16x16x32_bf16 v[192:195], v[232:235], v[16:19], v[192:195]
ds_read_b128 v[224:227], v248 offset:34816
v_mfma_f32_16x16x32_bf16 v[192:195], v[236:239], v[20:23], v[192:195]
v_exp_f32 v217, v217
v_mfma_f32_16x16x32_bf16 v[196:199], v[232:235], v[48:51], v[196:199]
v_exp_f32 v218, v218
v_mfma_f32_16x16x32_bf16 v[196:199], v[236:239], v[52:55], v[196:199]
v_exp_f32 v219, v219
v_mfma_f32_16x16x32_bf16 v[200:203], v[232:235], v[80:83], v[200:203]
ds_read_b128 v[228:231], v248 offset:35328
v_cvt_pk_bf16_f32 v154, v216, v217
v_mfma_f32_16x16x32_bf16 v[200:203], v[236:239], v[84:87], v[200:203]
v_cvt_pk_bf16_f32 v155, v218, v219
v_mfma_f32_16x16x32_bf16 v[204:207], v[232:235], v[112:115], v[204:207]
v_exp_f32 v220, v220
v_mfma_f32_16x16x32_bf16 v[204:207], v[236:239], v[116:119], v[204:207]
s_waitcnt lgkmcnt(2)
v_mfma_f32_16x16x32_bf16 v[192:195], v[240:243], v[24:27], v[192:195]
ds_read_b128 v[232:235], v248 offset:38912
v_mfma_f32_16x16x32_bf16 v[192:195], v[244:247], v[28:31], v[192:195]
v_exp_f32 v221, v221
v_mfma_f32_16x16x32_bf16 v[196:199], v[240:243], v[56:59], v[196:199]
v_exp_f32 v222, v222
v_mfma_f32_16x16x32_bf16 v[196:199], v[244:247], v[60:63], v[196:199]
v_exp_f32 v223, v223
v_mfma_f32_16x16x32_bf16 v[200:203], v[240:243], v[88:91], v[200:203]
ds_read_b128 v[236:239], v248 offset:39424
v_cvt_pk_bf16_f32 v158, v220, v221
v_mfma_f32_16x16x32_bf16 v[200:203], v[244:247], v[92:95], v[200:203]
v_cvt_pk_bf16_f32 v159, v222, v223
v_mfma_f32_16x16x32_bf16 v[204:207], v[240:243], v[120:123], v[204:207]
v_mfma_f32_16x16x32_bf16 v[204:207], v[244:247], v[124:127], v[204:207]
s_waitcnt lgkmcnt(2)
v_mfma_f32_16x16x32_bf16 v[208:211], v[224:227], v[0:3], 0
ds_read_b128 v[240:243], v248 offset:43008
v_mfma_f32_16x16x32_bf16 v[208:211], v[228:231], v[4:7], v[208:211]
v_exp_f32 v192, v192
v_mfma_f32_16x16x32_bf16 v[212:215], v[224:227], v[32:35], 0
v_exp_f32 v193, v193
v_mfma_f32_16x16x32_bf16 v[212:215], v[228:231], v[36:39], v[212:215]
v_exp_f32 v194, v194
v_mfma_f32_16x16x32_bf16 v[216:219], v[224:227], v[64:67], 0
ds_read_b128 v[244:247], v248 offset:43520
v_cvt_pk_bf16_f32 v160, v192, v193
v_mfma_f32_16x16x32_bf16 v[216:219], v[228:231], v[68:71], v[216:219]
v_exp_f32 v195, v195
v_mfma_f32_16x16x32_bf16 v[220:223], v[224:227], v[96:99], 0
v_exp_f32 v196, v196
v_mfma_f32_16x16x32_bf16 v[220:223], v[228:231], v[100:103], v[220:223]
s_waitcnt lgkmcnt(2)
v_cvt_pk_bf16_f32 v161, v194, v195
v_mfma_f32_16x16x32_bf16 v[208:211], v[232:235], v[8:11], v[208:211]
ds_read_b128 v[224:227], v248 offset:47104
v_mfma_f32_16x16x32_bf16 v[208:211], v[236:239], v[12:15], v[208:211]
v_exp_f32 v197, v197
v_mfma_f32_16x16x32_bf16 v[212:215], v[232:235], v[40:43], v[212:215]
v_exp_f32 v198, v198
v_mfma_f32_16x16x32_bf16 v[212:215], v[236:239], v[44:47], v[212:215]
v_exp_f32 v199, v199
v_mfma_f32_16x16x32_bf16 v[216:219], v[232:235], v[72:75], v[216:219]
ds_read_b128 v[228:231], v248 offset:47616
v_cvt_pk_bf16_f32 v164, v196, v197
v_mfma_f32_16x16x32_bf16 v[216:219], v[236:239], v[76:79], v[216:219]
v_cvt_pk_bf16_f32 v165, v198, v199
v_mfma_f32_16x16x32_bf16 v[220:223], v[232:235], v[104:107], v[220:223]
v_exp_f32 v200, v200
v_mfma_f32_16x16x32_bf16 v[220:223], v[236:239], v[108:111], v[220:223]
s_waitcnt lgkmcnt(2)
s_waitcnt vmcnt(0)
s_barrier
v_mfma_f32_16x16x32_bf16 v[208:211], v[240:243], v[16:19], v[208:211]
ds_read_b128 v[232:235], v248 offset:49152
v_mfma_f32_16x16x32_bf16 v[208:211], v[244:247], v[20:23], v[208:211]
v_exp_f32 v201, v201
v_mfma_f32_16x16x32_bf16 v[212:215], v[240:243], v[48:51], v[212:215]
v_exp_f32 v202, v202
v_mfma_f32_16x16x32_bf16 v[212:215], v[244:247], v[52:55], v[212:215]
v_exp_f32 v203, v203
v_mfma_f32_16x16x32_bf16 v[216:219], v[240:243], v[80:83], v[216:219]
ds_read_b128 v[236:239], v248 offset:49664
v_cvt_pk_bf16_f32 v168, v200, v201
v_mfma_f32_16x16x32_bf16 v[216:219], v[244:247], v[84:87], v[216:219]
v_cvt_pk_bf16_f32 v169, v202, v203
v_mfma_f32_16x16x32_bf16 v[220:223], v[240:243], v[112:115], v[220:223]
v_exp_f32 v204, v204
v_mfma_f32_16x16x32_bf16 v[220:223], v[244:247], v[116:119], v[220:223]
s_waitcnt lgkmcnt(2)
v_mfma_f32_16x16x32_bf16 v[208:211], v[224:227], v[24:27], v[208:211]
ds_read_b128 v[240:243], v248 offset:53248
v_mfma_f32_16x16x32_bf16 v[208:211], v[228:231], v[28:31], v[208:211]
v_exp_f32 v205, v205
v_mfma_f32_16x16x32_bf16 v[212:215], v[224:227], v[56:59], v[212:215]
v_exp_f32 v206, v206
v_mfma_f32_16x16x32_bf16 v[212:215], v[228:231], v[60:63], v[212:215]
v_exp_f32 v207, v207
v_mfma_f32_16x16x32_bf16 v[216:219], v[224:227], v[88:91], v[216:219]
ds_read_b128 v[244:247], v248 offset:53760
v_cvt_pk_bf16_f32 v172, v204, v205
v_mfma_f32_16x16x32_bf16 v[216:219], v[228:231], v[92:95], v[216:219]
v_cvt_pk_bf16_f32 v173, v206, v207
v_mfma_f32_16x16x32_bf16 v[220:223], v[224:227], v[120:123], v[220:223]
v_mfma_f32_16x16x32_bf16 v[220:223], v[228:231], v[124:127], v[220:223]
s_waitcnt lgkmcnt(2)
v_mfma_f32_16x16x32_bf16 v[192:195], v[232:235], v[0:3], 0
ds_read_b128 v[224:227], v248 offset:57344
v_mfma_f32_16x16x32_bf16 v[192:195], v[236:239], v[4:7], v[192:195]
v_exp_f32 v208, v208
v_mfma_f32_16x16x32_bf16 v[196:199], v[232:235], v[32:35], 0
v_exp_f32 v209, v209
v_mfma_f32_16x16x32_bf16 v[196:199], v[236:239], v[36:39], v[196:199]
v_exp_f32 v210, v210
v_mfma_f32_16x16x32_bf16 v[200:203], v[232:235], v[64:67], 0
ds_read_b128 v[228:231], v248 offset:57856
v_cvt_pk_bf16_f32 v162, v208, v209
v_mfma_f32_16x16x32_bf16 v[200:203], v[236:239], v[68:71], v[200:203]
v_exp_f32 v211, v211
v_mfma_f32_16x16x32_bf16 v[204:207], v[232:235], v[96:99], 0
v_exp_f32 v212, v212
v_mfma_f32_16x16x32_bf16 v[204:207], v[236:239], v[100:103], v[204:207]
s_waitcnt lgkmcnt(2)
v_cvt_pk_bf16_f32 v163, v210, v211
v_mfma_f32_16x16x32_bf16 v[192:195], v[240:243], v[8:11], v[192:195]
ds_read_b128 v[232:235], v248 offset:61440
v_mfma_f32_16x16x32_bf16 v[192:195], v[244:247], v[12:15], v[192:195]
v_exp_f32 v213, v213
v_mfma_f32_16x16x32_bf16 v[196:199], v[240:243], v[40:43], v[196:199]
v_exp_f32 v214, v214
v_mfma_f32_16x16x32_bf16 v[196:199], v[244:247], v[44:47], v[196:199]
v_exp_f32 v215, v215
v_mfma_f32_16x16x32_bf16 v[200:203], v[240:243], v[72:75], v[200:203]
ds_read_b128 v[236:239], v248 offset:61952
v_cvt_pk_bf16_f32 v166, v212, v213
v_mfma_f32_16x16x32_bf16 v[200:203], v[244:247], v[76:79], v[200:203]
v_cvt_pk_bf16_f32 v167, v214, v215
v_mfma_f32_16x16x32_bf16 v[204:207], v[240:243], v[104:107], v[204:207]
v_exp_f32 v216, v216
v_mfma_f32_16x16x32_bf16 v[204:207], v[244:247], v[108:111], v[204:207]
s_waitcnt lgkmcnt(2)
v_mfma_f32_16x16x32_bf16 v[192:195], v[224:227], v[16:19], v[192:195]
ds_read_b128 v[240:243], v248 offset:51200
v_mfma_f32_16x16x32_bf16 v[192:195], v[228:231], v[20:23], v[192:195]
v_exp_f32 v217, v217
v_mfma_f32_16x16x32_bf16 v[196:199], v[224:227], v[48:51], v[196:199]
v_exp_f32 v218, v218
v_mfma_f32_16x16x32_bf16 v[196:199], v[228:231], v[52:55], v[196:199]
v_exp_f32 v219, v219
v_mfma_f32_16x16x32_bf16 v[200:203], v[224:227], v[80:83], v[200:203]
ds_read_b128 v[244:247], v248 offset:51712
v_cvt_pk_bf16_f32 v170, v216, v217
v_mfma_f32_16x16x32_bf16 v[200:203], v[228:231], v[84:87], v[200:203]
v_cvt_pk_bf16_f32 v171, v218, v219
v_mfma_f32_16x16x32_bf16 v[204:207], v[224:227], v[112:115], v[204:207]
v_exp_f32 v220, v220
v_mfma_f32_16x16x32_bf16 v[204:207], v[228:231], v[116:119], v[204:207]
s_waitcnt lgkmcnt(2)
v_mfma_f32_16x16x32_bf16 v[192:195], v[232:235], v[24:27], v[192:195]
ds_read_b128 v[224:227], v248 offset:55296
v_mfma_f32_16x16x32_bf16 v[192:195], v[236:239], v[28:31], v[192:195]
v_exp_f32 v221, v221
v_mfma_f32_16x16x32_bf16 v[196:199], v[232:235], v[56:59], v[196:199]
v_exp_f32 v222, v222
v_mfma_f32_16x16x32_bf16 v[196:199], v[236:239], v[60:63], v[196:199]
v_exp_f32 v223, v223
v_mfma_f32_16x16x32_bf16 v[200:203], v[232:235], v[88:91], v[200:203]
ds_read_b128 v[228:231], v248 offset:55808
v_cvt_pk_bf16_f32 v174, v220, v221
v_mfma_f32_16x16x32_bf16 v[200:203], v[236:239], v[92:95], v[200:203]
v_cvt_pk_bf16_f32 v175, v222, v223
v_mfma_f32_16x16x32_bf16 v[204:207], v[232:235], v[120:123], v[204:207]
v_mfma_f32_16x16x32_bf16 v[204:207], v[236:239], v[124:127], v[204:207]
s_waitcnt lgkmcnt(2)
v_mfma_f32_16x16x32_bf16 v[208:211], v[240:243], v[0:3], 0
ds_read_b128 v[232:235], v248 offset:59392
v_mfma_f32_16x16x32_bf16 v[208:211], v[244:247], v[4:7], v[208:211]
v_exp_f32 v192, v192
v_mfma_f32_16x16x32_bf16 v[212:215], v[240:243], v[32:35], 0
v_exp_f32 v193, v193
v_mfma_f32_16x16x32_bf16 v[212:215], v[244:247], v[36:39], v[212:215]
v_exp_f32 v194, v194
v_mfma_f32_16x16x32_bf16 v[216:219], v[240:243], v[64:67], 0
ds_read_b128 v[236:239], v248 offset:59904
v_cvt_pk_bf16_f32 v176, v192, v193
v_mfma_f32_16x16x32_bf16 v[216:219], v[244:247], v[68:71], v[216:219]
v_exp_f32 v195, v195
v_mfma_f32_16x16x32_bf16 v[220:223], v[240:243], v[96:99], 0
v_exp_f32 v196, v196
v_mfma_f32_16x16x32_bf16 v[220:223], v[244:247], v[100:103], v[220:223]
s_waitcnt lgkmcnt(2)
v_cvt_pk_bf16_f32 v177, v194, v195
v_mfma_f32_16x16x32_bf16 v[208:211], v[224:227], v[8:11], v[208:211]
ds_read_b128 v[240:243], v248 offset:63488
v_mfma_f32_16x16x32_bf16 v[208:211], v[228:231], v[12:15], v[208:211]
v_exp_f32 v197, v197
v_mfma_f32_16x16x32_bf16 v[212:215], v[224:227], v[40:43], v[212:215]
v_exp_f32 v198, v198
v_mfma_f32_16x16x32_bf16 v[212:215], v[228:231], v[44:47], v[212:215]
v_exp_f32 v199, v199
v_mfma_f32_16x16x32_bf16 v[216:219], v[224:227], v[72:75], v[216:219]
ds_read_b128 v[244:247], v248 offset:64000
v_cvt_pk_bf16_f32 v180, v196, v197
v_mfma_f32_16x16x32_bf16 v[216:219], v[228:231], v[76:79], v[216:219]
v_cvt_pk_bf16_f32 v181, v198, v199
v_mfma_f32_16x16x32_bf16 v[220:223], v[224:227], v[104:107], v[220:223]
v_exp_f32 v200, v200
v_mfma_f32_16x16x32_bf16 v[220:223], v[228:231], v[108:111], v[220:223]
s_waitcnt lgkmcnt(2)
v_xor_b32 v248, 0x10000, v248
v_mfma_f32_16x16x32_bf16 v[208:211], v[232:235], v[16:19], v[208:211]
ds_read_b128 v[224:227], v248 offset:0
v_mfma_f32_16x16x32_bf16 v[208:211], v[236:239], v[20:23], v[208:211]
v_exp_f32 v201, v201
v_mfma_f32_16x16x32_bf16 v[212:215], v[232:235], v[48:51], v[212:215]
v_exp_f32 v202, v202
v_mfma_f32_16x16x32_bf16 v[212:215], v[236:239], v[52:55], v[212:215]
v_exp_f32 v203, v203
v_mfma_f32_16x16x32_bf16 v[216:219], v[232:235], v[80:83], v[216:219]
ds_read_b128 v[228:231], v248 offset:512
v_cvt_pk_bf16_f32 v184, v200, v201
v_mfma_f32_16x16x32_bf16 v[216:219], v[236:239], v[84:87], v[216:219]
v_cvt_pk_bf16_f32 v185, v202, v203
v_mfma_f32_16x16x32_bf16 v[220:223], v[232:235], v[112:115], v[220:223]
v_exp_f32 v204, v204
v_mfma_f32_16x16x32_bf16 v[220:223], v[236:239], v[116:119], v[220:223]
s_waitcnt lgkmcnt(2)
v_mfma_f32_16x16x32_bf16 v[208:211], v[240:243], v[24:27], v[208:211]
ds_read_b128 v[232:235], v248 offset:4096
v_mfma_f32_16x16x32_bf16 v[208:211], v[244:247], v[28:31], v[208:211]
v_exp_f32 v205, v205
v_mfma_f32_16x16x32_bf16 v[212:215], v[240:243], v[56:59], v[212:215]
v_exp_f32 v206, v206
v_mfma_f32_16x16x32_bf16 v[212:215], v[244:247], v[60:63], v[212:215]
v_exp_f32 v207, v207
v_mfma_f32_16x16x32_bf16 v[216:219], v[240:243], v[88:91], v[216:219]
ds_read_b128 v[236:239], v248 offset:4608
v_cvt_pk_bf16_f32 v188, v204, v205
v_mfma_f32_16x16x32_bf16 v[216:219], v[244:247], v[92:95], v[216:219]
v_cvt_pk_bf16_f32 v189, v206, v207
v_mfma_f32_16x16x32_bf16 v[220:223], v[240:243], v[120:123], v[220:223]
v_mfma_f32_16x16x32_bf16 v[220:223], v[244:247], v[124:127], v[220:223]
s_waitcnt lgkmcnt(2)
v_mfma_f32_16x16x32_bf16 v[192:195], v[224:227], v[0:3], 0
ds_read_b128 v[240:243], v248 offset:8192
v_mfma_f32_16x16x32_bf16 v[192:195], v[228:231], v[4:7], v[192:195]
v_exp_f32 v208, v208
v_mfma_f32_16x16x32_bf16 v[196:199], v[224:227], v[32:35], 0
v_exp_f32 v209, v209
v_mfma_f32_16x16x32_bf16 v[196:199], v[228:231], v[36:39], v[196:199]
v_exp_f32 v210, v210
v_mfma_f32_16x16x32_bf16 v[200:203], v[224:227], v[64:67], 0
ds_read_b128 v[244:247], v248 offset:8704
v_cvt_pk_bf16_f32 v178, v208, v209
v_mfma_f32_16x16x32_bf16 v[200:203], v[228:231], v[68:71], v[200:203]
v_exp_f32 v211, v211
v_mfma_f32_16x16x32_bf16 v[204:207], v[224:227], v[96:99], 0
v_exp_f32 v212, v212
v_mfma_f32_16x16x32_bf16 v[204:207], v[228:231], v[100:103], v[204:207]
s_waitcnt lgkmcnt(2)
v_cvt_pk_bf16_f32 v179, v210, v211
v_mfma_f32_16x16x32_bf16 v[192:195], v[232:235], v[8:11], v[192:195]
ds_read_b128 v[224:227], v248 offset:12288
v_mfma_f32_16x16x32_bf16 v[192:195], v[236:239], v[12:15], v[192:195]
v_exp_f32 v213, v213
v_mfma_f32_16x16x32_bf16 v[196:199], v[232:235], v[40:43], v[196:199]
ds_read_b128 v[4:7], v255 offset:0
ds_read_b128 v[36:39], v255 offset:1024
v_mfma_f32_16x16x32_bf16 v[196:199], v[236:239], v[44:47], v[196:199]
v_exp_f32 v214, v214
v_mfma_f32_16x16x32_bf16 v[200:203], v[232:235], v[72:75], v[200:203]
ds_read_b128 v[228:231], v248 offset:12800
v_xor_b32 v12, 0x10000, v249
v_mfma_f32_16x16x32_bf16 v[200:203], v[236:239], v[76:79], v[200:203]
v_xor_b32 v13, 0x10000, v250
v_cvt_pk_bf16_f32 v182, v212, v213
v_mfma_f32_16x16x32_bf16 v[204:207], v[232:235], v[104:107], v[204:207]
ds_read_b128 v[68:71], v255 offset:2048
ds_read_b128 v[100:103], v255 offset:3072
v_mfma_f32_16x16x32_bf16 v[204:207], v[236:239], v[108:111], v[204:207]
s_waitcnt lgkmcnt(6)
v_mov_b32 v2, 0
v_mfma_f32_16x16x32_bf16 v[192:195], v[240:243], v[16:19], v[192:195]
ds_read_b64_tr_b16 v[232:233], v12 offset:0
ds_read_b64_tr_b16 v[234:235], v12 offset:2048
v_mfma_f32_16x16x32_bf16 v[192:195], v[244:247], v[20:23], v[192:195]
v_exp_f32 v215, v215
v_mfma_f32_16x16x32_bf16 v[196:199], v[240:243], v[48:51], v[196:199]
ds_read_b128 v[8:11], v255 offset:4096
ds_read_b128 v[40:43], v255 offset:5120
v_mfma_f32_16x16x32_bf16 v[196:199], v[244:247], v[52:55], v[196:199]
v_cvt_pk_bf16_f32 v183, v214, v215
v_mov_b32 v3, 0
v_mfma_f32_16x16x32_bf16 v[200:203], v[240:243], v[80:83], v[200:203]
ds_read_b64_tr_b16 v[236:237], v12 offset:16384
ds_read_b64_tr_b16 v[238:239], v12 offset:18432
v_mfma_f32_16x16x32_bf16 v[200:203], v[244:247], v[84:87], v[200:203]
v_exp_f32 v216, v216
v_mfma_f32_16x16x32_bf16 v[204:207], v[240:243], v[112:115], v[204:207]
ds_read_b128 v[72:75], v255 offset:6144
ds_read_b128 v[104:107], v255 offset:7168
v_mfma_f32_16x16x32_bf16 v[204:207], v[244:247], v[116:119], v[204:207]
s_waitcnt lgkmcnt(10)
v_mov_b32 v34, 0
v_mfma_f32_16x16x32_bf16 v[192:195], v[224:227], v[24:27], v[192:195]
ds_read_b64_tr_b16 v[240:241], v12 offset:32768
ds_read_b64_tr_b16 v[242:243], v12 offset:34816
v_mfma_f32_16x16x32_bf16 v[192:195], v[228:231], v[28:31], v[192:195]
v_exp_f32 v217, v217
v_mfma_f32_16x16x32_bf16 v[196:199], v[224:227], v[56:59], v[196:199]
v_exp_f32 v218, v218
v_mfma_f32_16x16x32_bf16 v[196:199], v[228:231], v[60:63], v[196:199]
v_exp_f32 v219, v219
v_mfma_f32_16x16x32_bf16 v[200:203], v[224:227], v[88:91], v[200:203]
ds_read_b64_tr_b16 v[244:245], v12 offset:49152
ds_read_b64_tr_b16 v[246:247], v12 offset:51200
v_mfma_f32_16x16x32_bf16 v[200:203], v[228:231], v[92:95], v[200:203]
v_cvt_pk_bf16_f32 v186, v216, v217
v_cvt_pk_bf16_f32 v187, v218, v219
v_mfma_f32_16x16x32_bf16 v[204:207], v[224:227], v[120:123], v[204:207]
v_exp_f32 v220, v220
v_mfma_f32_16x16x32_bf16 v[204:207], v[228:231], v[124:127], v[204:207]
s_waitcnt lgkmcnt(6)
s_waitcnt lgkmcnt(4)
v_mfma_f32_16x16x32_bf16 a[0:3], v[232:235], v[128:131], a[0:3]
ds_read_b64_tr_b16 v[224:225], v13 offset:0
ds_read_b64_tr_b16 v[226:227], v13 offset:2048
v_mfma_f32_16x16x32_bf16 a[0:3], v[236:239], v[144:147], a[0:3]
v_exp_f32 v221, v221
v_mfma_f32_16x16x32_bf16 a[4:7], v[232:235], v[132:135], a[4:7]
v_exp_f32 v222, v222
v_mfma_f32_16x16x32_bf16 a[4:7], v[236:239], v[148:151], a[4:7]
v_exp_f32 v223, v223
v_mfma_f32_16x16x32_bf16 a[8:11], v[232:235], v[136:139], a[8:11]
ds_read_b64_tr_b16 v[228:229], v13 offset:16384
ds_read_b64_tr_b16 v[230:231], v13 offset:18432
v_mfma_f32_16x16x32_bf16 a[8:11], v[236:239], v[152:155], a[8:11]
v_cvt_pk_bf16_f32 v190, v220, v221
v_cvt_pk_bf16_f32 v191, v222, v223
v_mfma_f32_16x16x32_bf16 a[12:15], v[232:235], v[140:143], a[12:15]
v_exp_f32 v192, v192
v_mfma_f32_16x16x32_bf16 a[12:15], v[236:239], v[156:159], a[12:15]
s_waitcnt lgkmcnt(4)
v_mov_b32 v35, 0
v_mfma_f32_16x16x32_bf16 a[0:3], v[240:243], v[160:163], a[0:3]
ds_read_b64_tr_b16 v[232:233], v13 offset:32768
ds_read_b64_tr_b16 v[234:235], v13 offset:34816
v_mfma_f32_16x16x32_bf16 a[0:3], v[244:247], v[176:179], a[0:3]
v_exp_f32 v193, v193
v_mfma_f32_16x16x32_bf16 a[4:7], v[240:243], v[164:167], a[4:7]
v_exp_f32 v194, v194
v_mfma_f32_16x16x32_bf16 a[4:7], v[244:247], v[180:183], a[4:7]
v_exp_f32 v195, v195
v_mfma_f32_16x16x32_bf16 a[8:11], v[240:243], v[168:171], a[8:11]
ds_read_b64_tr_b16 v[236:237], v13 offset:49152
ds_read_b64_tr_b16 v[238:239], v13 offset:51200
v_mfma_f32_16x16x32_bf16 a[8:11], v[244:247], v[184:187], a[8:11]
v_cvt_pk_bf16_f32 v0, v192, v193
v_cvt_pk_bf16_f32 v1, v194, v195
v_mfma_f32_16x16x32_bf16 a[12:15], v[240:243], v[172:175], a[12:15]
v_exp_f32 v196, v196
v_mfma_f32_16x16x32_bf16 a[12:15], v[244:247], v[188:191], a[12:15]
s_waitcnt lgkmcnt(4)
v_mov_b32 v66, 0
v_mfma_f32_16x16x32_bf16 a[16:19], v[224:227], v[128:131], a[16:19]
ds_read_b64_tr_b16 v[240:241], v249 offset:33280
ds_read_b64_tr_b16 v[242:243], v249 offset:35328
v_mfma_f32_16x16x32_bf16 a[16:19], v[228:231], v[144:147], a[16:19]
v_exp_f32 v197, v197
v_mfma_f32_16x16x32_bf16 a[20:23], v[224:227], v[132:135], a[20:23]
v_exp_f32 v198, v198
v_mfma_f32_16x16x32_bf16 a[20:23], v[228:231], v[148:151], a[20:23]
v_exp_f32 v199, v199
v_mfma_f32_16x16x32_bf16 a[24:27], v[224:227], v[136:139], a[24:27]
ds_read_b64_tr_b16 v[244:245], v249 offset:49664
ds_read_b64_tr_b16 v[246:247], v249 offset:51712
v_mfma_f32_16x16x32_bf16 a[24:27], v[228:231], v[152:155], a[24:27]
v_cvt_pk_bf16_f32 v32, v196, v197
v_cvt_pk_bf16_f32 v33, v198, v199
v_mfma_f32_16x16x32_bf16 a[28:31], v[224:227], v[140:143], a[28:31]
v_exp_f32 v200, v200
v_mfma_f32_16x16x32_bf16 a[28:31], v[228:231], v[156:159], a[28:31]
s_waitcnt lgkmcnt(4)
v_mov_b32 v67, 0
v_mfma_f32_16x16x32_bf16 a[16:19], v[232:235], v[160:163], a[16:19]
ds_read_b64_tr_b16 v[224:225], v12 offset:512
ds_read_b64_tr_b16 v[226:227], v12 offset:2560
v_mfma_f32_16x16x32_bf16 a[16:19], v[236:239], v[176:179], a[16:19]
v_exp_f32 v201, v201
v_mfma_f32_16x16x32_bf16 a[20:23], v[232:235], v[164:167], a[20:23]
v_exp_f32 v202, v202
v_mfma_f32_16x16x32_bf16 a[20:23], v[236:239], v[180:183], a[20:23]
v_exp_f32 v203, v203
v_mfma_f32_16x16x32_bf16 a[24:27], v[232:235], v[168:171], a[24:27]
ds_read_b64_tr_b16 v[228:229], v12 offset:16896
ds_read_b64_tr_b16 v[230:231], v12 offset:18944
v_mfma_f32_16x16x32_bf16 a[24:27], v[236:239], v[184:187], a[24:27]
v_cvt_pk_bf16_f32 v64, v200, v201
v_cvt_pk_bf16_f32 v65, v202, v203
v_mfma_f32_16x16x32_bf16 a[28:31], v[232:235], v[172:175], a[28:31]
v_exp_f32 v204, v204
v_mfma_f32_16x16x32_bf16 a[28:31], v[236:239], v[188:191], a[28:31]
s_waitcnt lgkmcnt(4)
v_mov_b32 v98, 0
v_mfma_f32_16x16x32_bf16 a[32:35], v[240:243], v[4:7], a[32:35]
ds_read_b64_tr_b16 v[232:233], v249 offset:0
ds_read_b64_tr_b16 v[234:235], v249 offset:2048
v_mfma_f32_16x16x32_bf16 a[32:35], v[244:247], v[8:11], a[32:35]
v_exp_f32 v205, v205
v_mfma_f32_16x16x32_bf16 a[36:39], v[240:243], v[36:39], a[36:39]
v_exp_f32 v206, v206
v_mfma_f32_16x16x32_bf16 a[36:39], v[244:247], v[40:43], a[36:39]
v_exp_f32 v207, v207
v_mfma_f32_16x16x32_bf16 a[40:43], v[240:243], v[68:71], a[40:43]
ds_read_b64_tr_b16 v[236:237], v250 offset:0
ds_read_b64_tr_b16 v[238:239], v250 offset:2048
v_mfma_f32_16x16x32_bf16 a[40:43], v[244:247], v[72:75], a[40:43]
v_cvt_pk_bf16_f32 v96, v204, v205
v_cvt_pk_bf16_f32 v97, v206, v207
v_mfma_f32_16x16x32_bf16 a[44:47], v[240:243], v[100:103], a[44:47]
v_mov_b32 v99, 0
v_mfma_f32_16x16x32_bf16 a[44:47], v[244:247], v[104:107], a[44:47]
s_waitcnt lgkmcnt(4)
v_mfma_f32_16x16x32_bf16 a[32:35], v[224:227], v[128:131], a[32:35]
ds_read_b64_tr_b16 v[240:241], v12 offset:33280
ds_read_b64_tr_b16 v[242:243], v12 offset:35328
v_mfma_f32_16x16x32_bf16 a[32:35], v[228:231], v[144:147], a[32:35]
v_mfma_f32_16x16x32_bf16 a[36:39], v[224:227], v[132:135], a[36:39]
v_mfma_f32_16x16x32_bf16 a[36:39], v[228:231], v[148:151], a[36:39]
v_mfma_f32_16x16x32_bf16 a[40:43], v[224:227], v[136:139], a[40:43]
ds_read_b64_tr_b16 v[244:245], v12 offset:49664
ds_read_b64_tr_b16 v[246:247], v12 offset:51712
v_mfma_f32_16x16x32_bf16 a[40:43], v[228:231], v[152:155], a[40:43]
v_mfma_f32_16x16x32_bf16 a[44:47], v[224:227], v[140:143], a[44:47]
v_mfma_f32_16x16x32_bf16 a[44:47], v[228:231], v[156:159], a[44:47]
s_waitcnt lgkmcnt(4)
v_mfma_f32_16x16x32_bf16 a[0:3], v[232:235], v[0:3], a[0:3]
ds_read_b64_tr_b16 v[224:225], v249 offset:512
ds_read_b64_tr_b16 v[226:227], v249 offset:2560
v_mfma_f32_16x16x32_bf16 a[4:7], v[232:235], v[32:35], a[4:7]
v_mfma_f32_16x16x32_bf16 a[8:11], v[232:235], v[64:67], a[8:11]
v_mfma_f32_16x16x32_bf16 a[12:15], v[232:235], v[96:99], a[12:15]
v_mfma_f32_16x16x32_bf16 a[16:19], v[236:239], v[0:3], a[16:19]
ds_read_b64_tr_b16 v[228:229], v250 offset:512
ds_read_b64_tr_b16 v[230:231], v250 offset:2560
v_mfma_f32_16x16x32_bf16 a[20:23], v[236:239], v[32:35], a[20:23]
v_mfma_f32_16x16x32_bf16 a[24:27], v[236:239], v[64:67], a[24:27]
v_mfma_f32_16x16x32_bf16 a[28:31], v[236:239], v[96:99], a[28:31]
s_waitcnt lgkmcnt(4)
v_mfma_f32_16x16x32_bf16 a[32:35], v[240:243], v[160:163], a[32:35]
ds_read_b64_tr_b16 v[232:233], v250 offset:33280
ds_read_b64_tr_b16 v[234:235], v250 offset:35328
v_mfma_f32_16x16x32_bf16 a[32:35], v[244:247], v[176:179], a[32:35]
v_mfma_f32_16x16x32_bf16 a[36:39], v[240:243], v[164:167], a[36:39]
v_mfma_f32_16x16x32_bf16 a[36:39], v[244:247], v[180:183], a[36:39]
v_mfma_f32_16x16x32_bf16 a[40:43], v[240:243], v[168:171], a[40:43]
ds_read_b64_tr_b16 v[236:237], v250 offset:49664
ds_read_b64_tr_b16 v[238:239], v250 offset:51712
v_accvgpr_read_b32 v192, a0
v_mfma_f32_16x16x32_bf16 a[40:43], v[244:247], v[184:187], a[40:43]
v_accvgpr_read_b32 v193, a4
v_accvgpr_read_b32 v194, a8
v_accvgpr_read_b32 v195, a12
v_mfma_f32_16x16x32_bf16 a[44:47], v[240:243], v[172:175], a[44:47]
v_lshlrev_b32 v253, 2, v252
v_subrev_u32 v196, 0x0d800000, v192
v_subrev_u32 v197, 0x0d800000, v193
v_mfma_f32_16x16x32_bf16 a[44:47], v[244:247], v[188:191], a[44:47]
s_waitcnt lgkmcnt(4)
v_subrev_u32 v198, 0x0d800000, v194
v_subrev_u32 v199, 0x0d800000, v195
v_mfma_f32_16x16x32_bf16 a[32:35], v[224:227], v[0:3], a[32:35]
ds_read_b64_tr_b16 v[240:241], v13 offset:512
ds_read_b64_tr_b16 v[242:243], v13 offset:2560
v_max3_u32 v254, v196, v197, v198
v_mfma_f32_16x16x32_bf16 a[36:39], v[224:227], v[32:35], a[36:39]
v_max_u32 v254, v254, v199
v_mfma_f32_16x16x32_bf16 a[40:43], v[224:227], v[64:67], a[40:43]
s_mov_b64 exec, 0xffff
s_xor_b32 s35, s48, 0
buffer_store_dword v192, v253, s[24:27], s35 offen offset:4 sc1
s_xor_b32 s35, s48, 1024
buffer_store_dword v193, v253, s[24:27], s35 offen offset:4 sc1
s_xor_b32 s35, s48, 2048
buffer_store_dword v194, v253, s[24:27], s35 offen offset:4 sc1
s_xor_b32 s35, s48, 3072
buffer_store_dword v195, v253, s[24:27], s35 offen offset:4 sc1
v_cmp_le_u32 vcc, 0x64000000, v254
s_mov_b64 exec, -1
v_mfma_f32_16x16x32_bf16 a[44:47], v[224:227], v[96:99], a[44:47]
v_accvgpr_read_b32 v192, a0
v_accvgpr_read_b32 v193, a1
v_mfma_f32_16x16x32_bf16 a[48:51], v[228:231], v[0:3], a[48:51]
ds_read_b64_tr_b16 v[244:245], v13 offset:16896
ds_read_b64_tr_b16 v[246:247], v13 offset:18944
v_mfma_f32_16x16x32_bf16 a[52:55], v[228:231], v[32:35], a[52:55]
v_accvgpr_read_b32 v194, a2
v_accvgpr_read_b32 v195, a3
v_mfma_f32_16x16x32_bf16 a[56:59], v[228:231], v[64:67], a[56:59]
v_cvt_pk_bf16_f32 v16, v192, v193
v_cvt_pk_bf16_f32 v17, v194, v195
v_mfma_f32_16x16x32_bf16 a[60:63], v[228:231], v[96:99], a[60:63]
s_waitcnt lgkmcnt(4)
v_accvgpr_read_b32 v200, a4
v_mfma_f32_16x16x32_bf16 a[48:51], v[232:235], v[4:7], a[48:51]
ds_read_b64_tr_b16 v[224:225], v13 offset:33280
ds_read_b64_tr_b16 v[226:227], v13 offset:35328
v_mfma_f32_16x16x32_bf16 a[48:51], v[236:239], v[8:11], a[48:51]
v_accvgpr_read_b32 v201, a5
v_accvgpr_read_b32 v202, a6
v_mfma_f32_16x16x32_bf16 a[52:55], v[232:235], v[36:39], a[52:55]
v_accvgpr_read_b32 v203, a7
v_cvt_pk_bf16_f32 v48, v200, v201
v_mfma_f32_16x16x32_bf16 a[52:55], v[236:239], v[40:43], a[52:55]
v_cvt_pk_bf16_f32 v49, v202, v203
v_accvgpr_read_b32 v208, a8
v_mfma_f32_16x16x32_bf16 a[56:59], v[232:235], v[68:71], a[56:59]
ds_read_b64_tr_b16 v[228:229], v13 offset:49664
ds_read_b64_tr_b16 v[230:231], v13 offset:51712
v_mfma_f32_16x16x32_bf16 a[56:59], v[236:239], v[72:75], a[56:59]
v_accvgpr_read_b32 v209, a9
v_accvgpr_read_b32 v210, a10
v_mfma_f32_16x16x32_bf16 a[60:63], v[232:235], v[100:103], a[60:63]
v_accvgpr_read_b32 v211, a11
v_cvt_pk_bf16_f32 v80, v208, v209
v_mfma_f32_16x16x32_bf16 a[60:63], v[236:239], v[104:107], a[60:63]
s_waitcnt lgkmcnt(4)
v_cvt_pk_bf16_f32 v81, v210, v211
v_mfma_f32_16x16x32_bf16 a[48:51], v[240:243], v[128:131], a[48:51]
ds_read_b64_tr_b16 v[232:233], v249 offset:36864
ds_read_b64_tr_b16 v[234:235], v249 offset:38912
v_mfma_f32_16x16x32_bf16 a[48:51], v[244:247], v[144:147], a[48:51]
v_accvgpr_read_b32 v216, a12
v_accvgpr_read_b32 v217, a13
v_mfma_f32_16x16x32_bf16 a[52:55], v[240:243], v[132:135], a[52:55]
v_accvgpr_read_b32 v218, a14
v_accvgpr_read_b32 v219, a15
v_mfma_f32_16x16x32_bf16 a[52:55], v[244:247], v[148:151], a[52:55]
v_cvt_pk_bf16_f32 v112, v216, v217
v_cvt_pk_bf16_f32 v113, v218, v219
v_mfma_f32_16x16x32_bf16 a[56:59], v[240:243], v[136:139], a[56:59]
ds_read_b64_tr_b16 v[236:237], v249 offset:53248
ds_read_b64_tr_b16 v[238:239], v249 offset:55296
v_mfma_f32_16x16x32_bf16 a[56:59], v[244:247], v[152:155], a[56:59]
v_accvgpr_read_b32 v196, a16
v_accvgpr_read_b32 v197, a17
v_mfma_f32_16x16x32_bf16 a[60:63], v[240:243], v[140:143], a[60:63]
v_accvgpr_read_b32 v198, a18
v_accvgpr_read_b32 v199, a19
v_mfma_f32_16x16x32_bf16 a[60:63], v[244:247], v[156:159], a[60:63]
s_waitcnt lgkmcnt(4)
v_cvt_pk_bf16_f32 v18, v196, v197
v_mfma_f32_16x16x32_bf16 a[48:51], v[224:227], v[160:163], a[48:51]
ds_read_b64_tr_b16 v[240:241], v12 offset:4096
ds_read_b64_tr_b16 v[242:243], v12 offset:6144
v_mfma_f32_16x16x32_bf16 a[48:51], v[228:231], v[176:179], a[48:51]
v_cvt_pk_bf16_f32 v19, v198, v199
buffer_store_dwordx4 v[16:19], v252, s[20:23], s40 offen offset:0 sc1
v_mfma_f32_16x16x32_bf16 a[52:55], v[224:227], v[164:167], a[52:55]
v_accvgpr_read_b32 v204, a20
v_accvgpr_read_b32 v205, a21
v_mfma_f32_16x16x32_bf16 a[52:55], v[228:231], v[180:183], a[52:55]
v_accvgpr_read_b32 v206, a22
v_accvgpr_read_b32 v207, a23
v_mfma_f32_16x16x32_bf16 a[56:59], v[224:227], v[168:171], a[56:59]
ds_read_b64_tr_b16 v[244:245], v12 offset:20480
ds_read_b64_tr_b16 v[246:247], v12 offset:22528
v_mfma_f32_16x16x32_bf16 a[56:59], v[228:231], v[184:187], a[56:59]
v_cvt_pk_bf16_f32 v50, v204, v205
v_cvt_pk_bf16_f32 v51, v206, v207
v_mfma_f32_16x16x32_bf16 a[60:63], v[224:227], v[172:175], a[60:63]
buffer_store_dwordx4 v[48:51], v252, s[20:23], s41 offen offset:0 sc1
v_accvgpr_read_b32 v212, a24
v_mfma_f32_16x16x32_bf16 a[60:63], v[228:231], v[188:191], a[60:63]
s_waitcnt lgkmcnt(4)
v_accvgpr_read_b32 v213, a25
v_mfma_f32_16x16x32_bf16 a[64:67], v[232:235], v[4:7], a[64:67]
ds_read_b64_tr_b16 v[224:225], v12 offset:36864
ds_read_b64_tr_b16 v[226:227], v12 offset:38912
v_mfma_f32_16x16x32_bf16 a[64:67], v[236:239], v[8:11], a[64:67]
v_accvgpr_read_b32 v214, a26
v_accvgpr_read_b32 v215, a27
v_mfma_f32_16x16x32_bf16 a[68:71], v[232:235], v[36:39], a[68:71]
v_cvt_pk_bf16_f32 v82, v212, v213
v_cvt_pk_bf16_f32 v83, v214, v215
v_mfma_f32_16x16x32_bf16 a[68:71], v[236:239], v[40:43], a[68:71]
buffer_store_dwordx4 v[80:83], v252, s[20:23], s42 offen offset:0 sc1
v_accvgpr_read_b32 v220, a28
v_mfma_f32_16x16x32_bf16 a[72:75], v[232:235], v[68:71], a[72:75]
ds_read_b64_tr_b16 v[228:229], v12 offset:53248
ds_read_b64_tr_b16 v[230:231], v12 offset:55296
v_mfma_f32_16x16x32_bf16 a[72:75], v[236:239], v[72:75], a[72:75]
v_accvgpr_read_b32 v221, a29
v_accvgpr_read_b32 v222, a30
v_mfma_f32_16x16x32_bf16 a[76:79], v[232:235], v[100:103], a[76:79]
v_accvgpr_read_b32 v223, a31
v_cvt_pk_bf16_f32 v114, v220, v221
v_mfma_f32_16x16x32_bf16 a[76:79], v[236:239], v[104:107], a[76:79]
s_waitcnt lgkmcnt(4)
v_cvt_pk_bf16_f32 v115, v222, v223
v_mfma_f32_16x16x32_bf16 a[64:67], v[240:243], v[128:131], a[64:67]
ds_read_b64_tr_b16 v[232:233], v249 offset:4096
ds_read_b64_tr_b16 v[234:235], v249 offset:6144
v_mfma_f32_16x16x32_bf16 a[64:67], v[244:247], v[144:147], a[64:67]
buffer_store_dwordx4 v[112:115], v252, s[20:23], s43 offen offset:0 sc1
v_accvgpr_read_b32 v192, a32
v_mfma_f32_16x16x32_bf16 a[68:71], v[240:243], v[132:135], a[68:71]
v_accvgpr_read_b32 v193, a33
v_accvgpr_read_b32 v194, a34
v_mfma_f32_16x16x32_bf16 a[68:71], v[244:247], v[148:151], a[68:71]
v_accvgpr_read_b32 v195, a35
v_cvt_pk_bf16_f32 v20, v192, v193
v_mfma_f32_16x16x32_bf16 a[72:75], v[240:243], v[136:139], a[72:75]
ds_read_b64_tr_b16 v[236:237], v250 offset:4096
ds_read_b64_tr_b16 v[238:239], v250 offset:6144
v_mfma_f32_16x16x32_bf16 a[72:75], v[244:247], v[152:155], a[72:75]
v_cvt_pk_bf16_f32 v21, v194, v195
v_accvgpr_read_b32 v200, a36
v_mfma_f32_16x16x32_bf16 a[76:79], v[240:243], v[140:143], a[76:79]
v_accvgpr_read_b32 v201, a37
v_accvgpr_read_b32 v202, a38
v_mfma_f32_16x16x32_bf16 a[76:79], v[244:247], v[156:159], a[76:79]
s_waitcnt lgkmcnt(4)
v_accvgpr_read_b32 v203, a39
v_mfma_f32_16x16x32_bf16 a[64:67], v[224:227], v[160:163], a[64:67]
ds_read_b64_tr_b16 v[240:241], v250 offset:36864
ds_read_b64_tr_b16 v[242:243], v250 offset:38912
v_mfma_f32_16x16x32_bf16 a[64:67], v[228:231], v[176:179], a[64:67]
v_cvt_pk_bf16_f32 v52, v200, v201
v_cvt_pk_bf16_f32 v53, v202, v203
v_mfma_f32_16x16x32_bf16 a[68:71], v[224:227], v[164:167], a[68:71]
v_accvgpr_read_b32 v208, a40
v_accvgpr_read_b32 v209, a41
v_mfma_f32_16x16x32_bf16 a[68:71], v[228:231], v[180:183], a[68:71]
v_accvgpr_read_b32 v210, a42
v_accvgpr_read_b32 v211, a43
v_mfma_f32_16x16x32_bf16 a[72:75], v[224:227], v[168:171], a[72:75]
ds_read_b64_tr_b16 v[244:245], v250 offset:53248
ds_read_b64_tr_b16 v[246:247], v250 offset:55296
v_mfma_f32_16x16x32_bf16 a[72:75], v[228:231], v[184:187], a[72:75]
v_cvt_pk_bf16_f32 v84, v208, v209
v_cvt_pk_bf16_f32 v85, v210, v211
v_mfma_f32_16x16x32_bf16 a[76:79], v[224:227], v[172:175], a[76:79]
v_accvgpr_read_b32 v216, a44
v_accvgpr_read_b32 v217, a45
v_mfma_f32_16x16x32_bf16 a[76:79], v[228:231], v[188:191], a[76:79]
s_waitcnt lgkmcnt(4)
v_accvgpr_read_b32 v218, a46
v_mfma_f32_16x16x32_bf16 a[64:67], v[232:235], v[0:3], a[64:67]
ds_read_b64_tr_b16 v[224:225], v13 offset:4096
ds_read_b64_tr_b16 v[226:227], v13 offset:6144
v_mfma_f32_16x16x32_bf16 a[68:71], v[232:235], v[32:35], a[68:71]
v_accvgpr_read_b32 v219, a47
v_cvt_pk_bf16_f32 v116, v216, v217
v_mfma_f32_16x16x32_bf16 a[72:75], v[232:235], v[64:67], a[72:75]
v_cvt_pk_bf16_f32 v117, v218, v219
v_accvgpr_read_b32 v196, a48
v_mfma_f32_16x16x32_bf16 a[76:79], v[232:235], v[96:99], a[76:79]
v_accvgpr_read_b32 v197, a49
v_accvgpr_read_b32 v198, a50
v_mfma_f32_16x16x32_bf16 a[80:83], v[236:239], v[0:3], a[80:83]
ds_read_b64_tr_b16 v[228:229], v13 offset:20480
ds_read_b64_tr_b16 v[230:231], v13 offset:22528
v_mfma_f32_16x16x32_bf16 a[84:87], v[236:239], v[32:35], a[84:87]
v_accvgpr_read_b32 v199, a51
v_cvt_pk_bf16_f32 v22, v196, v197
v_mfma_f32_16x16x32_bf16 a[88:91], v[236:239], v[64:67], a[88:91]
v_cvt_pk_bf16_f32 v23, v198, v199
buffer_store_dwordx4 v[20:23], v252, s[20:23], s40 offen offset:1024 sc1
v_mfma_f32_16x16x32_bf16 a[92:95], v[236:239], v[96:99], a[92:95]
s_waitcnt lgkmcnt(4)
v_accvgpr_read_b32 v204, a52
v_mfma_f32_16x16x32_bf16 a[80:83], v[240:243], v[4:7], a[80:83]
ds_read_b64_tr_b16 v[232:233], v13 offset:36864
ds_read_b64_tr_b16 v[234:235], v13 offset:38912
v_mfma_f32_16x16x32_bf16 a[80:83], v[244:247], v[8:11], a[80:83]
v_accvgpr_read_b32 v205, a53
v_accvgpr_read_b32 v206, a54
v_mfma_f32_16x16x32_bf16 a[84:87], v[240:243], v[36:39], a[84:87]
v_accvgpr_read_b32 v207, a55
v_cvt_pk_bf16_f32 v54, v204, v205
v_mfma_f32_16x16x32_bf16 a[84:87], v[244:247], v[40:43], a[84:87]
v_cvt_pk_bf16_f32 v55, v206, v207
buffer_store_dwordx4 v[52:55], v252, s[20:23], s41 offen offset:1024 sc1
v_mfma_f32_16x16x32_bf16 a[88:91], v[240:243], v[68:71], a[88:91]
ds_read_b64_tr_b16 v[236:237], v13 offset:53248
ds_read_b64_tr_b16 v[238:239], v13 offset:55296
v_mfma_f32_16x16x32_bf16 a[88:91], v[244:247], v[72:75], a[88:91]
v_accvgpr_read_b32 v212, a56
v_accvgpr_read_b32 v213, a57
v_mfma_f32_16x16x32_bf16 a[92:95], v[240:243], v[100:103], a[92:95]
v_accvgpr_read_b32 v214, a58
v_accvgpr_read_b32 v215, a59
v_mfma_f32_16x16x32_bf16 a[92:95], v[244:247], v[104:107], a[92:95]
s_waitcnt lgkmcnt(4)
v_cvt_pk_bf16_f32 v86, v212, v213
v_mfma_f32_16x16x32_bf16 a[80:83], v[224:227], v[128:131], a[80:83]
ds_read_b64_tr_b16 v[240:241], v249 offset:37376
ds_read_b64_tr_b16 v[242:243], v249 offset:39424
v_mfma_f32_16x16x32_bf16 a[80:83], v[228:231], v[144:147], a[80:83]
v_cvt_pk_bf16_f32 v87, v214, v215
buffer_store_dwordx4 v[84:87], v252, s[20:23], s42 offen offset:1024 sc1
v_mfma_f32_16x16x32_bf16 a[84:87], v[224:227], v[132:135], a[84:87]
v_accvgpr_read_b32 v220, a60
v_accvgpr_read_b32 v221, a61
v_mfma_f32_16x16x32_bf16 a[84:87], v[228:231], v[148:151], a[84:87]
v_accvgpr_read_b32 v222, a62
v_accvgpr_read_b32 v223, a63
v_mfma_f32_16x16x32_bf16 a[88:91], v[224:227], v[136:139], a[88:91]
ds_read_b64_tr_b16 v[244:245], v249 offset:53760
ds_read_b64_tr_b16 v[246:247], v249 offset:55808
v_mfma_f32_16x16x32_bf16 a[88:91], v[228:231], v[152:155], a[88:91]
v_cvt_pk_bf16_f32 v118, v220, v221
v_cvt_pk_bf16_f32 v119, v222, v223
v_mfma_f32_16x16x32_bf16 a[92:95], v[224:227], v[140:143], a[92:95]
buffer_store_dwordx4 v[116:119], v252, s[20:23], s43 offen offset:1024 sc1
v_accvgpr_read_b32 v192, a64
v_mfma_f32_16x16x32_bf16 a[92:95], v[228:231], v[156:159], a[92:95]
s_waitcnt lgkmcnt(4)
v_accvgpr_read_b32 v193, a65
v_mfma_f32_16x16x32_bf16 a[80:83], v[232:235], v[160:163], a[80:83]
ds_read_b64_tr_b16 v[224:225], v12 offset:4608
ds_read_b64_tr_b16 v[226:227], v12 offset:6656
v_mfma_f32_16x16x32_bf16 a[80:83], v[236:239], v[176:179], a[80:83]
v_accvgpr_read_b32 v194, a66
v_accvgpr_read_b32 v195, a67
v_mfma_f32_16x16x32_bf16 a[84:87], v[232:235], v[164:167], a[84:87]
v_cvt_pk_bf16_f32 v24, v192, v193
v_cvt_pk_bf16_f32 v25, v194, v195
v_mfma_f32_16x16x32_bf16 a[84:87], v[236:239], v[180:183], a[84:87]
v_accvgpr_read_b32 v200, a68
v_accvgpr_read_b32 v201, a69
v_mfma_f32_16x16x32_bf16 a[88:91], v[232:235], v[168:171], a[88:91]
ds_read_b64_tr_b16 v[228:229], v12 offset:20992
ds_read_b64_tr_b16 v[230:231], v12 offset:23040
v_mfma_f32_16x16x32_bf16 a[88:91], v[236:239], v[184:187], a[88:91]
v_accvgpr_read_b32 v202, a70
v_accvgpr_read_b32 v203, a71
v_mfma_f32_16x16x32_bf16 a[92:95], v[232:235], v[172:175], a[92:95]
v_cvt_pk_bf16_f32 v56, v200, v201
v_cvt_pk_bf16_f32 v57, v202, v203
v_mfma_f32_16x16x32_bf16 a[92:95], v[236:239], v[188:191], a[92:95]
s_waitcnt lgkmcnt(4)
v_accvgpr_read_b32 v208, a72
v_mfma_f32_16x16x32_bf16 a[96:99], v[240:243], v[4:7], a[96:99]
ds_read_b64_tr_b16 v[232:233], v12 offset:37376
ds_read_b64_tr_b16 v[234:235], v12 offset:39424
v_mfma_f32_16x16x32_bf16 a[96:99], v[244:247], v[8:11], a[96:99]
v_accvgpr_read_b32 v209, a73
v_accvgpr_read_b32 v210, a74
v_mfma_f32_16x16x32_bf16 a[100:103], v[240:243], v[36:39], a[100:103]
v_accvgpr_read_b32 v211, a75
v_cvt_pk_bf16_f32 v88, v208, v209
v_mfma_f32_16x16x32_bf16 a[100:103], v[244:247], v[40:43], a[100:103]
v_cvt_pk_bf16_f32 v89, v210, v211
v_accvgpr_read_b32 v216, a76
v_mfma_f32_16x16x32_bf16 a[104:107], v[240:243], v[68:71], a[104:107]
ds_read_b64_tr_b16 v[236:237], v12 offset:53760
ds_read_b64_tr_b16 v[238:239], v12 offset:55808
v_mfma_f32_16x16x32_bf16 a[104:107], v[244:247], v[72:75], a[104:107]
v_accvgpr_read_b32 v217, a77
v_accvgpr_read_b32 v218, a78
v_mfma_f32_16x16x32_bf16 a[108:111], v[240:243], v[100:103], a[108:111]
v_accvgpr_read_b32 v219, a79
v_cvt_pk_bf16_f32 v120, v216, v217
v_mfma_f32_16x16x32_bf16 a[108:111], v[244:247], v[104:107], a[108:111]
s_waitcnt lgkmcnt(4)
v_cvt_pk_bf16_f32 v121, v218, v219
v_mfma_f32_16x16x32_bf16 a[96:99], v[224:227], v[128:131], a[96:99]
ds_read_b64_tr_b16 v[240:241], v249 offset:4608
ds_read_b64_tr_b16 v[242:243], v249 offset:6656
v_mfma_f32_16x16x32_bf16 a[96:99], v[228:231], v[144:147], a[96:99]
v_accvgpr_read_b32 v196, a80
v_accvgpr_read_b32 v197, a81
v_mfma_f32_16x16x32_bf16 a[100:103], v[224:227], v[132:135], a[100:103]
v_accvgpr_read_b32 v198, a82
v_accvgpr_read_b32 v199, a83
v_mfma_f32_16x16x32_bf16 a[100:103], v[228:231], v[148:151], a[100:103]
v_cvt_pk_bf16_f32 v26, v196, v197
v_cvt_pk_bf16_f32 v27, v198, v199
v_mfma_f32_16x16x32_bf16 a[104:107], v[224:227], v[136:139], a[104:107]
ds_read_b64_tr_b16 v[244:245], v250 offset:4608
ds_read_b64_tr_b16 v[246:247], v250 offset:6656
v_mfma_f32_16x16x32_bf16 a[104:107], v[228:231], v[152:155], a[104:107]
buffer_store_dwordx4 v[24:27], v252, s[20:23], s40 offen offset:2048 sc1
v_accvgpr_read_b32 v204, a84
v_mfma_f32_16x16x32_bf16 a[108:111], v[224:227], v[140:143], a[108:111]
v_accvgpr_read_b32 v205, a85
v_accvgpr_read_b32 v206, a86
v_mfma_f32_16x16x32_bf16 a[108:111], v[228:231], v[156:159], a[108:111]
s_waitcnt lgkmcnt(4)
v_accvgpr_read_b32 v207, a87
v_mfma_f32_16x16x32_bf16 a[96:99], v[232:235], v[160:163], a[96:99]
ds_read_b64_tr_b16 v[224:225], v250 offset:37376
ds_read_b64_tr_b16 v[226:227], v250 offset:39424
v_mfma_f32_16x16x32_bf16 a[96:99], v[236:239], v[176:179], a[96:99]
v_cvt_pk_bf16_f32 v58, v204, v205
v_cvt_pk_bf16_f32 v59, v206, v207
v_mfma_f32_16x16x32_bf16 a[100:103], v[232:235], v[164:167], a[100:103]
buffer_store_dwordx4 v[56:59], v252, s[20:23], s41 offen offset:2048 sc1
v_accvgpr_read_b32 v212, a88
v_mfma_f32_16x16x32_bf16 a[100:103], v[236:239], v[180:183], a[100:103]
v_accvgpr_read_b32 v213, a89
v_accvgpr_read_b32 v214, a90
v_mfma_f32_16x16x32_bf16 a[104:107], v[232:235], v[168:171], a[104:107]
ds_read_b64_tr_b16 v[228:229], v250 offset:53760
ds_read_b64_tr_b16 v[230:231], v250 offset:55808
v_mfma_f32_16x16x32_bf16 a[104:107], v[236:239], v[184:187], a[104:107]
v_accvgpr_read_b32 v215, a91
v_cvt_pk_bf16_f32 v90, v212, v213
v_mfma_f32_16x16x32_bf16 a[108:111], v[232:235], v[172:175], a[108:111]
v_cvt_pk_bf16_f32 v91, v214, v215
buffer_store_dwordx4 v[88:91], v252, s[20:23], s42 offen offset:2048 sc1
v_mfma_f32_16x16x32_bf16 a[108:111], v[236:239], v[188:191], a[108:111]
s_waitcnt lgkmcnt(4)
v_accvgpr_read_b32 v220, a92
v_mfma_f32_16x16x32_bf16 a[96:99], v[240:243], v[0:3], a[96:99]
ds_read_b64_tr_b16 v[232:233], v13 offset:4608
ds_read_b64_tr_b16 v[234:235], v13 offset:6656
v_mfma_f32_16x16x32_bf16 a[100:103], v[240:243], v[32:35], a[100:103]
v_accvgpr_read_b32 v221, a93
v_accvgpr_read_b32 v222, a94
v_mfma_f32_16x16x32_bf16 a[104:107], v[240:243], v[64:67], a[104:107]
v_accvgpr_read_b32 v223, a95
v_cvt_pk_bf16_f32 v122, v220, v221
v_mfma_f32_16x16x32_bf16 a[108:111], v[240:243], v[96:99], a[108:111]
v_cvt_pk_bf16_f32 v123, v222, v223
buffer_store_dwordx4 v[120:123], v252, s[20:23], s43 offen offset:2048 sc1
v_mfma_f32_16x16x32_bf16 a[112:115], v[244:247], v[0:3], a[112:115]
ds_read_b64_tr_b16 v[236:237], v13 offset:20992
ds_read_b64_tr_b16 v[238:239], v13 offset:23040
v_mfma_f32_16x16x32_bf16 a[116:119], v[244:247], v[32:35], a[116:119]
v_accvgpr_read_b32 v192, a96
v_accvgpr_read_b32 v193, a97
v_mfma_f32_16x16x32_bf16 a[120:123], v[244:247], v[64:67], a[120:123]
v_accvgpr_read_b32 v194, a98
v_accvgpr_read_b32 v195, a99
v_mfma_f32_16x16x32_bf16 a[124:127], v[244:247], v[96:99], a[124:127]
s_waitcnt lgkmcnt(4)
v_cvt_pk_bf16_f32 v28, v192, v193
v_mfma_f32_16x16x32_bf16 a[112:115], v[224:227], v[4:7], a[112:115]
ds_read_b64_tr_b16 v[240:241], v13 offset:37376
ds_read_b64_tr_b16 v[242:243], v13 offset:39424
v_mfma_f32_16x16x32_bf16 a[112:115], v[228:231], v[8:11], a[112:115]
v_cvt_pk_bf16_f32 v29, v194, v195
v_accvgpr_read_b32 v200, a100
v_mfma_f32_16x16x32_bf16 a[116:119], v[224:227], v[36:39], a[116:119]
v_accvgpr_read_b32 v201, a101
v_accvgpr_read_b32 v202, a102
v_mfma_f32_16x16x32_bf16 a[116:119], v[228:231], v[40:43], a[116:119]
v_accvgpr_read_b32 v203, a103
v_cvt_pk_bf16_f32 v60, v200, v201
v_mfma_f32_16x16x32_bf16 a[120:123], v[224:227], v[68:71], a[120:123]
ds_read_b64_tr_b16 v[244:245], v13 offset:53760
ds_read_b64_tr_b16 v[246:247], v13 offset:55808
v_mfma_f32_16x16x32_bf16 a[120:123], v[228:231], v[72:75], a[120:123]
v_cvt_pk_bf16_f32 v61, v202, v203
v_accvgpr_read_b32 v208, a104
v_mfma_f32_16x16x32_bf16 a[124:127], v[224:227], v[100:103], a[124:127]
v_accvgpr_read_b32 v209, a105
v_accvgpr_read_b32 v210, a106
v_mfma_f32_16x16x32_bf16 a[124:127], v[228:231], v[104:107], a[124:127]
s_waitcnt lgkmcnt(4)
v_accvgpr_read_b32 v211, a107
v_mfma_f32_16x16x32_bf16 a[112:115], v[232:235], v[128:131], a[112:115]
ds_read_b64_tr_b16 v[224:225], v249 offset:40960
ds_read_b64_tr_b16 v[226:227], v249 offset:43008
v_mfma_f32_16x16x32_bf16 a[112:115], v[236:239], v[144:147], a[112:115]
v_cvt_pk_bf16_f32 v92, v208, v209
v_cvt_pk_bf16_f32 v93, v210, v211
v_mfma_f32_16x16x32_bf16 a[116:119], v[232:235], v[132:135], a[116:119]
v_accvgpr_read_b32 v216, a108
v_accvgpr_read_b32 v217, a109
v_mfma_f32_16x16x32_bf16 a[116:119], v[236:239], v[148:151], a[116:119]
v_accvgpr_read_b32 v218, a110
v_accvgpr_read_b32 v219, a111
v_mfma_f32_16x16x32_bf16 a[120:123], v[232:235], v[136:139], a[120:123]
ds_read_b64_tr_b16 v[228:229], v249 offset:57344
ds_read_b64_tr_b16 v[230:231], v249 offset:59392
v_mfma_f32_16x16x32_bf16 a[120:123], v[236:239], v[152:155], a[120:123]
v_cvt_pk_bf16_f32 v124, v216, v217
v_cvt_pk_bf16_f32 v125, v218, v219
v_mfma_f32_16x16x32_bf16 a[124:127], v[232:235], v[140:143], a[124:127]
v_mfma_f32_16x16x32_bf16 a[124:127], v[236:239], v[156:159], a[124:127]
s_waitcnt lgkmcnt(4)
v_mfma_f32_16x16x32_bf16 a[112:115], v[240:243], v[160:163], a[112:115]
ds_read_b64_tr_b16 v[232:233], v12 offset:8192
ds_read_b64_tr_b16 v[234:235], v12 offset:10240
v_mfma_f32_16x16x32_bf16 a[112:115], v[244:247], v[176:179], a[112:115]
v_mfma_f32_16x16x32_bf16 a[116:119], v[240:243], v[164:167], a[116:119]
v_mfma_f32_16x16x32_bf16 a[116:119], v[244:247], v[180:183], a[116:119]
v_mfma_f32_16x16x32_bf16 a[120:123], v[240:243], v[168:171], a[120:123]
ds_read_b64_tr_b16 v[236:237], v12 offset:24576
ds_read_b64_tr_b16 v[238:239], v12 offset:26624
v_mfma_f32_16x16x32_bf16 a[120:123], v[244:247], v[184:187], a[120:123]
v_mfma_f32_16x16x32_bf16 a[124:127], v[240:243], v[172:175], a[124:127]
s_nop 0
v_accvgpr_read_b32 v196, a112
v_accvgpr_read_b32 v197, a113
v_mfma_f32_16x16x32_bf16 a[124:127], v[244:247], v[188:191], a[124:127]
s_waitcnt lgkmcnt(4)
v_accvgpr_read_b32 v198, a114
v_mfma_f32_16x16x32_bf16 a[128:131], v[224:227], v[4:7], a[128:131]
ds_read_b64_tr_b16 v[240:241], v12 offset:40960
ds_read_b64_tr_b16 v[242:243], v12 offset:43008
v_mfma_f32_16x16x32_bf16 a[128:131], v[228:231], v[8:11], a[128:131]
v_accvgpr_read_b32 v199, a115
v_cvt_pk_bf16_f32 v30, v196, v197
v_mfma_f32_16x16x32_bf16 a[132:135], v[224:227], v[36:39], a[132:135]
v_cvt_pk_bf16_f32 v31, v198, v199
buffer_store_dwordx4 v[28:31], v252, s[20:23], s40 offen offset:3072 sc1
v_mfma_f32_16x16x32_bf16 a[132:135], v[228:231], v[40:43], a[132:135]
v_accvgpr_read_b32 v204, a116
v_accvgpr_read_b32 v205, a117
v_mfma_f32_16x16x32_bf16 a[136:139], v[224:227], v[68:71], a[136:139]
ds_read_b64_tr_b16 v[244:245], v12 offset:57344
ds_read_b64_tr_b16 v[246:247], v12 offset:59392
v_mfma_f32_16x16x32_bf16 a[136:139], v[228:231], v[72:75], a[136:139]
v_accvgpr_read_b32 v206, a118
v_accvgpr_read_b32 v207, a119
v_mfma_f32_16x16x32_bf16 a[140:143], v[224:227], v[100:103], a[140:143]
v_cvt_pk_bf16_f32 v62, v204, v205
v_cvt_pk_bf16_f32 v63, v206, v207
v_mfma_f32_16x16x32_bf16 a[140:143], v[228:231], v[104:107], a[140:143]
s_waitcnt lgkmcnt(4)
buffer_store_dwordx4 v[60:63], v252, s[20:23], s41 offen offset:3072 sc1
v_mfma_f32_16x16x32_bf16 a[128:131], v[232:235], v[128:131], a[128:131]
ds_read_b64_tr_b16 v[224:225], v249 offset:8192
ds_read_b64_tr_b16 v[226:227], v249 offset:10240
v_mfma_f32_16x16x32_bf16 a[128:131], v[236:239], v[144:147], a[128:131]
v_accvgpr_read_b32 v212, a120
v_accvgpr_read_b32 v213, a121
v_mfma_f32_16x16x32_bf16 a[132:135], v[232:235], v[132:135], a[132:135]
v_accvgpr_read_b32 v214, a122
v_accvgpr_read_b32 v215, a123
v_mfma_f32_16x16x32_bf16 a[132:135], v[236:239], v[148:151], a[132:135]
v_cvt_pk_bf16_f32 v94, v212, v213
v_cvt_pk_bf16_f32 v95, v214, v215
v_mfma_f32_16x16x32_bf16 a[136:139], v[232:235], v[136:139], a[136:139]
ds_read_b64_tr_b16 v[228:229], v250 offset:8192
ds_read_b64_tr_b16 v[230:231], v250 offset:10240
v_mfma_f32_16x16x32_bf16 a[136:139], v[236:239], v[152:155], a[136:139]
buffer_store_dwordx4 v[92:95], v252, s[20:23], s42 offen offset:3072 sc1
v_accvgpr_read_b32 v220, a124
v_mfma_f32_16x16x32_bf16 a[140:143], v[232:235], v[140:143], a[140:143]
v_accvgpr_read_b32 v221, a125
v_accvgpr_read_b32 v222, a126
v_mfma_f32_16x16x32_bf16 a[140:143], v[236:239], v[156:159], a[140:143]
s_waitcnt lgkmcnt(4)
v_accvgpr_read_b32 v223, a127
v_mfma_f32_16x16x32_bf16 a[128:131], v[240:243], v[160:163], a[128:131]
ds_read_b64_tr_b16 v[232:233], v250 offset:40960
ds_read_b64_tr_b16 v[234:235], v250 offset:43008
v_mfma_f32_16x16x32_bf16 a[128:131], v[244:247], v[176:179], a[128:131]
v_cvt_pk_bf16_f32 v126, v220, v221
v_cvt_pk_bf16_f32 v127, v222, v223
v_mfma_f32_16x16x32_bf16 a[132:135], v[240:243], v[164:167], a[132:135]
buffer_store_dwordx4 v[124:127], v252, s[20:23], s43 offen offset:3072 sc1
v_mfma_f32_16x16x32_bf16 a[132:135], v[244:247], v[180:183], a[132:135]
v_mfma_f32_16x16x32_bf16 a[136:139], v[240:243], v[168:171], a[136:139]
ds_read_b64_tr_b16 v[236:237], v250 offset:57344
ds_read_b64_tr_b16 v[238:239], v250 offset:59392
v_mfma_f32_16x16x32_bf16 a[136:139], v[244:247], v[184:187], a[136:139]
v_mfma_f32_16x16x32_bf16 a[140:143], v[240:243], v[172:175], a[140:143]
v_mfma_f32_16x16x32_bf16 a[140:143], v[244:247], v[188:191], a[140:143]
s_waitcnt lgkmcnt(4)
v_mfma_f32_16x16x32_bf16 a[128:131], v[224:227], v[0:3], a[128:131]
ds_read_b64_tr_b16 v[240:241], v13 offset:8192
ds_read_b64_tr_b16 v[242:243], v13 offset:10240
v_mfma_f32_16x16x32_bf16 a[132:135], v[224:227], v[32:35], a[132:135]
v_mfma_f32_16x16x32_bf16 a[136:139], v[224:227], v[64:67], a[136:139]
v_mfma_f32_16x16x32_bf16 a[140:143], v[224:227], v[96:99], a[140:143]
v_mfma_f32_16x16x32_bf16 a[144:147], v[228:231], v[0:3], a[144:147]
ds_read_b64_tr_b16 v[244:245], v13 offset:24576
ds_read_b64_tr_b16 v[246:247], v13 offset:26624
v_mfma_f32_16x16x32_bf16 a[148:151], v[228:231], v[32:35], a[148:151]
v_accvgpr_read_b32 v192, a128
v_accvgpr_read_b32 v193, a129
v_mfma_f32_16x16x32_bf16 a[152:155], v[228:231], v[64:67], a[152:155]
v_accvgpr_read_b32 v194, a130
v_accvgpr_read_b32 v195, a131
v_mfma_f32_16x16x32_bf16 a[156:159], v[228:231], v[96:99], a[156:159]
s_waitcnt lgkmcnt(4)
v_cvt_pk_bf16_f32 v16, v192, v193
v_mfma_f32_16x16x32_bf16 a[144:147], v[232:235], v[4:7], a[144:147]
ds_read_b64_tr_b16 v[224:225], v13 offset:40960
ds_read_b64_tr_b16 v[226:227], v13 offset:43008
v_mfma_f32_16x16x32_bf16 a[144:147], v[236:239], v[8:11], a[144:147]
v_cvt_pk_bf16_f32 v17, v194, v195
v_accvgpr_read_b32 v200, a132
v_mfma_f32_16x16x32_bf16 a[148:151], v[232:235], v[36:39], a[148:151]
v_accvgpr_read_b32 v201, a133
v_accvgpr_read_b32 v202, a134
v_mfma_f32_16x16x32_bf16 a[148:151], v[236:239], v[40:43], a[148:151]
v_accvgpr_read_b32 v203, a135
v_cvt_pk_bf16_f32 v48, v200, v201
v_mfma_f32_16x16x32_bf16 a[152:155], v[232:235], v[68:71], a[152:155]
ds_read_b64_tr_b16 v[228:229], v13 offset:57344
ds_read_b64_tr_b16 v[230:231], v13 offset:59392
v_mfma_f32_16x16x32_bf16 a[152:155], v[236:239], v[72:75], a[152:155]
v_cvt_pk_bf16_f32 v49, v202, v203
v_accvgpr_read_b32 v208, a136
v_mfma_f32_16x16x32_bf16 a[156:159], v[232:235], v[100:103], a[156:159]
v_accvgpr_read_b32 v209, a137
v_accvgpr_read_b32 v210, a138
v_mfma_f32_16x16x32_bf16 a[156:159], v[236:239], v[104:107], a[156:159]
s_waitcnt lgkmcnt(4)
v_accvgpr_read_b32 v211, a139
v_mfma_f32_16x16x32_bf16 a[144:147], v[240:243], v[128:131], a[144:147]
ds_read_b64_tr_b16 v[232:233], v249 offset:41472
ds_read_b64_tr_b16 v[234:235], v249 offset:43520
v_mfma_f32_16x16x32_bf16 a[144:147], v[244:247], v[144:147], a[144:147]
v_cvt_pk_bf16_f32 v80, v208, v209
v_cvt_pk_bf16_f32 v81, v210, v211
v_mfma_f32_16x16x32_bf16 a[148:151], v[240:243], v[132:135], a[148:151]
v_accvgpr_read_b32 v216, a140
v_accvgpr_read_b32 v217, a141
v_mfma_f32_16x16x32_bf16 a[148:151], v[244:247], v[148:151], a[148:151]
v_accvgpr_read_b32 v218, a142
v_accvgpr_read_b32 v219, a143
v_mfma_f32_16x16x32_bf16 a[152:155], v[240:243], v[136:139], a[152:155]
ds_read_b64_tr_b16 v[236:237], v249 offset:57856
ds_read_b64_tr_b16 v[238:239], v249 offset:59904
v_mfma_f32_16x16x32_bf16 a[152:155], v[244:247], v[152:155], a[152:155]
v_cvt_pk_bf16_f32 v112, v216, v217
v_cvt_pk_bf16_f32 v113, v218, v219
v_mfma_f32_16x16x32_bf16 a[156:159], v[240:243], v[140:143], a[156:159]
v_mfma_f32_16x16x32_bf16 a[156:159], v[244:247], v[156:159], a[156:159]
s_waitcnt lgkmcnt(4)
v_mfma_f32_16x16x32_bf16 a[144:147], v[224:227], v[160:163], a[144:147]
ds_read_b64_tr_b16 v[240:241], v12 offset:8704
ds_read_b64_tr_b16 v[242:243], v12 offset:10752
v_mfma_f32_16x16x32_bf16 a[144:147], v[228:231], v[176:179], a[144:147]
v_mfma_f32_16x16x32_bf16 a[148:151], v[224:227], v[164:167], a[148:151]
v_mfma_f32_16x16x32_bf16 a[148:151], v[228:231], v[180:183], a[148:151]
v_mfma_f32_16x16x32_bf16 a[152:155], v[224:227], v[168:171], a[152:155]
ds_read_b64_tr_b16 v[244:245], v12 offset:25088
ds_read_b64_tr_b16 v[246:247], v12 offset:27136
v_mfma_f32_16x16x32_bf16 a[152:155], v[228:231], v[184:187], a[152:155]
v_mfma_f32_16x16x32_bf16 a[156:159], v[224:227], v[172:175], a[156:159]
s_nop 0
v_accvgpr_read_b32 v196, a144
v_accvgpr_read_b32 v197, a145
v_mfma_f32_16x16x32_bf16 a[156:159], v[228:231], v[188:191], a[156:159]
s_waitcnt lgkmcnt(4)
v_accvgpr_read_b32 v198, a146
v_mfma_f32_16x16x32_bf16 a[160:163], v[232:235], v[4:7], a[160:163]
ds_read_b64_tr_b16 v[224:225], v12 offset:41472
ds_read_b64_tr_b16 v[226:227], v12 offset:43520
v_mfma_f32_16x16x32_bf16 a[160:163], v[236:239], v[8:11], a[160:163]
v_accvgpr_read_b32 v199, a147
v_cvt_pk_bf16_f32 v18, v196, v197
v_mfma_f32_16x16x32_bf16 a[164:167], v[232:235], v[36:39], a[164:167]
v_cvt_pk_bf16_f32 v19, v198, v199
buffer_store_dwordx4 v[16:19], v252, s[20:23], s44 offen offset:0 sc1
v_mfma_f32_16x16x32_bf16 a[164:167], v[236:239], v[40:43], a[164:167]
v_accvgpr_read_b32 v204, a148
v_accvgpr_read_b32 v205, a149
v_mfma_f32_16x16x32_bf16 a[168:171], v[232:235], v[68:71], a[168:171]
ds_read_b64_tr_b16 v[228:229], v12 offset:57856
ds_read_b64_tr_b16 v[230:231], v12 offset:59904
v_mfma_f32_16x16x32_bf16 a[168:171], v[236:239], v[72:75], a[168:171]
v_accvgpr_read_b32 v206, a150
v_accvgpr_read_b32 v207, a151
v_mfma_f32_16x16x32_bf16 a[172:175], v[232:235], v[100:103], a[172:175]
v_cvt_pk_bf16_f32 v50, v204, v205
v_cvt_pk_bf16_f32 v51, v206, v207
v_mfma_f32_16x16x32_bf16 a[172:175], v[236:239], v[104:107], a[172:175]
s_waitcnt lgkmcnt(4)
buffer_store_dwordx4 v[48:51], v252, s[20:23], s45 offen offset:0 sc1
v_mfma_f32_16x16x32_bf16 a[160:163], v[240:243], v[128:131], a[160:163]
ds_read_b64_tr_b16 v[232:233], v249 offset:8704
ds_read_b64_tr_b16 v[234:235], v249 offset:10752
v_mfma_f32_16x16x32_bf16 a[160:163], v[244:247], v[144:147], a[160:163]
v_accvgpr_read_b32 v212, a152
v_accvgpr_read_b32 v213, a153
v_mfma_f32_16x16x32_bf16 a[164:167], v[240:243], v[132:135], a[164:167]
v_accvgpr_read_b32 v214, a154
v_accvgpr_read_b32 v215, a155
v_mfma_f32_16x16x32_bf16 a[164:167], v[244:247], v[148:151], a[164:167]
v_cvt_pk_bf16_f32 v82, v212, v213
v_cvt_pk_bf16_f32 v83, v214, v215
v_mfma_f32_16x16x32_bf16 a[168:171], v[240:243], v[136:139], a[168:171]
ds_read_b64_tr_b16 v[236:237], v250 offset:8704
ds_read_b64_tr_b16 v[238:239], v250 offset:10752
v_mfma_f32_16x16x32_bf16 a[168:171], v[244:247], v[152:155], a[168:171]
buffer_store_dwordx4 v[80:83], v252, s[20:23], s46 offen offset:0 sc1
v_accvgpr_read_b32 v220, a156
v_mfma_f32_16x16x32_bf16 a[172:175], v[240:243], v[140:143], a[172:175]
v_accvgpr_read_b32 v221, a157
v_accvgpr_read_b32 v222, a158
v_mfma_f32_16x16x32_bf16 a[172:175], v[244:247], v[156:159], a[172:175]
s_waitcnt lgkmcnt(4)
v_accvgpr_read_b32 v223, a159
v_mfma_f32_16x16x32_bf16 a[160:163], v[224:227], v[160:163], a[160:163]
ds_read_b64_tr_b16 v[240:241], v250 offset:41472
ds_read_b64_tr_b16 v[242:243], v250 offset:43520
v_mfma_f32_16x16x32_bf16 a[160:163], v[228:231], v[176:179], a[160:163]
v_cvt_pk_bf16_f32 v114, v220, v221
v_cvt_pk_bf16_f32 v115, v222, v223
v_mfma_f32_16x16x32_bf16 a[164:167], v[224:227], v[164:167], a[164:167]
buffer_store_dwordx4 v[112:115], v252, s[20:23], s47 offen offset:0 sc1
v_mfma_f32_16x16x32_bf16 a[164:167], v[228:231], v[180:183], a[164:167]
v_mfma_f32_16x16x32_bf16 a[168:171], v[224:227], v[168:171], a[168:171]
ds_read_b64_tr_b16 v[244:245], v250 offset:57856
ds_read_b64_tr_b16 v[246:247], v250 offset:59904
v_mfma_f32_16x16x32_bf16 a[168:171], v[228:231], v[184:187], a[168:171]
v_mfma_f32_16x16x32_bf16 a[172:175], v[224:227], v[172:175], a[172:175]
v_mfma_f32_16x16x32_bf16 a[172:175], v[228:231], v[188:191], a[172:175]
s_waitcnt lgkmcnt(4)
v_mfma_f32_16x16x32_bf16 a[160:163], v[232:235], v[0:3], a[160:163]
ds_read_b64_tr_b16 v[224:225], v13 offset:8704
ds_read_b64_tr_b16 v[226:227], v13 offset:10752
v_mfma_f32_16x16x32_bf16 a[164:167], v[232:235], v[32:35], a[164:167]
v_mfma_f32_16x16x32_bf16 a[168:171], v[232:235], v[64:67], a[168:171]
v_mfma_f32_16x16x32_bf16 a[172:175], v[232:235], v[96:99], a[172:175]
v_mfma_f32_16x16x32_bf16 a[176:179], v[236:239], v[0:3], a[176:179]
ds_read_b64_tr_b16 v[228:229], v13 offset:25088
ds_read_b64_tr_b16 v[230:231], v13 offset:27136
v_mfma_f32_16x16x32_bf16 a[180:183], v[236:239], v[32:35], a[180:183]
v_accvgpr_read_b32 v192, a160
v_accvgpr_read_b32 v193, a161
v_mfma_f32_16x16x32_bf16 a[184:187], v[236:239], v[64:67], a[184:187]
v_accvgpr_read_b32 v194, a162
v_accvgpr_read_b32 v195, a163
v_mfma_f32_16x16x32_bf16 a[188:191], v[236:239], v[96:99], a[188:191]
s_waitcnt lgkmcnt(4)
v_cvt_pk_bf16_f32 v20, v192, v193
v_mfma_f32_16x16x32_bf16 a[176:179], v[240:243], v[4:7], a[176:179]
ds_read_b64_tr_b16 v[232:233], v13 offset:41472
ds_read_b64_tr_b16 v[234:235], v13 offset:43520
v_mfma_f32_16x16x32_bf16 a[176:179], v[244:247], v[8:11], a[176:179]
v_cvt_pk_bf16_f32 v21, v194, v195
v_accvgpr_read_b32 v200, a164
v_mfma_f32_16x16x32_bf16 a[180:183], v[240:243], v[36:39], a[180:183]
v_accvgpr_read_b32 v201, a165
v_accvgpr_read_b32 v202, a166
v_mfma_f32_16x16x32_bf16 a[180:183], v[244:247], v[40:43], a[180:183]
v_accvgpr_read_b32 v203, a167
v_cvt_pk_bf16_f32 v52, v200, v201
v_mfma_f32_16x16x32_bf16 a[184:187], v[240:243], v[68:71], a[184:187]
ds_read_b64_tr_b16 v[236:237], v13 offset:57856
ds_read_b64_tr_b16 v[238:239], v13 offset:59904
v_mfma_f32_16x16x32_bf16 a[184:187], v[244:247], v[72:75], a[184:187]
v_cvt_pk_bf16_f32 v53, v202, v203
v_accvgpr_read_b32 v208, a168
v_mfma_f32_16x16x32_bf16 a[188:191], v[240:243], v[100:103], a[188:191]
v_accvgpr_read_b32 v209, a169
v_accvgpr_read_b32 v210, a170
v_mfma_f32_16x16x32_bf16 a[188:191], v[244:247], v[104:107], a[188:191]
s_waitcnt lgkmcnt(4)
v_accvgpr_read_b32 v211, a171
v_mfma_f32_16x16x32_bf16 a[176:179], v[224:227], v[128:131], a[176:179]
ds_read_b64_tr_b16 v[240:241], v249 offset:45056
ds_read_b64_tr_b16 v[242:243], v249 offset:47104
v_mfma_f32_16x16x32_bf16 a[176:179], v[228:231], v[144:147], a[176:179]
v_cvt_pk_bf16_f32 v84, v208, v209
v_cvt_pk_bf16_f32 v85, v210, v211
v_mfma_f32_16x16x32_bf16 a[180:183], v[224:227], v[132:135], a[180:183]
v_accvgpr_read_b32 v216, a172
v_accvgpr_read_b32 v217, a173
v_mfma_f32_16x16x32_bf16 a[180:183], v[228:231], v[148:151], a[180:183]
v_accvgpr_read_b32 v218, a174
v_accvgpr_read_b32 v219, a175
v_mfma_f32_16x16x32_bf16 a[184:187], v[224:227], v[136:139], a[184:187]
ds_read_b64_tr_b16 v[244:245], v249 offset:61440
ds_read_b64_tr_b16 v[246:247], v249 offset:63488
v_mfma_f32_16x16x32_bf16 a[184:187], v[228:231], v[152:155], a[184:187]
v_cvt_pk_bf16_f32 v116, v216, v217
v_cvt_pk_bf16_f32 v117, v218, v219
v_mfma_f32_16x16x32_bf16 a[188:191], v[224:227], v[140:143], a[188:191]
v_mfma_f32_16x16x32_bf16 a[188:191], v[228:231], v[156:159], a[188:191]
s_waitcnt lgkmcnt(4)
v_mfma_f32_16x16x32_bf16 a[176:179], v[232:235], v[160:163], a[176:179]
ds_read_b64_tr_b16 v[224:225], v12 offset:12288
ds_read_b64_tr_b16 v[226:227], v12 offset:14336
v_mfma_f32_16x16x32_bf16 a[176:179], v[236:239], v[176:179], a[176:179]
v_mfma_f32_16x16x32_bf16 a[180:183], v[232:235], v[164:167], a[180:183]
v_mfma_f32_16x16x32_bf16 a[180:183], v[236:239], v[180:183], a[180:183]
v_mfma_f32_16x16x32_bf16 a[184:187], v[232:235], v[168:171], a[184:187]
ds_read_b64_tr_b16 v[228:229], v12 offset:28672
ds_read_b64_tr_b16 v[230:231], v12 offset:30720
v_mfma_f32_16x16x32_bf16 a[184:187], v[236:239], v[184:187], a[184:187]
v_mfma_f32_16x16x32_bf16 a[188:191], v[232:235], v[172:175], a[188:191]
s_nop 0
v_accvgpr_read_b32 v196, a176
v_accvgpr_read_b32 v197, a177
v_mfma_f32_16x16x32_bf16 a[188:191], v[236:239], v[188:191], a[188:191]
s_waitcnt lgkmcnt(4)
v_accvgpr_read_b32 v198, a178
v_mfma_f32_16x16x32_bf16 a[192:195], v[240:243], v[4:7], a[192:195]
ds_read_b64_tr_b16 v[232:233], v12 offset:45056
ds_read_b64_tr_b16 v[234:235], v12 offset:47104
v_mfma_f32_16x16x32_bf16 a[192:195], v[244:247], v[8:11], a[192:195]
v_accvgpr_read_b32 v199, a179
v_cvt_pk_bf16_f32 v22, v196, v197
v_mfma_f32_16x16x32_bf16 a[196:199], v[240:243], v[36:39], a[196:199]
v_cvt_pk_bf16_f32 v23, v198, v199
buffer_store_dwordx4 v[20:23], v252, s[20:23], s44 offen offset:1024 sc1
v_mfma_f32_16x16x32_bf16 a[196:199], v[244:247], v[40:43], a[196:199]
v_accvgpr_read_b32 v204, a180
v_accvgpr_read_b32 v205, a181
v_mfma_f32_16x16x32_bf16 a[200:203], v[240:243], v[68:71], a[200:203]
ds_read_b64_tr_b16 v[236:237], v12 offset:61440
ds_read_b64_tr_b16 v[238:239], v12 offset:63488
v_mfma_f32_16x16x32_bf16 a[200:203], v[244:247], v[72:75], a[200:203]
v_accvgpr_read_b32 v206, a182
v_accvgpr_read_b32 v207, a183
v_mfma_f32_16x16x32_bf16 a[204:207], v[240:243], v[100:103], a[204:207]
v_cvt_pk_bf16_f32 v54, v204, v205
v_cvt_pk_bf16_f32 v55, v206, v207
v_mfma_f32_16x16x32_bf16 a[204:207], v[244:247], v[104:107], a[204:207]
s_waitcnt lgkmcnt(4)
buffer_store_dwordx4 v[52:55], v252, s[20:23], s45 offen offset:1024 sc1
v_mfma_f32_16x16x32_bf16 a[192:195], v[224:227], v[128:131], a[192:195]
ds_read_b64_tr_b16 v[240:241], v249 offset:12288
ds_read_b64_tr_b16 v[242:243], v249 offset:14336
v_mfma_f32_16x16x32_bf16 a[192:195], v[228:231], v[144:147], a[192:195]
v_accvgpr_read_b32 v212, a184
v_accvgpr_read_b32 v213, a185
v_mfma_f32_16x16x32_bf16 a[196:199], v[224:227], v[132:135], a[196:199]
v_accvgpr_read_b32 v214, a186
v_accvgpr_read_b32 v215, a187
v_mfma_f32_16x16x32_bf16 a[196:199], v[228:231], v[148:151], a[196:199]
v_cvt_pk_bf16_f32 v86, v212, v213
v_cvt_pk_bf16_f32 v87, v214, v215
v_mfma_f32_16x16x32_bf16 a[200:203], v[224:227], v[136:139], a[200:203]
ds_read_b64_tr_b16 v[244:245], v250 offset:12288
ds_read_b64_tr_b16 v[246:247], v250 offset:14336
v_mfma_f32_16x16x32_bf16 a[200:203], v[228:231], v[152:155], a[200:203]
buffer_store_dwordx4 v[84:87], v252, s[20:23], s46 offen offset:1024 sc1
v_accvgpr_read_b32 v220, a188
v_mfma_f32_16x16x32_bf16 a[204:207], v[224:227], v[140:143], a[204:207]
v_accvgpr_read_b32 v221, a189
v_accvgpr_read_b32 v222, a190
v_mfma_f32_16x16x32_bf16 a[204:207], v[228:231], v[156:159], a[204:207]
s_waitcnt lgkmcnt(4)
v_accvgpr_read_b32 v223, a191
v_mfma_f32_16x16x32_bf16 a[192:195], v[232:235], v[160:163], a[192:195]
ds_read_b64_tr_b16 v[224:225], v250 offset:45056
ds_read_b64_tr_b16 v[226:227], v250 offset:47104
v_mfma_f32_16x16x32_bf16 a[192:195], v[236:239], v[176:179], a[192:195]
v_cvt_pk_bf16_f32 v118, v220, v221
v_cvt_pk_bf16_f32 v119, v222, v223
v_mfma_f32_16x16x32_bf16 a[196:199], v[232:235], v[164:167], a[196:199]
buffer_store_dwordx4 v[116:119], v252, s[20:23], s47 offen offset:1024 sc1
v_mfma_f32_16x16x32_bf16 a[196:199], v[236:239], v[180:183], a[196:199]
v_mfma_f32_16x16x32_bf16 a[200:203], v[232:235], v[168:171], a[200:203]
ds_read_b64_tr_b16 v[228:229], v250 offset:61440
ds_read_b64_tr_b16 v[230:231], v250 offset:63488
v_mfma_f32_16x16x32_bf16 a[200:203], v[236:239], v[184:187], a[200:203]
v_mfma_f32_16x16x32_bf16 a[204:207], v[232:235], v[172:175], a[204:207]
v_mfma_f32_16x16x32_bf16 a[204:207], v[236:239], v[188:191], a[204:207]
s_waitcnt lgkmcnt(4)
v_mfma_f32_16x16x32_bf16 a[192:195], v[240:243], v[0:3], a[192:195]
ds_read_b64_tr_b16 v[232:233], v13 offset:12288
ds_read_b64_tr_b16 v[234:235], v13 offset:14336
v_mfma_f32_16x16x32_bf16 a[196:199], v[240:243], v[32:35], a[196:199]
v_mfma_f32_16x16x32_bf16 a[200:203], v[240:243], v[64:67], a[200:203]
v_mfma_f32_16x16x32_bf16 a[204:207], v[240:243], v[96:99], a[204:207]
v_mfma_f32_16x16x32_bf16 a[208:211], v[244:247], v[0:3], a[208:211]
ds_read_b64_tr_b16 v[236:237], v13 offset:28672
ds_read_b64_tr_b16 v[238:239], v13 offset:30720
v_mfma_f32_16x16x32_bf16 a[212:215], v[244:247], v[32:35], a[212:215]
v_accvgpr_read_b32 v192, a192
v_accvgpr_read_b32 v193, a193
v_mfma_f32_16x16x32_bf16 a[216:219], v[244:247], v[64:67], a[216:219]
v_accvgpr_read_b32 v194, a194
v_accvgpr_read_b32 v195, a195
v_mfma_f32_16x16x32_bf16 a[220:223], v[244:247], v[96:99], a[220:223]
s_waitcnt lgkmcnt(4)
v_cvt_pk_bf16_f32 v24, v192, v193
v_mfma_f32_16x16x32_bf16 a[208:211], v[224:227], v[4:7], a[208:211]
ds_read_b64_tr_b16 v[240:241], v13 offset:45056
ds_read_b64_tr_b16 v[242:243], v13 offset:47104
v_mfma_f32_16x16x32_bf16 a[208:211], v[228:231], v[8:11], a[208:211]
v_cvt_pk_bf16_f32 v25, v194, v195
v_accvgpr_read_b32 v200, a196
v_mfma_f32_16x16x32_bf16 a[212:215], v[224:227], v[36:39], a[212:215]
v_accvgpr_read_b32 v201, a197
v_accvgpr_read_b32 v202, a198
v_mfma_f32_16x16x32_bf16 a[212:215], v[228:231], v[40:43], a[212:215]
v_accvgpr_read_b32 v203, a199
v_cvt_pk_bf16_f32 v56, v200, v201
v_mfma_f32_16x16x32_bf16 a[216:219], v[224:227], v[68:71], a[216:219]
ds_read_b64_tr_b16 v[244:245], v13 offset:61440
ds_read_b64_tr_b16 v[246:247], v13 offset:63488
v_mfma_f32_16x16x32_bf16 a[216:219], v[228:231], v[72:75], a[216:219]
v_cvt_pk_bf16_f32 v57, v202, v203
v_accvgpr_read_b32 v208, a200
v_mfma_f32_16x16x32_bf16 a[220:223], v[224:227], v[100:103], a[220:223]
v_accvgpr_read_b32 v209, a201
v_accvgpr_read_b32 v210, a202
v_mfma_f32_16x16x32_bf16 a[220:223], v[228:231], v[104:107], a[220:223]
s_waitcnt lgkmcnt(4)
v_accvgpr_read_b32 v211, a203
v_mfma_f32_16x16x32_bf16 a[208:211], v[232:235], v[128:131], a[208:211]
ds_read_b64_tr_b16 v[224:225], v249 offset:45568
ds_read_b64_tr_b16 v[226:227], v249 offset:47616
v_mfma_f32_16x16x32_bf16 a[208:211], v[236:239], v[144:147], a[208:211]
v_cvt_pk_bf16_f32 v88, v208, v209
v_cvt_pk_bf16_f32 v89, v210, v211
v_mfma_f32_16x16x32_bf16 a[212:215], v[232:235], v[132:135], a[212:215]
v_accvgpr_read_b32 v216, a204
v_accvgpr_read_b32 v217, a205
v_mfma_f32_16x16x32_bf16 a[212:215], v[236:239], v[148:151], a[212:215]
v_accvgpr_read_b32 v218, a206
v_accvgpr_read_b32 v219, a207
v_mfma_f32_16x16x32_bf16 a[216:219], v[232:235], v[136:139], a[216:219]
ds_read_b64_tr_b16 v[228:229], v249 offset:61952
ds_read_b64_tr_b16 v[230:231], v249 offset:64000
v_mfma_f32_16x16x32_bf16 a[216:219], v[236:239], v[152:155], a[216:219]
v_cvt_pk_bf16_f32 v120, v216, v217
v_cvt_pk_bf16_f32 v121, v218, v219
v_mfma_f32_16x16x32_bf16 a[220:223], v[232:235], v[140:143], a[220:223]
v_mfma_f32_16x16x32_bf16 a[220:223], v[236:239], v[156:159], a[220:223]
s_waitcnt lgkmcnt(4)
v_mfma_f32_16x16x32_bf16 a[208:211], v[240:243], v[160:163], a[208:211]
ds_read_b64_tr_b16 v[232:233], v12 offset:12800
ds_read_b64_tr_b16 v[234:235], v12 offset:14848
v_mfma_f32_16x16x32_bf16 a[208:211], v[244:247], v[176:179], a[208:211]
v_mfma_f32_16x16x32_bf16 a[212:215], v[240:243], v[164:167], a[212:215]
v_mfma_f32_16x16x32_bf16 a[212:215], v[244:247], v[180:183], a[212:215]
v_mfma_f32_16x16x32_bf16 a[216:219], v[240:243], v[168:171], a[216:219]
ds_read_b64_tr_b16 v[236:237], v12 offset:29184
ds_read_b64_tr_b16 v[238:239], v12 offset:31232
v_mfma_f32_16x16x32_bf16 a[216:219], v[244:247], v[184:187], a[216:219]
v_mfma_f32_16x16x32_bf16 a[220:223], v[240:243], v[172:175], a[220:223]
s_nop 0
v_accvgpr_read_b32 v196, a208
v_accvgpr_read_b32 v197, a209
v_mfma_f32_16x16x32_bf16 a[220:223], v[244:247], v[188:191], a[220:223]
s_waitcnt lgkmcnt(4)
v_accvgpr_read_b32 v198, a210
v_mfma_f32_16x16x32_bf16 a[224:227], v[224:227], v[4:7], a[224:227]
ds_read_b64_tr_b16 v[240:241], v12 offset:45568
ds_read_b64_tr_b16 v[242:243], v12 offset:47616
v_mfma_f32_16x16x32_bf16 a[224:227], v[228:231], v[8:11], a[224:227]
v_accvgpr_read_b32 v199, a211
v_cvt_pk_bf16_f32 v26, v196, v197
v_mfma_f32_16x16x32_bf16 a[228:231], v[224:227], v[36:39], a[228:231]
v_cvt_pk_bf16_f32 v27, v198, v199
buffer_store_dwordx4 v[24:27], v252, s[20:23], s44 offen offset:2048 sc1
v_mfma_f32_16x16x32_bf16 a[228:231], v[228:231], v[40:43], a[228:231]
v_accvgpr_read_b32 v204, a212
v_accvgpr_read_b32 v205, a213
v_mfma_f32_16x16x32_bf16 a[232:235], v[224:227], v[68:71], a[232:235]
ds_read_b64_tr_b16 v[244:245], v12 offset:61952
ds_read_b64_tr_b16 v[246:247], v12 offset:64000
v_mfma_f32_16x16x32_bf16 a[232:235], v[228:231], v[72:75], a[232:235]
v_accvgpr_read_b32 v206, a214
v_accvgpr_read_b32 v207, a215
v_mfma_f32_16x16x32_bf16 a[236:239], v[224:227], v[100:103], a[236:239]
v_cvt_pk_bf16_f32 v58, v204, v205
v_cvt_pk_bf16_f32 v59, v206, v207
v_mfma_f32_16x16x32_bf16 a[236:239], v[228:231], v[104:107], a[236:239]
s_waitcnt lgkmcnt(4)
buffer_store_dwordx4 v[56:59], v252, s[20:23], s45 offen offset:2048 sc1
v_mfma_f32_16x16x32_bf16 a[224:227], v[232:235], v[128:131], a[224:227]
ds_read_b64_tr_b16 v[224:225], v249 offset:12800
ds_read_b64_tr_b16 v[226:227], v249 offset:14848
v_mfma_f32_16x16x32_bf16 a[224:227], v[236:239], v[144:147], a[224:227]
v_accvgpr_read_b32 v212, a216
v_accvgpr_read_b32 v213, a217
v_mfma_f32_16x16x32_bf16 a[228:231], v[232:235], v[132:135], a[228:231]
v_accvgpr_read_b32 v214, a218
v_accvgpr_read_b32 v215, a219
v_mfma_f32_16x16x32_bf16 a[228:231], v[236:239], v[148:151], a[228:231]
v_cvt_pk_bf16_f32 v90, v212, v213
v_cvt_pk_bf16_f32 v91, v214, v215
v_mfma_f32_16x16x32_bf16 a[232:235], v[232:235], v[136:139], a[232:235]
ds_read_b64_tr_b16 v[228:229], v250 offset:12800
ds_read_b64_tr_b16 v[230:231], v250 offset:14848
v_mfma_f32_16x16x32_bf16 a[232:235], v[236:239], v[152:155], a[232:235]
buffer_store_dwordx4 v[88:91], v252, s[20:23], s46 offen offset:2048 sc1
v_accvgpr_read_b32 v220, a220
v_mfma_f32_16x16x32_bf16 a[236:239], v[232:235], v[140:143], a[236:239]
v_accvgpr_read_b32 v221, a221
v_accvgpr_read_b32 v222, a222
v_mfma_f32_16x16x32_bf16 a[236:239], v[236:239], v[156:159], a[236:239]
s_waitcnt lgkmcnt(4)
v_accvgpr_read_b32 v223, a223
v_mfma_f32_16x16x32_bf16 a[224:227], v[240:243], v[160:163], a[224:227]
ds_read_b64_tr_b16 v[232:233], v250 offset:45568
ds_read_b64_tr_b16 v[234:235], v250 offset:47616
v_mfma_f32_16x16x32_bf16 a[224:227], v[244:247], v[176:179], a[224:227]
v_cvt_pk_bf16_f32 v122, v220, v221
v_cvt_pk_bf16_f32 v123, v222, v223
v_mfma_f32_16x16x32_bf16 a[228:231], v[240:243], v[164:167], a[228:231]
buffer_store_dwordx4 v[120:123], v252, s[20:23], s47 offen offset:2048 sc1
v_mfma_f32_16x16x32_bf16 a[228:231], v[244:247], v[180:183], a[228:231]
v_mfma_f32_16x16x32_bf16 a[232:235], v[240:243], v[168:171], a[232:235]
ds_read_b64_tr_b16 v[236:237], v250 offset:61952
ds_read_b64_tr_b16 v[238:239], v250 offset:64000
v_mfma_f32_16x16x32_bf16 a[232:235], v[244:247], v[184:187], a[232:235]
v_mfma_f32_16x16x32_bf16 a[236:239], v[240:243], v[172:175], a[236:239]
v_mfma_f32_16x16x32_bf16 a[236:239], v[244:247], v[188:191], a[236:239]
s_waitcnt lgkmcnt(4)
v_mfma_f32_16x16x32_bf16 a[224:227], v[224:227], v[0:3], a[224:227]
ds_read_b64_tr_b16 v[240:241], v13 offset:12800
ds_read_b64_tr_b16 v[242:243], v13 offset:14848
v_mfma_f32_16x16x32_bf16 a[228:231], v[224:227], v[32:35], a[228:231]
v_mfma_f32_16x16x32_bf16 a[232:235], v[224:227], v[64:67], a[232:235]
v_mfma_f32_16x16x32_bf16 a[236:239], v[224:227], v[96:99], a[236:239]
v_mfma_f32_16x16x32_bf16 a[240:243], v[228:231], v[0:3], a[240:243]
ds_read_b64_tr_b16 v[244:245], v13 offset:29184
ds_read_b64_tr_b16 v[246:247], v13 offset:31232
v_mfma_f32_16x16x32_bf16 a[244:247], v[228:231], v[32:35], a[244:247]
v_accvgpr_read_b32 v192, a224
v_accvgpr_read_b32 v193, a225
v_mfma_f32_16x16x32_bf16 a[248:251], v[228:231], v[64:67], a[248:251]
v_accvgpr_read_b32 v194, a226
v_accvgpr_read_b32 v195, a227
v_mfma_f32_16x16x32_bf16 a[252:255], v[228:231], v[96:99], a[252:255]
s_waitcnt lgkmcnt(4)
v_cvt_pk_bf16_f32 v28, v192, v193
v_mfma_f32_16x16x32_bf16 a[240:243], v[232:235], v[4:7], a[240:243]
ds_read_b64_tr_b16 v[224:225], v13 offset:45568
ds_read_b64_tr_b16 v[226:227], v13 offset:47616
v_mfma_f32_16x16x32_bf16 a[240:243], v[236:239], v[8:11], a[240:243]
v_cvt_pk_bf16_f32 v29, v194, v195
v_accvgpr_read_b32 v200, a228
v_mfma_f32_16x16x32_bf16 a[244:247], v[232:235], v[36:39], a[244:247]
v_accvgpr_read_b32 v201, a229
v_accvgpr_read_b32 v202, a230
v_mfma_f32_16x16x32_bf16 a[244:247], v[236:239], v[40:43], a[244:247]
v_accvgpr_read_b32 v203, a231
v_cvt_pk_bf16_f32 v60, v200, v201
v_mfma_f32_16x16x32_bf16 a[248:251], v[232:235], v[68:71], a[248:251]
ds_read_b64_tr_b16 v[228:229], v13 offset:61952
ds_read_b64_tr_b16 v[230:231], v13 offset:64000
v_mfma_f32_16x16x32_bf16 a[248:251], v[236:239], v[72:75], a[248:251]
v_cvt_pk_bf16_f32 v61, v202, v203
v_accvgpr_read_b32 v208, a232
v_mfma_f32_16x16x32_bf16 a[252:255], v[232:235], v[100:103], a[252:255]
v_accvgpr_read_b32 v209, a233
v_accvgpr_read_b32 v210, a234
v_mfma_f32_16x16x32_bf16 a[252:255], v[236:239], v[104:107], a[252:255]
s_waitcnt lgkmcnt(4)
v_accvgpr_read_b32 v211, a235
v_mfma_f32_16x16x32_bf16 a[240:243], v[240:243], v[128:131], a[240:243]
v_cvt_pk_bf16_f32 v92, v208, v209
v_cvt_pk_bf16_f32 v93, v210, v211
v_mfma_f32_16x16x32_bf16 a[240:243], v[244:247], v[144:147], a[240:243]
v_accvgpr_read_b32 v216, a236
v_accvgpr_read_b32 v217, a237
v_mfma_f32_16x16x32_bf16 a[244:247], v[240:243], v[132:135], a[244:247]
v_accvgpr_read_b32 v218, a238
v_accvgpr_read_b32 v219, a239
v_mfma_f32_16x16x32_bf16 a[244:247], v[244:247], v[148:151], a[244:247]
v_cvt_pk_bf16_f32 v124, v216, v217
v_cvt_pk_bf16_f32 v125, v218, v219
v_mfma_f32_16x16x32_bf16 a[248:251], v[240:243], v[136:139], a[248:251]
v_mfma_f32_16x16x32_bf16 a[248:251], v[244:247], v[152:155], a[248:251]
v_mfma_f32_16x16x32_bf16 a[252:255], v[240:243], v[140:143], a[252:255]
v_mfma_f32_16x16x32_bf16 a[252:255], v[244:247], v[156:159], a[252:255]
s_waitcnt lgkmcnt(0)
v_mfma_f32_16x16x32_bf16 a[240:243], v[224:227], v[160:163], a[240:243]
v_mfma_f32_16x16x32_bf16 a[240:243], v[228:231], v[176:179], a[240:243]
v_mfma_f32_16x16x32_bf16 a[244:247], v[224:227], v[164:167], a[244:247]
v_mfma_f32_16x16x32_bf16 a[244:247], v[228:231], v[180:183], a[244:247]
v_mfma_f32_16x16x32_bf16 a[248:251], v[224:227], v[168:171], a[248:251]
v_mfma_f32_16x16x32_bf16 a[248:251], v[228:231], v[184:187], a[248:251]
v_mfma_f32_16x16x32_bf16 a[252:255], v[224:227], v[172:175], a[252:255]
s_nop 2
v_accvgpr_read_b32 v196, a240
v_accvgpr_read_b32 v197, a241
v_accvgpr_read_b32 v198, a242
v_accvgpr_read_b32 v199, a243
v_mfma_f32_16x16x32_bf16 a[252:255], v[228:231], v[188:191], a[252:255]
v_cvt_pk_bf16_f32 v30, v196, v197
v_cvt_pk_bf16_f32 v31, v198, v199
buffer_store_dwordx4 v[28:31], v252, s[20:23], s44 offen offset:3072 sc1
v_accvgpr_read_b32 v204, a244
v_accvgpr_read_b32 v205, a245
v_accvgpr_read_b32 v206, a246
v_accvgpr_read_b32 v207, a247
v_cvt_pk_bf16_f32 v62, v204, v205
v_cvt_pk_bf16_f32 v63, v206, v207
buffer_store_dwordx4 v[60:63], v252, s[20:23], s45 offen offset:3072 sc1
v_accvgpr_read_b32 v212, a248
v_accvgpr_read_b32 v213, a249
v_accvgpr_read_b32 v214, a250
v_accvgpr_read_b32 v215, a251
v_cvt_pk_bf16_f32 v94, v212, v213
v_cvt_pk_bf16_f32 v95, v214, v215
buffer_store_dwordx4 v[92:95], v252, s[20:23], s46 offen offset:3072 sc1
v_accvgpr_read_b32 v220, a252
v_accvgpr_read_b32 v221, a253
v_accvgpr_read_b32 v222, a254
v_accvgpr_read_b32 v223, a255
v_cvt_pk_bf16_f32 v126, v220, v221
v_cvt_pk_bf16_f32 v127, v222, v223
buffer_store_dwordx4 v[124:127], v252, s[20:23], s47 offen offset:3072 sc1
s_branch L2_chk
L2_chk:
LC_start:
s_cmp_lg_u64 vcc, 0
s_cselect_b32 s98, 1, 0
LC_again:
s_lshl_b32 s48, s38, 7
s_lshl_b32 s49, s38, 7
s_lshl_b32 s50, s38, 7
s_mov_b32 s51, s37
s_cmp_eq_u32 s37, 5
s_cselect_b32 s14, 1, 0
s_cselect_b32 s52, 0x7fff0000, s52
s_cselect_b32 s53, 0x7fff0000, s53
s_cselect_b32 s54, 0x7fff0000, s54
s_cmp_eq_u32 s34, 0
s_cselect_b32 s15, 0x6c00000, s52
s_cselect_b32 s15, s15, 0x7fff0000
LC_common:
s_nop 0
s_bfe_u32 s3, s2, 0x30003
s_lshl_b32 s13, s34, 4
s_or_b32 s13, s13, s3
s_lshl_b32 s13, s13, 11
s_lshr_b32 s101, s3, 1
s_xor_b32 s101, s101, s34
s_lshl_b32 s101, s101, 10
s_add_u32 s101, s101, s100
s_cmp_eq_u32 s14, 1
s_cselect_b32 s13, 0x7fff0000, s13
s_add_u32 s28, s4, 0x7000000
s_addc_u32 s29, s5, 0
s_mov_b32 s30, 0x4e2000
s_mov_b32 s31, 0x00020000
s_lshl_b32 s33, s34, 7
v_bfe_u32 v5, v252, 4, 3
v_lshrrev_b32 v6, 8, v252
v_xor_b32 v5, v5, v6
v_lshrrev_b32 v6, 7, v252
v_lshl_add_u32 v6, v6, 9, s33
v_lshl_add_u32 v5, v5, 4, v6
v_xor_b32 v6, 64, v5
v_add_u32 v6, 0x1000, v6
s_cmp_ge_u32 s99, 60
s_cbranch_scc0 LC_side
LC_sideok:
s_add_u32 m0, s101, 0
s_nop 0
buffer_load_dwordx4 v5, s[28:31], s52 offen sc1 lds
s_add_u32 m0, s101, 4096
s_nop 0
buffer_load_dwordx4 v6, s[28:31], s52 offen sc1 lds
s_add_u32 m0, s101, 8192
s_nop 0
buffer_load_dwordx4 v5, s[28:31], s53 offen sc1 lds
s_add_u32 m0, s101, 12288
s_nop 0
buffer_load_dwordx4 v6, s[28:31], s53 offen sc1 lds
s_add_u32 m0, s101, 16384
s_nop 0
buffer_load_dwordx4 v5, s[28:31], s54 offen sc1 lds
s_add_u32 m0, s101, 20480
s_nop 0
buffer_load_dwordx4 v6, s[28:31], s54 offen sc1 lds
s_xor_b32 s33, s13, 0x0
buffer_load_dwordx4 a[0:3], v252, s[56:59], s33 offen offset:0
buffer_load_dwordx4 a[4:7], v252, s[56:59], s33 offen offset:1024
s_xor_b32 s35, s13, 0x4000
buffer_load_dwordx4 a[64:67], v252, s[56:59], s35 offen offset:0
buffer_load_dwordx4 a[68:71], v252, s[56:59], s35 offen offset:1024
s_xor_b32 s39, s13, 0x800
buffer_load_dwordx4 a[8:11], v252, s[56:59], s39 offen offset:0
buffer_load_dwordx4 a[12:15], v252, s[56:59], s39 offen offset:1024
s_xor_b32 s32, s13, 0x4800
buffer_load_dwordx4 a[72:75], v252, s[56:59], s32 offen offset:0
buffer_load_dwordx4 a[76:79], v252, s[56:59], s32 offen offset:1024
s_lshl_b32 s32, s34, 2
s_add_u32 s32, s32, s100
s_and_b32 s33, s98, 1
v_mov_b32 v42, s32
v_mov_b32 v43, s33
ds_write_b32 v42, v43 offset:24576
v_lshrrev_b32 v0, 4, v252
v_and_b32 v2, 15, v0
v_lshrrev_b32 v3, 4, v0
s_add_u32 s8, s6, 0x0
s_addc_u32 s9, s7, 0
s_mov_b32 s10, 0x4e2000
s_mov_b32 s11, 0x00020000
s_lshl_b32 s55, s34, 13
s_add_u32 s55, s55, 0x21000
s_lshl_b32 s33, s34, 7
v_bfe_u32 v9, v252, 4, 3
v_lshrrev_b32 v1, 7, v252
v_xor_b32 v9, v9, v1
v_lshl_add_u32 v1, v1, 9, s33
v_lshl_add_u32 v9, v9, 4, v1
s_and_b32 s72, s100, 0x8000
s_lshl_b32 s73, s34, 11
s_add_u32 s73, s73, 0xe000
s_xor_b32 s73, s73, s72
v_mov_b32 v4, 0x7fff0000
v_cmp_eq_u32 vcc, 0, v3
v_mov_b32 v1, s52
s_nop 0
v_cndmask_b32 v4, v4, v1, vcc
v_cmp_eq_u32 vcc, 1, v3
v_mov_b32 v1, s53
s_nop 0
v_cndmask_b32 v4, v4, v1, vcc
v_cmp_eq_u32 vcc, 2, v3
v_mov_b32 v1, s54
s_nop 0
v_cndmask_b32 v4, v4, v1, vcc
v_lshl_add_u32 v4, v2, 9, v4
v_lshrrev_b32 v7, 3, v4
s_add_u32 s20, s4, 0x2000000
s_addc_u32 s21, s5, 0
s_mov_b32 s22, 0x22e4000
s_mov_b32 s23, 0x00020000
s_add_u32 s40, s18, 0x0
s_addc_u32 s41, s19, 0
s_mov_b32 s42, 0x4e2000
s_mov_b32 s43, 0x00020000
s_add_u32 s60, s4, 0x7c00000
s_addc_u32 s61, s5, 0
s_mov_b32 s12, 0xffff0000
v_mov_b32 v40, s48
s_lshl_b32 s33, s34, 11
v_add_u32 v10, s33, v252
s_lshl_b32 s32, s3, 10
v_xor_b32 v38, s32, v10
s_xor_b32 s32, s72, 0x8000
v_add_u32 v38, s32, v38
v_add_u32 v15, s32, v252
v_xor_b32 v39, 0x400, v38
v_lshrrev_b32 v1, 1, v2
v_xor_b32 v1, v1, v3
v_lshrrev_b32 v11, 3, v2
v_lshlrev_b32 v11, 12, v11
v_lshl_add_u32 v11, v1, 4, v11
v_and_b32 v1, 7, v2
v_lshl_add_u32 v11, v1, 7, v11
s_and_b32 s32, s3, 1
s_lshl_b32 s32, s32, 6
v_xor_b32 v11, s32, v11
v_add_u32 v11, s100, v11
v_xor_b32 v12, 64, v11
s_lshl_b32 s33, s34, 12
s_add_u32 s33, s33, 0x18000
s_xor_b32 s33, s33, s72
v_mul_u32_u24 v13, 80, v0
v_add_u32 v13, s33, v13
v_cmp_eq_u32 vcc, 3, v3
v_mov_b32 v4, 0x100000
s_nop 0
v_cndmask_b32 v13, v13, v4, vcc
s_lshl_b32 s32, s51, 2
s_add_u32 s33, s33, s32
v_mul_u32_u24 v14, 80, v2
v_add_u32 v14, s33, v14
v_xor_b32 v1, v1, v3
v_lshlrev_b32 v1, 4, v1
v_lshl_add_u32 v1, v2, 7, v1
v_add_u32 v32, s55, v1
v_xor_b32 v33, 64, v32
v_add_u32 v35, s73, v1
v_xor_b32 v36, 64, v35
v_add_u32 v34, s55, v252
v_add_u32 v37, s73, v252
s_lshl_b32 s32, s34, 11
s_xor_b32 s33, s72, 0x1b000
s_cmp_lt_u32 s34, 2
s_cselect_b32 s33, 0x20000, s33
s_cselect_b32 s35, 13, 12
s_add_u32 s32, s32, s33
s_mul_i32 s33, s51, 3
s_add_u32 s39, s33, 0
s_and_b32 s39, s39, 3
s_lshl_b32 s39, s39, s35
s_add_u32 s39, s39, s32
v_add_u32 v44, s39, v252
s_add_u32 s39, s33, 1
s_and_b32 s39, s39, 3
s_lshl_b32 s39, s39, s35
s_add_u32 s39, s39, s32
v_add_u32 v45, s39, v252
s_add_u32 s39, s33, 2
s_and_b32 s39, s39, 3
s_lshl_b32 s39, s39, s35
s_add_u32 s39, s39, s32
v_add_u32 v46, s39, v252
s_add_u32 s32, s51, 1
s_sub_u32 s33, s32, 6
s_cselect_b32 s32, s32, s33
s_mul_i32 s44, s32, 0x600000
s_add_u32 s32, s51, 2
s_sub_u32 s33, s32, 6
s_cselect_b32 s32, s32, s33
s_mul_i32 s45, s32, 0x600000
s_add_u32 s32, s51, 3
s_sub_u32 s33, s32, 6
s_cselect_b32 s32, s32, s33
s_mul_i32 s46, s32, 0x600000
s_add_u32 s32, s51, 4
s_sub_u32 s33, s32, 6
s_cselect_b32 s32, s32, s33
s_mul_i32 s47, s32, 0x600000
v_mov_b32 v41, 1
v_and_b32 v42, 3, v0
v_lshl_add_u32 v42, v42, 2, s100
s_lshl_b32 s33, s34, 12
s_sub_u32 s33, s33, s72
s_cmp_lt_u32 s98, 2
s_cselect_b32 s33, s33, 0x100000
v_add_u32 v1, s33, v252
v_add_u32 v1, 0x1c000, v1
s_waitcnt vmcnt(14)
s_waitcnt lgkmcnt(0)
s_barrier
ds_read_b32 v43, v42 offset:24576
ds_write_b128 v1, v[16:19] offset:0
ds_write_b128 v1, v[20:23] offset:1024
ds_write_b128 v1, v[24:27] offset:2048
ds_write_b128 v1, v[28:31] offset:3072
s_waitcnt lgkmcnt(4)
v_cmp_ne_u32 vcc, 0, v43
s_cbranch_vccnz LC_slow
s_mov_b64 exec, 1
buffer_atomic_add v41, v40, s[56:59], s15 offen
s_mov_b64 exec, -1
s_cmp_eq_u32 s14, 1
s_cbranch_scc1 L2_fin
s_add_u32 s32, s51, 5
s_sub_u32 s33, s32, 6
s_cselect_b32 s32, s32, s33
s_mul_i32 s15, s32, 0x600000
s_add_u32 m0, s73, 0
s_add_u32 s33, s54, 0
buffer_load_dwordx4 v9, s[8:11], s33 offen lds
s_add_u32 m0, s73, 1024
s_add_u32 s35, s54, 4096
buffer_load_dwordx4 v9, s[8:11], s35 offen lds
s_xor_b32 s39, s13, 0x1000
buffer_load_dwordx4 a[16:19], v252, s[56:59], s39 offen offset:0
buffer_load_dwordx4 a[20:23], v252, s[56:59], s39 offen offset:1024
s_xor_b32 s32, s13, 0x5000
buffer_load_dwordx4 a[80:83], v252, s[56:59], s32 offen offset:0
buffer_load_dwordx4 a[84:87], v252, s[56:59], s32 offen offset:1024
s_xor_b32 s33, s13, 0x1800
buffer_load_dwordx4 a[24:27], v252, s[56:59], s33 offen offset:0
buffer_load_dwordx4 a[28:31], v252, s[56:59], s33 offen offset:1024
s_xor_b32 s35, s13, 0x5800
buffer_load_dwordx4 a[88:91], v252, s[56:59], s35 offen offset:0
buffer_load_dwordx4 a[92:95], v252, s[56:59], s35 offen offset:1024
s_xor_b32 s39, s13, 0x2000
buffer_load_dwordx4 a[32:35], v252, s[56:59], s39 offen offset:0
buffer_load_dwordx4 a[36:39], v252, s[56:59], s39 offen offset:1024
ds_read_b128 v[52:55], v32 offset:0
ds_read_b128 v[60:63], v33 offset:0
s_waitcnt lgkmcnt(1)
v_lshlrev_b32 v48, 16, v52
v_and_b32 v49, s12, v52
v_lshlrev_b32 v50, 16, v53
v_and_b32 v51, s12, v53
v_lshlrev_b32 v52, 16, v54
v_and_b32 v53, s12, v54
v_lshlrev_b32 v54, 16, v55
v_and_b32 v55, s12, v55
s_waitcnt lgkmcnt(0)
v_lshlrev_b32 v56, 16, v60
v_and_b32 v57, s12, v60
v_lshlrev_b32 v58, 16, v61
v_and_b32 v59, s12, v61
v_lshlrev_b32 v60, 16, v62
v_and_b32 v61, s12, v62
v_lshlrev_b32 v62, 16, v63
v_and_b32 v63, s12, v63
ds_read_b128 v[68:71], v32 offset:2048
ds_read_b128 v[76:79], v33 offset:2048
s_waitcnt lgkmcnt(1)
v_lshlrev_b32 v64, 16, v68
v_and_b32 v65, s12, v68
v_lshlrev_b32 v66, 16, v69
v_and_b32 v67, s12, v69
v_lshlrev_b32 v68, 16, v70
v_and_b32 v69, s12, v70
v_lshlrev_b32 v70, 16, v71
v_and_b32 v71, s12, v71
s_waitcnt lgkmcnt(0)
v_lshlrev_b32 v72, 16, v76
v_and_b32 v73, s12, v76
v_lshlrev_b32 v74, 16, v77
v_and_b32 v75, s12, v77
v_lshlrev_b32 v76, 16, v78
v_and_b32 v77, s12, v78
v_lshlrev_b32 v78, 16, v79
v_and_b32 v79, s12, v79
s_waitcnt vmcnt(11)
s_xor_b32 s32, s13, 0x6000
buffer_load_dwordx4 a[96:99], v252, s[56:59], s32 offen offset:0
s_waitcnt vmcnt(11)
buffer_load_dwordx4 a[100:103], v252, s[56:59], s32 offen offset:1024
s_waitcnt vmcnt(11)
s_xor_b32 s33, s13, 0x2800
buffer_load_dwordx4 a[40:43], v252, s[56:59], s33 offen offset:0
s_waitcnt vmcnt(11)
buffer_load_dwordx4 a[44:47], v252, s[56:59], s33 offen offset:1024
s_waitcnt vmcnt(11)
s_xor_b32 s35, s13, 0x6800
buffer_load_dwordx4 a[104:107], v252, s[56:59], s35 offen offset:0
s_waitcnt vmcnt(11)
buffer_load_dwordx4 a[108:111], v252, s[56:59], s35 offen offset:1024
s_waitcnt vmcnt(11)
s_mov_b32 s70, 0
s_atomic_add s70, s[60:61], s48 glc
s_waitcnt vmcnt(10)
s_xor_b32 s39, s13, 0x3000
buffer_load_dwordx4 a[48:51], v252, s[56:59], s39 offen offset:0
s_waitcnt vmcnt(10)
buffer_load_dwordx4 a[52:55], v252, s[56:59], s39 offen offset:1024
s_waitcnt vmcnt(10)
s_xor_b32 s32, s13, 0x7000
buffer_load_dwordx4 a[112:115], v252, s[56:59], s32 offen offset:0
s_waitcnt vmcnt(10)
buffer_load_dwordx4 a[116:119], v252, s[56:59], s32 offen offset:1024
s_waitcnt vmcnt(10)
s_xor_b32 s33, s13, 0x3800
buffer_load_dwordx4 a[56:59], v252, s[56:59], s33 offen offset:0
s_waitcnt vmcnt(10)
buffer_load_dwordx4 a[60:63], v252, s[56:59], s33 offen offset:1024
s_waitcnt vmcnt(10)
s_xor_b32 s35, s13, 0x7800
buffer_load_dwordx4 a[120:123], v252, s[56:59], s35 offen offset:0
s_waitcnt vmcnt(10)
buffer_load_dwordx4 a[124:127], v252, s[56:59], s35 offen offset:1024
s_waitcnt lgkmcnt(0)
s_cmp_lt_u32 s70, 6
s_cbranch_scc1 LC_poll
s_cmp_ge_u32 s98, 2
s_cbranch_scc1 LC_poll
LC_got:
buffer_load_dwordx4 v[156:159], v7, s[24:27], 0 offen offset:0 sc1
buffer_load_dwordx4 v[160:163], v7, s[24:27], 0 offen offset:16 sc1
buffer_load_dwordx4 v[164:167], v7, s[24:27], 0 offen offset:32 sc1
s_add_u32 s39, s52, s44
buffer_load_dwordx4 v[168:171], v10, s[20:23], s39 offen offset:0 sc1
s_add_u32 s32, s52, s45
buffer_load_dwordx4 v[172:175], v10, s[20:23], s32 offen offset:0 sc1
s_add_u32 s33, s52, s46
buffer_load_dwordx4 v[176:179], v10, s[20:23], s33 offen offset:0 sc1
s_add_u32 s35, s52, s47
buffer_load_dwordx4 v[180:183], v10, s[20:23], s35 offen offset:0 sc1
s_add_u32 s39, s52, s15
buffer_load_dwordx4 v[184:187], v10, s[20:23], s39 offen offset:0 sc1
s_add_u32 s32, s52, s44
buffer_load_dwordx4 v[188:191], v10, s[20:23], s32 offen offset:1024 sc1
s_add_u32 s33, s52, s45
buffer_load_dwordx4 v[192:195], v10, s[20:23], s33 offen offset:1024 sc1
s_add_u32 s35, s52, s46
buffer_load_dwordx4 v[196:199], v10, s[20:23], s35 offen offset:1024 sc1
s_add_u32 s39, s52, s47
buffer_load_dwordx4 v[200:203], v10, s[20:23], s39 offen offset:1024 sc1
s_add_u32 s32, s52, s15
buffer_load_dwordx4 v[204:207], v10, s[20:23], s32 offen offset:1024 sc1
s_xor_b32 s33, s13, 0x20000
buffer_load_dwordx4 a[128:131], v252, s[56:59], s33 offen offset:0
s_barrier
ds_read_b128 v[132:135], v11 offset:0
ds_read_b128 v[136:139], v11 offset:8192
ds_read_b128 v[140:143], v11 offset:16384
ds_read_b128 v[144:147], v12 offset:0
ds_read_b128 v[148:151], v12 offset:8192
s_waitcnt vmcnt(24)
s_waitcnt vmcnt(23)
s_waitcnt vmcnt(22)
s_waitcnt vmcnt(21)
s_waitcnt vmcnt(20)
s_waitcnt vmcnt(19)
s_waitcnt vmcnt(18)
s_waitcnt vmcnt(17)
s_waitcnt vmcnt(16)
s_waitcnt vmcnt(15)
s_waitcnt vmcnt(14)
s_waitcnt lgkmcnt(4)
v_mfma_f32_16x16x32_bf16 v[48:51], a[0:3], v[132:135], v[48:51]
ds_read_b128 v[152:155], v12 offset:16384
v_mfma_f32_16x16x32_bf16 v[52:55], a[4:7], v[132:135], v[52:55]
v_mfma_f32_16x16x32_bf16 v[56:59], a[64:67], v[132:135], v[56:59]
v_mfma_f32_16x16x32_bf16 v[60:63], a[68:71], v[132:135], v[60:63]
s_waitcnt lgkmcnt(4)
v_mfma_f32_16x16x32_bf16 v[64:67], a[0:3], v[136:139], v[64:67]
ds_read_b128 v[132:135], v11 offset:1024
v_mfma_f32_16x16x32_bf16 v[68:71], a[4:7], v[136:139], v[68:71]
v_mfma_f32_16x16x32_bf16 v[72:75], a[64:67], v[136:139], v[72:75]
v_mfma_f32_16x16x32_bf16 v[76:79], a[68:71], v[136:139], v[76:79]
ds_read_b128 v[84:87], v35 offset:0
ds_read_b128 v[92:95], v36 offset:0
s_waitcnt lgkmcnt(1)
v_lshlrev_b32 v80, 16, v84
v_and_b32 v81, s12, v84
v_lshlrev_b32 v82, 16, v85
v_and_b32 v83, s12, v85
v_lshlrev_b32 v84, 16, v86
v_and_b32 v85, s12, v86
v_lshlrev_b32 v86, 16, v87
v_and_b32 v87, s12, v87
s_waitcnt lgkmcnt(0)
v_lshlrev_b32 v88, 16, v92
v_and_b32 v89, s12, v92
v_lshlrev_b32 v90, 16, v93
v_and_b32 v91, s12, v93
v_lshlrev_b32 v92, 16, v94
v_and_b32 v93, s12, v94
v_lshlrev_b32 v94, 16, v95
v_and_b32 v95, s12, v95
v_mfma_f32_16x16x32_bf16 v[80:83], a[0:3], v[140:143], v[80:83]
ds_read_b128 v[136:139], v11 offset:9216
v_mfma_f32_16x16x32_bf16 v[84:87], a[4:7], v[140:143], v[84:87]
v_mfma_f32_16x16x32_bf16 v[88:91], a[64:67], v[140:143], v[88:91]
v_mfma_f32_16x16x32_bf16 v[92:95], a[68:71], v[140:143], v[92:95]
v_mfma_f32_16x16x32_bf16 v[48:51], a[8:11], v[144:147], v[48:51]
ds_read_b128 v[140:143], v11 offset:17408
v_mfma_f32_16x16x32_bf16 v[52:55], a[12:15], v[144:147], v[52:55]
v_mfma_f32_16x16x32_bf16 v[56:59], a[72:75], v[144:147], v[56:59]
v_mfma_f32_16x16x32_bf16 v[60:63], a[76:79], v[144:147], v[60:63]
v_mfma_f32_16x16x32_bf16 v[64:67], a[8:11], v[148:151], v[64:67]
ds_read_b128 v[144:147], v12 offset:1024
v_mfma_f32_16x16x32_bf16 v[68:71], a[12:15], v[148:151], v[68:71]
v_mfma_f32_16x16x32_bf16 v[72:75], a[72:75], v[148:151], v[72:75]
v_mfma_f32_16x16x32_bf16 v[76:79], a[76:79], v[148:151], v[76:79]
v_mfma_f32_16x16x32_bf16 v[80:83], a[8:11], v[152:155], v[80:83]
ds_read_b128 v[148:151], v12 offset:9216
v_mfma_f32_16x16x32_bf16 v[84:87], a[12:15], v[152:155], v[84:87]
v_mfma_f32_16x16x32_bf16 v[88:91], a[72:75], v[152:155], v[88:91]
v_mfma_f32_16x16x32_bf16 v[92:95], a[76:79], v[152:155], v[92:95]
v_mfma_f32_16x16x32_bf16 v[48:51], a[16:19], v[132:135], v[48:51]
ds_read_b128 v[152:155], v12 offset:17408
v_mfma_f32_16x16x32_bf16 v[52:55], a[20:23], v[132:135], v[52:55]
v_mfma_f32_16x16x32_bf16 v[56:59], a[80:83], v[132:135], v[56:59]
v_mfma_f32_16x16x32_bf16 v[60:63], a[84:87], v[132:135], v[60:63]
s_waitcnt lgkmcnt(4)
v_mfma_f32_16x16x32_bf16 v[64:67], a[16:19], v[136:139], v[64:67]
ds_read_b128 v[132:135], v11 offset:2048
v_mfma_f32_16x16x32_bf16 v[68:71], a[20:23], v[136:139], v[68:71]
v_mfma_f32_16x16x32_bf16 v[72:75], a[80:83], v[136:139], v[72:75]
v_mfma_f32_16x16x32_bf16 v[76:79], a[84:87], v[136:139], v[76:79]
s_waitcnt lgkmcnt(4)
v_mfma_f32_16x16x32_bf16 v[80:83], a[16:19], v[140:143], v[80:83]
ds_read_b128 v[136:139], v11 offset:10240
v_mfma_f32_16x16x32_bf16 v[84:87], a[20:23], v[140:143], v[84:87]
v_mfma_f32_16x16x32_bf16 v[88:91], a[80:83], v[140:143], v[88:91]
v_mfma_f32_16x16x32_bf16 v[92:95], a[84:87], v[140:143], v[92:95]
s_waitcnt lgkmcnt(4)
v_mfma_f32_16x16x32_bf16 v[48:51], a[24:27], v[144:147], v[48:51]
ds_read_b128 v[140:143], v11 offset:18432
v_mfma_f32_16x16x32_bf16 v[52:55], a[28:31], v[144:147], v[52:55]
v_mfma_f32_16x16x32_bf16 v[56:59], a[88:91], v[144:147], v[56:59]
v_mfma_f32_16x16x32_bf16 v[60:63], a[92:95], v[144:147], v[60:63]
s_waitcnt lgkmcnt(4)
v_mfma_f32_16x16x32_bf16 v[64:67], a[24:27], v[148:151], v[64:67]
ds_read_b128 v[144:147], v12 offset:2048
v_mfma_f32_16x16x32_bf16 v[68:71], a[28:31], v[148:151], v[68:71]
v_mfma_f32_16x16x32_bf16 v[72:75], a[88:91], v[148:151], v[72:75]
v_mfma_f32_16x16x32_bf16 v[76:79], a[92:95], v[148:151], v[76:79]
s_waitcnt lgkmcnt(4)
v_mfma_f32_16x16x32_bf16 v[80:83], a[24:27], v[152:155], v[80:83]
ds_read_b128 v[148:151], v12 offset:10240
v_mfma_f32_16x16x32_bf16 v[84:87], a[28:31], v[152:155], v[84:87]
v_mfma_f32_16x16x32_bf16 v[88:91], a[88:91], v[152:155], v[88:91]
v_mfma_f32_16x16x32_bf16 v[92:95], a[92:95], v[152:155], v[92:95]
s_waitcnt lgkmcnt(4)
v_mfma_f32_16x16x32_bf16 v[48:51], a[32:35], v[132:135], v[48:51]
ds_read_b128 v[152:155], v12 offset:18432
v_mfma_f32_16x16x32_bf16 v[52:55], a[36:39], v[132:135], v[52:55]
v_mfma_f32_16x16x32_bf16 v[56:59], a[96:99], v[132:135], v[56:59]
v_mfma_f32_16x16x32_bf16 v[60:63], a[100:103], v[132:135], v[60:63]
s_waitcnt lgkmcnt(4)
v_mfma_f32_16x16x32_bf16 v[64:67], a[32:35], v[136:139], v[64:67]
ds_read_b128 v[132:135], v11 offset:3072
v_mfma_f32_16x16x32_bf16 v[68:71], a[36:39], v[136:139], v[68:71]
v_mfma_f32_16x16x32_bf16 v[72:75], a[96:99], v[136:139], v[72:75]
v_mfma_f32_16x16x32_bf16 v[76:79], a[100:103], v[136:139], v[76:79]
s_waitcnt lgkmcnt(4)
v_mfma_f32_16x16x32_bf16 v[80:83], a[32:35], v[140:143], v[80:83]
ds_read_b128 v[136:139], v11 offset:11264
v_mfma_f32_16x16x32_bf16 v[84:87], a[36:39], v[140:143], v[84:87]
v_mfma_f32_16x16x32_bf16 v[88:91], a[96:99], v[140:143], v[88:91]
v_mfma_f32_16x16x32_bf16 v[92:95], a[100:103], v[140:143], v[92:95]
s_waitcnt lgkmcnt(4)
v_mfma_f32_16x16x32_bf16 v[48:51], a[40:43], v[144:147], v[48:51]
ds_read_b128 v[140:143], v11 offset:19456
v_mfma_f32_16x16x32_bf16 v[52:55], a[44:47], v[144:147], v[52:55]
v_mfma_f32_16x16x32_bf16 v[56:59], a[104:107], v[144:147], v[56:59]
v_mfma_f32_16x16x32_bf16 v[60:63], a[108:111], v[144:147], v[60:63]
s_waitcnt lgkmcnt(4)
v_mfma_f32_16x16x32_bf16 v[64:67], a[40:43], v[148:151], v[64:67]
ds_read_b128 v[144:147], v12 offset:3072
v_mfma_f32_16x16x32_bf16 v[68:71], a[44:47], v[148:151], v[68:71]
v_mfma_f32_16x16x32_bf16 v[72:75], a[104:107], v[148:151], v[72:75]
v_mfma_f32_16x16x32_bf16 v[76:79], a[108:111], v[148:151], v[76:79]
s_waitcnt lgkmcnt(4)
v_mfma_f32_16x16x32_bf16 v[80:83], a[40:43], v[152:155], v[80:83]
ds_read_b128 v[148:151], v12 offset:11264
v_mfma_f32_16x16x32_bf16 v[84:87], a[44:47], v[152:155], v[84:87]
v_mfma_f32_16x16x32_bf16 v[88:91], a[104:107], v[152:155], v[88:91]
v_mfma_f32_16x16x32_bf16 v[92:95], a[108:111], v[152:155], v[92:95]
s_waitcnt lgkmcnt(4)
v_mfma_f32_16x16x32_bf16 v[48:51], a[48:51], v[132:135], v[48:51]
ds_read_b128 v[152:155], v12 offset:19456
v_mfma_f32_16x16x32_bf16 v[52:55], a[52:55], v[132:135], v[52:55]
v_mfma_f32_16x16x32_bf16 v[56:59], a[112:115], v[132:135], v[56:59]
v_mfma_f32_16x16x32_bf16 v[60:63], a[116:119], v[132:135], v[60:63]
s_waitcnt lgkmcnt(4)
v_mfma_f32_16x16x32_bf16 v[64:67], a[48:51], v[136:139], v[64:67]
v_mfma_f32_16x16x32_bf16 v[68:71], a[52:55], v[136:139], v[68:71]
v_mfma_f32_16x16x32_bf16 v[72:75], a[112:115], v[136:139], v[72:75]
v_mfma_f32_16x16x32_bf16 v[76:79], a[116:119], v[136:139], v[76:79]
s_waitcnt lgkmcnt(3)
v_mfma_f32_16x16x32_bf16 v[80:83], a[48:51], v[140:143], v[80:83]
v_mfma_f32_16x16x32_bf16 v[84:87], a[52:55], v[140:143], v[84:87]
v_mfma_f32_16x16x32_bf16 v[88:91], a[112:115], v[140:143], v[88:91]
v_mfma_f32_16x16x32_bf16 v[92:95], a[116:119], v[140:143], v[92:95]
s_waitcnt lgkmcnt(2)
v_mfma_f32_16x16x32_bf16 v[48:51], a[56:59], v[144:147], v[48:51]
v_mfma_f32_16x16x32_bf16 v[52:55], a[60:63], v[144:147], v[52:55]
v_mfma_f32_16x16x32_bf16 v[56:59], a[120:123], v[144:147], v[56:59]
v_mfma_f32_16x16x32_bf16 v[60:63], a[124:127], v[144:147], v[60:63]
s_waitcnt lgkmcnt(1)
v_mfma_f32_16x16x32_bf16 v[64:67], a[56:59], v[148:151], v[64:67]
v_mfma_f32_16x16x32_bf16 v[68:71], a[60:63], v[148:151], v[68:71]
v_mfma_f32_16x16x32_bf16 v[72:75], a[120:123], v[148:151], v[72:75]
v_mfma_f32_16x16x32_bf16 v[76:79], a[124:127], v[148:151], v[76:79]
s_waitcnt lgkmcnt(0)
v_mfma_f32_16x16x32_bf16 v[80:83], a[56:59], v[152:155], v[80:83]
v_mfma_f32_16x16x32_bf16 v[84:87], a[60:63], v[152:155], v[84:87]
v_mfma_f32_16x16x32_bf16 v[88:91], a[120:123], v[152:155], v[88:91]
v_mfma_f32_16x16x32_bf16 v[92:95], a[124:127], v[152:155], v[92:95]
s_waitcnt vmcnt(13)
buffer_load_dwordx4 a[132:135], v252, s[56:59], s33 offen offset:1024
s_waitcnt vmcnt(13)
s_xor_b32 s35, s13, 0x24000
buffer_load_dwordx4 a[192:195], v252, s[56:59], s35 offen offset:0
s_waitcnt vmcnt(13)
buffer_load_dwordx4 a[196:199], v252, s[56:59], s35 offen offset:1024
v_max3_f32 v1, v156, v158, v160
v_max3_f32 v117, v162, v164, v166
v_max_f32 v1, v1, v117
v_sub_f32 v156, v156, v1
v_sub_f32 v158, v158, v1
v_sub_f32 v160, v160, v1
v_sub_f32 v162, v162, v1
v_sub_f32 v164, v164, v1
v_sub_f32 v166, v166, v1
v_exp_f32 v156, v156
v_exp_f32 v158, v158
v_exp_f32 v160, v160
v_exp_f32 v162, v162
v_exp_f32 v164, v164
v_exp_f32 v166, v166
s_nop 0
v_mul_f32 v1, v156, v157
v_fmac_f32 v1, v158, v159
v_fmac_f32 v1, v160, v161
v_fmac_f32 v1, v162, v163
v_fmac_f32 v1, v164, v165
v_fmac_f32 v1, v166, v167
v_rcp_f32 v1, v1
s_nop 0
v_mul_f32 v108, v156, v1
v_mul_f32 v109, v158, v1
v_mul_f32 v110, v160, v1
v_mul_f32 v111, v162, v1
v_mul_f32 v112, v164, v1
v_mul_f32 v113, v166, v1
v_mul_f32 v114, v156, v1
v_mul_f32 v115, v158, v1
ds_write_b128 v13, v[108:111]
ds_write_b128 v13, v[112:115] offset:16
ds_write_b64 v13, v[110:111] offset:32
ds_write_b64 v13, v[112:113] offset:40
ds_read2_b32 v[16:17], v14 offset0:1 offset1:1
ds_read2_b32 v[18:19], v14 offset0:2 offset1:2
ds_read2_b32 v[20:21], v14 offset0:3 offset1:3
ds_read2_b32 v[22:23], v14 offset0:4 offset1:4
ds_read2_b32 v[24:25], v14 offset0:5 offset1:5
ds_read2_b32 v[26:27], v14 offset0:6 offset1:6
v_add_u32 v14, 0x500, v14
s_waitcnt vmcnt(13)
s_xor_b32 s39, s13, 0x20800
buffer_load_dwordx4 a[136:139], v252, s[56:59], s39 offen offset:0
ds_read_b128 v[96:99], v44 offset:0
s_waitcnt lgkmcnt(1)
v_lshlrev_b32 v116, 16, v168
v_and_b32 v117, s12, v168
v_lshlrev_b32 v118, 16, v169
v_and_b32 v119, s12, v169
v_lshlrev_b32 v120, 16, v170
v_and_b32 v121, s12, v170
v_lshlrev_b32 v122, 16, v171
v_and_b32 v123, s12, v171
v_pk_mul_f32 v[108:109], v[116:117], v[16:17]
v_pk_mul_f32 v[110:111], v[118:119], v[16:17]
v_pk_mul_f32 v[112:113], v[120:121], v[16:17]
v_pk_mul_f32 v[114:115], v[122:123], v[16:17]
s_waitcnt vmcnt(13)
buffer_load_dwordx4 a[140:143], v252, s[56:59], s39 offen offset:1024
v_lshlrev_b32 v116, 16, v172
v_and_b32 v117, s12, v172
v_lshlrev_b32 v118, 16, v173
v_and_b32 v119, s12, v173
v_lshlrev_b32 v120, 16, v174
v_and_b32 v121, s12, v174
v_lshlrev_b32 v122, 16, v175
v_and_b32 v123, s12, v175
v_pk_fma_f32 v[108:109], v[116:117], v[18:19], v[108:109]
v_pk_fma_f32 v[110:111], v[118:119], v[18:19], v[110:111]
v_pk_fma_f32 v[112:113], v[120:121], v[18:19], v[112:113]
v_pk_fma_f32 v[114:115], v[122:123], v[18:19], v[114:115]
s_waitcnt vmcnt(13)
s_xor_b32 s32, s13, 0x24800
buffer_load_dwordx4 a[200:203], v252, s[56:59], s32 offen offset:0
v_lshlrev_b32 v116, 16, v176
v_and_b32 v117, s12, v176
v_lshlrev_b32 v118, 16, v177
v_and_b32 v119, s12, v177
v_lshlrev_b32 v120, 16, v178
v_and_b32 v121, s12, v178
v_lshlrev_b32 v122, 16, v179
v_and_b32 v123, s12, v179
v_pk_fma_f32 v[108:109], v[116:117], v[20:21], v[108:109]
v_pk_fma_f32 v[110:111], v[118:119], v[20:21], v[110:111]
v_pk_fma_f32 v[112:113], v[120:121], v[20:21], v[112:113]
v_pk_fma_f32 v[114:115], v[122:123], v[20:21], v[114:115]
s_waitcnt vmcnt(13)
buffer_load_dwordx4 a[204:207], v252, s[56:59], s32 offen offset:1024
v_lshlrev_b32 v116, 16, v180
v_and_b32 v117, s12, v180
v_lshlrev_b32 v118, 16, v181
v_and_b32 v119, s12, v181
v_lshlrev_b32 v120, 16, v182
v_and_b32 v121, s12, v182
v_lshlrev_b32 v122, 16, v183
v_and_b32 v123, s12, v183
v_pk_fma_f32 v[108:109], v[116:117], v[22:23], v[108:109]
v_pk_fma_f32 v[110:111], v[118:119], v[22:23], v[110:111]
v_pk_fma_f32 v[112:113], v[120:121], v[22:23], v[112:113]
v_pk_fma_f32 v[114:115], v[122:123], v[22:23], v[114:115]
s_waitcnt lgkmcnt(0)
v_lshlrev_b32 v116, 16, v96
v_and_b32 v117, s12, v96
v_lshlrev_b32 v118, 16, v97
v_and_b32 v119, s12, v97
v_lshlrev_b32 v120, 16, v98
v_and_b32 v121, s12, v98
v_lshlrev_b32 v122, 16, v99
v_and_b32 v123, s12, v99
v_pk_fma_f32 v[108:109], v[116:117], v[26:27], v[108:109]
v_pk_fma_f32 v[110:111], v[118:119], v[26:27], v[110:111]
v_pk_fma_f32 v[112:113], v[120:121], v[26:27], v[112:113]
v_pk_fma_f32 v[114:115], v[122:123], v[26:27], v[114:115]
s_waitcnt vmcnt(13)
s_add_u32 s33, s53, s44
buffer_load_dwordx4 v[208:211], v10, s[20:23], s33 offen offset:0 sc1
v_lshlrev_b32 v116, 16, v184
v_and_b32 v117, s12, v184
v_lshlrev_b32 v118, 16, v185
v_and_b32 v119, s12, v185
v_lshlrev_b32 v120, 16, v186
v_and_b32 v121, s12, v186
v_lshlrev_b32 v122, 16, v187
v_and_b32 v123, s12, v187
v_pk_fma_f32 v[108:109], v[116:117], v[24:25], v[108:109]
v_pk_fma_f32 v[110:111], v[118:119], v[24:25], v[110:111]
v_pk_fma_f32 v[112:113], v[120:121], v[24:25], v[112:113]
v_pk_fma_f32 v[114:115], v[122:123], v[24:25], v[114:115]
v_cvt_pk_bf16_f32 v116, v108, v109
v_cvt_pk_bf16_f32 v117, v110, v111
v_cvt_pk_bf16_f32 v118, v112, v113
v_cvt_pk_bf16_f32 v119, v114, v115
ds_write_b128 v38, v[116:119] offset:0
s_waitcnt vmcnt(13)
s_xor_b32 s35, s13, 0x21000
buffer_load_dwordx4 a[144:147], v252, s[56:59], s35 offen offset:0
ds_read_b128 v[96:99], v44 offset:1024
v_lshlrev_b32 v116, 16, v188
v_and_b32 v117, s12, v188
v_lshlrev_b32 v118, 16, v189
v_and_b32 v119, s12, v189
v_lshlrev_b32 v120, 16, v190
v_and_b32 v121, s12, v190
v_lshlrev_b32 v122, 16, v191
v_and_b32 v123, s12, v191
v_pk_mul_f32 v[108:109], v[116:117], v[16:17]
v_pk_mul_f32 v[110:111], v[118:119], v[16:17]
v_pk_mul_f32 v[112:113], v[120:121], v[16:17]
v_pk_mul_f32 v[114:115], v[122:123], v[16:17]
s_waitcnt vmcnt(13)
buffer_load_dwordx4 a[148:151], v252, s[56:59], s35 offen offset:1024
v_lshlrev_b32 v116, 16, v192
v_and_b32 v117, s12, v192
v_lshlrev_b32 v118, 16, v193
v_and_b32 v119, s12, v193
v_lshlrev_b32 v120, 16, v194
v_and_b32 v121, s12, v194
v_lshlrev_b32 v122, 16, v195
v_and_b32 v123, s12, v195
v_pk_fma_f32 v[108:109], v[116:117], v[18:19], v[108:109]
v_pk_fma_f32 v[110:111], v[118:119], v[18:19], v[110:111]
v_pk_fma_f32 v[112:113], v[120:121], v[18:19], v[112:113]
v_pk_fma_f32 v[114:115], v[122:123], v[18:19], v[114:115]
s_waitcnt vmcnt(13)
s_add_u32 s39, s53, s45
buffer_load_dwordx4 v[212:215], v10, s[20:23], s39 offen offset:0 sc1
v_lshlrev_b32 v116, 16, v196
v_and_b32 v117, s12, v196
v_lshlrev_b32 v118, 16, v197
v_and_b32 v119, s12, v197
v_lshlrev_b32 v120, 16, v198
v_and_b32 v121, s12, v198
v_lshlrev_b32 v122, 16, v199
v_and_b32 v123, s12, v199
v_pk_fma_f32 v[108:109], v[116:117], v[20:21], v[108:109]
v_pk_fma_f32 v[110:111], v[118:119], v[20:21], v[110:111]
v_pk_fma_f32 v[112:113], v[120:121], v[20:21], v[112:113]
v_pk_fma_f32 v[114:115], v[122:123], v[20:21], v[114:115]
s_waitcnt vmcnt(13)
s_xor_b32 s32, s13, 0x25000
buffer_load_dwordx4 a[208:211], v252, s[56:59], s32 offen offset:0
v_lshlrev_b32 v116, 16, v200
v_and_b32 v117, s12, v200
v_lshlrev_b32 v118, 16, v201
v_and_b32 v119, s12, v201
v_lshlrev_b32 v120, 16, v202
v_and_b32 v121, s12, v202
v_lshlrev_b32 v122, 16, v203
v_and_b32 v123, s12, v203
v_pk_fma_f32 v[108:109], v[116:117], v[22:23], v[108:109]
v_pk_fma_f32 v[110:111], v[118:119], v[22:23], v[110:111]
v_pk_fma_f32 v[112:113], v[120:121], v[22:23], v[112:113]
v_pk_fma_f32 v[114:115], v[122:123], v[22:23], v[114:115]
s_waitcnt lgkmcnt(0)
v_lshlrev_b32 v116, 16, v96
v_and_b32 v117, s12, v96
v_lshlrev_b32 v118, 16, v97
v_and_b32 v119, s12, v97
v_lshlrev_b32 v120, 16, v98
v_and_b32 v121, s12, v98
v_lshlrev_b32 v122, 16, v99
v_and_b32 v123, s12, v99
v_pk_fma_f32 v[108:109], v[116:117], v[26:27], v[108:109]
v_pk_fma_f32 v[110:111], v[118:119], v[26:27], v[110:111]
v_pk_fma_f32 v[112:113], v[120:121], v[26:27], v[112:113]
v_pk_fma_f32 v[114:115], v[122:123], v[26:27], v[114:115]
s_waitcnt vmcnt(13)
buffer_load_dwordx4 a[212:215], v252, s[56:59], s32 offen offset:1024
v_lshlrev_b32 v116, 16, v204
v_and_b32 v117, s12, v204
v_lshlrev_b32 v118, 16, v205
v_and_b32 v119, s12, v205
v_lshlrev_b32 v120, 16, v206
v_and_b32 v121, s12, v206
v_lshlrev_b32 v122, 16, v207
v_and_b32 v123, s12, v207
v_pk_fma_f32 v[108:109], v[116:117], v[24:25], v[108:109]
v_pk_fma_f32 v[110:111], v[118:119], v[24:25], v[110:111]
v_pk_fma_f32 v[112:113], v[120:121], v[24:25], v[112:113]
v_pk_fma_f32 v[114:115], v[122:123], v[24:25], v[114:115]
ds_read2_b32 v[16:17], v14 offset0:1 offset1:1
ds_read2_b32 v[18:19], v14 offset0:2 offset1:2
ds_read2_b32 v[20:21], v14 offset0:3 offset1:3
ds_read2_b32 v[22:23], v14 offset0:4 offset1:4
ds_read2_b32 v[24:25], v14 offset0:5 offset1:5
ds_read2_b32 v[26:27], v14 offset0:6 offset1:6
v_add_u32 v14, 0x500, v14
v_cvt_pk_bf16_f32 v116, v108, v109
v_cvt_pk_bf16_f32 v117, v110, v111
v_cvt_pk_bf16_f32 v118, v112, v113
v_cvt_pk_bf16_f32 v119, v114, v115
ds_write_b128 v39, v[116:119] offset:0
s_waitcnt vmcnt(13)
s_add_u32 s33, s53, s46
buffer_load_dwordx4 v[216:219], v10, s[20:23], s33 offen offset:0 sc1
s_waitcnt vmcnt(13)
s_xor_b32 s35, s13, 0x21800
buffer_load_dwordx4 a[152:155], v252, s[56:59], s35 offen offset:0
s_waitcnt vmcnt(13)
buffer_load_dwordx4 a[156:159], v252, s[56:59], s35 offen offset:1024
s_waitcnt vmcnt(13)
s_add_u32 s39, s53, s47
buffer_load_dwordx4 v[220:223], v10, s[20:23], s39 offen offset:0 sc1
s_waitcnt vmcnt(13)
s_xor_b32 s32, s13, 0x25800
buffer_load_dwordx4 a[216:219], v252, s[56:59], s32 offen offset:0
s_waitcnt vmcnt(13)
buffer_load_dwordx4 a[220:223], v252, s[56:59], s32 offen offset:1024
s_waitcnt vmcnt(13)
s_add_u32 s33, s53, s15
buffer_load_dwordx4 v[224:227], v10, s[20:23], s33 offen offset:0 sc1
s_waitcnt vmcnt(13)
s_xor_b32 s35, s13, 0x22000
buffer_load_dwordx4 a[160:163], v252, s[56:59], s35 offen offset:0
s_waitcnt lgkmcnt(0)
s_barrier
ds_read_b128 v[132:135], v15 offset:0
ds_read_b128 v[136:139], v15 offset:1024
ds_read_b128 v[140:143], v15 offset:2048
ds_read_b128 v[144:147], v15 offset:3072
ds_read_b128 v[148:151], v15 offset:4096
s_waitcnt lgkmcnt(4)
v_mfma_f32_16x16x32_bf16 v[48:51], a[128:131], v[132:135], v[48:51]
ds_read_b128 v[152:155], v15 offset:5120
v_mfma_f32_16x16x32_bf16 v[52:55], a[132:135], v[132:135], v[52:55]
v_mfma_f32_16x16x32_bf16 v[56:59], a[192:195], v[132:135], v[56:59]
v_mfma_f32_16x16x32_bf16 v[60:63], a[196:199], v[132:135], v[60:63]
s_waitcnt vmcnt(13)
buffer_load_dwordx4 a[164:167], v252, s[56:59], s35 offen offset:1024
s_waitcnt lgkmcnt(4)
v_mfma_f32_16x16x32_bf16 v[48:51], a[136:139], v[136:139], v[48:51]
ds_read_b128 v[132:135], v15 offset:6144
v_mfma_f32_16x16x32_bf16 v[52:55], a[140:143], v[136:139], v[52:55]
v_mfma_f32_16x16x32_bf16 v[56:59], a[200:203], v[136:139], v[56:59]
v_mfma_f32_16x16x32_bf16 v[60:63], a[204:207], v[136:139], v[60:63]
ds_read_b128 v[96:99], v45 offset:0
v_lshlrev_b32 v116, 16, v208
v_and_b32 v117, s12, v208
v_lshlrev_b32 v118, 16, v209
v_and_b32 v119, s12, v209
v_lshlrev_b32 v120, 16, v210
v_and_b32 v121, s12, v210
v_lshlrev_b32 v122, 16, v211
v_and_b32 v123, s12, v211
v_pk_mul_f32 v[108:109], v[116:117], v[16:17]
v_pk_mul_f32 v[110:111], v[118:119], v[16:17]
v_pk_mul_f32 v[112:113], v[120:121], v[16:17]
v_pk_mul_f32 v[114:115], v[122:123], v[16:17]
s_waitcnt vmcnt(13)
s_add_u32 s39, s53, s44
buffer_load_dwordx4 v[228:231], v10, s[20:23], s39 offen offset:1024 sc1
s_waitcnt vmcnt(13)
s_xor_b32 s32, s13, 0x26000
buffer_load_dwordx4 a[224:227], v252, s[56:59], s32 offen offset:0
s_waitcnt vmcnt(13)
buffer_load_dwordx4 a[228:231], v252, s[56:59], s32 offen offset:1024
v_lshlrev_b32 v116, 16, v212
v_and_b32 v117, s12, v212
v_lshlrev_b32 v118, 16, v213
v_and_b32 v119, s12, v213
v_lshlrev_b32 v120, 16, v214
v_and_b32 v121, s12, v214
v_lshlrev_b32 v122, 16, v215
v_and_b32 v123, s12, v215
v_pk_fma_f32 v[108:109], v[116:117], v[18:19], v[108:109]
v_pk_fma_f32 v[110:111], v[118:119], v[18:19], v[110:111]
v_pk_fma_f32 v[112:113], v[120:121], v[18:19], v[112:113]
v_pk_fma_f32 v[114:115], v[122:123], v[18:19], v[114:115]
s_waitcnt vmcnt(13)
s_add_u32 s33, s53, s45
buffer_load_dwordx4 v[232:235], v10, s[20:23], s33 offen offset:1024 sc1
s_waitcnt vmcnt(13)
s_xor_b32 s35, s13, 0x22800
buffer_load_dwordx4 a[168:171], v252, s[56:59], s35 offen offset:0
s_waitcnt lgkmcnt(5)
v_mfma_f32_16x16x32_bf16 v[48:51], a[144:147], v[140:143], v[48:51]
v_mfma_f32_16x16x32_bf16 v[52:55], a[148:151], v[140:143], v[52:55]
v_mfma_f32_16x16x32_bf16 v[56:59], a[208:211], v[140:143], v[56:59]
v_mfma_f32_16x16x32_bf16 v[60:63], a[212:215], v[140:143], v[60:63]
s_waitcnt vmcnt(13)
buffer_load_dwordx4 a[172:175], v252, s[56:59], s35 offen offset:1024
v_lshlrev_b32 v116, 16, v216
v_and_b32 v117, s12, v216
v_lshlrev_b32 v118, 16, v217
v_and_b32 v119, s12, v217
v_lshlrev_b32 v120, 16, v218
v_and_b32 v121, s12, v218
v_lshlrev_b32 v122, 16, v219
v_and_b32 v123, s12, v219
v_pk_fma_f32 v[108:109], v[116:117], v[20:21], v[108:109]
v_pk_fma_f32 v[110:111], v[118:119], v[20:21], v[110:111]
v_pk_fma_f32 v[112:113], v[120:121], v[20:21], v[112:113]
v_pk_fma_f32 v[114:115], v[122:123], v[20:21], v[114:115]
s_waitcnt vmcnt(13)
s_add_u32 s39, s53, s46
buffer_load_dwordx4 v[236:239], v10, s[20:23], s39 offen offset:1024 sc1
s_waitcnt vmcnt(13)
s_xor_b32 s32, s13, 0x26800
buffer_load_dwordx4 a[232:235], v252, s[56:59], s32 offen offset:0
s_waitcnt vmcnt(13)
buffer_load_dwordx4 a[236:239], v252, s[56:59], s32 offen offset:1024
v_lshlrev_b32 v116, 16, v220
v_and_b32 v117, s12, v220
v_lshlrev_b32 v118, 16, v221
v_and_b32 v119, s12, v221
v_lshlrev_b32 v120, 16, v222
v_and_b32 v121, s12, v222
v_lshlrev_b32 v122, 16, v223
v_and_b32 v123, s12, v223
v_pk_fma_f32 v[108:109], v[116:117], v[22:23], v[108:109]
v_pk_fma_f32 v[110:111], v[118:119], v[22:23], v[110:111]
v_pk_fma_f32 v[112:113], v[120:121], v[22:23], v[112:113]
v_pk_fma_f32 v[114:115], v[122:123], v[22:23], v[114:115]
s_waitcnt lgkmcnt(0)
v_lshlrev_b32 v116, 16, v96
v_and_b32 v117, s12, v96
v_lshlrev_b32 v118, 16, v97
v_and_b32 v119, s12, v97
v_lshlrev_b32 v120, 16, v98
v_and_b32 v121, s12, v98
v_lshlrev_b32 v122, 16, v99
v_and_b32 v123, s12, v99
v_pk_fma_f32 v[108:109], v[116:117], v[26:27], v[108:109]
v_pk_fma_f32 v[110:111], v[118:119], v[26:27], v[110:111]
v_pk_fma_f32 v[112:113], v[120:121], v[26:27], v[112:113]
v_pk_fma_f32 v[114:115], v[122:123], v[26:27], v[114:115]
s_waitcnt vmcnt(13)
s_add_u32 s33, s53, s47
buffer_load_dwordx4 v[240:243], v10, s[20:23], s33 offen offset:1024 sc1
s_waitcnt vmcnt(13)
s_xor_b32 s35, s13, 0x23000
buffer_load_dwordx4 a[176:179], v252, s[56:59], s35 offen offset:0
v_mfma_f32_16x16x32_bf16 v[48:51], a[152:155], v[144:147], v[48:51]
v_mfma_f32_16x16x32_bf16 v[52:55], a[156:159], v[144:147], v[52:55]
v_mfma_f32_16x16x32_bf16 v[56:59], a[216:219], v[144:147], v[56:59]
v_mfma_f32_16x16x32_bf16 v[60:63], a[220:223], v[144:147], v[60:63]
s_waitcnt vmcnt(13)
buffer_load_dwordx4 a[180:183], v252, s[56:59], s35 offen offset:1024
v_lshlrev_b32 v116, 16, v224
v_and_b32 v117, s12, v224
v_lshlrev_b32 v118, 16, v225
v_and_b32 v119, s12, v225
v_lshlrev_b32 v120, 16, v226
v_and_b32 v121, s12, v226
v_lshlrev_b32 v122, 16, v227
v_and_b32 v123, s12, v227
v_pk_fma_f32 v[108:109], v[116:117], v[24:25], v[108:109]
v_pk_fma_f32 v[110:111], v[118:119], v[24:25], v[110:111]
v_pk_fma_f32 v[112:113], v[120:121], v[24:25], v[112:113]
v_pk_fma_f32 v[114:115], v[122:123], v[24:25], v[114:115]
v_cvt_pk_bf16_f32 v116, v108, v109
v_cvt_pk_bf16_f32 v117, v110, v111
v_cvt_pk_bf16_f32 v118, v112, v113
v_cvt_pk_bf16_f32 v119, v114, v115
ds_write_b128 v38, v[116:119] offset:8192
s_waitcnt vmcnt(13)
s_add_u32 s39, s53, s15
buffer_load_dwordx4 v[244:247], v10, s[20:23], s39 offen offset:1024 sc1
s_waitcnt vmcnt(13)
s_xor_b32 s32, s13, 0x27000
buffer_load_dwordx4 a[240:243], v252, s[56:59], s32 offen offset:0
s_waitcnt vmcnt(13)
buffer_load_dwordx4 a[244:247], v252, s[56:59], s32 offen offset:1024
ds_read_b128 v[96:99], v45 offset:1024
v_lshlrev_b32 v116, 16, v228
v_and_b32 v117, s12, v228
v_lshlrev_b32 v118, 16, v229
v_and_b32 v119, s12, v229
v_lshlrev_b32 v120, 16, v230
v_and_b32 v121, s12, v230
v_lshlrev_b32 v122, 16, v231
v_and_b32 v123, s12, v231
v_pk_mul_f32 v[108:109], v[116:117], v[16:17]
v_pk_mul_f32 v[110:111], v[118:119], v[16:17]
v_pk_mul_f32 v[112:113], v[120:121], v[16:17]
v_pk_mul_f32 v[114:115], v[122:123], v[16:17]
s_waitcnt vmcnt(13)
s_xor_b32 s33, s13, 0x23800
buffer_load_dwordx4 a[184:187], v252, s[56:59], s33 offen offset:0
s_waitcnt vmcnt(13)
buffer_load_dwordx4 a[188:191], v252, s[56:59], s33 offen offset:1024
v_mfma_f32_16x16x32_bf16 v[48:51], a[160:163], v[148:151], v[48:51]
v_mfma_f32_16x16x32_bf16 v[52:55], a[164:167], v[148:151], v[52:55]
v_mfma_f32_16x16x32_bf16 v[56:59], a[224:227], v[148:151], v[56:59]
v_mfma_f32_16x16x32_bf16 v[60:63], a[228:231], v[148:151], v[60:63]
s_waitcnt vmcnt(13)
s_xor_b32 s35, s13, 0x27800
buffer_load_dwordx4 a[248:251], v252, s[56:59], s35 offen offset:0
v_lshlrev_b32 v116, 16, v232
v_and_b32 v117, s12, v232
v_lshlrev_b32 v118, 16, v233
v_and_b32 v119, s12, v233
v_lshlrev_b32 v120, 16, v234
v_and_b32 v121, s12, v234
v_lshlrev_b32 v122, 16, v235
v_and_b32 v123, s12, v235
v_pk_fma_f32 v[108:109], v[116:117], v[18:19], v[108:109]
v_pk_fma_f32 v[110:111], v[118:119], v[18:19], v[110:111]
v_pk_fma_f32 v[112:113], v[120:121], v[18:19], v[112:113]
v_pk_fma_f32 v[114:115], v[122:123], v[18:19], v[114:115]
s_waitcnt vmcnt(13)
buffer_load_dwordx4 a[252:255], v252, s[56:59], s35 offen offset:1024
s_waitcnt vmcnt(13)
s_add_u32 s39, s54, s44
buffer_load_dwordx4 v[156:159], v10, s[20:23], s39 offen offset:0 sc1
s_waitcnt vmcnt(13)
s_add_u32 s32, s54, s45
buffer_load_dwordx4 v[160:163], v10, s[20:23], s32 offen offset:0 sc1
v_lshlrev_b32 v116, 16, v236
v_and_b32 v117, s12, v236
v_lshlrev_b32 v118, 16, v237
v_and_b32 v119, s12, v237
v_lshlrev_b32 v120, 16, v238
v_and_b32 v121, s12, v238
v_lshlrev_b32 v122, 16, v239
v_and_b32 v123, s12, v239
v_pk_fma_f32 v[108:109], v[116:117], v[20:21], v[108:109]
v_pk_fma_f32 v[110:111], v[118:119], v[20:21], v[110:111]
v_pk_fma_f32 v[112:113], v[120:121], v[20:21], v[112:113]
v_pk_fma_f32 v[114:115], v[122:123], v[20:21], v[114:115]
s_waitcnt vmcnt(13)
s_add_u32 s33, s54, s46
buffer_load_dwordx4 v[164:167], v10, s[20:23], s33 offen offset:0 sc1
s_waitcnt vmcnt(13)
s_add_u32 s35, s54, s47
buffer_load_dwordx4 v[168:171], v10, s[20:23], s35 offen offset:0 sc1
v_mfma_f32_16x16x32_bf16 v[48:51], a[168:171], v[152:155], v[48:51]
v_mfma_f32_16x16x32_bf16 v[52:55], a[172:175], v[152:155], v[52:55]
v_mfma_f32_16x16x32_bf16 v[56:59], a[232:235], v[152:155], v[56:59]
v_mfma_f32_16x16x32_bf16 v[60:63], a[236:239], v[152:155], v[60:63]
s_waitcnt vmcnt(13)
s_add_u32 s39, s54, s15
buffer_load_dwordx4 v[172:175], v10, s[20:23], s39 offen offset:0 sc1
v_lshlrev_b32 v116, 16, v240
v_and_b32 v117, s12, v240
v_lshlrev_b32 v118, 16, v241
v_and_b32 v119, s12, v241
v_lshlrev_b32 v120, 16, v242
v_and_b32 v121, s12, v242
v_lshlrev_b32 v122, 16, v243
v_and_b32 v123, s12, v243
v_pk_fma_f32 v[108:109], v[116:117], v[22:23], v[108:109]
v_pk_fma_f32 v[110:111], v[118:119], v[22:23], v[110:111]
v_pk_fma_f32 v[112:113], v[120:121], v[22:23], v[112:113]
v_pk_fma_f32 v[114:115], v[122:123], v[22:23], v[114:115]
s_waitcnt lgkmcnt(0)
v_lshlrev_b32 v116, 16, v96
v_and_b32 v117, s12, v96
v_lshlrev_b32 v118, 16, v97
v_and_b32 v119, s12, v97
v_lshlrev_b32 v120, 16, v98
v_and_b32 v121, s12, v98
v_lshlrev_b32 v122, 16, v99
v_and_b32 v123, s12, v99
v_pk_fma_f32 v[108:109], v[116:117], v[26:27], v[108:109]
v_pk_fma_f32 v[110:111], v[118:119], v[26:27], v[110:111]
v_pk_fma_f32 v[112:113], v[120:121], v[26:27], v[112:113]
v_pk_fma_f32 v[114:115], v[122:123], v[26:27], v[114:115]
s_waitcnt vmcnt(13)
s_add_u32 s32, s54, s44
buffer_load_dwordx4 v[176:179], v10, s[20:23], s32 offen offset:1024 sc1
s_waitcnt vmcnt(13)
s_add_u32 s33, s54, s45
buffer_load_dwordx4 v[180:183], v10, s[20:23], s33 offen offset:1024 sc1
s_waitcnt vmcnt(13)
s_add_u32 s35, s54, s46
buffer_load_dwordx4 v[184:187], v10, s[20:23], s35 offen offset:1024 sc1
v_lshlrev_b32 v116, 16, v244
v_and_b32 v117, s12, v244
v_lshlrev_b32 v118, 16, v245
v_and_b32 v119, s12, v245
v_lshlrev_b32 v120, 16, v246
v_and_b32 v121, s12, v246
v_lshlrev_b32 v122, 16, v247
v_and_b32 v123, s12, v247
v_pk_fma_f32 v[108:109], v[116:117], v[24:25], v[108:109]
v_pk_fma_f32 v[110:111], v[118:119], v[24:25], v[110:111]
v_pk_fma_f32 v[112:113], v[120:121], v[24:25], v[112:113]
v_pk_fma_f32 v[114:115], v[122:123], v[24:25], v[114:115]
ds_read2_b32 v[16:17], v14 offset0:1 offset1:1
ds_read2_b32 v[18:19], v14 offset0:2 offset1:2
ds_read2_b32 v[20:21], v14 offset0:3 offset1:3
ds_read2_b32 v[22:23], v14 offset0:4 offset1:4
ds_read2_b32 v[24:25], v14 offset0:5 offset1:5
ds_read2_b32 v[26:27], v14 offset0:6 offset1:6
v_cvt_pk_bf16_f32 v116, v108, v109
v_cvt_pk_bf16_f32 v117, v110, v111
v_cvt_pk_bf16_f32 v118, v112, v113
v_cvt_pk_bf16_f32 v119, v114, v115
ds_write_b128 v39, v[116:119] offset:8192
s_waitcnt vmcnt(13)
s_add_u32 s39, s54, s47
buffer_load_dwordx4 v[188:191], v10, s[20:23], s39 offen offset:1024 sc1
s_waitcnt vmcnt(13)
s_add_u32 s32, s54, s15
buffer_load_dwordx4 v[192:195], v10, s[20:23], s32 offen offset:1024 sc1
v_mfma_f32_16x16x32_bf16 v[48:51], a[176:179], v[132:135], v[48:51]
v_mfma_f32_16x16x32_bf16 v[52:55], a[180:183], v[132:135], v[52:55]
v_mfma_f32_16x16x32_bf16 v[56:59], a[240:243], v[132:135], v[56:59]
v_mfma_f32_16x16x32_bf16 v[60:63], a[244:247], v[132:135], v[60:63]
s_waitcnt vmcnt(13)
s_waitcnt vmcnt(12)
s_waitcnt vmcnt(11)
s_waitcnt vmcnt(10)
s_waitcnt lgkmcnt(0)
s_barrier
ds_read_b128 v[136:139], v15 offset:7168
ds_read_b128 v[140:143], v15 offset:8192
ds_read_b128 v[144:147], v15 offset:9216
ds_read_b128 v[148:151], v15 offset:10240
ds_read_b128 v[152:155], v15 offset:11264
s_waitcnt lgkmcnt(4)
v_mfma_f32_16x16x32_bf16 v[48:51], a[184:187], v[136:139], v[48:51]
ds_read_b128 v[132:135], v15 offset:12288
v_mfma_f32_16x16x32_bf16 v[52:55], a[188:191], v[136:139], v[52:55]
v_mfma_f32_16x16x32_bf16 v[56:59], a[248:251], v[136:139], v[56:59]
v_mfma_f32_16x16x32_bf16 v[60:63], a[252:255], v[136:139], v[60:63]
s_waitcnt lgkmcnt(4)
v_mfma_f32_16x16x32_bf16 v[64:67], a[128:131], v[140:143], v[64:67]
ds_read_b128 v[136:139], v15 offset:13312
v_mfma_f32_16x16x32_bf16 v[68:71], a[132:135], v[140:143], v[68:71]
v_mfma_f32_16x16x32_bf16 v[72:75], a[192:195], v[140:143], v[72:75]
v_mfma_f32_16x16x32_bf16 v[76:79], a[196:199], v[140:143], v[76:79]
v_cvt_pk_bf16_f32 v48, v48, v49
v_cvt_pk_bf16_f32 v49, v50, v51
v_cvt_pk_bf16_f32 v50, v52, v53
v_cvt_pk_bf16_f32 v51, v54, v55
ds_write_b128 v32, v[48:51] offset:0
v_cvt_pk_bf16_f32 v56, v56, v57
v_cvt_pk_bf16_f32 v57, v58, v59
v_cvt_pk_bf16_f32 v58, v60, v61
v_cvt_pk_bf16_f32 v59, v62, v63
ds_write_b128 v33, v[56:59] offset:0
ds_read_b128 v[52:55], v34 offset:0
ds_read_b128 v[60:63], v34 offset:1024
s_waitcnt lgkmcnt(8)
v_mfma_f32_16x16x32_bf16 v[64:67], a[136:139], v[144:147], v[64:67]
ds_read_b128 v[140:143], v15 offset:14336
v_mfma_f32_16x16x32_bf16 v[68:71], a[140:143], v[144:147], v[68:71]
v_mfma_f32_16x16x32_bf16 v[72:75], a[200:203], v[144:147], v[72:75]
v_mfma_f32_16x16x32_bf16 v[76:79], a[204:207], v[144:147], v[76:79]
s_waitcnt lgkmcnt(8)
v_mfma_f32_16x16x32_bf16 v[64:67], a[144:147], v[148:151], v[64:67]
ds_read_b128 v[144:147], v15 offset:15360
v_mfma_f32_16x16x32_bf16 v[68:71], a[148:151], v[148:151], v[68:71]
v_mfma_f32_16x16x32_bf16 v[72:75], a[208:211], v[148:151], v[72:75]
v_mfma_f32_16x16x32_bf16 v[76:79], a[212:215], v[148:151], v[76:79]
s_waitcnt lgkmcnt(8)
v_mfma_f32_16x16x32_bf16 v[64:67], a[152:155], v[152:155], v[64:67]
v_mfma_f32_16x16x32_bf16 v[68:71], a[156:159], v[152:155], v[68:71]
v_mfma_f32_16x16x32_bf16 v[72:75], a[216:219], v[152:155], v[72:75]
v_mfma_f32_16x16x32_bf16 v[76:79], a[220:223], v[152:155], v[76:79]
s_waitcnt lgkmcnt(7)
v_mfma_f32_16x16x32_bf16 v[64:67], a[160:163], v[132:135], v[64:67]
v_mfma_f32_16x16x32_bf16 v[68:71], a[164:167], v[132:135], v[68:71]
v_mfma_f32_16x16x32_bf16 v[72:75], a[224:227], v[132:135], v[72:75]
v_mfma_f32_16x16x32_bf16 v[76:79], a[228:231], v[132:135], v[76:79]
s_waitcnt lgkmcnt(6)
v_mfma_f32_16x16x32_bf16 v[64:67], a[168:171], v[136:139], v[64:67]
v_mfma_f32_16x16x32_bf16 v[68:71], a[172:175], v[136:139], v[68:71]
v_mfma_f32_16x16x32_bf16 v[72:75], a[232:235], v[136:139], v[72:75]
v_mfma_f32_16x16x32_bf16 v[76:79], a[236:239], v[136:139], v[76:79]
s_waitcnt lgkmcnt(1)
v_mfma_f32_16x16x32_bf16 v[64:67], a[176:179], v[140:143], v[64:67]
v_mfma_f32_16x16x32_bf16 v[68:71], a[180:183], v[140:143], v[68:71]
v_mfma_f32_16x16x32_bf16 v[72:75], a[240:243], v[140:143], v[72:75]
v_mfma_f32_16x16x32_bf16 v[76:79], a[244:247], v[140:143], v[76:79]
s_waitcnt lgkmcnt(0)
v_mfma_f32_16x16x32_bf16 v[64:67], a[184:187], v[144:147], v[64:67]
v_mfma_f32_16x16x32_bf16 v[68:71], a[188:191], v[144:147], v[68:71]
v_mfma_f32_16x16x32_bf16 v[72:75], a[248:251], v[144:147], v[72:75]
v_mfma_f32_16x16x32_bf16 v[76:79], a[252:255], v[144:147], v[76:79]
s_waitcnt vmcnt(9)
s_add_u32 s33, s52, 0
buffer_store_dwordx4 v[52:55], v9, s[40:43], s33 offen sc1
s_add_u32 s35, s52, 4096
buffer_store_dwordx4 v[60:63], v9, s[40:43], s35 offen sc1
v_cvt_pk_bf16_f32 v64, v64, v65
v_cvt_pk_bf16_f32 v65, v66, v67
v_cvt_pk_bf16_f32 v66, v68, v69
v_cvt_pk_bf16_f32 v67, v70, v71
ds_write_b128 v32, v[64:67] offset:2048
v_cvt_pk_bf16_f32 v72, v72, v73
v_cvt_pk_bf16_f32 v73, v74, v75
v_cvt_pk_bf16_f32 v74, v76, v77
v_cvt_pk_bf16_f32 v75, v78, v79
ds_write_b128 v33, v[72:75] offset:2048
ds_read_b128 v[68:71], v34 offset:2048
ds_read_b128 v[76:79], v34 offset:3072
ds_read_b128 v[96:99], v46 offset:0
v_lshlrev_b32 v116, 16, v156
v_and_b32 v117, s12, v156
v_lshlrev_b32 v118, 16, v157
v_and_b32 v119, s12, v157
v_lshlrev_b32 v120, 16, v158
v_and_b32 v121, s12, v158
v_lshlrev_b32 v122, 16, v159
v_and_b32 v123, s12, v159
v_pk_mul_f32 v[108:109], v[116:117], v[16:17]
v_pk_mul_f32 v[110:111], v[118:119], v[16:17]
v_pk_mul_f32 v[112:113], v[120:121], v[16:17]
v_pk_mul_f32 v[114:115], v[122:123], v[16:17]
s_waitcnt vmcnt(10)
s_add_u32 s39, s53, 0
s_waitcnt lgkmcnt(2)
buffer_store_dwordx4 v[68:71], v9, s[40:43], s39 offen sc1
s_add_u32 s32, s53, 4096
s_waitcnt lgkmcnt(1)
buffer_store_dwordx4 v[76:79], v9, s[40:43], s32 offen sc1
v_lshlrev_b32 v116, 16, v160
v_and_b32 v117, s12, v160
v_lshlrev_b32 v118, 16, v161
v_and_b32 v119, s12, v161
v_lshlrev_b32 v120, 16, v162
v_and_b32 v121, s12, v162
v_lshlrev_b32 v122, 16, v163
v_and_b32 v123, s12, v163
v_pk_fma_f32 v[108:109], v[116:117], v[18:19], v[108:109]
v_pk_fma_f32 v[110:111], v[118:119], v[18:19], v[110:111]
v_pk_fma_f32 v[112:113], v[120:121], v[18:19], v[112:113]
v_pk_fma_f32 v[114:115], v[122:123], v[18:19], v[114:115]
s_waitcnt vmcnt(11)
v_lshlrev_b32 v116, 16, v164
v_and_b32 v117, s12, v164
v_lshlrev_b32 v118, 16, v165
v_and_b32 v119, s12, v165
v_lshlrev_b32 v120, 16, v166
v_and_b32 v121, s12, v166
v_lshlrev_b32 v122, 16, v167
v_and_b32 v123, s12, v167
v_pk_fma_f32 v[108:109], v[116:117], v[20:21], v[108:109]
v_pk_fma_f32 v[110:111], v[118:119], v[20:21], v[110:111]
v_pk_fma_f32 v[112:113], v[120:121], v[20:21], v[112:113]
v_pk_fma_f32 v[114:115], v[122:123], v[20:21], v[114:115]
s_waitcnt vmcnt(10)
v_lshlrev_b32 v116, 16, v168
v_and_b32 v117, s12, v168
v_lshlrev_b32 v118, 16, v169
v_and_b32 v119, s12, v169
v_lshlrev_b32 v120, 16, v170
v_and_b32 v121, s12, v170
v_lshlrev_b32 v122, 16, v171
v_and_b32 v123, s12, v171
v_pk_fma_f32 v[108:109], v[116:117], v[22:23], v[108:109]
v_pk_fma_f32 v[110:111], v[118:119], v[22:23], v[110:111]
v_pk_fma_f32 v[112:113], v[120:121], v[22:23], v[112:113]
v_pk_fma_f32 v[114:115], v[122:123], v[22:23], v[114:115]
s_waitcnt lgkmcnt(0)
v_lshlrev_b32 v116, 16, v96
v_and_b32 v117, s12, v96
v_lshlrev_b32 v118, 16, v97
v_and_b32 v119, s12, v97
v_lshlrev_b32 v120, 16, v98
v_and_b32 v121, s12, v98
v_lshlrev_b32 v122, 16, v99
v_and_b32 v123, s12, v99
v_pk_fma_f32 v[108:109], v[116:117], v[26:27], v[108:109]
v_pk_fma_f32 v[110:111], v[118:119], v[26:27], v[110:111]
v_pk_fma_f32 v[112:113], v[120:121], v[26:27], v[112:113]
v_pk_fma_f32 v[114:115], v[122:123], v[26:27], v[114:115]
s_waitcnt vmcnt(9)
v_lshlrev_b32 v116, 16, v172
v_and_b32 v117, s12, v172
v_lshlrev_b32 v118, 16, v173
v_and_b32 v119, s12, v173
v_lshlrev_b32 v120, 16, v174
v_and_b32 v121, s12, v174
v_lshlrev_b32 v122, 16, v175
v_and_b32 v123, s12, v175
v_pk_fma_f32 v[108:109], v[116:117], v[24:25], v[108:109]
v_pk_fma_f32 v[110:111], v[118:119], v[24:25], v[110:111]
v_pk_fma_f32 v[112:113], v[120:121], v[24:25], v[112:113]
v_pk_fma_f32 v[114:115], v[122:123], v[24:25], v[114:115]
v_cvt_pk_bf16_f32 v116, v108, v109
v_cvt_pk_bf16_f32 v117, v110, v111
v_cvt_pk_bf16_f32 v118, v112, v113
v_cvt_pk_bf16_f32 v119, v114, v115
ds_write_b128 v38, v[116:119] offset:16384
s_waitcnt vmcnt(8)
ds_read_b128 v[96:99], v46 offset:1024
v_lshlrev_b32 v116, 16, v176
v_and_b32 v117, s12, v176
v_lshlrev_b32 v118, 16, v177
v_and_b32 v119, s12, v177
v_lshlrev_b32 v120, 16, v178
v_and_b32 v121, s12, v178
v_lshlrev_b32 v122, 16, v179
v_and_b32 v123, s12, v179
v_pk_mul_f32 v[108:109], v[116:117], v[16:17]
v_pk_mul_f32 v[110:111], v[118:119], v[16:17]
v_pk_mul_f32 v[112:113], v[120:121], v[16:17]
v_pk_mul_f32 v[114:115], v[122:123], v[16:17]
s_waitcnt vmcnt(7)
v_lshlrev_b32 v116, 16, v180
v_and_b32 v117, s12, v180
v_lshlrev_b32 v118, 16, v181
v_and_b32 v119, s12, v181
v_lshlrev_b32 v120, 16, v182
v_and_b32 v121, s12, v182
v_lshlrev_b32 v122, 16, v183
v_and_b32 v123, s12, v183
v_pk_fma_f32 v[108:109], v[116:117], v[18:19], v[108:109]
v_pk_fma_f32 v[110:111], v[118:119], v[18:19], v[110:111]
v_pk_fma_f32 v[112:113], v[120:121], v[18:19], v[112:113]
v_pk_fma_f32 v[114:115], v[122:123], v[18:19], v[114:115]
s_waitcnt vmcnt(6)
v_lshlrev_b32 v116, 16, v184
v_and_b32 v117, s12, v184
v_lshlrev_b32 v118, 16, v185
v_and_b32 v119, s12, v185
v_lshlrev_b32 v120, 16, v186
v_and_b32 v121, s12, v186
v_lshlrev_b32 v122, 16, v187
v_and_b32 v123, s12, v187
v_pk_fma_f32 v[108:109], v[116:117], v[20:21], v[108:109]
v_pk_fma_f32 v[110:111], v[118:119], v[20:21], v[110:111]
v_pk_fma_f32 v[112:113], v[120:121], v[20:21], v[112:113]
v_pk_fma_f32 v[114:115], v[122:123], v[20:21], v[114:115]
s_waitcnt vmcnt(5)
v_lshlrev_b32 v116, 16, v188
v_and_b32 v117, s12, v188
v_lshlrev_b32 v118, 16, v189
v_and_b32 v119, s12, v189
v_lshlrev_b32 v120, 16, v190
v_and_b32 v121, s12, v190
v_lshlrev_b32 v122, 16, v191
v_and_b32 v123, s12, v191
v_pk_fma_f32 v[108:109], v[116:117], v[22:23], v[108:109]
v_pk_fma_f32 v[110:111], v[118:119], v[22:23], v[110:111]
v_pk_fma_f32 v[112:113], v[120:121], v[22:23], v[112:113]
v_pk_fma_f32 v[114:115], v[122:123], v[22:23], v[114:115]
s_waitcnt lgkmcnt(0)
v_lshlrev_b32 v116, 16, v96
v_and_b32 v117, s12, v96
v_lshlrev_b32 v118, 16, v97
v_and_b32 v119, s12, v97
v_lshlrev_b32 v120, 16, v98
v_and_b32 v121, s12, v98
v_lshlrev_b32 v122, 16, v99
v_and_b32 v123, s12, v99
v_pk_fma_f32 v[108:109], v[116:117], v[26:27], v[108:109]
v_pk_fma_f32 v[110:111], v[118:119], v[26:27], v[110:111]
v_pk_fma_f32 v[112:113], v[120:121], v[26:27], v[112:113]
v_pk_fma_f32 v[114:115], v[122:123], v[26:27], v[114:115]
s_waitcnt vmcnt(4)
v_lshlrev_b32 v116, 16, v192
v_and_b32 v117, s12, v192
v_lshlrev_b32 v118, 16, v193
v_and_b32 v119, s12, v193
v_lshlrev_b32 v120, 16, v194
v_and_b32 v121, s12, v194
v_lshlrev_b32 v122, 16, v195
v_and_b32 v123, s12, v195
v_pk_fma_f32 v[108:109], v[116:117], v[24:25], v[108:109]
v_pk_fma_f32 v[110:111], v[118:119], v[24:25], v[110:111]
v_pk_fma_f32 v[112:113], v[120:121], v[24:25], v[112:113]
v_pk_fma_f32 v[114:115], v[122:123], v[24:25], v[114:115]
v_cvt_pk_bf16_f32 v116, v108, v109
v_cvt_pk_bf16_f32 v117, v110, v111
v_cvt_pk_bf16_f32 v118, v112, v113
v_cvt_pk_bf16_f32 v119, v114, v115
ds_write_b128 v39, v[116:119] offset:16384
s_waitcnt lgkmcnt(0)
s_barrier
ds_read_b128 v[148:151], v15 offset:16384
ds_read_b128 v[152:155], v15 offset:17408
ds_read_b128 v[132:135], v15 offset:18432
ds_read_b128 v[136:139], v15 offset:19456
ds_read_b128 v[140:143], v15 offset:20480
s_waitcnt lgkmcnt(4)
v_mfma_f32_16x16x32_bf16 v[80:83], a[128:131], v[148:151], v[80:83]
ds_read_b128 v[144:147], v15 offset:21504
v_mfma_f32_16x16x32_bf16 v[84:87], a[132:135], v[148:151], v[84:87]
v_mfma_f32_16x16x32_bf16 v[88:91], a[192:195], v[148:151], v[88:91]
v_mfma_f32_16x16x32_bf16 v[92:95], a[196:199], v[148:151], v[92:95]
s_waitcnt lgkmcnt(4)
v_mfma_f32_16x16x32_bf16 v[80:83], a[136:139], v[152:155], v[80:83]
ds_read_b128 v[148:151], v15 offset:22528
v_mfma_f32_16x16x32_bf16 v[84:87], a[140:143], v[152:155], v[84:87]
v_mfma_f32_16x16x32_bf16 v[88:91], a[200:203], v[152:155], v[88:91]
v_mfma_f32_16x16x32_bf16 v[92:95], a[204:207], v[152:155], v[92:95]
s_waitcnt lgkmcnt(4)
v_mfma_f32_16x16x32_bf16 v[80:83], a[144:147], v[132:135], v[80:83]
ds_read_b128 v[152:155], v15 offset:23552
v_mfma_f32_16x16x32_bf16 v[84:87], a[148:151], v[132:135], v[84:87]
v_mfma_f32_16x16x32_bf16 v[88:91], a[208:211], v[132:135], v[88:91]
v_mfma_f32_16x16x32_bf16 v[92:95], a[212:215], v[132:135], v[92:95]
s_waitcnt lgkmcnt(4)
v_mfma_f32_16x16x32_bf16 v[80:83], a[152:155], v[136:139], v[80:83]
v_mfma_f32_16x16x32_bf16 v[84:87], a[156:159], v[136:139], v[84:87]
v_mfma_f32_16x16x32_bf16 v[88:91], a[216:219], v[136:139], v[88:91]
v_mfma_f32_16x16x32_bf16 v[92:95], a[220:223], v[136:139], v[92:95]
s_waitcnt lgkmcnt(3)
v_mfma_f32_16x16x32_bf16 v[80:83], a[160:163], v[140:143], v[80:83]
v_mfma_f32_16x16x32_bf16 v[84:87], a[164:167], v[140:143], v[84:87]
v_mfma_f32_16x16x32_bf16 v[88:91], a[224:227], v[140:143], v[88:91]
v_mfma_f32_16x16x32_bf16 v[92:95], a[228:231], v[140:143], v[92:95]
s_waitcnt lgkmcnt(2)
v_mfma_f32_16x16x32_bf16 v[80:83], a[168:171], v[144:147], v[80:83]
v_mfma_f32_16x16x32_bf16 v[84:87], a[172:175], v[144:147], v[84:87]
v_mfma_f32_16x16x32_bf16 v[88:91], a[232:235], v[144:147], v[88:91]
v_mfma_f32_16x16x32_bf16 v[92:95], a[236:239], v[144:147], v[92:95]
s_waitcnt lgkmcnt(1)
v_mfma_f32_16x16x32_bf16 v[80:83], a[176:179], v[148:151], v[80:83]
v_mfma_f32_16x16x32_bf16 v[84:87], a[180:183], v[148:151], v[84:87]
v_mfma_f32_16x16x32_bf16 v[88:91], a[240:243], v[148:151], v[88:91]
v_mfma_f32_16x16x32_bf16 v[92:95], a[244:247], v[148:151], v[92:95]
s_waitcnt lgkmcnt(0)
v_mfma_f32_16x16x32_bf16 v[80:83], a[184:187], v[152:155], v[80:83]
v_mfma_f32_16x16x32_bf16 v[84:87], a[188:191], v[152:155], v[84:87]
v_mfma_f32_16x16x32_bf16 v[88:91], a[248:251], v[152:155], v[88:91]
v_mfma_f32_16x16x32_bf16 v[92:95], a[252:255], v[152:155], v[92:95]
s_nop 4
v_cvt_pk_bf16_f32 v80, v80, v81
v_cvt_pk_bf16_f32 v81, v82, v83
v_cvt_pk_bf16_f32 v82, v84, v85
v_cvt_pk_bf16_f32 v83, v86, v87
ds_write_b128 v35, v[80:83] offset:0
v_cvt_pk_bf16_f32 v88, v88, v89
v_cvt_pk_bf16_f32 v89, v90, v91
v_cvt_pk_bf16_f32 v90, v92, v93
v_cvt_pk_bf16_f32 v91, v94, v95
ds_write_b128 v36, v[88:91] offset:0
ds_read_b128 v[84:87], v37 offset:0
ds_read_b128 v[92:95], v37 offset:1024
s_add_u32 s33, s54, 0
s_waitcnt lgkmcnt(1)
buffer_store_dwordx4 v[84:87], v9, s[40:43], s33 offen sc1
s_add_u32 s35, s54, 4096
s_waitcnt lgkmcnt(0)
buffer_store_dwordx4 v[92:95], v9, s[40:43], s35 offen sc1
s_branch L2_fin
LC_poll:
s_mov_b32 s36, 0
s_cmp_lt_u32 s98, 2
s_cselect_b32 s33, 0xfff, -1
s_cselect_b32 s35, 6, 0x6
LC_poll2:
s_mov_b32 s70, 0
s_atomic_add s70, s[60:61], s48 glc
s_cmp_lt_u32 s2, 240
s_cbranch_scc1 LC_poll3
s_mov_b32 s71, 0
s_atomic_add s71, s[60:61], s49 glc
s_mov_b32 s72, 0
s_atomic_add s72, s[60:61], s50 glc
s_waitcnt lgkmcnt(0)
s_min_u32 s70, s70, s71
s_min_u32 s70, s70, s72
LC_poll3:
s_waitcnt lgkmcnt(0)
s_and_b32 s70, s70, s33
s_cmp_ge_u32 s70, s35
s_cbranch_scc1 LC_poll4
s_sleep 2
s_add_u32 s36, s36, 1
s_cmp_gt_u32 s36, 0x40000
s_cbranch_scc0 LC_poll2
LC_poll4:
s_cmp_lt_u32 s98, 2
s_cbranch_scc1 LC_got
s_mul_i32 s33, s51, 0x600000
v_readfirstlane_b32 s32, v44
s_add_u32 s35, s33, s52
s_mov_b32 m0, s32
s_nop 0
buffer_load_dwordx4 v10, s[20:23], s35 offen offset:0 sc1 lds
buffer_load_dwordx4 v10, s[20:23], s35 offen offset:1024 sc1 lds
v_readfirstlane_b32 s32, v45
s_add_u32 s35, s33, s53
s_mov_b32 m0, s32
s_nop 0
buffer_load_dwordx4 v10, s[20:23], s35 offen offset:0 sc1 lds
buffer_load_dwordx4 v10, s[20:23], s35 offen offset:1024 sc1 lds
v_readfirstlane_b32 s32, v46
s_add_u32 s35, s33, s54
s_mov_b32 m0, s32
s_nop 0
buffer_load_dwordx4 v10, s[20:23], s35 offen offset:0 sc1 lds
buffer_load_dwordx4 v10, s[20:23], s35 offen offset:1024 sc1 lds
s_waitcnt vmcnt(0)
s_branch LC_got
LC_side:
s_cmp_eq_u32 s14, 1
s_cbranch_scc1 LC_sideok
s_cmp_lt_u32 s2, 240
s_cbranch_scc1 LC_side1
s_barrier
LC_side1:
s_mov_b32 s36, 0
s_mov_b32 s33, 0x6c01400
LC_side2:
buffer_load_dword v1, off, s[56:59], s33 sc1
s_waitcnt vmcnt(0)
v_readfirstlane_b32 s99, v1
s_add_u32 s36, s36, 1
s_cmp_gt_u32 s36, 0x40000
s_cbranch_scc1 LC_side3
s_cmp_ge_u32 s99, 60
s_cbranch_scc1 LC_side3
s_sleep 8
s_branch LC_side2
LC_side3:
s_cmp_lt_u32 s98, 2
s_cbranch_scc1 LC_sideok
s_add_u32 s8, s6, 0x0
s_addc_u32 s9, s7, 0
s_mov_b32 s10, 0x4e2000
s_mov_b32 s11, 0x00020000
s_lshl_b32 s55, s34, 13
s_add_u32 s55, s55, 0x21000
s_lshl_b32 s33, s34, 7
v_bfe_u32 v9, v252, 4, 3
v_lshrrev_b32 v1, 7, v252
v_xor_b32 v9, v9, v1
v_lshl_add_u32 v1, v1, 9, s33
v_lshl_add_u32 v9, v9, 4, v1
s_add_u32 m0, s55, 0
s_add_u32 s39, s52, 0
buffer_load_dwordx4 v9, s[8:11], s39 offen lds
s_add_u32 m0, s55, 1024
s_add_u32 s32, s52, 4096
buffer_load_dwordx4 v9, s[8:11], s32 offen lds
s_add_u32 m0, s55, 2048
s_add_u32 s33, s53, 0
buffer_load_dwordx4 v9, s[8:11], s33 offen lds
s_add_u32 m0, s55, 3072
s_add_u32 s35, s53, 4096
buffer_load_dwordx4 v9, s[8:11], s35 offen lds
s_waitcnt vmcnt(0)
s_branch LC_sideok
LC_slow:
s_waitcnt vmcnt(0) lgkmcnt(0)
s_barrier
s_mov_b32 s50, 0xe1a06800
s_mov_b32 s51, 0x4e608d04
s_mul_i32 s39, s37, 9
s_lshr_b64 s[50:51], s[50:51], s39
s_and_b32 s39, s50, 0x1ff
s_bfe_u32 s49, s50, 0x90009
s_sub_u32 s29, s49, s39
s_lshl_b32 s50, s37, 2
s_lshr_b32 s59, 0x766666, s50
s_and_b32 s59, s59, 15
s_sub_u32 s31, s29, s59
s_lshr_b32 s31, s31, 1
s_sub_u32 s31, s31, 1
s_lshl_b32 s39, s39, 14
s_lshl_b32 s49, s49, 14
s_add_u32 s28, s39, 0x4000
s_cmp_eq_u32 s37, 5
s_cselect_b32 s33, 0xff800000, 0
s_mov_b32 s32, 0xffff
s_add_u32 s12, s4, 0x6800000
s_addc_u32 s13, s5, 0
s_mov_b32 s14, s49
s_mov_b32 s15, 0x00020000
s_add_u32 s8, s4, 0x0
s_addc_u32 s9, s5, 0
s_mov_b32 s10, 0x4e4000
s_mov_b32 s11, 0x00020000
s_mul_i32 s35, s37, 0x600000
s_add_u32 s20, s4, 0x2000000
s_addc_u32 s21, s5, 0
s_add_u32 s20, s20, s35
s_addc_u32 s21, s21, 0
s_mov_b32 s22, 0x4e4000
s_mov_b32 s23, 0x00020000
s_add_u32 s24, s4, 0x6000000
s_addc_u32 s25, s5, 0
s_mov_b32 s26, 0x9c800
s_mov_b32 s27, 0x00020000
s_lshl_b32 s35, s38, 4
s_lshl_b32 s41, s34, 2
s_add_u32 s35, s35, s41
s_lshl_b32 s40, s35, 13
s_lshl_b32 s48, s35, 10
s_lshl_b32 s35, s37, 3
s_add_u32 s48, s48, s35
v_bfe_u32 v248, v252, 4, 3
v_lshlrev_b32 v248, 6, v248
v_bfe_u32 v253, v252, 7, 1
v_lshl_or_b32 v248, v253, 10, v248
v_bfe_u32 v253, v252, 8, 2
v_lshl_or_b32 v248, v253, 4, v248
v_bfe_u32 v253, v252, 6, 1
v_lshlrev_b32 v253, 5, v253
v_xor_b32 v248, v248, v253
v_and_b32 v249, 0x1c0, v252
v_bfe_u32 v253, v252, 9, 1
v_lshl_or_b32 v249, v253, 10, v249
v_bfe_u32 v253, v252, 8, 1
v_lshl_or_b32 v249, v253, 5, v249
v_bfe_u32 v253, v252, 4, 2
v_lshl_or_b32 v249, v253, 3, v249
v_xor_b32 v250, 32, v249
v_and_b32 v251, 0xfffffe7f, v251
s_mul_i32 s36, s34, 0xa000
s_mov_b32 s56, s36
s_add_u32 s57, s56, 32768
s_mov_b32 s55, 4
v_bfe_i32 v188, v252, 8, 1
LS_q:
s_add_u32 s44, s40, 4096
buffer_load_dwordx4 v[0:3], v252, s[8:11], s40 offen offset:0
buffer_load_dwordx4 v[4:7], v252, s[8:11], s40 offen offset:1024
buffer_load_dwordx4 v[8:11], v252, s[8:11], s40 offen offset:2048
buffer_load_dwordx4 v[12:15], v252, s[8:11], s40 offen offset:3072
buffer_load_dwordx4 v[16:19], v252, s[8:11], s44 offen offset:0
buffer_load_dwordx4 v[20:23], v252, s[8:11], s44 offen offset:1024
buffer_load_dwordx4 v[24:27], v252, s[8:11], s44 offen offset:2048
buffer_load_dwordx4 v[28:31], v252, s[8:11], s44 offen offset:3072
s_mov_b32 s53, s56
s_mov_b32 s58, s39
s_add_u32 m0, s53, 0
s_add_u32 s54, s58, 0
buffer_load_dwordx4 v251, s[12:15], s54 offen offset:0 lds
buffer_load_dwordx4 v251, s[12:15], s54 offen offset:1024 lds
buffer_load_dwordx4 v251, s[12:15], s54 offen offset:2048 lds
buffer_load_dwordx4 v251, s[12:15], s54 offen offset:3072 lds
s_add_u32 m0, s53, 4096
s_add_u32 s54, s58, 128
buffer_load_dwordx4 v251, s[12:15], s54 offen offset:0 lds
buffer_load_dwordx4 v251, s[12:15], s54 offen offset:1024 lds
buffer_load_dwordx4 v251, s[12:15], s54 offen offset:2048 lds
buffer_load_dwordx4 v251, s[12:15], s54 offen offset:3072 lds
s_add_u32 m0, s53, 8192
s_add_u32 s54, s58, 256
buffer_load_dwordx4 v251, s[12:15], s54 offen offset:0 lds
buffer_load_dwordx4 v251, s[12:15], s54 offen offset:1024 lds
buffer_load_dwordx4 v251, s[12:15], s54 offen offset:2048 lds
buffer_load_dwordx4 v251, s[12:15], s54 offen offset:3072 lds
s_add_u32 m0, s53, 12288
s_add_u32 s54, s58, 384
buffer_load_dwordx4 v251, s[12:15], s54 offen offset:0 lds
buffer_load_dwordx4 v251, s[12:15], s54 offen offset:1024 lds
buffer_load_dwordx4 v251, s[12:15], s54 offen offset:2048 lds
buffer_load_dwordx4 v251, s[12:15], s54 offen offset:3072 lds
s_add_u32 s53, s53, 0x4000
s_cmp_eq_u32 s53, s57
s_cselect_b32 s53, s56, s53
s_add_u32 s58, s58, 0x4000
s_mov_b32 s51, s29
s_mov_b32 s52, s56
v_mov_b32 v172, 0xff800000
v_accvgpr_write_b32 a0, 0
v_accvgpr_write_b32 a1, 0
v_accvgpr_write_b32 a2, 0
v_accvgpr_write_b32 a3, 0
v_accvgpr_write_b32 a4, 0
v_accvgpr_write_b32 a5, 0
v_accvgpr_write_b32 a6, 0
v_accvgpr_write_b32 a7, 0
v_accvgpr_write_b32 a8, 0
v_accvgpr_write_b32 a9, 0
v_accvgpr_write_b32 a10, 0
v_accvgpr_write_b32 a11, 0
v_accvgpr_write_b32 a12, 0
v_accvgpr_write_b32 a13, 0
v_accvgpr_write_b32 a14, 0
v_accvgpr_write_b32 a15, 0
v_accvgpr_write_b32 a16, 0
v_accvgpr_write_b32 a17, 0
v_accvgpr_write_b32 a18, 0
v_accvgpr_write_b32 a19, 0
v_accvgpr_write_b32 a20, 0
v_accvgpr_write_b32 a21, 0
v_accvgpr_write_b32 a22, 0
v_accvgpr_write_b32 a23, 0
v_accvgpr_write_b32 a24, 0
v_accvgpr_write_b32 a25, 0
v_accvgpr_write_b32 a26, 0
v_accvgpr_write_b32 a27, 0
v_accvgpr_write_b32 a28, 0
v_accvgpr_write_b32 a29, 0
v_accvgpr_write_b32 a30, 0
v_accvgpr_write_b32 a31, 0
v_accvgpr_write_b32 a32, 0
v_accvgpr_write_b32 a33, 0
v_accvgpr_write_b32 a34, 0
v_accvgpr_write_b32 a35, 0
v_accvgpr_write_b32 a36, 0
v_accvgpr_write_b32 a37, 0
v_accvgpr_write_b32 a38, 0
v_accvgpr_write_b32 a39, 0
v_accvgpr_write_b32 a40, 0
v_accvgpr_write_b32 a41, 0
v_accvgpr_write_b32 a42, 0
v_accvgpr_write_b32 a43, 0
v_accvgpr_write_b32 a44, 0
v_accvgpr_write_b32 a45, 0
v_accvgpr_write_b32 a46, 0
v_accvgpr_write_b32 a47, 0
v_accvgpr_write_b32 a48, 0
v_accvgpr_write_b32 a49, 0
v_accvgpr_write_b32 a50, 0
v_accvgpr_write_b32 a51, 0
v_accvgpr_write_b32 a52, 0
v_accvgpr_write_b32 a53, 0
v_accvgpr_write_b32 a54, 0
v_accvgpr_write_b32 a55, 0
v_accvgpr_write_b32 a56, 0
v_accvgpr_write_b32 a57, 0
v_accvgpr_write_b32 a58, 0
v_accvgpr_write_b32 a59, 0
v_accvgpr_write_b32 a60, 0
v_accvgpr_write_b32 a61, 0
v_accvgpr_write_b32 a62, 0
v_accvgpr_write_b32 a63, 0
LS_loop:
s_add_u32 m0, s53, 0
s_add_u32 s54, s58, 0
buffer_load_dwordx4 v251, s[12:15], s54 offen offset:0 lds
buffer_load_dwordx4 v251, s[12:15], s54 offen offset:1024 lds
buffer_load_dwordx4 v251, s[12:15], s54 offen offset:2048 lds
buffer_load_dwordx4 v251, s[12:15], s54 offen offset:3072 lds
s_add_u32 m0, s53, 4096
s_add_u32 s54, s58, 128
buffer_load_dwordx4 v251, s[12:15], s54 offen offset:0 lds
buffer_load_dwordx4 v251, s[12:15], s54 offen offset:1024 lds
buffer_load_dwordx4 v251, s[12:15], s54 offen offset:2048 lds
buffer_load_dwordx4 v251, s[12:15], s54 offen offset:3072 lds
s_add_u32 m0, s53, 8192
s_add_u32 s54, s58, 256
buffer_load_dwordx4 v251, s[12:15], s54 offen offset:0 lds
buffer_load_dwordx4 v251, s[12:15], s54 offen offset:1024 lds
buffer_load_dwordx4 v251, s[12:15], s54 offen offset:2048 lds
buffer_load_dwordx4 v251, s[12:15], s54 offen offset:3072 lds
s_add_u32 m0, s53, 12288
s_add_u32 s54, s58, 384
buffer_load_dwordx4 v251, s[12:15], s54 offen offset:0 lds
buffer_load_dwordx4 v251, s[12:15], s54 offen offset:1024 lds
buffer_load_dwordx4 v251, s[12:15], s54 offen offset:2048 lds
buffer_load_dwordx4 v251, s[12:15], s54 offen offset:3072 lds
s_add_u32 s53, s53, 0x4000
s_cmp_eq_u32 s53, s57
s_cselect_b32 s53, s56, s53
s_add_u32 s58, s58, 0x4000
v_add_u32 v177, s52, v248
v_add_u32 v178, s52, v249
v_add_u32 v179, s52, v250
s_add_u32 s52, s52, 0x4000
s_cmp_eq_u32 s52, s57
s_cselect_b32 s52, s56, s52
s_cmp_eq_u32 s51, 1
s_cselect_b32 s54, s33, 0
v_and_b32 v192, s54, v188
v_and_b32 v193, s54, v188
v_and_b32 v194, s54, v188
v_and_b32 v195, s54, v188
s_waitcnt vmcnt(16)
ds_read_b128 v[32:35], v177 offset:0
ds_read_b128 v[64:67], v177 offset:2048
ds_read_b128 v[36:39], v177 offset:512
ds_read_b128 v[68:71], v177 offset:2560
ds_read_b128 v[40:43], v177 offset:4096
ds_read_b128 v[72:75], v177 offset:6144
ds_read_b128 v[44:47], v177 offset:4608
ds_read_b128 v[76:79], v177 offset:6656
ds_read_b128 v[48:51], v177 offset:8192
ds_read_b128 v[80:83], v177 offset:10240
ds_read_b128 v[52:55], v177 offset:8704
ds_read_b128 v[84:87], v177 offset:10752
ds_read_b128 v[56:59], v177 offset:12288
ds_read_b128 v[88:91], v177 offset:14336
ds_read_b128 v[60:63], v177 offset:12800
ds_read_b128 v[92:95], v177 offset:14848
s_waitcnt lgkmcnt(14)
v_mfma_f32_16x16x32_bf16 v[160:163], v[32:35], v[0:3], v[192:195]
v_mfma_f32_16x16x32_bf16 v[164:167], v[64:67], v[0:3], v[192:195]
s_waitcnt lgkmcnt(12)
v_mfma_f32_16x16x32_bf16 v[160:163], v[36:39], v[4:7], v[160:163]
v_mfma_f32_16x16x32_bf16 v[164:167], v[68:71], v[4:7], v[164:167]
s_waitcnt lgkmcnt(10)
v_mfma_f32_16x16x32_bf16 v[160:163], v[40:43], v[8:11], v[160:163]
v_mfma_f32_16x16x32_bf16 v[164:167], v[72:75], v[8:11], v[164:167]
s_waitcnt lgkmcnt(8)
v_mfma_f32_16x16x32_bf16 v[160:163], v[44:47], v[12:15], v[160:163]
v_mfma_f32_16x16x32_bf16 v[164:167], v[76:79], v[12:15], v[164:167]
s_waitcnt lgkmcnt(6)
v_mfma_f32_16x16x32_bf16 v[160:163], v[48:51], v[16:19], v[160:163]
v_mfma_f32_16x16x32_bf16 v[164:167], v[80:83], v[16:19], v[164:167]
s_waitcnt lgkmcnt(4)
v_mfma_f32_16x16x32_bf16 v[160:163], v[52:55], v[20:23], v[160:163]
v_mfma_f32_16x16x32_bf16 v[164:167], v[84:87], v[20:23], v[164:167]
s_waitcnt lgkmcnt(2)
v_mfma_f32_16x16x32_bf16 v[160:163], v[56:59], v[24:27], v[160:163]
v_mfma_f32_16x16x32_bf16 v[164:167], v[88:91], v[24:27], v[164:167]
s_waitcnt lgkmcnt(0)
v_mfma_f32_16x16x32_bf16 v[160:163], v[60:63], v[28:31], v[160:163]
v_mfma_f32_16x16x32_bf16 v[164:167], v[92:95], v[28:31], v[164:167]
ds_read_b64_tr_b16 v[96:97], v178 offset:0
ds_read_b64_tr_b16 v[98:99], v178 offset:2048
ds_read_b64_tr_b16 v[100:101], v179 offset:0
ds_read_b64_tr_b16 v[102:103], v179 offset:2048
ds_read_b64_tr_b16 v[104:105], v178 offset:512
ds_read_b64_tr_b16 v[106:107], v178 offset:2560
ds_read_b64_tr_b16 v[108:109], v179 offset:512
ds_read_b64_tr_b16 v[110:111], v179 offset:2560
ds_read_b64_tr_b16 v[112:113], v178 offset:4096
ds_read_b64_tr_b16 v[114:115], v178 offset:6144
ds_read_b64_tr_b16 v[116:117], v179 offset:4096
ds_read_b64_tr_b16 v[118:119], v179 offset:6144
ds_read_b64_tr_b16 v[120:121], v178 offset:4608
ds_read_b64_tr_b16 v[122:123], v178 offset:6656
ds_read_b64_tr_b16 v[124:125], v179 offset:4608
ds_read_b64_tr_b16 v[126:127], v179 offset:6656
ds_read_b64_tr_b16 v[128:129], v178 offset:8192
ds_read_b64_tr_b16 v[130:131], v178 offset:10240
ds_read_b64_tr_b16 v[132:133], v179 offset:8192
ds_read_b64_tr_b16 v[134:135], v179 offset:10240
ds_read_b64_tr_b16 v[136:137], v178 offset:8704
ds_read_b64_tr_b16 v[138:139], v178 offset:10752
ds_read_b64_tr_b16 v[140:141], v179 offset:8704
ds_read_b64_tr_b16 v[142:143], v179 offset:10752
ds_read_b64_tr_b16 v[144:145], v178 offset:12288
ds_read_b64_tr_b16 v[146:147], v178 offset:14336
ds_read_b64_tr_b16 v[148:149], v179 offset:12288
ds_read_b64_tr_b16 v[150:151], v179 offset:14336
ds_read_b64_tr_b16 v[152:153], v178 offset:12800
ds_read_b64_tr_b16 v[154:155], v178 offset:14848
ds_read_b64_tr_b16 v[156:157], v179 offset:12800
ds_read_b64_tr_b16 v[158:159], v179 offset:14848
s_nop 7
v_max3_f32 v175, v160, v161, v162
v_max3_f32 v175, v175, v163, v164
v_max3_f32 v175, v175, v165, v166
v_max3_f32 v175, v175, v167, v172
v_mov_b32 v176, v175
s_nop 1
v_permlane32_swap_b32 v175, v176
s_nop 1
v_max_f32 v175, v175, v176
v_mov_b32 v176, v175
s_nop 1
v_permlane16_swap_b32 v175, v176
s_nop 1
v_max_f32 v175, v175, v176
v_sub_f32 v174, v172, v175
v_exp_f32 v174, v174
v_mov_b32 v172, v175
v_sub_f32 v160, v160, v172
v_sub_f32 v161, v161, v172
v_sub_f32 v162, v162, v172
v_sub_f32 v163, v163, v172
v_sub_f32 v164, v164, v172
v_sub_f32 v165, v165, v172
v_sub_f32 v166, v166, v172
v_sub_f32 v167, v167, v172
v_exp_f32 v160, v160
v_exp_f32 v161, v161
v_exp_f32 v162, v162
v_exp_f32 v163, v163
v_exp_f32 v164, v164
v_exp_f32 v165, v165
v_exp_f32 v166, v166
v_exp_f32 v167, v167
v_cmp_neq_f32 vcc, 1.0, v174
v_cvt_pk_bf16_f32 v168, v160, v161
v_cvt_pk_bf16_f32 v169, v162, v163
v_cvt_pk_bf16_f32 v170, v164, v165
v_cvt_pk_bf16_f32 v171, v166, v167
s_cbranch_vccz LS_nors
v_accvgpr_read_b32 v180, a0
v_accvgpr_read_b32 v181, a1
v_accvgpr_read_b32 v182, a2
v_accvgpr_read_b32 v183, a3
v_accvgpr_read_b32 v184, a4
v_accvgpr_read_b32 v185, a5
v_accvgpr_read_b32 v186, a6
v_accvgpr_read_b32 v187, a7
v_mul_f32 v180, v180, v174
v_mul_f32 v181, v181, v174
v_mul_f32 v182, v182, v174
v_mul_f32 v183, v183, v174
v_mul_f32 v184, v184, v174
v_mul_f32 v185, v185, v174
v_mul_f32 v186, v186, v174
v_mul_f32 v187, v187, v174
v_accvgpr_write_b32 a0, v180
v_accvgpr_write_b32 a1, v181
v_accvgpr_write_b32 a2, v182
v_accvgpr_write_b32 a3, v183
v_accvgpr_write_b32 a4, v184
v_accvgpr_write_b32 a5, v185
v_accvgpr_write_b32 a6, v186
v_accvgpr_write_b32 a7, v187
v_accvgpr_read_b32 v180, a8
v_accvgpr_read_b32 v181, a9
v_accvgpr_read_b32 v182, a10
v_accvgpr_read_b32 v183, a11
v_accvgpr_read_b32 v184, a12
v_accvgpr_read_b32 v185, a13
v_accvgpr_read_b32 v186, a14
v_accvgpr_read_b32 v187, a15
v_mul_f32 v180, v180, v174
v_mul_f32 v181, v181, v174
v_mul_f32 v182, v182, v174
v_mul_f32 v183, v183, v174
v_mul_f32 v184, v184, v174
v_mul_f32 v185, v185, v174
v_mul_f32 v186, v186, v174
v_mul_f32 v187, v187, v174
v_accvgpr_write_b32 a8, v180
v_accvgpr_write_b32 a9, v181
v_accvgpr_write_b32 a10, v182
v_accvgpr_write_b32 a11, v183
v_accvgpr_write_b32 a12, v184
v_accvgpr_write_b32 a13, v185
v_accvgpr_write_b32 a14, v186
v_accvgpr_write_b32 a15, v187
v_accvgpr_read_b32 v180, a16
v_accvgpr_read_b32 v181, a17
v_accvgpr_read_b32 v182, a18
v_accvgpr_read_b32 v183, a19
v_accvgpr_read_b32 v184, a20
v_accvgpr_read_b32 v185, a21
v_accvgpr_read_b32 v186, a22
v_accvgpr_read_b32 v187, a23
v_mul_f32 v180, v180, v174
v_mul_f32 v181, v181, v174
v_mul_f32 v182, v182, v174
v_mul_f32 v183, v183, v174
v_mul_f32 v184, v184, v174
v_mul_f32 v185, v185, v174
v_mul_f32 v186, v186, v174
v_mul_f32 v187, v187, v174
v_accvgpr_write_b32 a16, v180
v_accvgpr_write_b32 a17, v181
v_accvgpr_write_b32 a18, v182
v_accvgpr_write_b32 a19, v183
v_accvgpr_write_b32 a20, v184
v_accvgpr_write_b32 a21, v185
v_accvgpr_write_b32 a22, v186
v_accvgpr_write_b32 a23, v187
v_accvgpr_read_b32 v180, a24
v_accvgpr_read_b32 v181, a25
v_accvgpr_read_b32 v182, a26
v_accvgpr_read_b32 v183, a27
v_accvgpr_read_b32 v184, a28
v_accvgpr_read_b32 v185, a29
v_accvgpr_read_b32 v186, a30
v_accvgpr_read_b32 v187, a31
v_mul_f32 v180, v180, v174
v_mul_f32 v181, v181, v174
v_mul_f32 v182, v182, v174
v_mul_f32 v183, v183, v174
v_mul_f32 v184, v184, v174
v_mul_f32 v185, v185, v174
v_mul_f32 v186, v186, v174
v_mul_f32 v187, v187, v174
v_accvgpr_write_b32 a24, v180
v_accvgpr_write_b32 a25, v181
v_accvgpr_write_b32 a26, v182
v_accvgpr_write_b32 a27, v183
v_accvgpr_write_b32 a28, v184
v_accvgpr_write_b32 a29, v185
v_accvgpr_write_b32 a30, v186
v_accvgpr_write_b32 a31, v187
v_accvgpr_read_b32 v180, a32
v_accvgpr_read_b32 v181, a33
v_accvgpr_read_b32 v182, a34
v_accvgpr_read_b32 v183, a35
v_accvgpr_read_b32 v184, a36
v_accvgpr_read_b32 v185, a37
v_accvgpr_read_b32 v186, a38
v_accvgpr_read_b32 v187, a39
v_mul_f32 v180, v180, v174
v_mul_f32 v181, v181, v174
v_mul_f32 v182, v182, v174
v_mul_f32 v183, v183, v174
v_mul_f32 v184, v184, v174
v_mul_f32 v185, v185, v174
v_mul_f32 v186, v186, v174
v_mul_f32 v187, v187, v174
v_accvgpr_write_b32 a32, v180
v_accvgpr_write_b32 a33, v181
v_accvgpr_write_b32 a34, v182
v_accvgpr_write_b32 a35, v183
v_accvgpr_write_b32 a36, v184
v_accvgpr_write_b32 a37, v185
v_accvgpr_write_b32 a38, v186
v_accvgpr_write_b32 a39, v187
v_accvgpr_read_b32 v180, a40
v_accvgpr_read_b32 v181, a41
v_accvgpr_read_b32 v182, a42
v_accvgpr_read_b32 v183, a43
v_accvgpr_read_b32 v184, a44
v_accvgpr_read_b32 v185, a45
v_accvgpr_read_b32 v186, a46
v_accvgpr_read_b32 v187, a47
v_mul_f32 v180, v180, v174
v_mul_f32 v181, v181, v174
v_mul_f32 v182, v182, v174
v_mul_f32 v183, v183, v174
v_mul_f32 v184, v184, v174
v_mul_f32 v185, v185, v174
v_mul_f32 v186, v186, v174
v_mul_f32 v187, v187, v174
v_accvgpr_write_b32 a40, v180
v_accvgpr_write_b32 a41, v181
v_accvgpr_write_b32 a42, v182
v_accvgpr_write_b32 a43, v183
v_accvgpr_write_b32 a44, v184
v_accvgpr_write_b32 a45, v185
v_accvgpr_write_b32 a46, v186
v_accvgpr_write_b32 a47, v187
v_accvgpr_read_b32 v180, a48
v_accvgpr_read_b32 v181, a49
v_accvgpr_read_b32 v182, a50
v_accvgpr_read_b32 v183, a51
v_accvgpr_read_b32 v184, a52
v_accvgpr_read_b32 v185, a53
v_accvgpr_read_b32 v186, a54
v_accvgpr_read_b32 v187, a55
v_mul_f32 v180, v180, v174
v_mul_f32 v181, v181, v174
v_mul_f32 v182, v182, v174
v_mul_f32 v183, v183, v174
v_mul_f32 v184, v184, v174
v_mul_f32 v185, v185, v174
v_mul_f32 v186, v186, v174
v_mul_f32 v187, v187, v174
v_accvgpr_write_b32 a48, v180
v_accvgpr_write_b32 a49, v181
v_accvgpr_write_b32 a50, v182
v_accvgpr_write_b32 a51, v183
v_accvgpr_write_b32 a52, v184
v_accvgpr_write_b32 a53, v185
v_accvgpr_write_b32 a54, v186
v_accvgpr_write_b32 a55, v187
v_accvgpr_read_b32 v180, a56
v_accvgpr_read_b32 v181, a57
v_accvgpr_read_b32 v182, a58
v_accvgpr_read_b32 v183, a59
v_accvgpr_read_b32 v184, a60
v_accvgpr_read_b32 v185, a61
v_accvgpr_read_b32 v186, a62
v_accvgpr_read_b32 v187, a63
v_mul_f32 v180, v180, v174
v_mul_f32 v181, v181, v174
v_mul_f32 v182, v182, v174
v_mul_f32 v183, v183, v174
v_mul_f32 v184, v184, v174
v_mul_f32 v185, v185, v174
v_mul_f32 v186, v186, v174
v_mul_f32 v187, v187, v174
v_accvgpr_write_b32 a56, v180
v_accvgpr_write_b32 a57, v181
v_accvgpr_write_b32 a58, v182
v_accvgpr_write_b32 a59, v183
v_accvgpr_write_b32 a60, v184
v_accvgpr_write_b32 a61, v185
v_accvgpr_write_b32 a62, v186
v_accvgpr_write_b32 a63, v187
LS_nors:
s_waitcnt lgkmcnt(0)
s_nop 1
v_mfma_f32_16x16x32_bf16 a[0:3], v[96:99], v[168:171], a[0:3]
v_mfma_f32_16x16x32_bf16 a[4:7], v[100:103], v[168:171], a[4:7]
v_mfma_f32_16x16x32_bf16 a[8:11], v[104:107], v[168:171], a[8:11]
v_mfma_f32_16x16x32_bf16 a[12:15], v[108:111], v[168:171], a[12:15]
v_mfma_f32_16x16x32_bf16 a[16:19], v[112:115], v[168:171], a[16:19]
v_mfma_f32_16x16x32_bf16 a[20:23], v[116:119], v[168:171], a[20:23]
v_mfma_f32_16x16x32_bf16 a[24:27], v[120:123], v[168:171], a[24:27]
v_mfma_f32_16x16x32_bf16 a[28:31], v[124:127], v[168:171], a[28:31]
v_mfma_f32_16x16x32_bf16 a[32:35], v[128:131], v[168:171], a[32:35]
v_mfma_f32_16x16x32_bf16 a[36:39], v[132:135], v[168:171], a[36:39]
v_mfma_f32_16x16x32_bf16 a[40:43], v[136:139], v[168:171], a[40:43]
v_mfma_f32_16x16x32_bf16 a[44:47], v[140:143], v[168:171], a[44:47]
v_mfma_f32_16x16x32_bf16 a[48:51], v[144:147], v[168:171], a[48:51]
v_mfma_f32_16x16x32_bf16 a[52:55], v[148:151], v[168:171], a[52:55]
v_mfma_f32_16x16x32_bf16 a[56:59], v[152:155], v[168:171], a[56:59]
v_mfma_f32_16x16x32_bf16 a[60:63], v[156:159], v[168:171], a[60:63]
s_sub_u32 s51, s51, 1
s_cmp_lg_u32 s51, 0
s_cbranch_scc1 LS_loop
s_nop 15
v_accvgpr_read_b32 v173, a0
v_accvgpr_read_b32 v180, a0
v_accvgpr_read_b32 v181, a1
v_accvgpr_read_b32 v182, a2
v_accvgpr_read_b32 v183, a3
v_accvgpr_read_b32 v184, a4
v_accvgpr_read_b32 v185, a5
v_accvgpr_read_b32 v186, a6
v_accvgpr_read_b32 v187, a7
v_cvt_pk_bf16_f32 v32, v180, v181
v_cvt_pk_bf16_f32 v33, v182, v183
v_cvt_pk_bf16_f32 v34, v184, v185
v_cvt_pk_bf16_f32 v35, v186, v187
buffer_store_dwordx4 v[32:35], v252, s[20:23], s40 offen offset:0 sc1
v_accvgpr_read_b32 v180, a8
v_accvgpr_read_b32 v181, a9
v_accvgpr_read_b32 v182, a10
v_accvgpr_read_b32 v183, a11
v_accvgpr_read_b32 v184, a12
v_accvgpr_read_b32 v185, a13
v_accvgpr_read_b32 v186, a14
v_accvgpr_read_b32 v187, a15
v_cvt_pk_bf16_f32 v36, v180, v181
v_cvt_pk_bf16_f32 v37, v182, v183
v_cvt_pk_bf16_f32 v38, v184, v185
v_cvt_pk_bf16_f32 v39, v186, v187
buffer_store_dwordx4 v[36:39], v252, s[20:23], s40 offen offset:1024 sc1
v_accvgpr_read_b32 v180, a16
v_accvgpr_read_b32 v181, a17
v_accvgpr_read_b32 v182, a18
v_accvgpr_read_b32 v183, a19
v_accvgpr_read_b32 v184, a20
v_accvgpr_read_b32 v185, a21
v_accvgpr_read_b32 v186, a22
v_accvgpr_read_b32 v187, a23
v_cvt_pk_bf16_f32 v40, v180, v181
v_cvt_pk_bf16_f32 v41, v182, v183
v_cvt_pk_bf16_f32 v42, v184, v185
v_cvt_pk_bf16_f32 v43, v186, v187
buffer_store_dwordx4 v[40:43], v252, s[20:23], s40 offen offset:2048 sc1
v_accvgpr_read_b32 v180, a24
v_accvgpr_read_b32 v181, a25
v_accvgpr_read_b32 v182, a26
v_accvgpr_read_b32 v183, a27
v_accvgpr_read_b32 v184, a28
v_accvgpr_read_b32 v185, a29
v_accvgpr_read_b32 v186, a30
v_accvgpr_read_b32 v187, a31
v_cvt_pk_bf16_f32 v44, v180, v181
v_cvt_pk_bf16_f32 v45, v182, v183
v_cvt_pk_bf16_f32 v46, v184, v185
v_cvt_pk_bf16_f32 v47, v186, v187
buffer_store_dwordx4 v[44:47], v252, s[20:23], s40 offen offset:3072 sc1
v_accvgpr_read_b32 v180, a32
v_accvgpr_read_b32 v181, a33
v_accvgpr_read_b32 v182, a34
v_accvgpr_read_b32 v183, a35
v_accvgpr_read_b32 v184, a36
v_accvgpr_read_b32 v185, a37
v_accvgpr_read_b32 v186, a38
v_accvgpr_read_b32 v187, a39
v_cvt_pk_bf16_f32 v48, v180, v181
v_cvt_pk_bf16_f32 v49, v182, v183
v_cvt_pk_bf16_f32 v50, v184, v185
v_cvt_pk_bf16_f32 v51, v186, v187
buffer_store_dwordx4 v[48:51], v252, s[20:23], s44 offen offset:0 sc1
v_accvgpr_read_b32 v180, a40
v_accvgpr_read_b32 v181, a41
v_accvgpr_read_b32 v182, a42
v_accvgpr_read_b32 v183, a43
v_accvgpr_read_b32 v184, a44
v_accvgpr_read_b32 v185, a45
v_accvgpr_read_b32 v186, a46
v_accvgpr_read_b32 v187, a47
v_cvt_pk_bf16_f32 v52, v180, v181
v_cvt_pk_bf16_f32 v53, v182, v183
v_cvt_pk_bf16_f32 v54, v184, v185
v_cvt_pk_bf16_f32 v55, v186, v187
buffer_store_dwordx4 v[52:55], v252, s[20:23], s44 offen offset:1024 sc1
v_accvgpr_read_b32 v180, a48
v_accvgpr_read_b32 v181, a49
v_accvgpr_read_b32 v182, a50
v_accvgpr_read_b32 v183, a51
v_accvgpr_read_b32 v184, a52
v_accvgpr_read_b32 v185, a53
v_accvgpr_read_b32 v186, a54
v_accvgpr_read_b32 v187, a55
v_cvt_pk_bf16_f32 v56, v180, v181
v_cvt_pk_bf16_f32 v57, v182, v183
v_cvt_pk_bf16_f32 v58, v184, v185
v_cvt_pk_bf16_f32 v59, v186, v187
buffer_store_dwordx4 v[56:59], v252, s[20:23], s44 offen offset:2048 sc1
v_accvgpr_read_b32 v180, a56
v_accvgpr_read_b32 v181, a57
v_accvgpr_read_b32 v182, a58
v_accvgpr_read_b32 v183, a59
v_accvgpr_read_b32 v184, a60
v_accvgpr_read_b32 v185, a61
v_accvgpr_read_b32 v186, a62
v_accvgpr_read_b32 v187, a63
v_cvt_pk_bf16_f32 v60, v180, v181
v_cvt_pk_bf16_f32 v61, v182, v183
v_cvt_pk_bf16_f32 v62, v184, v185
v_cvt_pk_bf16_f32 v63, v186, v187
buffer_store_dwordx4 v[60:63], v252, s[20:23], s44 offen offset:3072 sc1
v_lshlrev_b32 v175, 2, v252
s_mov_b64 exec, 0xffff
buffer_store_dwordx2 v[172:173], v175, s[24:27], s48 offen sc1
s_mov_b64 exec, -1
s_waitcnt vmcnt(0)
s_add_u32 s40, s40, 8192
s_add_u32 s48, s48, 1024
s_sub_u32 s55, s55, 1
s_cmp_lg_u32 s55, 0
s_cbranch_scc1 LS_q
s_barrier
s_add_u32 s56, s4, 0x1000000
s_addc_u32 s57, s5, 0
s_mov_b32 s58, 0x6c02000
s_mov_b32 s59, 0x00020000
s_mul_i32 s35, s37, 3
s_and_b32 s36, s35, 3
s_lshl_b32 s36, s36, 2
s_lshr_b32 s52, s35, 2
s_add_u32 s36, s36, s52
s_lshl_b32 s52, s38, 4
s_add_u32 s52, s52, s36
s_lshl_b32 s52, s52, 13
s_add_u32 s35, s35, 1
s_and_b32 s36, s35, 3
s_lshl_b32 s36, s36, 2
s_lshr_b32 s53, s35, 2
s_add_u32 s36, s36, s53
s_lshl_b32 s53, s38, 4
s_add_u32 s53, s53, s36
s_lshl_b32 s53, s53, 13
s_add_u32 s35, s35, 1
s_and_b32 s36, s35, 3
s_lshl_b32 s36, s36, 2
s_lshr_b32 s54, s35, 2
s_add_u32 s36, s36, s54
s_lshl_b32 s54, s38, 4
s_add_u32 s54, s54, s36
s_lshl_b32 s54, s54, 13
s_mov_b32 s99, 0
s_mov_b32 s98, 2
s_branch LC_again
LT_disp:
s_cmp_eq_u32 s34, 0
s_cbranch_scc1 LT_start
s_mov_b32 s41, s34
s_mul_i32 s40, s34, 6
s_add_u32 s40, s40, s37
s_add_u32 s40, s40, 42
s_cmp_lt_u32 s40, 60
s_cbranch_scc1 LE_common
s_branch L2_end
LT_start:
s_waitcnt lgkmcnt(0)
s_add_u32 s12, s4, 0x6800000
s_addc_u32 s13, s5, 0
s_mov_b32 s14, s49
s_mov_b32 s15, 0x00020000
s_add_u32 s8, s4, 0x0
s_addc_u32 s9, s5, 0
s_mov_b32 s10, 0x4e4000
s_mov_b32 s11, 0x00020000
s_mul_i32 s35, s37, 0x600000
s_add_u32 s20, s4, 0x2000000
s_addc_u32 s21, s5, 0
s_add_u32 s20, s20, s35
s_addc_u32 s21, s21, 0
s_mov_b32 s22, 0x4e4000
s_mov_b32 s23, 0x00020000
s_add_u32 s24, s4, 0x6000000
s_addc_u32 s25, s5, 0
s_mov_b32 s26, 0x9c800
s_mov_b32 s27, 0x00020000
s_lshl_b32 s35, s38, 4
s_lshl_b32 s41, s34, 2
s_add_u32 s35, s35, s41
s_lshl_b32 s40, s35, 13
s_lshl_b32 s48, s35, 10
s_lshl_b32 s35, s37, 3
s_add_u32 s48, s48, s35
v_bfe_u32 v248, v252, 4, 3
v_lshlrev_b32 v248, 6, v248
v_bfe_u32 v253, v252, 7, 1
v_lshl_or_b32 v248, v253, 10, v248
v_bfe_u32 v253, v252, 8, 2
v_lshl_or_b32 v248, v253, 4, v248
v_bfe_u32 v253, v252, 6, 1
v_lshlrev_b32 v253, 5, v253
v_xor_b32 v248, v248, v253
v_and_b32 v249, 0x1c0, v252
v_bfe_u32 v253, v252, 9, 1
v_lshl_or_b32 v249, v253, 10, v249
v_bfe_u32 v253, v252, 8, 1
v_lshl_or_b32 v249, v253, 5, v249
v_bfe_u32 v253, v252, 4, 2
v_lshl_or_b32 v249, v253, 3, v249
v_xor_b32 v250, 32, v249
s_mov_b32 s56, 90112
s_add_u32 s57, s56, 65536
s_mov_b32 s55, 1
v_bfe_i32 v188, v252, 8, 1
LT_q:
s_add_u32 s44, s40, 4096
buffer_load_dwordx4 v[0:3], v252, s[8:11], s40 offen offset:0
buffer_load_dwordx4 v[4:7], v252, s[8:11], s40 offen offset:1024
buffer_load_dwordx4 v[8:11], v252, s[8:11], s40 offen offset:2048
buffer_load_dwordx4 v[12:15], v252, s[8:11], s40 offen offset:3072
buffer_load_dwordx4 v[16:19], v252, s[8:11], s44 offen offset:0
buffer_load_dwordx4 v[20:23], v252, s[8:11], s44 offen offset:1024
buffer_load_dwordx4 v[24:27], v252, s[8:11], s44 offen offset:2048
buffer_load_dwordx4 v[28:31], v252, s[8:11], s44 offen offset:3072
s_mov_b32 s53, s56
s_mov_b32 s58, s39
s_add_u32 m0, s53, 0
s_add_u32 s54, s58, 0
buffer_load_dwordx4 v251, s[12:15], s54 offen offset:0 lds
buffer_load_dwordx4 v251, s[12:15], s54 offen offset:1024 lds
buffer_load_dwordx4 v251, s[12:15], s54 offen offset:2048 lds
buffer_load_dwordx4 v251, s[12:15], s54 offen offset:3072 lds
s_add_u32 m0, s53, 4096
s_add_u32 s54, s58, 128
buffer_load_dwordx4 v251, s[12:15], s54 offen offset:0 lds
buffer_load_dwordx4 v251, s[12:15], s54 offen offset:1024 lds
buffer_load_dwordx4 v251, s[12:15], s54 offen offset:2048 lds
buffer_load_dwordx4 v251, s[12:15], s54 offen offset:3072 lds
s_add_u32 m0, s53, 8192
s_add_u32 s54, s58, 256
buffer_load_dwordx4 v251, s[12:15], s54 offen offset:0 lds
buffer_load_dwordx4 v251, s[12:15], s54 offen offset:1024 lds
buffer_load_dwordx4 v251, s[12:15], s54 offen offset:2048 lds
buffer_load_dwordx4 v251, s[12:15], s54 offen offset:3072 lds
s_add_u32 m0, s53, 12288
s_add_u32 s54, s58, 384
buffer_load_dwordx4 v251, s[12:15], s54 offen offset:0 lds
buffer_load_dwordx4 v251, s[12:15], s54 offen offset:1024 lds
buffer_load_dwordx4 v251, s[12:15], s54 offen offset:2048 lds
buffer_load_dwordx4 v251, s[12:15], s54 offen offset:3072 lds
s_add_u32 s53, s53, 0x4000
s_cmp_eq_u32 s53, s57
s_cselect_b32 s53, s56, s53
s_add_u32 s58, s58, 0x4000
s_add_u32 m0, s53, 0
s_add_u32 s54, s58, 0
buffer_load_dwordx4 v251, s[12:15], s54 offen offset:0 lds
buffer_load_dwordx4 v251, s[12:15], s54 offen offset:1024 lds
buffer_load_dwordx4 v251, s[12:15], s54 offen offset:2048 lds
buffer_load_dwordx4 v251, s[12:15], s54 offen offset:3072 lds
s_add_u32 m0, s53, 4096
s_add_u32 s54, s58, 128
buffer_load_dwordx4 v251, s[12:15], s54 offen offset:0 lds
buffer_load_dwordx4 v251, s[12:15], s54 offen offset:1024 lds
buffer_load_dwordx4 v251, s[12:15], s54 offen offset:2048 lds
buffer_load_dwordx4 v251, s[12:15], s54 offen offset:3072 lds
s_add_u32 m0, s53, 8192
s_add_u32 s54, s58, 256
buffer_load_dwordx4 v251, s[12:15], s54 offen offset:0 lds
buffer_load_dwordx4 v251, s[12:15], s54 offen offset:1024 lds
buffer_load_dwordx4 v251, s[12:15], s54 offen offset:2048 lds
buffer_load_dwordx4 v251, s[12:15], s54 offen offset:3072 lds
s_add_u32 m0, s53, 12288
s_add_u32 s54, s58, 384
buffer_load_dwordx4 v251, s[12:15], s54 offen offset:0 lds
buffer_load_dwordx4 v251, s[12:15], s54 offen offset:1024 lds
buffer_load_dwordx4 v251, s[12:15], s54 offen offset:2048 lds
buffer_load_dwordx4 v251, s[12:15], s54 offen offset:3072 lds
s_add_u32 s53, s53, 0x4000
s_cmp_eq_u32 s53, s57
s_cselect_b32 s53, s56, s53
s_add_u32 s58, s58, 0x4000
s_add_u32 m0, s53, 0
s_add_u32 s54, s58, 0
buffer_load_dwordx4 v251, s[12:15], s54 offen offset:0 lds
buffer_load_dwordx4 v251, s[12:15], s54 offen offset:1024 lds
buffer_load_dwordx4 v251, s[12:15], s54 offen offset:2048 lds
buffer_load_dwordx4 v251, s[12:15], s54 offen offset:3072 lds
s_add_u32 m0, s53, 4096
s_add_u32 s54, s58, 128
buffer_load_dwordx4 v251, s[12:15], s54 offen offset:0 lds
buffer_load_dwordx4 v251, s[12:15], s54 offen offset:1024 lds
buffer_load_dwordx4 v251, s[12:15], s54 offen offset:2048 lds
buffer_load_dwordx4 v251, s[12:15], s54 offen offset:3072 lds
s_add_u32 m0, s53, 8192
s_add_u32 s54, s58, 256
buffer_load_dwordx4 v251, s[12:15], s54 offen offset:0 lds
buffer_load_dwordx4 v251, s[12:15], s54 offen offset:1024 lds
buffer_load_dwordx4 v251, s[12:15], s54 offen offset:2048 lds
buffer_load_dwordx4 v251, s[12:15], s54 offen offset:3072 lds
s_add_u32 m0, s53, 12288
s_add_u32 s54, s58, 384
buffer_load_dwordx4 v251, s[12:15], s54 offen offset:0 lds
buffer_load_dwordx4 v251, s[12:15], s54 offen offset:1024 lds
buffer_load_dwordx4 v251, s[12:15], s54 offen offset:2048 lds
buffer_load_dwordx4 v251, s[12:15], s54 offen offset:3072 lds
s_add_u32 s53, s53, 0x4000
s_cmp_eq_u32 s53, s57
s_cselect_b32 s53, s56, s53
s_add_u32 s58, s58, 0x4000
s_mov_b32 s51, s29
s_mov_b32 s52, s56
v_mov_b32 v172, 0xff800000
v_accvgpr_write_b32 a0, 0
v_accvgpr_write_b32 a1, 0
v_accvgpr_write_b32 a2, 0
v_accvgpr_write_b32 a3, 0
v_accvgpr_write_b32 a4, 0
v_accvgpr_write_b32 a5, 0
v_accvgpr_write_b32 a6, 0
v_accvgpr_write_b32 a7, 0
v_accvgpr_write_b32 a8, 0
v_accvgpr_write_b32 a9, 0
v_accvgpr_write_b32 a10, 0
v_accvgpr_write_b32 a11, 0
v_accvgpr_write_b32 a12, 0
v_accvgpr_write_b32 a13, 0
v_accvgpr_write_b32 a14, 0
v_accvgpr_write_b32 a15, 0
v_accvgpr_write_b32 a16, 0
v_accvgpr_write_b32 a17, 0
v_accvgpr_write_b32 a18, 0
v_accvgpr_write_b32 a19, 0
v_accvgpr_write_b32 a20, 0
v_accvgpr_write_b32 a21, 0
v_accvgpr_write_b32 a22, 0
v_accvgpr_write_b32 a23, 0
v_accvgpr_write_b32 a24, 0
v_accvgpr_write_b32 a25, 0
v_accvgpr_write_b32 a26, 0
v_accvgpr_write_b32 a27, 0
v_accvgpr_write_b32 a28, 0
v_accvgpr_write_b32 a29, 0
v_accvgpr_write_b32 a30, 0
v_accvgpr_write_b32 a31, 0
v_accvgpr_write_b32 a32, 0
v_accvgpr_write_b32 a33, 0
v_accvgpr_write_b32 a34, 0
v_accvgpr_write_b32 a35, 0
v_accvgpr_write_b32 a36, 0
v_accvgpr_write_b32 a37, 0
v_accvgpr_write_b32 a38, 0
v_accvgpr_write_b32 a39, 0
v_accvgpr_write_b32 a40, 0
v_accvgpr_write_b32 a41, 0
v_accvgpr_write_b32 a42, 0
v_accvgpr_write_b32 a43, 0
v_accvgpr_write_b32 a44, 0
v_accvgpr_write_b32 a45, 0
v_accvgpr_write_b32 a46, 0
v_accvgpr_write_b32 a47, 0
v_accvgpr_write_b32 a48, 0
v_accvgpr_write_b32 a49, 0
v_accvgpr_write_b32 a50, 0
v_accvgpr_write_b32 a51, 0
v_accvgpr_write_b32 a52, 0
v_accvgpr_write_b32 a53, 0
v_accvgpr_write_b32 a54, 0
v_accvgpr_write_b32 a55, 0
v_accvgpr_write_b32 a56, 0
v_accvgpr_write_b32 a57, 0
v_accvgpr_write_b32 a58, 0
v_accvgpr_write_b32 a59, 0
v_accvgpr_write_b32 a60, 0
v_accvgpr_write_b32 a61, 0
v_accvgpr_write_b32 a62, 0
v_accvgpr_write_b32 a63, 0
LT_loop:
s_add_u32 m0, s53, 0
s_add_u32 s54, s58, 0
buffer_load_dwordx4 v251, s[12:15], s54 offen offset:0 lds
buffer_load_dwordx4 v251, s[12:15], s54 offen offset:1024 lds
buffer_load_dwordx4 v251, s[12:15], s54 offen offset:2048 lds
buffer_load_dwordx4 v251, s[12:15], s54 offen offset:3072 lds
s_add_u32 m0, s53, 4096
s_add_u32 s54, s58, 128
buffer_load_dwordx4 v251, s[12:15], s54 offen offset:0 lds
buffer_load_dwordx4 v251, s[12:15], s54 offen offset:1024 lds
buffer_load_dwordx4 v251, s[12:15], s54 offen offset:2048 lds
buffer_load_dwordx4 v251, s[12:15], s54 offen offset:3072 lds
s_add_u32 m0, s53, 8192
s_add_u32 s54, s58, 256
buffer_load_dwordx4 v251, s[12:15], s54 offen offset:0 lds
buffer_load_dwordx4 v251, s[12:15], s54 offen offset:1024 lds
buffer_load_dwordx4 v251, s[12:15], s54 offen offset:2048 lds
buffer_load_dwordx4 v251, s[12:15], s54 offen offset:3072 lds
s_add_u32 m0, s53, 12288
s_add_u32 s54, s58, 384
buffer_load_dwordx4 v251, s[12:15], s54 offen offset:0 lds
buffer_load_dwordx4 v251, s[12:15], s54 offen offset:1024 lds
buffer_load_dwordx4 v251, s[12:15], s54 offen offset:2048 lds
buffer_load_dwordx4 v251, s[12:15], s54 offen offset:3072 lds
s_add_u32 s53, s53, 0x4000
s_cmp_eq_u32 s53, s57
s_cselect_b32 s53, s56, s53
s_add_u32 s58, s58, 0x4000
v_add_u32 v177, s52, v248
v_add_u32 v178, s52, v249
v_add_u32 v179, s52, v250
s_add_u32 s52, s52, 0x4000
s_cmp_eq_u32 s52, s57
s_cselect_b32 s52, s56, s52
s_cmp_eq_u32 s51, 1
s_cselect_b32 s54, s33, 0
v_and_b32 v192, s54, v188
v_and_b32 v193, s54, v188
v_and_b32 v194, s54, v188
v_and_b32 v195, s54, v188
s_waitcnt vmcnt(48)
ds_read_b128 v[32:35], v177 offset:0
ds_read_b128 v[64:67], v177 offset:2048
ds_read_b128 v[36:39], v177 offset:512
ds_read_b128 v[68:71], v177 offset:2560
ds_read_b128 v[40:43], v177 offset:4096
ds_read_b128 v[72:75], v177 offset:6144
ds_read_b128 v[44:47], v177 offset:4608
ds_read_b128 v[76:79], v177 offset:6656
ds_read_b128 v[48:51], v177 offset:8192
ds_read_b128 v[80:83], v177 offset:10240
ds_read_b128 v[52:55], v177 offset:8704
ds_read_b128 v[84:87], v177 offset:10752
ds_read_b128 v[56:59], v177 offset:12288
ds_read_b128 v[88:91], v177 offset:14336
ds_read_b128 v[60:63], v177 offset:12800
ds_read_b128 v[92:95], v177 offset:14848
s_waitcnt lgkmcnt(14)
v_mfma_f32_16x16x32_bf16 v[160:163], v[32:35], v[0:3], v[192:195]
v_mfma_f32_16x16x32_bf16 v[164:167], v[64:67], v[0:3], v[192:195]
s_waitcnt lgkmcnt(12)
v_mfma_f32_16x16x32_bf16 v[160:163], v[36:39], v[4:7], v[160:163]
v_mfma_f32_16x16x32_bf16 v[164:167], v[68:71], v[4:7], v[164:167]
s_waitcnt lgkmcnt(10)
v_mfma_f32_16x16x32_bf16 v[160:163], v[40:43], v[8:11], v[160:163]
v_mfma_f32_16x16x32_bf16 v[164:167], v[72:75], v[8:11], v[164:167]
s_waitcnt lgkmcnt(8)
v_mfma_f32_16x16x32_bf16 v[160:163], v[44:47], v[12:15], v[160:163]
v_mfma_f32_16x16x32_bf16 v[164:167], v[76:79], v[12:15], v[164:167]
s_waitcnt lgkmcnt(6)
v_mfma_f32_16x16x32_bf16 v[160:163], v[48:51], v[16:19], v[160:163]
v_mfma_f32_16x16x32_bf16 v[164:167], v[80:83], v[16:19], v[164:167]
s_waitcnt lgkmcnt(4)
v_mfma_f32_16x16x32_bf16 v[160:163], v[52:55], v[20:23], v[160:163]
v_mfma_f32_16x16x32_bf16 v[164:167], v[84:87], v[20:23], v[164:167]
s_waitcnt lgkmcnt(2)
v_mfma_f32_16x16x32_bf16 v[160:163], v[56:59], v[24:27], v[160:163]
v_mfma_f32_16x16x32_bf16 v[164:167], v[88:91], v[24:27], v[164:167]
s_waitcnt lgkmcnt(0)
v_mfma_f32_16x16x32_bf16 v[160:163], v[60:63], v[28:31], v[160:163]
v_mfma_f32_16x16x32_bf16 v[164:167], v[92:95], v[28:31], v[164:167]
ds_read_b64_tr_b16 v[96:97], v178 offset:0
ds_read_b64_tr_b16 v[98:99], v178 offset:2048
ds_read_b64_tr_b16 v[100:101], v179 offset:0
ds_read_b64_tr_b16 v[102:103], v179 offset:2048
ds_read_b64_tr_b16 v[104:105], v178 offset:512
ds_read_b64_tr_b16 v[106:107], v178 offset:2560
ds_read_b64_tr_b16 v[108:109], v179 offset:512
ds_read_b64_tr_b16 v[110:111], v179 offset:2560
ds_read_b64_tr_b16 v[112:113], v178 offset:4096
ds_read_b64_tr_b16 v[114:115], v178 offset:6144
ds_read_b64_tr_b16 v[116:117], v179 offset:4096
ds_read_b64_tr_b16 v[118:119], v179 offset:6144
ds_read_b64_tr_b16 v[120:121], v178 offset:4608
ds_read_b64_tr_b16 v[122:123], v178 offset:6656
ds_read_b64_tr_b16 v[124:125], v179 offset:4608
ds_read_b64_tr_b16 v[126:127], v179 offset:6656
ds_read_b64_tr_b16 v[128:129], v178 offset:8192
ds_read_b64_tr_b16 v[130:131], v178 offset:10240
ds_read_b64_tr_b16 v[132:133], v179 offset:8192
ds_read_b64_tr_b16 v[134:135], v179 offset:10240
ds_read_b64_tr_b16 v[136:137], v178 offset:8704
ds_read_b64_tr_b16 v[138:139], v178 offset:10752
ds_read_b64_tr_b16 v[140:141], v179 offset:8704
ds_read_b64_tr_b16 v[142:143], v179 offset:10752
ds_read_b64_tr_b16 v[144:145], v178 offset:12288
ds_read_b64_tr_b16 v[146:147], v178 offset:14336
ds_read_b64_tr_b16 v[148:149], v179 offset:12288
ds_read_b64_tr_b16 v[150:151], v179 offset:14336
ds_read_b64_tr_b16 v[152:153], v178 offset:12800
ds_read_b64_tr_b16 v[154:155], v178 offset:14848
ds_read_b64_tr_b16 v[156:157], v179 offset:12800
ds_read_b64_tr_b16 v[158:159], v179 offset:14848
s_nop 7
v_max3_f32 v175, v160, v161, v162
v_max3_f32 v175, v175, v163, v164
v_max3_f32 v175, v175, v165, v166
v_max3_f32 v175, v175, v167, v172
v_mov_b32 v176, v175
s_nop 1
v_permlane32_swap_b32 v175, v176
s_nop 1
v_max_f32 v175, v175, v176
v_mov_b32 v176, v175
s_nop 1
v_permlane16_swap_b32 v175, v176
s_nop 1
v_max_f32 v175, v175, v176
v_sub_f32 v174, v172, v175
v_exp_f32 v174, v174
v_mov_b32 v172, v175
v_sub_f32 v160, v160, v172
v_sub_f32 v161, v161, v172
v_sub_f32 v162, v162, v172
v_sub_f32 v163, v163, v172
v_sub_f32 v164, v164, v172
v_sub_f32 v165, v165, v172
v_sub_f32 v166, v166, v172
v_sub_f32 v167, v167, v172
v_exp_f32 v160, v160
v_exp_f32 v161, v161
v_exp_f32 v162, v162
v_exp_f32 v163, v163
v_exp_f32 v164, v164
v_exp_f32 v165, v165
v_exp_f32 v166, v166
v_exp_f32 v167, v167
v_cmp_neq_f32 vcc, 1.0, v174
v_cvt_pk_bf16_f32 v168, v160, v161
v_cvt_pk_bf16_f32 v169, v162, v163
v_cvt_pk_bf16_f32 v170, v164, v165
v_cvt_pk_bf16_f32 v171, v166, v167
s_cbranch_vccz LT_nors
v_accvgpr_read_b32 v180, a0
v_accvgpr_read_b32 v181, a1
v_accvgpr_read_b32 v182, a2
v_accvgpr_read_b32 v183, a3
v_accvgpr_read_b32 v184, a4
v_accvgpr_read_b32 v185, a5
v_accvgpr_read_b32 v186, a6
v_accvgpr_read_b32 v187, a7
v_mul_f32 v180, v180, v174
v_mul_f32 v181, v181, v174
v_mul_f32 v182, v182, v174
v_mul_f32 v183, v183, v174
v_mul_f32 v184, v184, v174
v_mul_f32 v185, v185, v174
v_mul_f32 v186, v186, v174
v_mul_f32 v187, v187, v174
v_accvgpr_write_b32 a0, v180
v_accvgpr_write_b32 a1, v181
v_accvgpr_write_b32 a2, v182
v_accvgpr_write_b32 a3, v183
v_accvgpr_write_b32 a4, v184
v_accvgpr_write_b32 a5, v185
v_accvgpr_write_b32 a6, v186
v_accvgpr_write_b32 a7, v187
v_accvgpr_read_b32 v180, a8
v_accvgpr_read_b32 v181, a9
v_accvgpr_read_b32 v182, a10
v_accvgpr_read_b32 v183, a11
v_accvgpr_read_b32 v184, a12
v_accvgpr_read_b32 v185, a13
v_accvgpr_read_b32 v186, a14
v_accvgpr_read_b32 v187, a15
v_mul_f32 v180, v180, v174
v_mul_f32 v181, v181, v174
v_mul_f32 v182, v182, v174
v_mul_f32 v183, v183, v174
v_mul_f32 v184, v184, v174
v_mul_f32 v185, v185, v174
v_mul_f32 v186, v186, v174
v_mul_f32 v187, v187, v174
v_accvgpr_write_b32 a8, v180
v_accvgpr_write_b32 a9, v181
v_accvgpr_write_b32 a10, v182
v_accvgpr_write_b32 a11, v183
v_accvgpr_write_b32 a12, v184
v_accvgpr_write_b32 a13, v185
v_accvgpr_write_b32 a14, v186
v_accvgpr_write_b32 a15, v187
v_accvgpr_read_b32 v180, a16
v_accvgpr_read_b32 v181, a17
v_accvgpr_read_b32 v182, a18
v_accvgpr_read_b32 v183, a19
v_accvgpr_read_b32 v184, a20
v_accvgpr_read_b32 v185, a21
v_accvgpr_read_b32 v186, a22
v_accvgpr_read_b32 v187, a23
v_mul_f32 v180, v180, v174
v_mul_f32 v181, v181, v174
v_mul_f32 v182, v182, v174
v_mul_f32 v183, v183, v174
v_mul_f32 v184, v184, v174
v_mul_f32 v185, v185, v174
v_mul_f32 v186, v186, v174
v_mul_f32 v187, v187, v174
v_accvgpr_write_b32 a16, v180
v_accvgpr_write_b32 a17, v181
v_accvgpr_write_b32 a18, v182
v_accvgpr_write_b32 a19, v183
v_accvgpr_write_b32 a20, v184
v_accvgpr_write_b32 a21, v185
v_accvgpr_write_b32 a22, v186
v_accvgpr_write_b32 a23, v187
v_accvgpr_read_b32 v180, a24
v_accvgpr_read_b32 v181, a25
v_accvgpr_read_b32 v182, a26
v_accvgpr_read_b32 v183, a27
v_accvgpr_read_b32 v184, a28
v_accvgpr_read_b32 v185, a29
v_accvgpr_read_b32 v186, a30
v_accvgpr_read_b32 v187, a31
v_mul_f32 v180, v180, v174
v_mul_f32 v181, v181, v174
v_mul_f32 v182, v182, v174
v_mul_f32 v183, v183, v174
v_mul_f32 v184, v184, v174
v_mul_f32 v185, v185, v174
v_mul_f32 v186, v186, v174
v_mul_f32 v187, v187, v174
v_accvgpr_write_b32 a24, v180
v_accvgpr_write_b32 a25, v181
v_accvgpr_write_b32 a26, v182
v_accvgpr_write_b32 a27, v183
v_accvgpr_write_b32 a28, v184
v_accvgpr_write_b32 a29, v185
v_accvgpr_write_b32 a30, v186
v_accvgpr_write_b32 a31, v187
v_accvgpr_read_b32 v180, a32
v_accvgpr_read_b32 v181, a33
v_accvgpr_read_b32 v182, a34
v_accvgpr_read_b32 v183, a35
v_accvgpr_read_b32 v184, a36
v_accvgpr_read_b32 v185, a37
v_accvgpr_read_b32 v186, a38
v_accvgpr_read_b32 v187, a39
v_mul_f32 v180, v180, v174
v_mul_f32 v181, v181, v174
v_mul_f32 v182, v182, v174
v_mul_f32 v183, v183, v174
v_mul_f32 v184, v184, v174
v_mul_f32 v185, v185, v174
v_mul_f32 v186, v186, v174
v_mul_f32 v187, v187, v174
v_accvgpr_write_b32 a32, v180
v_accvgpr_write_b32 a33, v181
v_accvgpr_write_b32 a34, v182
v_accvgpr_write_b32 a35, v183
v_accvgpr_write_b32 a36, v184
v_accvgpr_write_b32 a37, v185
v_accvgpr_write_b32 a38, v186
v_accvgpr_write_b32 a39, v187
v_accvgpr_read_b32 v180, a40
v_accvgpr_read_b32 v181, a41
v_accvgpr_read_b32 v182, a42
v_accvgpr_read_b32 v183, a43
v_accvgpr_read_b32 v184, a44
v_accvgpr_read_b32 v185, a45
v_accvgpr_read_b32 v186, a46
v_accvgpr_read_b32 v187, a47
v_mul_f32 v180, v180, v174
v_mul_f32 v181, v181, v174
v_mul_f32 v182, v182, v174
v_mul_f32 v183, v183, v174
v_mul_f32 v184, v184, v174
v_mul_f32 v185, v185, v174
v_mul_f32 v186, v186, v174
v_mul_f32 v187, v187, v174
v_accvgpr_write_b32 a40, v180
v_accvgpr_write_b32 a41, v181
v_accvgpr_write_b32 a42, v182
v_accvgpr_write_b32 a43, v183
v_accvgpr_write_b32 a44, v184
v_accvgpr_write_b32 a45, v185
v_accvgpr_write_b32 a46, v186
v_accvgpr_write_b32 a47, v187
v_accvgpr_read_b32 v180, a48
v_accvgpr_read_b32 v181, a49
v_accvgpr_read_b32 v182, a50
v_accvgpr_read_b32 v183, a51
v_accvgpr_read_b32 v184, a52
v_accvgpr_read_b32 v185, a53
v_accvgpr_read_b32 v186, a54
v_accvgpr_read_b32 v187, a55
v_mul_f32 v180, v180, v174
v_mul_f32 v181, v181, v174
v_mul_f32 v182, v182, v174
v_mul_f32 v183, v183, v174
v_mul_f32 v184, v184, v174
v_mul_f32 v185, v185, v174
v_mul_f32 v186, v186, v174
v_mul_f32 v187, v187, v174
v_accvgpr_write_b32 a48, v180
v_accvgpr_write_b32 a49, v181
v_accvgpr_write_b32 a50, v182
v_accvgpr_write_b32 a51, v183
v_accvgpr_write_b32 a52, v184
v_accvgpr_write_b32 a53, v185
v_accvgpr_write_b32 a54, v186
v_accvgpr_write_b32 a55, v187
v_accvgpr_read_b32 v180, a56
v_accvgpr_read_b32 v181, a57
v_accvgpr_read_b32 v182, a58
v_accvgpr_read_b32 v183, a59
v_accvgpr_read_b32 v184, a60
v_accvgpr_read_b32 v185, a61
v_accvgpr_read_b32 v186, a62
v_accvgpr_read_b32 v187, a63
v_mul_f32 v180, v180, v174
v_mul_f32 v181, v181, v174
v_mul_f32 v182, v182, v174
v_mul_f32 v183, v183, v174
v_mul_f32 v184, v184, v174
v_mul_f32 v185, v185, v174
v_mul_f32 v186, v186, v174
v_mul_f32 v187, v187, v174
v_accvgpr_write_b32 a56, v180
v_accvgpr_write_b32 a57, v181
v_accvgpr_write_b32 a58, v182
v_accvgpr_write_b32 a59, v183
v_accvgpr_write_b32 a60, v184
v_accvgpr_write_b32 a61, v185
v_accvgpr_write_b32 a62, v186
v_accvgpr_write_b32 a63, v187
LT_nors:
s_waitcnt lgkmcnt(0)
s_nop 1
v_mfma_f32_16x16x32_bf16 a[0:3], v[96:99], v[168:171], a[0:3]
v_mfma_f32_16x16x32_bf16 a[4:7], v[100:103], v[168:171], a[4:7]
v_mfma_f32_16x16x32_bf16 a[8:11], v[104:107], v[168:171], a[8:11]
v_mfma_f32_16x16x32_bf16 a[12:15], v[108:111], v[168:171], a[12:15]
v_mfma_f32_16x16x32_bf16 a[16:19], v[112:115], v[168:171], a[16:19]
v_mfma_f32_16x16x32_bf16 a[20:23], v[116:119], v[168:171], a[20:23]
v_mfma_f32_16x16x32_bf16 a[24:27], v[120:123], v[168:171], a[24:27]
v_mfma_f32_16x16x32_bf16 a[28:31], v[124:127], v[168:171], a[28:31]
v_mfma_f32_16x16x32_bf16 a[32:35], v[128:131], v[168:171], a[32:35]
v_mfma_f32_16x16x32_bf16 a[36:39], v[132:135], v[168:171], a[36:39]
v_mfma_f32_16x16x32_bf16 a[40:43], v[136:139], v[168:171], a[40:43]
v_mfma_f32_16x16x32_bf16 a[44:47], v[140:143], v[168:171], a[44:47]
v_mfma_f32_16x16x32_bf16 a[48:51], v[144:147], v[168:171], a[48:51]
v_mfma_f32_16x16x32_bf16 a[52:55], v[148:151], v[168:171], a[52:55]
v_mfma_f32_16x16x32_bf16 a[56:59], v[152:155], v[168:171], a[56:59]
v_mfma_f32_16x16x32_bf16 a[60:63], v[156:159], v[168:171], a[60:63]
s_sub_u32 s51, s51, 1
s_cmp_lg_u32 s51, 0
s_cbranch_scc1 LT_loop
s_nop 15
v_accvgpr_read_b32 v173, a0
v_accvgpr_read_b32 v180, a0
v_accvgpr_read_b32 v181, a1
v_accvgpr_read_b32 v182, a2
v_accvgpr_read_b32 v183, a3
v_accvgpr_read_b32 v184, a4
v_accvgpr_read_b32 v185, a5
v_accvgpr_read_b32 v186, a6
v_accvgpr_read_b32 v187, a7
v_cvt_pk_bf16_f32 v32, v180, v181
v_cvt_pk_bf16_f32 v33, v182, v183
v_cvt_pk_bf16_f32 v34, v184, v185
v_cvt_pk_bf16_f32 v35, v186, v187
buffer_store_dwordx4 v[32:35], v252, s[20:23], s40 offen offset:0 sc1
v_accvgpr_read_b32 v180, a8
v_accvgpr_read_b32 v181, a9
v_accvgpr_read_b32 v182, a10
v_accvgpr_read_b32 v183, a11
v_accvgpr_read_b32 v184, a12
v_accvgpr_read_b32 v185, a13
v_accvgpr_read_b32 v186, a14
v_accvgpr_read_b32 v187, a15
v_cvt_pk_bf16_f32 v36, v180, v181
v_cvt_pk_bf16_f32 v37, v182, v183
v_cvt_pk_bf16_f32 v38, v184, v185
v_cvt_pk_bf16_f32 v39, v186, v187
buffer_store_dwordx4 v[36:39], v252, s[20:23], s40 offen offset:1024 sc1
v_accvgpr_read_b32 v180, a16
v_accvgpr_read_b32 v181, a17
v_accvgpr_read_b32 v182, a18
v_accvgpr_read_b32 v183, a19
v_accvgpr_read_b32 v184, a20
v_accvgpr_read_b32 v185, a21
v_accvgpr_read_b32 v186, a22
v_accvgpr_read_b32 v187, a23
v_cvt_pk_bf16_f32 v40, v180, v181
v_cvt_pk_bf16_f32 v41, v182, v183
v_cvt_pk_bf16_f32 v42, v184, v185
v_cvt_pk_bf16_f32 v43, v186, v187
buffer_store_dwordx4 v[40:43], v252, s[20:23], s40 offen offset:2048 sc1
v_accvgpr_read_b32 v180, a24
v_accvgpr_read_b32 v181, a25
v_accvgpr_read_b32 v182, a26
v_accvgpr_read_b32 v183, a27
v_accvgpr_read_b32 v184, a28
v_accvgpr_read_b32 v185, a29
v_accvgpr_read_b32 v186, a30
v_accvgpr_read_b32 v187, a31
v_cvt_pk_bf16_f32 v44, v180, v181
v_cvt_pk_bf16_f32 v45, v182, v183
v_cvt_pk_bf16_f32 v46, v184, v185
v_cvt_pk_bf16_f32 v47, v186, v187
buffer_store_dwordx4 v[44:47], v252, s[20:23], s40 offen offset:3072 sc1
v_accvgpr_read_b32 v180, a32
v_accvgpr_read_b32 v181, a33
v_accvgpr_read_b32 v182, a34
v_accvgpr_read_b32 v183, a35
v_accvgpr_read_b32 v184, a36
v_accvgpr_read_b32 v185, a37
v_accvgpr_read_b32 v186, a38
v_accvgpr_read_b32 v187, a39
v_cvt_pk_bf16_f32 v48, v180, v181
v_cvt_pk_bf16_f32 v49, v182, v183
v_cvt_pk_bf16_f32 v50, v184, v185
v_cvt_pk_bf16_f32 v51, v186, v187
buffer_store_dwordx4 v[48:51], v252, s[20:23], s44 offen offset:0 sc1
v_accvgpr_read_b32 v180, a40
v_accvgpr_read_b32 v181, a41
v_accvgpr_read_b32 v182, a42
v_accvgpr_read_b32 v183, a43
v_accvgpr_read_b32 v184, a44
v_accvgpr_read_b32 v185, a45
v_accvgpr_read_b32 v186, a46
v_accvgpr_read_b32 v187, a47
v_cvt_pk_bf16_f32 v52, v180, v181
v_cvt_pk_bf16_f32 v53, v182, v183
v_cvt_pk_bf16_f32 v54, v184, v185
v_cvt_pk_bf16_f32 v55, v186, v187
buffer_store_dwordx4 v[52:55], v252, s[20:23], s44 offen offset:1024 sc1
v_accvgpr_read_b32 v180, a48
v_accvgpr_read_b32 v181, a49
v_accvgpr_read_b32 v182, a50
v_accvgpr_read_b32 v183, a51
v_accvgpr_read_b32 v184, a52
v_accvgpr_read_b32 v185, a53
v_accvgpr_read_b32 v186, a54
v_accvgpr_read_b32 v187, a55
v_cvt_pk_bf16_f32 v56, v180, v181
v_cvt_pk_bf16_f32 v57, v182, v183
v_cvt_pk_bf16_f32 v58, v184, v185
v_cvt_pk_bf16_f32 v59, v186, v187
buffer_store_dwordx4 v[56:59], v252, s[20:23], s44 offen offset:2048 sc1
v_accvgpr_read_b32 v180, a56
v_accvgpr_read_b32 v181, a57
v_accvgpr_read_b32 v182, a58
v_accvgpr_read_b32 v183, a59
v_accvgpr_read_b32 v184, a60
v_accvgpr_read_b32 v185, a61
v_accvgpr_read_b32 v186, a62
v_accvgpr_read_b32 v187, a63
v_cvt_pk_bf16_f32 v60, v180, v181
v_cvt_pk_bf16_f32 v61, v182, v183
v_cvt_pk_bf16_f32 v62, v184, v185
v_cvt_pk_bf16_f32 v63, v186, v187
buffer_store_dwordx4 v[60:63], v252, s[20:23], s44 offen offset:3072 sc1
v_lshlrev_b32 v175, 2, v252
s_mov_b64 exec, 0xffff
buffer_store_dwordx2 v[172:173], v175, s[24:27], s48 offen sc1
s_mov_b64 exec, -1
s_waitcnt vmcnt(0)
s_add_u32 s40, s40, 8192
s_add_u32 s48, s48, 1024
s_sub_u32 s55, s55, 1
s_cmp_lg_u32 s55, 0
s_cbranch_scc1 LT_q
s_add_u32 s52, s4, 0x7c00000
s_addc_u32 s53, s5, 0
s_mov_b32 s54, 0x2000
s_mov_b32 s55, 0x00020000
v_mov_b32 v1, 4992
v_mov_b32 v2, 1
s_mov_b64 exec, 1
s_waitcnt vmcnt(0)
buffer_atomic_add v2, v1, s[52:55], 0 offen
s_mov_b64 exec, -1
s_branch L2_fin
LE_start:
s_cmp_ge_u32 s37, 32
s_cbranch_scc1 L2_end
v_lshrrev_b32 v1, 6, v0
s_sub_u32 s37, s37, 30
s_lshl_b32 s35, s35, 1
v_readfirstlane_b32 s41, v1
s_add_u32 s35, s35, s37
s_mul_i32 s35, s35, 3
s_add_u32 s40, s35, s41
s_cmp_ge_u32 s41, 3
s_cbranch_scc1 LC_help
LE_common:
v_and_b32 v1, 63, v0
s_mul_i32 s58, s40, 167
s_mov_b32 s59, 167
s_mov_b32 s42, 0
s_mov_b32 s49, 512
v_lshrrev_b32 v33, 1, v1
v_and_b32 v34, 1, v1
v_mul_u32_u24 v6, 0x5000, v33
v_lshl_add_u32 v6, v34, 4, v6
v_lshlrev_b32 v33, 2, v33
s_mul_i32 s50, s40, 655360
s_mul_i32 s48, s40, 128
s_waitcnt lgkmcnt(0)
s_add_u32 s8, s4, 0x7800000
s_addc_u32 s9, s5, 0
s_mov_b32 s10, 0x2000
s_mov_b32 s11, 0x00020000
s_add_u32 s12, s4, 0x8000000
s_addc_u32 s13, s5, 0
s_mov_b32 s14, 0x2800000
s_mov_b32 s15, 0x00020000
buffer_load_dword v4, v33, s[8:11], s48 offen
buffer_load_dwordx4 v[192:195], v6, s[12:15], s50 offen offset:0
buffer_load_dwordx4 v[196:199], v6, s[12:15], s50 offen offset:32
buffer_load_dwordx4 v[200:203], v6, s[12:15], s50 offen offset:64
buffer_load_dwordx4 v[204:207], v6, s[12:15], s50 offen offset:96
buffer_load_dwordx4 v[208:211], v6, s[12:15], s50 offen offset:128
buffer_load_dwordx4 v[212:215], v6, s[12:15], s50 offen offset:160
buffer_load_dwordx4 v[216:219], v6, s[12:15], s50 offen offset:192
buffer_load_dwordx4 v[220:223], v6, s[12:15], s50 offen offset:224
buffer_load_dwordx4 v[224:227], v6, s[12:15], s50 offen offset:256
buffer_load_dwordx4 v[228:231], v6, s[12:15], s50 offen offset:288
buffer_load_dwordx4 v[232:235], v6, s[12:15], s50 offen offset:320
buffer_load_dwordx4 v[236:239], v6, s[12:15], s50 offen offset:352
buffer_load_dwordx4 v[240:243], v6, s[12:15], s50 offen offset:384
buffer_load_dwordx4 v[244:247], v6, s[12:15], s50 offen offset:416
buffer_load_dwordx4 v[248:251], v6, s[12:15], s50 offen offset:448
buffer_load_dwordx4 v[252:255], v6, s[12:15], s50 offen offset:480
s_add_u32 s16, s16, 0x0
s_addc_u32 s17, s17, 0
s_mov_b32 s18, 0x4e20
s_mov_b32 s19, 0x00020000
v_lshlrev_b32 v35, 1, v1
s_lshl_b32 s48, s58, 1
buffer_load_ushort v76, v35, s[16:19], s48 offen offset:0
buffer_load_ushort v77, v35, s[16:19], s48 offen offset:128
buffer_load_ushort v78, v35, s[16:19], s48 offen offset:256
s_add_u32 s16, s4, 0x6800000
s_addc_u32 s17, s5, 0
s_mov_b32 s18, 0x4e2000
s_mov_b32 s19, 0x00020000
s_add_u32 s20, s4, 0x7000000
s_addc_u32 s21, s5, 0
s_mov_b32 s22, 0x4e2000
s_mov_b32 s23, 0x00020000
v_lshlrev_b32 v5, 2, v34
v_and_b32 v2, 15, v1
v_lshrrev_b32 v3, 4, v1
v_mov_b32 v16, 1
v_mov_b32 v17, 4
v_and_b32 v33, 1, v2
v_lshlrev_b32 v33, 4, v33
v_lshlrev_b32 v33, v33, v16
v_mul_u32_u24 v33, 0x3f80, v33
v_lshrrev_b32 v34, 1, v2
v_cmp_eq_u32 vcc, 0, v34
s_nop 1
v_cndmask_b32 v40, 0, v33, vcc
v_cmp_eq_u32 vcc, 1, v34
s_nop 1
v_cndmask_b32 v41, 0, v33, vcc
v_cmp_eq_u32 vcc, 2, v34
s_nop 1
v_cndmask_b32 v42, 0, v33, vcc
v_cmp_eq_u32 vcc, 3, v34
s_nop 1
v_cndmask_b32 v43, 0, v33, vcc
v_cmp_eq_u32 vcc, 4, v34
s_nop 1
v_cndmask_b32 v44, 0, v33, vcc
v_cmp_eq_u32 vcc, 5, v34
s_nop 1
v_cndmask_b32 v45, 0, v33, vcc
v_cmp_eq_u32 vcc, 6, v34
s_nop 1
v_cndmask_b32 v46, 0, v33, vcc
v_cmp_eq_u32 vcc, 7, v34
s_nop 1
v_cndmask_b32 v47, 0, v33, vcc
v_lshlrev_b32 v39, 5, v2
v_lshl_add_u32 v39, v3, 3, v39
v_lshlrev_b32 v2, 4, v2
s_mul_i32 s48, s41, 21504
s_add_u32 s48, s48, 4096
v_mov_b32 v36, s48
v_lshl_add_u32 v38, v3, 2, v36
s_lshl_b32 s36, s41, 10
v_mov_b32 v7, s36
v_lshlrev_b32 v35, 4, v1
v_add_u32 v68, s48, v35
v_add_u32 v35, s36, v35
v_lshlrev_b32 v33, 2, v1
v_mov_b32 v72, 0xffff
v_mov_b32 v73, 0xffff
v_mov_b32 v74, 0xffff
v_mov_b32 v75, 0xffff
s_sub_u32 s36, s59, 0
v_cmp_gt_u32 vcc, s36, v33
v_mov_b32 v48, 0
s_nop 0
v_cndmask_b32 v18, 0, v16, vcc
s_sub_u32 s36, s59, 1
v_cmp_gt_u32 vcc, s36, v33
v_mov_b32 v49, 0
s_nop 0
v_cndmask_b32 v19, 0, v16, vcc
s_sub_u32 s36, s59, 2
v_cmp_gt_u32 vcc, s36, v33
v_mov_b32 v50, 0
s_nop 0
v_cndmask_b32 v20, 0, v16, vcc
s_sub_u32 s36, s59, 3
v_cmp_gt_u32 vcc, s36, v33
v_mov_b32 v51, 0
s_nop 0
v_cndmask_b32 v21, 0, v16, vcc
LE_pass:
ds_write_b128 v35, v[48:51]
ds_write_b128 v68, v[72:75] offset:0
ds_write_b128 v68, v[72:75] offset:1024
ds_write_b128 v68, v[72:75] offset:2048
ds_write_b128 v68, v[72:75] offset:3072
ds_write_b128 v68, v[72:75] offset:4096
ds_write_b128 v68, v[72:75] offset:5120
ds_write_b128 v68, v[72:75] offset:6144
ds_write_b128 v68, v[72:75] offset:7168
ds_write_b128 v68, v[72:75] offset:8192
ds_write_b128 v68, v[72:75] offset:9216
ds_write_b128 v68, v[72:75] offset:10240
ds_write_b128 v68, v[72:75] offset:11264
ds_write_b128 v68, v[72:75] offset:12288
ds_write_b128 v68, v[72:75] offset:13312
ds_write_b128 v68, v[72:75] offset:14336
ds_write_b128 v68, v[72:75] offset:15360
ds_write_b128 v68, v[72:75] offset:16384
ds_write_b128 v68, v[72:75] offset:17408
ds_write_b128 v68, v[72:75] offset:18432
ds_write_b128 v68, v[72:75] offset:19456
v_lshl_add_u32 v32, v1, 2, v36
ds_write_b32 v32, v48 offset:20480
s_waitcnt vmcnt(19)
v_sub_u32 v32, v4, v5
s_waitcnt vmcnt(15)
v_cmpx_lt_i32 vcc, 0, v32
s_cbranch_execz LE_c
v_mad_u32_u16 v128, v192, 1, v7 op_sel:[1,0,0,0]
ds_add_u32 v128, v16
v_cmpx_lt_i32 vcc, 1, v32
v_mad_u32_u16 v129, v193, 1, v7 op_sel:[1,0,0,0]
ds_add_u32 v129, v16
v_cmpx_lt_i32 vcc, 2, v32
v_mad_u32_u16 v130, v194, 1, v7 op_sel:[1,0,0,0]
ds_add_u32 v130, v16
v_cmpx_lt_i32 vcc, 3, v32
v_mad_u32_u16 v131, v195, 1, v7 op_sel:[1,0,0,0]
ds_add_u32 v131, v16
s_waitcnt vmcnt(14)
v_cmpx_lt_i32 vcc, 8, v32
s_cbranch_execz LE_c
v_mad_u32_u16 v132, v196, 1, v7 op_sel:[1,0,0,0]
ds_add_u32 v132, v16
v_cmpx_lt_i32 vcc, 9, v32
v_mad_u32_u16 v133, v197, 1, v7 op_sel:[1,0,0,0]
ds_add_u32 v133, v16
v_cmpx_lt_i32 vcc, 10, v32
v_mad_u32_u16 v134, v198, 1, v7 op_sel:[1,0,0,0]
ds_add_u32 v134, v16
v_cmpx_lt_i32 vcc, 11, v32
v_mad_u32_u16 v135, v199, 1, v7 op_sel:[1,0,0,0]
ds_add_u32 v135, v16
s_waitcnt vmcnt(13)
v_cmpx_lt_i32 vcc, 16, v32
s_cbranch_execz LE_c
v_mad_u32_u16 v136, v200, 1, v7 op_sel:[1,0,0,0]
ds_add_u32 v136, v16
v_cmpx_lt_i32 vcc, 17, v32
v_mad_u32_u16 v137, v201, 1, v7 op_sel:[1,0,0,0]
ds_add_u32 v137, v16
v_cmpx_lt_i32 vcc, 18, v32
v_mad_u32_u16 v138, v202, 1, v7 op_sel:[1,0,0,0]
ds_add_u32 v138, v16
v_cmpx_lt_i32 vcc, 19, v32
v_mad_u32_u16 v139, v203, 1, v7 op_sel:[1,0,0,0]
ds_add_u32 v139, v16
s_waitcnt vmcnt(12)
v_cmpx_lt_i32 vcc, 24, v32
s_cbranch_execz LE_c
v_mad_u32_u16 v140, v204, 1, v7 op_sel:[1,0,0,0]
ds_add_u32 v140, v16
v_cmpx_lt_i32 vcc, 25, v32
v_mad_u32_u16 v141, v205, 1, v7 op_sel:[1,0,0,0]
ds_add_u32 v141, v16
v_cmpx_lt_i32 vcc, 26, v32
v_mad_u32_u16 v142, v206, 1, v7 op_sel:[1,0,0,0]
ds_add_u32 v142, v16
v_cmpx_lt_i32 vcc, 27, v32
v_mad_u32_u16 v143, v207, 1, v7 op_sel:[1,0,0,0]
ds_add_u32 v143, v16
s_waitcnt vmcnt(11)
v_cmpx_lt_i32 vcc, 32, v32
s_cbranch_execz LE_c
v_mad_u32_u16 v144, v208, 1, v7 op_sel:[1,0,0,0]
ds_add_u32 v144, v16
v_cmpx_lt_i32 vcc, 33, v32
v_mad_u32_u16 v145, v209, 1, v7 op_sel:[1,0,0,0]
ds_add_u32 v145, v16
v_cmpx_lt_i32 vcc, 34, v32
v_mad_u32_u16 v146, v210, 1, v7 op_sel:[1,0,0,0]
ds_add_u32 v146, v16
v_cmpx_lt_i32 vcc, 35, v32
v_mad_u32_u16 v147, v211, 1, v7 op_sel:[1,0,0,0]
ds_add_u32 v147, v16
s_waitcnt vmcnt(10)
v_cmpx_lt_i32 vcc, 40, v32
s_cbranch_execz LE_c
v_mad_u32_u16 v148, v212, 1, v7 op_sel:[1,0,0,0]
ds_add_u32 v148, v16
v_cmpx_lt_i32 vcc, 41, v32
v_mad_u32_u16 v149, v213, 1, v7 op_sel:[1,0,0,0]
ds_add_u32 v149, v16
v_cmpx_lt_i32 vcc, 42, v32
v_mad_u32_u16 v150, v214, 1, v7 op_sel:[1,0,0,0]
ds_add_u32 v150, v16
v_cmpx_lt_i32 vcc, 43, v32
v_mad_u32_u16 v151, v215, 1, v7 op_sel:[1,0,0,0]
ds_add_u32 v151, v16
s_waitcnt vmcnt(9)
v_cmpx_lt_i32 vcc, 48, v32
s_cbranch_execz LE_c
v_mad_u32_u16 v152, v216, 1, v7 op_sel:[1,0,0,0]
ds_add_u32 v152, v16
v_cmpx_lt_i32 vcc, 49, v32
v_mad_u32_u16 v153, v217, 1, v7 op_sel:[1,0,0,0]
ds_add_u32 v153, v16
v_cmpx_lt_i32 vcc, 50, v32
v_mad_u32_u16 v154, v218, 1, v7 op_sel:[1,0,0,0]
ds_add_u32 v154, v16
v_cmpx_lt_i32 vcc, 51, v32
v_mad_u32_u16 v155, v219, 1, v7 op_sel:[1,0,0,0]
ds_add_u32 v155, v16
s_waitcnt vmcnt(8)
v_cmpx_lt_i32 vcc, 56, v32
s_cbranch_execz LE_c
v_mad_u32_u16 v156, v220, 1, v7 op_sel:[1,0,0,0]
ds_add_u32 v156, v16
v_cmpx_lt_i32 vcc, 57, v32
v_mad_u32_u16 v157, v221, 1, v7 op_sel:[1,0,0,0]
ds_add_u32 v157, v16
v_cmpx_lt_i32 vcc, 58, v32
v_mad_u32_u16 v158, v222, 1, v7 op_sel:[1,0,0,0]
ds_add_u32 v158, v16
v_cmpx_lt_i32 vcc, 59, v32
v_mad_u32_u16 v159, v223, 1, v7 op_sel:[1,0,0,0]
ds_add_u32 v159, v16
s_waitcnt vmcnt(7)
v_cmpx_lt_i32 vcc, 64, v32
s_cbranch_execz LE_c
v_mad_u32_u16 v160, v224, 1, v7 op_sel:[1,0,0,0]
ds_add_u32 v160, v16
v_cmpx_lt_i32 vcc, 65, v32
v_mad_u32_u16 v161, v225, 1, v7 op_sel:[1,0,0,0]
ds_add_u32 v161, v16
v_cmpx_lt_i32 vcc, 66, v32
v_mad_u32_u16 v162, v226, 1, v7 op_sel:[1,0,0,0]
ds_add_u32 v162, v16
v_cmpx_lt_i32 vcc, 67, v32
v_mad_u32_u16 v163, v227, 1, v7 op_sel:[1,0,0,0]
ds_add_u32 v163, v16
s_waitcnt vmcnt(6)
v_cmpx_lt_i32 vcc, 72, v32
s_cbranch_execz LE_c
v_mad_u32_u16 v164, v228, 1, v7 op_sel:[1,0,0,0]
ds_add_u32 v164, v16
v_cmpx_lt_i32 vcc, 73, v32
v_mad_u32_u16 v165, v229, 1, v7 op_sel:[1,0,0,0]
ds_add_u32 v165, v16
v_cmpx_lt_i32 vcc, 74, v32
v_mad_u32_u16 v166, v230, 1, v7 op_sel:[1,0,0,0]
ds_add_u32 v166, v16
v_cmpx_lt_i32 vcc, 75, v32
v_mad_u32_u16 v167, v231, 1, v7 op_sel:[1,0,0,0]
ds_add_u32 v167, v16
s_waitcnt vmcnt(5)
v_cmpx_lt_i32 vcc, 80, v32
s_cbranch_execz LE_c
v_mad_u32_u16 v168, v232, 1, v7 op_sel:[1,0,0,0]
ds_add_u32 v168, v16
v_cmpx_lt_i32 vcc, 81, v32
v_mad_u32_u16 v169, v233, 1, v7 op_sel:[1,0,0,0]
ds_add_u32 v169, v16
v_cmpx_lt_i32 vcc, 82, v32
v_mad_u32_u16 v170, v234, 1, v7 op_sel:[1,0,0,0]
ds_add_u32 v170, v16
v_cmpx_lt_i32 vcc, 83, v32
v_mad_u32_u16 v171, v235, 1, v7 op_sel:[1,0,0,0]
ds_add_u32 v171, v16
s_waitcnt vmcnt(4)
v_cmpx_lt_i32 vcc, 88, v32
s_cbranch_execz LE_c
v_mad_u32_u16 v172, v236, 1, v7 op_sel:[1,0,0,0]
ds_add_u32 v172, v16
v_cmpx_lt_i32 vcc, 89, v32
v_mad_u32_u16 v173, v237, 1, v7 op_sel:[1,0,0,0]
ds_add_u32 v173, v16
v_cmpx_lt_i32 vcc, 90, v32
v_mad_u32_u16 v174, v238, 1, v7 op_sel:[1,0,0,0]
ds_add_u32 v174, v16
v_cmpx_lt_i32 vcc, 91, v32
v_mad_u32_u16 v175, v239, 1, v7 op_sel:[1,0,0,0]
ds_add_u32 v175, v16
s_waitcnt vmcnt(3)
v_cmpx_lt_i32 vcc, 96, v32
s_cbranch_execz LE_c
v_mad_u32_u16 v176, v240, 1, v7 op_sel:[1,0,0,0]
ds_add_u32 v176, v16
v_cmpx_lt_i32 vcc, 97, v32
v_mad_u32_u16 v177, v241, 1, v7 op_sel:[1,0,0,0]
ds_add_u32 v177, v16
v_cmpx_lt_i32 vcc, 98, v32
v_mad_u32_u16 v178, v242, 1, v7 op_sel:[1,0,0,0]
ds_add_u32 v178, v16
v_cmpx_lt_i32 vcc, 99, v32
v_mad_u32_u16 v179, v243, 1, v7 op_sel:[1,0,0,0]
ds_add_u32 v179, v16
s_waitcnt vmcnt(2)
v_cmpx_lt_i32 vcc, 104, v32
s_cbranch_execz LE_c
v_mad_u32_u16 v180, v244, 1, v7 op_sel:[1,0,0,0]
ds_add_u32 v180, v16
v_cmpx_lt_i32 vcc, 105, v32
v_mad_u32_u16 v181, v245, 1, v7 op_sel:[1,0,0,0]
ds_add_u32 v181, v16
v_cmpx_lt_i32 vcc, 106, v32
v_mad_u32_u16 v182, v246, 1, v7 op_sel:[1,0,0,0]
ds_add_u32 v182, v16
v_cmpx_lt_i32 vcc, 107, v32
v_mad_u32_u16 v183, v247, 1, v7 op_sel:[1,0,0,0]
ds_add_u32 v183, v16
s_waitcnt vmcnt(1)
v_cmpx_lt_i32 vcc, 112, v32
s_cbranch_execz LE_c
v_mad_u32_u16 v184, v248, 1, v7 op_sel:[1,0,0,0]
ds_add_u32 v184, v16
v_cmpx_lt_i32 vcc, 113, v32
v_mad_u32_u16 v185, v249, 1, v7 op_sel:[1,0,0,0]
ds_add_u32 v185, v16
v_cmpx_lt_i32 vcc, 114, v32
v_mad_u32_u16 v186, v250, 1, v7 op_sel:[1,0,0,0]
ds_add_u32 v186, v16
v_cmpx_lt_i32 vcc, 115, v32
v_mad_u32_u16 v187, v251, 1, v7 op_sel:[1,0,0,0]
ds_add_u32 v187, v16
s_waitcnt vmcnt(0)
v_cmpx_lt_i32 vcc, 120, v32
s_cbranch_execz LE_c
v_mad_u32_u16 v188, v252, 1, v7 op_sel:[1,0,0,0]
ds_add_u32 v188, v16
v_cmpx_lt_i32 vcc, 121, v32
v_mad_u32_u16 v189, v253, 1, v7 op_sel:[1,0,0,0]
ds_add_u32 v189, v16
v_cmpx_lt_i32 vcc, 122, v32
v_mad_u32_u16 v190, v254, 1, v7 op_sel:[1,0,0,0]
ds_add_u32 v190, v16
v_cmpx_lt_i32 vcc, 123, v32
v_mad_u32_u16 v191, v255, 1, v7 op_sel:[1,0,0,0]
ds_add_u32 v191, v16
LE_c:
s_mov_b64 exec, -1
ds_read_b128 v[24:27], v35
s_waitcnt lgkmcnt(0)
v_add_u32 v24, 3, v24
v_lshrrev_b32 v24, 2, v24
v_max_u32 v24, v24, v18
v_add_u32 v25, 3, v25
v_lshrrev_b32 v25, 2, v25
v_max_u32 v25, v25, v19
v_add_u32 v26, 3, v26
v_lshrrev_b32 v26, 2, v26
v_max_u32 v26, v26, v20
v_add_u32 v27, 3, v27
v_lshrrev_b32 v27, 2, v27
v_max_u32 v27, v27, v21
v_add_u32 v33, v24, v25
v_add3_u32 v33, v33, v26, v27
v_mov_b32 v64, v33
s_nop 1
v_add_u32_dpp v64, v64, v64 row_shr:1 row_mask:0xf bank_mask:0xf
s_nop 1
v_add_u32_dpp v64, v64, v64 row_shr:2 row_mask:0xf bank_mask:0xf
s_nop 1
v_add_u32_dpp v64, v64, v64 row_shr:4 row_mask:0xf bank_mask:0xf
s_nop 1
v_add_u32_dpp v64, v64, v64 row_shr:8 row_mask:0xf bank_mask:0xf
s_nop 1
v_add_u32_dpp v64, v64, v64 row_bcast:15 row_mask:0xa bank_mask:0xf
s_nop 1
v_add_u32_dpp v64, v64, v64 row_bcast:31 row_mask:0xc bank_mask:0xf
s_nop 1
v_readlane_b32 s44, v64, 63
v_sub_u32 v28, v64, v33
v_add_u32 v29, v28, v24
v_add_u32 v30, v29, v25
v_add_u32 v31, v30, v26
v_add3_u32 v33, v28, v24, -1
v_lshlrev_b32 v34, v33, v18
v_lshrrev_b32 v33, 5, v33
v_lshl_add_u32 v33, v33, 2, v36
ds_or_b32 v33, v34 offset:20480
v_lshl_add_u32 v28, v28, 4, v36
v_add3_u32 v33, v29, v25, -1
v_lshlrev_b32 v34, v33, v19
v_lshrrev_b32 v33, 5, v33
v_lshl_add_u32 v33, v33, 2, v36
ds_or_b32 v33, v34 offset:20480
v_lshl_add_u32 v29, v29, 4, v36
v_add3_u32 v33, v30, v26, -1
v_lshlrev_b32 v34, v33, v20
v_lshrrev_b32 v33, 5, v33
v_lshl_add_u32 v33, v33, 2, v36
ds_or_b32 v33, v34 offset:20480
v_lshl_add_u32 v30, v30, 4, v36
v_add3_u32 v33, v31, v27, -1
v_lshlrev_b32 v34, v33, v21
v_lshrrev_b32 v33, 5, v33
v_lshl_add_u32 v33, v33, 2, v36
ds_or_b32 v33, v34 offset:20480
v_lshl_add_u32 v31, v31, 4, v36
ds_write_b128 v35, v[28:31]
s_add_u32 s44, s44, 31
s_lshr_b32 s44, s44, 5
v_cmpx_lt_i32 vcc, 0, v32
s_cbranch_execz LE_p
ds_add_rtn_u32 v128, v128, v17
v_cmpx_lt_i32 vcc, 1, v32
ds_add_rtn_u32 v129, v129, v17
v_cmpx_lt_i32 vcc, 2, v32
ds_add_rtn_u32 v130, v130, v17
v_cmpx_lt_i32 vcc, 3, v32
ds_add_rtn_u32 v131, v131, v17
v_cmpx_lt_i32 vcc, 8, v32
s_cbranch_execz LE_p
ds_add_rtn_u32 v132, v132, v17
v_cmpx_lt_i32 vcc, 9, v32
ds_add_rtn_u32 v133, v133, v17
v_cmpx_lt_i32 vcc, 10, v32
ds_add_rtn_u32 v134, v134, v17
v_cmpx_lt_i32 vcc, 11, v32
ds_add_rtn_u32 v135, v135, v17
v_cmpx_lt_i32 vcc, 16, v32
s_cbranch_execz LE_p
ds_add_rtn_u32 v136, v136, v17
v_cmpx_lt_i32 vcc, 17, v32
ds_add_rtn_u32 v137, v137, v17
v_cmpx_lt_i32 vcc, 18, v32
ds_add_rtn_u32 v138, v138, v17
v_cmpx_lt_i32 vcc, 19, v32
ds_add_rtn_u32 v139, v139, v17
v_cmpx_lt_i32 vcc, 24, v32
s_cbranch_execz LE_p
ds_add_rtn_u32 v140, v140, v17
v_cmpx_lt_i32 vcc, 25, v32
ds_add_rtn_u32 v141, v141, v17
v_cmpx_lt_i32 vcc, 26, v32
ds_add_rtn_u32 v142, v142, v17
v_cmpx_lt_i32 vcc, 27, v32
ds_add_rtn_u32 v143, v143, v17
v_cmpx_lt_i32 vcc, 32, v32
s_cbranch_execz LE_p
ds_add_rtn_u32 v144, v144, v17
v_cmpx_lt_i32 vcc, 33, v32
ds_add_rtn_u32 v145, v145, v17
v_cmpx_lt_i32 vcc, 34, v32
ds_add_rtn_u32 v146, v146, v17
v_cmpx_lt_i32 vcc, 35, v32
ds_add_rtn_u32 v147, v147, v17
v_cmpx_lt_i32 vcc, 40, v32
s_cbranch_execz LE_p
ds_add_rtn_u32 v148, v148, v17
v_cmpx_lt_i32 vcc, 41, v32
ds_add_rtn_u32 v149, v149, v17
v_cmpx_lt_i32 vcc, 42, v32
ds_add_rtn_u32 v150, v150, v17
v_cmpx_lt_i32 vcc, 43, v32
ds_add_rtn_u32 v151, v151, v17
v_cmpx_lt_i32 vcc, 48, v32
s_cbranch_execz LE_p
ds_add_rtn_u32 v152, v152, v17
v_cmpx_lt_i32 vcc, 49, v32
ds_add_rtn_u32 v153, v153, v17
v_cmpx_lt_i32 vcc, 50, v32
ds_add_rtn_u32 v154, v154, v17
v_cmpx_lt_i32 vcc, 51, v32
ds_add_rtn_u32 v155, v155, v17
v_cmpx_lt_i32 vcc, 56, v32
s_cbranch_execz LE_p
ds_add_rtn_u32 v156, v156, v17
v_cmpx_lt_i32 vcc, 57, v32
ds_add_rtn_u32 v157, v157, v17
v_cmpx_lt_i32 vcc, 58, v32
ds_add_rtn_u32 v158, v158, v17
v_cmpx_lt_i32 vcc, 59, v32
ds_add_rtn_u32 v159, v159, v17
v_cmpx_lt_i32 vcc, 64, v32
s_cbranch_execz LE_p
ds_add_rtn_u32 v160, v160, v17
v_cmpx_lt_i32 vcc, 65, v32
ds_add_rtn_u32 v161, v161, v17
v_cmpx_lt_i32 vcc, 66, v32
ds_add_rtn_u32 v162, v162, v17
v_cmpx_lt_i32 vcc, 67, v32
ds_add_rtn_u32 v163, v163, v17
v_cmpx_lt_i32 vcc, 72, v32
s_cbranch_execz LE_p
ds_add_rtn_u32 v164, v164, v17
v_cmpx_lt_i32 vcc, 73, v32
ds_add_rtn_u32 v165, v165, v17
v_cmpx_lt_i32 vcc, 74, v32
ds_add_rtn_u32 v166, v166, v17
v_cmpx_lt_i32 vcc, 75, v32
ds_add_rtn_u32 v167, v167, v17
v_cmpx_lt_i32 vcc, 80, v32
s_cbranch_execz LE_p
ds_add_rtn_u32 v168, v168, v17
v_cmpx_lt_i32 vcc, 81, v32
ds_add_rtn_u32 v169, v169, v17
v_cmpx_lt_i32 vcc, 82, v32
ds_add_rtn_u32 v170, v170, v17
v_cmpx_lt_i32 vcc, 83, v32
ds_add_rtn_u32 v171, v171, v17
v_cmpx_lt_i32 vcc, 88, v32
s_cbranch_execz LE_p
ds_add_rtn_u32 v172, v172, v17
v_cmpx_lt_i32 vcc, 89, v32
ds_add_rtn_u32 v173, v173, v17
v_cmpx_lt_i32 vcc, 90, v32
ds_add_rtn_u32 v174, v174, v17
v_cmpx_lt_i32 vcc, 91, v32
ds_add_rtn_u32 v175, v175, v17
v_cmpx_lt_i32 vcc, 96, v32
s_cbranch_execz LE_p
ds_add_rtn_u32 v176, v176, v17
v_cmpx_lt_i32 vcc, 97, v32
ds_add_rtn_u32 v177, v177, v17
v_cmpx_lt_i32 vcc, 98, v32
ds_add_rtn_u32 v178, v178, v17
v_cmpx_lt_i32 vcc, 99, v32
ds_add_rtn_u32 v179, v179, v17
v_cmpx_lt_i32 vcc, 104, v32
s_cbranch_execz LE_p
ds_add_rtn_u32 v180, v180, v17
v_cmpx_lt_i32 vcc, 105, v32
ds_add_rtn_u32 v181, v181, v17
v_cmpx_lt_i32 vcc, 106, v32
ds_add_rtn_u32 v182, v182, v17
v_cmpx_lt_i32 vcc, 107, v32
ds_add_rtn_u32 v183, v183, v17
v_cmpx_lt_i32 vcc, 112, v32
s_cbranch_execz LE_p
ds_add_rtn_u32 v184, v184, v17
v_cmpx_lt_i32 vcc, 113, v32
ds_add_rtn_u32 v185, v185, v17
v_cmpx_lt_i32 vcc, 114, v32
ds_add_rtn_u32 v186, v186, v17
v_cmpx_lt_i32 vcc, 115, v32
ds_add_rtn_u32 v187, v187, v17
v_cmpx_lt_i32 vcc, 120, v32
s_cbranch_execz LE_p
ds_add_rtn_u32 v188, v188, v17
v_cmpx_lt_i32 vcc, 121, v32
ds_add_rtn_u32 v189, v189, v17
v_cmpx_lt_i32 vcc, 122, v32
ds_add_rtn_u32 v190, v190, v17
v_cmpx_lt_i32 vcc, 123, v32
ds_add_rtn_u32 v191, v191, v17
LE_p:
s_mov_b64 exec, -1
v_lshl_add_u32 v33, v1, 2, v36
ds_read_b32 v37, v33 offset:20480
s_waitcnt lgkmcnt(0)
v_cmpx_lt_i32 vcc, 0, v32
s_cbranch_execz LE_w
ds_write_b32 v128, v192
v_cmpx_lt_i32 vcc, 1, v32
ds_write_b32 v129, v193
v_cmpx_lt_i32 vcc, 2, v32
ds_write_b32 v130, v194
v_cmpx_lt_i32 vcc, 3, v32
ds_write_b32 v131, v195
v_cmpx_lt_i32 vcc, 8, v32
s_cbranch_execz LE_w
ds_write_b32 v132, v196
v_cmpx_lt_i32 vcc, 9, v32
ds_write_b32 v133, v197
v_cmpx_lt_i32 vcc, 10, v32
ds_write_b32 v134, v198
v_cmpx_lt_i32 vcc, 11, v32
ds_write_b32 v135, v199
v_cmpx_lt_i32 vcc, 16, v32
s_cbranch_execz LE_w
ds_write_b32 v136, v200
v_cmpx_lt_i32 vcc, 17, v32
ds_write_b32 v137, v201
v_cmpx_lt_i32 vcc, 18, v32
ds_write_b32 v138, v202
v_cmpx_lt_i32 vcc, 19, v32
ds_write_b32 v139, v203
v_cmpx_lt_i32 vcc, 24, v32
s_cbranch_execz LE_w
ds_write_b32 v140, v204
v_cmpx_lt_i32 vcc, 25, v32
ds_write_b32 v141, v205
v_cmpx_lt_i32 vcc, 26, v32
ds_write_b32 v142, v206
v_cmpx_lt_i32 vcc, 27, v32
ds_write_b32 v143, v207
v_cmpx_lt_i32 vcc, 32, v32
s_cbranch_execz LE_w
ds_write_b32 v144, v208
v_cmpx_lt_i32 vcc, 33, v32
ds_write_b32 v145, v209
v_cmpx_lt_i32 vcc, 34, v32
ds_write_b32 v146, v210
v_cmpx_lt_i32 vcc, 35, v32
ds_write_b32 v147, v211
v_cmpx_lt_i32 vcc, 40, v32
s_cbranch_execz LE_w
ds_write_b32 v148, v212
v_cmpx_lt_i32 vcc, 41, v32
ds_write_b32 v149, v213
v_cmpx_lt_i32 vcc, 42, v32
ds_write_b32 v150, v214
v_cmpx_lt_i32 vcc, 43, v32
ds_write_b32 v151, v215
v_cmpx_lt_i32 vcc, 48, v32
s_cbranch_execz LE_w
ds_write_b32 v152, v216
v_cmpx_lt_i32 vcc, 49, v32
ds_write_b32 v153, v217
v_cmpx_lt_i32 vcc, 50, v32
ds_write_b32 v154, v218
v_cmpx_lt_i32 vcc, 51, v32
ds_write_b32 v155, v219
v_cmpx_lt_i32 vcc, 56, v32
s_cbranch_execz LE_w
ds_write_b32 v156, v220
v_cmpx_lt_i32 vcc, 57, v32
ds_write_b32 v157, v221
v_cmpx_lt_i32 vcc, 58, v32
ds_write_b32 v158, v222
v_cmpx_lt_i32 vcc, 59, v32
ds_write_b32 v159, v223
v_cmpx_lt_i32 vcc, 64, v32
s_cbranch_execz LE_w
ds_write_b32 v160, v224
v_cmpx_lt_i32 vcc, 65, v32
ds_write_b32 v161, v225
v_cmpx_lt_i32 vcc, 66, v32
ds_write_b32 v162, v226
v_cmpx_lt_i32 vcc, 67, v32
ds_write_b32 v163, v227
v_cmpx_lt_i32 vcc, 72, v32
s_cbranch_execz LE_w
ds_write_b32 v164, v228
v_cmpx_lt_i32 vcc, 73, v32
ds_write_b32 v165, v229
v_cmpx_lt_i32 vcc, 74, v32
ds_write_b32 v166, v230
v_cmpx_lt_i32 vcc, 75, v32
ds_write_b32 v167, v231
v_cmpx_lt_i32 vcc, 80, v32
s_cbranch_execz LE_w
ds_write_b32 v168, v232
v_cmpx_lt_i32 vcc, 81, v32
ds_write_b32 v169, v233
v_cmpx_lt_i32 vcc, 82, v32
ds_write_b32 v170, v234
v_cmpx_lt_i32 vcc, 83, v32
ds_write_b32 v171, v235
v_cmpx_lt_i32 vcc, 88, v32
s_cbranch_execz LE_w
ds_write_b32 v172, v236
v_cmpx_lt_i32 vcc, 89, v32
ds_write_b32 v173, v237
v_cmpx_lt_i32 vcc, 90, v32
ds_write_b32 v174, v238
v_cmpx_lt_i32 vcc, 91, v32
ds_write_b32 v175, v239
v_cmpx_lt_i32 vcc, 96, v32
s_cbranch_execz LE_w
ds_write_b32 v176, v240
v_cmpx_lt_i32 vcc, 97, v32
ds_write_b32 v177, v241
v_cmpx_lt_i32 vcc, 98, v32
ds_write_b32 v178, v242
v_cmpx_lt_i32 vcc, 99, v32
ds_write_b32 v179, v243
v_cmpx_lt_i32 vcc, 104, v32
s_cbranch_execz LE_w
ds_write_b32 v180, v244
v_cmpx_lt_i32 vcc, 105, v32
ds_write_b32 v181, v245
v_cmpx_lt_i32 vcc, 106, v32
ds_write_b32 v182, v246
v_cmpx_lt_i32 vcc, 107, v32
ds_write_b32 v183, v247
v_cmpx_lt_i32 vcc, 112, v32
s_cbranch_execz LE_w
ds_write_b32 v184, v248
v_cmpx_lt_i32 vcc, 113, v32
ds_write_b32 v185, v249
v_cmpx_lt_i32 vcc, 114, v32
ds_write_b32 v186, v250
v_cmpx_lt_i32 vcc, 115, v32
ds_write_b32 v187, v251
v_cmpx_lt_i32 vcc, 120, v32
s_cbranch_execz LE_w
ds_write_b32 v188, v252
v_cmpx_lt_i32 vcc, 121, v32
ds_write_b32 v189, v253
v_cmpx_lt_i32 vcc, 122, v32
ds_write_b32 v190, v254
v_cmpx_lt_i32 vcc, 123, v32
ds_write_b32 v191, v255
LE_w:
s_mov_b64 exec, -1
s_waitcnt vmcnt(0)
s_mov_b32 s51, 0
v_lshlrev_b32 v80, 16, v76
v_lshlrev_b32 v81, 16, v77
v_lshlrev_b32 v82, 16, v78
v_mov_b32 v34, v38
ds_read2_b32 v[52:53], v34 offset0:0 offset1:4
ds_read2_b32 v[54:55], v34 offset0:8 offset1:12
s_waitcnt lgkmcnt(0)
ds_read2_b32 v[56:57], v34 offset0:16 offset1:20
ds_read2_b32 v[58:59], v34 offset0:24 offset1:28
v_mad_u32_u16 v60, v52, s49, v2
v_mad_u32_u16 v61, v53, s49, v2
v_mad_u32_u16 v62, v54, s49, v2
v_mad_u32_u16 v63, v55, s49, v2
buffer_load_dwordx4 a[0:3], v60, s[16:19], 0 offen
buffer_load_dwordx4 a[4:7], v60, s[16:19], 0 offen offset:256
buffer_load_dwordx4 a[8:11], v61, s[16:19], 0 offen
buffer_load_dwordx4 a[12:15], v61, s[16:19], 0 offen offset:256
buffer_load_dwordx4 a[16:19], v62, s[16:19], 0 offen
buffer_load_dwordx4 a[20:23], v62, s[16:19], 0 offen offset:256
buffer_load_dwordx4 a[24:27], v63, s[16:19], 0 offen
buffer_load_dwordx4 a[28:31], v63, s[16:19], 0 offen offset:256
s_waitcnt lgkmcnt(0)
ds_read2_b32 v[52:53], v34 offset0:32 offset1:36
ds_read2_b32 v[54:55], v34 offset0:40 offset1:44
v_mad_u32_u16 v60, v56, s49, v2
v_mad_u32_u16 v61, v57, s49, v2
v_mad_u32_u16 v62, v58, s49, v2
v_mad_u32_u16 v63, v59, s49, v2
buffer_load_dwordx4 a[32:35], v60, s[16:19], 0 offen
buffer_load_dwordx4 a[36:39], v60, s[16:19], 0 offen offset:256
buffer_load_dwordx4 a[40:43], v61, s[16:19], 0 offen
buffer_load_dwordx4 a[44:47], v61, s[16:19], 0 offen offset:256
buffer_load_dwordx4 a[48:51], v62, s[16:19], 0 offen
buffer_load_dwordx4 a[52:55], v62, s[16:19], 0 offen offset:256
buffer_load_dwordx4 a[56:59], v63, s[16:19], 0 offen
buffer_load_dwordx4 a[60:63], v63, s[16:19], 0 offen offset:256
s_waitcnt lgkmcnt(0)
ds_read2_b32 v[56:57], v34 offset0:48 offset1:52
ds_read2_b32 v[58:59], v34 offset0:56 offset1:60
v_mad_u32_u16 v60, v52, s49, v2
v_mad_u32_u16 v61, v53, s49, v2
v_mad_u32_u16 v62, v54, s49, v2
v_mad_u32_u16 v63, v55, s49, v2
buffer_load_dwordx4 a[64:67], v60, s[16:19], 0 offen
buffer_load_dwordx4 a[68:71], v60, s[16:19], 0 offen offset:256
buffer_load_dwordx4 a[72:75], v61, s[16:19], 0 offen
buffer_load_dwordx4 a[76:79], v61, s[16:19], 0 offen offset:256
buffer_load_dwordx4 a[80:83], v62, s[16:19], 0 offen
buffer_load_dwordx4 a[84:87], v62, s[16:19], 0 offen offset:256
buffer_load_dwordx4 a[88:91], v63, s[16:19], 0 offen
buffer_load_dwordx4 a[92:95], v63, s[16:19], 0 offen offset:256
s_waitcnt lgkmcnt(0)
ds_read2_b32 v[52:53], v34 offset0:64 offset1:68
ds_read2_b32 v[54:55], v34 offset0:72 offset1:76
v_mad_u32_u16 v60, v56, s49, v2
v_mad_u32_u16 v61, v57, s49, v2
v_mad_u32_u16 v62, v58, s49, v2
v_mad_u32_u16 v63, v59, s49, v2
buffer_load_dwordx4 a[96:99], v60, s[16:19], 0 offen
buffer_load_dwordx4 a[100:103], v60, s[16:19], 0 offen offset:256
buffer_load_dwordx4 a[104:107], v61, s[16:19], 0 offen
buffer_load_dwordx4 a[108:111], v61, s[16:19], 0 offen offset:256
buffer_load_dwordx4 a[112:115], v62, s[16:19], 0 offen
buffer_load_dwordx4 a[116:119], v62, s[16:19], 0 offen offset:256
buffer_load_dwordx4 a[120:123], v63, s[16:19], 0 offen
buffer_load_dwordx4 a[124:127], v63, s[16:19], 0 offen offset:256
s_waitcnt lgkmcnt(0)
ds_read2_b32 v[56:57], v34 offset0:80 offset1:84
ds_read2_b32 v[58:59], v34 offset0:88 offset1:92
v_mad_u32_u16 v60, v52, s49, v2
v_mad_u32_u16 v61, v53, s49, v2
v_mad_u32_u16 v62, v54, s49, v2
v_mad_u32_u16 v63, v55, s49, v2
buffer_load_dwordx4 a[128:131], v60, s[16:19], 0 offen
buffer_load_dwordx4 a[132:135], v60, s[16:19], 0 offen offset:256
buffer_load_dwordx4 a[136:139], v61, s[16:19], 0 offen
buffer_load_dwordx4 a[140:143], v61, s[16:19], 0 offen offset:256
buffer_load_dwordx4 a[144:147], v62, s[16:19], 0 offen
buffer_load_dwordx4 a[148:151], v62, s[16:19], 0 offen offset:256
buffer_load_dwordx4 a[152:155], v63, s[16:19], 0 offen
buffer_load_dwordx4 a[156:159], v63, s[16:19], 0 offen offset:256
s_waitcnt lgkmcnt(0)
ds_read2_b32 v[52:53], v34 offset0:96 offset1:100
ds_read2_b32 v[54:55], v34 offset0:104 offset1:108
v_mad_u32_u16 v60, v56, s49, v2
v_mad_u32_u16 v61, v57, s49, v2
v_mad_u32_u16 v62, v58, s49, v2
v_mad_u32_u16 v63, v59, s49, v2
buffer_load_dwordx4 a[160:163], v60, s[16:19], 0 offen
buffer_load_dwordx4 a[164:167], v60, s[16:19], 0 offen offset:256
buffer_load_dwordx4 a[168:171], v61, s[16:19], 0 offen
buffer_load_dwordx4 a[172:175], v61, s[16:19], 0 offen offset:256
buffer_load_dwordx4 a[176:179], v62, s[16:19], 0 offen
buffer_load_dwordx4 a[180:183], v62, s[16:19], 0 offen offset:256
buffer_load_dwordx4 a[184:187], v63, s[16:19], 0 offen
buffer_load_dwordx4 a[188:191], v63, s[16:19], 0 offen offset:256
s_waitcnt lgkmcnt(0)
ds_read2_b32 v[56:57], v34 offset0:112 offset1:116
ds_read2_b32 v[58:59], v34 offset0:120 offset1:124
v_mad_u32_u16 v60, v52, s49, v2
v_mad_u32_u16 v61, v53, s49, v2
v_mad_u32_u16 v62, v54, s49, v2
v_mad_u32_u16 v63, v55, s49, v2
buffer_load_dwordx4 a[192:195], v60, s[16:19], 0 offen
buffer_load_dwordx4 a[196:199], v60, s[16:19], 0 offen offset:256
buffer_load_dwordx4 a[200:203], v61, s[16:19], 0 offen
buffer_load_dwordx4 a[204:207], v61, s[16:19], 0 offen offset:256
buffer_load_dwordx4 a[208:211], v62, s[16:19], 0 offen
buffer_load_dwordx4 a[212:215], v62, s[16:19], 0 offen offset:256
buffer_load_dwordx4 a[216:219], v63, s[16:19], 0 offen
buffer_load_dwordx4 a[220:223], v63, s[16:19], 0 offen offset:256
s_waitcnt lgkmcnt(0)
ds_read2_b32 v[52:53], v34 offset0:128 offset1:132
ds_read2_b32 v[54:55], v34 offset0:136 offset1:140
v_mad_u32_u16 v60, v56, s49, v2
v_mad_u32_u16 v61, v57, s49, v2
v_mad_u32_u16 v62, v58, s49, v2
v_mad_u32_u16 v63, v59, s49, v2
buffer_load_dwordx4 a[224:227], v60, s[16:19], 0 offen
buffer_load_dwordx4 a[228:231], v60, s[16:19], 0 offen offset:256
buffer_load_dwordx4 a[232:235], v61, s[16:19], 0 offen
buffer_load_dwordx4 a[236:239], v61, s[16:19], 0 offen offset:256
buffer_load_dwordx4 a[240:243], v62, s[16:19], 0 offen
buffer_load_dwordx4 a[244:247], v62, s[16:19], 0 offen offset:256
buffer_load_dwordx4 a[248:251], v63, s[16:19], 0 offen
buffer_load_dwordx4 a[252:255], v63, s[16:19], 0 offen offset:256
v_add_u32 v34, 512, v34
s_mov_b32 s45, 0
s_lshl_b32 s47, s58, 9
LE_loop:
v_readlane_b32 s46, v37, s45
s_add_u32 s45, s45, 1
s_waitcnt vmcnt(56)
v_mfma_f32_16x16x32_bf16 v[48:51], a[0:3], v[40:43], v[48:51]
v_mfma_f32_16x16x32_bf16 v[48:51], a[4:7], v[44:47], v[48:51]
s_bitcmp1_b32 s46, 0
s_cbranch_scc0 LE_nf0
v_readlane_b32 s57, v80, s51
s_add_u32 s51, s51, 1
s_and_b32 s51, s51, 63
s_cbranch_scc1 LE_dg0
v_mov_b32 v80, v81
v_mov_b32 v81, v82
LE_dg0:
s_nop 3
v_mul_f32 v48, s57, v48
v_mul_f32 v49, s57, v49
v_mul_f32 v50, s57, v50
v_mul_f32 v51, s57, v51
s_cmp_eq_u32 s42, 0
s_cbranch_scc1 LE_fl0
buffer_load_dwordx2 v[66:67], v39, s[20:23], s47 offen sc1
s_waitcnt vmcnt(0)
v_lshlrev_b32 v64, 16, v66
v_and_b32 v65, 0xffff0000, v66
v_add_f32 v48, v48, v64
v_add_f32 v49, v49, v65
v_lshlrev_b32 v64, 16, v67
v_and_b32 v65, 0xffff0000, v67
v_add_f32 v50, v50, v64
v_add_f32 v51, v51, v65
LE_fl0:
v_cvt_pk_bf16_f32 v64, v48, v49
v_cvt_pk_bf16_f32 v65, v50, v51
v_mov_b32 v48, 0
v_mov_b32 v49, 0
v_mov_b32 v50, 0
v_mov_b32 v51, 0
buffer_store_dwordx2 v[64:65], v39, s[20:23], s47 offen sc1
s_add_u32 s47, s47, 512
LE_nf0:
v_mfma_f32_16x16x32_bf16 v[48:51], a[8:11], v[40:43], v[48:51]
v_mfma_f32_16x16x32_bf16 v[48:51], a[12:15], v[44:47], v[48:51]
s_bitcmp1_b32 s46, 1
s_cbranch_scc0 LE_nf1
v_readlane_b32 s57, v80, s51
s_add_u32 s51, s51, 1
s_and_b32 s51, s51, 63
s_cbranch_scc1 LE_dg1
v_mov_b32 v80, v81
v_mov_b32 v81, v82
LE_dg1:
s_nop 3
v_mul_f32 v48, s57, v48
v_mul_f32 v49, s57, v49
v_mul_f32 v50, s57, v50
v_mul_f32 v51, s57, v51
s_cmp_eq_u32 s42, 0
s_cbranch_scc1 LE_fl1
buffer_load_dwordx2 v[66:67], v39, s[20:23], s47 offen sc1
s_waitcnt vmcnt(0)
v_lshlrev_b32 v64, 16, v66
v_and_b32 v65, 0xffff0000, v66
v_add_f32 v48, v48, v64
v_add_f32 v49, v49, v65
v_lshlrev_b32 v64, 16, v67
v_and_b32 v65, 0xffff0000, v67
v_add_f32 v50, v50, v64
v_add_f32 v51, v51, v65
LE_fl1:
v_cvt_pk_bf16_f32 v64, v48, v49
v_cvt_pk_bf16_f32 v65, v50, v51
v_mov_b32 v48, 0
v_mov_b32 v49, 0
v_mov_b32 v50, 0
v_mov_b32 v51, 0
buffer_store_dwordx2 v[64:65], v39, s[20:23], s47 offen sc1
s_add_u32 s47, s47, 512
LE_nf1:
v_mfma_f32_16x16x32_bf16 v[48:51], a[16:19], v[40:43], v[48:51]
v_mfma_f32_16x16x32_bf16 v[48:51], a[20:23], v[44:47], v[48:51]
s_bitcmp1_b32 s46, 2
s_cbranch_scc0 LE_nf2
v_readlane_b32 s57, v80, s51
s_add_u32 s51, s51, 1
s_and_b32 s51, s51, 63
s_cbranch_scc1 LE_dg2
v_mov_b32 v80, v81
v_mov_b32 v81, v82
LE_dg2:
s_nop 3
v_mul_f32 v48, s57, v48
v_mul_f32 v49, s57, v49
v_mul_f32 v50, s57, v50
v_mul_f32 v51, s57, v51
s_cmp_eq_u32 s42, 0
s_cbranch_scc1 LE_fl2
buffer_load_dwordx2 v[66:67], v39, s[20:23], s47 offen sc1
s_waitcnt vmcnt(0)
v_lshlrev_b32 v64, 16, v66
v_and_b32 v65, 0xffff0000, v66
v_add_f32 v48, v48, v64
v_add_f32 v49, v49, v65
v_lshlrev_b32 v64, 16, v67
v_and_b32 v65, 0xffff0000, v67
v_add_f32 v50, v50, v64
v_add_f32 v51, v51, v65
LE_fl2:
v_cvt_pk_bf16_f32 v64, v48, v49
v_cvt_pk_bf16_f32 v65, v50, v51
v_mov_b32 v48, 0
v_mov_b32 v49, 0
v_mov_b32 v50, 0
v_mov_b32 v51, 0
buffer_store_dwordx2 v[64:65], v39, s[20:23], s47 offen sc1
s_add_u32 s47, s47, 512
LE_nf2:
v_mfma_f32_16x16x32_bf16 v[48:51], a[24:27], v[40:43], v[48:51]
v_mfma_f32_16x16x32_bf16 v[48:51], a[28:31], v[44:47], v[48:51]
s_bitcmp1_b32 s46, 3
s_cbranch_scc0 LE_nf3
v_readlane_b32 s57, v80, s51
s_add_u32 s51, s51, 1
s_and_b32 s51, s51, 63
s_cbranch_scc1 LE_dg3
v_mov_b32 v80, v81
v_mov_b32 v81, v82
LE_dg3:
s_nop 3
v_mul_f32 v48, s57, v48
v_mul_f32 v49, s57, v49
v_mul_f32 v50, s57, v50
v_mul_f32 v51, s57, v51
s_cmp_eq_u32 s42, 0
s_cbranch_scc1 LE_fl3
buffer_load_dwordx2 v[66:67], v39, s[20:23], s47 offen sc1
s_waitcnt vmcnt(0)
v_lshlrev_b32 v64, 16, v66
v_and_b32 v65, 0xffff0000, v66
v_add_f32 v48, v48, v64
v_add_f32 v49, v49, v65
v_lshlrev_b32 v64, 16, v67
v_and_b32 v65, 0xffff0000, v67
v_add_f32 v50, v50, v64
v_add_f32 v51, v51, v65
LE_fl3:
v_cvt_pk_bf16_f32 v64, v48, v49
v_cvt_pk_bf16_f32 v65, v50, v51
v_mov_b32 v48, 0
v_mov_b32 v49, 0
v_mov_b32 v50, 0
v_mov_b32 v51, 0
buffer_store_dwordx2 v[64:65], v39, s[20:23], s47 offen sc1
s_add_u32 s47, s47, 512
LE_nf3:
s_waitcnt lgkmcnt(0)
ds_read2_b32 v[56:57], v34 offset0:16 offset1:20
ds_read2_b32 v[58:59], v34 offset0:24 offset1:28
v_mad_u32_u16 v60, v52, s49, v2
v_mad_u32_u16 v61, v53, s49, v2
v_mad_u32_u16 v62, v54, s49, v2
v_mad_u32_u16 v63, v55, s49, v2
buffer_load_dwordx4 a[0:3], v60, s[16:19], 0 offen
buffer_load_dwordx4 a[4:7], v60, s[16:19], 0 offen offset:256
buffer_load_dwordx4 a[8:11], v61, s[16:19], 0 offen
buffer_load_dwordx4 a[12:15], v61, s[16:19], 0 offen offset:256
buffer_load_dwordx4 a[16:19], v62, s[16:19], 0 offen
buffer_load_dwordx4 a[20:23], v62, s[16:19], 0 offen offset:256
buffer_load_dwordx4 a[24:27], v63, s[16:19], 0 offen
buffer_load_dwordx4 a[28:31], v63, s[16:19], 0 offen offset:256
s_waitcnt vmcnt(56)
v_mfma_f32_16x16x32_bf16 v[48:51], a[32:35], v[40:43], v[48:51]
v_mfma_f32_16x16x32_bf16 v[48:51], a[36:39], v[44:47], v[48:51]
s_bitcmp1_b32 s46, 4
s_cbranch_scc0 LE_nf4
v_readlane_b32 s57, v80, s51
s_add_u32 s51, s51, 1
s_and_b32 s51, s51, 63
s_cbranch_scc1 LE_dg4
v_mov_b32 v80, v81
v_mov_b32 v81, v82
LE_dg4:
s_nop 3
v_mul_f32 v48, s57, v48
v_mul_f32 v49, s57, v49
v_mul_f32 v50, s57, v50
v_mul_f32 v51, s57, v51
s_cmp_eq_u32 s42, 0
s_cbranch_scc1 LE_fl4
buffer_load_dwordx2 v[66:67], v39, s[20:23], s47 offen sc1
s_waitcnt vmcnt(0)
v_lshlrev_b32 v64, 16, v66
v_and_b32 v65, 0xffff0000, v66
v_add_f32 v48, v48, v64
v_add_f32 v49, v49, v65
v_lshlrev_b32 v64, 16, v67
v_and_b32 v65, 0xffff0000, v67
v_add_f32 v50, v50, v64
v_add_f32 v51, v51, v65
LE_fl4:
v_cvt_pk_bf16_f32 v64, v48, v49
v_cvt_pk_bf16_f32 v65, v50, v51
v_mov_b32 v48, 0
v_mov_b32 v49, 0
v_mov_b32 v50, 0
v_mov_b32 v51, 0
buffer_store_dwordx2 v[64:65], v39, s[20:23], s47 offen sc1
s_add_u32 s47, s47, 512
LE_nf4:
v_mfma_f32_16x16x32_bf16 v[48:51], a[40:43], v[40:43], v[48:51]
v_mfma_f32_16x16x32_bf16 v[48:51], a[44:47], v[44:47], v[48:51]
s_bitcmp1_b32 s46, 5
s_cbranch_scc0 LE_nf5
v_readlane_b32 s57, v80, s51
s_add_u32 s51, s51, 1
s_and_b32 s51, s51, 63
s_cbranch_scc1 LE_dg5
v_mov_b32 v80, v81
v_mov_b32 v81, v82
LE_dg5:
s_nop 3
v_mul_f32 v48, s57, v48
v_mul_f32 v49, s57, v49
v_mul_f32 v50, s57, v50
v_mul_f32 v51, s57, v51
s_cmp_eq_u32 s42, 0
s_cbranch_scc1 LE_fl5
buffer_load_dwordx2 v[66:67], v39, s[20:23], s47 offen sc1
s_waitcnt vmcnt(0)
v_lshlrev_b32 v64, 16, v66
v_and_b32 v65, 0xffff0000, v66
v_add_f32 v48, v48, v64
v_add_f32 v49, v49, v65
v_lshlrev_b32 v64, 16, v67
v_and_b32 v65, 0xffff0000, v67
v_add_f32 v50, v50, v64
v_add_f32 v51, v51, v65
LE_fl5:
v_cvt_pk_bf16_f32 v64, v48, v49
v_cvt_pk_bf16_f32 v65, v50, v51
v_mov_b32 v48, 0
v_mov_b32 v49, 0
v_mov_b32 v50, 0
v_mov_b32 v51, 0
buffer_store_dwordx2 v[64:65], v39, s[20:23], s47 offen sc1
s_add_u32 s47, s47, 512
LE_nf5:
v_mfma_f32_16x16x32_bf16 v[48:51], a[48:51], v[40:43], v[48:51]
v_mfma_f32_16x16x32_bf16 v[48:51], a[52:55], v[44:47], v[48:51]
s_bitcmp1_b32 s46, 6
s_cbranch_scc0 LE_nf6
v_readlane_b32 s57, v80, s51
s_add_u32 s51, s51, 1
s_and_b32 s51, s51, 63
s_cbranch_scc1 LE_dg6
v_mov_b32 v80, v81
v_mov_b32 v81, v82
LE_dg6:
s_nop 3
v_mul_f32 v48, s57, v48
v_mul_f32 v49, s57, v49
v_mul_f32 v50, s57, v50
v_mul_f32 v51, s57, v51
s_cmp_eq_u32 s42, 0
s_cbranch_scc1 LE_fl6
buffer_load_dwordx2 v[66:67], v39, s[20:23], s47 offen sc1
s_waitcnt vmcnt(0)
v_lshlrev_b32 v64, 16, v66
v_and_b32 v65, 0xffff0000, v66
v_add_f32 v48, v48, v64
v_add_f32 v49, v49, v65
v_lshlrev_b32 v64, 16, v67
v_and_b32 v65, 0xffff0000, v67
v_add_f32 v50, v50, v64
v_add_f32 v51, v51, v65
LE_fl6:
v_cvt_pk_bf16_f32 v64, v48, v49
v_cvt_pk_bf16_f32 v65, v50, v51
v_mov_b32 v48, 0
v_mov_b32 v49, 0
v_mov_b32 v50, 0
v_mov_b32 v51, 0
buffer_store_dwordx2 v[64:65], v39, s[20:23], s47 offen sc1
s_add_u32 s47, s47, 512
LE_nf6:
v_mfma_f32_16x16x32_bf16 v[48:51], a[56:59], v[40:43], v[48:51]
v_mfma_f32_16x16x32_bf16 v[48:51], a[60:63], v[44:47], v[48:51]
s_bitcmp1_b32 s46, 7
s_cbranch_scc0 LE_nf7
v_readlane_b32 s57, v80, s51
s_add_u32 s51, s51, 1
s_and_b32 s51, s51, 63
s_cbranch_scc1 LE_dg7
v_mov_b32 v80, v81
v_mov_b32 v81, v82
LE_dg7:
s_nop 3
v_mul_f32 v48, s57, v48
v_mul_f32 v49, s57, v49
v_mul_f32 v50, s57, v50
v_mul_f32 v51, s57, v51
s_cmp_eq_u32 s42, 0
s_cbranch_scc1 LE_fl7
buffer_load_dwordx2 v[66:67], v39, s[20:23], s47 offen sc1
s_waitcnt vmcnt(0)
v_lshlrev_b32 v64, 16, v66
v_and_b32 v65, 0xffff0000, v66
v_add_f32 v48, v48, v64
v_add_f32 v49, v49, v65
v_lshlrev_b32 v64, 16, v67
v_and_b32 v65, 0xffff0000, v67
v_add_f32 v50, v50, v64
v_add_f32 v51, v51, v65
LE_fl7:
v_cvt_pk_bf16_f32 v64, v48, v49
v_cvt_pk_bf16_f32 v65, v50, v51
v_mov_b32 v48, 0
v_mov_b32 v49, 0
v_mov_b32 v50, 0
v_mov_b32 v51, 0
buffer_store_dwordx2 v[64:65], v39, s[20:23], s47 offen sc1
s_add_u32 s47, s47, 512
LE_nf7:
s_waitcnt lgkmcnt(0)
ds_read2_b32 v[52:53], v34 offset0:32 offset1:36
ds_read2_b32 v[54:55], v34 offset0:40 offset1:44
v_mad_u32_u16 v60, v56, s49, v2
v_mad_u32_u16 v61, v57, s49, v2
v_mad_u32_u16 v62, v58, s49, v2
v_mad_u32_u16 v63, v59, s49, v2
buffer_load_dwordx4 a[32:35], v60, s[16:19], 0 offen
buffer_load_dwordx4 a[36:39], v60, s[16:19], 0 offen offset:256
buffer_load_dwordx4 a[40:43], v61, s[16:19], 0 offen
buffer_load_dwordx4 a[44:47], v61, s[16:19], 0 offen offset:256
buffer_load_dwordx4 a[48:51], v62, s[16:19], 0 offen
buffer_load_dwordx4 a[52:55], v62, s[16:19], 0 offen offset:256
buffer_load_dwordx4 a[56:59], v63, s[16:19], 0 offen
buffer_load_dwordx4 a[60:63], v63, s[16:19], 0 offen offset:256
s_waitcnt vmcnt(56)
v_mfma_f32_16x16x32_bf16 v[48:51], a[64:67], v[40:43], v[48:51]
v_mfma_f32_16x16x32_bf16 v[48:51], a[68:71], v[44:47], v[48:51]
s_bitcmp1_b32 s46, 8
s_cbranch_scc0 LE_nf8
v_readlane_b32 s57, v80, s51
s_add_u32 s51, s51, 1
s_and_b32 s51, s51, 63
s_cbranch_scc1 LE_dg8
v_mov_b32 v80, v81
v_mov_b32 v81, v82
LE_dg8:
s_nop 3
v_mul_f32 v48, s57, v48
v_mul_f32 v49, s57, v49
v_mul_f32 v50, s57, v50
v_mul_f32 v51, s57, v51
s_cmp_eq_u32 s42, 0
s_cbranch_scc1 LE_fl8
buffer_load_dwordx2 v[66:67], v39, s[20:23], s47 offen sc1
s_waitcnt vmcnt(0)
v_lshlrev_b32 v64, 16, v66
v_and_b32 v65, 0xffff0000, v66
v_add_f32 v48, v48, v64
v_add_f32 v49, v49, v65
v_lshlrev_b32 v64, 16, v67
v_and_b32 v65, 0xffff0000, v67
v_add_f32 v50, v50, v64
v_add_f32 v51, v51, v65
LE_fl8:
v_cvt_pk_bf16_f32 v64, v48, v49
v_cvt_pk_bf16_f32 v65, v50, v51
v_mov_b32 v48, 0
v_mov_b32 v49, 0
v_mov_b32 v50, 0
v_mov_b32 v51, 0
buffer_store_dwordx2 v[64:65], v39, s[20:23], s47 offen sc1
s_add_u32 s47, s47, 512
LE_nf8:
v_mfma_f32_16x16x32_bf16 v[48:51], a[72:75], v[40:43], v[48:51]
v_mfma_f32_16x16x32_bf16 v[48:51], a[76:79], v[44:47], v[48:51]
s_bitcmp1_b32 s46, 9
s_cbranch_scc0 LE_nf9
v_readlane_b32 s57, v80, s51
s_add_u32 s51, s51, 1
s_and_b32 s51, s51, 63
s_cbranch_scc1 LE_dg9
v_mov_b32 v80, v81
v_mov_b32 v81, v82
LE_dg9:
s_nop 3
v_mul_f32 v48, s57, v48
v_mul_f32 v49, s57, v49
v_mul_f32 v50, s57, v50
v_mul_f32 v51, s57, v51
s_cmp_eq_u32 s42, 0
s_cbranch_scc1 LE_fl9
buffer_load_dwordx2 v[66:67], v39, s[20:23], s47 offen sc1
s_waitcnt vmcnt(0)
v_lshlrev_b32 v64, 16, v66
v_and_b32 v65, 0xffff0000, v66
v_add_f32 v48, v48, v64
v_add_f32 v49, v49, v65
v_lshlrev_b32 v64, 16, v67
v_and_b32 v65, 0xffff0000, v67
v_add_f32 v50, v50, v64
v_add_f32 v51, v51, v65
LE_fl9:
v_cvt_pk_bf16_f32 v64, v48, v49
v_cvt_pk_bf16_f32 v65, v50, v51
v_mov_b32 v48, 0
v_mov_b32 v49, 0
v_mov_b32 v50, 0
v_mov_b32 v51, 0
buffer_store_dwordx2 v[64:65], v39, s[20:23], s47 offen sc1
s_add_u32 s47, s47, 512
LE_nf9:
v_mfma_f32_16x16x32_bf16 v[48:51], a[80:83], v[40:43], v[48:51]
v_mfma_f32_16x16x32_bf16 v[48:51], a[84:87], v[44:47], v[48:51]
s_bitcmp1_b32 s46, 10
s_cbranch_scc0 LE_nf10
v_readlane_b32 s57, v80, s51
s_add_u32 s51, s51, 1
s_and_b32 s51, s51, 63
s_cbranch_scc1 LE_dg10
v_mov_b32 v80, v81
v_mov_b32 v81, v82
LE_dg10:
s_nop 3
v_mul_f32 v48, s57, v48
v_mul_f32 v49, s57, v49
v_mul_f32 v50, s57, v50
v_mul_f32 v51, s57, v51
s_cmp_eq_u32 s42, 0
s_cbranch_scc1 LE_fl10
buffer_load_dwordx2 v[66:67], v39, s[20:23], s47 offen sc1
s_waitcnt vmcnt(0)
v_lshlrev_b32 v64, 16, v66
v_and_b32 v65, 0xffff0000, v66
v_add_f32 v48, v48, v64
v_add_f32 v49, v49, v65
v_lshlrev_b32 v64, 16, v67
v_and_b32 v65, 0xffff0000, v67
v_add_f32 v50, v50, v64
v_add_f32 v51, v51, v65
LE_fl10:
v_cvt_pk_bf16_f32 v64, v48, v49
v_cvt_pk_bf16_f32 v65, v50, v51
v_mov_b32 v48, 0
v_mov_b32 v49, 0
v_mov_b32 v50, 0
v_mov_b32 v51, 0
buffer_store_dwordx2 v[64:65], v39, s[20:23], s47 offen sc1
s_add_u32 s47, s47, 512
LE_nf10:
v_mfma_f32_16x16x32_bf16 v[48:51], a[88:91], v[40:43], v[48:51]
v_mfma_f32_16x16x32_bf16 v[48:51], a[92:95], v[44:47], v[48:51]
s_bitcmp1_b32 s46, 11
s_cbranch_scc0 LE_nf11
v_readlane_b32 s57, v80, s51
s_add_u32 s51, s51, 1
s_and_b32 s51, s51, 63
s_cbranch_scc1 LE_dg11
v_mov_b32 v80, v81
v_mov_b32 v81, v82
LE_dg11:
s_nop 3
v_mul_f32 v48, s57, v48
v_mul_f32 v49, s57, v49
v_mul_f32 v50, s57, v50
v_mul_f32 v51, s57, v51
s_cmp_eq_u32 s42, 0
s_cbranch_scc1 LE_fl11
buffer_load_dwordx2 v[66:67], v39, s[20:23], s47 offen sc1
s_waitcnt vmcnt(0)
v_lshlrev_b32 v64, 16, v66
v_and_b32 v65, 0xffff0000, v66
v_add_f32 v48, v48, v64
v_add_f32 v49, v49, v65
v_lshlrev_b32 v64, 16, v67
v_and_b32 v65, 0xffff0000, v67
v_add_f32 v50, v50, v64
v_add_f32 v51, v51, v65
LE_fl11:
v_cvt_pk_bf16_f32 v64, v48, v49
v_cvt_pk_bf16_f32 v65, v50, v51
v_mov_b32 v48, 0
v_mov_b32 v49, 0
v_mov_b32 v50, 0
v_mov_b32 v51, 0
buffer_store_dwordx2 v[64:65], v39, s[20:23], s47 offen sc1
s_add_u32 s47, s47, 512
LE_nf11:
s_waitcnt lgkmcnt(0)
ds_read2_b32 v[56:57], v34 offset0:48 offset1:52
ds_read2_b32 v[58:59], v34 offset0:56 offset1:60
v_mad_u32_u16 v60, v52, s49, v2
v_mad_u32_u16 v61, v53, s49, v2
v_mad_u32_u16 v62, v54, s49, v2
v_mad_u32_u16 v63, v55, s49, v2
buffer_load_dwordx4 a[64:67], v60, s[16:19], 0 offen
buffer_load_dwordx4 a[68:71], v60, s[16:19], 0 offen offset:256
buffer_load_dwordx4 a[72:75], v61, s[16:19], 0 offen
buffer_load_dwordx4 a[76:79], v61, s[16:19], 0 offen offset:256
buffer_load_dwordx4 a[80:83], v62, s[16:19], 0 offen
buffer_load_dwordx4 a[84:87], v62, s[16:19], 0 offen offset:256
buffer_load_dwordx4 a[88:91], v63, s[16:19], 0 offen
buffer_load_dwordx4 a[92:95], v63, s[16:19], 0 offen offset:256
s_waitcnt vmcnt(56)
v_mfma_f32_16x16x32_bf16 v[48:51], a[96:99], v[40:43], v[48:51]
v_mfma_f32_16x16x32_bf16 v[48:51], a[100:103], v[44:47], v[48:51]
s_bitcmp1_b32 s46, 12
s_cbranch_scc0 LE_nf12
v_readlane_b32 s57, v80, s51
s_add_u32 s51, s51, 1
s_and_b32 s51, s51, 63
s_cbranch_scc1 LE_dg12
v_mov_b32 v80, v81
v_mov_b32 v81, v82
LE_dg12:
s_nop 3
v_mul_f32 v48, s57, v48
v_mul_f32 v49, s57, v49
v_mul_f32 v50, s57, v50
v_mul_f32 v51, s57, v51
s_cmp_eq_u32 s42, 0
s_cbranch_scc1 LE_fl12
buffer_load_dwordx2 v[66:67], v39, s[20:23], s47 offen sc1
s_waitcnt vmcnt(0)
v_lshlrev_b32 v64, 16, v66
v_and_b32 v65, 0xffff0000, v66
v_add_f32 v48, v48, v64
v_add_f32 v49, v49, v65
v_lshlrev_b32 v64, 16, v67
v_and_b32 v65, 0xffff0000, v67
v_add_f32 v50, v50, v64
v_add_f32 v51, v51, v65
LE_fl12:
v_cvt_pk_bf16_f32 v64, v48, v49
v_cvt_pk_bf16_f32 v65, v50, v51
v_mov_b32 v48, 0
v_mov_b32 v49, 0
v_mov_b32 v50, 0
v_mov_b32 v51, 0
buffer_store_dwordx2 v[64:65], v39, s[20:23], s47 offen sc1
s_add_u32 s47, s47, 512
LE_nf12:
v_mfma_f32_16x16x32_bf16 v[48:51], a[104:107], v[40:43], v[48:51]
v_mfma_f32_16x16x32_bf16 v[48:51], a[108:111], v[44:47], v[48:51]
s_bitcmp1_b32 s46, 13
s_cbranch_scc0 LE_nf13
v_readlane_b32 s57, v80, s51
s_add_u32 s51, s51, 1
s_and_b32 s51, s51, 63
s_cbranch_scc1 LE_dg13
v_mov_b32 v80, v81
v_mov_b32 v81, v82
LE_dg13:
s_nop 3
v_mul_f32 v48, s57, v48
v_mul_f32 v49, s57, v49
v_mul_f32 v50, s57, v50
v_mul_f32 v51, s57, v51
s_cmp_eq_u32 s42, 0
s_cbranch_scc1 LE_fl13
buffer_load_dwordx2 v[66:67], v39, s[20:23], s47 offen sc1
s_waitcnt vmcnt(0)
v_lshlrev_b32 v64, 16, v66
v_and_b32 v65, 0xffff0000, v66
v_add_f32 v48, v48, v64
v_add_f32 v49, v49, v65
v_lshlrev_b32 v64, 16, v67
v_and_b32 v65, 0xffff0000, v67
v_add_f32 v50, v50, v64
v_add_f32 v51, v51, v65
LE_fl13:
v_cvt_pk_bf16_f32 v64, v48, v49
v_cvt_pk_bf16_f32 v65, v50, v51
v_mov_b32 v48, 0
v_mov_b32 v49, 0
v_mov_b32 v50, 0
v_mov_b32 v51, 0
buffer_store_dwordx2 v[64:65], v39, s[20:23], s47 offen sc1
s_add_u32 s47, s47, 512
LE_nf13:
v_mfma_f32_16x16x32_bf16 v[48:51], a[112:115], v[40:43], v[48:51]
v_mfma_f32_16x16x32_bf16 v[48:51], a[116:119], v[44:47], v[48:51]
s_bitcmp1_b32 s46, 14
s_cbranch_scc0 LE_nf14
v_readlane_b32 s57, v80, s51
s_add_u32 s51, s51, 1
s_and_b32 s51, s51, 63
s_cbranch_scc1 LE_dg14
v_mov_b32 v80, v81
v_mov_b32 v81, v82
LE_dg14:
s_nop 3
v_mul_f32 v48, s57, v48
v_mul_f32 v49, s57, v49
v_mul_f32 v50, s57, v50
v_mul_f32 v51, s57, v51
s_cmp_eq_u32 s42, 0
s_cbranch_scc1 LE_fl14
buffer_load_dwordx2 v[66:67], v39, s[20:23], s47 offen sc1
s_waitcnt vmcnt(0)
v_lshlrev_b32 v64, 16, v66
v_and_b32 v65, 0xffff0000, v66
v_add_f32 v48, v48, v64
v_add_f32 v49, v49, v65
v_lshlrev_b32 v64, 16, v67
v_and_b32 v65, 0xffff0000, v67
v_add_f32 v50, v50, v64
v_add_f32 v51, v51, v65
LE_fl14:
v_cvt_pk_bf16_f32 v64, v48, v49
v_cvt_pk_bf16_f32 v65, v50, v51
v_mov_b32 v48, 0
v_mov_b32 v49, 0
v_mov_b32 v50, 0
v_mov_b32 v51, 0
buffer_store_dwordx2 v[64:65], v39, s[20:23], s47 offen sc1
s_add_u32 s47, s47, 512
LE_nf14:
v_mfma_f32_16x16x32_bf16 v[48:51], a[120:123], v[40:43], v[48:51]
v_mfma_f32_16x16x32_bf16 v[48:51], a[124:127], v[44:47], v[48:51]
s_bitcmp1_b32 s46, 15
s_cbranch_scc0 LE_nf15
v_readlane_b32 s57, v80, s51
s_add_u32 s51, s51, 1
s_and_b32 s51, s51, 63
s_cbranch_scc1 LE_dg15
v_mov_b32 v80, v81
v_mov_b32 v81, v82
LE_dg15:
s_nop 3
v_mul_f32 v48, s57, v48
v_mul_f32 v49, s57, v49
v_mul_f32 v50, s57, v50
v_mul_f32 v51, s57, v51
s_cmp_eq_u32 s42, 0
s_cbranch_scc1 LE_fl15
buffer_load_dwordx2 v[66:67], v39, s[20:23], s47 offen sc1
s_waitcnt vmcnt(0)
v_lshlrev_b32 v64, 16, v66
v_and_b32 v65, 0xffff0000, v66
v_add_f32 v48, v48, v64
v_add_f32 v49, v49, v65
v_lshlrev_b32 v64, 16, v67
v_and_b32 v65, 0xffff0000, v67
v_add_f32 v50, v50, v64
v_add_f32 v51, v51, v65
LE_fl15:
v_cvt_pk_bf16_f32 v64, v48, v49
v_cvt_pk_bf16_f32 v65, v50, v51
v_mov_b32 v48, 0
v_mov_b32 v49, 0
v_mov_b32 v50, 0
v_mov_b32 v51, 0
buffer_store_dwordx2 v[64:65], v39, s[20:23], s47 offen sc1
s_add_u32 s47, s47, 512
LE_nf15:
s_waitcnt lgkmcnt(0)
ds_read2_b32 v[52:53], v34 offset0:64 offset1:68
ds_read2_b32 v[54:55], v34 offset0:72 offset1:76
v_mad_u32_u16 v60, v56, s49, v2
v_mad_u32_u16 v61, v57, s49, v2
v_mad_u32_u16 v62, v58, s49, v2
v_mad_u32_u16 v63, v59, s49, v2
buffer_load_dwordx4 a[96:99], v60, s[16:19], 0 offen
buffer_load_dwordx4 a[100:103], v60, s[16:19], 0 offen offset:256
buffer_load_dwordx4 a[104:107], v61, s[16:19], 0 offen
buffer_load_dwordx4 a[108:111], v61, s[16:19], 0 offen offset:256
buffer_load_dwordx4 a[112:115], v62, s[16:19], 0 offen
buffer_load_dwordx4 a[116:119], v62, s[16:19], 0 offen offset:256
buffer_load_dwordx4 a[120:123], v63, s[16:19], 0 offen
buffer_load_dwordx4 a[124:127], v63, s[16:19], 0 offen offset:256
s_waitcnt vmcnt(56)
v_mfma_f32_16x16x32_bf16 v[48:51], a[128:131], v[40:43], v[48:51]
v_mfma_f32_16x16x32_bf16 v[48:51], a[132:135], v[44:47], v[48:51]
s_bitcmp1_b32 s46, 16
s_cbranch_scc0 LE_nf16
v_readlane_b32 s57, v80, s51
s_add_u32 s51, s51, 1
s_and_b32 s51, s51, 63
s_cbranch_scc1 LE_dg16
v_mov_b32 v80, v81
v_mov_b32 v81, v82
LE_dg16:
s_nop 3
v_mul_f32 v48, s57, v48
v_mul_f32 v49, s57, v49
v_mul_f32 v50, s57, v50
v_mul_f32 v51, s57, v51
s_cmp_eq_u32 s42, 0
s_cbranch_scc1 LE_fl16
buffer_load_dwordx2 v[66:67], v39, s[20:23], s47 offen sc1
s_waitcnt vmcnt(0)
v_lshlrev_b32 v64, 16, v66
v_and_b32 v65, 0xffff0000, v66
v_add_f32 v48, v48, v64
v_add_f32 v49, v49, v65
v_lshlrev_b32 v64, 16, v67
v_and_b32 v65, 0xffff0000, v67
v_add_f32 v50, v50, v64
v_add_f32 v51, v51, v65
LE_fl16:
v_cvt_pk_bf16_f32 v64, v48, v49
v_cvt_pk_bf16_f32 v65, v50, v51
v_mov_b32 v48, 0
v_mov_b32 v49, 0
v_mov_b32 v50, 0
v_mov_b32 v51, 0
buffer_store_dwordx2 v[64:65], v39, s[20:23], s47 offen sc1
s_add_u32 s47, s47, 512
LE_nf16:
v_mfma_f32_16x16x32_bf16 v[48:51], a[136:139], v[40:43], v[48:51]
v_mfma_f32_16x16x32_bf16 v[48:51], a[140:143], v[44:47], v[48:51]
s_bitcmp1_b32 s46, 17
s_cbranch_scc0 LE_nf17
v_readlane_b32 s57, v80, s51
s_add_u32 s51, s51, 1
s_and_b32 s51, s51, 63
s_cbranch_scc1 LE_dg17
v_mov_b32 v80, v81
v_mov_b32 v81, v82
LE_dg17:
s_nop 3
v_mul_f32 v48, s57, v48
v_mul_f32 v49, s57, v49
v_mul_f32 v50, s57, v50
v_mul_f32 v51, s57, v51
s_cmp_eq_u32 s42, 0
s_cbranch_scc1 LE_fl17
buffer_load_dwordx2 v[66:67], v39, s[20:23], s47 offen sc1
s_waitcnt vmcnt(0)
v_lshlrev_b32 v64, 16, v66
v_and_b32 v65, 0xffff0000, v66
v_add_f32 v48, v48, v64
v_add_f32 v49, v49, v65
v_lshlrev_b32 v64, 16, v67
v_and_b32 v65, 0xffff0000, v67
v_add_f32 v50, v50, v64
v_add_f32 v51, v51, v65
LE_fl17:
v_cvt_pk_bf16_f32 v64, v48, v49
v_cvt_pk_bf16_f32 v65, v50, v51
v_mov_b32 v48, 0
v_mov_b32 v49, 0
v_mov_b32 v50, 0
v_mov_b32 v51, 0
buffer_store_dwordx2 v[64:65], v39, s[20:23], s47 offen sc1
s_add_u32 s47, s47, 512
LE_nf17:
v_mfma_f32_16x16x32_bf16 v[48:51], a[144:147], v[40:43], v[48:51]
v_mfma_f32_16x16x32_bf16 v[48:51], a[148:151], v[44:47], v[48:51]
s_bitcmp1_b32 s46, 18
s_cbranch_scc0 LE_nf18
v_readlane_b32 s57, v80, s51
s_add_u32 s51, s51, 1
s_and_b32 s51, s51, 63
s_cbranch_scc1 LE_dg18
v_mov_b32 v80, v81
v_mov_b32 v81, v82
LE_dg18:
s_nop 3
v_mul_f32 v48, s57, v48
v_mul_f32 v49, s57, v49
v_mul_f32 v50, s57, v50
v_mul_f32 v51, s57, v51
s_cmp_eq_u32 s42, 0
s_cbranch_scc1 LE_fl18
buffer_load_dwordx2 v[66:67], v39, s[20:23], s47 offen sc1
s_waitcnt vmcnt(0)
v_lshlrev_b32 v64, 16, v66
v_and_b32 v65, 0xffff0000, v66
v_add_f32 v48, v48, v64
v_add_f32 v49, v49, v65
v_lshlrev_b32 v64, 16, v67
v_and_b32 v65, 0xffff0000, v67
v_add_f32 v50, v50, v64
v_add_f32 v51, v51, v65
LE_fl18:
v_cvt_pk_bf16_f32 v64, v48, v49
v_cvt_pk_bf16_f32 v65, v50, v51
v_mov_b32 v48, 0
v_mov_b32 v49, 0
v_mov_b32 v50, 0
v_mov_b32 v51, 0
buffer_store_dwordx2 v[64:65], v39, s[20:23], s47 offen sc1
s_add_u32 s47, s47, 512
LE_nf18:
v_mfma_f32_16x16x32_bf16 v[48:51], a[152:155], v[40:43], v[48:51]
v_mfma_f32_16x16x32_bf16 v[48:51], a[156:159], v[44:47], v[48:51]
s_bitcmp1_b32 s46, 19
s_cbranch_scc0 LE_nf19
v_readlane_b32 s57, v80, s51
s_add_u32 s51, s51, 1
s_and_b32 s51, s51, 63
s_cbranch_scc1 LE_dg19
v_mov_b32 v80, v81
v_mov_b32 v81, v82
LE_dg19:
s_nop 3
v_mul_f32 v48, s57, v48
v_mul_f32 v49, s57, v49
v_mul_f32 v50, s57, v50
v_mul_f32 v51, s57, v51
s_cmp_eq_u32 s42, 0
s_cbranch_scc1 LE_fl19
buffer_load_dwordx2 v[66:67], v39, s[20:23], s47 offen sc1
s_waitcnt vmcnt(0)
v_lshlrev_b32 v64, 16, v66
v_and_b32 v65, 0xffff0000, v66
v_add_f32 v48, v48, v64
v_add_f32 v49, v49, v65
v_lshlrev_b32 v64, 16, v67
v_and_b32 v65, 0xffff0000, v67
v_add_f32 v50, v50, v64
v_add_f32 v51, v51, v65
LE_fl19:
v_cvt_pk_bf16_f32 v64, v48, v49
v_cvt_pk_bf16_f32 v65, v50, v51
v_mov_b32 v48, 0
v_mov_b32 v49, 0
v_mov_b32 v50, 0
v_mov_b32 v51, 0
buffer_store_dwordx2 v[64:65], v39, s[20:23], s47 offen sc1
s_add_u32 s47, s47, 512
LE_nf19:
s_waitcnt lgkmcnt(0)
ds_read2_b32 v[56:57], v34 offset0:80 offset1:84
ds_read2_b32 v[58:59], v34 offset0:88 offset1:92
v_mad_u32_u16 v60, v52, s49, v2
v_mad_u32_u16 v61, v53, s49, v2
v_mad_u32_u16 v62, v54, s49, v2
v_mad_u32_u16 v63, v55, s49, v2
buffer_load_dwordx4 a[128:131], v60, s[16:19], 0 offen
buffer_load_dwordx4 a[132:135], v60, s[16:19], 0 offen offset:256
buffer_load_dwordx4 a[136:139], v61, s[16:19], 0 offen
buffer_load_dwordx4 a[140:143], v61, s[16:19], 0 offen offset:256
buffer_load_dwordx4 a[144:147], v62, s[16:19], 0 offen
buffer_load_dwordx4 a[148:151], v62, s[16:19], 0 offen offset:256
buffer_load_dwordx4 a[152:155], v63, s[16:19], 0 offen
buffer_load_dwordx4 a[156:159], v63, s[16:19], 0 offen offset:256
s_waitcnt vmcnt(56)
v_mfma_f32_16x16x32_bf16 v[48:51], a[160:163], v[40:43], v[48:51]
v_mfma_f32_16x16x32_bf16 v[48:51], a[164:167], v[44:47], v[48:51]
s_bitcmp1_b32 s46, 20
s_cbranch_scc0 LE_nf20
v_readlane_b32 s57, v80, s51
s_add_u32 s51, s51, 1
s_and_b32 s51, s51, 63
s_cbranch_scc1 LE_dg20
v_mov_b32 v80, v81
v_mov_b32 v81, v82
LE_dg20:
s_nop 3
v_mul_f32 v48, s57, v48
v_mul_f32 v49, s57, v49
v_mul_f32 v50, s57, v50
v_mul_f32 v51, s57, v51
s_cmp_eq_u32 s42, 0
s_cbranch_scc1 LE_fl20
buffer_load_dwordx2 v[66:67], v39, s[20:23], s47 offen sc1
s_waitcnt vmcnt(0)
v_lshlrev_b32 v64, 16, v66
v_and_b32 v65, 0xffff0000, v66
v_add_f32 v48, v48, v64
v_add_f32 v49, v49, v65
v_lshlrev_b32 v64, 16, v67
v_and_b32 v65, 0xffff0000, v67
v_add_f32 v50, v50, v64
v_add_f32 v51, v51, v65
LE_fl20:
v_cvt_pk_bf16_f32 v64, v48, v49
v_cvt_pk_bf16_f32 v65, v50, v51
v_mov_b32 v48, 0
v_mov_b32 v49, 0
v_mov_b32 v50, 0
v_mov_b32 v51, 0
buffer_store_dwordx2 v[64:65], v39, s[20:23], s47 offen sc1
s_add_u32 s47, s47, 512
LE_nf20:
v_mfma_f32_16x16x32_bf16 v[48:51], a[168:171], v[40:43], v[48:51]
v_mfma_f32_16x16x32_bf16 v[48:51], a[172:175], v[44:47], v[48:51]
s_bitcmp1_b32 s46, 21
s_cbranch_scc0 LE_nf21
v_readlane_b32 s57, v80, s51
s_add_u32 s51, s51, 1
s_and_b32 s51, s51, 63
s_cbranch_scc1 LE_dg21
v_mov_b32 v80, v81
v_mov_b32 v81, v82
LE_dg21:
s_nop 3
v_mul_f32 v48, s57, v48
v_mul_f32 v49, s57, v49
v_mul_f32 v50, s57, v50
v_mul_f32 v51, s57, v51
s_cmp_eq_u32 s42, 0
s_cbranch_scc1 LE_fl21
buffer_load_dwordx2 v[66:67], v39, s[20:23], s47 offen sc1
s_waitcnt vmcnt(0)
v_lshlrev_b32 v64, 16, v66
v_and_b32 v65, 0xffff0000, v66
v_add_f32 v48, v48, v64
v_add_f32 v49, v49, v65
v_lshlrev_b32 v64, 16, v67
v_and_b32 v65, 0xffff0000, v67
v_add_f32 v50, v50, v64
v_add_f32 v51, v51, v65
LE_fl21:
v_cvt_pk_bf16_f32 v64, v48, v49
v_cvt_pk_bf16_f32 v65, v50, v51
v_mov_b32 v48, 0
v_mov_b32 v49, 0
v_mov_b32 v50, 0
v_mov_b32 v51, 0
buffer_store_dwordx2 v[64:65], v39, s[20:23], s47 offen sc1
s_add_u32 s47, s47, 512
LE_nf21:
v_mfma_f32_16x16x32_bf16 v[48:51], a[176:179], v[40:43], v[48:51]
v_mfma_f32_16x16x32_bf16 v[48:51], a[180:183], v[44:47], v[48:51]
s_bitcmp1_b32 s46, 22
s_cbranch_scc0 LE_nf22
v_readlane_b32 s57, v80, s51
s_add_u32 s51, s51, 1
s_and_b32 s51, s51, 63
s_cbranch_scc1 LE_dg22
v_mov_b32 v80, v81
v_mov_b32 v81, v82
LE_dg22:
s_nop 3
v_mul_f32 v48, s57, v48
v_mul_f32 v49, s57, v49
v_mul_f32 v50, s57, v50
v_mul_f32 v51, s57, v51
s_cmp_eq_u32 s42, 0
s_cbranch_scc1 LE_fl22
buffer_load_dwordx2 v[66:67], v39, s[20:23], s47 offen sc1
s_waitcnt vmcnt(0)
v_lshlrev_b32 v64, 16, v66
v_and_b32 v65, 0xffff0000, v66
v_add_f32 v48, v48, v64
v_add_f32 v49, v49, v65
v_lshlrev_b32 v64, 16, v67
v_and_b32 v65, 0xffff0000, v67
v_add_f32 v50, v50, v64
v_add_f32 v51, v51, v65
LE_fl22:
v_cvt_pk_bf16_f32 v64, v48, v49
v_cvt_pk_bf16_f32 v65, v50, v51
v_mov_b32 v48, 0
v_mov_b32 v49, 0
v_mov_b32 v50, 0
v_mov_b32 v51, 0
buffer_store_dwordx2 v[64:65], v39, s[20:23], s47 offen sc1
s_add_u32 s47, s47, 512
LE_nf22:
v_mfma_f32_16x16x32_bf16 v[48:51], a[184:187], v[40:43], v[48:51]
v_mfma_f32_16x16x32_bf16 v[48:51], a[188:191], v[44:47], v[48:51]
s_bitcmp1_b32 s46, 23
s_cbranch_scc0 LE_nf23
v_readlane_b32 s57, v80, s51
s_add_u32 s51, s51, 1
s_and_b32 s51, s51, 63
s_cbranch_scc1 LE_dg23
v_mov_b32 v80, v81
v_mov_b32 v81, v82
LE_dg23:
s_nop 3
v_mul_f32 v48, s57, v48
v_mul_f32 v49, s57, v49
v_mul_f32 v50, s57, v50
v_mul_f32 v51, s57, v51
s_cmp_eq_u32 s42, 0
s_cbranch_scc1 LE_fl23
buffer_load_dwordx2 v[66:67], v39, s[20:23], s47 offen sc1
s_waitcnt vmcnt(0)
v_lshlrev_b32 v64, 16, v66
v_and_b32 v65, 0xffff0000, v66
v_add_f32 v48, v48, v64
v_add_f32 v49, v49, v65
v_lshlrev_b32 v64, 16, v67
v_and_b32 v65, 0xffff0000, v67
v_add_f32 v50, v50, v64
v_add_f32 v51, v51, v65
LE_fl23:
v_cvt_pk_bf16_f32 v64, v48, v49
v_cvt_pk_bf16_f32 v65, v50, v51
v_mov_b32 v48, 0
v_mov_b32 v49, 0
v_mov_b32 v50, 0
v_mov_b32 v51, 0
buffer_store_dwordx2 v[64:65], v39, s[20:23], s47 offen sc1
s_add_u32 s47, s47, 512
LE_nf23:
s_waitcnt lgkmcnt(0)
ds_read2_b32 v[52:53], v34 offset0:96 offset1:100
ds_read2_b32 v[54:55], v34 offset0:104 offset1:108
v_mad_u32_u16 v60, v56, s49, v2
v_mad_u32_u16 v61, v57, s49, v2
v_mad_u32_u16 v62, v58, s49, v2
v_mad_u32_u16 v63, v59, s49, v2
buffer_load_dwordx4 a[160:163], v60, s[16:19], 0 offen
buffer_load_dwordx4 a[164:167], v60, s[16:19], 0 offen offset:256
buffer_load_dwordx4 a[168:171], v61, s[16:19], 0 offen
buffer_load_dwordx4 a[172:175], v61, s[16:19], 0 offen offset:256
buffer_load_dwordx4 a[176:179], v62, s[16:19], 0 offen
buffer_load_dwordx4 a[180:183], v62, s[16:19], 0 offen offset:256
buffer_load_dwordx4 a[184:187], v63, s[16:19], 0 offen
buffer_load_dwordx4 a[188:191], v63, s[16:19], 0 offen offset:256
s_waitcnt vmcnt(56)
v_mfma_f32_16x16x32_bf16 v[48:51], a[192:195], v[40:43], v[48:51]
v_mfma_f32_16x16x32_bf16 v[48:51], a[196:199], v[44:47], v[48:51]
s_bitcmp1_b32 s46, 24
s_cbranch_scc0 LE_nf24
v_readlane_b32 s57, v80, s51
s_add_u32 s51, s51, 1
s_and_b32 s51, s51, 63
s_cbranch_scc1 LE_dg24
v_mov_b32 v80, v81
v_mov_b32 v81, v82
LE_dg24:
s_nop 3
v_mul_f32 v48, s57, v48
v_mul_f32 v49, s57, v49
v_mul_f32 v50, s57, v50
v_mul_f32 v51, s57, v51
s_cmp_eq_u32 s42, 0
s_cbranch_scc1 LE_fl24
buffer_load_dwordx2 v[66:67], v39, s[20:23], s47 offen sc1
s_waitcnt vmcnt(0)
v_lshlrev_b32 v64, 16, v66
v_and_b32 v65, 0xffff0000, v66
v_add_f32 v48, v48, v64
v_add_f32 v49, v49, v65
v_lshlrev_b32 v64, 16, v67
v_and_b32 v65, 0xffff0000, v67
v_add_f32 v50, v50, v64
v_add_f32 v51, v51, v65
LE_fl24:
v_cvt_pk_bf16_f32 v64, v48, v49
v_cvt_pk_bf16_f32 v65, v50, v51
v_mov_b32 v48, 0
v_mov_b32 v49, 0
v_mov_b32 v50, 0
v_mov_b32 v51, 0
buffer_store_dwordx2 v[64:65], v39, s[20:23], s47 offen sc1
s_add_u32 s47, s47, 512
LE_nf24:
v_mfma_f32_16x16x32_bf16 v[48:51], a[200:203], v[40:43], v[48:51]
v_mfma_f32_16x16x32_bf16 v[48:51], a[204:207], v[44:47], v[48:51]
s_bitcmp1_b32 s46, 25
s_cbranch_scc0 LE_nf25
v_readlane_b32 s57, v80, s51
s_add_u32 s51, s51, 1
s_and_b32 s51, s51, 63
s_cbranch_scc1 LE_dg25
v_mov_b32 v80, v81
v_mov_b32 v81, v82
LE_dg25:
s_nop 3
v_mul_f32 v48, s57, v48
v_mul_f32 v49, s57, v49
v_mul_f32 v50, s57, v50
v_mul_f32 v51, s57, v51
s_cmp_eq_u32 s42, 0
s_cbranch_scc1 LE_fl25
buffer_load_dwordx2 v[66:67], v39, s[20:23], s47 offen sc1
s_waitcnt vmcnt(0)
v_lshlrev_b32 v64, 16, v66
v_and_b32 v65, 0xffff0000, v66
v_add_f32 v48, v48, v64
v_add_f32 v49, v49, v65
v_lshlrev_b32 v64, 16, v67
v_and_b32 v65, 0xffff0000, v67
v_add_f32 v50, v50, v64
v_add_f32 v51, v51, v65
LE_fl25:
v_cvt_pk_bf16_f32 v64, v48, v49
v_cvt_pk_bf16_f32 v65, v50, v51
v_mov_b32 v48, 0
v_mov_b32 v49, 0
v_mov_b32 v50, 0
v_mov_b32 v51, 0
buffer_store_dwordx2 v[64:65], v39, s[20:23], s47 offen sc1
s_add_u32 s47, s47, 512
LE_nf25:
v_mfma_f32_16x16x32_bf16 v[48:51], a[208:211], v[40:43], v[48:51]
v_mfma_f32_16x16x32_bf16 v[48:51], a[212:215], v[44:47], v[48:51]
s_bitcmp1_b32 s46, 26
s_cbranch_scc0 LE_nf26
v_readlane_b32 s57, v80, s51
s_add_u32 s51, s51, 1
s_and_b32 s51, s51, 63
s_cbranch_scc1 LE_dg26
v_mov_b32 v80, v81
v_mov_b32 v81, v82
LE_dg26:
s_nop 3
v_mul_f32 v48, s57, v48
v_mul_f32 v49, s57, v49
v_mul_f32 v50, s57, v50
v_mul_f32 v51, s57, v51
s_cmp_eq_u32 s42, 0
s_cbranch_scc1 LE_fl26
buffer_load_dwordx2 v[66:67], v39, s[20:23], s47 offen sc1
s_waitcnt vmcnt(0)
v_lshlrev_b32 v64, 16, v66
v_and_b32 v65, 0xffff0000, v66
v_add_f32 v48, v48, v64
v_add_f32 v49, v49, v65
v_lshlrev_b32 v64, 16, v67
v_and_b32 v65, 0xffff0000, v67
v_add_f32 v50, v50, v64
v_add_f32 v51, v51, v65
LE_fl26:
v_cvt_pk_bf16_f32 v64, v48, v49
v_cvt_pk_bf16_f32 v65, v50, v51
v_mov_b32 v48, 0
v_mov_b32 v49, 0
v_mov_b32 v50, 0
v_mov_b32 v51, 0
buffer_store_dwordx2 v[64:65], v39, s[20:23], s47 offen sc1
s_add_u32 s47, s47, 512
LE_nf26:
v_mfma_f32_16x16x32_bf16 v[48:51], a[216:219], v[40:43], v[48:51]
v_mfma_f32_16x16x32_bf16 v[48:51], a[220:223], v[44:47], v[48:51]
s_bitcmp1_b32 s46, 27
s_cbranch_scc0 LE_nf27
v_readlane_b32 s57, v80, s51
s_add_u32 s51, s51, 1
s_and_b32 s51, s51, 63
s_cbranch_scc1 LE_dg27
v_mov_b32 v80, v81
v_mov_b32 v81, v82
LE_dg27:
s_nop 3
v_mul_f32 v48, s57, v48
v_mul_f32 v49, s57, v49
v_mul_f32 v50, s57, v50
v_mul_f32 v51, s57, v51
s_cmp_eq_u32 s42, 0
s_cbranch_scc1 LE_fl27
buffer_load_dwordx2 v[66:67], v39, s[20:23], s47 offen sc1
s_waitcnt vmcnt(0)
v_lshlrev_b32 v64, 16, v66
v_and_b32 v65, 0xffff0000, v66
v_add_f32 v48, v48, v64
v_add_f32 v49, v49, v65
v_lshlrev_b32 v64, 16, v67
v_and_b32 v65, 0xffff0000, v67
v_add_f32 v50, v50, v64
v_add_f32 v51, v51, v65
LE_fl27:
v_cvt_pk_bf16_f32 v64, v48, v49
v_cvt_pk_bf16_f32 v65, v50, v51
v_mov_b32 v48, 0
v_mov_b32 v49, 0
v_mov_b32 v50, 0
v_mov_b32 v51, 0
buffer_store_dwordx2 v[64:65], v39, s[20:23], s47 offen sc1
s_add_u32 s47, s47, 512
LE_nf27:
s_waitcnt lgkmcnt(0)
ds_read2_b32 v[56:57], v34 offset0:112 offset1:116
ds_read2_b32 v[58:59], v34 offset0:120 offset1:124
v_mad_u32_u16 v60, v52, s49, v2
v_mad_u32_u16 v61, v53, s49, v2
v_mad_u32_u16 v62, v54, s49, v2
v_mad_u32_u16 v63, v55, s49, v2
buffer_load_dwordx4 a[192:195], v60, s[16:19], 0 offen
buffer_load_dwordx4 a[196:199], v60, s[16:19], 0 offen offset:256
buffer_load_dwordx4 a[200:203], v61, s[16:19], 0 offen
buffer_load_dwordx4 a[204:207], v61, s[16:19], 0 offen offset:256
buffer_load_dwordx4 a[208:211], v62, s[16:19], 0 offen
buffer_load_dwordx4 a[212:215], v62, s[16:19], 0 offen offset:256
buffer_load_dwordx4 a[216:219], v63, s[16:19], 0 offen
buffer_load_dwordx4 a[220:223], v63, s[16:19], 0 offen offset:256
s_waitcnt vmcnt(56)
v_mfma_f32_16x16x32_bf16 v[48:51], a[224:227], v[40:43], v[48:51]
v_mfma_f32_16x16x32_bf16 v[48:51], a[228:231], v[44:47], v[48:51]
s_bitcmp1_b32 s46, 28
s_cbranch_scc0 LE_nf28
v_readlane_b32 s57, v80, s51
s_add_u32 s51, s51, 1
s_and_b32 s51, s51, 63
s_cbranch_scc1 LE_dg28
v_mov_b32 v80, v81
v_mov_b32 v81, v82
LE_dg28:
s_nop 3
v_mul_f32 v48, s57, v48
v_mul_f32 v49, s57, v49
v_mul_f32 v50, s57, v50
v_mul_f32 v51, s57, v51
s_cmp_eq_u32 s42, 0
s_cbranch_scc1 LE_fl28
buffer_load_dwordx2 v[66:67], v39, s[20:23], s47 offen sc1
s_waitcnt vmcnt(0)
v_lshlrev_b32 v64, 16, v66
v_and_b32 v65, 0xffff0000, v66
v_add_f32 v48, v48, v64
v_add_f32 v49, v49, v65
v_lshlrev_b32 v64, 16, v67
v_and_b32 v65, 0xffff0000, v67
v_add_f32 v50, v50, v64
v_add_f32 v51, v51, v65
LE_fl28:
v_cvt_pk_bf16_f32 v64, v48, v49
v_cvt_pk_bf16_f32 v65, v50, v51
v_mov_b32 v48, 0
v_mov_b32 v49, 0
v_mov_b32 v50, 0
v_mov_b32 v51, 0
buffer_store_dwordx2 v[64:65], v39, s[20:23], s47 offen sc1
s_add_u32 s47, s47, 512
LE_nf28:
v_mfma_f32_16x16x32_bf16 v[48:51], a[232:235], v[40:43], v[48:51]
v_mfma_f32_16x16x32_bf16 v[48:51], a[236:239], v[44:47], v[48:51]
s_bitcmp1_b32 s46, 29
s_cbranch_scc0 LE_nf29
v_readlane_b32 s57, v80, s51
s_add_u32 s51, s51, 1
s_and_b32 s51, s51, 63
s_cbranch_scc1 LE_dg29
v_mov_b32 v80, v81
v_mov_b32 v81, v82
LE_dg29:
s_nop 3
v_mul_f32 v48, s57, v48
v_mul_f32 v49, s57, v49
v_mul_f32 v50, s57, v50
v_mul_f32 v51, s57, v51
s_cmp_eq_u32 s42, 0
s_cbranch_scc1 LE_fl29
buffer_load_dwordx2 v[66:67], v39, s[20:23], s47 offen sc1
s_waitcnt vmcnt(0)
v_lshlrev_b32 v64, 16, v66
v_and_b32 v65, 0xffff0000, v66
v_add_f32 v48, v48, v64
v_add_f32 v49, v49, v65
v_lshlrev_b32 v64, 16, v67
v_and_b32 v65, 0xffff0000, v67
v_add_f32 v50, v50, v64
v_add_f32 v51, v51, v65
LE_fl29:
v_cvt_pk_bf16_f32 v64, v48, v49
v_cvt_pk_bf16_f32 v65, v50, v51
v_mov_b32 v48, 0
v_mov_b32 v49, 0
v_mov_b32 v50, 0
v_mov_b32 v51, 0
buffer_store_dwordx2 v[64:65], v39, s[20:23], s47 offen sc1
s_add_u32 s47, s47, 512
LE_nf29:
v_mfma_f32_16x16x32_bf16 v[48:51], a[240:243], v[40:43], v[48:51]
v_mfma_f32_16x16x32_bf16 v[48:51], a[244:247], v[44:47], v[48:51]
s_bitcmp1_b32 s46, 30
s_cbranch_scc0 LE_nf30
v_readlane_b32 s57, v80, s51
s_add_u32 s51, s51, 1
s_and_b32 s51, s51, 63
s_cbranch_scc1 LE_dg30
v_mov_b32 v80, v81
v_mov_b32 v81, v82
LE_dg30:
s_nop 3
v_mul_f32 v48, s57, v48
v_mul_f32 v49, s57, v49
v_mul_f32 v50, s57, v50
v_mul_f32 v51, s57, v51
s_cmp_eq_u32 s42, 0
s_cbranch_scc1 LE_fl30
buffer_load_dwordx2 v[66:67], v39, s[20:23], s47 offen sc1
s_waitcnt vmcnt(0)
v_lshlrev_b32 v64, 16, v66
v_and_b32 v65, 0xffff0000, v66
v_add_f32 v48, v48, v64
v_add_f32 v49, v49, v65
v_lshlrev_b32 v64, 16, v67
v_and_b32 v65, 0xffff0000, v67
v_add_f32 v50, v50, v64
v_add_f32 v51, v51, v65
LE_fl30:
v_cvt_pk_bf16_f32 v64, v48, v49
v_cvt_pk_bf16_f32 v65, v50, v51
v_mov_b32 v48, 0
v_mov_b32 v49, 0
v_mov_b32 v50, 0
v_mov_b32 v51, 0
buffer_store_dwordx2 v[64:65], v39, s[20:23], s47 offen sc1
s_add_u32 s47, s47, 512
LE_nf30:
v_mfma_f32_16x16x32_bf16 v[48:51], a[248:251], v[40:43], v[48:51]
v_mfma_f32_16x16x32_bf16 v[48:51], a[252:255], v[44:47], v[48:51]
s_bitcmp1_b32 s46, 31
s_cbranch_scc0 LE_nf31
v_readlane_b32 s57, v80, s51
s_add_u32 s51, s51, 1
s_and_b32 s51, s51, 63
s_cbranch_scc1 LE_dg31
v_mov_b32 v80, v81
v_mov_b32 v81, v82
LE_dg31:
s_nop 3
v_mul_f32 v48, s57, v48
v_mul_f32 v49, s57, v49
v_mul_f32 v50, s57, v50
v_mul_f32 v51, s57, v51
s_cmp_eq_u32 s42, 0
s_cbranch_scc1 LE_fl31
buffer_load_dwordx2 v[66:67], v39, s[20:23], s47 offen sc1
s_waitcnt vmcnt(0)
v_lshlrev_b32 v64, 16, v66
v_and_b32 v65, 0xffff0000, v66
v_add_f32 v48, v48, v64
v_add_f32 v49, v49, v65
v_lshlrev_b32 v64, 16, v67
v_and_b32 v65, 0xffff0000, v67
v_add_f32 v50, v50, v64
v_add_f32 v51, v51, v65
LE_fl31:
v_cvt_pk_bf16_f32 v64, v48, v49
v_cvt_pk_bf16_f32 v65, v50, v51
v_mov_b32 v48, 0
v_mov_b32 v49, 0
v_mov_b32 v50, 0
v_mov_b32 v51, 0
buffer_store_dwordx2 v[64:65], v39, s[20:23], s47 offen sc1
s_add_u32 s47, s47, 512
LE_nf31:
s_waitcnt lgkmcnt(0)
ds_read2_b32 v[52:53], v34 offset0:128 offset1:132
ds_read2_b32 v[54:55], v34 offset0:136 offset1:140
v_mad_u32_u16 v60, v56, s49, v2
v_mad_u32_u16 v61, v57, s49, v2
v_mad_u32_u16 v62, v58, s49, v2
v_mad_u32_u16 v63, v59, s49, v2
buffer_load_dwordx4 a[224:227], v60, s[16:19], 0 offen
buffer_load_dwordx4 a[228:231], v60, s[16:19], 0 offen offset:256
buffer_load_dwordx4 a[232:235], v61, s[16:19], 0 offen
buffer_load_dwordx4 a[236:239], v61, s[16:19], 0 offen offset:256
buffer_load_dwordx4 a[240:243], v62, s[16:19], 0 offen
buffer_load_dwordx4 a[244:247], v62, s[16:19], 0 offen offset:256
buffer_load_dwordx4 a[248:251], v63, s[16:19], 0 offen
buffer_load_dwordx4 a[252:255], v63, s[16:19], 0 offen offset:256
v_add_u32 v34, 512, v34
s_cmp_lt_u32 s45, s44
s_cbranch_scc1 LE_loop
s_add_u32 s42, s42, 1
s_mul_i32 s43, s42, 128
v_cmp_lt_u32 vcc, s43, v4
s_cbranch_vccz LE_done
s_cmp_ge_u32 s42, 40
s_cbranch_scc1 LE_done
s_waitcnt vmcnt(0) lgkmcnt(0)
s_add_u32 s50, s50, 512
v_add_u32 v5, 0x80, v5
buffer_load_dwordx4 v[192:195], v6, s[12:15], s50 offen offset:0
buffer_load_dwordx4 v[196:199], v6, s[12:15], s50 offen offset:32
buffer_load_dwordx4 v[200:203], v6, s[12:15], s50 offen offset:64
buffer_load_dwordx4 v[204:207], v6, s[12:15], s50 offen offset:96
buffer_load_dwordx4 v[208:211], v6, s[12:15], s50 offen offset:128
buffer_load_dwordx4 v[212:215], v6, s[12:15], s50 offen offset:160
buffer_load_dwordx4 v[216:219], v6, s[12:15], s50 offen offset:192
buffer_load_dwordx4 v[220:223], v6, s[12:15], s50 offen offset:224
buffer_load_dwordx4 v[224:227], v6, s[12:15], s50 offen offset:256
buffer_load_dwordx4 v[228:231], v6, s[12:15], s50 offen offset:288
buffer_load_dwordx4 v[232:235], v6, s[12:15], s50 offen offset:320
buffer_load_dwordx4 v[236:239], v6, s[12:15], s50 offen offset:352
buffer_load_dwordx4 v[240:243], v6, s[12:15], s50 offen offset:384
buffer_load_dwordx4 v[244:247], v6, s[12:15], s50 offen offset:416
buffer_load_dwordx4 v[248:251], v6, s[12:15], s50 offen offset:448
buffer_load_dwordx4 v[252:255], v6, s[12:15], s50 offen offset:480
s_branch LE_pass
LE_done:
s_add_u32 s52, s4, 0x7c00000
s_addc_u32 s53, s5, 0
s_mov_b32 s54, 0x2000
s_mov_b32 s55, 0x00020000
v_mov_b32 v20, 5120
v_mov_b32 v21, 1
s_mov_b64 exec, 1
s_waitcnt vmcnt(0)
buffer_atomic_add v21, v20, s[52:55], 0 offen
s_mov_b64 exec, -1
s_getpc_b64 s[52:53]
LE_pc:
s_sub_u32 s52, s52, LE_pc-L2_tails
s_subb_u32 s53, s53, 0
s_mov_b32 s54, LT_disp-L2_tails
s_mov_b32 s55, 0x00020000
s_mov_b64 exec, -1
v_lshlrev_b32 v30, 7, v1
s_mov_b32 s56, 0x0
buffer_load_dword v32, v30, s[52:55], s56 offen
s_mov_b32 s56, 0x2000
buffer_load_dword v33, v30, s[52:55], s56 offen
s_mov_b32 s56, 0x4000
buffer_load_dword v34, v30, s[52:55], s56 offen
s_mov_b32 s56, 0x6000
buffer_load_dword v35, v30, s[52:55], s56 offen
s_mov_b32 s56, 0x8000
buffer_load_dword v36, v30, s[52:55], s56 offen
s_mov_b32 s56, 0xa000
buffer_load_dword v37, v30, s[52:55], s56 offen
s_mov_b32 s56, 0xc000
buffer_load_dword v38, v30, s[52:55], s56 offen
s_cmp_ge_u32 s2, 240
s_cbranch_scc1 LC_help
s_branch L2_end
LC_help:
s_waitcnt vmcnt(0)
s_mov_b32 s100, 0
s_load_dwordx2 s[6:7], s[0:1], 0
s_load_dwordx2 s[18:19], s[0:1], 72
s_mov_b32 s34, s41
v_mbcnt_lo_u32_b32 v252, -1, 0
v_mbcnt_hi_u32_b32 v252, -1, v252
v_lshlrev_b32 v252, 4, v252
s_and_b32 s32, s2, 7
s_mul_i32 s32, s32, 5
s_bfe_u32 s33, s2, 0x10003
s_mul_i32 s35, s33, 3
s_add_u32 s32, s32, s35
s_add_u32 s35, s32, 0
s_lshl_b32 s48, s35, 7
s_lshl_b32 s52, s35, 17
s_add_u32 s52, s52, 122880
s_add_u32 s35, s32, 1
s_lshl_b32 s49, s35, 7
s_lshl_b32 s53, s35, 17
s_add_u32 s53, s53, 122880
s_add_u32 s35, s32, 2
s_lshl_b32 s50, s35, 7
s_lshl_b32 s54, s35, 17
s_add_u32 s54, s54, 122880
s_cmp_eq_u32 s49, 4992
s_cselect_b32 s53, 5111808, s53
s_cmp_eq_u32 s33, 1
s_cselect_b32 s54, 0x7fff0000, s54
s_cselect_b32 s50, s48, s50
s_mov_b32 s15, 0x7fff0000
s_mov_b32 s14, 0
s_mov_b32 s99, 0
s_mov_b32 s51, 0
s_mov_b32 s98, 2
s_waitcnt lgkmcnt(0)
s_add_u32 s24, s4, 0x6000000
s_addc_u32 s25, s5, 0
s_mov_b32 s26, 0x9c800
s_mov_b32 s27, 0x00020000
s_add_u32 s56, s4, 0x1000000
s_addc_u32 s57, s5, 0
s_mov_b32 s58, 0x6c02000
s_mov_b32 s59, 0x00020000
s_branch LC_common
L2_fin:
L2_end:
s_endpgm
.section .rodata,"a"
.p2align 6
.amdhsa_kernel k1_kernel
  .amdhsa_next_free_vgpr 256
  .amdhsa_next_free_sgpr 102
  .amdhsa_accum_offset 256
  .amdhsa_group_segment_fixed_size 0
  .amdhsa_kernarg_size 96
  .amdhsa_user_sgpr_count 2
  .amdhsa_user_sgpr_kernarg_segment_ptr 1
  .amdhsa_system_sgpr_workgroup_id_x 1
.end_amdhsa_kernel
.p2align 6
.amdhsa_kernel k2_kernel
  .amdhsa_next_free_vgpr 512
  .amdhsa_next_free_sgpr 102
  .amdhsa_accum_offset 256
  .amdhsa_group_segment_fixed_size 0
  .amdhsa_kernarg_size 96
  .amdhsa_user_sgpr_count 2
  .amdhsa_user_sgpr_kernarg_segment_ptr 1
  .amdhsa_system_sgpr_workgroup_id_x 1
.end_amdhsa_kernel
```

```asm
; @launch kernel=k1_kernel grid=(249,1,1) block=(512,1,1) lds=163840
; @launch kernel=k2_kernel grid=(256,1,1) block=(256,1,1) lds=163840
.amdgcn_target "amdgcn-amd-amdhsa--gfx950"
.text
.globl k1_kernel
.p2align 8
.type k1_kernel,@function
k1_kernel:
s_getpc_b64 s[56:57]
s_load_dwordx16 s[16:31], s[0:1], 0
s_load_dwordx8 s[32:39], s[0:1], 64
s_cmp_ge_u32 s2, 249
s_cbranch_scc1 L1_end
v_lshrrev_b32 v1, 6, v0
v_and_b32 v2, 63, v0
s_lshr_b32 s3, s2, 3
v_readfirstlane_b32 s60, v1
s_mul_i32 s5, s3, 8
s_add_u32 s5, s5, s60
s_and_b32 s56, s56, 0xffffff00
s_mov_b32 s58, L2_end-k1_kernel
s_mov_b32 s59, 0x00020000
s_and_b32 s6, s5, 15
s_lshl_b32 s6, s6, 13
v_lshlrev_b32 v10, 7, v2
buffer_load_dword v255, v10, s[56:59], s6 offen
v_and_b32 v3, 15, v2
v_lshrrev_b32 v4, 4, v2
s_and_b32 s62, s3, 7
s_sub_u32 s4, s2, 40
s_cmp_lt_u32 s2, 40
s_cbranch_scc1 L1_notq
s_mov_b32 s61, 0
v_lshlrev_b32 v16, 4, v2
s_mul_i32 s63, s60, 6144
s_mul_i32 s6, s4, 24576
s_mul_i32 s7, s60, 3072
s_add_u32 s64, s6, s7
s_add_u32 s65, s64, 4096
s_lshl_b32 s7, s60, 6
v_lshrrev_b32 v5, 2, v2
v_and_b32 v6, 3, v2
v_lshrrev_b32 v7, 5, v2
v_lshlrev_b32 v7, 1, v7
v_xor_b32 v6, v6, v7
v_lshl_add_u32 v5, v5, 9, s7
v_lshl_add_u32 v17, v6, 4, v5
v_add_u32 v18, 0x1c00, v17
s_xor_b32 s6, s62, 0
s_lshl_b32 s66, s6, 14
s_xor_b32 s6, s62, 1
s_lshl_b32 s67, s6, 14
s_xor_b32 s6, s62, 2
s_lshl_b32 s68, s6, 14
s_xor_b32 s6, s62, 3
s_lshl_b32 s69, s6, 14
s_xor_b32 s6, s62, 4
s_lshl_b32 s70, s6, 14
s_xor_b32 s6, s62, 5
s_lshl_b32 s71, s6, 14
s_xor_b32 s6, s62, 6
s_lshl_b32 s72, s6, 14
s_xor_b32 s6, s62, 7
s_lshl_b32 s73, s6, 14
s_waitcnt lgkmcnt(0)
s_add_u32 s40, s16, 0x0
s_addc_u32 s41, s17, 0
s_mov_b32 s42, 0x4e2000
s_mov_b32 s43, 0x00020000
s_add_u32 s44, s26, 0x0
s_addc_u32 s45, s27, 0
s_mov_b32 s46, 0x20000
s_mov_b32 s47, 0x00020000
buffer_load_dwordx4 v[40:43], v16, s[40:43], s64 offen offset:0
buffer_load_dwordx4 v[44:47], v16, s[40:43], s64 offen offset:1024
buffer_load_dwordx4 v[48:51], v16, s[40:43], s64 offen offset:2048
s_add_u32 m0, s63, 0x0
s_nop 0
buffer_load_dwordx4 v17, s[44:47], s66 offen offset:0 lds
buffer_load_dwordx4 v18, s[44:47], s66 offen offset:1024 lds
s_add_u32 m0, s63, 0x800
s_nop 0
buffer_load_dwordx4 v17, s[44:47], s67 offen offset:0 lds
buffer_load_dwordx4 v18, s[44:47], s67 offen offset:1024 lds
v_bfe_u32 v5, v2, 2, 3
v_xor_b32 v5, s62, v5
v_and_b32 v6, 3, v2
v_lshlrev_b32 v7, 10, v5
v_lshl_add_u32 v7, v6, 8, v7
v_add_u32 v7, 0xc000, v7
v_and_b32 v5, 1, v5
v_lshl_or_b32 v6, v5, 2, v6
v_lshrrev_b32 v5, 5, v2
s_mul_i32 s6, s60, 6
v_add3_u32 v8, v5, s6, 0
v_lshrrev_b32 v9, 4, v8
v_lshl_add_u32 v9, v9, 13, v7
v_and_b32 v8, 15, v8
v_xor_b32 v8, v8, v6
v_lshl_add_u32 v36, v8, 4, v9
v_add3_u32 v8, v5, s6, 2
v_lshrrev_b32 v9, 4, v8
v_lshl_add_u32 v9, v9, 13, v7
v_and_b32 v8, 15, v8
v_xor_b32 v8, v8, v6
v_lshl_add_u32 v37, v8, 4, v9
v_add3_u32 v8, v5, s6, 4
v_lshrrev_b32 v9, 4, v8
v_lshl_add_u32 v9, v9, 13, v7
v_and_b32 v8, 15, v8
v_xor_b32 v8, v8, v6
v_lshl_add_u32 v38, v8, 4, v9
v_xor_b32 v5, v3, v4
v_lshlrev_b32 v5, 4, v5
v_lshl_add_u32 v5, v4, 8, v5
v_add_u32 v31, 0xc000, v5
v_xor_b32 v32, 64, v31
v_lshrrev_b32 v5, 2, v3
v_and_b32 v6, 3, v3
v_and_b32 v7, 1, v4
v_lshlrev_b32 v7, 1, v7
v_lshl_add_u32 v8, v4, 3, v5
v_lshlrev_b32 v8, 6, v8
v_add_u32 v8, s63, v8
v_and_b32 v9, 1, v6
v_lshl_add_u32 v8, v9, 3, v8
v_lshrrev_b32 v6, 1, v6
v_xor_b32 v6, v6, v7
v_xor_b32 v9, 0, v6
v_lshl_add_u32 v25, v9, 4, v8
v_xor_b32 v9, 2, v6
v_lshl_add_u32 v26, v9, 4, v8
v_lshrrev_b32 v5, 3, v2
v_and_b32 v6, 7, v2
v_lshrrev_b32 v7, 1, v5
v_xor_b32 v6, v6, v7
v_and_b32 v7, 4, v5
v_add_u32 v5, v5, v7
s_mul_i32 s6, s60, 16384
v_lshl_add_u32 v5, v5, 9, s6
v_lshl_add_u32 v21, v6, 4, v5
v_xor_b32 v6, 4, v6
v_lshl_add_u32 v22, v6, 4, v5
v_add_u32 v22, 0x1c00, v22
s_lshr_b32 s7, s62, 1
s_xor_b32 s6, s7, 0
s_lshl_b32 s74, s6, 7
s_add_u32 s75, s74, 2048
s_xor_b32 s6, s7, 1
s_lshl_b32 s76, s6, 7
s_add_u32 s77, s76, 2048
s_xor_b32 s6, s7, 2
s_lshl_b32 s78, s6, 7
s_add_u32 s79, s78, 2048
s_xor_b32 s6, s7, 3
s_lshl_b32 s80, s6, 7
s_add_u32 s81, s80, 2048
s_and_b32 s6, s62, 1
s_lshl_b32 s6, s6, 2
v_lshrrev_b32 v5, 1, v3
v_xor_b32 v5, v5, v4
v_xor_b32 v5, s6, v5
v_lshl_add_u32 v6, v3, 7, s63
v_lshl_add_u32 v29, v5, 4, v6
v_xor_b32 v30, 64, v29
s_mul_i32 s6, s60, 1
s_xor_b32 s6, s6, s62
s_lshl_b32 s6, s6, 10
s_add_u32 s6, s6, 0x12000
v_lshrrev_b32 v5, 1, v4
v_and_b32 v6, 1, v4
v_lshl_add_u32 v5, v5, 8, s6
v_lshl_add_u32 v5, v6, 3, v5
v_lshl_add_u32 v33, v3, 4, v5
v_xor_b32 v34, 0x400, v33
v_add_u32 v35, 0x12000, v16
s_mul_i32 s6, s4, 24576
s_mul_i32 s7, s60, 1024
s_add_u32 s82, s6, s7
s_add_u32 s83, s82, 8192
s_add_u32 s84, s82, 16384
s_mov_b32 s86, 0x3db8aa3b
s_mov_b32 s87, 0x3db8aa3b
s_mov_b32 s88, 0x3727c5ac
s_mov_b32 s89, 0x3b800000
s_mov_b32 s90, 0xffff0000
s_add_u32 s48, s28, 0x0
s_addc_u32 s49, s29, 0
s_mov_b32 s50, 0x20000
s_mov_b32 s51, 0x00020000
s_add_u32 s52, s38, 0x0
s_addc_u32 s53, s39, 0
s_mov_b32 s54, 0x4e4000
s_mov_b32 s55, 0x00020000
s_add_u32 s56, s38, 0x6800000
s_addc_u32 s57, s39, 0
s_mov_b32 s58, 0x4e4000
s_mov_b32 s59, 0x00020000
v_lshlrev_b32 v11, 4, v4
s_lshr_b32 s8, s66, 8
buffer_load_dwordx4 v[172:175], v11, s[48:51], s8 offen
s_lshr_b32 s8, s67, 8
buffer_load_dwordx4 v[176:179], v11, s[48:51], s8 offen
s_lshr_b32 s8, s68, 8
buffer_load_dwordx4 v[180:183], v11, s[48:51], s8 offen
s_lshr_b32 s8, s69, 8
buffer_load_dwordx4 v[184:187], v11, s[48:51], s8 offen
s_lshr_b32 s8, s70, 8
buffer_load_dwordx4 v[188:191], v11, s[48:51], s8 offen
s_lshr_b32 s8, s71, 8
buffer_load_dwordx4 v[192:195], v11, s[48:51], s8 offen
s_lshr_b32 s8, s72, 8
buffer_load_dwordx4 v[196:199], v11, s[48:51], s8 offen
s_lshr_b32 s8, s73, 8
buffer_load_dwordx4 v[200:203], v11, s[48:51], s8 offen
s_waitcnt vmcnt(14)
v_lshlrev_b32 v76, 16, v40
v_and_b32 v77, s90, v40
v_lshlrev_b32 v78, 16, v41
v_and_b32 v79, s90, v41
v_lshlrev_b32 v80, 16, v42
v_and_b32 v81, s90, v42
v_lshlrev_b32 v82, 16, v43
v_and_b32 v83, s90, v43
v_pk_add_f32 v[100:101], v[76:77], v[78:79]
v_pk_mul_f32 v[102:103], v[76:77], v[76:77]
v_pk_add_f32 v[40:41], v[80:81], v[82:83]
v_pk_fma_f32 v[102:103], v[78:79], v[78:79], v[102:103]
v_pk_add_f32 v[100:101], v[100:101], v[40:41]
v_pk_fma_f32 v[102:103], v[80:81], v[80:81], v[102:103]
v_add_f32 v100, v100, v101
v_pk_fma_f32 v[102:103], v[82:83], v[82:83], v[102:103]
v_add_f32 v102, v102, v103
s_waitcnt vmcnt(13)
v_lshlrev_b32 v84, 16, v44
v_and_b32 v85, s90, v44
v_lshlrev_b32 v86, 16, v45
v_and_b32 v87, s90, v45
v_lshlrev_b32 v88, 16, v46
v_and_b32 v89, s90, v46
v_lshlrev_b32 v90, 16, v47
v_and_b32 v91, s90, v47
v_pk_add_f32 v[104:105], v[84:85], v[86:87]
v_pk_mul_f32 v[106:107], v[84:85], v[84:85]
v_pk_add_f32 v[44:45], v[88:89], v[90:91]
v_pk_fma_f32 v[106:107], v[86:87], v[86:87], v[106:107]
v_pk_add_f32 v[104:105], v[104:105], v[44:45]
v_pk_fma_f32 v[106:107], v[88:89], v[88:89], v[106:107]
v_add_f32 v104, v104, v105
v_pk_fma_f32 v[106:107], v[90:91], v[90:91], v[106:107]
v_add_f32 v106, v106, v107
s_waitcnt vmcnt(12)
v_lshlrev_b32 v92, 16, v48
v_and_b32 v93, s90, v48
v_lshlrev_b32 v94, 16, v49
v_and_b32 v95, s90, v49
v_lshlrev_b32 v96, 16, v50
v_and_b32 v97, s90, v50
v_lshlrev_b32 v98, 16, v51
v_and_b32 v99, s90, v51
v_pk_add_f32 v[108:109], v[92:93], v[94:95]
v_pk_mul_f32 v[110:111], v[92:93], v[92:93]
v_pk_add_f32 v[48:49], v[96:97], v[98:99]
v_pk_fma_f32 v[110:111], v[94:95], v[94:95], v[110:111]
v_pk_add_f32 v[108:109], v[108:109], v[48:49]
v_pk_fma_f32 v[110:111], v[96:97], v[96:97], v[110:111]
v_add_f32 v108, v108, v109
v_pk_fma_f32 v[110:111], v[98:99], v[98:99], v[110:111]
v_add_f32 v110, v110, v111
v_permlane16_swap_b32 v100, v102
v_permlane16_swap_b32 v104, v106
v_permlane16_swap_b32 v108, v110
v_add_f32 v100, v100, v102
v_add_f32 v104, v104, v106
v_add_f32 v108, v108, v110
v_add_f32_dpp v101, v100, v100 row_ror:8 row_mask:0xf bank_mask:0x3
v_add_f32_dpp v101, v104, v104 row_ror:8 row_mask:0xf bank_mask:0xc
v_add_f32_dpp v109, v108, v108 row_ror:8 row_mask:0xf bank_mask:0xf
s_nop 0
v_add_f32_dpp v102, v101, v101 row_half_mirror row_mask:0xf bank_mask:0x5
v_add_f32_dpp v102, v109, v109 row_half_mirror row_mask:0xf bank_mask:0xa
s_nop 1
v_add_f32_dpp v102, v102, v102 quad_perm:[1,0,3,2] row_mask:0xf bank_mask:0xf
s_nop 1
v_add_f32_dpp v102, v102, v102 quad_perm:[2,3,0,1] row_mask:0xf bank_mask:0xf
v_mov_b32 v103, v102
s_nop 1
v_permlane16_swap_b32 v103, v102
v_mul_f32 v103, s89, v103
v_mul_f32 v102, s89, v102
v_fma_f32 v102, -v103, v103, v102
v_max_f32 v102, 0, v102
v_cvt_pk_bf16_f32 v102, v102, v102
v_and_b32 v102, s90, v102
v_add_f32 v102, s88, v102
v_cvt_pk_bf16_f32 v102, v102, v102
v_and_b32 v102, s90, v102
v_sqrt_f32 v102, v102
s_nop 0
v_cvt_pk_bf16_f32 v102, v102, v102
v_and_b32 v102, s90, v102
v_rcp_f32 v102, v102
s_nop 0
v_mul_f32 v103, -v103, v102
s_nop 1
v_mov_b64_dpp v[100:101], v[102:103] row_newbcast:0 row_mask:0xf bank_mask:0xf
v_mov_b64_dpp v[104:105], v[102:103] row_newbcast:8 row_mask:0xf bank_mask:0xf
v_mov_b64_dpp v[108:109], v[102:103] row_newbcast:4 row_mask:0xf bank_mask:0xf
v_fma_f32 v76, v76, v100, v101
v_fma_f32 v77, v77, v100, v101
v_fma_f32 v78, v78, v100, v101
v_fma_f32 v79, v79, v100, v101
v_fma_f32 v80, v80, v100, v101
v_fma_f32 v81, v81, v100, v101
v_fma_f32 v82, v82, v100, v101
v_fma_f32 v83, v83, v100, v101
v_cvt_pk_bf16_f32 v40, v76, v77
v_cvt_pk_bf16_f32 v41, v78, v79
v_cvt_pk_bf16_f32 v42, v80, v81
v_cvt_pk_bf16_f32 v43, v82, v83
ds_write_b128 v36, v[40:43]
v_fma_f32 v84, v84, v104, v105
v_fma_f32 v85, v85, v104, v105
v_fma_f32 v86, v86, v104, v105
v_fma_f32 v87, v87, v104, v105
v_fma_f32 v88, v88, v104, v105
v_fma_f32 v89, v89, v104, v105
v_fma_f32 v90, v90, v104, v105
v_fma_f32 v91, v91, v104, v105
v_cvt_pk_bf16_f32 v44, v84, v85
v_cvt_pk_bf16_f32 v45, v86, v87
v_cvt_pk_bf16_f32 v46, v88, v89
v_cvt_pk_bf16_f32 v47, v90, v91
ds_write_b128 v37, v[44:47]
v_fma_f32 v92, v92, v108, v109
v_fma_f32 v93, v93, v108, v109
v_fma_f32 v94, v94, v108, v109
v_fma_f32 v95, v95, v108, v109
v_fma_f32 v96, v96, v108, v109
v_fma_f32 v97, v97, v108, v109
v_fma_f32 v98, v98, v108, v109
v_fma_f32 v99, v99, v108, v109
v_cvt_pk_bf16_f32 v48, v92, v93
v_cvt_pk_bf16_f32 v49, v94, v95
v_cvt_pk_bf16_f32 v50, v96, v97
v_cvt_pk_bf16_f32 v51, v98, v99
ds_write_b128 v38, v[48:51]
s_add_u32 m0, s63, 0x1000
s_nop 0
buffer_load_dwordx4 v17, s[44:47], s68 offen offset:0 lds
buffer_load_dwordx4 v18, s[44:47], s68 offen offset:1024 lds
s_waitcnt vmcnt(12)
ds_read_b64_tr_b16 v[100:101], v25 offset:0
ds_read_b64_tr_b16 v[102:103], v25 offset:256
ds_read_b64_tr_b16 v[104:105], v26 offset:0
ds_read_b64_tr_b16 v[106:107], v26 offset:256
s_waitcnt lgkmcnt(4)
s_barrier
ds_read_b128 v[124:127], v31 offset:0
ds_read_b128 v[128:131], v31 offset:8192
ds_read_b128 v[132:135], v31 offset:16384
ds_read_b128 v[136:139], v32 offset:1024
s_waitcnt vmcnt(10)
ds_read_b64_tr_b16 v[108:109], v25 offset:2048
ds_read_b64_tr_b16 v[110:111], v25 offset:2304
s_waitcnt lgkmcnt(5)
v_mfma_f32_16x16x32_bf16 v[52:55], v[100:103], v[124:127], 0
ds_read_b128 v[140:143], v32 offset:9216
s_waitcnt lgkmcnt(5)
v_mfma_f32_16x16x32_bf16 v[56:59], v[100:103], v[128:131], 0
ds_read_b128 v[144:147], v32 offset:17408
s_waitcnt lgkmcnt(5)
v_mfma_f32_16x16x32_bf16 v[60:63], v[100:103], v[132:135], 0
ds_read_b64_tr_b16 v[112:113], v26 offset:2048
ds_read_b64_tr_b16 v[114:115], v26 offset:2304
v_mfma_f32_16x16x32_bf16 v[64:67], v[104:107], v[124:127], 0
s_add_u32 m0, s63, 0x0
s_nop 0
buffer_load_dwordx4 v17, s[44:47], s69 offen offset:0 lds
buffer_load_dwordx4 v18, s[44:47], s69 offen offset:1024 lds
v_mfma_f32_16x16x32_bf16 v[68:71], v[104:107], v[128:131], 0
v_and_b32 v5, 31, v2
v_lshrrev_b32 v6, 5, v2
v_mfma_f32_16x16x32_bf16 v[72:75], v[104:107], v[132:135], 0
ds_read_b128 v[148:151], v31 offset:2048
s_waitcnt vmcnt(2)
ds_read_b64_tr_b16 v[116:117], v25 offset:4096
ds_read_b64_tr_b16 v[118:119], v25 offset:4352
s_waitcnt lgkmcnt(7)
v_mfma_f32_16x16x32_bf16 v[52:55], v[108:111], v[136:139], v[52:55]
ds_read_b128 v[152:155], v31 offset:10240
s_lshr_b32 s6, s64, 9
s_waitcnt lgkmcnt(7)
v_mfma_f32_16x16x32_bf16 v[56:59], v[108:111], v[140:143], v[56:59]
ds_read_b128 v[156:159], v31 offset:18432
v_cmp_eq_u32 vcc, 0, v5
s_waitcnt lgkmcnt(7)
v_mfma_f32_16x16x32_bf16 v[60:63], v[108:111], v[144:147], v[60:63]
ds_read_b64_tr_b16 v[120:121], v26 offset:4096
ds_read_b64_tr_b16 v[122:123], v26 offset:4352
s_waitcnt lgkmcnt(7)
v_mfma_f32_16x16x32_bf16 v[64:67], v[112:115], v[136:139], v[64:67]
s_add_u32 m0, s63, 0x800
s_nop 0
buffer_load_dwordx4 v17, s[44:47], s70 offen offset:0 lds
buffer_load_dwordx4 v18, s[44:47], s70 offen offset:1024 lds
v_mfma_f32_16x16x32_bf16 v[68:71], v[112:115], v[140:143], v[68:71]
s_sub_u32 s6, 10000, s6
v_mov_b32 v7, 0x7fffffff
v_mfma_f32_16x16x32_bf16 v[72:75], v[112:115], v[144:147], v[72:75]
ds_read_b128 v[160:163], v32 offset:3072
s_waitcnt vmcnt(2)
ds_read_b64_tr_b16 v[100:101], v25 offset:0
ds_read_b64_tr_b16 v[102:103], v25 offset:256
s_waitcnt lgkmcnt(7)
v_mfma_f32_16x16x32_bf16 v[52:55], v[116:119], v[148:151], v[52:55]
ds_read_b128 v[164:167], v32 offset:11264
v_cndmask_b32 v6, v7, v6, vcc
s_waitcnt lgkmcnt(7)
v_mfma_f32_16x16x32_bf16 v[56:59], v[116:119], v[152:155], v[56:59]
ds_read_b128 v[168:171], v32 offset:19456
v_cmp_gt_i32 vcc, s6, v6
s_waitcnt lgkmcnt(7)
v_mfma_f32_16x16x32_bf16 v[60:63], v[116:119], v[156:159], v[60:63]
ds_read_b64_tr_b16 v[104:105], v26 offset:0
ds_read_b64_tr_b16 v[106:107], v26 offset:256
s_waitcnt lgkmcnt(7)
v_mfma_f32_16x16x32_bf16 v[64:67], v[120:123], v[148:151], v[64:67]
s_add_u32 m0, s63, 0x1000
s_nop 0
buffer_load_dwordx4 v17, s[44:47], s71 offen offset:0 lds
buffer_load_dwordx4 v18, s[44:47], s71 offen offset:1024 lds
v_mfma_f32_16x16x32_bf16 v[68:71], v[120:123], v[152:155], v[68:71]
v_and_b32 v5, s90, v40
v_or_b32 v5, 0x3f80, v5
v_mfma_f32_16x16x32_bf16 v[72:75], v[120:123], v[156:159], v[72:75]
ds_read_b128 v[124:127], v31 offset:4096
s_waitcnt vmcnt(2)
ds_read_b64_tr_b16 v[108:109], v25 offset:2048
ds_read_b64_tr_b16 v[110:111], v25 offset:2304
s_waitcnt lgkmcnt(7)
v_mfma_f32_16x16x32_bf16 v[52:55], v[100:103], v[160:163], v[52:55]
ds_read_b128 v[128:131], v31 offset:12288
s_sub_u32 s6, s6, 2
s_waitcnt lgkmcnt(7)
v_mfma_f32_16x16x32_bf16 v[56:59], v[100:103], v[164:167], v[56:59]
ds_read_b128 v[132:135], v31 offset:20480
v_cndmask_b32 v40, v40, v5, vcc
s_waitcnt lgkmcnt(7)
v_mfma_f32_16x16x32_bf16 v[60:63], v[100:103], v[168:171], v[60:63]
ds_read_b64_tr_b16 v[112:113], v26 offset:2048
ds_read_b64_tr_b16 v[114:115], v26 offset:2304
s_waitcnt lgkmcnt(7)
v_mfma_f32_16x16x32_bf16 v[64:67], v[104:107], v[160:163], v[64:67]
s_add_u32 m0, s63, 0x0
s_nop 0
buffer_load_dwordx4 v17, s[44:47], s72 offen offset:0 lds
buffer_load_dwordx4 v18, s[44:47], s72 offen offset:1024 lds
v_mfma_f32_16x16x32_bf16 v[68:71], v[104:107], v[164:167], v[68:71]
v_cmp_gt_i32 vcc, s6, v6
v_and_b32 v5, s90, v44
v_mfma_f32_16x16x32_bf16 v[72:75], v[104:107], v[168:171], v[72:75]
ds_read_b128 v[136:139], v32 offset:5120
s_waitcnt vmcnt(2)
ds_read_b64_tr_b16 v[116:117], v25 offset:4096
ds_read_b64_tr_b16 v[118:119], v25 offset:4352
s_waitcnt lgkmcnt(7)
v_mfma_f32_16x16x32_bf16 v[52:55], v[108:111], v[124:127], v[52:55]
ds_read_b128 v[140:143], v32 offset:13312
v_or_b32 v5, 0x3f80, v5
s_waitcnt lgkmcnt(7)
v_mfma_f32_16x16x32_bf16 v[56:59], v[108:111], v[128:131], v[56:59]
ds_read_b128 v[144:147], v32 offset:21504
s_sub_u32 s6, s6, 2
s_waitcnt lgkmcnt(7)
v_mfma_f32_16x16x32_bf16 v[60:63], v[108:111], v[132:135], v[60:63]
ds_read_b64_tr_b16 v[120:121], v26 offset:4096
ds_read_b64_tr_b16 v[122:123], v26 offset:4352
s_waitcnt lgkmcnt(7)
v_mfma_f32_16x16x32_bf16 v[64:67], v[112:115], v[124:127], v[64:67]
s_add_u32 m0, s63, 0x800
s_nop 0
buffer_load_dwordx4 v17, s[44:47], s73 offen offset:0 lds
buffer_load_dwordx4 v18, s[44:47], s73 offen offset:1024 lds
v_mfma_f32_16x16x32_bf16 v[68:71], v[112:115], v[128:131], v[68:71]
v_cndmask_b32 v44, v44, v5, vcc
v_cmp_gt_i32 vcc, s6, v6
v_mfma_f32_16x16x32_bf16 v[72:75], v[112:115], v[132:135], v[72:75]
ds_read_b128 v[148:151], v31 offset:6144
s_waitcnt vmcnt(2)
ds_read_b64_tr_b16 v[100:101], v25 offset:0
ds_read_b64_tr_b16 v[102:103], v25 offset:256
s_waitcnt lgkmcnt(7)
v_mfma_f32_16x16x32_bf16 v[52:55], v[116:119], v[136:139], v[52:55]
ds_read_b128 v[152:155], v31 offset:14336
v_and_b32 v5, s90, v48
s_waitcnt lgkmcnt(7)
v_mfma_f32_16x16x32_bf16 v[56:59], v[116:119], v[140:143], v[56:59]
ds_read_b128 v[156:159], v31 offset:22528
v_or_b32 v5, 0x3f80, v5
s_waitcnt lgkmcnt(7)
v_mfma_f32_16x16x32_bf16 v[60:63], v[116:119], v[144:147], v[60:63]
ds_read_b64_tr_b16 v[104:105], v26 offset:0
ds_read_b64_tr_b16 v[106:107], v26 offset:256
s_waitcnt lgkmcnt(7)
v_mfma_f32_16x16x32_bf16 v[64:67], v[120:123], v[136:139], v[64:67]
s_add_u32 m0, s63, 0x1000
s_nop 0
buffer_load_dwordx4 v21, s[48:51], s74 offen offset:0 lds
buffer_load_dwordx4 v22, s[48:51], s74 offen offset:1024 lds
v_mfma_f32_16x16x32_bf16 v[68:71], v[120:123], v[140:143], v[68:71]
s_sub_u32 s6, s6, 2
v_cndmask_b32 v48, v48, v5, vcc
v_mfma_f32_16x16x32_bf16 v[72:75], v[120:123], v[144:147], v[72:75]
ds_read_b128 v[160:163], v32 offset:7168
s_waitcnt vmcnt(2)
ds_read_b64_tr_b16 v[108:109], v25 offset:2048
ds_read_b64_tr_b16 v[110:111], v25 offset:2304
s_waitcnt lgkmcnt(7)
v_mfma_f32_16x16x32_bf16 v[52:55], v[100:103], v[148:151], v[52:55]
ds_read_b128 v[164:167], v32 offset:15360
s_waitcnt lgkmcnt(7)
v_mfma_f32_16x16x32_bf16 v[56:59], v[100:103], v[152:155], v[56:59]
ds_read_b128 v[168:171], v32 offset:23552
s_waitcnt lgkmcnt(7)
v_mfma_f32_16x16x32_bf16 v[60:63], v[100:103], v[156:159], v[60:63]
ds_read_b64_tr_b16 v[112:113], v26 offset:2048
ds_read_b64_tr_b16 v[114:115], v26 offset:2304
s_waitcnt lgkmcnt(7)
v_mfma_f32_16x16x32_bf16 v[64:67], v[104:107], v[148:151], v[64:67]
s_add_u32 m0, s63, 0x0
s_nop 0
buffer_load_dwordx4 v21, s[48:51], s75 offen offset:0 lds
buffer_load_dwordx4 v22, s[48:51], s75 offen offset:1024 lds
v_mfma_f32_16x16x32_bf16 v[68:71], v[104:107], v[152:155], v[68:71]
v_mfma_f32_16x16x32_bf16 v[72:75], v[104:107], v[156:159], v[72:75]
s_waitcnt lgkmcnt(4)
v_mfma_f32_16x16x32_bf16 v[52:55], v[108:111], v[160:163], v[52:55]
s_waitcnt lgkmcnt(3)
v_mfma_f32_16x16x32_bf16 v[56:59], v[108:111], v[164:167], v[56:59]
s_waitcnt lgkmcnt(2)
v_mfma_f32_16x16x32_bf16 v[60:63], v[108:111], v[168:171], v[60:63]
s_waitcnt lgkmcnt(0)
v_mfma_f32_16x16x32_bf16 v[64:67], v[112:115], v[160:163], v[64:67]
s_nop 1
v_cvt_pk_bf16_f32 v52, v52, v53
v_cvt_pk_bf16_f32 v53, v54, v55
ds_write_b64 v33, v[52:53] offset:0
s_add_u32 m0, s63, 0x800
s_nop 0
buffer_load_dwordx4 v21, s[48:51], s76 offen offset:0 lds
buffer_load_dwordx4 v22, s[48:51], s76 offen offset:1024 lds
v_mfma_f32_16x16x32_bf16 v[68:71], v[112:115], v[164:167], v[68:71]
v_cvt_pk_bf16_f32 v56, v56, v57
v_cvt_pk_bf16_f32 v57, v58, v59
ds_write_b64 v33, v[56:57] offset:8192
v_mfma_f32_16x16x32_bf16 v[72:75], v[112:115], v[168:171], v[72:75]
v_cvt_pk_bf16_f32 v60, v60, v61
v_cvt_pk_bf16_f32 v61, v62, v63
ds_write_b64 v33, v[60:61] offset:16384
v_cvt_pk_bf16_f32 v64, v64, v65
v_cvt_pk_bf16_f32 v65, v66, v67
ds_write_b64 v33, v[64:65] offset:512
v_cvt_pk_bf16_f32 v68, v68, v69
v_cvt_pk_bf16_f32 v69, v70, v71
ds_write_b64 v33, v[68:69] offset:8704
v_cvt_pk_bf16_f32 v72, v72, v73
v_cvt_pk_bf16_f32 v73, v74, v75
ds_write_b64 v33, v[72:73] offset:16896
s_waitcnt vmcnt(4)
ds_read_b128 v[116:119], v29 offset:4096
ds_read_b128 v[120:123], v30 offset:4096
s_waitcnt lgkmcnt(2)
s_barrier
ds_read_b128 v[124:127], v35 offset:0
ds_read_b128 v[128:131], v35 offset:8192
ds_read_b128 v[132:135], v35 offset:16384
ds_read_b128 v[136:139], v35 offset:1024
s_waitcnt lgkmcnt(3)
v_mfma_f32_16x16x32_bf16 v[76:79], v[116:119], v[124:127], 0
ds_read_b128 v[140:143], v35 offset:9216
s_waitcnt lgkmcnt(3)
v_mfma_f32_16x16x32_bf16 v[84:87], v[116:119], v[128:131], 0
ds_read_b128 v[144:147], v35 offset:17408
s_waitcnt lgkmcnt(3)
v_mfma_f32_16x16x32_bf16 v[92:95], v[116:119], v[132:135], 0
v_mfma_f32_16x16x32_bf16 v[204:207], v[172:175], v[124:127], 0
v_mfma_f32_16x16x32_bf16 v[208:211], v[172:175], v[128:131], 0
v_mfma_f32_16x16x32_bf16 v[212:215], v[172:175], v[132:135], 0
s_waitcnt vmcnt(2)
ds_read_b128 v[100:103], v29 offset:0
s_waitcnt lgkmcnt(3)
v_mfma_f32_16x16x32_bf16 v[76:79], v[120:123], v[136:139], v[76:79]
s_add_u32 m0, s63, 0x1000
s_nop 0
buffer_load_dwordx4 v21, s[48:51], s77 offen offset:0 lds
buffer_load_dwordx4 v22, s[48:51], s77 offen offset:1024 lds
s_waitcnt lgkmcnt(2)
v_mfma_f32_16x16x32_bf16 v[84:87], v[120:123], v[140:143], v[84:87]
s_waitcnt lgkmcnt(1)
v_mfma_f32_16x16x32_bf16 v[92:95], v[120:123], v[144:147], v[92:95]
ds_read_b128 v[104:107], v30 offset:0
v_mfma_f32_16x16x32_bf16 v[204:207], v[176:179], v[136:139], v[204:207]
v_mfma_f32_16x16x32_bf16 v[208:211], v[176:179], v[140:143], v[208:211]
v_mfma_f32_16x16x32_bf16 v[212:215], v[176:179], v[144:147], v[212:215]
ds_read_b128 v[148:151], v35 offset:2048
s_waitcnt vmcnt(2)
ds_read_b128 v[108:111], v29 offset:2048
s_waitcnt lgkmcnt(3)
v_mfma_f32_16x16x32_bf16 v[80:83], v[100:103], v[124:127], 0
ds_read_b128 v[152:155], v35 offset:10240
v_mfma_f32_16x16x32_bf16 v[88:91], v[100:103], v[128:131], 0
ds_read_b128 v[156:159], v35 offset:18432
v_mfma_f32_16x16x32_bf16 v[96:99], v[100:103], v[132:135], 0
s_waitcnt lgkmcnt(4)
v_mfma_f32_16x16x32_bf16 v[80:83], v[104:107], v[136:139], v[80:83]
s_add_u32 m0, s63, 0x0
s_nop 0
buffer_load_dwordx4 v21, s[48:51], s78 offen offset:0 lds
buffer_load_dwordx4 v22, s[48:51], s78 offen offset:1024 lds
v_mfma_f32_16x16x32_bf16 v[88:91], v[104:107], v[140:143], v[88:91]
v_mfma_f32_16x16x32_bf16 v[96:99], v[104:107], v[144:147], v[96:99]
ds_read_b128 v[160:163], v35 offset:3072
ds_read_b128 v[112:115], v30 offset:2048
s_waitcnt lgkmcnt(4)
v_mfma_f32_16x16x32_bf16 v[76:79], v[108:111], v[148:151], v[76:79]
ds_read_b128 v[164:167], v35 offset:11264
s_waitcnt lgkmcnt(4)
v_mfma_f32_16x16x32_bf16 v[84:87], v[108:111], v[152:155], v[84:87]
ds_read_b128 v[168:171], v35 offset:19456
s_waitcnt lgkmcnt(4)
v_mfma_f32_16x16x32_bf16 v[92:95], v[108:111], v[156:159], v[92:95]
v_mfma_f32_16x16x32_bf16 v[204:207], v[180:183], v[148:151], v[204:207]
v_mfma_f32_16x16x32_bf16 v[208:211], v[180:183], v[152:155], v[208:211]
v_mfma_f32_16x16x32_bf16 v[212:215], v[180:183], v[156:159], v[212:215]
s_waitcnt vmcnt(2)
ds_read_b128 v[116:119], v29 offset:4096
s_waitcnt lgkmcnt(3)
v_mfma_f32_16x16x32_bf16 v[76:79], v[112:115], v[160:163], v[76:79]
s_add_u32 m0, s63, 0x800
s_nop 0
buffer_load_dwordx4 v21, s[48:51], s79 offen offset:0 lds
buffer_load_dwordx4 v22, s[48:51], s79 offen offset:1024 lds
s_waitcnt lgkmcnt(2)
v_mfma_f32_16x16x32_bf16 v[84:87], v[112:115], v[164:167], v[84:87]
s_waitcnt lgkmcnt(1)
v_mfma_f32_16x16x32_bf16 v[92:95], v[112:115], v[168:171], v[92:95]
ds_read_b128 v[120:123], v30 offset:4096
v_mfma_f32_16x16x32_bf16 v[204:207], v[184:187], v[160:163], v[204:207]
v_mfma_f32_16x16x32_bf16 v[208:211], v[184:187], v[164:167], v[208:211]
v_mfma_f32_16x16x32_bf16 v[212:215], v[184:187], v[168:171], v[212:215]
ds_read_b128 v[124:127], v35 offset:4096
s_waitcnt vmcnt(2)
ds_read_b128 v[100:103], v29 offset:0
s_waitcnt lgkmcnt(3)
v_mfma_f32_16x16x32_bf16 v[80:83], v[116:119], v[148:151], v[80:83]
ds_read_b128 v[128:131], v35 offset:12288
v_mfma_f32_16x16x32_bf16 v[88:91], v[116:119], v[152:155], v[88:91]
ds_read_b128 v[132:135], v35 offset:20480
v_mfma_f32_16x16x32_bf16 v[96:99], v[116:119], v[156:159], v[96:99]
s_waitcnt lgkmcnt(4)
v_mfma_f32_16x16x32_bf16 v[80:83], v[120:123], v[160:163], v[80:83]
s_add_u32 m0, s63, 0x1000
s_nop 0
buffer_load_dwordx4 v21, s[48:51], s80 offen offset:0 lds
buffer_load_dwordx4 v22, s[48:51], s80 offen offset:1024 lds
v_mfma_f32_16x16x32_bf16 v[88:91], v[120:123], v[164:167], v[88:91]
v_mfma_f32_16x16x32_bf16 v[96:99], v[120:123], v[168:171], v[96:99]
ds_read_b128 v[136:139], v35 offset:5120
ds_read_b128 v[104:107], v30 offset:0
s_waitcnt lgkmcnt(4)
v_mfma_f32_16x16x32_bf16 v[76:79], v[100:103], v[124:127], v[76:79]
ds_read_b128 v[140:143], v35 offset:13312
s_waitcnt lgkmcnt(4)
v_mfma_f32_16x16x32_bf16 v[84:87], v[100:103], v[128:131], v[84:87]
ds_read_b128 v[144:147], v35 offset:21504
s_waitcnt lgkmcnt(4)
v_mfma_f32_16x16x32_bf16 v[92:95], v[100:103], v[132:135], v[92:95]
v_mfma_f32_16x16x32_bf16 v[204:207], v[188:191], v[124:127], v[204:207]
v_mfma_f32_16x16x32_bf16 v[208:211], v[188:191], v[128:131], v[208:211]
v_mfma_f32_16x16x32_bf16 v[212:215], v[188:191], v[132:135], v[212:215]
s_waitcnt vmcnt(2)
ds_read_b128 v[108:111], v29 offset:2048
s_waitcnt lgkmcnt(3)
v_mfma_f32_16x16x32_bf16 v[76:79], v[104:107], v[136:139], v[76:79]
s_add_u32 m0, s63, 0x0
s_nop 0
buffer_load_dwordx4 v21, s[48:51], s81 offen offset:0 lds
buffer_load_dwordx4 v22, s[48:51], s81 offen offset:1024 lds
s_waitcnt lgkmcnt(2)
v_mfma_f32_16x16x32_bf16 v[84:87], v[104:107], v[140:143], v[84:87]
buffer_store_dwordx4 v[40:43], v16, s[56:59], s64 offen offset:0 sc1
buffer_store_dwordx4 v[44:47], v16, s[56:59], s64 offen offset:1024 sc1
s_waitcnt lgkmcnt(1)
v_mfma_f32_16x16x32_bf16 v[92:95], v[104:107], v[144:147], v[92:95]
ds_read_b128 v[112:115], v30 offset:2048
buffer_store_dwordx4 v[48:51], v16, s[56:59], s64 offen offset:2048 sc1
v_mfma_f32_16x16x32_bf16 v[204:207], v[192:195], v[136:139], v[204:207]
v_mfma_f32_16x16x32_bf16 v[208:211], v[192:195], v[140:143], v[208:211]
v_mfma_f32_16x16x32_bf16 v[212:215], v[192:195], v[144:147], v[212:215]
ds_read_b128 v[148:151], v35 offset:6144
s_waitcnt vmcnt(5)
ds_read_b128 v[116:119], v29 offset:4096
s_waitcnt lgkmcnt(3)
v_mfma_f32_16x16x32_bf16 v[80:83], v[108:111], v[124:127], v[80:83]
ds_read_b128 v[152:155], v35 offset:14336
v_mfma_f32_16x16x32_bf16 v[88:91], v[108:111], v[128:131], v[88:91]
ds_read_b128 v[156:159], v35 offset:22528
v_mfma_f32_16x16x32_bf16 v[96:99], v[108:111], v[132:135], v[96:99]
s_waitcnt lgkmcnt(4)
v_mfma_f32_16x16x32_bf16 v[80:83], v[112:115], v[136:139], v[80:83]
v_mfma_f32_16x16x32_bf16 v[88:91], v[112:115], v[140:143], v[88:91]
v_mfma_f32_16x16x32_bf16 v[96:99], v[112:115], v[144:147], v[96:99]
ds_read_b128 v[160:163], v35 offset:7168
ds_read_b128 v[120:123], v30 offset:4096
s_waitcnt lgkmcnt(4)
v_mfma_f32_16x16x32_bf16 v[76:79], v[116:119], v[148:151], v[76:79]
ds_read_b128 v[164:167], v35 offset:15360
s_waitcnt lgkmcnt(4)
v_mfma_f32_16x16x32_bf16 v[84:87], v[116:119], v[152:155], v[84:87]
ds_read_b128 v[168:171], v35 offset:23552
s_waitcnt lgkmcnt(4)
v_mfma_f32_16x16x32_bf16 v[92:95], v[116:119], v[156:159], v[92:95]
v_mfma_f32_16x16x32_bf16 v[204:207], v[196:199], v[148:151], v[204:207]
v_mfma_f32_16x16x32_bf16 v[208:211], v[196:199], v[152:155], v[208:211]
v_mfma_f32_16x16x32_bf16 v[212:215], v[196:199], v[156:159], v[212:215]
s_waitcnt vmcnt(3)
ds_read_b128 v[100:103], v29 offset:0
s_waitcnt lgkmcnt(3)
v_mfma_f32_16x16x32_bf16 v[76:79], v[120:123], v[160:163], v[76:79]
s_waitcnt lgkmcnt(2)
v_mfma_f32_16x16x32_bf16 v[84:87], v[120:123], v[164:167], v[84:87]
s_waitcnt lgkmcnt(1)
v_mfma_f32_16x16x32_bf16 v[92:95], v[120:123], v[168:171], v[92:95]
ds_read_b128 v[104:107], v30 offset:0
v_mfma_f32_16x16x32_bf16 v[204:207], v[200:203], v[160:163], v[204:207]
v_mfma_f32_16x16x32_bf16 v[208:211], v[200:203], v[164:167], v[208:211]
v_mfma_f32_16x16x32_bf16 v[212:215], v[200:203], v[168:171], v[212:215]
s_waitcnt lgkmcnt(1)
v_mfma_f32_16x16x32_bf16 v[80:83], v[100:103], v[148:151], v[80:83]
s_nop 3
v_mul_f32 v204, -v204, s86
v_mfma_f32_16x16x32_bf16 v[88:91], v[100:103], v[152:155], v[88:91]
v_mul_f32 v208, -v208, s86
v_mfma_f32_16x16x32_bf16 v[96:99], v[100:103], v[156:159], v[96:99]
v_mul_f32 v212, -v212, s86
s_waitcnt lgkmcnt(0)
v_mfma_f32_16x16x32_bf16 v[80:83], v[104:107], v[160:163], v[80:83]
v_mfma_f32_16x16x32_bf16 v[88:91], v[104:107], v[164:167], v[88:91]
v_mfma_f32_16x16x32_bf16 v[96:99], v[104:107], v[168:171], v[96:99]
v_fma_f32 v76, v76, s86, v204
v_fma_f32 v77, v77, s86, v204
v_fma_f32 v78, v78, s86, v204
v_fma_f32 v79, v79, s86, v204
s_nop 1
v_fma_f32 v80, v80, s86, v204
v_fma_f32 v81, v81, s86, v204
v_fma_f32 v82, v82, s86, v204
v_fma_f32 v83, v83, s86, v204
v_cvt_pk_bf16_f32 v76, v76, v77
v_cvt_pk_bf16_f32 v77, v78, v79
v_cvt_pk_bf16_f32 v78, v80, v81
v_cvt_pk_bf16_f32 v79, v82, v83
buffer_store_dwordx4 v[76:79], v16, s[52:55], s82 offen offset:0 sc1
v_fma_f32 v84, v84, s86, v208
v_fma_f32 v85, v85, s86, v208
v_fma_f32 v86, v86, s86, v208
v_fma_f32 v87, v87, s86, v208
v_fma_f32 v88, v88, s86, v208
v_fma_f32 v89, v89, s86, v208
v_fma_f32 v90, v90, s86, v208
v_fma_f32 v91, v91, s86, v208
v_cvt_pk_bf16_f32 v84, v84, v85
v_cvt_pk_bf16_f32 v85, v86, v87
v_cvt_pk_bf16_f32 v86, v88, v89
v_cvt_pk_bf16_f32 v87, v90, v91
buffer_store_dwordx4 v[84:87], v16, s[52:55], s83 offen offset:0 sc1
v_fma_f32 v92, v92, s86, v212
v_fma_f32 v93, v93, s86, v212
v_fma_f32 v94, v94, s86, v212
v_fma_f32 v95, v95, s86, v212
v_fma_f32 v96, v96, s86, v212
v_fma_f32 v97, v97, s86, v212
v_fma_f32 v98, v98, s86, v212
v_fma_f32 v99, v99, s86, v212
v_cvt_pk_bf16_f32 v92, v92, v93
v_cvt_pk_bf16_f32 v93, v94, v95
v_cvt_pk_bf16_f32 v94, v96, v97
v_cvt_pk_bf16_f32 v95, v98, v99
buffer_store_dwordx4 v[92:95], v16, s[52:55], s84 offen offset:0 sc1
s_branch L1_fin
L1_notq:
s_sub_u32 s4, s2, 32
s_cmp_lt_u32 s2, 32
s_cbranch_scc1 L1_edge
s_mov_b32 s61, 1
v_lshlrev_b32 v16, 4, v2
s_mul_i32 s63, s60, 6144
s_and_b32 s6, s4, 3
s_lshl_b32 s6, s6, 6
s_mul_i32 s7, s60, 8
s_add_u32 s6, s6, s7
v_lshrrev_b32 v5, 5, v2
v_and_b32 v6, 31, v2
v_lshlrev_b32 v6, 4, v6
v_mov_b32 v176, v6
s_cmp_ge_u32 s4, 4
s_cselect_b64 vcc, -1, 0
v_add3_u32 v7, v5, s6, 0
v_and_b32 v8, 0x80, v7
v_bfe_u32 v9, v7, 2, 1
v_lshl_or_b32 v8, v9, 6, v8
v_bfe_u32 v9, v7, 4, 1
v_lshl_or_b32 v8, v9, 5, v8
v_and_b32 v9, 3, v7
v_lshl_or_b32 v8, v9, 3, v8
v_bfe_u32 v9, v7, 5, 2
v_lshl_or_b32 v8, v9, 1, v8
v_bfe_u32 v9, v7, 3, 1
v_or_b32 v8, v9, v8
v_cndmask_b32 v8, v8, v7, vcc
v_lshl_add_u32 v40, v8, 9, v6
v_add3_u32 v7, v5, s6, 2
v_and_b32 v8, 0x80, v7
v_bfe_u32 v9, v7, 2, 1
v_lshl_or_b32 v8, v9, 6, v8
v_bfe_u32 v9, v7, 4, 1
v_lshl_or_b32 v8, v9, 5, v8
v_and_b32 v9, 3, v7
v_lshl_or_b32 v8, v9, 3, v8
v_bfe_u32 v9, v7, 5, 2
v_lshl_or_b32 v8, v9, 1, v8
v_bfe_u32 v9, v7, 3, 1
v_or_b32 v8, v9, v8
v_cndmask_b32 v8, v8, v7, vcc
v_lshl_add_u32 v44, v8, 9, v6
v_add3_u32 v7, v5, s6, 4
v_and_b32 v8, 0x80, v7
v_bfe_u32 v9, v7, 2, 1
v_lshl_or_b32 v8, v9, 6, v8
v_bfe_u32 v9, v7, 4, 1
v_lshl_or_b32 v8, v9, 5, v8
v_and_b32 v9, 3, v7
v_lshl_or_b32 v8, v9, 3, v8
v_bfe_u32 v9, v7, 5, 2
v_lshl_or_b32 v8, v9, 1, v8
v_bfe_u32 v9, v7, 3, 1
v_or_b32 v8, v9, v8
v_cndmask_b32 v8, v8, v7, vcc
v_lshl_add_u32 v48, v8, 9, v6
v_add3_u32 v7, v5, s6, 6
v_and_b32 v8, 0x80, v7
v_bfe_u32 v9, v7, 2, 1
v_lshl_or_b32 v8, v9, 6, v8
v_bfe_u32 v9, v7, 4, 1
v_lshl_or_b32 v8, v9, 5, v8
v_and_b32 v9, 3, v7
v_lshl_or_b32 v8, v9, 3, v8
v_bfe_u32 v9, v7, 5, 2
v_lshl_or_b32 v8, v9, 1, v8
v_bfe_u32 v9, v7, 3, 1
v_or_b32 v8, v9, v8
v_cndmask_b32 v8, v8, v7, vcc
v_lshl_add_u32 v52, v8, 9, v6
s_lshl_b32 s7, s60, 6
v_lshrrev_b32 v5, 2, v2
v_and_b32 v6, 3, v2
v_lshrrev_b32 v7, 5, v2
v_lshlrev_b32 v7, 1, v7
v_xor_b32 v6, v6, v7
v_lshl_add_u32 v5, v5, 9, s7
v_lshl_add_u32 v17, v6, 4, v5
v_add_u32 v18, 0x1c00, v17
s_xor_b32 s6, s62, 0
s_lshl_b32 s66, s6, 14
s_xor_b32 s6, s62, 1
s_lshl_b32 s67, s6, 14
s_xor_b32 s6, s62, 2
s_lshl_b32 s68, s6, 14
s_xor_b32 s6, s62, 3
s_lshl_b32 s69, s6, 14
s_xor_b32 s6, s62, 4
s_lshl_b32 s70, s6, 14
s_xor_b32 s6, s62, 5
s_lshl_b32 s71, s6, 14
s_xor_b32 s6, s62, 6
s_lshl_b32 s72, s6, 14
s_xor_b32 s6, s62, 7
s_lshl_b32 s73, s6, 14
s_waitcnt lgkmcnt(0)
s_cmp_ge_u32 s4, 4
s_cselect_b32 s6, s30, s24
s_cselect_b32 s7, s31, s25
s_add_u32 s40, s6, 0x0
s_addc_u32 s41, s7, 0
s_mov_b32 s42, 0x20000
s_mov_b32 s43, 0x00020000
s_add_u32 s44, s32, 0x0
s_addc_u32 s45, s33, 0
s_mov_b32 s46, 0x20000
s_mov_b32 s47, 0x00020000
buffer_load_dwordx4 v[40:43], v40, s[40:43], 0 offen
buffer_load_dwordx4 v[44:47], v44, s[40:43], 0 offen
buffer_load_dwordx4 v[48:51], v48, s[40:43], 0 offen
buffer_load_dwordx4 v[52:55], v52, s[40:43], 0 offen
buffer_load_dwordx4 v[176:179], v176, s[40:43], 0 offen
s_add_u32 m0, s63, 0x0
s_nop 0
buffer_load_dwordx4 v17, s[44:47], s66 offen offset:0 lds
buffer_load_dwordx4 v18, s[44:47], s66 offen offset:1024 lds
s_add_u32 m0, s63, 0x800
s_nop 0
buffer_load_dwordx4 v17, s[44:47], s67 offen offset:0 lds
buffer_load_dwordx4 v18, s[44:47], s67 offen offset:1024 lds
v_bfe_u32 v5, v2, 2, 3
v_xor_b32 v5, s62, v5
v_and_b32 v6, 3, v2
v_lshlrev_b32 v7, 10, v5
v_lshl_add_u32 v7, v6, 8, v7
v_add_u32 v7, 0xc000, v7
v_and_b32 v5, 1, v5
v_lshl_or_b32 v6, v5, 2, v6
v_lshrrev_b32 v5, 5, v2
s_mul_i32 s6, s60, 8
v_add3_u32 v8, v5, s6, 0
v_lshrrev_b32 v9, 4, v8
v_lshl_add_u32 v9, v9, 13, v7
v_and_b32 v8, 15, v8
v_xor_b32 v8, v8, v6
v_lshl_add_u32 v36, v8, 4, v9
v_add3_u32 v8, v5, s6, 2
v_lshrrev_b32 v9, 4, v8
v_lshl_add_u32 v9, v9, 13, v7
v_and_b32 v8, 15, v8
v_xor_b32 v8, v8, v6
v_lshl_add_u32 v37, v8, 4, v9
v_add3_u32 v8, v5, s6, 4
v_lshrrev_b32 v9, 4, v8
v_lshl_add_u32 v9, v9, 13, v7
v_and_b32 v8, 15, v8
v_xor_b32 v8, v8, v6
v_lshl_add_u32 v38, v8, 4, v9
v_add3_u32 v8, v5, s6, 6
v_lshrrev_b32 v9, 4, v8
v_lshl_add_u32 v9, v9, 13, v7
v_and_b32 v8, 15, v8
v_xor_b32 v8, v8, v6
v_lshl_add_u32 v39, v8, 4, v9
v_xor_b32 v5, v3, v4
v_lshlrev_b32 v5, 4, v5
v_lshl_add_u32 v5, v4, 8, v5
v_add_u32 v31, 0xc000, v5
v_xor_b32 v32, 64, v31
v_lshrrev_b32 v5, 2, v3
v_and_b32 v6, 3, v3
v_and_b32 v7, 1, v4
v_lshlrev_b32 v7, 1, v7
v_lshl_add_u32 v8, v4, 3, v5
v_lshlrev_b32 v8, 6, v8
v_add_u32 v8, s63, v8
v_xor_b32 v6, v6, v7
v_xor_b32 v9, 0, v6
v_lshl_add_u32 v25, v9, 4, v8
v_add_u32 v26, 8, v25
s_lshr_b32 s6, s4, 2
s_lshl_b32 s6, s6, 17
s_and_b32 s7, s4, 3
s_lshl_b32 s7, s7, 12
s_add_u32 s6, s6, s7
s_mul_i32 s7, s60, 16384
s_add_u32 s82, s6, s7
s_add_u32 s83, s82, 16384
s_add_u32 s52, s38, 0x1000000
s_addc_u32 s53, s39, 0
s_mov_b32 s54, 0x40000
s_mov_b32 s55, 0x00020000
s_mov_b32 s90, 0xffff0000
s_waitcnt vmcnt(4)
v_lshlrev_b32 v180, 16, v176
v_and_b32 v181, s90, v176
v_lshlrev_b32 v182, 16, v177
v_and_b32 v183, s90, v177
v_lshlrev_b32 v184, 16, v178
v_and_b32 v185, s90, v178
v_lshlrev_b32 v186, 16, v179
v_and_b32 v187, s90, v179
v_lshlrev_b32 v176, 16, v40
v_and_b32 v177, s90, v40
v_sub_f32 v176, v176, v180
v_sub_f32 v177, v177, v181
v_cvt_pk_bf16_f32 v40, v176, v177
v_lshlrev_b32 v176, 16, v41
v_and_b32 v177, s90, v41
v_sub_f32 v176, v176, v182
v_sub_f32 v177, v177, v183
v_cvt_pk_bf16_f32 v41, v176, v177
v_lshlrev_b32 v176, 16, v42
v_and_b32 v177, s90, v42
v_sub_f32 v176, v176, v184
v_sub_f32 v177, v177, v185
v_cvt_pk_bf16_f32 v42, v176, v177
v_lshlrev_b32 v176, 16, v43
v_and_b32 v177, s90, v43
v_sub_f32 v176, v176, v186
v_sub_f32 v177, v177, v187
v_cvt_pk_bf16_f32 v43, v176, v177
v_lshlrev_b32 v176, 16, v44
v_and_b32 v177, s90, v44
v_sub_f32 v176, v176, v180
v_sub_f32 v177, v177, v181
v_cvt_pk_bf16_f32 v44, v176, v177
v_lshlrev_b32 v176, 16, v45
v_and_b32 v177, s90, v45
v_sub_f32 v176, v176, v182
v_sub_f32 v177, v177, v183
v_cvt_pk_bf16_f32 v45, v176, v177
v_lshlrev_b32 v176, 16, v46
v_and_b32 v177, s90, v46
v_sub_f32 v176, v176, v184
v_sub_f32 v177, v177, v185
v_cvt_pk_bf16_f32 v46, v176, v177
v_lshlrev_b32 v176, 16, v47
v_and_b32 v177, s90, v47
v_sub_f32 v176, v176, v186
v_sub_f32 v177, v177, v187
v_cvt_pk_bf16_f32 v47, v176, v177
v_lshlrev_b32 v176, 16, v48
v_and_b32 v177, s90, v48
v_sub_f32 v176, v176, v180
v_sub_f32 v177, v177, v181
v_cvt_pk_bf16_f32 v48, v176, v177
v_lshlrev_b32 v176, 16, v49
v_and_b32 v177, s90, v49
v_sub_f32 v176, v176, v182
v_sub_f32 v177, v177, v183
v_cvt_pk_bf16_f32 v49, v176, v177
v_lshlrev_b32 v176, 16, v50
v_and_b32 v177, s90, v50
v_sub_f32 v176, v176, v184
v_sub_f32 v177, v177, v185
v_cvt_pk_bf16_f32 v50, v176, v177
v_lshlrev_b32 v176, 16, v51
v_and_b32 v177, s90, v51
v_sub_f32 v176, v176, v186
v_sub_f32 v177, v177, v187
v_cvt_pk_bf16_f32 v51, v176, v177
v_lshlrev_b32 v176, 16, v52
v_and_b32 v177, s90, v52
v_sub_f32 v176, v176, v180
v_sub_f32 v177, v177, v181
v_cvt_pk_bf16_f32 v52, v176, v177
v_lshlrev_b32 v176, 16, v53
v_and_b32 v177, s90, v53
v_sub_f32 v176, v176, v182
v_sub_f32 v177, v177, v183
v_cvt_pk_bf16_f32 v53, v176, v177
v_lshlrev_b32 v176, 16, v54
v_and_b32 v177, s90, v54
v_sub_f32 v176, v176, v184
v_sub_f32 v177, v177, v185
v_cvt_pk_bf16_f32 v54, v176, v177
v_lshlrev_b32 v176, 16, v55
v_and_b32 v177, s90, v55
v_sub_f32 v176, v176, v186
v_sub_f32 v177, v177, v187
v_cvt_pk_bf16_f32 v55, v176, v177
ds_write_b128 v36, v[40:43]
ds_write_b128 v37, v[44:47]
ds_write_b128 v38, v[48:51]
ds_write_b128 v39, v[52:55]
s_add_u32 m0, s63, 0x1000
s_nop 0
buffer_load_dwordx4 v17, s[44:47], s68 offen offset:0 lds
buffer_load_dwordx4 v18, s[44:47], s68 offen offset:1024 lds
s_waitcnt vmcnt(4)
ds_read_b64_tr_b16 v[88:89], v25 offset:0
ds_read_b64_tr_b16 v[90:91], v25 offset:256
ds_read_b64_tr_b16 v[92:93], v26 offset:0
ds_read_b64_tr_b16 v[94:95], v26 offset:256
s_waitcnt lgkmcnt(4)
s_barrier
ds_read_b128 v[112:115], v31 offset:0
ds_read_b128 v[116:119], v31 offset:8192
ds_read_b128 v[120:123], v31 offset:16384
ds_read_b128 v[124:127], v31 offset:24576
ds_read_b128 v[128:131], v32 offset:1024
s_waitcnt vmcnt(2)
ds_read_b64_tr_b16 v[96:97], v25 offset:2048
ds_read_b64_tr_b16 v[98:99], v25 offset:2304
s_waitcnt lgkmcnt(6)
v_mfma_f32_16x16x32_bf16 v[56:59], v[112:115], v[88:91], 0
ds_read_b128 v[132:135], v32 offset:9216
s_waitcnt lgkmcnt(6)
v_mfma_f32_16x16x32_bf16 v[60:63], v[116:119], v[88:91], 0
ds_read_b128 v[136:139], v32 offset:17408
s_waitcnt lgkmcnt(6)
v_mfma_f32_16x16x32_bf16 v[64:67], v[120:123], v[88:91], 0
ds_read_b128 v[140:143], v32 offset:25600
s_waitcnt lgkmcnt(6)
v_mfma_f32_16x16x32_bf16 v[68:71], v[124:127], v[88:91], 0
ds_read_b64_tr_b16 v[100:101], v26 offset:2048
ds_read_b64_tr_b16 v[102:103], v26 offset:2304
v_mfma_f32_16x16x32_bf16 v[72:75], v[112:115], v[92:95], 0
s_add_u32 m0, s63, 0x0
s_nop 0
buffer_load_dwordx4 v17, s[44:47], s69 offen offset:0 lds
buffer_load_dwordx4 v18, s[44:47], s69 offen offset:1024 lds
v_mfma_f32_16x16x32_bf16 v[76:79], v[116:119], v[92:95], 0
v_mfma_f32_16x16x32_bf16 v[80:83], v[120:123], v[92:95], 0
v_mfma_f32_16x16x32_bf16 v[84:87], v[124:127], v[92:95], 0
ds_read_b128 v[144:147], v31 offset:2048
s_waitcnt vmcnt(2)
ds_read_b64_tr_b16 v[104:105], v25 offset:4096
ds_read_b64_tr_b16 v[106:107], v25 offset:4352
s_waitcnt lgkmcnt(8)
v_mfma_f32_16x16x32_bf16 v[56:59], v[128:131], v[96:99], v[56:59]
ds_read_b128 v[148:151], v31 offset:10240
s_waitcnt lgkmcnt(8)
v_mfma_f32_16x16x32_bf16 v[60:63], v[132:135], v[96:99], v[60:63]
ds_read_b128 v[152:155], v31 offset:18432
s_waitcnt lgkmcnt(8)
v_mfma_f32_16x16x32_bf16 v[64:67], v[136:139], v[96:99], v[64:67]
ds_read_b128 v[156:159], v31 offset:26624
s_waitcnt lgkmcnt(8)
v_mfma_f32_16x16x32_bf16 v[68:71], v[140:143], v[96:99], v[68:71]
ds_read_b64_tr_b16 v[108:109], v26 offset:4096
ds_read_b64_tr_b16 v[110:111], v26 offset:4352
s_waitcnt lgkmcnt(8)
v_mfma_f32_16x16x32_bf16 v[72:75], v[128:131], v[100:103], v[72:75]
s_add_u32 m0, s63, 0x800
s_nop 0
buffer_load_dwordx4 v17, s[44:47], s70 offen offset:0 lds
buffer_load_dwordx4 v18, s[44:47], s70 offen offset:1024 lds
v_mfma_f32_16x16x32_bf16 v[76:79], v[132:135], v[100:103], v[76:79]
v_mfma_f32_16x16x32_bf16 v[80:83], v[136:139], v[100:103], v[80:83]
v_mfma_f32_16x16x32_bf16 v[84:87], v[140:143], v[100:103], v[84:87]
ds_read_b128 v[160:163], v32 offset:3072
s_waitcnt vmcnt(2)
ds_read_b64_tr_b16 v[88:89], v25 offset:0
ds_read_b64_tr_b16 v[90:91], v25 offset:256
s_waitcnt lgkmcnt(8)
v_mfma_f32_16x16x32_bf16 v[56:59], v[144:147], v[104:107], v[56:59]
ds_read_b128 v[164:167], v32 offset:11264
s_waitcnt lgkmcnt(8)
v_mfma_f32_16x16x32_bf16 v[60:63], v[148:151], v[104:107], v[60:63]
ds_read_b128 v[168:171], v32 offset:19456
s_waitcnt lgkmcnt(8)
v_mfma_f32_16x16x32_bf16 v[64:67], v[152:155], v[104:107], v[64:67]
ds_read_b128 v[172:175], v32 offset:27648
s_waitcnt lgkmcnt(8)
v_mfma_f32_16x16x32_bf16 v[68:71], v[156:159], v[104:107], v[68:71]
ds_read_b64_tr_b16 v[92:93], v26 offset:0
ds_read_b64_tr_b16 v[94:95], v26 offset:256
s_waitcnt lgkmcnt(8)
v_mfma_f32_16x16x32_bf16 v[72:75], v[144:147], v[108:111], v[72:75]
s_add_u32 m0, s63, 0x1000
s_nop 0
buffer_load_dwordx4 v17, s[44:47], s71 offen offset:0 lds
buffer_load_dwordx4 v18, s[44:47], s71 offen offset:1024 lds
v_mfma_f32_16x16x32_bf16 v[76:79], v[148:151], v[108:111], v[76:79]
v_mfma_f32_16x16x32_bf16 v[80:83], v[152:155], v[108:111], v[80:83]
v_mfma_f32_16x16x32_bf16 v[84:87], v[156:159], v[108:111], v[84:87]
ds_read_b128 v[112:115], v31 offset:4096
s_waitcnt vmcnt(2)
ds_read_b64_tr_b16 v[96:97], v25 offset:2048
ds_read_b64_tr_b16 v[98:99], v25 offset:2304
s_waitcnt lgkmcnt(8)
v_mfma_f32_16x16x32_bf16 v[56:59], v[160:163], v[88:91], v[56:59]
ds_read_b128 v[116:119], v31 offset:12288
s_waitcnt lgkmcnt(8)
v_mfma_f32_16x16x32_bf16 v[60:63], v[164:167], v[88:91], v[60:63]
ds_read_b128 v[120:123], v31 offset:20480
s_waitcnt lgkmcnt(8)
v_mfma_f32_16x16x32_bf16 v[64:67], v[168:171], v[88:91], v[64:67]
ds_read_b128 v[124:127], v31 offset:28672
s_waitcnt lgkmcnt(8)
v_mfma_f32_16x16x32_bf16 v[68:71], v[172:175], v[88:91], v[68:71]
ds_read_b64_tr_b16 v[100:101], v26 offset:2048
ds_read_b64_tr_b16 v[102:103], v26 offset:2304
s_waitcnt lgkmcnt(8)
v_mfma_f32_16x16x32_bf16 v[72:75], v[160:163], v[92:95], v[72:75]
s_add_u32 m0, s63, 0x0
s_nop 0
buffer_load_dwordx4 v17, s[44:47], s72 offen offset:0 lds
buffer_load_dwordx4 v18, s[44:47], s72 offen offset:1024 lds
v_mfma_f32_16x16x32_bf16 v[76:79], v[164:167], v[92:95], v[76:79]
v_mfma_f32_16x16x32_bf16 v[80:83], v[168:171], v[92:95], v[80:83]
v_mfma_f32_16x16x32_bf16 v[84:87], v[172:175], v[92:95], v[84:87]
ds_read_b128 v[128:131], v32 offset:5120
s_waitcnt vmcnt(2)
ds_read_b64_tr_b16 v[104:105], v25 offset:4096
ds_read_b64_tr_b16 v[106:107], v25 offset:4352
s_waitcnt lgkmcnt(8)
v_mfma_f32_16x16x32_bf16 v[56:59], v[112:115], v[96:99], v[56:59]
ds_read_b128 v[132:135], v32 offset:13312
s_waitcnt lgkmcnt(8)
v_mfma_f32_16x16x32_bf16 v[60:63], v[116:119], v[96:99], v[60:63]
ds_read_b128 v[136:139], v32 offset:21504
s_waitcnt lgkmcnt(8)
v_mfma_f32_16x16x32_bf16 v[64:67], v[120:123], v[96:99], v[64:67]
ds_read_b128 v[140:143], v32 offset:29696
s_waitcnt lgkmcnt(8)
v_mfma_f32_16x16x32_bf16 v[68:71], v[124:127], v[96:99], v[68:71]
ds_read_b64_tr_b16 v[108:109], v26 offset:4096
ds_read_b64_tr_b16 v[110:111], v26 offset:4352
s_waitcnt lgkmcnt(8)
v_mfma_f32_16x16x32_bf16 v[72:75], v[112:115], v[100:103], v[72:75]
s_add_u32 m0, s63, 0x800
s_nop 0
buffer_load_dwordx4 v17, s[44:47], s73 offen offset:0 lds
buffer_load_dwordx4 v18, s[44:47], s73 offen offset:1024 lds
v_mfma_f32_16x16x32_bf16 v[76:79], v[116:119], v[100:103], v[76:79]
v_mfma_f32_16x16x32_bf16 v[80:83], v[120:123], v[100:103], v[80:83]
v_mfma_f32_16x16x32_bf16 v[84:87], v[124:127], v[100:103], v[84:87]
ds_read_b128 v[144:147], v31 offset:6144
s_waitcnt vmcnt(2)
ds_read_b64_tr_b16 v[88:89], v25 offset:0
ds_read_b64_tr_b16 v[90:91], v25 offset:256
s_waitcnt lgkmcnt(8)
v_mfma_f32_16x16x32_bf16 v[56:59], v[128:131], v[104:107], v[56:59]
ds_read_b128 v[148:151], v31 offset:14336
s_waitcnt lgkmcnt(8)
v_mfma_f32_16x16x32_bf16 v[60:63], v[132:135], v[104:107], v[60:63]
ds_read_b128 v[152:155], v31 offset:22528
s_waitcnt lgkmcnt(8)
v_mfma_f32_16x16x32_bf16 v[64:67], v[136:139], v[104:107], v[64:67]
ds_read_b128 v[156:159], v31 offset:30720
s_waitcnt lgkmcnt(8)
v_mfma_f32_16x16x32_bf16 v[68:71], v[140:143], v[104:107], v[68:71]
ds_read_b64_tr_b16 v[92:93], v26 offset:0
ds_read_b64_tr_b16 v[94:95], v26 offset:256
s_waitcnt lgkmcnt(8)
v_mfma_f32_16x16x32_bf16 v[72:75], v[128:131], v[108:111], v[72:75]
v_mfma_f32_16x16x32_bf16 v[76:79], v[132:135], v[108:111], v[76:79]
v_mfma_f32_16x16x32_bf16 v[80:83], v[136:139], v[108:111], v[80:83]
v_mfma_f32_16x16x32_bf16 v[84:87], v[140:143], v[108:111], v[84:87]
ds_read_b128 v[160:163], v32 offset:7168
s_waitcnt vmcnt(0)
ds_read_b64_tr_b16 v[96:97], v25 offset:2048
ds_read_b64_tr_b16 v[98:99], v25 offset:2304
s_waitcnt lgkmcnt(8)
v_mfma_f32_16x16x32_bf16 v[56:59], v[144:147], v[88:91], v[56:59]
ds_read_b128 v[164:167], v32 offset:15360
s_waitcnt lgkmcnt(8)
v_mfma_f32_16x16x32_bf16 v[60:63], v[148:151], v[88:91], v[60:63]
ds_read_b128 v[168:171], v32 offset:23552
s_waitcnt lgkmcnt(8)
v_mfma_f32_16x16x32_bf16 v[64:67], v[152:155], v[88:91], v[64:67]
ds_read_b128 v[172:175], v32 offset:31744
s_waitcnt lgkmcnt(8)
v_mfma_f32_16x16x32_bf16 v[68:71], v[156:159], v[88:91], v[68:71]
ds_read_b64_tr_b16 v[100:101], v26 offset:2048
ds_read_b64_tr_b16 v[102:103], v26 offset:2304
s_waitcnt lgkmcnt(8)
v_mfma_f32_16x16x32_bf16 v[72:75], v[144:147], v[92:95], v[72:75]
v_mfma_f32_16x16x32_bf16 v[76:79], v[148:151], v[92:95], v[76:79]
v_mfma_f32_16x16x32_bf16 v[80:83], v[152:155], v[92:95], v[80:83]
v_mfma_f32_16x16x32_bf16 v[84:87], v[156:159], v[92:95], v[84:87]
s_waitcnt lgkmcnt(5)
v_mfma_f32_16x16x32_bf16 v[56:59], v[160:163], v[96:99], v[56:59]
s_waitcnt lgkmcnt(4)
v_mfma_f32_16x16x32_bf16 v[60:63], v[164:167], v[96:99], v[60:63]
s_waitcnt lgkmcnt(3)
v_mfma_f32_16x16x32_bf16 v[64:67], v[168:171], v[96:99], v[64:67]
s_waitcnt lgkmcnt(2)
v_mfma_f32_16x16x32_bf16 v[68:71], v[172:175], v[96:99], v[68:71]
s_waitcnt lgkmcnt(0)
v_mfma_f32_16x16x32_bf16 v[72:75], v[160:163], v[100:103], v[72:75]
v_cvt_pk_bf16_f32 v56, v56, v57
v_cvt_pk_bf16_f32 v57, v58, v59
v_cvt_pk_bf16_f32 v58, v60, v61
v_cvt_pk_bf16_f32 v59, v62, v63
buffer_store_dwordx4 v[56:59], v16, s[52:55], s82 offen offset:0 sc1
v_mfma_f32_16x16x32_bf16 v[76:79], v[164:167], v[100:103], v[76:79]
v_mfma_f32_16x16x32_bf16 v[80:83], v[168:171], v[100:103], v[80:83]
v_cvt_pk_bf16_f32 v64, v64, v65
v_cvt_pk_bf16_f32 v65, v66, v67
v_cvt_pk_bf16_f32 v66, v68, v69
v_cvt_pk_bf16_f32 v67, v70, v71
buffer_store_dwordx4 v[64:67], v16, s[52:55], s82 offen offset:2048 sc1
v_mfma_f32_16x16x32_bf16 v[84:87], v[172:175], v[100:103], v[84:87]
v_cvt_pk_bf16_f32 v72, v72, v73
v_cvt_pk_bf16_f32 v73, v74, v75
v_cvt_pk_bf16_f32 v74, v76, v77
v_cvt_pk_bf16_f32 v75, v78, v79
buffer_store_dwordx4 v[72:75], v16, s[52:55], s82 offen offset:1024 sc1
v_cvt_pk_bf16_f32 v80, v80, v81
v_cvt_pk_bf16_f32 v81, v82, v83
s_nop 0
v_cvt_pk_bf16_f32 v82, v84, v85
v_cvt_pk_bf16_f32 v83, v86, v87
buffer_store_dwordx4 v[80:83], v16, s[52:55], s82 offen offset:3072 sc1
s_branch L1_fin
L1_edge:
s_mov_b32 s61, 4
s_mov_b32 s4, s2
s_mul_i32 s6, s4, 20000
v_lshlrev_b32 v5, 4, v0
v_lshlrev_b32 v6, 2, v2
v_add_u32 v6, 0x10000, v6
v_mov_b32 v7, 0
ds_write_b32 v6, v7
s_mov_b32 s66, 0
s_mov_b32 s67, 8192
s_mov_b32 s68, 16384
s_waitcnt lgkmcnt(0)
s_add_u32 s56, s38, 0x7c00000
s_addc_u32 s57, s39, 0
s_mov_b32 s58, 0x2000
s_mov_b32 s59, 0x00020000
s_cmp_eq_u32 s4, 0
s_cselect_b32 s9, 0, 0x7fff0000
v_mov_b32 v8, 0
v_mov_b32 v9, 0
v_mov_b32 v10, 0
v_mov_b32 v11, 0
buffer_store_dwordx4 v[8:11], v5, s[56:59], s9 offen
s_add_u32 s40, s20, 0x0
s_addc_u32 s41, s21, 0
s_add_u32 s40, s40, s6
s_addc_u32 s41, s41, 0
s_mov_b32 s42, 0x4e20
s_mov_b32 s43, 0x00020000
s_add_u32 s44, s18, 0x0
s_addc_u32 s45, s19, 0
s_add_u32 s44, s44, s6
s_addc_u32 s45, s45, 0
s_mov_b32 s46, 0x4e20
s_mov_b32 s47, 0x00020000
buffer_load_dwordx4 v[16:19], v5, s[40:43], s66 offen
buffer_load_dwordx4 v[20:23], v5, s[40:43], s67 offen
buffer_load_dwordx4 v[24:27], v5, s[40:43], s68 offen
buffer_load_dwordx4 v[28:31], v5, s[44:47], s66 offen
buffer_load_dwordx4 v[32:35], v5, s[44:47], s67 offen
buffer_load_dwordx4 v[36:39], v5, s[44:47], s68 offen
s_add_u32 s48, s38, 0x8000000
s_addc_u32 s49, s39, 0
s_mov_b32 s50, 0x2800000
s_mov_b32 s51, 0x00020000
s_add_u32 s52, s38, 0x7800000
s_addc_u32 s53, s39, 0
s_mov_b32 s54, 0x2000
s_mov_b32 s55, 0x00020000
s_mov_b32 s9, 6279
s_mov_b32 s10, 4294967129
s_mov_b32 s11, 0x10000
v_mov_b32 v7, 1
v_cmp_gt_u32 vcc, 0xe2, v0
s_mov_b64 s[12:13], vcc
s_barrier
s_waitcnt vmcnt(5)
v_mul_u32_u24 v40, s9, v16
v_lshrrev_b32 v40, 20, v40
v_lshl_add_u32 v52, v40, 2, s11
ds_add_rtn_u32 v52, v52, v7
v_mad_i32_i24 v16, v40, s10, v16
v_mul_u32_u24 v41, s9, v17
v_lshrrev_b32 v41, 20, v41
v_lshl_add_u32 v53, v41, 2, s11
ds_add_rtn_u32 v53, v53, v7
v_mad_i32_i24 v17, v41, s10, v17
v_mul_u32_u24 v42, s9, v18
v_lshrrev_b32 v42, 20, v42
v_lshl_add_u32 v54, v42, 2, s11
ds_add_rtn_u32 v54, v54, v7
v_mad_i32_i24 v18, v42, s10, v18
v_mul_u32_u24 v43, s9, v19
v_lshrrev_b32 v43, 20, v43
v_lshl_add_u32 v55, v43, 2, s11
ds_add_rtn_u32 v55, v55, v7
v_mad_i32_i24 v19, v43, s10, v19
s_waitcnt vmcnt(4)
v_mul_u32_u24 v44, s9, v20
v_lshrrev_b32 v44, 20, v44
v_lshl_add_u32 v56, v44, 2, s11
ds_add_rtn_u32 v56, v56, v7
v_mad_i32_i24 v20, v44, s10, v20
v_mul_u32_u24 v45, s9, v21
v_lshrrev_b32 v45, 20, v45
v_lshl_add_u32 v57, v45, 2, s11
ds_add_rtn_u32 v57, v57, v7
v_mad_i32_i24 v21, v45, s10, v21
v_mul_u32_u24 v46, s9, v22
v_lshrrev_b32 v46, 20, v46
v_lshl_add_u32 v58, v46, 2, s11
ds_add_rtn_u32 v58, v58, v7
v_mad_i32_i24 v22, v46, s10, v22
v_mul_u32_u24 v47, s9, v23
v_lshrrev_b32 v47, 20, v47
v_lshl_add_u32 v59, v47, 2, s11
ds_add_rtn_u32 v59, v59, v7
v_mad_i32_i24 v23, v47, s10, v23
s_waitcnt vmcnt(3)
s_mov_b64 exec, s[12:13]
v_mul_u32_u24 v48, s9, v24
v_lshrrev_b32 v48, 20, v48
v_lshl_add_u32 v60, v48, 2, s11
ds_add_rtn_u32 v60, v60, v7
v_mad_i32_i24 v24, v48, s10, v24
v_mul_u32_u24 v49, s9, v25
v_lshrrev_b32 v49, 20, v49
v_lshl_add_u32 v61, v49, 2, s11
ds_add_rtn_u32 v61, v61, v7
v_mad_i32_i24 v25, v49, s10, v25
v_mul_u32_u24 v50, s9, v26
v_lshrrev_b32 v50, 20, v50
v_lshl_add_u32 v62, v50, 2, s11
ds_add_rtn_u32 v62, v62, v7
v_mad_i32_i24 v26, v50, s10, v26
v_mul_u32_u24 v51, s9, v27
v_lshrrev_b32 v51, 20, v51
v_lshl_add_u32 v63, v51, 2, s11
ds_add_rtn_u32 v63, v63, v7
v_mad_i32_i24 v27, v51, s10, v27
s_mov_b64 exec, -1
s_waitcnt vmcnt(2) lgkmcnt(4)
v_and_b32 v8, 0x7f, v52
v_lshl_or_b32 v28, v16, 18, v28
v_lshlrev_b32 v8, 2, v8
v_lshl_add_u32 v8, v40, 9, v8
ds_write_b32 v8, v28
v_and_b32 v8, 0x7f, v53
v_lshl_or_b32 v29, v17, 18, v29
v_lshlrev_b32 v8, 2, v8
v_lshl_add_u32 v8, v41, 9, v8
ds_write_b32 v8, v29
v_and_b32 v8, 0x7f, v54
v_lshl_or_b32 v30, v18, 18, v30
v_lshlrev_b32 v8, 2, v8
v_lshl_add_u32 v8, v42, 9, v8
ds_write_b32 v8, v30
v_and_b32 v8, 0x7f, v55
v_lshl_or_b32 v31, v19, 18, v31
v_lshlrev_b32 v8, 2, v8
v_lshl_add_u32 v8, v43, 9, v8
ds_write_b32 v8, v31
s_waitcnt vmcnt(1) lgkmcnt(4)
v_and_b32 v8, 0x7f, v56
v_lshl_or_b32 v32, v20, 18, v32
v_lshlrev_b32 v8, 2, v8
v_lshl_add_u32 v8, v44, 9, v8
ds_write_b32 v8, v32
v_and_b32 v8, 0x7f, v57
v_lshl_or_b32 v33, v21, 18, v33
v_lshlrev_b32 v8, 2, v8
v_lshl_add_u32 v8, v45, 9, v8
ds_write_b32 v8, v33
v_and_b32 v8, 0x7f, v58
v_lshl_or_b32 v34, v22, 18, v34
v_lshlrev_b32 v8, 2, v8
v_lshl_add_u32 v8, v46, 9, v8
ds_write_b32 v8, v34
v_and_b32 v8, 0x7f, v59
v_lshl_or_b32 v35, v23, 18, v35
v_lshlrev_b32 v8, 2, v8
v_lshl_add_u32 v8, v47, 9, v8
ds_write_b32 v8, v35
s_waitcnt vmcnt(0) lgkmcnt(8)
s_mov_b64 exec, s[12:13]
v_and_b32 v8, 0x7f, v60
v_lshl_or_b32 v36, v24, 18, v36
v_lshlrev_b32 v8, 2, v8
v_lshl_add_u32 v8, v48, 9, v8
ds_write_b32 v8, v36
v_and_b32 v8, 0x7f, v61
v_lshl_or_b32 v37, v25, 18, v37
v_lshlrev_b32 v8, 2, v8
v_lshl_add_u32 v8, v49, 9, v8
ds_write_b32 v8, v37
v_and_b32 v8, 0x7f, v62
v_lshl_or_b32 v38, v26, 18, v38
v_lshlrev_b32 v8, 2, v8
v_lshl_add_u32 v8, v50, 9, v8
ds_write_b32 v8, v38
v_and_b32 v8, 0x7f, v63
v_lshl_or_b32 v39, v27, 18, v39
v_lshlrev_b32 v8, 2, v8
v_lshl_add_u32 v8, v51, 9, v8
ds_write_b32 v8, v39
s_mov_b64 exec, -1
s_waitcnt lgkmcnt(0)
s_barrier
ds_read_b32 v8, v6
s_mul_i32 s6, s60, 4096
v_lshlrev_b32 v10, 4, v2
v_add_u32 v9, s6, v10
ds_read_b128 v[64:67], v9 offset:0
ds_read_b128 v[68:71], v9 offset:1024
ds_read_b128 v[72:75], v9 offset:2048
ds_read_b128 v[76:79], v9 offset:3072
v_lshrrev_b32 v11, 5, v2
v_mul_u32_u24 v11, 0x9fe00, v11
v_add_u32 v10, v10, v11
s_mul_i32 s6, s60, 5242880
s_mul_i32 s7, s4, 20480
s_add_u32 s6, s6, s7
v_lshlrev_b32 v9, 7, v2
s_lshl_b32 s8, s4, 2
s_cmp_eq_u32 s60, 0
s_cselect_b32 s8, s8, 0x7fff0000
s_waitcnt lgkmcnt(4)
buffer_store_dword v8, v9, s[52:55], s8 offen sc1
v_cmp_lt_u32 vcc, 0x80, v8
s_cbranch_vccnz L1_eslow
s_waitcnt lgkmcnt(3)
buffer_store_dwordx4 v[64:67], v10, s[48:51], s6 offen sc1
s_add_u32 s6, s6, 1310720
s_waitcnt lgkmcnt(2)
buffer_store_dwordx4 v[68:71], v10, s[48:51], s6 offen sc1
s_add_u32 s6, s6, 1310720
s_waitcnt lgkmcnt(1)
buffer_store_dwordx4 v[72:75], v10, s[48:51], s6 offen sc1
s_add_u32 s6, s6, 1310720
s_waitcnt lgkmcnt(0)
buffer_store_dwordx4 v[76:79], v10, s[48:51], s6 offen sc1
s_add_u32 s6, s6, 1310720
s_branch L1_fin
L1_eslow:
s_mov_b32 s9, 655360
v_mul_u32_u24 v40, s9, v40
v_lshl_add_u32 v40, v52, 2, v40
v_mul_u32_u24 v41, s9, v41
v_lshl_add_u32 v41, v53, 2, v41
v_mul_u32_u24 v42, s9, v42
v_lshl_add_u32 v42, v54, 2, v42
v_mul_u32_u24 v43, s9, v43
v_lshl_add_u32 v43, v55, 2, v43
v_mul_u32_u24 v44, s9, v44
v_lshl_add_u32 v44, v56, 2, v44
v_mul_u32_u24 v45, s9, v45
v_lshl_add_u32 v45, v57, 2, v45
v_mul_u32_u24 v46, s9, v46
v_lshl_add_u32 v46, v58, 2, v46
v_mul_u32_u24 v47, s9, v47
v_lshl_add_u32 v47, v59, 2, v47
v_mul_u32_u24 v48, s9, v48
v_lshl_add_u32 v48, v60, 2, v48
v_mul_u32_u24 v49, s9, v49
v_lshl_add_u32 v49, v61, 2, v49
v_mul_u32_u24 v50, s9, v50
v_lshl_add_u32 v50, v62, 2, v50
v_mul_u32_u24 v51, s9, v51
v_lshl_add_u32 v51, v63, 2, v51
buffer_store_dword v28, v40, s[48:51], s7 offen
buffer_store_dword v29, v41, s[48:51], s7 offen
buffer_store_dword v30, v42, s[48:51], s7 offen
buffer_store_dword v31, v43, s[48:51], s7 offen
buffer_store_dword v32, v44, s[48:51], s7 offen
buffer_store_dword v33, v45, s[48:51], s7 offen
buffer_store_dword v34, v46, s[48:51], s7 offen
buffer_store_dword v35, v47, s[48:51], s7 offen
s_mov_b64 exec, s[12:13]
buffer_store_dword v36, v48, s[48:51], s7 offen
buffer_store_dword v37, v49, s[48:51], s7 offen
buffer_store_dword v38, v50, s[48:51], s7 offen
buffer_store_dword v39, v51, s[48:51], s7 offen
s_mov_b64 exec, -1
L1_fin:
L1_end:
s_endpgm
.globl k2_kernel
.p2align 8
.type k2_kernel,@function
k2_kernel:
s_load_dwordx2 s[4:5], s[0:1], 88
s_load_dwordx2 s[6:7], s[0:1], 0
s_load_dwordx2 s[16:17], s[0:1], 24
s_load_dwordx2 s[18:19], s[0:1], 72
s_and_b32 s35, s2, 7
s_lshr_b32 s37, s2, 3
s_cmp_ge_u32 s37, 30
s_cbranch_scc1 LE_start
s_mul_i32 s38, s37, 52
s_lshr_b32 s38, s38, 8
s_mul_i32 s39, s38, 5
s_sub_u32 s39, s37, s39
s_mov_b32 s37, s38
s_mul_i32 s38, s35, 5
s_add_u32 s38, s38, s39
v_lshrrev_b32 v1, 6, v0
v_and_b32 v252, 63, v0
v_lshlrev_b32 v252, 4, v252
v_readfirstlane_b32 s34, v1
s_mov_b32 s50, 0xe1a06800
s_mov_b32 s51, 0x4e608d04
s_mul_i32 s39, s37, 9
s_lshr_b64 s[50:51], s[50:51], s39
s_and_b32 s39, s50, 0x1ff
s_bfe_u32 s49, s50, 0x90009
s_sub_u32 s29, s49, s39
s_lshl_b32 s50, s37, 2
s_lshr_b32 s59, 0x766666, s50
s_and_b32 s59, s59, 15
s_sub_u32 s31, s29, s59
s_lshr_b32 s31, s31, 1
s_sub_u32 s31, s31, 1
s_lshl_b32 s39, s39, 14
s_lshl_b32 s49, s49, 14
s_add_u32 s28, s39, 0x4000
s_cmp_eq_u32 s37, 5
s_cselect_b32 s33, 0xff800000, 0
s_mov_b32 s32, 0xffff
v_and_b32 v2, 63, v0
v_bfe_u32 v3, v2, 3, 2
v_bfe_u32 v4, v2, 2, 1
v_lshlrev_b32 v251, 12, v3
v_lshl_or_b32 v251, v4, 9, v251
v_lshl_or_b32 v251, v1, 7, v251
v_lshrrev_b32 v4, 5, v2
v_lshl_or_b32 v251, v4, 6, v251
v_and_b32 v3, 2, v3
v_and_b32 v4, 3, v2
v_xor_b32 v3, v3, v4
v_lshl_or_b32 v251, v3, 4, v251
s_cmp_eq_u32 s38, 39
s_cbranch_scc1 LT_disp
s_lshl_b32 s30, s34, 12
s_mov_b32 m0, s30
s_waitcnt lgkmcnt(0)
s_add_u32 s12, s4, 0x6800000
s_addc_u32 s13, s5, 0
s_mov_b32 s14, s49
s_mov_b32 s15, 0x00020000
buffer_load_dwordx4 v251, s[12:15], s39 offen offset:0 lds
buffer_load_dwordx4 v251, s[12:15], s39 offen offset:1024 lds
buffer_load_dwordx4 v251, s[12:15], s39 offen offset:2048 lds
buffer_load_dwordx4 v251, s[12:15], s39 offen offset:3072 lds
s_add_u32 m0, s30, 0x4000
s_nop 0
buffer_load_dwordx4 v251, s[12:15], s28 offen offset:0 lds
buffer_load_dwordx4 v251, s[12:15], s28 offen offset:1024 lds
s_add_u32 s8, s4, 0x0
s_addc_u32 s9, s5, 0
s_mov_b32 s10, 0x4e4000
s_mov_b32 s11, 0x00020000
s_mul_i32 s35, s37, 0x600000
s_add_u32 s20, s4, 0x2000000
s_addc_u32 s21, s5, 0
s_add_u32 s20, s20, s35
s_addc_u32 s21, s21, 0
s_mov_b32 s22, 0x4e4000
s_mov_b32 s23, 0x00020000
s_add_u32 s24, s4, 0x6000000
s_addc_u32 s25, s5, 0
s_mov_b32 s26, 0x9c800
s_mov_b32 s27, 0x00020000
s_lshl_b32 s35, s38, 4
s_lshl_b32 s41, s34, 2
s_add_u32 s35, s35, s41
s_mul_i32 s41, s37, 3
s_sub_u32 s42, s34, s41
s_and_b32 s42, s42, 3
s_add_u32 s41, s41, s42
s_lshr_b32 s41, s41, 2
s_cmp_eq_u32 s37, 5
s_cselect_b32 s42, 3, s42
s_cmp_lt_u32 s42, 3
s_cselect_b32 s41, s41, 0
s_cselect_b32 s50, 1, 0
s_add_u32 s35, s35, s41
s_lshl_b32 s40, s35, 13
s_lshl_b32 s48, s35, 10
s_lshl_b32 s35, s37, 3
s_add_u32 s48, s48, s35
s_xor_b32 s41, s40, 8192
s_xor_b32 s42, s40, 16384
s_xor_b32 s43, s40, 24576
s_add_u32 s44, s40, 4096
s_add_u32 s45, s41, 4096
s_add_u32 s46, s42, 4096
s_add_u32 s47, s43, 4096
s_mul_i32 s35, s37, 3
s_and_b32 s36, s35, 3
s_lshl_b32 s36, s36, 2
s_lshr_b32 s52, s35, 2
s_add_u32 s36, s36, s52
s_lshl_b32 s52, s38, 4
s_add_u32 s52, s52, s36
s_lshl_b32 s52, s52, 13
s_add_u32 s35, s35, 1
s_and_b32 s36, s35, 3
s_lshl_b32 s36, s36, 2
s_lshr_b32 s53, s35, 2
s_add_u32 s36, s36, s53
s_lshl_b32 s53, s38, 4
s_add_u32 s53, s53, s36
s_lshl_b32 s53, s53, 13
s_add_u32 s35, s35, 1
s_and_b32 s36, s35, 3
s_lshl_b32 s36, s36, 2
s_lshr_b32 s54, s35, 2
s_add_u32 s36, s36, s54
s_lshl_b32 s54, s38, 4
s_add_u32 s54, s54, s36
s_lshl_b32 s54, s54, 13
v_mov_b32 v208, 0
v_mov_b32 v209, 0
v_mov_b32 v210, 0
v_mov_b32 v211, 0
buffer_load_dwordx4 v[0:3], v252, s[8:11], s40 offen offset:0
buffer_load_dwordx4 v[32:35], v252, s[8:11], s41 offen offset:0
v_mfma_f32_32x32x16_bf16 a[0:15], v[208:211], v[208:211], 0
buffer_load_dwordx4 v[64:67], v252, s[8:11], s42 offen offset:0
v_mfma_f32_32x32x16_bf16 a[16:31], v[208:211], v[208:211], 0
buffer_load_dwordx4 v[96:99], v252, s[8:11], s43 offen offset:0
buffer_load_dwordx4 v[4:7], v252, s[8:11], s40 offen offset:1024
v_mfma_f32_32x32x16_bf16 a[32:47], v[208:211], v[208:211], 0
buffer_load_dwordx4 v[36:39], v252, s[8:11], s41 offen offset:1024
v_mfma_f32_32x32x16_bf16 a[48:63], v[208:211], v[208:211], 0
buffer_load_dwordx4 v[68:71], v252, s[8:11], s42 offen offset:1024
buffer_load_dwordx4 v[100:103], v252, s[8:11], s43 offen offset:1024
v_mfma_f32_32x32x16_bf16 a[64:79], v[208:211], v[208:211], 0
buffer_load_dwordx4 v[8:11], v252, s[8:11], s40 offen offset:2048
v_mfma_f32_32x32x16_bf16 a[80:95], v[208:211], v[208:211], 0
buffer_load_dwordx4 v[40:43], v252, s[8:11], s41 offen offset:2048
buffer_load_dwordx4 v[72:75], v252, s[8:11], s42 offen offset:2048
v_mfma_f32_32x32x16_bf16 a[96:111], v[208:211], v[208:211], 0
buffer_load_dwordx4 v[104:107], v252, s[8:11], s43 offen offset:2048
v_mfma_f32_32x32x16_bf16 a[112:127], v[208:211], v[208:211], 0
buffer_load_dwordx4 v[12:15], v252, s[8:11], s40 offen offset:3072
buffer_load_dwordx4 v[44:47], v252, s[8:11], s41 offen offset:3072
v_mfma_f32_32x32x16_bf16 a[128:143], v[208:211], v[208:211], 0
buffer_load_dwordx4 v[76:79], v252, s[8:11], s42 offen offset:3072
v_mfma_f32_32x32x16_bf16 a[144:159], v[208:211], v[208:211], 0
buffer_load_dwordx4 v[108:111], v252, s[8:11], s43 offen offset:3072
buffer_load_dwordx4 v[16:19], v252, s[8:11], s44 offen offset:0
v_mfma_f32_32x32x16_bf16 a[160:175], v[208:211], v[208:211], 0
buffer_load_dwordx4 v[48:51], v252, s[8:11], s45 offen offset:0
v_mfma_f32_32x32x16_bf16 a[176:191], v[208:211], v[208:211], 0
buffer_load_dwordx4 v[80:83], v252, s[8:11], s46 offen offset:0
buffer_load_dwordx4 v[112:115], v252, s[8:11], s47 offen offset:0
v_mfma_f32_32x32x16_bf16 a[192:207], v[208:211], v[208:211], 0
buffer_load_dwordx4 v[20:23], v252, s[8:11], s44 offen offset:1024
v_mfma_f32_32x32x16_bf16 a[208:223], v[208:211], v[208:211], 0
buffer_load_dwordx4 v[52:55], v252, s[8:11], s45 offen offset:1024
buffer_load_dwordx4 v[84:87], v252, s[8:11], s46 offen offset:1024
v_mfma_f32_32x32x16_bf16 a[224:239], v[208:211], v[208:211], 0
buffer_load_dwordx4 v[116:119], v252, s[8:11], s47 offen offset:1024
v_mfma_f32_32x32x16_bf16 a[240:255], v[208:211], v[208:211], 0
v_bfe_u32 v248, v252, 4, 3
v_lshlrev_b32 v248, 6, v248
v_bfe_u32 v253, v252, 7, 1
v_lshl_or_b32 v248, v253, 10, v248
v_bfe_u32 v253, v252, 8, 2
v_lshl_or_b32 v248, v253, 4, v248
v_bfe_u32 v253, v252, 6, 1
v_lshlrev_b32 v253, 5, v253
v_xor_b32 v248, v248, v253
v_and_b32 v249, 0x1c0, v252
v_bfe_u32 v253, v252, 9, 1
v_lshl_or_b32 v249, v253, 10, v249
v_bfe_u32 v253, v252, 8, 1
v_lshl_or_b32 v249, v253, 5, v249
v_bfe_u32 v253, v252, 4, 2
v_lshl_or_b32 v249, v253, 3, v249
v_xor_b32 v250, 32, v249
s_waitcnt vmcnt(24)
s_barrier
ds_read_b128 v[224:227], v248 offset:0
ds_read_b128 v[228:231], v248 offset:512
ds_read_b128 v[232:235], v248 offset:2048
ds_read_b128 v[236:239], v248 offset:2560
s_waitcnt lgkmcnt(2)
s_waitcnt vmcnt(16)
v_mfma_f32_16x16x32_bf16 v[160:163], v[224:227], v[0:3], 0
ds_read_b128 v[240:243], v248 offset:16384
v_mfma_f32_16x16x32_bf16 v[160:163], v[228:231], v[4:7], v[160:163]
buffer_load_dwordx4 v[24:27], v252, s[8:11], s44 offen offset:2048
v_mfma_f32_16x16x32_bf16 v[164:167], v[224:227], v[32:35], 0
v_mfma_f32_16x16x32_bf16 v[164:167], v[228:231], v[36:39], v[164:167]
buffer_load_dwordx4 v[56:59], v252, s[8:11], s45 offen offset:2048
v_mfma_f32_16x16x32_bf16 v[168:171], v[224:227], v[64:67], 0
ds_read_b128 v[244:247], v248 offset:16896
v_mfma_f32_16x16x32_bf16 v[168:171], v[228:231], v[68:71], v[168:171]
buffer_load_dwordx4 v[88:91], v252, s[8:11], s46 offen offset:2048
v_mfma_f32_16x16x32_bf16 v[172:175], v[224:227], v[96:99], 0
v_mfma_f32_16x16x32_bf16 v[172:175], v[228:231], v[100:103], v[172:175]
s_waitcnt lgkmcnt(2)
buffer_load_dwordx4 v[120:123], v252, s[8:11], s47 offen offset:2048
v_mfma_f32_16x16x32_bf16 v[176:179], v[232:235], v[0:3], 0
ds_read_b128 v[224:227], v248 offset:4096
v_mfma_f32_16x16x32_bf16 v[176:179], v[236:239], v[4:7], v[176:179]
buffer_load_dwordx4 v[28:31], v252, s[8:11], s44 offen offset:3072
v_mfma_f32_16x16x32_bf16 v[180:183], v[232:235], v[32:35], 0
v_mfma_f32_16x16x32_bf16 v[180:183], v[236:239], v[36:39], v[180:183]
buffer_load_dwordx4 v[60:63], v252, s[8:11], s45 offen offset:3072
v_mfma_f32_16x16x32_bf16 v[184:187], v[232:235], v[64:67], 0
ds_read_b128 v[228:231], v248 offset:4608
v_mfma_f32_16x16x32_bf16 v[184:187], v[236:239], v[68:71], v[184:187]
buffer_load_dwordx4 v[92:95], v252, s[8:11], s46 offen offset:3072
v_mfma_f32_16x16x32_bf16 v[188:191], v[232:235], v[96:99], 0
v_mfma_f32_16x16x32_bf16 v[188:191], v[236:239], v[100:103], v[188:191]
s_waitcnt lgkmcnt(2)
buffer_load_dwordx4 v[124:127], v252, s[8:11], s47 offen offset:3072
v_mfma_f32_16x16x32_bf16 v[192:195], v[240:243], v[0:3], 0
ds_read_b128 v[232:235], v248 offset:6144
v_mfma_f32_16x16x32_bf16 v[192:195], v[244:247], v[4:7], v[192:195]
v_mfma_f32_16x16x32_bf16 v[196:199], v[240:243], v[32:35], 0
v_mfma_f32_16x16x32_bf16 v[196:199], v[244:247], v[36:39], v[196:199]
v_mfma_f32_16x16x32_bf16 v[200:203], v[240:243], v[64:67], 0
ds_read_b128 v[236:239], v248 offset:6656
v_mfma_f32_16x16x32_bf16 v[200:203], v[244:247], v[68:71], v[200:203]
v_mfma_f32_16x16x32_bf16 v[204:207], v[240:243], v[96:99], 0
v_mfma_f32_16x16x32_bf16 v[204:207], v[244:247], v[100:103], v[204:207]
s_waitcnt lgkmcnt(2)
s_waitcnt vmcnt(16)
v_mfma_f32_16x16x32_bf16 v[160:163], v[224:227], v[8:11], v[160:163]
ds_read_b128 v[240:243], v248 offset:20480
v_mfma_f32_16x16x32_bf16 v[160:163], v[228:231], v[12:15], v[160:163]
buffer_load_dwordx4 v251, s[12:15], s28 offen offset:2048 lds
v_mfma_f32_16x16x32_bf16 v[164:167], v[224:227], v[40:43], v[164:167]
v_mfma_f32_16x16x32_bf16 v[164:167], v[228:231], v[44:47], v[164:167]
buffer_load_dwordx4 v251, s[12:15], s28 offen offset:3072 lds
v_mfma_f32_16x16x32_bf16 v[168:171], v[224:227], v[72:75], v[168:171]
ds_read_b128 v[244:247], v248 offset:20992
v_mfma_f32_16x16x32_bf16 v[168:171], v[228:231], v[76:79], v[168:171]
s_add_u32 s28, s28, 0x4000
s_add_u32 m0, s30, 0x8000
s_nop 0
v_mfma_f32_16x16x32_bf16 v[172:175], v[224:227], v[104:107], v[172:175]
v_mfma_f32_16x16x32_bf16 v[172:175], v[228:231], v[108:111], v[172:175]
s_waitcnt lgkmcnt(2)
buffer_load_dwordx4 v251, s[12:15], s28 offen offset:0 lds
v_mfma_f32_16x16x32_bf16 v[176:179], v[232:235], v[8:11], v[176:179]
ds_read_b128 v[224:227], v248 offset:8192
v_mfma_f32_16x16x32_bf16 v[176:179], v[236:239], v[12:15], v[176:179]
buffer_load_dwordx4 v251, s[12:15], s28 offen offset:1024 lds
v_mfma_f32_16x16x32_bf16 v[180:183], v[232:235], v[40:43], v[180:183]
v_mfma_f32_16x16x32_bf16 v[180:183], v[236:239], v[44:47], v[180:183]
buffer_load_dwordx4 v251, s[12:15], s28 offen offset:2048 lds
v_mfma_f32_16x16x32_bf16 v[184:187], v[232:235], v[72:75], v[184:187]
ds_read_b128 v[228:231], v248 offset:8704
v_mfma_f32_16x16x32_bf16 v[184:187], v[236:239], v[76:79], v[184:187]
buffer_load_dwordx4 v251, s[12:15], s28 offen offset:3072 lds
v_mfma_f32_16x16x32_bf16 v[188:191], v[232:235], v[104:107], v[188:191]
v_mfma_f32_16x16x32_bf16 v[188:191], v[236:239], v[108:111], v[188:191]
s_waitcnt lgkmcnt(2)
v_mfma_f32_16x16x32_bf16 v[192:195], v[240:243], v[8:11], v[192:195]
ds_read_b128 v[232:235], v248 offset:10240
v_mfma_f32_16x16x32_bf16 v[192:195], v[244:247], v[12:15], v[192:195]
v_mfma_f32_16x16x32_bf16 v[196:199], v[240:243], v[40:43], v[196:199]
v_mfma_f32_16x16x32_bf16 v[196:199], v[244:247], v[44:47], v[196:199]
v_mfma_f32_16x16x32_bf16 v[200:203], v[240:243], v[72:75], v[200:203]
ds_read_b128 v[236:239], v248 offset:10752
v_mfma_f32_16x16x32_bf16 v[200:203], v[244:247], v[76:79], v[200:203]
v_mfma_f32_16x16x32_bf16 v[204:207], v[240:243], v[104:107], v[204:207]
v_mfma_f32_16x16x32_bf16 v[204:207], v[244:247], v[108:111], v[204:207]
s_waitcnt lgkmcnt(2)
s_waitcnt vmcnt(14)
v_mfma_f32_16x16x32_bf16 v[160:163], v[224:227], v[16:19], v[160:163]
ds_read_b128 v[240:243], v248 offset:24576
v_mfma_f32_16x16x32_bf16 v[160:163], v[228:231], v[20:23], v[160:163]
s_add_u32 s28, s28, 0x4000
s_add_u32 m0, s30, 0xc000
s_nop 0
v_mfma_f32_16x16x32_bf16 v[164:167], v[224:227], v[48:51], v[164:167]
v_mfma_f32_16x16x32_bf16 v[164:167], v[228:231], v[52:55], v[164:167]
buffer_load_dwordx4 v251, s[12:15], s28 offen offset:0 lds
v_mfma_f32_16x16x32_bf16 v[168:171], v[224:227], v[80:83], v[168:171]
ds_read_b128 v[244:247], v248 offset:25088
v_mfma_f32_16x16x32_bf16 v[168:171], v[228:231], v[84:87], v[168:171]
buffer_load_dwordx4 v251, s[12:15], s28 offen offset:1024 lds
v_mfma_f32_16x16x32_bf16 v[172:175], v[224:227], v[112:115], v[172:175]
v_mfma_f32_16x16x32_bf16 v[172:175], v[228:231], v[116:119], v[172:175]
s_waitcnt lgkmcnt(2)
buffer_load_dwordx4 v251, s[12:15], s28 offen offset:2048 lds
v_mfma_f32_16x16x32_bf16 v[176:179], v[232:235], v[16:19], v[176:179]
ds_read_b128 v[224:227], v248 offset:12288
v_mfma_f32_16x16x32_bf16 v[176:179], v[236:239], v[20:23], v[176:179]
buffer_load_dwordx4 v251, s[12:15], s28 offen offset:3072 lds
v_mfma_f32_16x16x32_bf16 v[180:183], v[232:235], v[48:51], v[180:183]
v_mfma_f32_16x16x32_bf16 v[180:183], v[236:239], v[52:55], v[180:183]
v_mfma_f32_16x16x32_bf16 v[184:187], v[232:235], v[80:83], v[184:187]
ds_read_b128 v[228:231], v248 offset:12800
v_mfma_f32_16x16x32_bf16 v[184:187], v[236:239], v[84:87], v[184:187]
v_mfma_f32_16x16x32_bf16 v[188:191], v[232:235], v[112:115], v[188:191]
v_mfma_f32_16x16x32_bf16 v[188:191], v[236:239], v[116:119], v[188:191]
s_waitcnt lgkmcnt(2)
v_mfma_f32_16x16x32_bf16 v[192:195], v[240:243], v[16:19], v[192:195]
ds_read_b128 v[232:235], v248 offset:14336
v_mfma_f32_16x16x32_bf16 v[192:195], v[244:247], v[20:23], v[192:195]
v_mfma_f32_16x16x32_bf16 v[196:199], v[240:243], v[48:51], v[196:199]
v_mfma_f32_16x16x32_bf16 v[196:199], v[244:247], v[52:55], v[196:199]
v_mfma_f32_16x16x32_bf16 v[200:203], v[240:243], v[80:83], v[200:203]
ds_read_b128 v[236:239], v248 offset:14848
v_mfma_f32_16x16x32_bf16 v[200:203], v[244:247], v[84:87], v[200:203]
v_mfma_f32_16x16x32_bf16 v[204:207], v[240:243], v[112:115], v[204:207]
v_mfma_f32_16x16x32_bf16 v[204:207], v[244:247], v[116:119], v[204:207]
s_waitcnt lgkmcnt(2)
s_waitcnt vmcnt(10)
v_mfma_f32_16x16x32_bf16 v[160:163], v[224:227], v[24:27], v[160:163]
ds_read_b128 v[240:243], v248 offset:28672
v_mfma_f32_16x16x32_bf16 v[160:163], v[228:231], v[28:31], v[160:163]
s_add_u32 s28, s28, 0x4000
s_add_u32 m0, s30, 0x10000
s_nop 0
v_mfma_f32_16x16x32_bf16 v[164:167], v[224:227], v[56:59], v[164:167]
v_mfma_f32_16x16x32_bf16 v[164:167], v[228:231], v[60:63], v[164:167]
buffer_load_dwordx4 v251, s[12:15], s28 offen offset:0 lds
v_mfma_f32_16x16x32_bf16 v[168:171], v[224:227], v[88:91], v[168:171]
ds_read_b128 v[244:247], v248 offset:29184
v_mfma_f32_16x16x32_bf16 v[168:171], v[228:231], v[92:95], v[168:171]
buffer_load_dwordx4 v251, s[12:15], s28 offen offset:1024 lds
v_mfma_f32_16x16x32_bf16 v[172:175], v[224:227], v[120:123], v[172:175]
v_mfma_f32_16x16x32_bf16 v[172:175], v[228:231], v[124:127], v[172:175]
s_waitcnt lgkmcnt(2)
buffer_load_dwordx4 v251, s[12:15], s28 offen offset:2048 lds
v_mfma_f32_16x16x32_bf16 v[176:179], v[232:235], v[24:27], v[176:179]
v_mfma_f32_16x16x32_bf16 v[176:179], v[236:239], v[28:31], v[176:179]
buffer_load_dwordx4 v251, s[12:15], s28 offen offset:3072 lds
v_mfma_f32_16x16x32_bf16 v[180:183], v[232:235], v[56:59], v[180:183]
v_mfma_f32_16x16x32_bf16 v[180:183], v[236:239], v[60:63], v[180:183]
v_mfma_f32_16x16x32_bf16 v[184:187], v[232:235], v[88:91], v[184:187]
v_mfma_f32_16x16x32_bf16 v[184:187], v[236:239], v[92:95], v[184:187]
v_mfma_f32_16x16x32_bf16 v[188:191], v[232:235], v[120:123], v[188:191]
v_mfma_f32_16x16x32_bf16 v[188:191], v[236:239], v[124:127], v[188:191]
s_waitcnt lgkmcnt(0)
v_mfma_f32_16x16x32_bf16 v[192:195], v[240:243], v[24:27], v[192:195]
v_mfma_f32_16x16x32_bf16 v[192:195], v[244:247], v[28:31], v[192:195]
v_mfma_f32_16x16x32_bf16 v[196:199], v[240:243], v[56:59], v[196:199]
v_mfma_f32_16x16x32_bf16 v[196:199], v[244:247], v[60:63], v[196:199]
v_mfma_f32_16x16x32_bf16 v[200:203], v[240:243], v[88:91], v[200:203]
v_mfma_f32_16x16x32_bf16 v[200:203], v[244:247], v[92:95], v[200:203]
v_mfma_f32_16x16x32_bf16 v[204:207], v[240:243], v[120:123], v[204:207]
v_mfma_f32_16x16x32_bf16 v[204:207], v[244:247], v[124:127], v[204:207]
s_nop 3
v_max3_f32 v224, v160, v161, v162
v_max3_f32 v225, v164, v165, v166
v_max3_f32 v226, v168, v169, v170
v_max3_f32 v227, v172, v173, v174
v_max3_f32 v224, v224, v163, v176
v_max3_f32 v225, v225, v167, v180
v_max3_f32 v226, v226, v171, v184
v_max3_f32 v227, v227, v175, v188
v_max3_f32 v224, v224, v177, v178
v_max3_f32 v225, v225, v181, v182
v_max3_f32 v226, v226, v185, v186
v_max3_f32 v227, v227, v189, v190
v_max_f32 v224, v224, v179
v_max_f32 v225, v225, v183
v_max_f32 v226, v226, v187
v_max_f32 v227, v227, v191
s_add_u32 s28, s28, 0x4000
s_xor_b32 s30, s30, 0x10000
v_mov_b32 v228, v224
v_mov_b32 v229, v225
v_mov_b32 v230, v226
v_mov_b32 v231, v227
v_permlane32_swap_b32 v224, v228
v_permlane32_swap_b32 v225, v229
v_permlane32_swap_b32 v226, v230
v_permlane32_swap_b32 v227, v231
v_max_f32 v224, v224, v228
v_max_f32 v225, v225, v229
v_max_f32 v226, v226, v230
v_max_f32 v227, v227, v231
v_mov_b32 v228, v224
v_mov_b32 v229, v225
v_mov_b32 v230, v226
v_mov_b32 v231, v227
v_permlane16_swap_b32 v224, v228
v_permlane16_swap_b32 v225, v229
v_permlane16_swap_b32 v226, v230
v_permlane16_swap_b32 v227, v231
v_max_f32 v224, v224, v228
v_max_f32 v225, v225, v229
v_max_f32 v226, v226, v230
v_max_f32 v227, v227, v231
s_waitcnt vmcnt(8)
s_barrier
ds_read_b128 v[232:235], v248 offset:18432
ds_read_b128 v[236:239], v248 offset:18944
ds_read_b128 v[240:243], v248 offset:22528
ds_read_b128 v[244:247], v248 offset:23040
v_cvt_pk_bf16_f32 v228, -v224, -v224
v_cvt_pk_bf16_f32 v229, -v225, -v225
v_cvt_pk_bf16_f32 v230, -v226, -v226
v_cvt_pk_bf16_f32 v231, -v227, -v227
v_lshlrev_b32 v253, 2, v252
v_lshlrev_b32 v147, 16, v228
v_lshlrev_b32 v151, 16, v229
v_lshlrev_b32 v155, 16, v230
v_lshlrev_b32 v159, 16, v231
s_mov_b64 exec, 0xffff
v_bfi_b32 v0, s32, v228, v0
v_bfi_b32 v32, s32, v229, v32
v_bfi_b32 v64, s32, v230, v64
v_bfi_b32 v96, s32, v231, v96
v_xor_b32 v224, 0x80000000, v147
v_xor_b32 v225, 0x80000000, v151
v_xor_b32 v226, 0x80000000, v155
v_xor_b32 v227, 0x80000000, v159
s_xor_b32 s35, s48, 0
buffer_store_dword v224, v253, s[24:27], s35 offen offset:0 sc1
s_xor_b32 s35, s48, 1024
buffer_store_dword v225, v253, s[24:27], s35 offen offset:0 sc1
s_xor_b32 s35, s48, 2048
buffer_store_dword v226, v253, s[24:27], s35 offen offset:0 sc1
s_xor_b32 s35, s48, 3072
buffer_store_dword v227, v253, s[24:27], s35 offen offset:0 sc1
s_mov_b64 exec, -1
s_waitcnt lgkmcnt(2)
v_mfma_f32_16x16x32_bf16 v[208:211], v[232:235], v[0:3], 0
ds_read_b128 v[224:227], v248 offset:26624
v_add_f32 v192, v192, v147
v_add_f32 v193, v193, v147
v_add_f32 v194, v194, v147
v_mfma_f32_16x16x32_bf16 v[208:211], v[236:239], v[4:7], v[208:211]
v_add_f32 v195, v195, v147
v_exp_f32 v192, v192
v_mfma_f32_16x16x32_bf16 v[212:215], v[232:235], v[32:35], 0
v_exp_f32 v193, v193
v_exp_f32 v194, v194
v_mfma_f32_16x16x32_bf16 v[212:215], v[236:239], v[36:39], v[212:215]
v_exp_f32 v195, v195
v_add_f32 v196, v196, v151
v_add_f32 v197, v197, v151
v_mfma_f32_16x16x32_bf16 v[216:219], v[232:235], v[64:67], 0
ds_read_b128 v[228:231], v248 offset:27136
v_cvt_pk_bf16_f32 v144, v192, v193
v_cvt_pk_bf16_f32 v145, v194, v195
v_add_f32 v198, v198, v151
v_mfma_f32_16x16x32_bf16 v[216:219], v[236:239], v[68:71], v[216:219]
v_add_f32 v199, v199, v151
v_exp_f32 v196, v196
v_mfma_f32_16x16x32_bf16 v[220:223], v[232:235], v[96:99], 0
v_exp_f32 v197, v197
v_exp_f32 v198, v198
v_mfma_f32_16x16x32_bf16 v[220:223], v[236:239], v[100:103], v[220:223]
s_waitcnt lgkmcnt(2)
v_exp_f32 v199, v199
v_cvt_pk_bf16_f32 v148, v196, v197
v_mfma_f32_16x16x32_bf16 v[208:211], v[240:243], v[8:11], v[208:211]
ds_read_b128 v[232:235], v248 offset:30720
v_cvt_pk_bf16_f32 v149, v198, v199
v_add_f32 v200, v200, v155
v_add_f32 v201, v201, v155
v_mfma_f32_16x16x32_bf16 v[208:211], v[244:247], v[12:15], v[208:211]
v_add_f32 v202, v202, v155
v_add_f32 v203, v203, v155
v_exp_f32 v200, v200
v_mfma_f32_16x16x32_bf16 v[212:215], v[240:243], v[40:43], v[212:215]
v_exp_f32 v201, v201
v_exp_f32 v202, v202
v_mfma_f32_16x16x32_bf16 v[212:215], v[244:247], v[44:47], v[212:215]
v_exp_f32 v203, v203
v_add_f32 v204, v204, v159
v_add_f32 v205, v205, v159
v_mfma_f32_16x16x32_bf16 v[216:219], v[240:243], v[72:75], v[216:219]
ds_read_b128 v[236:239], v248 offset:31232
v_cvt_pk_bf16_f32 v152, v200, v201
v_cvt_pk_bf16_f32 v153, v202, v203
v_add_f32 v206, v206, v159
v_mfma_f32_16x16x32_bf16 v[216:219], v[244:247], v[76:79], v[216:219]
v_add_f32 v207, v207, v159
v_exp_f32 v204, v204
v_mfma_f32_16x16x32_bf16 v[220:223], v[240:243], v[104:107], v[220:223]
v_exp_f32 v205, v205
v_exp_f32 v206, v206
v_mfma_f32_16x16x32_bf16 v[220:223], v[244:247], v[108:111], v[220:223]
s_waitcnt lgkmcnt(2)
v_exp_f32 v207, v207
v_cvt_pk_bf16_f32 v156, v204, v205
v_mfma_f32_16x16x32_bf16 v[208:211], v[224:227], v[16:19], v[208:211]
ds_read_b128 v[240:243], v248 offset:32768
v_cvt_pk_bf16_f32 v157, v206, v207
v_add_f32 v160, v160, v147
v_add_f32 v161, v161, v147
v_mfma_f32_16x16x32_bf16 v[208:211], v[228:231], v[20:23], v[208:211]
v_add_f32 v162, v162, v147
v_add_f32 v163, v163, v147
v_exp_f32 v160, v160
v_mfma_f32_16x16x32_bf16 v[212:215], v[224:227], v[48:51], v[212:215]
v_exp_f32 v161, v161
v_exp_f32 v162, v162
v_mfma_f32_16x16x32_bf16 v[212:215], v[228:231], v[52:55], v[212:215]
v_exp_f32 v163, v163
v_add_f32 v164, v164, v151
v_add_f32 v165, v165, v151
v_mfma_f32_16x16x32_bf16 v[216:219], v[224:227], v[80:83], v[216:219]
ds_read_b128 v[244:247], v248 offset:33280
v_cvt_pk_bf16_f32 v128, v160, v161
v_cvt_pk_bf16_f32 v129, v162, v163
v_add_f32 v166, v166, v151
v_mfma_f32_16x16x32_bf16 v[216:219], v[228:231], v[84:87], v[216:219]
v_add_f32 v167, v167, v151
v_exp_f32 v164, v164
v_mfma_f32_16x16x32_bf16 v[220:223], v[224:227], v[112:115], v[220:223]
v_exp_f32 v165, v165
v_exp_f32 v166, v166
v_mfma_f32_16x16x32_bf16 v[220:223], v[228:231], v[116:119], v[220:223]
s_waitcnt lgkmcnt(2)
v_exp_f32 v167, v167
v_cvt_pk_bf16_f32 v132, v164, v165
v_mfma_f32_16x16x32_bf16 v[208:211], v[232:235], v[24:27], v[208:211]
ds_read_b128 v[224:227], v248 offset:36864
v_cvt_pk_bf16_f32 v133, v166, v167
v_add_f32 v168, v168, v155
v_add_f32 v169, v169, v155
v_mfma_f32_16x16x32_bf16 v[208:211], v[236:239], v[28:31], v[208:211]
v_add_f32 v170, v170, v155
v_add_f32 v171, v171, v155
v_exp_f32 v168, v168
v_mfma_f32_16x16x32_bf16 v[212:215], v[232:235], v[56:59], v[212:215]
v_exp_f32 v169, v169
v_exp_f32 v170, v170
v_mfma_f32_16x16x32_bf16 v[212:215], v[236:239], v[60:63], v[212:215]
v_exp_f32 v171, v171
v_add_f32 v172, v172, v159
v_add_f32 v173, v173, v159
v_mfma_f32_16x16x32_bf16 v[216:219], v[232:235], v[88:91], v[216:219]
ds_read_b128 v[228:231], v248 offset:37376
v_cvt_pk_bf16_f32 v136, v168, v169
v_cvt_pk_bf16_f32 v137, v170, v171
v_add_f32 v174, v174, v159
v_mfma_f32_16x16x32_bf16 v[216:219], v[236:239], v[92:95], v[216:219]
v_add_f32 v175, v175, v159
v_exp_f32 v172, v172
v_mfma_f32_16x16x32_bf16 v[220:223], v[232:235], v[120:123], v[220:223]
v_exp_f32 v173, v173
v_exp_f32 v174, v174
v_mfma_f32_16x16x32_bf16 v[220:223], v[236:239], v[124:127], v[220:223]
s_waitcnt lgkmcnt(2)
v_exp_f32 v175, v175
v_cvt_pk_bf16_f32 v140, v172, v173
v_mfma_f32_16x16x32_bf16 v[192:195], v[240:243], v[0:3], 0
ds_read_b128 v[232:235], v248 offset:40960
v_cvt_pk_bf16_f32 v141, v174, v175
v_add_f32 v176, v176, v147
v_add_f32 v177, v177, v147
v_mfma_f32_16x16x32_bf16 v[192:195], v[244:247], v[4:7], v[192:195]
v_add_f32 v178, v178, v147
v_add_f32 v179, v179, v147
v_exp_f32 v176, v176
v_mfma_f32_16x16x32_bf16 v[196:199], v[240:243], v[32:35], 0
v_exp_f32 v177, v177
v_exp_f32 v178, v178
v_mfma_f32_16x16x32_bf16 v[196:199], v[244:247], v[36:39], v[196:199]
v_exp_f32 v179, v179
v_add_f32 v180, v180, v151
v_add_f32 v181, v181, v151
v_mfma_f32_16x16x32_bf16 v[200:203], v[240:243], v[64:67], 0
ds_read_b128 v[236:239], v248 offset:41472
v_cvt_pk_bf16_f32 v130, v176, v177
v_cvt_pk_bf16_f32 v131, v178, v179
v_add_f32 v182, v182, v151
v_mfma_f32_16x16x32_bf16 v[200:203], v[244:247], v[68:71], v[200:203]
v_add_f32 v183, v183, v151
v_exp_f32 v180, v180
v_mfma_f32_16x16x32_bf16 v[204:207], v[240:243], v[96:99], 0
v_exp_f32 v181, v181
v_exp_f32 v182, v182
v_mfma_f32_16x16x32_bf16 v[204:207], v[244:247], v[100:103], v[204:207]
s_waitcnt lgkmcnt(2)
v_exp_f32 v183, v183
v_cvt_pk_bf16_f32 v134, v180, v181
v_mfma_f32_16x16x32_bf16 v[192:195], v[224:227], v[8:11], v[192:195]
ds_read_b128 v[240:243], v248 offset:45056
v_cvt_pk_bf16_f32 v135, v182, v183
v_add_f32 v184, v184, v155
v_add_f32 v185, v185, v155
v_mfma_f32_16x16x32_bf16 v[192:195], v[228:231], v[12:15], v[192:195]
v_add_f32 v186, v186, v155
v_add_f32 v187, v187, v155
v_exp_f32 v184, v184
v_mfma_f32_16x16x32_bf16 v[196:199], v[224:227], v[40:43], v[196:199]
v_exp_f32 v185, v185
v_exp_f32 v186, v186
v_mfma_f32_16x16x32_bf16 v[196:199], v[228:231], v[44:47], v[196:199]
v_exp_f32 v187, v187
v_add_f32 v188, v188, v159
v_add_f32 v189, v189, v159
v_mfma_f32_16x16x32_bf16 v[200:203], v[224:227], v[72:75], v[200:203]
ds_read_b128 v[244:247], v248 offset:45568
v_cvt_pk_bf16_f32 v138, v184, v185
v_cvt_pk_bf16_f32 v139, v186, v187
v_add_f32 v190, v190, v159
v_mfma_f32_16x16x32_bf16 v[200:203], v[228:231], v[76:79], v[200:203]
v_add_f32 v191, v191, v159
v_exp_f32 v188, v188
v_mfma_f32_16x16x32_bf16 v[204:207], v[224:227], v[104:107], v[204:207]
v_exp_f32 v189, v189
v_exp_f32 v190, v190
v_mfma_f32_16x16x32_bf16 v[204:207], v[228:231], v[108:111], v[204:207]
s_waitcnt lgkmcnt(2)
v_exp_f32 v191, v191
v_cvt_pk_bf16_f32 v142, v188, v189
v_mfma_f32_16x16x32_bf16 v[192:195], v[232:235], v[16:19], v[192:195]
ds_read_b64_tr_b16 v[224:225], v249 offset:0
v_cvt_pk_bf16_f32 v143, v190, v191
v_exp_f32 v208, v208
v_mfma_f32_16x16x32_bf16 v[192:195], v[236:239], v[20:23], v[192:195]
v_exp_f32 v209, v209
v_exp_f32 v210, v210
v_mfma_f32_16x16x32_bf16 v[196:199], v[232:235], v[48:51], v[196:199]
ds_read_b64_tr_b16 v[226:227], v249 offset:2048
v_exp_f32 v211, v211
v_cvt_pk_bf16_f32 v146, v208, v209
v_mfma_f32_16x16x32_bf16 v[196:199], v[236:239], v[52:55], v[196:199]
v_cvt_pk_bf16_f32 v147, v210, v211
v_exp_f32 v212, v212
v_mfma_f32_16x16x32_bf16 v[200:203], v[232:235], v[80:83], v[200:203]
ds_read_b64_tr_b16 v[228:229], v249 offset:16384
v_exp_f32 v213, v213
v_mfma_f32_16x16x32_bf16 v[200:203], v[236:239], v[84:87], v[200:203]
v_exp_f32 v214, v214
v_exp_f32 v215, v215
v_mfma_f32_16x16x32_bf16 v[204:207], v[232:235], v[112:115], v[204:207]
ds_read_b64_tr_b16 v[230:231], v249 offset:18432
v_cvt_pk_bf16_f32 v150, v212, v213
v_cvt_pk_bf16_f32 v151, v214, v215
v_mfma_f32_16x16x32_bf16 v[204:207], v[236:239], v[116:119], v[204:207]
s_waitcnt lgkmcnt(4)
v_exp_f32 v216, v216
v_mfma_f32_16x16x32_bf16 v[192:195], v[240:243], v[24:27], v[192:195]
ds_read_b64_tr_b16 v[232:233], v250 offset:0
v_exp_f32 v217, v217
v_mfma_f32_16x16x32_bf16 v[192:195], v[244:247], v[28:31], v[192:195]
v_exp_f32 v218, v218
v_exp_f32 v219, v219
v_mfma_f32_16x16x32_bf16 v[196:199], v[240:243], v[56:59], v[196:199]
ds_read_b64_tr_b16 v[234:235], v250 offset:2048
v_cvt_pk_bf16_f32 v154, v216, v217
v_cvt_pk_bf16_f32 v155, v218, v219
v_mfma_f32_16x16x32_bf16 v[196:199], v[244:247], v[60:63], v[196:199]
v_exp_f32 v220, v220
v_exp_f32 v221, v221
v_mfma_f32_16x16x32_bf16 v[200:203], v[240:243], v[88:91], v[200:203]
ds_read_b64_tr_b16 v[236:237], v250 offset:16384
v_exp_f32 v222, v222
v_cvt_pk_bf16_f32 v158, v220, v221
v_mfma_f32_16x16x32_bf16 v[200:203], v[244:247], v[92:95], v[200:203]
v_exp_f32 v223, v223
v_mfma_f32_16x16x32_bf16 v[204:207], v[240:243], v[120:123], v[204:207]
ds_read_b64_tr_b16 v[238:239], v250 offset:18432
v_cvt_pk_bf16_f32 v159, v222, v223
v_mfma_f32_16x16x32_bf16 v[204:207], v[244:247], v[124:127], v[204:207]
s_cmp_eq_u32 s50, 1
s_cselect_b32 s40, 0x7fff0000, s40
s_cselect_b32 s44, 0x7fff0000, s44
.p2align 6
L2_loop:
s_waitcnt lgkmcnt(4)
v_mfma_f32_16x16x32_bf16 a[0:3], v[224:227], v[128:131], a[0:3]
ds_read_b64_tr_b16 v[240:241], v249 offset:512
v_mfma_f32_16x16x32_bf16 a[0:3], v[228:231], v[144:147], a[0:3]
v_mfma_f32_16x16x32_bf16 a[4:7], v[224:227], v[132:135], a[4:7]
ds_read_b64_tr_b16 v[242:243], v249 offset:2560
v_mfma_f32_16x16x32_bf16 a[4:7], v[228:231], v[148:151], a[4:7]
v_exp_f32 v192, v192
v_mfma_f32_16x16x32_bf16 a[8:11], v[224:227], v[136:139], a[8:11]
ds_read_b64_tr_b16 v[244:245], v249 offset:16896
v_mfma_f32_16x16x32_bf16 a[8:11], v[228:231], v[152:155], a[8:11]
v_exp_f32 v193, v193
v_mfma_f32_16x16x32_bf16 a[12:15], v[224:227], v[140:143], a[12:15]
ds_read_b64_tr_b16 v[246:247], v249 offset:18944
v_cvt_pk_bf16_f32 v160, v192, v193
v_mfma_f32_16x16x32_bf16 a[12:15], v[228:231], v[156:159], a[12:15]
s_waitcnt lgkmcnt(4)
v_mfma_f32_16x16x32_bf16 a[16:19], v[232:235], v[128:131], a[16:19]
ds_read_b64_tr_b16 v[176:177], v250 offset:512
v_mfma_f32_16x16x32_bf16 a[16:19], v[236:239], v[144:147], a[16:19]
v_exp_f32 v194, v194
v_mfma_f32_16x16x32_bf16 a[20:23], v[232:235], v[132:135], a[20:23]
ds_read_b64_tr_b16 v[178:179], v250 offset:2560
v_mfma_f32_16x16x32_bf16 a[20:23], v[236:239], v[148:151], a[20:23]
v_exp_f32 v195, v195
v_mfma_f32_16x16x32_bf16 a[24:27], v[232:235], v[136:139], a[24:27]
ds_read_b64_tr_b16 v[180:181], v250 offset:16896
v_cvt_pk_bf16_f32 v161, v194, v195
v_mfma_f32_16x16x32_bf16 a[24:27], v[236:239], v[152:155], a[24:27]
v_exp_f32 v196, v196
v_mfma_f32_16x16x32_bf16 a[28:31], v[232:235], v[140:143], a[28:31]
ds_read_b64_tr_b16 v[182:183], v250 offset:18944
v_mfma_f32_16x16x32_bf16 a[28:31], v[236:239], v[156:159], a[28:31]
s_waitcnt lgkmcnt(4)
v_mfma_f32_16x16x32_bf16 a[32:35], v[240:243], v[128:131], a[32:35]
ds_read_b128 v[224:227], v248 offset:34816
v_mfma_f32_16x16x32_bf16 a[32:35], v[244:247], v[144:147], a[32:35]
v_exp_f32 v197, v197
v_mfma_f32_16x16x32_bf16 a[36:39], v[240:243], v[132:135], a[36:39]
v_exp_f32 v198, v198
v_mfma_f32_16x16x32_bf16 a[36:39], v[244:247], v[148:151], a[36:39]
v_exp_f32 v199, v199
v_mfma_f32_16x16x32_bf16 a[40:43], v[240:243], v[136:139], a[40:43]
ds_read_b128 v[228:231], v248 offset:35328
v_cvt_pk_bf16_f32 v164, v196, v197
v_mfma_f32_16x16x32_bf16 a[40:43], v[244:247], v[152:155], a[40:43]
v_cvt_pk_bf16_f32 v165, v198, v199
v_mfma_f32_16x16x32_bf16 a[44:47], v[240:243], v[140:143], a[44:47]
v_exp_f32 v200, v200
v_mfma_f32_16x16x32_bf16 a[44:47], v[244:247], v[156:159], a[44:47]
s_waitcnt lgkmcnt(2)
v_mfma_f32_16x16x32_bf16 a[48:51], v[176:179], v[128:131], a[48:51]
ds_read_b128 v[232:235], v248 offset:38912
v_mfma_f32_16x16x32_bf16 a[48:51], v[180:183], v[144:147], a[48:51]
v_exp_f32 v201, v201
v_mfma_f32_16x16x32_bf16 a[52:55], v[176:179], v[132:135], a[52:55]
v_exp_f32 v202, v202
v_mfma_f32_16x16x32_bf16 a[52:55], v[180:183], v[148:151], a[52:55]
v_exp_f32 v203, v203
v_mfma_f32_16x16x32_bf16 a[56:59], v[176:179], v[136:139], a[56:59]
ds_read_b128 v[236:239], v248 offset:39424
v_cvt_pk_bf16_f32 v168, v200, v201
v_mfma_f32_16x16x32_bf16 a[56:59], v[180:183], v[152:155], a[56:59]
v_cvt_pk_bf16_f32 v169, v202, v203
v_mfma_f32_16x16x32_bf16 a[60:63], v[176:179], v[140:143], a[60:63]
v_exp_f32 v204, v204
v_mfma_f32_16x16x32_bf16 a[60:63], v[180:183], v[156:159], a[60:63]
s_waitcnt lgkmcnt(2)
v_mfma_f32_16x16x32_bf16 v[208:211], v[224:227], v[0:3], 0
ds_read_b128 v[240:243], v248 offset:43008
v_mfma_f32_16x16x32_bf16 v[208:211], v[228:231], v[4:7], v[208:211]
v_exp_f32 v205, v205
v_mfma_f32_16x16x32_bf16 v[212:215], v[224:227], v[32:35], 0
v_exp_f32 v206, v206
v_mfma_f32_16x16x32_bf16 v[212:215], v[228:231], v[36:39], v[212:215]
v_exp_f32 v207, v207
v_mfma_f32_16x16x32_bf16 v[216:219], v[224:227], v[64:67], 0
ds_read_b128 v[244:247], v248 offset:43520
v_cvt_pk_bf16_f32 v172, v204, v205
v_mfma_f32_16x16x32_bf16 v[216:219], v[228:231], v[68:71], v[216:219]
v_cvt_pk_bf16_f32 v173, v206, v207
v_mfma_f32_16x16x32_bf16 v[220:223], v[224:227], v[96:99], 0
v_mfma_f32_16x16x32_bf16 v[220:223], v[228:231], v[100:103], v[220:223]
s_waitcnt lgkmcnt(2)
v_mfma_f32_16x16x32_bf16 v[208:211], v[232:235], v[8:11], v[208:211]
ds_read_b128 v[176:179], v248 offset:47104
v_mfma_f32_16x16x32_bf16 v[208:211], v[236:239], v[12:15], v[208:211]
v_mfma_f32_16x16x32_bf16 v[212:215], v[232:235], v[40:43], v[212:215]
v_mfma_f32_16x16x32_bf16 v[212:215], v[236:239], v[44:47], v[212:215]
v_mfma_f32_16x16x32_bf16 v[216:219], v[232:235], v[72:75], v[216:219]
ds_read_b128 v[180:183], v248 offset:47616
v_mfma_f32_16x16x32_bf16 v[216:219], v[236:239], v[76:79], v[216:219]
v_mfma_f32_16x16x32_bf16 v[220:223], v[232:235], v[104:107], v[220:223]
v_mfma_f32_16x16x32_bf16 v[220:223], v[236:239], v[108:111], v[220:223]
s_waitcnt lgkmcnt(2)
v_mfma_f32_16x16x32_bf16 v[208:211], v[240:243], v[16:19], v[208:211]
ds_read_b64_tr_b16 v[224:225], v249 offset:4096
v_mfma_f32_16x16x32_bf16 v[208:211], v[244:247], v[20:23], v[208:211]
v_mfma_f32_16x16x32_bf16 v[212:215], v[240:243], v[48:51], v[212:215]
ds_read_b64_tr_b16 v[226:227], v249 offset:6144
v_mfma_f32_16x16x32_bf16 v[212:215], v[244:247], v[52:55], v[212:215]
v_mfma_f32_16x16x32_bf16 v[216:219], v[240:243], v[80:83], v[216:219]
ds_read_b64_tr_b16 v[228:229], v249 offset:20480
v_mfma_f32_16x16x32_bf16 v[216:219], v[244:247], v[84:87], v[216:219]
v_mfma_f32_16x16x32_bf16 v[220:223], v[240:243], v[112:115], v[220:223]
ds_read_b64_tr_b16 v[230:231], v249 offset:22528
v_mfma_f32_16x16x32_bf16 v[220:223], v[244:247], v[116:119], v[220:223]
s_waitcnt lgkmcnt(4)
v_mfma_f32_16x16x32_bf16 v[208:211], v[176:179], v[24:27], v[208:211]
ds_read_b64_tr_b16 v[232:233], v250 offset:4096
v_mfma_f32_16x16x32_bf16 v[208:211], v[180:183], v[28:31], v[208:211]
v_mfma_f32_16x16x32_bf16 v[212:215], v[176:179], v[56:59], v[212:215]
ds_read_b64_tr_b16 v[234:235], v250 offset:6144
v_mfma_f32_16x16x32_bf16 v[212:215], v[180:183], v[60:63], v[212:215]
v_mfma_f32_16x16x32_bf16 v[216:219], v[176:179], v[88:91], v[216:219]
ds_read_b64_tr_b16 v[236:237], v250 offset:20480
v_mfma_f32_16x16x32_bf16 v[216:219], v[180:183], v[92:95], v[216:219]
v_mfma_f32_16x16x32_bf16 v[220:223], v[176:179], v[120:123], v[220:223]
ds_read_b64_tr_b16 v[238:239], v250 offset:22528
v_mfma_f32_16x16x32_bf16 v[220:223], v[180:183], v[124:127], v[220:223]
s_waitcnt lgkmcnt(4)
v_mfma_f32_16x16x32_bf16 a[64:67], v[224:227], v[128:131], a[64:67]
ds_read_b64_tr_b16 v[240:241], v249 offset:4608
v_mfma_f32_16x16x32_bf16 a[64:67], v[228:231], v[144:147], a[64:67]
v_mfma_f32_16x16x32_bf16 a[68:71], v[224:227], v[132:135], a[68:71]
ds_read_b64_tr_b16 v[242:243], v249 offset:6656
v_mfma_f32_16x16x32_bf16 a[68:71], v[228:231], v[148:151], a[68:71]
v_exp_f32 v208, v208
v_mfma_f32_16x16x32_bf16 a[72:75], v[224:227], v[136:139], a[72:75]
ds_read_b64_tr_b16 v[244:245], v249 offset:20992
v_mfma_f32_16x16x32_bf16 a[72:75], v[228:231], v[152:155], a[72:75]
v_exp_f32 v209, v209
v_mfma_f32_16x16x32_bf16 a[76:79], v[224:227], v[140:143], a[76:79]
ds_read_b64_tr_b16 v[246:247], v249 offset:23040
v_cvt_pk_bf16_f32 v162, v208, v209
v_mfma_f32_16x16x32_bf16 a[76:79], v[228:231], v[156:159], a[76:79]
s_waitcnt lgkmcnt(4)
s_waitcnt vmcnt(0)
s_barrier
s_add_u32 m0, s30, 0x4000
v_mfma_f32_16x16x32_bf16 a[80:83], v[232:235], v[128:131], a[80:83]
ds_read_b64_tr_b16 v[224:225], v250 offset:4608
v_mfma_f32_16x16x32_bf16 a[80:83], v[236:239], v[144:147], a[80:83]
buffer_load_dwordx4 v251, s[12:15], s28 offen offset:0 lds
v_mfma_f32_16x16x32_bf16 a[84:87], v[232:235], v[132:135], a[84:87]
ds_read_b64_tr_b16 v[226:227], v250 offset:6656
v_mfma_f32_16x16x32_bf16 a[84:87], v[236:239], v[148:151], a[84:87]
v_exp_f32 v210, v210
v_mfma_f32_16x16x32_bf16 a[88:91], v[232:235], v[136:139], a[88:91]
ds_read_b64_tr_b16 v[228:229], v250 offset:20992
v_mfma_f32_16x16x32_bf16 a[88:91], v[236:239], v[152:155], a[88:91]
v_exp_f32 v211, v211
v_mfma_f32_16x16x32_bf16 a[92:95], v[232:235], v[140:143], a[92:95]
ds_read_b64_tr_b16 v[230:231], v250 offset:23040
v_cvt_pk_bf16_f32 v163, v210, v211
v_mfma_f32_16x16x32_bf16 a[92:95], v[236:239], v[156:159], a[92:95]
s_waitcnt lgkmcnt(4)
v_mfma_f32_16x16x32_bf16 a[96:99], v[240:243], v[128:131], a[96:99]
ds_read_b128 v[232:235], v248 offset:49152
v_mfma_f32_16x16x32_bf16 a[96:99], v[244:247], v[144:147], a[96:99]
buffer_load_dwordx4 v251, s[12:15], s28 offen offset:1024 lds
v_mfma_f32_16x16x32_bf16 a[100:103], v[240:243], v[132:135], a[100:103]
v_exp_f32 v212, v212
v_mfma_f32_16x16x32_bf16 a[100:103], v[244:247], v[148:151], a[100:103]
v_exp_f32 v213, v213
v_mfma_f32_16x16x32_bf16 a[104:107], v[240:243], v[136:139], a[104:107]
ds_read_b128 v[236:239], v248 offset:49664
v_cvt_pk_bf16_f32 v166, v212, v213
v_mfma_f32_16x16x32_bf16 a[104:107], v[244:247], v[152:155], a[104:107]
v_exp_f32 v214, v214
v_mfma_f32_16x16x32_bf16 a[108:111], v[240:243], v[140:143], a[108:111]
v_exp_f32 v215, v215
v_mfma_f32_16x16x32_bf16 a[108:111], v[244:247], v[156:159], a[108:111]
s_waitcnt lgkmcnt(2)
v_cvt_pk_bf16_f32 v167, v214, v215
v_mfma_f32_16x16x32_bf16 a[112:115], v[224:227], v[128:131], a[112:115]
ds_read_b128 v[240:243], v248 offset:53248
v_mfma_f32_16x16x32_bf16 a[112:115], v[228:231], v[144:147], a[112:115]
buffer_load_dwordx4 v251, s[12:15], s28 offen offset:2048 lds
v_mfma_f32_16x16x32_bf16 a[116:119], v[224:227], v[132:135], a[116:119]
v_exp_f32 v216, v216
v_mfma_f32_16x16x32_bf16 a[116:119], v[228:231], v[148:151], a[116:119]
v_exp_f32 v217, v217
v_mfma_f32_16x16x32_bf16 a[120:123], v[224:227], v[136:139], a[120:123]
ds_read_b128 v[244:247], v248 offset:53760
v_cvt_pk_bf16_f32 v170, v216, v217
v_mfma_f32_16x16x32_bf16 a[120:123], v[228:231], v[152:155], a[120:123]
v_exp_f32 v218, v218
v_mfma_f32_16x16x32_bf16 a[124:127], v[224:227], v[140:143], a[124:127]
v_exp_f32 v219, v219
v_mfma_f32_16x16x32_bf16 a[124:127], v[228:231], v[156:159], a[124:127]
s_waitcnt lgkmcnt(2)
v_cvt_pk_bf16_f32 v171, v218, v219
v_mfma_f32_16x16x32_bf16 v[192:195], v[232:235], v[0:3], 0
ds_read_b128 v[224:227], v248 offset:57344
v_mfma_f32_16x16x32_bf16 v[192:195], v[236:239], v[4:7], v[192:195]
buffer_load_dwordx4 v251, s[12:15], s28 offen offset:3072 lds
v_mfma_f32_16x16x32_bf16 v[196:199], v[232:235], v[32:35], 0
v_exp_f32 v220, v220
v_mfma_f32_16x16x32_bf16 v[196:199], v[236:239], v[36:39], v[196:199]
s_add_u32 s28, s28, 0x4000
v_mfma_f32_16x16x32_bf16 v[200:203], v[232:235], v[64:67], 0
ds_read_b128 v[228:231], v248 offset:57856
v_mfma_f32_16x16x32_bf16 v[200:203], v[236:239], v[68:71], v[200:203]
v_exp_f32 v221, v221
v_mfma_f32_16x16x32_bf16 v[204:207], v[232:235], v[96:99], 0
v_exp_f32 v222, v222
v_mfma_f32_16x16x32_bf16 v[204:207], v[236:239], v[100:103], v[204:207]
s_waitcnt lgkmcnt(2)
s_add_u32 m0, s30, 0x8000
v_mfma_f32_16x16x32_bf16 v[192:195], v[240:243], v[8:11], v[192:195]
ds_read_b128 v[232:235], v248 offset:61440
v_cvt_pk_bf16_f32 v174, v220, v221
v_mfma_f32_16x16x32_bf16 v[192:195], v[244:247], v[12:15], v[192:195]
buffer_load_dwordx4 v251, s[12:15], s28 offen offset:0 lds
v_mfma_f32_16x16x32_bf16 v[196:199], v[240:243], v[40:43], v[196:199]
v_exp_f32 v223, v223
v_mfma_f32_16x16x32_bf16 v[196:199], v[244:247], v[44:47], v[196:199]
v_mfma_f32_16x16x32_bf16 v[200:203], v[240:243], v[72:75], v[200:203]
ds_read_b128 v[236:239], v248 offset:61952
v_cvt_pk_bf16_f32 v175, v222, v223
v_mfma_f32_16x16x32_bf16 v[200:203], v[244:247], v[76:79], v[200:203]
v_mfma_f32_16x16x32_bf16 v[204:207], v[240:243], v[104:107], v[204:207]
v_mfma_f32_16x16x32_bf16 v[204:207], v[244:247], v[108:111], v[204:207]
s_waitcnt lgkmcnt(2)
v_mfma_f32_16x16x32_bf16 v[192:195], v[224:227], v[16:19], v[192:195]
ds_read_b64_tr_b16 v[240:241], v249 offset:8192
v_mfma_f32_16x16x32_bf16 v[192:195], v[228:231], v[20:23], v[192:195]
buffer_load_dwordx4 v251, s[12:15], s28 offen offset:1024 lds
v_mfma_f32_16x16x32_bf16 v[196:199], v[224:227], v[48:51], v[196:199]
ds_read_b64_tr_b16 v[242:243], v249 offset:10240
v_mfma_f32_16x16x32_bf16 v[196:199], v[228:231], v[52:55], v[196:199]
v_mfma_f32_16x16x32_bf16 v[200:203], v[224:227], v[80:83], v[200:203]
ds_read_b64_tr_b16 v[244:245], v249 offset:24576
v_mfma_f32_16x16x32_bf16 v[200:203], v[228:231], v[84:87], v[200:203]
v_mfma_f32_16x16x32_bf16 v[204:207], v[224:227], v[112:115], v[204:207]
ds_read_b64_tr_b16 v[246:247], v249 offset:26624
v_mfma_f32_16x16x32_bf16 v[204:207], v[228:231], v[116:119], v[204:207]
s_waitcnt lgkmcnt(4)
v_mfma_f32_16x16x32_bf16 v[192:195], v[232:235], v[24:27], v[192:195]
ds_read_b64_tr_b16 v[224:225], v250 offset:8192
v_mfma_f32_16x16x32_bf16 v[192:195], v[236:239], v[28:31], v[192:195]
buffer_load_dwordx4 v251, s[12:15], s28 offen offset:2048 lds
v_mfma_f32_16x16x32_bf16 v[196:199], v[232:235], v[56:59], v[196:199]
ds_read_b64_tr_b16 v[226:227], v250 offset:10240
v_mfma_f32_16x16x32_bf16 v[196:199], v[236:239], v[60:63], v[196:199]
v_mfma_f32_16x16x32_bf16 v[200:203], v[232:235], v[88:91], v[200:203]
ds_read_b64_tr_b16 v[228:229], v250 offset:24576
v_mfma_f32_16x16x32_bf16 v[200:203], v[236:239], v[92:95], v[200:203]
v_mfma_f32_16x16x32_bf16 v[204:207], v[232:235], v[120:123], v[204:207]
ds_read_b64_tr_b16 v[230:231], v250 offset:26624
v_mfma_f32_16x16x32_bf16 v[204:207], v[236:239], v[124:127], v[204:207]
s_waitcnt lgkmcnt(4)
v_mfma_f32_16x16x32_bf16 a[128:131], v[240:243], v[128:131], a[128:131]
ds_read_b64_tr_b16 v[232:233], v249 offset:8704
v_mfma_f32_16x16x32_bf16 a[128:131], v[244:247], v[144:147], a[128:131]
buffer_load_dwordx4 v251, s[12:15], s28 offen offset:3072 lds
v_mfma_f32_16x16x32_bf16 a[132:135], v[240:243], v[132:135], a[132:135]
ds_read_b64_tr_b16 v[234:235], v249 offset:10752
v_mfma_f32_16x16x32_bf16 a[132:135], v[244:247], v[148:151], a[132:135]
s_add_u32 s28, s28, 0x4000
v_mfma_f32_16x16x32_bf16 a[136:139], v[240:243], v[136:139], a[136:139]
ds_read_b64_tr_b16 v[236:237], v249 offset:25088
v_mfma_f32_16x16x32_bf16 a[136:139], v[244:247], v[152:155], a[136:139]
v_exp_f32 v192, v192
v_mfma_f32_16x16x32_bf16 a[140:143], v[240:243], v[140:143], a[140:143]
ds_read_b64_tr_b16 v[238:239], v249 offset:27136
v_mfma_f32_16x16x32_bf16 a[140:143], v[244:247], v[156:159], a[140:143]
s_waitcnt lgkmcnt(4)
v_mfma_f32_16x16x32_bf16 a[144:147], v[224:227], v[128:131], a[144:147]
ds_read_b64_tr_b16 v[240:241], v250 offset:8704
v_mfma_f32_16x16x32_bf16 a[144:147], v[228:231], v[144:147], a[144:147]
v_exp_f32 v193, v193
v_mfma_f32_16x16x32_bf16 a[148:151], v[224:227], v[132:135], a[148:151]
ds_read_b64_tr_b16 v[242:243], v250 offset:10752
v_cvt_pk_bf16_f32 v176, v192, v193
v_mfma_f32_16x16x32_bf16 a[148:151], v[228:231], v[148:151], a[148:151]
v_exp_f32 v194, v194
v_mfma_f32_16x16x32_bf16 a[152:155], v[224:227], v[136:139], a[152:155]
ds_read_b64_tr_b16 v[244:245], v250 offset:25088
v_mfma_f32_16x16x32_bf16 a[152:155], v[228:231], v[152:155], a[152:155]
v_exp_f32 v195, v195
v_mfma_f32_16x16x32_bf16 a[156:159], v[224:227], v[140:143], a[156:159]
ds_read_b64_tr_b16 v[246:247], v250 offset:27136
v_cvt_pk_bf16_f32 v177, v194, v195
v_mfma_f32_16x16x32_bf16 a[156:159], v[228:231], v[156:159], a[156:159]
s_waitcnt lgkmcnt(4)
v_mfma_f32_16x16x32_bf16 a[160:163], v[232:235], v[128:131], a[160:163]
ds_read_b128 v[224:227], v248 offset:51200
v_mfma_f32_16x16x32_bf16 a[160:163], v[236:239], v[144:147], a[160:163]
v_exp_f32 v196, v196
v_mfma_f32_16x16x32_bf16 a[164:167], v[232:235], v[132:135], a[164:167]
v_exp_f32 v197, v197
v_mfma_f32_16x16x32_bf16 a[164:167], v[236:239], v[148:151], a[164:167]
v_exp_f32 v198, v198
v_mfma_f32_16x16x32_bf16 a[168:171], v[232:235], v[136:139], a[168:171]
ds_read_b128 v[228:231], v248 offset:51712
v_cvt_pk_bf16_f32 v180, v196, v197
v_mfma_f32_16x16x32_bf16 a[168:171], v[236:239], v[152:155], a[168:171]
v_exp_f32 v199, v199
v_mfma_f32_16x16x32_bf16 a[172:175], v[232:235], v[140:143], a[172:175]
v_exp_f32 v200, v200
v_mfma_f32_16x16x32_bf16 a[172:175], v[236:239], v[156:159], a[172:175]
s_waitcnt lgkmcnt(2)
v_cvt_pk_bf16_f32 v181, v198, v199
v_mfma_f32_16x16x32_bf16 a[176:179], v[240:243], v[128:131], a[176:179]
ds_read_b128 v[232:235], v248 offset:55296
v_mfma_f32_16x16x32_bf16 a[176:179], v[244:247], v[144:147], a[176:179]
v_exp_f32 v201, v201
v_mfma_f32_16x16x32_bf16 a[180:183], v[240:243], v[132:135], a[180:183]
v_exp_f32 v202, v202
v_mfma_f32_16x16x32_bf16 a[180:183], v[244:247], v[148:151], a[180:183]
v_exp_f32 v203, v203
v_mfma_f32_16x16x32_bf16 a[184:187], v[240:243], v[136:139], a[184:187]
ds_read_b128 v[236:239], v248 offset:55808
v_cvt_pk_bf16_f32 v184, v200, v201
v_mfma_f32_16x16x32_bf16 a[184:187], v[244:247], v[152:155], a[184:187]
v_cvt_pk_bf16_f32 v185, v202, v203
v_mfma_f32_16x16x32_bf16 a[188:191], v[240:243], v[140:143], a[188:191]
v_exp_f32 v204, v204
v_mfma_f32_16x16x32_bf16 a[188:191], v[244:247], v[156:159], a[188:191]
s_waitcnt lgkmcnt(2)
v_mfma_f32_16x16x32_bf16 v[208:211], v[224:227], v[0:3], 0
ds_read_b128 v[240:243], v248 offset:59392
v_mfma_f32_16x16x32_bf16 v[208:211], v[228:231], v[4:7], v[208:211]
v_exp_f32 v205, v205
v_mfma_f32_16x16x32_bf16 v[212:215], v[224:227], v[32:35], 0
v_exp_f32 v206, v206
v_mfma_f32_16x16x32_bf16 v[212:215], v[228:231], v[36:39], v[212:215]
v_exp_f32 v207, v207
v_mfma_f32_16x16x32_bf16 v[216:219], v[224:227], v[64:67], 0
ds_read_b128 v[244:247], v248 offset:59904
v_cvt_pk_bf16_f32 v188, v204, v205
v_mfma_f32_16x16x32_bf16 v[216:219], v[228:231], v[68:71], v[216:219]
v_cvt_pk_bf16_f32 v189, v206, v207
v_mfma_f32_16x16x32_bf16 v[220:223], v[224:227], v[96:99], 0
v_mfma_f32_16x16x32_bf16 v[220:223], v[228:231], v[100:103], v[220:223]
s_waitcnt lgkmcnt(2)
v_mfma_f32_16x16x32_bf16 v[208:211], v[232:235], v[8:11], v[208:211]
ds_read_b128 v[224:227], v248 offset:63488
v_mfma_f32_16x16x32_bf16 v[208:211], v[236:239], v[12:15], v[208:211]
v_mfma_f32_16x16x32_bf16 v[212:215], v[232:235], v[40:43], v[212:215]
v_mfma_f32_16x16x32_bf16 v[212:215], v[236:239], v[44:47], v[212:215]
v_mfma_f32_16x16x32_bf16 v[216:219], v[232:235], v[72:75], v[216:219]
ds_read_b128 v[228:231], v248 offset:64000
v_mfma_f32_16x16x32_bf16 v[216:219], v[236:239], v[76:79], v[216:219]
v_mfma_f32_16x16x32_bf16 v[220:223], v[232:235], v[104:107], v[220:223]
v_mfma_f32_16x16x32_bf16 v[220:223], v[236:239], v[108:111], v[220:223]
s_waitcnt lgkmcnt(2)
v_mfma_f32_16x16x32_bf16 v[208:211], v[240:243], v[16:19], v[208:211]
ds_read_b64_tr_b16 v[232:233], v249 offset:12288
v_mfma_f32_16x16x32_bf16 v[208:211], v[244:247], v[20:23], v[208:211]
v_mfma_f32_16x16x32_bf16 v[212:215], v[240:243], v[48:51], v[212:215]
ds_read_b64_tr_b16 v[234:235], v249 offset:14336
v_mfma_f32_16x16x32_bf16 v[212:215], v[244:247], v[52:55], v[212:215]
v_mfma_f32_16x16x32_bf16 v[216:219], v[240:243], v[80:83], v[216:219]
ds_read_b64_tr_b16 v[236:237], v249 offset:28672
v_mfma_f32_16x16x32_bf16 v[216:219], v[244:247], v[84:87], v[216:219]
v_mfma_f32_16x16x32_bf16 v[220:223], v[240:243], v[112:115], v[220:223]
ds_read_b64_tr_b16 v[238:239], v249 offset:30720
v_mfma_f32_16x16x32_bf16 v[220:223], v[244:247], v[116:119], v[220:223]
s_waitcnt lgkmcnt(4)
v_mfma_f32_16x16x32_bf16 v[208:211], v[224:227], v[24:27], v[208:211]
ds_read_b64_tr_b16 v[240:241], v250 offset:12288
v_mfma_f32_16x16x32_bf16 v[208:211], v[228:231], v[28:31], v[208:211]
v_mfma_f32_16x16x32_bf16 v[212:215], v[224:227], v[56:59], v[212:215]
ds_read_b64_tr_b16 v[242:243], v250 offset:14336
v_mfma_f32_16x16x32_bf16 v[212:215], v[228:231], v[60:63], v[212:215]
v_mfma_f32_16x16x32_bf16 v[216:219], v[224:227], v[88:91], v[216:219]
ds_read_b64_tr_b16 v[244:245], v250 offset:28672
v_mfma_f32_16x16x32_bf16 v[216:219], v[228:231], v[92:95], v[216:219]
v_mfma_f32_16x16x32_bf16 v[220:223], v[224:227], v[120:123], v[220:223]
ds_read_b64_tr_b16 v[246:247], v250 offset:30720
v_xor_b32 v248, 0x10000, v248
v_mfma_f32_16x16x32_bf16 v[220:223], v[228:231], v[124:127], v[220:223]
s_waitcnt lgkmcnt(4)
v_mfma_f32_16x16x32_bf16 a[192:195], v[232:235], v[128:131], a[192:195]
ds_read_b64_tr_b16 v[224:225], v249 offset:12800
v_mfma_f32_16x16x32_bf16 a[192:195], v[236:239], v[144:147], a[192:195]
v_mfma_f32_16x16x32_bf16 a[196:199], v[232:235], v[132:135], a[196:199]
ds_read_b64_tr_b16 v[226:227], v249 offset:14848
v_mfma_f32_16x16x32_bf16 a[196:199], v[236:239], v[148:151], a[196:199]
v_exp_f32 v208, v208
v_mfma_f32_16x16x32_bf16 a[200:203], v[232:235], v[136:139], a[200:203]
ds_read_b64_tr_b16 v[228:229], v249 offset:29184
v_mfma_f32_16x16x32_bf16 a[200:203], v[236:239], v[152:155], a[200:203]
v_exp_f32 v209, v209
v_mfma_f32_16x16x32_bf16 a[204:207], v[232:235], v[140:143], a[204:207]
ds_read_b64_tr_b16 v[230:231], v249 offset:31232
v_cvt_pk_bf16_f32 v178, v208, v209
v_mfma_f32_16x16x32_bf16 a[204:207], v[236:239], v[156:159], a[204:207]
s_waitcnt lgkmcnt(4)
v_mfma_f32_16x16x32_bf16 a[208:211], v[240:243], v[128:131], a[208:211]
ds_read_b64_tr_b16 v[232:233], v250 offset:12800
v_mfma_f32_16x16x32_bf16 a[208:211], v[244:247], v[144:147], a[208:211]
v_exp_f32 v210, v210
v_mfma_f32_16x16x32_bf16 a[212:215], v[240:243], v[132:135], a[212:215]
ds_read_b64_tr_b16 v[234:235], v250 offset:14848
v_mfma_f32_16x16x32_bf16 a[212:215], v[244:247], v[148:151], a[212:215]
v_exp_f32 v211, v211
v_mfma_f32_16x16x32_bf16 a[216:219], v[240:243], v[136:139], a[216:219]
ds_read_b64_tr_b16 v[236:237], v250 offset:29184
v_cvt_pk_bf16_f32 v179, v210, v211
v_mfma_f32_16x16x32_bf16 a[216:219], v[244:247], v[152:155], a[216:219]
v_exp_f32 v212, v212
v_mfma_f32_16x16x32_bf16 a[220:223], v[240:243], v[140:143], a[220:223]
ds_read_b64_tr_b16 v[238:239], v250 offset:31232
v_mfma_f32_16x16x32_bf16 a[220:223], v[244:247], v[156:159], a[220:223]
s_waitcnt lgkmcnt(4)
v_mfma_f32_16x16x32_bf16 a[224:227], v[224:227], v[128:131], a[224:227]
ds_read_b128 v[240:243], v248 offset:0
v_mfma_f32_16x16x32_bf16 a[224:227], v[228:231], v[144:147], a[224:227]
v_exp_f32 v213, v213
v_mfma_f32_16x16x32_bf16 a[228:231], v[224:227], v[132:135], a[228:231]
v_exp_f32 v214, v214
v_mfma_f32_16x16x32_bf16 a[228:231], v[228:231], v[148:151], a[228:231]
v_exp_f32 v215, v215
v_mfma_f32_16x16x32_bf16 a[232:235], v[224:227], v[136:139], a[232:235]
ds_read_b128 v[244:247], v248 offset:512
v_cvt_pk_bf16_f32 v182, v212, v213
v_mfma_f32_16x16x32_bf16 a[232:235], v[228:231], v[152:155], a[232:235]
v_cvt_pk_bf16_f32 v183, v214, v215
v_mfma_f32_16x16x32_bf16 a[236:239], v[224:227], v[140:143], a[236:239]
v_exp_f32 v216, v216
v_mfma_f32_16x16x32_bf16 a[236:239], v[228:231], v[156:159], a[236:239]
s_waitcnt lgkmcnt(2)
v_mfma_f32_16x16x32_bf16 a[240:243], v[232:235], v[128:131], a[240:243]
ds_read_b128 v[224:227], v248 offset:4096
v_mfma_f32_16x16x32_bf16 a[240:243], v[236:239], v[144:147], a[240:243]
v_exp_f32 v217, v217
v_mfma_f32_16x16x32_bf16 a[244:247], v[232:235], v[132:135], a[244:247]
v_exp_f32 v218, v218
v_mfma_f32_16x16x32_bf16 a[244:247], v[236:239], v[148:151], a[244:247]
v_exp_f32 v219, v219
v_mfma_f32_16x16x32_bf16 a[248:251], v[232:235], v[136:139], a[248:251]
ds_read_b128 v[228:231], v248 offset:4608
v_cvt_pk_bf16_f32 v186, v216, v217
v_mfma_f32_16x16x32_bf16 a[248:251], v[236:239], v[152:155], a[248:251]
v_cvt_pk_bf16_f32 v187, v218, v219
v_mfma_f32_16x16x32_bf16 a[252:255], v[232:235], v[140:143], a[252:255]
v_exp_f32 v220, v220
v_mfma_f32_16x16x32_bf16 a[252:255], v[236:239], v[156:159], a[252:255]
s_waitcnt lgkmcnt(2)
v_mfma_f32_16x16x32_bf16 v[192:195], v[240:243], v[0:3], 0
ds_read_b128 v[232:235], v248 offset:8192
v_mfma_f32_16x16x32_bf16 v[192:195], v[244:247], v[4:7], v[192:195]
v_exp_f32 v221, v221
v_mfma_f32_16x16x32_bf16 v[196:199], v[240:243], v[32:35], 0
v_exp_f32 v222, v222
v_mfma_f32_16x16x32_bf16 v[196:199], v[244:247], v[36:39], v[196:199]
v_exp_f32 v223, v223
v_mfma_f32_16x16x32_bf16 v[200:203], v[240:243], v[64:67], 0
ds_read_b128 v[236:239], v248 offset:8704
v_cvt_pk_bf16_f32 v190, v220, v221
v_mfma_f32_16x16x32_bf16 v[200:203], v[244:247], v[68:71], v[200:203]
v_cvt_pk_bf16_f32 v191, v222, v223
v_mfma_f32_16x16x32_bf16 v[204:207], v[240:243], v[96:99], 0
v_mfma_f32_16x16x32_bf16 v[204:207], v[244:247], v[100:103], v[204:207]
s_waitcnt lgkmcnt(2)
v_mfma_f32_16x16x32_bf16 v[192:195], v[224:227], v[8:11], v[192:195]
ds_read_b128 v[240:243], v248 offset:12288
v_mfma_f32_16x16x32_bf16 v[192:195], v[228:231], v[12:15], v[192:195]
v_mfma_f32_16x16x32_bf16 v[196:199], v[224:227], v[40:43], v[196:199]
v_mfma_f32_16x16x32_bf16 v[196:199], v[228:231], v[44:47], v[196:199]
v_mfma_f32_16x16x32_bf16 v[200:203], v[224:227], v[72:75], v[200:203]
ds_read_b128 v[244:247], v248 offset:12800
v_mfma_f32_16x16x32_bf16 v[200:203], v[228:231], v[76:79], v[200:203]
v_mfma_f32_16x16x32_bf16 v[204:207], v[224:227], v[104:107], v[204:207]
v_mfma_f32_16x16x32_bf16 v[204:207], v[228:231], v[108:111], v[204:207]
s_waitcnt lgkmcnt(2)
v_mfma_f32_16x16x32_bf16 v[192:195], v[232:235], v[16:19], v[192:195]
ds_read_b64_tr_b16 v[224:225], v249 offset:32768
v_mfma_f32_16x16x32_bf16 v[192:195], v[236:239], v[20:23], v[192:195]
v_mfma_f32_16x16x32_bf16 v[196:199], v[232:235], v[48:51], v[196:199]
ds_read_b64_tr_b16 v[226:227], v249 offset:34816
v_mfma_f32_16x16x32_bf16 v[196:199], v[236:239], v[52:55], v[196:199]
v_mfma_f32_16x16x32_bf16 v[200:203], v[232:235], v[80:83], v[200:203]
ds_read_b64_tr_b16 v[228:229], v249 offset:49152
v_mfma_f32_16x16x32_bf16 v[200:203], v[236:239], v[84:87], v[200:203]
v_mfma_f32_16x16x32_bf16 v[204:207], v[232:235], v[112:115], v[204:207]
ds_read_b64_tr_b16 v[230:231], v249 offset:51200
v_mfma_f32_16x16x32_bf16 v[204:207], v[236:239], v[116:119], v[204:207]
s_waitcnt lgkmcnt(4)
v_mfma_f32_16x16x32_bf16 v[192:195], v[240:243], v[24:27], v[192:195]
ds_read_b64_tr_b16 v[232:233], v250 offset:32768
v_mfma_f32_16x16x32_bf16 v[192:195], v[244:247], v[28:31], v[192:195]
v_mfma_f32_16x16x32_bf16 v[196:199], v[240:243], v[56:59], v[196:199]
ds_read_b64_tr_b16 v[234:235], v250 offset:34816
v_mfma_f32_16x16x32_bf16 v[196:199], v[244:247], v[60:63], v[196:199]
v_mfma_f32_16x16x32_bf16 v[200:203], v[240:243], v[88:91], v[200:203]
ds_read_b64_tr_b16 v[236:237], v250 offset:49152
v_mfma_f32_16x16x32_bf16 v[200:203], v[244:247], v[92:95], v[200:203]
s_sub_u32 s31, s31, 1
v_mfma_f32_16x16x32_bf16 v[204:207], v[240:243], v[120:123], v[204:207]
ds_read_b64_tr_b16 v[238:239], v250 offset:51200
v_mfma_f32_16x16x32_bf16 v[204:207], v[244:247], v[124:127], v[204:207]
s_cbranch_scc1 L2_tail_1
s_waitcnt lgkmcnt(4)
v_mfma_f32_16x16x32_bf16 a[0:3], v[224:227], v[160:163], a[0:3]
ds_read_b64_tr_b16 v[240:241], v249 offset:33280
v_mfma_f32_16x16x32_bf16 a[0:3], v[228:231], v[176:179], a[0:3]
v_mfma_f32_16x16x32_bf16 a[4:7], v[224:227], v[164:167], a[4:7]
ds_read_b64_tr_b16 v[242:243], v249 offset:35328
v_mfma_f32_16x16x32_bf16 a[4:7], v[228:231], v[180:183], a[4:7]
v_exp_f32 v192, v192
v_mfma_f32_16x16x32_bf16 a[8:11], v[224:227], v[168:171], a[8:11]
ds_read_b64_tr_b16 v[244:245], v249 offset:49664
v_mfma_f32_16x16x32_bf16 a[8:11], v[228:231], v[184:187], a[8:11]
v_exp_f32 v193, v193
v_mfma_f32_16x16x32_bf16 a[12:15], v[224:227], v[172:175], a[12:15]
ds_read_b64_tr_b16 v[246:247], v249 offset:51712
v_cvt_pk_bf16_f32 v128, v192, v193
v_mfma_f32_16x16x32_bf16 a[12:15], v[228:231], v[188:191], a[12:15]
s_waitcnt lgkmcnt(4)
v_mfma_f32_16x16x32_bf16 a[16:19], v[232:235], v[160:163], a[16:19]
ds_read_b64_tr_b16 v[144:145], v250 offset:33280
v_mfma_f32_16x16x32_bf16 a[16:19], v[236:239], v[176:179], a[16:19]
v_exp_f32 v194, v194
v_mfma_f32_16x16x32_bf16 a[20:23], v[232:235], v[164:167], a[20:23]
ds_read_b64_tr_b16 v[146:147], v250 offset:35328
v_mfma_f32_16x16x32_bf16 a[20:23], v[236:239], v[180:183], a[20:23]
v_exp_f32 v195, v195
v_mfma_f32_16x16x32_bf16 a[24:27], v[232:235], v[168:171], a[24:27]
ds_read_b64_tr_b16 v[148:149], v250 offset:49664
v_cvt_pk_bf16_f32 v129, v194, v195
v_mfma_f32_16x16x32_bf16 a[24:27], v[236:239], v[184:187], a[24:27]
v_exp_f32 v196, v196
v_mfma_f32_16x16x32_bf16 a[28:31], v[232:235], v[172:175], a[28:31]
ds_read_b64_tr_b16 v[150:151], v250 offset:51712
v_mfma_f32_16x16x32_bf16 a[28:31], v[236:239], v[188:191], a[28:31]
s_waitcnt lgkmcnt(4)
v_mfma_f32_16x16x32_bf16 a[32:35], v[240:243], v[160:163], a[32:35]
ds_read_b128 v[224:227], v248 offset:2048
v_mfma_f32_16x16x32_bf16 a[32:35], v[244:247], v[176:179], a[32:35]
v_exp_f32 v197, v197
v_mfma_f32_16x16x32_bf16 a[36:39], v[240:243], v[164:167], a[36:39]
v_exp_f32 v198, v198
v_mfma_f32_16x16x32_bf16 a[36:39], v[244:247], v[180:183], a[36:39]
v_exp_f32 v199, v199
v_mfma_f32_16x16x32_bf16 a[40:43], v[240:243], v[168:171], a[40:43]
ds_read_b128 v[228:231], v248 offset:2560
v_cvt_pk_bf16_f32 v132, v196, v197
v_mfma_f32_16x16x32_bf16 a[40:43], v[244:247], v[184:187], a[40:43]
v_cvt_pk_bf16_f32 v133, v198, v199
v_mfma_f32_16x16x32_bf16 a[44:47], v[240:243], v[172:175], a[44:47]
v_exp_f32 v200, v200
v_mfma_f32_16x16x32_bf16 a[44:47], v[244:247], v[188:191], a[44:47]
s_waitcnt lgkmcnt(2)
v_mfma_f32_16x16x32_bf16 a[48:51], v[144:147], v[160:163], a[48:51]
ds_read_b128 v[232:235], v248 offset:6144
v_mfma_f32_16x16x32_bf16 a[48:51], v[148:151], v[176:179], a[48:51]
v_exp_f32 v201, v201
v_mfma_f32_16x16x32_bf16 a[52:55], v[144:147], v[164:167], a[52:55]
v_exp_f32 v202, v202
v_mfma_f32_16x16x32_bf16 a[52:55], v[148:151], v[180:183], a[52:55]
v_exp_f32 v203, v203
v_mfma_f32_16x16x32_bf16 a[56:59], v[144:147], v[168:171], a[56:59]
ds_read_b128 v[236:239], v248 offset:6656
v_cvt_pk_bf16_f32 v136, v200, v201
v_mfma_f32_16x16x32_bf16 a[56:59], v[148:151], v[184:187], a[56:59]
v_cvt_pk_bf16_f32 v137, v202, v203
v_mfma_f32_16x16x32_bf16 a[60:63], v[144:147], v[172:175], a[60:63]
v_exp_f32 v204, v204
v_mfma_f32_16x16x32_bf16 a[60:63], v[148:151], v[188:191], a[60:63]
s_waitcnt lgkmcnt(2)
v_mfma_f32_16x16x32_bf16 v[208:211], v[224:227], v[0:3], 0
ds_read_b128 v[240:243], v248 offset:10240
v_mfma_f32_16x16x32_bf16 v[208:211], v[228:231], v[4:7], v[208:211]
v_exp_f32 v205, v205
v_mfma_f32_16x16x32_bf16 v[212:215], v[224:227], v[32:35], 0
v_exp_f32 v206, v206
v_mfma_f32_16x16x32_bf16 v[212:215], v[228:231], v[36:39], v[212:215]
v_exp_f32 v207, v207
v_mfma_f32_16x16x32_bf16 v[216:219], v[224:227], v[64:67], 0
ds_read_b128 v[244:247], v248 offset:10752
v_cvt_pk_bf16_f32 v140, v204, v205
v_mfma_f32_16x16x32_bf16 v[216:219], v[228:231], v[68:71], v[216:219]
v_cvt_pk_bf16_f32 v141, v206, v207
v_mfma_f32_16x16x32_bf16 v[220:223], v[224:227], v[96:99], 0
v_mfma_f32_16x16x32_bf16 v[220:223], v[228:231], v[100:103], v[220:223]
s_waitcnt lgkmcnt(2)
v_mfma_f32_16x16x32_bf16 v[208:211], v[232:235], v[8:11], v[208:211]
ds_read_b128 v[144:147], v248 offset:14336
v_mfma_f32_16x16x32_bf16 v[208:211], v[236:239], v[12:15], v[208:211]
v_mfma_f32_16x16x32_bf16 v[212:215], v[232:235], v[40:43], v[212:215]
v_mfma_f32_16x16x32_bf16 v[212:215], v[236:239], v[44:47], v[212:215]
v_mfma_f32_16x16x32_bf16 v[216:219], v[232:235], v[72:75], v[216:219]
ds_read_b128 v[148:151], v248 offset:14848
v_mfma_f32_16x16x32_bf16 v[216:219], v[236:239], v[76:79], v[216:219]
v_mfma_f32_16x16x32_bf16 v[220:223], v[232:235], v[104:107], v[220:223]
v_mfma_f32_16x16x32_bf16 v[220:223], v[236:239], v[108:111], v[220:223]
s_waitcnt lgkmcnt(2)
v_mfma_f32_16x16x32_bf16 v[208:211], v[240:243], v[16:19], v[208:211]
ds_read_b64_tr_b16 v[224:225], v249 offset:36864
v_mfma_f32_16x16x32_bf16 v[208:211], v[244:247], v[20:23], v[208:211]
v_mfma_f32_16x16x32_bf16 v[212:215], v[240:243], v[48:51], v[212:215]
ds_read_b64_tr_b16 v[226:227], v249 offset:38912
v_mfma_f32_16x16x32_bf16 v[212:215], v[244:247], v[52:55], v[212:215]
v_mfma_f32_16x16x32_bf16 v[216:219], v[240:243], v[80:83], v[216:219]
ds_read_b64_tr_b16 v[228:229], v249 offset:53248
v_mfma_f32_16x16x32_bf16 v[216:219], v[244:247], v[84:87], v[216:219]
v_mfma_f32_16x16x32_bf16 v[220:223], v[240:243], v[112:115], v[220:223]
ds_read_b64_tr_b16 v[230:231], v249 offset:55296
v_mfma_f32_16x16x32_bf16 v[220:223], v[244:247], v[116:119], v[220:223]
s_waitcnt lgkmcnt(4)
v_mfma_f32_16x16x32_bf16 v[208:211], v[144:147], v[24:27], v[208:211]
ds_read_b64_tr_b16 v[232:233], v250 offset:36864
v_mfma_f32_16x16x32_bf16 v[208:211], v[148:151], v[28:31], v[208:211]
v_mfma_f32_16x16x32_bf16 v[212:215], v[144:147], v[56:59], v[212:215]
ds_read_b64_tr_b16 v[234:235], v250 offset:38912
v_mfma_f32_16x16x32_bf16 v[212:215], v[148:151], v[60:63], v[212:215]
v_mfma_f32_16x16x32_bf16 v[216:219], v[144:147], v[88:91], v[216:219]
ds_read_b64_tr_b16 v[236:237], v250 offset:53248
v_mfma_f32_16x16x32_bf16 v[216:219], v[148:151], v[92:95], v[216:219]
v_mfma_f32_16x16x32_bf16 v[220:223], v[144:147], v[120:123], v[220:223]
ds_read_b64_tr_b16 v[238:239], v250 offset:55296
v_mfma_f32_16x16x32_bf16 v[220:223], v[148:151], v[124:127], v[220:223]
s_waitcnt lgkmcnt(4)
v_mfma_f32_16x16x32_bf16 a[64:67], v[224:227], v[160:163], a[64:67]
ds_read_b64_tr_b16 v[240:241], v249 offset:37376
v_mfma_f32_16x16x32_bf16 a[64:67], v[228:231], v[176:179], a[64:67]
v_mfma_f32_16x16x32_bf16 a[68:71], v[224:227], v[164:167], a[68:71]
ds_read_b64_tr_b16 v[242:243], v249 offset:39424
v_mfma_f32_16x16x32_bf16 a[68:71], v[228:231], v[180:183], a[68:71]
v_exp_f32 v208, v208
v_mfma_f32_16x16x32_bf16 a[72:75], v[224:227], v[168:171], a[72:75]
ds_read_b64_tr_b16 v[244:245], v249 offset:53760
v_mfma_f32_16x16x32_bf16 a[72:75], v[228:231], v[184:187], a[72:75]
v_exp_f32 v209, v209
v_mfma_f32_16x16x32_bf16 a[76:79], v[224:227], v[172:175], a[76:79]
ds_read_b64_tr_b16 v[246:247], v249 offset:55808
v_cvt_pk_bf16_f32 v130, v208, v209
v_mfma_f32_16x16x32_bf16 a[76:79], v[228:231], v[188:191], a[76:79]
s_waitcnt lgkmcnt(4)
s_waitcnt vmcnt(0)
s_barrier
s_add_u32 m0, s30, 0xc000
v_mfma_f32_16x16x32_bf16 a[80:83], v[232:235], v[160:163], a[80:83]
ds_read_b64_tr_b16 v[224:225], v250 offset:37376
v_mfma_f32_16x16x32_bf16 a[80:83], v[236:239], v[176:179], a[80:83]
buffer_load_dwordx4 v251, s[12:15], s28 offen offset:0 lds
v_mfma_f32_16x16x32_bf16 a[84:87], v[232:235], v[164:167], a[84:87]
ds_read_b64_tr_b16 v[226:227], v250 offset:39424
v_mfma_f32_16x16x32_bf16 a[84:87], v[236:239], v[180:183], a[84:87]
v_exp_f32 v210, v210
v_mfma_f32_16x16x32_bf16 a[88:91], v[232:235], v[168:171], a[88:91]
ds_read_b64_tr_b16 v[228:229], v250 offset:53760
v_mfma_f32_16x16x32_bf16 a[88:91], v[236:239], v[184:187], a[88:91]
v_exp_f32 v211, v211
v_mfma_f32_16x16x32_bf16 a[92:95], v[232:235], v[172:175], a[92:95]
ds_read_b64_tr_b16 v[230:231], v250 offset:55808
v_cvt_pk_bf16_f32 v131, v210, v211
v_mfma_f32_16x16x32_bf16 a[92:95], v[236:239], v[188:191], a[92:95]
s_waitcnt lgkmcnt(4)
v_mfma_f32_16x16x32_bf16 a[96:99], v[240:243], v[160:163], a[96:99]
ds_read_b128 v[232:235], v248 offset:16384
v_mfma_f32_16x16x32_bf16 a[96:99], v[244:247], v[176:179], a[96:99]
buffer_load_dwordx4 v251, s[12:15], s28 offen offset:1024 lds
v_mfma_f32_16x16x32_bf16 a[100:103], v[240:243], v[164:167], a[100:103]
v_exp_f32 v212, v212
v_mfma_f32_16x16x32_bf16 a[100:103], v[244:247], v[180:183], a[100:103]
v_exp_f32 v213, v213
v_mfma_f32_16x16x32_bf16 a[104:107], v[240:243], v[168:171], a[104:107]
ds_read_b128 v[236:239], v248 offset:16896
v_cvt_pk_bf16_f32 v134, v212, v213
v_mfma_f32_16x16x32_bf16 a[104:107], v[244:247], v[184:187], a[104:107]
v_exp_f32 v214, v214
v_mfma_f32_16x16x32_bf16 a[108:111], v[240:243], v[172:175], a[108:111]
v_exp_f32 v215, v215
v_mfma_f32_16x16x32_bf16 a[108:111], v[244:247], v[188:191], a[108:111]
s_waitcnt lgkmcnt(2)
v_cvt_pk_bf16_f32 v135, v214, v215
v_mfma_f32_16x16x32_bf16 a[112:115], v[224:227], v[160:163], a[112:115]
ds_read_b128 v[240:243], v248 offset:20480
v_mfma_f32_16x16x32_bf16 a[112:115], v[228:231], v[176:179], a[112:115]
buffer_load_dwordx4 v251, s[12:15], s28 offen offset:2048 lds
v_mfma_f32_16x16x32_bf16 a[116:119], v[224:227], v[164:167], a[116:119]
v_exp_f32 v216, v216
v_mfma_f32_16x16x32_bf16 a[116:119], v[228:231], v[180:183], a[116:119]
v_exp_f32 v217, v217
v_mfma_f32_16x16x32_bf16 a[120:123], v[224:227], v[168:171], a[120:123]
ds_read_b128 v[244:247], v248 offset:20992
v_cvt_pk_bf16_f32 v138, v216, v217
v_mfma_f32_16x16x32_bf16 a[120:123], v[228:231], v[184:187], a[120:123]
v_exp_f32 v218, v218
v_mfma_f32_16x16x32_bf16 a[124:127], v[224:227], v[172:175], a[124:127]
v_exp_f32 v219, v219
v_mfma_f32_16x16x32_bf16 a[124:127], v[228:231], v[188:191], a[124:127]
s_waitcnt lgkmcnt(2)
v_cvt_pk_bf16_f32 v139, v218, v219
v_mfma_f32_16x16x32_bf16 v[192:195], v[232:235], v[0:3], 0
ds_read_b128 v[224:227], v248 offset:24576
v_mfma_f32_16x16x32_bf16 v[192:195], v[236:239], v[4:7], v[192:195]
buffer_load_dwordx4 v251, s[12:15], s28 offen offset:3072 lds
v_mfma_f32_16x16x32_bf16 v[196:199], v[232:235], v[32:35], 0
s_xor_b32 s30, s30, 0x10000
v_mfma_f32_16x16x32_bf16 v[196:199], v[236:239], v[36:39], v[196:199]
s_add_u32 s28, s28, 0x4000
v_mfma_f32_16x16x32_bf16 v[200:203], v[232:235], v[64:67], 0
ds_read_b128 v[228:231], v248 offset:25088
v_mfma_f32_16x16x32_bf16 v[200:203], v[236:239], v[68:71], v[200:203]
v_exp_f32 v220, v220
v_mfma_f32_16x16x32_bf16 v[204:207], v[232:235], v[96:99], 0
v_exp_f32 v221, v221
v_mfma_f32_16x16x32_bf16 v[204:207], v[236:239], v[100:103], v[204:207]
s_waitcnt lgkmcnt(2)
s_add_u32 m0, s30, 0x0
v_mfma_f32_16x16x32_bf16 v[192:195], v[240:243], v[8:11], v[192:195]
ds_read_b128 v[232:235], v248 offset:28672
v_cvt_pk_bf16_f32 v142, v220, v221
v_mfma_f32_16x16x32_bf16 v[192:195], v[244:247], v[12:15], v[192:195]
buffer_load_dwordx4 v251, s[12:15], s28 offen offset:0 lds
v_mfma_f32_16x16x32_bf16 v[196:199], v[240:243], v[40:43], v[196:199]
v_exp_f32 v222, v222
v_mfma_f32_16x16x32_bf16 v[196:199], v[244:247], v[44:47], v[196:199]
v_exp_f32 v223, v223
v_mfma_f32_16x16x32_bf16 v[200:203], v[240:243], v[72:75], v[200:203]
ds_read_b128 v[236:239], v248 offset:29184
v_cvt_pk_bf16_f32 v143, v222, v223
v_mfma_f32_16x16x32_bf16 v[200:203], v[244:247], v[76:79], v[200:203]
v_mfma_f32_16x16x32_bf16 v[204:207], v[240:243], v[104:107], v[204:207]
v_mfma_f32_16x16x32_bf16 v[204:207], v[244:247], v[108:111], v[204:207]
s_waitcnt lgkmcnt(2)
v_mfma_f32_16x16x32_bf16 v[192:195], v[224:227], v[16:19], v[192:195]
ds_read_b64_tr_b16 v[240:241], v249 offset:40960
v_mfma_f32_16x16x32_bf16 v[192:195], v[228:231], v[20:23], v[192:195]
buffer_load_dwordx4 v251, s[12:15], s28 offen offset:1024 lds
v_mfma_f32_16x16x32_bf16 v[196:199], v[224:227], v[48:51], v[196:199]
ds_read_b64_tr_b16 v[242:243], v249 offset:43008
v_mfma_f32_16x16x32_bf16 v[196:199], v[228:231], v[52:55], v[196:199]
v_mfma_f32_16x16x32_bf16 v[200:203], v[224:227], v[80:83], v[200:203]
ds_read_b64_tr_b16 v[244:245], v249 offset:57344
v_mfma_f32_16x16x32_bf16 v[200:203], v[228:231], v[84:87], v[200:203]
v_mfma_f32_16x16x32_bf16 v[204:207], v[224:227], v[112:115], v[204:207]
ds_read_b64_tr_b16 v[246:247], v249 offset:59392
v_mfma_f32_16x16x32_bf16 v[204:207], v[228:231], v[116:119], v[204:207]
s_waitcnt lgkmcnt(4)
v_mfma_f32_16x16x32_bf16 v[192:195], v[232:235], v[24:27], v[192:195]
ds_read_b64_tr_b16 v[224:225], v250 offset:40960
v_mfma_f32_16x16x32_bf16 v[192:195], v[236:239], v[28:31], v[192:195]
buffer_load_dwordx4 v251, s[12:15], s28 offen offset:2048 lds
v_mfma_f32_16x16x32_bf16 v[196:199], v[232:235], v[56:59], v[196:199]
ds_read_b64_tr_b16 v[226:227], v250 offset:43008
v_mfma_f32_16x16x32_bf16 v[196:199], v[236:239], v[60:63], v[196:199]
v_mfma_f32_16x16x32_bf16 v[200:203], v[232:235], v[88:91], v[200:203]
ds_read_b64_tr_b16 v[228:229], v250 offset:57344
v_mfma_f32_16x16x32_bf16 v[200:203], v[236:239], v[92:95], v[200:203]
v_mfma_f32_16x16x32_bf16 v[204:207], v[232:235], v[120:123], v[204:207]
ds_read_b64_tr_b16 v[230:231], v250 offset:59392
v_mfma_f32_16x16x32_bf16 v[204:207], v[236:239], v[124:127], v[204:207]
s_waitcnt lgkmcnt(4)
v_mfma_f32_16x16x32_bf16 a[128:131], v[240:243], v[160:163], a[128:131]
ds_read_b64_tr_b16 v[232:233], v249 offset:41472
v_mfma_f32_16x16x32_bf16 a[128:131], v[244:247], v[176:179], a[128:131]
buffer_load_dwordx4 v251, s[12:15], s28 offen offset:3072 lds
v_mfma_f32_16x16x32_bf16 a[132:135], v[240:243], v[164:167], a[132:135]
ds_read_b64_tr_b16 v[234:235], v249 offset:43520
v_mfma_f32_16x16x32_bf16 a[132:135], v[244:247], v[180:183], a[132:135]
s_add_u32 s28, s28, 0x4000
v_mfma_f32_16x16x32_bf16 a[136:139], v[240:243], v[168:171], a[136:139]
ds_read_b64_tr_b16 v[236:237], v249 offset:57856
v_mfma_f32_16x16x32_bf16 a[136:139], v[244:247], v[184:187], a[136:139]
v_exp_f32 v192, v192
v_mfma_f32_16x16x32_bf16 a[140:143], v[240:243], v[172:175], a[140:143]
ds_read_b64_tr_b16 v[238:239], v249 offset:59904
v_mfma_f32_16x16x32_bf16 a[140:143], v[244:247], v[188:191], a[140:143]
s_waitcnt lgkmcnt(4)
v_mfma_f32_16x16x32_bf16 a[144:147], v[224:227], v[160:163], a[144:147]
ds_read_b64_tr_b16 v[240:241], v250 offset:41472
v_mfma_f32_16x16x32_bf16 a[144:147], v[228:231], v[176:179], a[144:147]
v_exp_f32 v193, v193
v_mfma_f32_16x16x32_bf16 a[148:151], v[224:227], v[164:167], a[148:151]
ds_read_b64_tr_b16 v[242:243], v250 offset:43520
v_cvt_pk_bf16_f32 v144, v192, v193
v_mfma_f32_16x16x32_bf16 a[148:151], v[228:231], v[180:183], a[148:151]
v_exp_f32 v194, v194
v_mfma_f32_16x16x32_bf16 a[152:155], v[224:227], v[168:171], a[152:155]
ds_read_b64_tr_b16 v[244:245], v250 offset:57856
v_mfma_f32_16x16x32_bf16 a[152:155], v[228:231], v[184:187], a[152:155]
v_exp_f32 v195, v195
v_mfma_f32_16x16x32_bf16 a[156:159], v[224:227], v[172:175], a[156:159]
ds_read_b64_tr_b16 v[246:247], v250 offset:59904
v_cvt_pk_bf16_f32 v145, v194, v195
v_mfma_f32_16x16x32_bf16 a[156:159], v[228:231], v[188:191], a[156:159]
s_waitcnt lgkmcnt(4)
v_mfma_f32_16x16x32_bf16 a[160:163], v[232:235], v[160:163], a[160:163]
ds_read_b128 v[224:227], v248 offset:18432
v_mfma_f32_16x16x32_bf16 a[160:163], v[236:239], v[176:179], a[160:163]
v_exp_f32 v196, v196
v_mfma_f32_16x16x32_bf16 a[164:167], v[232:235], v[164:167], a[164:167]
v_exp_f32 v197, v197
v_mfma_f32_16x16x32_bf16 a[164:167], v[236:239], v[180:183], a[164:167]
v_exp_f32 v198, v198
v_mfma_f32_16x16x32_bf16 a[168:171], v[232:235], v[168:171], a[168:171]
ds_read_b128 v[228:231], v248 offset:18944
v_cvt_pk_bf16_f32 v148, v196, v197
v_mfma_f32_16x16x32_bf16 a[168:171], v[236:239], v[184:187], a[168:171]
v_exp_f32 v199, v199
v_mfma_f32_16x16x32_bf16 a[172:175], v[232:235], v[172:175], a[172:175]
v_exp_f32 v200, v200
v_mfma_f32_16x16x32_bf16 a[172:175], v[236:239], v[188:191], a[172:175]
s_waitcnt lgkmcnt(2)
v_cvt_pk_bf16_f32 v149, v198, v199
v_mfma_f32_16x16x32_bf16 a[176:179], v[240:243], v[160:163], a[176:179]
ds_read_b128 v[232:235], v248 offset:22528
v_mfma_f32_16x16x32_bf16 a[176:179], v[244:247], v[176:179], a[176:179]
v_exp_f32 v201, v201
v_mfma_f32_16x16x32_bf16 a[180:183], v[240:243], v[164:167], a[180:183]
v_exp_f32 v202, v202
v_mfma_f32_16x16x32_bf16 a[180:183], v[244:247], v[180:183], a[180:183]
v_exp_f32 v203, v203
v_mfma_f32_16x16x32_bf16 a[184:187], v[240:243], v[168:171], a[184:187]
ds_read_b128 v[236:239], v248 offset:23040
v_cvt_pk_bf16_f32 v152, v200, v201
v_mfma_f32_16x16x32_bf16 a[184:187], v[244:247], v[184:187], a[184:187]
v_cvt_pk_bf16_f32 v153, v202, v203
v_mfma_f32_16x16x32_bf16 a[188:191], v[240:243], v[172:175], a[188:191]
v_exp_f32 v204, v204
v_mfma_f32_16x16x32_bf16 a[188:191], v[244:247], v[188:191], a[188:191]
s_waitcnt lgkmcnt(2)
v_mfma_f32_16x16x32_bf16 v[208:211], v[224:227], v[0:3], 0
ds_read_b128 v[240:243], v248 offset:26624
v_mfma_f32_16x16x32_bf16 v[208:211], v[228:231], v[4:7], v[208:211]
v_exp_f32 v205, v205
v_mfma_f32_16x16x32_bf16 v[212:215], v[224:227], v[32:35], 0
v_exp_f32 v206, v206
v_mfma_f32_16x16x32_bf16 v[212:215], v[228:231], v[36:39], v[212:215]
v_exp_f32 v207, v207
v_mfma_f32_16x16x32_bf16 v[216:219], v[224:227], v[64:67], 0
ds_read_b128 v[244:247], v248 offset:27136
v_cvt_pk_bf16_f32 v156, v204, v205
v_mfma_f32_16x16x32_bf16 v[216:219], v[228:231], v[68:71], v[216:219]
v_cvt_pk_bf16_f32 v157, v206, v207
v_mfma_f32_16x16x32_bf16 v[220:223], v[224:227], v[96:99], 0
v_mfma_f32_16x16x32_bf16 v[220:223], v[228:231], v[100:103], v[220:223]
s_waitcnt lgkmcnt(2)
v_mfma_f32_16x16x32_bf16 v[208:211], v[232:235], v[8:11], v[208:211]
ds_read_b128 v[224:227], v248 offset:30720
v_mfma_f32_16x16x32_bf16 v[208:211], v[236:239], v[12:15], v[208:211]
v_mfma_f32_16x16x32_bf16 v[212:215], v[232:235], v[40:43], v[212:215]
v_mfma_f32_16x16x32_bf16 v[212:215], v[236:239], v[44:47], v[212:215]
v_mfma_f32_16x16x32_bf16 v[216:219], v[232:235], v[72:75], v[216:219]
ds_read_b128 v[228:231], v248 offset:31232
v_mfma_f32_16x16x32_bf16 v[216:219], v[236:239], v[76:79], v[216:219]
v_mfma_f32_16x16x32_bf16 v[220:223], v[232:235], v[104:107], v[220:223]
v_mfma_f32_16x16x32_bf16 v[220:223], v[236:239], v[108:111], v[220:223]
s_waitcnt lgkmcnt(2)
v_mfma_f32_16x16x32_bf16 v[208:211], v[240:243], v[16:19], v[208:211]
ds_read_b64_tr_b16 v[232:233], v249 offset:45056
v_mfma_f32_16x16x32_bf16 v[208:211], v[244:247], v[20:23], v[208:211]
v_mfma_f32_16x16x32_bf16 v[212:215], v[240:243], v[48:51], v[212:215]
ds_read_b64_tr_b16 v[234:235], v249 offset:47104
v_mfma_f32_16x16x32_bf16 v[212:215], v[244:247], v[52:55], v[212:215]
v_mfma_f32_16x16x32_bf16 v[216:219], v[240:243], v[80:83], v[216:219]
ds_read_b64_tr_b16 v[236:237], v249 offset:61440
v_mfma_f32_16x16x32_bf16 v[216:219], v[244:247], v[84:87], v[216:219]
v_mfma_f32_16x16x32_bf16 v[220:223], v[240:243], v[112:115], v[220:223]
ds_read_b64_tr_b16 v[238:239], v249 offset:63488
v_mfma_f32_16x16x32_bf16 v[220:223], v[244:247], v[116:119], v[220:223]
s_waitcnt lgkmcnt(4)
v_mfma_f32_16x16x32_bf16 v[208:211], v[224:227], v[24:27], v[208:211]
ds_read_b64_tr_b16 v[240:241], v250 offset:45056
v_mfma_f32_16x16x32_bf16 v[208:211], v[228:231], v[28:31], v[208:211]
v_mfma_f32_16x16x32_bf16 v[212:215], v[224:227], v[56:59], v[212:215]
ds_read_b64_tr_b16 v[242:243], v250 offset:47104
v_mfma_f32_16x16x32_bf16 v[212:215], v[228:231], v[60:63], v[212:215]
v_mfma_f32_16x16x32_bf16 v[216:219], v[224:227], v[88:91], v[216:219]
ds_read_b64_tr_b16 v[244:245], v250 offset:61440
v_mfma_f32_16x16x32_bf16 v[216:219], v[228:231], v[92:95], v[216:219]
v_mfma_f32_16x16x32_bf16 v[220:223], v[224:227], v[120:123], v[220:223]
ds_read_b64_tr_b16 v[246:247], v250 offset:63488
v_mfma_f32_16x16x32_bf16 v[220:223], v[228:231], v[124:127], v[220:223]
s_waitcnt lgkmcnt(4)
v_mfma_f32_16x16x32_bf16 a[192:195], v[232:235], v[160:163], a[192:195]
ds_read_b64_tr_b16 v[224:225], v249 offset:45568
v_mfma_f32_16x16x32_bf16 a[192:195], v[236:239], v[176:179], a[192:195]
v_mfma_f32_16x16x32_bf16 a[196:199], v[232:235], v[164:167], a[196:199]
ds_read_b64_tr_b16 v[226:227], v249 offset:47616
v_mfma_f32_16x16x32_bf16 a[196:199], v[236:239], v[180:183], a[196:199]
v_exp_f32 v208, v208
v_mfma_f32_16x16x32_bf16 a[200:203], v[232:235], v[168:171], a[200:203]
ds_read_b64_tr_b16 v[228:229], v249 offset:61952
v_mfma_f32_16x16x32_bf16 a[200:203], v[236:239], v[184:187], a[200:203]
v_exp_f32 v209, v209
v_mfma_f32_16x16x32_bf16 a[204:207], v[232:235], v[172:175], a[204:207]
ds_read_b64_tr_b16 v[230:231], v249 offset:64000
v_cvt_pk_bf16_f32 v146, v208, v209
v_mfma_f32_16x16x32_bf16 a[204:207], v[236:239], v[188:191], a[204:207]
s_waitcnt lgkmcnt(4)
v_mfma_f32_16x16x32_bf16 a[208:211], v[240:243], v[160:163], a[208:211]
ds_read_b64_tr_b16 v[232:233], v250 offset:45568
v_mfma_f32_16x16x32_bf16 a[208:211], v[244:247], v[176:179], a[208:211]
v_exp_f32 v210, v210
v_mfma_f32_16x16x32_bf16 a[212:215], v[240:243], v[164:167], a[212:215]
ds_read_b64_tr_b16 v[234:235], v250 offset:47616
v_mfma_f32_16x16x32_bf16 a[212:215], v[244:247], v[180:183], a[212:215]
v_exp_f32 v211, v211
v_mfma_f32_16x16x32_bf16 a[216:219], v[240:243], v[168:171], a[216:219]
ds_read_b64_tr_b16 v[236:237], v250 offset:61952
v_cvt_pk_bf16_f32 v147, v210, v211
v_mfma_f32_16x16x32_bf16 a[216:219], v[244:247], v[184:187], a[216:219]
v_exp_f32 v212, v212
v_mfma_f32_16x16x32_bf16 a[220:223], v[240:243], v[172:175], a[220:223]
ds_read_b64_tr_b16 v[238:239], v250 offset:64000
v_mfma_f32_16x16x32_bf16 a[220:223], v[244:247], v[188:191], a[220:223]
s_waitcnt lgkmcnt(4)
v_mfma_f32_16x16x32_bf16 a[224:227], v[224:227], v[160:163], a[224:227]
ds_read_b128 v[240:243], v248 offset:32768
v_mfma_f32_16x16x32_bf16 a[224:227], v[228:231], v[176:179], a[224:227]
v_exp_f32 v213, v213
v_mfma_f32_16x16x32_bf16 a[228:231], v[224:227], v[164:167], a[228:231]
v_exp_f32 v214, v214
v_mfma_f32_16x16x32_bf16 a[228:231], v[228:231], v[180:183], a[228:231]
v_exp_f32 v215, v215
v_mfma_f32_16x16x32_bf16 a[232:235], v[224:227], v[168:171], a[232:235]
ds_read_b128 v[244:247], v248 offset:33280
v_cvt_pk_bf16_f32 v150, v212, v213
v_mfma_f32_16x16x32_bf16 a[232:235], v[228:231], v[184:187], a[232:235]
v_cvt_pk_bf16_f32 v151, v214, v215
v_mfma_f32_16x16x32_bf16 a[236:239], v[224:227], v[172:175], a[236:239]
v_exp_f32 v216, v216
v_mfma_f32_16x16x32_bf16 a[236:239], v[228:231], v[188:191], a[236:239]
s_waitcnt lgkmcnt(2)
v_mfma_f32_16x16x32_bf16 a[240:243], v[232:235], v[160:163], a[240:243]
ds_read_b128 v[224:227], v248 offset:36864
v_mfma_f32_16x16x32_bf16 a[240:243], v[236:239], v[176:179], a[240:243]
v_exp_f32 v217, v217
v_mfma_f32_16x16x32_bf16 a[244:247], v[232:235], v[164:167], a[244:247]
v_exp_f32 v218, v218
v_mfma_f32_16x16x32_bf16 a[244:247], v[236:239], v[180:183], a[244:247]
v_exp_f32 v219, v219
v_mfma_f32_16x16x32_bf16 a[248:251], v[232:235], v[168:171], a[248:251]
ds_read_b128 v[228:231], v248 offset:37376
v_cvt_pk_bf16_f32 v154, v216, v217
v_mfma_f32_16x16x32_bf16 a[248:251], v[236:239], v[184:187], a[248:251]
v_cvt_pk_bf16_f32 v155, v218, v219
v_mfma_f32_16x16x32_bf16 a[252:255], v[232:235], v[172:175], a[252:255]
v_exp_f32 v220, v220
v_mfma_f32_16x16x32_bf16 a[252:255], v[236:239], v[188:191], a[252:255]
s_waitcnt lgkmcnt(2)
v_mfma_f32_16x16x32_bf16 v[192:195], v[240:243], v[0:3], 0
ds_read_b128 v[232:235], v248 offset:40960
v_mfma_f32_16x16x32_bf16 v[192:195], v[244:247], v[4:7], v[192:195]
v_xor_b32 v249, 0x10000, v249
v_mfma_f32_16x16x32_bf16 v[196:199], v[240:243], v[32:35], 0
v_exp_f32 v221, v221
v_mfma_f32_16x16x32_bf16 v[196:199], v[244:247], v[36:39], v[196:199]
v_xor_b32 v250, 0x10000, v250
v_cvt_pk_bf16_f32 v158, v220, v221
v_mfma_f32_16x16x32_bf16 v[200:203], v[240:243], v[64:67], 0
ds_read_b128 v[236:239], v248 offset:41472
v_mfma_f32_16x16x32_bf16 v[200:203], v[244:247], v[68:71], v[200:203]
v_exp_f32 v222, v222
v_mfma_f32_16x16x32_bf16 v[204:207], v[240:243], v[96:99], 0
v_exp_f32 v223, v223
v_mfma_f32_16x16x32_bf16 v[204:207], v[244:247], v[100:103], v[204:207]
s_waitcnt lgkmcnt(2)
v_cvt_pk_bf16_f32 v159, v222, v223
v_mfma_f32_16x16x32_bf16 v[192:195], v[224:227], v[8:11], v[192:195]
ds_read_b128 v[240:243], v248 offset:45056
v_mfma_f32_16x16x32_bf16 v[192:195], v[228:231], v[12:15], v[192:195]
v_mfma_f32_16x16x32_bf16 v[196:199], v[224:227], v[40:43], v[196:199]
v_mfma_f32_16x16x32_bf16 v[196:199], v[228:231], v[44:47], v[196:199]
v_mfma_f32_16x16x32_bf16 v[200:203], v[224:227], v[72:75], v[200:203]
ds_read_b128 v[244:247], v248 offset:45568
v_mfma_f32_16x16x32_bf16 v[200:203], v[228:231], v[76:79], v[200:203]
v_mfma_f32_16x16x32_bf16 v[204:207], v[224:227], v[104:107], v[204:207]
v_mfma_f32_16x16x32_bf16 v[204:207], v[228:231], v[108:111], v[204:207]
s_waitcnt lgkmcnt(2)
v_mfma_f32_16x16x32_bf16 v[192:195], v[232:235], v[16:19], v[192:195]
ds_read_b64_tr_b16 v[224:225], v249 offset:0
v_mfma_f32_16x16x32_bf16 v[192:195], v[236:239], v[20:23], v[192:195]
v_mfma_f32_16x16x32_bf16 v[196:199], v[232:235], v[48:51], v[196:199]
ds_read_b64_tr_b16 v[226:227], v249 offset:2048
v_mfma_f32_16x16x32_bf16 v[196:199], v[236:239], v[52:55], v[196:199]
v_mfma_f32_16x16x32_bf16 v[200:203], v[232:235], v[80:83], v[200:203]
ds_read_b64_tr_b16 v[228:229], v249 offset:16384
v_mfma_f32_16x16x32_bf16 v[200:203], v[236:239], v[84:87], v[200:203]
v_mfma_f32_16x16x32_bf16 v[204:207], v[232:235], v[112:115], v[204:207]
ds_read_b64_tr_b16 v[230:231], v249 offset:18432
v_mfma_f32_16x16x32_bf16 v[204:207], v[236:239], v[116:119], v[204:207]
s_waitcnt lgkmcnt(4)
v_mfma_f32_16x16x32_bf16 v[192:195], v[240:243], v[24:27], v[192:195]
ds_read_b64_tr_b16 v[232:233], v250 offset:0
v_mfma_f32_16x16x32_bf16 v[192:195], v[244:247], v[28:31], v[192:195]
v_mfma_f32_16x16x32_bf16 v[196:199], v[240:243], v[56:59], v[196:199]
ds_read_b64_tr_b16 v[234:235], v250 offset:2048
v_mfma_f32_16x16x32_bf16 v[196:199], v[244:247], v[60:63], v[196:199]
v_mfma_f32_16x16x32_bf16 v[200:203], v[240:243], v[88:91], v[200:203]
ds_read_b64_tr_b16 v[236:237], v250 offset:16384
v_mfma_f32_16x16x32_bf16 v[200:203], v[244:247], v[92:95], v[200:203]
s_sub_u32 s31, s31, 1
v_mfma_f32_16x16x32_bf16 v[204:207], v[240:243], v[120:123], v[204:207]
ds_read_b64_tr_b16 v[238:239], v250 offset:18432
v_mfma_f32_16x16x32_bf16 v[204:207], v[244:247], v[124:127], v[204:207]
s_cbranch_scc0 L2_loop
L2_tails:
L2_tail_1:
s_cmp_eq_u32 s59, 7
s_cbranch_scc1 L2_tail_1_7
L2_tail_1_6:
s_waitcnt lgkmcnt(4)
v_mfma_f32_16x16x32_bf16 a[0:3], v[224:227], v[160:163], a[0:3]
ds_read_b128 v[240:243], v248 offset:2048
v_mfma_f32_16x16x32_bf16 a[0:3], v[228:231], v[176:179], a[0:3]
s_lshl_b32 s36, s34, 13
v_mfma_f32_16x16x32_bf16 a[4:7], v[224:227], v[164:167], a[4:7]
s_add_u32 s56, s4, 0x1000000
s_addc_u32 s57, s5, 0
v_mfma_f32_16x16x32_bf16 a[4:7], v[228:231], v[180:183], a[4:7]
s_add_u32 s36, s36, 0x20000
s_mov_b32 s58, 0x6c02000
v_mfma_f32_16x16x32_bf16 a[8:11], v[224:227], v[168:171], a[8:11]
ds_read_b128 v[244:247], v248 offset:2560
s_mov_b32 s59, 0x00020000
v_mfma_f32_16x16x32_bf16 a[8:11], v[228:231], v[184:187], a[8:11]
v_add_u32 v255, s36, v252
s_lshr_b32 s35, s2, 1
v_mfma_f32_16x16x32_bf16 a[12:15], v[224:227], v[172:175], a[12:15]
s_and_b32 s35, s35, 28
s_add_u32 s35, s35, s34
v_mfma_f32_16x16x32_bf16 a[12:15], v[228:231], v[188:191], a[12:15]
s_waitcnt lgkmcnt(2)
s_lshl_b32 s35, s35, 13
v_mfma_f32_16x16x32_bf16 a[16:19], v[232:235], v[160:163], a[16:19]
ds_read_b128 v[224:227], v248 offset:6144
v_lshlrev_b32 v253, 3, v252
v_mfma_f32_16x16x32_bf16 a[16:19], v[236:239], v[176:179], a[16:19]
buffer_load_dword v253, v253, s[56:59], s35 offen
ds_write_b128 v255, v[160:163] offset:0
v_mfma_f32_16x16x32_bf16 a[20:23], v[232:235], v[164:167], a[20:23]
v_exp_f32 v192, v192
v_mfma_f32_16x16x32_bf16 a[20:23], v[236:239], v[180:183], a[20:23]
v_exp_f32 v193, v193
v_mfma_f32_16x16x32_bf16 a[24:27], v[232:235], v[168:171], a[24:27]
ds_read_b128 v[228:231], v248 offset:6656
v_cvt_pk_bf16_f32 v128, v192, v193
v_mfma_f32_16x16x32_bf16 a[24:27], v[236:239], v[184:187], a[24:27]
v_exp_f32 v194, v194
v_mfma_f32_16x16x32_bf16 a[28:31], v[232:235], v[172:175], a[28:31]
v_exp_f32 v195, v195
v_mfma_f32_16x16x32_bf16 a[28:31], v[236:239], v[188:191], a[28:31]
s_waitcnt lgkmcnt(3)
v_cvt_pk_bf16_f32 v129, v194, v195
v_mfma_f32_16x16x32_bf16 v[208:211], v[240:243], v[0:3], 0
ds_read_b128 v[232:235], v248 offset:10240
ds_write_b128 v255, v[164:167] offset:1024
v_mfma_f32_16x16x32_bf16 v[208:211], v[244:247], v[4:7], v[208:211]
v_exp_f32 v196, v196
v_mfma_f32_16x16x32_bf16 v[212:215], v[240:243], v[32:35], 0
v_exp_f32 v197, v197
v_mfma_f32_16x16x32_bf16 v[212:215], v[244:247], v[36:39], v[212:215]
v_exp_f32 v198, v198
v_mfma_f32_16x16x32_bf16 v[216:219], v[240:243], v[64:67], 0
ds_read_b128 v[236:239], v248 offset:10752
v_cvt_pk_bf16_f32 v132, v196, v197
v_mfma_f32_16x16x32_bf16 v[216:219], v[244:247], v[68:71], v[216:219]
v_exp_f32 v199, v199
v_mfma_f32_16x16x32_bf16 v[220:223], v[240:243], v[96:99], 0
v_exp_f32 v200, v200
v_mfma_f32_16x16x32_bf16 v[220:223], v[244:247], v[100:103], v[220:223]
s_waitcnt lgkmcnt(3)
v_cvt_pk_bf16_f32 v133, v198, v199
v_mfma_f32_16x16x32_bf16 v[208:211], v[224:227], v[8:11], v[208:211]
ds_read_b128 v[240:243], v248 offset:14336
ds_write_b128 v255, v[168:171] offset:2048
v_mfma_f32_16x16x32_bf16 v[208:211], v[228:231], v[12:15], v[208:211]
v_exp_f32 v201, v201
v_mfma_f32_16x16x32_bf16 v[212:215], v[224:227], v[40:43], v[212:215]
v_exp_f32 v202, v202
v_mfma_f32_16x16x32_bf16 v[212:215], v[228:231], v[44:47], v[212:215]
v_exp_f32 v203, v203
v_mfma_f32_16x16x32_bf16 v[216:219], v[224:227], v[72:75], v[216:219]
ds_read_b128 v[244:247], v248 offset:14848
v_cvt_pk_bf16_f32 v136, v200, v201
v_mfma_f32_16x16x32_bf16 v[216:219], v[228:231], v[76:79], v[216:219]
v_cvt_pk_bf16_f32 v137, v202, v203
ds_write_b128 v255, v[172:175] offset:3072
v_mfma_f32_16x16x32_bf16 v[220:223], v[224:227], v[104:107], v[220:223]
v_exp_f32 v204, v204
v_mfma_f32_16x16x32_bf16 v[220:223], v[228:231], v[108:111], v[220:223]
s_waitcnt lgkmcnt(4)
s_waitcnt vmcnt(1)
s_barrier
v_mfma_f32_16x16x32_bf16 v[208:211], v[232:235], v[16:19], v[208:211]
ds_read_b128 v[224:227], v248 offset:16384
s_add_u32 m0, s30, 0xc000
v_mfma_f32_16x16x32_bf16 v[208:211], v[236:239], v[20:23], v[208:211]
s_and_b32 s100, s30, 0x10000
buffer_load_dwordx4 v251, s[12:15], s28 offen offset:0 lds
v_mfma_f32_16x16x32_bf16 v[212:215], v[232:235], v[48:51], v[212:215]
s_xor_b32 s100, s100, 0x10000
v_mfma_f32_16x16x32_bf16 v[212:215], v[236:239], v[52:55], v[212:215]
v_exp_f32 v205, v205
v_mfma_f32_16x16x32_bf16 v[216:219], v[232:235], v[80:83], v[216:219]
ds_read_b128 v[228:231], v248 offset:16896
v_cvt_pk_bf16_f32 v140, v204, v205
v_mfma_f32_16x16x32_bf16 v[216:219], v[236:239], v[84:87], v[216:219]
v_exp_f32 v206, v206
v_mfma_f32_16x16x32_bf16 v[220:223], v[232:235], v[112:115], v[220:223]
v_exp_f32 v207, v207
v_mfma_f32_16x16x32_bf16 v[220:223], v[236:239], v[116:119], v[220:223]
s_waitcnt lgkmcnt(3)
v_cvt_pk_bf16_f32 v141, v206, v207
v_mfma_f32_16x16x32_bf16 v[208:211], v[240:243], v[24:27], v[208:211]
ds_read_b128 v[232:235], v248 offset:20480
buffer_load_dwordx4 v251, s[12:15], s28 offen offset:1024 lds
v_mfma_f32_16x16x32_bf16 v[208:211], v[244:247], v[28:31], v[208:211]
v_mfma_f32_16x16x32_bf16 v[212:215], v[240:243], v[56:59], v[212:215]
buffer_load_dwordx4 v251, s[12:15], s28 offen offset:2048 lds
v_mfma_f32_16x16x32_bf16 v[212:215], v[244:247], v[60:63], v[212:215]
v_mfma_f32_16x16x32_bf16 v[216:219], v[240:243], v[88:91], v[216:219]
ds_read_b128 v[236:239], v248 offset:20992
buffer_load_dwordx4 v251, s[12:15], s28 offen offset:3072 lds
v_mfma_f32_16x16x32_bf16 v[216:219], v[244:247], v[92:95], v[216:219]
v_mfma_f32_16x16x32_bf16 v[220:223], v[240:243], v[120:123], v[220:223]
s_add_u32 s28, s28, 0x4000
v_mfma_f32_16x16x32_bf16 v[220:223], v[244:247], v[124:127], v[220:223]
s_waitcnt lgkmcnt(2)
v_mfma_f32_16x16x32_bf16 v[192:195], v[224:227], v[0:3], 0
ds_read_b128 v[240:243], v248 offset:24576
v_mfma_f32_16x16x32_bf16 v[192:195], v[228:231], v[4:7], v[192:195]
v_exp_f32 v208, v208
v_mfma_f32_16x16x32_bf16 v[196:199], v[224:227], v[32:35], 0
v_exp_f32 v209, v209
v_mfma_f32_16x16x32_bf16 v[196:199], v[228:231], v[36:39], v[196:199]
v_exp_f32 v210, v210
v_mfma_f32_16x16x32_bf16 v[200:203], v[224:227], v[64:67], 0
ds_read_b128 v[244:247], v248 offset:25088
v_cvt_pk_bf16_f32 v130, v208, v209
v_mfma_f32_16x16x32_bf16 v[200:203], v[228:231], v[68:71], v[200:203]
v_exp_f32 v211, v211
v_mfma_f32_16x16x32_bf16 v[204:207], v[224:227], v[96:99], 0
v_exp_f32 v212, v212
v_mfma_f32_16x16x32_bf16 v[204:207], v[228:231], v[100:103], v[204:207]
s_waitcnt lgkmcnt(2)
v_cvt_pk_bf16_f32 v131, v210, v211
v_mfma_f32_16x16x32_bf16 v[192:195], v[232:235], v[8:11], v[192:195]
ds_read_b128 v[224:227], v248 offset:28672
v_mfma_f32_16x16x32_bf16 v[192:195], v[236:239], v[12:15], v[192:195]
v_exp_f32 v213, v213
v_mfma_f32_16x16x32_bf16 v[196:199], v[232:235], v[40:43], v[196:199]
v_exp_f32 v214, v214
v_mfma_f32_16x16x32_bf16 v[196:199], v[236:239], v[44:47], v[196:199]
v_exp_f32 v215, v215
v_mfma_f32_16x16x32_bf16 v[200:203], v[232:235], v[72:75], v[200:203]
ds_read_b128 v[228:231], v248 offset:29184
v_cvt_pk_bf16_f32 v134, v212, v213
v_mfma_f32_16x16x32_bf16 v[200:203], v[236:239], v[76:79], v[200:203]
v_cvt_pk_bf16_f32 v135, v214, v215
v_mfma_f32_16x16x32_bf16 v[204:207], v[232:235], v[104:107], v[204:207]
v_exp_f32 v216, v216
v_mfma_f32_16x16x32_bf16 v[204:207], v[236:239], v[108:111], v[204:207]
s_waitcnt lgkmcnt(2)
v_mfma_f32_16x16x32_bf16 v[192:195], v[240:243], v[16:19], v[192:195]
ds_read_b128 v[232:235], v248 offset:18432
v_mfma_f32_16x16x32_bf16 v[192:195], v[244:247], v[20:23], v[192:195]
v_exp_f32 v217, v217
v_mfma_f32_16x16x32_bf16 v[196:199], v[240:243], v[48:51], v[196:199]
v_exp_f32 v218, v218
v_mfma_f32_16x16x32_bf16 v[196:199], v[244:247], v[52:55], v[196:199]
v_exp_f32 v219, v219
v_mfma_f32_16x16x32_bf16 v[200:203], v[240:243], v[80:83], v[200:203]
ds_read_b128 v[236:239], v248 offset:18944
v_cvt_pk_bf16_f32 v138, v216, v217
v_mfma_f32_16x16x32_bf16 v[200:203], v[244:247], v[84:87], v[200:203]
v_cvt_pk_bf16_f32 v139, v218, v219
v_mfma_f32_16x16x32_bf16 v[204:207], v[240:243], v[112:115], v[204:207]
v_exp_f32 v220, v220
v_mfma_f32_16x16x32_bf16 v[204:207], v[244:247], v[116:119], v[204:207]
s_waitcnt lgkmcnt(2)
v_mfma_f32_16x16x32_bf16 v[192:195], v[224:227], v[24:27], v[192:195]
ds_read_b128 v[240:243], v248 offset:22528
v_mfma_f32_16x16x32_bf16 v[192:195], v[228:231], v[28:31], v[192:195]
v_exp_f32 v221, v221
v_mfma_f32_16x16x32_bf16 v[196:199], v[224:227], v[56:59], v[196:199]
v_exp_f32 v222, v222
v_mfma_f32_16x16x32_bf16 v[196:199], v[228:231], v[60:63], v[196:199]
v_exp_f32 v223, v223
v_mfma_f32_16x16x32_bf16 v[200:203], v[224:227], v[88:91], v[200:203]
ds_read_b128 v[244:247], v248 offset:23040
v_cvt_pk_bf16_f32 v142, v220, v221
v_mfma_f32_16x16x32_bf16 v[200:203], v[228:231], v[92:95], v[200:203]
v_cvt_pk_bf16_f32 v143, v222, v223
v_mfma_f32_16x16x32_bf16 v[204:207], v[224:227], v[120:123], v[204:207]
v_mfma_f32_16x16x32_bf16 v[204:207], v[228:231], v[124:127], v[204:207]
s_waitcnt lgkmcnt(2)
v_mfma_f32_16x16x32_bf16 v[208:211], v[232:235], v[0:3], 0
ds_read_b128 v[224:227], v248 offset:26624
v_mfma_f32_16x16x32_bf16 v[208:211], v[236:239], v[4:7], v[208:211]
v_exp_f32 v192, v192
v_mfma_f32_16x16x32_bf16 v[212:215], v[232:235], v[32:35], 0
v_exp_f32 v193, v193
v_mfma_f32_16x16x32_bf16 v[212:215], v[236:239], v[36:39], v[212:215]
v_exp_f32 v194, v194
v_mfma_f32_16x16x32_bf16 v[216:219], v[232:235], v[64:67], 0
ds_read_b128 v[228:231], v248 offset:27136
v_cvt_pk_bf16_f32 v144, v192, v193
v_mfma_f32_16x16x32_bf16 v[216:219], v[236:239], v[68:71], v[216:219]
v_exp_f32 v195, v195
v_mfma_f32_16x16x32_bf16 v[220:223], v[232:235], v[96:99], 0
v_exp_f32 v196, v196
v_mfma_f32_16x16x32_bf16 v[220:223], v[236:239], v[100:103], v[220:223]
s_waitcnt lgkmcnt(2)
v_cvt_pk_bf16_f32 v145, v194, v195
v_mfma_f32_16x16x32_bf16 v[208:211], v[240:243], v[8:11], v[208:211]
ds_read_b128 v[232:235], v248 offset:30720
v_mfma_f32_16x16x32_bf16 v[208:211], v[244:247], v[12:15], v[208:211]
v_exp_f32 v197, v197
v_mfma_f32_16x16x32_bf16 v[212:215], v[240:243], v[40:43], v[212:215]
v_exp_f32 v198, v198
v_mfma_f32_16x16x32_bf16 v[212:215], v[244:247], v[44:47], v[212:215]
v_exp_f32 v199, v199
v_mfma_f32_16x16x32_bf16 v[216:219], v[240:243], v[72:75], v[216:219]
ds_read_b128 v[236:239], v248 offset:31232
v_cvt_pk_bf16_f32 v148, v196, v197
v_mfma_f32_16x16x32_bf16 v[216:219], v[244:247], v[76:79], v[216:219]
v_cvt_pk_bf16_f32 v149, v198, v199
v_mfma_f32_16x16x32_bf16 v[220:223], v[240:243], v[104:107], v[220:223]
v_exp_f32 v200, v200
v_mfma_f32_16x16x32_bf16 v[220:223], v[244:247], v[108:111], v[220:223]
s_waitcnt lgkmcnt(2)
v_mfma_f32_16x16x32_bf16 v[208:211], v[224:227], v[16:19], v[208:211]
ds_read_b128 v[240:243], v248 offset:32768
v_mfma_f32_16x16x32_bf16 v[208:211], v[228:231], v[20:23], v[208:211]
v_exp_f32 v201, v201
v_mfma_f32_16x16x32_bf16 v[212:215], v[224:227], v[48:51], v[212:215]
v_exp_f32 v202, v202
v_mfma_f32_16x16x32_bf16 v[212:215], v[228:231], v[52:55], v[212:215]
v_exp_f32 v203, v203
v_mfma_f32_16x16x32_bf16 v[216:219], v[224:227], v[80:83], v[216:219]
ds_read_b128 v[244:247], v248 offset:33280
v_cvt_pk_bf16_f32 v152, v200, v201
v_mfma_f32_16x16x32_bf16 v[216:219], v[228:231], v[84:87], v[216:219]
v_cvt_pk_bf16_f32 v153, v202, v203
v_mfma_f32_16x16x32_bf16 v[220:223], v[224:227], v[112:115], v[220:223]
v_exp_f32 v204, v204
v_mfma_f32_16x16x32_bf16 v[220:223], v[228:231], v[116:119], v[220:223]
s_waitcnt lgkmcnt(2)
v_mfma_f32_16x16x32_bf16 v[208:211], v[232:235], v[24:27], v[208:211]
ds_read_b128 v[224:227], v248 offset:36864
v_mfma_f32_16x16x32_bf16 v[208:211], v[236:239], v[28:31], v[208:211]
v_exp_f32 v205, v205
v_mfma_f32_16x16x32_bf16 v[212:215], v[232:235], v[56:59], v[212:215]
v_exp_f32 v206, v206
v_mfma_f32_16x16x32_bf16 v[212:215], v[236:239], v[60:63], v[212:215]
v_exp_f32 v207, v207
v_mfma_f32_16x16x32_bf16 v[216:219], v[232:235], v[88:91], v[216:219]
ds_read_b128 v[228:231], v248 offset:37376
v_cvt_pk_bf16_f32 v156, v204, v205
v_mfma_f32_16x16x32_bf16 v[216:219], v[236:239], v[92:95], v[216:219]
v_cvt_pk_bf16_f32 v157, v206, v207
v_mfma_f32_16x16x32_bf16 v[220:223], v[232:235], v[120:123], v[220:223]
v_mfma_f32_16x16x32_bf16 v[220:223], v[236:239], v[124:127], v[220:223]
s_waitcnt lgkmcnt(2)
v_mfma_f32_16x16x32_bf16 v[192:195], v[240:243], v[0:3], 0
ds_read_b128 v[232:235], v248 offset:40960
v_mfma_f32_16x16x32_bf16 v[192:195], v[244:247], v[4:7], v[192:195]
v_exp_f32 v208, v208
v_mfma_f32_16x16x32_bf16 v[196:199], v[240:243], v[32:35], 0
v_exp_f32 v209, v209
v_mfma_f32_16x16x32_bf16 v[196:199], v[244:247], v[36:39], v[196:199]
v_exp_f32 v210, v210
v_mfma_f32_16x16x32_bf16 v[200:203], v[240:243], v[64:67], 0
ds_read_b128 v[236:239], v248 offset:41472
v_cvt_pk_bf16_f32 v146, v208, v209
v_mfma_f32_16x16x32_bf16 v[200:203], v[244:247], v[68:71], v[200:203]
v_exp_f32 v211, v211
v_mfma_f32_16x16x32_bf16 v[204:207], v[240:243], v[96:99], 0
v_exp_f32 v212, v212
v_mfma_f32_16x16x32_bf16 v[204:207], v[244:247], v[100:103], v[204:207]
s_waitcnt lgkmcnt(2)
v_cvt_pk_bf16_f32 v147, v210, v211
v_mfma_f32_16x16x32_bf16 v[192:195], v[224:227], v[8:11], v[192:195]
ds_read_b128 v[240:243], v248 offset:45056
v_mfma_f32_16x16x32_bf16 v[192:195], v[228:231], v[12:15], v[192:195]
v_exp_f32 v213, v213
v_mfma_f32_16x16x32_bf16 v[196:199], v[224:227], v[40:43], v[196:199]
v_exp_f32 v214, v214
v_mfma_f32_16x16x32_bf16 v[196:199], v[228:231], v[44:47], v[196:199]
v_exp_f32 v215, v215
v_mfma_f32_16x16x32_bf16 v[200:203], v[224:227], v[72:75], v[200:203]
ds_read_b128 v[244:247], v248 offset:45568
v_cvt_pk_bf16_f32 v150, v212, v213
v_mfma_f32_16x16x32_bf16 v[200:203], v[228:231], v[76:79], v[200:203]
v_cvt_pk_bf16_f32 v151, v214, v215
v_mfma_f32_16x16x32_bf16 v[204:207], v[224:227], v[104:107], v[204:207]
v_exp_f32 v216, v216
v_mfma_f32_16x16x32_bf16 v[204:207], v[228:231], v[108:111], v[204:207]
s_waitcnt lgkmcnt(2)
v_mfma_f32_16x16x32_bf16 v[192:195], v[232:235], v[16:19], v[192:195]
ds_read_b128 v[224:227], v248 offset:34816
v_mfma_f32_16x16x32_bf16 v[192:195], v[236:239], v[20:23], v[192:195]
v_exp_f32 v217, v217
v_mfma_f32_16x16x32_bf16 v[196:199], v[232:235], v[48:51], v[196:199]
v_exp_f32 v218, v218
v_mfma_f32_16x16x32_bf16 v[196:199], v[236:239], v[52:55], v[196:199]
v_exp_f32 v219, v219
v_mfma_f32_16x16x32_bf16 v[200:203], v[232:235], v[80:83], v[200:203]
ds_read_b128 v[228:231], v248 offset:35328
v_cvt_pk_bf16_f32 v154, v216, v217
v_mfma_f32_16x16x32_bf16 v[200:203], v[236:239], v[84:87], v[200:203]
v_cvt_pk_bf16_f32 v155, v218, v219
v_mfma_f32_16x16x32_bf16 v[204:207], v[232:235], v[112:115], v[204:207]
v_exp_f32 v220, v220
v_mfma_f32_16x16x32_bf16 v[204:207], v[236:239], v[116:119], v[204:207]
s_waitcnt lgkmcnt(2)
v_mfma_f32_16x16x32_bf16 v[192:195], v[240:243], v[24:27], v[192:195]
ds_read_b128 v[232:235], v248 offset:38912
v_mfma_f32_16x16x32_bf16 v[192:195], v[244:247], v[28:31], v[192:195]
v_exp_f32 v221, v221
v_mfma_f32_16x16x32_bf16 v[196:199], v[240:243], v[56:59], v[196:199]
v_exp_f32 v222, v222
v_mfma_f32_16x16x32_bf16 v[196:199], v[244:247], v[60:63], v[196:199]
v_exp_f32 v223, v223
v_mfma_f32_16x16x32_bf16 v[200:203], v[240:243], v[88:91], v[200:203]
ds_read_b128 v[236:239], v248 offset:39424
v_cvt_pk_bf16_f32 v158, v220, v221
v_mfma_f32_16x16x32_bf16 v[200:203], v[244:247], v[92:95], v[200:203]
v_cvt_pk_bf16_f32 v159, v222, v223
v_mfma_f32_16x16x32_bf16 v[204:207], v[240:243], v[120:123], v[204:207]
v_mfma_f32_16x16x32_bf16 v[204:207], v[244:247], v[124:127], v[204:207]
s_waitcnt lgkmcnt(2)
v_mfma_f32_16x16x32_bf16 v[208:211], v[224:227], v[0:3], 0
ds_read_b128 v[240:243], v248 offset:43008
v_mfma_f32_16x16x32_bf16 v[208:211], v[228:231], v[4:7], v[208:211]
v_exp_f32 v192, v192
v_mfma_f32_16x16x32_bf16 v[212:215], v[224:227], v[32:35], 0
v_exp_f32 v193, v193
v_mfma_f32_16x16x32_bf16 v[212:215], v[228:231], v[36:39], v[212:215]
v_exp_f32 v194, v194
v_mfma_f32_16x16x32_bf16 v[216:219], v[224:227], v[64:67], 0
ds_read_b128 v[244:247], v248 offset:43520
v_cvt_pk_bf16_f32 v160, v192, v193
v_mfma_f32_16x16x32_bf16 v[216:219], v[228:231], v[68:71], v[216:219]
v_exp_f32 v195, v195
v_mfma_f32_16x16x32_bf16 v[220:223], v[224:227], v[96:99], 0
v_exp_f32 v196, v196
v_mfma_f32_16x16x32_bf16 v[220:223], v[228:231], v[100:103], v[220:223]
s_waitcnt lgkmcnt(2)
v_cvt_pk_bf16_f32 v161, v194, v195
v_mfma_f32_16x16x32_bf16 v[208:211], v[232:235], v[8:11], v[208:211]
ds_read_b128 v[224:227], v248 offset:47104
v_mfma_f32_16x16x32_bf16 v[208:211], v[236:239], v[12:15], v[208:211]
v_exp_f32 v197, v197
v_mfma_f32_16x16x32_bf16 v[212:215], v[232:235], v[40:43], v[212:215]
v_exp_f32 v198, v198
v_mfma_f32_16x16x32_bf16 v[212:215], v[236:239], v[44:47], v[212:215]
v_exp_f32 v199, v199
v_mfma_f32_16x16x32_bf16 v[216:219], v[232:235], v[72:75], v[216:219]
ds_read_b128 v[228:231], v248 offset:47616
v_cvt_pk_bf16_f32 v164, v196, v197
v_mfma_f32_16x16x32_bf16 v[216:219], v[236:239], v[76:79], v[216:219]
v_cvt_pk_bf16_f32 v165, v198, v199
v_mfma_f32_16x16x32_bf16 v[220:223], v[232:235], v[104:107], v[220:223]
v_exp_f32 v200, v200
v_mfma_f32_16x16x32_bf16 v[220:223], v[236:239], v[108:111], v[220:223]
s_waitcnt lgkmcnt(2)
s_waitcnt vmcnt(0)
s_barrier
v_mfma_f32_16x16x32_bf16 v[208:211], v[240:243], v[16:19], v[208:211]
ds_read_b128 v[232:235], v248 offset:49152
s_add_u32 s8, s6, 0x0
s_addc_u32 s9, s7, 0
v_mfma_f32_16x16x32_bf16 v[208:211], v[244:247], v[20:23], v[208:211]
v_exp_f32 v201, v201
s_mov_b32 s10, 0x4e2000
v_mfma_f32_16x16x32_bf16 v[212:215], v[240:243], v[48:51], v[212:215]
v_exp_f32 v202, v202
s_mov_b32 s11, 0x00020000
v_mfma_f32_16x16x32_bf16 v[212:215], v[244:247], v[52:55], v[212:215]
v_exp_f32 v203, v203
s_lshl_b32 s55, s34, 13
v_mfma_f32_16x16x32_bf16 v[216:219], v[240:243], v[80:83], v[216:219]
ds_read_b128 v[236:239], v248 offset:49664
v_cvt_pk_bf16_f32 v168, v200, v201
s_add_u32 s55, s55, 0x21000
v_mfma_f32_16x16x32_bf16 v[216:219], v[244:247], v[84:87], v[216:219]
v_cvt_pk_bf16_f32 v169, v202, v203
s_lshl_b32 s36, s34, 7
v_bfe_u32 v253, v252, 4, 3
v_mfma_f32_16x16x32_bf16 v[220:223], v[240:243], v[112:115], v[220:223]
v_exp_f32 v204, v204
v_lshrrev_b32 v254, 7, v252
v_mfma_f32_16x16x32_bf16 v[220:223], v[244:247], v[116:119], v[220:223]
s_waitcnt lgkmcnt(2)
v_xor_b32 v253, v253, v254
v_lshl_add_u32 v254, v254, 9, s36
v_mfma_f32_16x16x32_bf16 v[208:211], v[224:227], v[24:27], v[208:211]
ds_read_b128 v[240:243], v248 offset:53248
v_lshl_add_u32 v253, v253, 4, v254
s_add_u32 m0, s55, 0
v_mfma_f32_16x16x32_bf16 v[208:211], v[228:231], v[28:31], v[208:211]
v_exp_f32 v205, v205
s_add_u32 s35, s52, 0
v_mfma_f32_16x16x32_bf16 v[212:215], v[224:227], v[56:59], v[212:215]
v_exp_f32 v206, v206
buffer_load_dwordx4 v253, s[8:11], s35 offen lds
v_mfma_f32_16x16x32_bf16 v[212:215], v[228:231], v[60:63], v[212:215]
v_exp_f32 v207, v207
s_add_u32 m0, s55, 1024
v_mfma_f32_16x16x32_bf16 v[216:219], v[224:227], v[88:91], v[216:219]
ds_read_b128 v[244:247], v248 offset:53760
v_cvt_pk_bf16_f32 v172, v204, v205
s_add_u32 s35, s52, 4096
v_mfma_f32_16x16x32_bf16 v[216:219], v[228:231], v[92:95], v[216:219]
v_cvt_pk_bf16_f32 v173, v206, v207
buffer_load_dwordx4 v253, s[8:11], s35 offen lds
s_add_u32 m0, s55, 2048
v_mfma_f32_16x16x32_bf16 v[220:223], v[224:227], v[120:123], v[220:223]
s_add_u32 s35, s53, 0
buffer_load_dwordx4 v253, s[8:11], s35 offen lds
s_add_u32 m0, s55, 3072
v_mfma_f32_16x16x32_bf16 v[220:223], v[228:231], v[124:127], v[220:223]
s_waitcnt lgkmcnt(2)
s_add_u32 s35, s53, 4096
buffer_load_dwordx4 v253, s[8:11], s35 offen lds
v_mfma_f32_16x16x32_bf16 v[192:195], v[232:235], v[0:3], 0
ds_read_b128 v[224:227], v248 offset:57344
v_mfma_f32_16x16x32_bf16 v[192:195], v[236:239], v[4:7], v[192:195]
v_exp_f32 v208, v208
v_mfma_f32_16x16x32_bf16 v[196:199], v[232:235], v[32:35], 0
v_exp_f32 v209, v209
v_mfma_f32_16x16x32_bf16 v[196:199], v[236:239], v[36:39], v[196:199]
v_exp_f32 v210, v210
v_mfma_f32_16x16x32_bf16 v[200:203], v[232:235], v[64:67], 0
ds_read_b128 v[228:231], v248 offset:57856
v_cvt_pk_bf16_f32 v162, v208, v209
v_mfma_f32_16x16x32_bf16 v[200:203], v[236:239], v[68:71], v[200:203]
v_exp_f32 v211, v211
v_mfma_f32_16x16x32_bf16 v[204:207], v[232:235], v[96:99], 0
v_exp_f32 v212, v212
v_mfma_f32_16x16x32_bf16 v[204:207], v[236:239], v[100:103], v[204:207]
s_waitcnt lgkmcnt(2)
v_cvt_pk_bf16_f32 v163, v210, v211
v_mfma_f32_16x16x32_bf16 v[192:195], v[240:243], v[8:11], v[192:195]
ds_read_b128 v[232:235], v248 offset:61440
v_mfma_f32_16x16x32_bf16 v[192:195], v[244:247], v[12:15], v[192:195]
v_exp_f32 v213, v213
v_mfma_f32_16x16x32_bf16 v[196:199], v[240:243], v[40:43], v[196:199]
v_exp_f32 v214, v214
v_mfma_f32_16x16x32_bf16 v[196:199], v[244:247], v[44:47], v[196:199]
v_exp_f32 v215, v215
v_mfma_f32_16x16x32_bf16 v[200:203], v[240:243], v[72:75], v[200:203]
ds_read_b128 v[236:239], v248 offset:61952
v_cvt_pk_bf16_f32 v166, v212, v213
v_mfma_f32_16x16x32_bf16 v[200:203], v[244:247], v[76:79], v[200:203]
v_cvt_pk_bf16_f32 v167, v214, v215
v_mfma_f32_16x16x32_bf16 v[204:207], v[240:243], v[104:107], v[204:207]
v_exp_f32 v216, v216
v_mfma_f32_16x16x32_bf16 v[204:207], v[244:247], v[108:111], v[204:207]
s_waitcnt lgkmcnt(2)
v_mfma_f32_16x16x32_bf16 v[192:195], v[224:227], v[16:19], v[192:195]
ds_read_b128 v[240:243], v248 offset:51200
v_mfma_f32_16x16x32_bf16 v[192:195], v[228:231], v[20:23], v[192:195]
v_exp_f32 v217, v217
v_mfma_f32_16x16x32_bf16 v[196:199], v[224:227], v[48:51], v[196:199]
v_exp_f32 v218, v218
v_mfma_f32_16x16x32_bf16 v[196:199], v[228:231], v[52:55], v[196:199]
v_exp_f32 v219, v219
v_mfma_f32_16x16x32_bf16 v[200:203], v[224:227], v[80:83], v[200:203]
ds_read_b128 v[244:247], v248 offset:51712
v_cvt_pk_bf16_f32 v170, v216, v217
v_mfma_f32_16x16x32_bf16 v[200:203], v[228:231], v[84:87], v[200:203]
v_cvt_pk_bf16_f32 v171, v218, v219
v_mfma_f32_16x16x32_bf16 v[204:207], v[224:227], v[112:115], v[204:207]
v_exp_f32 v220, v220
v_mfma_f32_16x16x32_bf16 v[204:207], v[228:231], v[116:119], v[204:207]
s_waitcnt lgkmcnt(2)
v_mfma_f32_16x16x32_bf16 v[192:195], v[232:235], v[24:27], v[192:195]
ds_read_b128 v[224:227], v248 offset:55296
v_mfma_f32_16x16x32_bf16 v[192:195], v[236:239], v[28:31], v[192:195]
v_exp_f32 v221, v221
v_mfma_f32_16x16x32_bf16 v[196:199], v[232:235], v[56:59], v[196:199]
v_exp_f32 v222, v222
v_mfma_f32_16x16x32_bf16 v[196:199], v[236:239], v[60:63], v[196:199]
v_exp_f32 v223, v223
v_mfma_f32_16x16x32_bf16 v[200:203], v[232:235], v[88:91], v[200:203]
ds_read_b128 v[228:231], v248 offset:55808
v_cvt_pk_bf16_f32 v174, v220, v221
v_mfma_f32_16x16x32_bf16 v[200:203], v[236:239], v[92:95], v[200:203]
v_cvt_pk_bf16_f32 v175, v222, v223
v_mfma_f32_16x16x32_bf16 v[204:207], v[232:235], v[120:123], v[204:207]
v_mfma_f32_16x16x32_bf16 v[204:207], v[236:239], v[124:127], v[204:207]
s_waitcnt lgkmcnt(2)
v_mfma_f32_16x16x32_bf16 v[208:211], v[240:243], v[0:3], 0
ds_read_b128 v[232:235], v248 offset:59392
v_mfma_f32_16x16x32_bf16 v[208:211], v[244:247], v[4:7], v[208:211]
v_exp_f32 v192, v192
v_mfma_f32_16x16x32_bf16 v[212:215], v[240:243], v[32:35], 0
v_exp_f32 v193, v193
v_mfma_f32_16x16x32_bf16 v[212:215], v[244:247], v[36:39], v[212:215]
v_exp_f32 v194, v194
v_mfma_f32_16x16x32_bf16 v[216:219], v[240:243], v[64:67], 0
ds_read_b128 v[236:239], v248 offset:59904
v_cvt_pk_bf16_f32 v0, v192, v193
v_mfma_f32_16x16x32_bf16 v[216:219], v[244:247], v[68:71], v[216:219]
v_exp_f32 v195, v195
v_mfma_f32_16x16x32_bf16 v[220:223], v[240:243], v[96:99], 0
v_exp_f32 v196, v196
v_mfma_f32_16x16x32_bf16 v[220:223], v[244:247], v[100:103], v[220:223]
s_waitcnt lgkmcnt(2)
v_cvt_pk_bf16_f32 v1, v194, v195
v_mfma_f32_16x16x32_bf16 v[208:211], v[224:227], v[8:11], v[208:211]
ds_read_b128 v[240:243], v248 offset:63488
v_mfma_f32_16x16x32_bf16 v[208:211], v[228:231], v[12:15], v[208:211]
v_exp_f32 v197, v197
v_mfma_f32_16x16x32_bf16 v[212:215], v[224:227], v[40:43], v[212:215]
ds_read_b128 v[4:7], v255 offset:0
ds_read_b128 v[36:39], v255 offset:1024
v_mfma_f32_16x16x32_bf16 v[212:215], v[228:231], v[44:47], v[212:215]
v_exp_f32 v198, v198
v_mfma_f32_16x16x32_bf16 v[216:219], v[224:227], v[72:75], v[216:219]
ds_read_b128 v[244:247], v248 offset:64000
v_xor_b32 v12, 0x10000, v249
v_mfma_f32_16x16x32_bf16 v[216:219], v[228:231], v[76:79], v[216:219]
v_xor_b32 v13, 0x10000, v250
v_cvt_pk_bf16_f32 v32, v196, v197
v_mfma_f32_16x16x32_bf16 v[220:223], v[224:227], v[104:107], v[220:223]
ds_read_b128 v[68:71], v255 offset:2048
ds_read_b128 v[100:103], v255 offset:3072
v_mfma_f32_16x16x32_bf16 v[220:223], v[228:231], v[108:111], v[220:223]
s_waitcnt lgkmcnt(6)
v_mfma_f32_16x16x32_bf16 v[208:211], v[232:235], v[16:19], v[208:211]
ds_read_b64_tr_b16 v[224:225], v12 offset:0
ds_read_b64_tr_b16 v[226:227], v12 offset:2048
v_mfma_f32_16x16x32_bf16 v[208:211], v[236:239], v[20:23], v[208:211]
v_exp_f32 v199, v199
v_mfma_f32_16x16x32_bf16 v[212:215], v[232:235], v[48:51], v[212:215]
v_cvt_pk_bf16_f32 v33, v198, v199
v_mfma_f32_16x16x32_bf16 v[212:215], v[236:239], v[52:55], v[212:215]
v_exp_f32 v200, v200
v_mfma_f32_16x16x32_bf16 v[216:219], v[232:235], v[80:83], v[216:219]
ds_read_b64_tr_b16 v[228:229], v12 offset:16384
ds_read_b64_tr_b16 v[230:231], v12 offset:18432
v_mfma_f32_16x16x32_bf16 v[216:219], v[236:239], v[84:87], v[216:219]
v_exp_f32 v201, v201
v_mfma_f32_16x16x32_bf16 v[220:223], v[232:235], v[112:115], v[220:223]
v_exp_f32 v202, v202
v_mfma_f32_16x16x32_bf16 v[220:223], v[236:239], v[116:119], v[220:223]
s_waitcnt lgkmcnt(6)
v_cvt_pk_bf16_f32 v64, v200, v201
v_mfma_f32_16x16x32_bf16 v[208:211], v[240:243], v[24:27], v[208:211]
ds_read_b64_tr_b16 v[232:233], v13 offset:0
ds_read_b64_tr_b16 v[234:235], v13 offset:2048
v_mfma_f32_16x16x32_bf16 v[208:211], v[244:247], v[28:31], v[208:211]
v_exp_f32 v203, v203
v_mfma_f32_16x16x32_bf16 v[212:215], v[240:243], v[56:59], v[212:215]
v_cvt_pk_bf16_f32 v65, v202, v203
v_mfma_f32_16x16x32_bf16 v[212:215], v[244:247], v[60:63], v[212:215]
v_exp_f32 v204, v204
v_mfma_f32_16x16x32_bf16 v[216:219], v[240:243], v[88:91], v[216:219]
ds_read_b64_tr_b16 v[236:237], v13 offset:16384
ds_read_b64_tr_b16 v[238:239], v13 offset:18432
v_mfma_f32_16x16x32_bf16 v[216:219], v[244:247], v[92:95], v[216:219]
v_exp_f32 v205, v205
v_mfma_f32_16x16x32_bf16 v[220:223], v[240:243], v[120:123], v[220:223]
v_exp_f32 v206, v206
v_mfma_f32_16x16x32_bf16 v[220:223], v[244:247], v[124:127], v[220:223]
s_waitcnt lgkmcnt(4)
v_mfma_f32_16x16x32_bf16 a[0:3], v[224:227], v[128:131], a[0:3]
ds_read_b64_tr_b16 v[240:241], v249 offset:33280
ds_read_b64_tr_b16 v[242:243], v249 offset:35328
v_mfma_f32_16x16x32_bf16 a[0:3], v[228:231], v[144:147], a[0:3]
v_exp_f32 v207, v207
v_mfma_f32_16x16x32_bf16 a[4:7], v[224:227], v[132:135], a[4:7]
v_cvt_pk_bf16_f32 v96, v204, v205
v_cvt_pk_bf16_f32 v97, v206, v207
v_mfma_f32_16x16x32_bf16 a[4:7], v[228:231], v[148:151], a[4:7]
v_exp_f32 v208, v208
v_mfma_f32_16x16x32_bf16 a[8:11], v[224:227], v[136:139], a[8:11]
ds_read_b64_tr_b16 v[244:245], v249 offset:49664
ds_read_b64_tr_b16 v[246:247], v249 offset:51712
v_mfma_f32_16x16x32_bf16 a[8:11], v[228:231], v[152:155], a[8:11]
v_exp_f32 v209, v209
v_mfma_f32_16x16x32_bf16 a[12:15], v[224:227], v[140:143], a[12:15]
v_exp_f32 v210, v210
v_mfma_f32_16x16x32_bf16 a[12:15], v[228:231], v[156:159], a[12:15]
s_waitcnt lgkmcnt(4)
v_cvt_pk_bf16_f32 v2, v208, v209
v_mfma_f32_16x16x32_bf16 a[16:19], v[232:235], v[128:131], a[16:19]
ds_read_b64_tr_b16 v[224:225], v12 offset:512
ds_read_b64_tr_b16 v[226:227], v12 offset:2560
v_mfma_f32_16x16x32_bf16 a[16:19], v[236:239], v[144:147], a[16:19]
v_exp_f32 v211, v211
v_mfma_f32_16x16x32_bf16 a[20:23], v[232:235], v[132:135], a[20:23]
v_cvt_pk_bf16_f32 v3, v210, v211
v_mfma_f32_16x16x32_bf16 a[20:23], v[236:239], v[148:151], a[20:23]
v_exp_f32 v212, v212
v_mfma_f32_16x16x32_bf16 a[24:27], v[232:235], v[136:139], a[24:27]
ds_read_b64_tr_b16 v[228:229], v12 offset:16896
ds_read_b64_tr_b16 v[230:231], v12 offset:18944
v_mfma_f32_16x16x32_bf16 a[24:27], v[236:239], v[152:155], a[24:27]
v_exp_f32 v213, v213
v_mfma_f32_16x16x32_bf16 a[28:31], v[232:235], v[140:143], a[28:31]
v_exp_f32 v214, v214
v_mfma_f32_16x16x32_bf16 a[28:31], v[236:239], v[156:159], a[28:31]
s_waitcnt lgkmcnt(4)
v_cvt_pk_bf16_f32 v34, v212, v213
v_mfma_f32_16x16x32_bf16 a[32:35], v[240:243], v[4:7], a[32:35]
ds_read_b64_tr_b16 v[232:233], v250 offset:33280
ds_read_b64_tr_b16 v[234:235], v250 offset:35328
v_mfma_f32_16x16x32_bf16 a[32:35], v[244:247], v[176:179], a[32:35]
v_exp_f32 v215, v215
v_mfma_f32_16x16x32_bf16 a[36:39], v[240:243], v[36:39], a[36:39]
v_cvt_pk_bf16_f32 v35, v214, v215
v_mfma_f32_16x16x32_bf16 a[36:39], v[244:247], v[180:183], a[36:39]
v_exp_f32 v216, v216
v_mfma_f32_16x16x32_bf16 a[40:43], v[240:243], v[68:71], a[40:43]
ds_read_b64_tr_b16 v[236:237], v250 offset:49664
ds_read_b64_tr_b16 v[238:239], v250 offset:51712
v_mfma_f32_16x16x32_bf16 a[40:43], v[244:247], v[184:187], a[40:43]
v_exp_f32 v217, v217
v_mfma_f32_16x16x32_bf16 a[44:47], v[240:243], v[100:103], a[44:47]
v_exp_f32 v218, v218
v_mfma_f32_16x16x32_bf16 a[44:47], v[244:247], v[188:191], a[44:47]
s_waitcnt lgkmcnt(4)
v_cvt_pk_bf16_f32 v66, v216, v217
v_mfma_f32_16x16x32_bf16 a[32:35], v[224:227], v[128:131], a[32:35]
ds_read_b64_tr_b16 v[240:241], v12 offset:32768
ds_read_b64_tr_b16 v[242:243], v12 offset:34816
v_mfma_f32_16x16x32_bf16 a[32:35], v[228:231], v[144:147], a[32:35]
v_exp_f32 v219, v219
v_mfma_f32_16x16x32_bf16 a[36:39], v[224:227], v[132:135], a[36:39]
v_cvt_pk_bf16_f32 v67, v218, v219
v_mfma_f32_16x16x32_bf16 a[36:39], v[228:231], v[148:151], a[36:39]
v_exp_f32 v220, v220
v_mfma_f32_16x16x32_bf16 a[40:43], v[224:227], v[136:139], a[40:43]
ds_read_b64_tr_b16 v[244:245], v12 offset:49152
ds_read_b64_tr_b16 v[246:247], v12 offset:51200
v_mfma_f32_16x16x32_bf16 a[40:43], v[228:231], v[152:155], a[40:43]
v_exp_f32 v221, v221
v_mfma_f32_16x16x32_bf16 a[44:47], v[224:227], v[140:143], a[44:47]
v_exp_f32 v222, v222
v_mfma_f32_16x16x32_bf16 a[44:47], v[228:231], v[156:159], a[44:47]
s_waitcnt lgkmcnt(4)
v_cvt_pk_bf16_f32 v98, v220, v221
v_mfma_f32_16x16x32_bf16 a[48:51], v[232:235], v[4:7], a[48:51]
ds_read_b64_tr_b16 v[224:225], v13 offset:32768
ds_read_b64_tr_b16 v[226:227], v13 offset:34816
v_mfma_f32_16x16x32_bf16 a[48:51], v[236:239], v[176:179], a[48:51]
v_exp_f32 v223, v223
v_mfma_f32_16x16x32_bf16 a[52:55], v[232:235], v[36:39], a[52:55]
v_cvt_pk_bf16_f32 v99, v222, v223
v_mfma_f32_16x16x32_bf16 a[52:55], v[236:239], v[180:183], a[52:55]
v_mfma_f32_16x16x32_bf16 a[56:59], v[232:235], v[68:71], a[56:59]
ds_read_b64_tr_b16 v[228:229], v13 offset:49152
ds_read_b64_tr_b16 v[230:231], v13 offset:51200
v_mfma_f32_16x16x32_bf16 a[56:59], v[236:239], v[184:187], a[56:59]
v_mfma_f32_16x16x32_bf16 a[60:63], v[232:235], v[100:103], a[60:63]
v_mfma_f32_16x16x32_bf16 a[60:63], v[236:239], v[188:191], a[60:63]
s_waitcnt lgkmcnt(4)
v_mfma_f32_16x16x32_bf16 a[0:3], v[240:243], v[160:163], a[0:3]
ds_read_b64_tr_b16 v[232:233], v12 offset:33280
ds_read_b64_tr_b16 v[234:235], v12 offset:35328
v_mfma_f32_16x16x32_bf16 a[0:3], v[244:247], v[0:3], a[0:3]
v_mfma_f32_16x16x32_bf16 a[4:7], v[240:243], v[164:167], a[4:7]
v_mfma_f32_16x16x32_bf16 a[4:7], v[244:247], v[32:35], a[4:7]
v_mfma_f32_16x16x32_bf16 a[8:11], v[240:243], v[168:171], a[8:11]
ds_read_b64_tr_b16 v[236:237], v12 offset:49664
ds_read_b64_tr_b16 v[238:239], v12 offset:51712
v_mfma_f32_16x16x32_bf16 a[8:11], v[244:247], v[64:67], a[8:11]
v_mfma_f32_16x16x32_bf16 a[12:15], v[240:243], v[172:175], a[12:15]
v_mfma_f32_16x16x32_bf16 a[12:15], v[244:247], v[96:99], a[12:15]
s_waitcnt lgkmcnt(4)
v_mfma_f32_16x16x32_bf16 a[16:19], v[224:227], v[160:163], a[16:19]
ds_read_b64_tr_b16 v[240:241], v13 offset:512
ds_read_b64_tr_b16 v[242:243], v13 offset:2560
v_mfma_f32_16x16x32_bf16 a[16:19], v[228:231], v[0:3], a[16:19]
v_mfma_f32_16x16x32_bf16 a[20:23], v[224:227], v[164:167], a[20:23]
v_mfma_f32_16x16x32_bf16 a[20:23], v[228:231], v[32:35], a[20:23]
v_mfma_f32_16x16x32_bf16 a[24:27], v[224:227], v[168:171], a[24:27]
ds_read_b64_tr_b16 v[244:245], v13 offset:16896
ds_read_b64_tr_b16 v[246:247], v13 offset:18944
v_accvgpr_read_b32 v192, a0
v_mfma_f32_16x16x32_bf16 a[24:27], v[228:231], v[64:67], a[24:27]
v_accvgpr_read_b32 v193, a4
v_accvgpr_read_b32 v194, a8
v_accvgpr_read_b32 v195, a12
v_mfma_f32_16x16x32_bf16 a[28:31], v[224:227], v[172:175], a[28:31]
v_lshlrev_b32 v253, 2, v252
v_subrev_u32 v196, 0x0d800000, v192
v_subrev_u32 v197, 0x0d800000, v193
v_mfma_f32_16x16x32_bf16 a[28:31], v[228:231], v[96:99], a[28:31]
s_waitcnt lgkmcnt(4)
v_subrev_u32 v198, 0x0d800000, v194
v_subrev_u32 v199, 0x0d800000, v195
v_mfma_f32_16x16x32_bf16 a[32:35], v[232:235], v[160:163], a[32:35]
ds_read_b64_tr_b16 v[224:225], v13 offset:33280
ds_read_b64_tr_b16 v[226:227], v13 offset:35328
v_max3_u32 v254, v196, v197, v198
v_mfma_f32_16x16x32_bf16 a[32:35], v[236:239], v[0:3], a[32:35]
v_max_u32 v254, v254, v199
v_mfma_f32_16x16x32_bf16 a[36:39], v[232:235], v[164:167], a[36:39]
s_mov_b64 exec, 0xffff
s_xor_b32 s35, s48, 0
buffer_store_dword v192, v253, s[24:27], s35 offen offset:4 sc1
s_xor_b32 s35, s48, 1024
buffer_store_dword v193, v253, s[24:27], s35 offen offset:4 sc1
s_xor_b32 s35, s48, 2048
buffer_store_dword v194, v253, s[24:27], s35 offen offset:4 sc1
s_xor_b32 s35, s48, 3072
buffer_store_dword v195, v253, s[24:27], s35 offen offset:4 sc1
v_cmp_le_u32 vcc, 0x64000000, v254
s_mov_b64 exec, -1
v_mfma_f32_16x16x32_bf16 a[36:39], v[236:239], v[32:35], a[36:39]
v_accvgpr_read_b32 v192, a0
v_accvgpr_read_b32 v193, a1
v_mfma_f32_16x16x32_bf16 a[40:43], v[232:235], v[168:171], a[40:43]
ds_read_b64_tr_b16 v[228:229], v13 offset:49664
ds_read_b64_tr_b16 v[230:231], v13 offset:51712
v_mfma_f32_16x16x32_bf16 a[40:43], v[236:239], v[64:67], a[40:43]
v_accvgpr_read_b32 v194, a2
v_accvgpr_read_b32 v195, a3
v_mfma_f32_16x16x32_bf16 a[44:47], v[232:235], v[172:175], a[44:47]
v_cvt_pk_bf16_f32 v16, v192, v193
v_cvt_pk_bf16_f32 v17, v194, v195
v_mfma_f32_16x16x32_bf16 a[44:47], v[236:239], v[96:99], a[44:47]
s_waitcnt lgkmcnt(4)
v_accvgpr_read_b32 v200, a4
v_mfma_f32_16x16x32_bf16 a[48:51], v[240:243], v[128:131], a[48:51]
ds_read_b64_tr_b16 v[232:233], v249 offset:36864
ds_read_b64_tr_b16 v[234:235], v249 offset:38912
v_mfma_f32_16x16x32_bf16 a[48:51], v[244:247], v[144:147], a[48:51]
v_accvgpr_read_b32 v201, a5
v_accvgpr_read_b32 v202, a6
v_mfma_f32_16x16x32_bf16 a[52:55], v[240:243], v[132:135], a[52:55]
v_accvgpr_read_b32 v203, a7
v_cvt_pk_bf16_f32 v48, v200, v201
v_mfma_f32_16x16x32_bf16 a[52:55], v[244:247], v[148:151], a[52:55]
v_cvt_pk_bf16_f32 v49, v202, v203
v_accvgpr_read_b32 v208, a8
v_mfma_f32_16x16x32_bf16 a[56:59], v[240:243], v[136:139], a[56:59]
ds_read_b64_tr_b16 v[236:237], v249 offset:53248
ds_read_b64_tr_b16 v[238:239], v249 offset:55296
v_mfma_f32_16x16x32_bf16 a[56:59], v[244:247], v[152:155], a[56:59]
v_accvgpr_read_b32 v209, a9
v_accvgpr_read_b32 v210, a10
v_mfma_f32_16x16x32_bf16 a[60:63], v[240:243], v[140:143], a[60:63]
v_accvgpr_read_b32 v211, a11
v_cvt_pk_bf16_f32 v80, v208, v209
v_mfma_f32_16x16x32_bf16 a[60:63], v[244:247], v[156:159], a[60:63]
s_waitcnt lgkmcnt(4)
v_cvt_pk_bf16_f32 v81, v210, v211
v_mfma_f32_16x16x32_bf16 a[48:51], v[224:227], v[160:163], a[48:51]
ds_read_b64_tr_b16 v[240:241], v12 offset:4096
ds_read_b64_tr_b16 v[242:243], v12 offset:6144
v_mfma_f32_16x16x32_bf16 a[48:51], v[228:231], v[0:3], a[48:51]
v_accvgpr_read_b32 v216, a12
v_accvgpr_read_b32 v217, a13
v_mfma_f32_16x16x32_bf16 a[52:55], v[224:227], v[164:167], a[52:55]
v_accvgpr_read_b32 v218, a14
v_accvgpr_read_b32 v219, a15
v_mfma_f32_16x16x32_bf16 a[52:55], v[228:231], v[32:35], a[52:55]
v_cvt_pk_bf16_f32 v112, v216, v217
v_cvt_pk_bf16_f32 v113, v218, v219
v_mfma_f32_16x16x32_bf16 a[56:59], v[224:227], v[168:171], a[56:59]
ds_read_b64_tr_b16 v[244:245], v12 offset:20480
ds_read_b64_tr_b16 v[246:247], v12 offset:22528
v_mfma_f32_16x16x32_bf16 a[56:59], v[228:231], v[64:67], a[56:59]
v_accvgpr_read_b32 v196, a16
v_accvgpr_read_b32 v197, a17
v_mfma_f32_16x16x32_bf16 a[60:63], v[224:227], v[172:175], a[60:63]
v_accvgpr_read_b32 v198, a18
v_accvgpr_read_b32 v199, a19
v_mfma_f32_16x16x32_bf16 a[60:63], v[228:231], v[96:99], a[60:63]
s_waitcnt lgkmcnt(4)
v_cvt_pk_bf16_f32 v18, v196, v197
v_mfma_f32_16x16x32_bf16 a[64:67], v[232:235], v[4:7], a[64:67]
ds_read_b64_tr_b16 v[224:225], v12 offset:36864
ds_read_b64_tr_b16 v[226:227], v12 offset:38912
v_mfma_f32_16x16x32_bf16 a[64:67], v[236:239], v[176:179], a[64:67]
v_cvt_pk_bf16_f32 v19, v198, v199
buffer_store_dwordx4 v[16:19], v252, s[20:23], s40 offen offset:0 sc1
v_mfma_f32_16x16x32_bf16 a[68:71], v[232:235], v[36:39], a[68:71]
ds_write_b128 v255, v[16:19] offset:0
v_accvgpr_read_b32 v204, a20
v_mfma_f32_16x16x32_bf16 a[68:71], v[236:239], v[180:183], a[68:71]
v_accvgpr_read_b32 v205, a21
v_accvgpr_read_b32 v206, a22
v_mfma_f32_16x16x32_bf16 a[72:75], v[232:235], v[68:71], a[72:75]
ds_read_b64_tr_b16 v[228:229], v12 offset:53248
ds_read_b64_tr_b16 v[230:231], v12 offset:55296
v_mfma_f32_16x16x32_bf16 a[72:75], v[236:239], v[184:187], a[72:75]
v_accvgpr_read_b32 v207, a23
v_cvt_pk_bf16_f32 v50, v204, v205
v_mfma_f32_16x16x32_bf16 a[76:79], v[232:235], v[100:103], a[76:79]
v_cvt_pk_bf16_f32 v51, v206, v207
buffer_store_dwordx4 v[48:51], v252, s[20:23], s41 offen offset:0 sc1
v_mfma_f32_16x16x32_bf16 a[76:79], v[236:239], v[188:191], a[76:79]
s_waitcnt lgkmcnt(5)
v_accvgpr_read_b32 v212, a24
v_mfma_f32_16x16x32_bf16 a[64:67], v[240:243], v[128:131], a[64:67]
ds_read_b64_tr_b16 v[232:233], v250 offset:36864
ds_read_b64_tr_b16 v[234:235], v250 offset:38912
v_mfma_f32_16x16x32_bf16 a[64:67], v[244:247], v[144:147], a[64:67]
v_accvgpr_read_b32 v213, a25
v_accvgpr_read_b32 v214, a26
v_mfma_f32_16x16x32_bf16 a[68:71], v[240:243], v[132:135], a[68:71]
v_accvgpr_read_b32 v215, a27
v_cvt_pk_bf16_f32 v82, v212, v213
v_mfma_f32_16x16x32_bf16 a[68:71], v[244:247], v[148:151], a[68:71]
v_cvt_pk_bf16_f32 v83, v214, v215
buffer_store_dwordx4 v[80:83], v252, s[20:23], s42 offen offset:0 sc1
v_mfma_f32_16x16x32_bf16 a[72:75], v[240:243], v[136:139], a[72:75]
ds_read_b64_tr_b16 v[236:237], v250 offset:53248
ds_read_b64_tr_b16 v[238:239], v250 offset:55296
v_mfma_f32_16x16x32_bf16 a[72:75], v[244:247], v[152:155], a[72:75]
v_accvgpr_read_b32 v220, a28
v_accvgpr_read_b32 v221, a29
v_mfma_f32_16x16x32_bf16 a[76:79], v[240:243], v[140:143], a[76:79]
v_accvgpr_read_b32 v222, a30
v_accvgpr_read_b32 v223, a31
v_mfma_f32_16x16x32_bf16 a[76:79], v[244:247], v[156:159], a[76:79]
s_waitcnt lgkmcnt(4)
v_cvt_pk_bf16_f32 v114, v220, v221
v_mfma_f32_16x16x32_bf16 a[64:67], v[224:227], v[160:163], a[64:67]
ds_read_b64_tr_b16 v[240:241], v13 offset:4096
ds_read_b64_tr_b16 v[242:243], v13 offset:6144
v_mfma_f32_16x16x32_bf16 a[64:67], v[228:231], v[0:3], a[64:67]
v_cvt_pk_bf16_f32 v115, v222, v223
buffer_store_dwordx4 v[112:115], v252, s[20:23], s43 offen offset:0 sc1
v_mfma_f32_16x16x32_bf16 a[68:71], v[224:227], v[164:167], a[68:71]
v_accvgpr_read_b32 v192, a32
v_accvgpr_read_b32 v193, a33
v_mfma_f32_16x16x32_bf16 a[68:71], v[228:231], v[32:35], a[68:71]
v_accvgpr_read_b32 v194, a34
v_accvgpr_read_b32 v195, a35
v_mfma_f32_16x16x32_bf16 a[72:75], v[224:227], v[168:171], a[72:75]
ds_read_b64_tr_b16 v[244:245], v13 offset:20480
ds_read_b64_tr_b16 v[246:247], v13 offset:22528
v_mfma_f32_16x16x32_bf16 a[72:75], v[228:231], v[64:67], a[72:75]
v_cvt_pk_bf16_f32 v20, v192, v193
v_cvt_pk_bf16_f32 v21, v194, v195
v_mfma_f32_16x16x32_bf16 a[76:79], v[224:227], v[172:175], a[76:79]
v_accvgpr_read_b32 v200, a36
v_accvgpr_read_b32 v201, a37
v_mfma_f32_16x16x32_bf16 a[76:79], v[228:231], v[96:99], a[76:79]
s_waitcnt lgkmcnt(4)
v_accvgpr_read_b32 v202, a38
v_mfma_f32_16x16x32_bf16 a[80:83], v[232:235], v[4:7], a[80:83]
ds_read_b64_tr_b16 v[224:225], v13 offset:36864
ds_read_b64_tr_b16 v[226:227], v13 offset:38912
v_mfma_f32_16x16x32_bf16 a[80:83], v[236:239], v[176:179], a[80:83]
v_accvgpr_read_b32 v203, a39
v_cvt_pk_bf16_f32 v52, v200, v201
v_mfma_f32_16x16x32_bf16 a[84:87], v[232:235], v[36:39], a[84:87]
v_cvt_pk_bf16_f32 v53, v202, v203
v_accvgpr_read_b32 v208, a40
v_mfma_f32_16x16x32_bf16 a[84:87], v[236:239], v[180:183], a[84:87]
v_accvgpr_read_b32 v209, a41
v_accvgpr_read_b32 v210, a42
v_mfma_f32_16x16x32_bf16 a[88:91], v[232:235], v[68:71], a[88:91]
ds_read_b64_tr_b16 v[228:229], v13 offset:53248
ds_read_b64_tr_b16 v[230:231], v13 offset:55296
v_mfma_f32_16x16x32_bf16 a[88:91], v[236:239], v[184:187], a[88:91]
v_accvgpr_read_b32 v211, a43
v_cvt_pk_bf16_f32 v84, v208, v209
v_mfma_f32_16x16x32_bf16 a[92:95], v[232:235], v[100:103], a[92:95]
v_cvt_pk_bf16_f32 v85, v210, v211
v_accvgpr_read_b32 v216, a44
v_mfma_f32_16x16x32_bf16 a[92:95], v[236:239], v[188:191], a[92:95]
s_waitcnt lgkmcnt(4)
v_accvgpr_read_b32 v217, a45
v_mfma_f32_16x16x32_bf16 a[80:83], v[240:243], v[128:131], a[80:83]
ds_read_b64_tr_b16 v[232:233], v249 offset:37376
ds_read_b64_tr_b16 v[234:235], v249 offset:39424
v_mfma_f32_16x16x32_bf16 a[80:83], v[244:247], v[144:147], a[80:83]
v_accvgpr_read_b32 v218, a46
v_accvgpr_read_b32 v219, a47
v_mfma_f32_16x16x32_bf16 a[84:87], v[240:243], v[132:135], a[84:87]
v_cvt_pk_bf16_f32 v116, v216, v217
v_cvt_pk_bf16_f32 v117, v218, v219
v_mfma_f32_16x16x32_bf16 a[84:87], v[244:247], v[148:151], a[84:87]
v_accvgpr_read_b32 v196, a48
v_accvgpr_read_b32 v197, a49
v_mfma_f32_16x16x32_bf16 a[88:91], v[240:243], v[136:139], a[88:91]
ds_read_b64_tr_b16 v[236:237], v249 offset:53760
ds_read_b64_tr_b16 v[238:239], v249 offset:55808
v_mfma_f32_16x16x32_bf16 a[88:91], v[244:247], v[152:155], a[88:91]
v_accvgpr_read_b32 v198, a50
v_accvgpr_read_b32 v199, a51
v_mfma_f32_16x16x32_bf16 a[92:95], v[240:243], v[140:143], a[92:95]
v_cvt_pk_bf16_f32 v22, v196, v197
v_cvt_pk_bf16_f32 v23, v198, v199
v_mfma_f32_16x16x32_bf16 a[92:95], v[244:247], v[156:159], a[92:95]
s_waitcnt lgkmcnt(4)
buffer_store_dwordx4 v[20:23], v252, s[20:23], s40 offen offset:1024 sc1
v_mfma_f32_16x16x32_bf16 a[80:83], v[224:227], v[160:163], a[80:83]
ds_read_b64_tr_b16 v[240:241], v12 offset:4608
ds_read_b64_tr_b16 v[242:243], v12 offset:6656
v_mfma_f32_16x16x32_bf16 a[80:83], v[228:231], v[0:3], a[80:83]
ds_write_b128 v255, v[20:23] offset:1024
v_accvgpr_read_b32 v204, a52
v_mfma_f32_16x16x32_bf16 a[84:87], v[224:227], v[164:167], a[84:87]
v_accvgpr_read_b32 v205, a53
v_accvgpr_read_b32 v206, a54
v_mfma_f32_16x16x32_bf16 a[84:87], v[228:231], v[32:35], a[84:87]
v_accvgpr_read_b32 v207, a55
v_cvt_pk_bf16_f32 v54, v204, v205
v_mfma_f32_16x16x32_bf16 a[88:91], v[224:227], v[168:171], a[88:91]
ds_read_b64_tr_b16 v[244:245], v12 offset:20992
ds_read_b64_tr_b16 v[246:247], v12 offset:23040
v_mfma_f32_16x16x32_bf16 a[88:91], v[228:231], v[64:67], a[88:91]
v_cvt_pk_bf16_f32 v55, v206, v207
buffer_store_dwordx4 v[52:55], v252, s[20:23], s41 offen offset:1024 sc1
v_mfma_f32_16x16x32_bf16 a[92:95], v[224:227], v[172:175], a[92:95]
v_accvgpr_read_b32 v212, a56
v_accvgpr_read_b32 v213, a57
v_mfma_f32_16x16x32_bf16 a[92:95], v[228:231], v[96:99], a[92:95]
s_waitcnt lgkmcnt(5)
v_accvgpr_read_b32 v214, a58
v_mfma_f32_16x16x32_bf16 a[96:99], v[232:235], v[4:7], a[96:99]
ds_read_b64_tr_b16 v[224:225], v12 offset:37376
ds_read_b64_tr_b16 v[226:227], v12 offset:39424
v_mfma_f32_16x16x32_bf16 a[96:99], v[236:239], v[176:179], a[96:99]
v_accvgpr_read_b32 v215, a59
v_cvt_pk_bf16_f32 v86, v212, v213
v_mfma_f32_16x16x32_bf16 a[100:103], v[232:235], v[36:39], a[100:103]
v_cvt_pk_bf16_f32 v87, v214, v215
buffer_store_dwordx4 v[84:87], v252, s[20:23], s42 offen offset:1024 sc1
v_mfma_f32_16x16x32_bf16 a[100:103], v[236:239], v[180:183], a[100:103]
v_accvgpr_read_b32 v220, a60
v_accvgpr_read_b32 v221, a61
v_mfma_f32_16x16x32_bf16 a[104:107], v[232:235], v[68:71], a[104:107]
ds_read_b64_tr_b16 v[228:229], v12 offset:53760
ds_read_b64_tr_b16 v[230:231], v12 offset:55808
v_mfma_f32_16x16x32_bf16 a[104:107], v[236:239], v[184:187], a[104:107]
v_accvgpr_read_b32 v222, a62
v_accvgpr_read_b32 v223, a63
v_mfma_f32_16x16x32_bf16 a[108:111], v[232:235], v[100:103], a[108:111]
v_cvt_pk_bf16_f32 v118, v220, v221
v_cvt_pk_bf16_f32 v119, v222, v223
v_mfma_f32_16x16x32_bf16 a[108:111], v[236:239], v[188:191], a[108:111]
s_waitcnt lgkmcnt(4)
buffer_store_dwordx4 v[116:119], v252, s[20:23], s43 offen offset:1024 sc1
v_mfma_f32_16x16x32_bf16 a[96:99], v[240:243], v[128:131], a[96:99]
ds_read_b64_tr_b16 v[232:233], v250 offset:37376
ds_read_b64_tr_b16 v[234:235], v250 offset:39424
v_mfma_f32_16x16x32_bf16 a[96:99], v[244:247], v[144:147], a[96:99]
v_accvgpr_read_b32 v192, a64
v_accvgpr_read_b32 v193, a65
v_mfma_f32_16x16x32_bf16 a[100:103], v[240:243], v[132:135], a[100:103]
v_accvgpr_read_b32 v194, a66
v_accvgpr_read_b32 v195, a67
v_mfma_f32_16x16x32_bf16 a[100:103], v[244:247], v[148:151], a[100:103]
v_cvt_pk_bf16_f32 v24, v192, v193
v_cvt_pk_bf16_f32 v25, v194, v195
v_mfma_f32_16x16x32_bf16 a[104:107], v[240:243], v[136:139], a[104:107]
ds_read_b64_tr_b16 v[236:237], v250 offset:53760
ds_read_b64_tr_b16 v[238:239], v250 offset:55808
v_mfma_f32_16x16x32_bf16 a[104:107], v[244:247], v[152:155], a[104:107]
v_accvgpr_read_b32 v200, a68
v_accvgpr_read_b32 v201, a69
v_mfma_f32_16x16x32_bf16 a[108:111], v[240:243], v[140:143], a[108:111]
v_accvgpr_read_b32 v202, a70
v_accvgpr_read_b32 v203, a71
v_mfma_f32_16x16x32_bf16 a[108:111], v[244:247], v[156:159], a[108:111]
s_waitcnt lgkmcnt(4)
v_cvt_pk_bf16_f32 v56, v200, v201
v_mfma_f32_16x16x32_bf16 a[96:99], v[224:227], v[160:163], a[96:99]
ds_read_b64_tr_b16 v[240:241], v13 offset:4608
ds_read_b64_tr_b16 v[242:243], v13 offset:6656
v_mfma_f32_16x16x32_bf16 a[96:99], v[228:231], v[0:3], a[96:99]
v_cvt_pk_bf16_f32 v57, v202, v203
v_accvgpr_read_b32 v208, a72
v_mfma_f32_16x16x32_bf16 a[100:103], v[224:227], v[164:167], a[100:103]
v_accvgpr_read_b32 v209, a73
v_accvgpr_read_b32 v210, a74
v_mfma_f32_16x16x32_bf16 a[100:103], v[228:231], v[32:35], a[100:103]
v_accvgpr_read_b32 v211, a75
v_cvt_pk_bf16_f32 v88, v208, v209
v_mfma_f32_16x16x32_bf16 a[104:107], v[224:227], v[168:171], a[104:107]
ds_read_b64_tr_b16 v[244:245], v13 offset:20992
ds_read_b64_tr_b16 v[246:247], v13 offset:23040
v_mfma_f32_16x16x32_bf16 a[104:107], v[228:231], v[64:67], a[104:107]
v_cvt_pk_bf16_f32 v89, v210, v211
v_accvgpr_read_b32 v216, a76
v_mfma_f32_16x16x32_bf16 a[108:111], v[224:227], v[172:175], a[108:111]
v_accvgpr_read_b32 v217, a77
v_accvgpr_read_b32 v218, a78
v_mfma_f32_16x16x32_bf16 a[108:111], v[228:231], v[96:99], a[108:111]
s_waitcnt lgkmcnt(4)
v_accvgpr_read_b32 v219, a79
v_mfma_f32_16x16x32_bf16 a[112:115], v[232:235], v[4:7], a[112:115]
ds_read_b64_tr_b16 v[224:225], v13 offset:37376
ds_read_b64_tr_b16 v[226:227], v13 offset:39424
v_mfma_f32_16x16x32_bf16 a[112:115], v[236:239], v[176:179], a[112:115]
v_cvt_pk_bf16_f32 v120, v216, v217
v_cvt_pk_bf16_f32 v121, v218, v219
v_mfma_f32_16x16x32_bf16 a[116:119], v[232:235], v[36:39], a[116:119]
v_accvgpr_read_b32 v196, a80
v_accvgpr_read_b32 v197, a81
v_mfma_f32_16x16x32_bf16 a[116:119], v[236:239], v[180:183], a[116:119]
v_accvgpr_read_b32 v198, a82
v_accvgpr_read_b32 v199, a83
v_mfma_f32_16x16x32_bf16 a[120:123], v[232:235], v[68:71], a[120:123]
ds_read_b64_tr_b16 v[228:229], v13 offset:53760
ds_read_b64_tr_b16 v[230:231], v13 offset:55808
v_mfma_f32_16x16x32_bf16 a[120:123], v[236:239], v[184:187], a[120:123]
v_cvt_pk_bf16_f32 v26, v196, v197
v_cvt_pk_bf16_f32 v27, v198, v199
v_mfma_f32_16x16x32_bf16 a[124:127], v[232:235], v[100:103], a[124:127]
buffer_store_dwordx4 v[24:27], v252, s[20:23], s40 offen offset:2048 sc1
ds_write_b128 v255, v[24:27] offset:2048
v_mfma_f32_16x16x32_bf16 a[124:127], v[236:239], v[188:191], a[124:127]
s_waitcnt lgkmcnt(5)
v_accvgpr_read_b32 v204, a84
v_mfma_f32_16x16x32_bf16 a[112:115], v[240:243], v[128:131], a[112:115]
ds_read_b64_tr_b16 v[232:233], v249 offset:40960
ds_read_b64_tr_b16 v[234:235], v249 offset:43008
v_mfma_f32_16x16x32_bf16 a[112:115], v[244:247], v[144:147], a[112:115]
v_accvgpr_read_b32 v205, a85
v_accvgpr_read_b32 v206, a86
v_mfma_f32_16x16x32_bf16 a[116:119], v[240:243], v[132:135], a[116:119]
v_accvgpr_read_b32 v207, a87
v_cvt_pk_bf16_f32 v58, v204, v205
v_mfma_f32_16x16x32_bf16 a[116:119], v[244:247], v[148:151], a[116:119]
v_cvt_pk_bf16_f32 v59, v206, v207
buffer_store_dwordx4 v[56:59], v252, s[20:23], s41 offen offset:2048 sc1
v_mfma_f32_16x16x32_bf16 a[120:123], v[240:243], v[136:139], a[120:123]
ds_read_b64_tr_b16 v[236:237], v249 offset:57344
ds_read_b64_tr_b16 v[238:239], v249 offset:59392
v_mfma_f32_16x16x32_bf16 a[120:123], v[244:247], v[152:155], a[120:123]
v_accvgpr_read_b32 v212, a88
v_accvgpr_read_b32 v213, a89
v_mfma_f32_16x16x32_bf16 a[124:127], v[240:243], v[140:143], a[124:127]
v_accvgpr_read_b32 v214, a90
v_accvgpr_read_b32 v215, a91
v_mfma_f32_16x16x32_bf16 a[124:127], v[244:247], v[156:159], a[124:127]
s_waitcnt lgkmcnt(5)
v_cvt_pk_bf16_f32 v90, v212, v213
v_mfma_f32_16x16x32_bf16 a[112:115], v[224:227], v[160:163], a[112:115]
ds_read_b64_tr_b16 v[240:241], v12 offset:8192
ds_read_b64_tr_b16 v[242:243], v12 offset:10240
v_mfma_f32_16x16x32_bf16 a[112:115], v[228:231], v[0:3], a[112:115]
v_cvt_pk_bf16_f32 v91, v214, v215
buffer_store_dwordx4 v[88:91], v252, s[20:23], s42 offen offset:2048 sc1
v_mfma_f32_16x16x32_bf16 a[116:119], v[224:227], v[164:167], a[116:119]
v_accvgpr_read_b32 v220, a92
v_accvgpr_read_b32 v221, a93
v_mfma_f32_16x16x32_bf16 a[116:119], v[228:231], v[32:35], a[116:119]
v_accvgpr_read_b32 v222, a94
v_accvgpr_read_b32 v223, a95
v_mfma_f32_16x16x32_bf16 a[120:123], v[224:227], v[168:171], a[120:123]
ds_read_b64_tr_b16 v[244:245], v12 offset:24576
ds_read_b64_tr_b16 v[246:247], v12 offset:26624
v_mfma_f32_16x16x32_bf16 a[120:123], v[228:231], v[64:67], a[120:123]
v_cvt_pk_bf16_f32 v122, v220, v221
v_cvt_pk_bf16_f32 v123, v222, v223
v_mfma_f32_16x16x32_bf16 a[124:127], v[224:227], v[172:175], a[124:127]
buffer_store_dwordx4 v[120:123], v252, s[20:23], s43 offen offset:2048 sc1
v_accvgpr_read_b32 v192, a96
v_mfma_f32_16x16x32_bf16 a[124:127], v[228:231], v[96:99], a[124:127]
s_waitcnt lgkmcnt(4)
v_accvgpr_read_b32 v193, a97
v_mfma_f32_16x16x32_bf16 a[128:131], v[232:235], v[4:7], a[128:131]
ds_read_b64_tr_b16 v[224:225], v12 offset:40960
ds_read_b64_tr_b16 v[226:227], v12 offset:43008
v_mfma_f32_16x16x32_bf16 a[128:131], v[236:239], v[176:179], a[128:131]
v_accvgpr_read_b32 v194, a98
v_accvgpr_read_b32 v195, a99
v_mfma_f32_16x16x32_bf16 a[132:135], v[232:235], v[36:39], a[132:135]
v_cvt_pk_bf16_f32 v28, v192, v193
v_cvt_pk_bf16_f32 v29, v194, v195
v_mfma_f32_16x16x32_bf16 a[132:135], v[236:239], v[180:183], a[132:135]
v_accvgpr_read_b32 v200, a100
v_accvgpr_read_b32 v201, a101
v_mfma_f32_16x16x32_bf16 a[136:139], v[232:235], v[68:71], a[136:139]
ds_read_b64_tr_b16 v[228:229], v12 offset:57344
ds_read_b64_tr_b16 v[230:231], v12 offset:59392
v_mfma_f32_16x16x32_bf16 a[136:139], v[236:239], v[184:187], a[136:139]
v_accvgpr_read_b32 v202, a102
v_accvgpr_read_b32 v203, a103
v_mfma_f32_16x16x32_bf16 a[140:143], v[232:235], v[100:103], a[140:143]
v_cvt_pk_bf16_f32 v60, v200, v201
v_cvt_pk_bf16_f32 v61, v202, v203
v_mfma_f32_16x16x32_bf16 a[140:143], v[236:239], v[188:191], a[140:143]
s_waitcnt lgkmcnt(4)
v_accvgpr_read_b32 v208, a104
v_mfma_f32_16x16x32_bf16 a[128:131], v[240:243], v[128:131], a[128:131]
ds_read_b64_tr_b16 v[232:233], v250 offset:40960
ds_read_b64_tr_b16 v[234:235], v250 offset:43008
v_mfma_f32_16x16x32_bf16 a[128:131], v[244:247], v[144:147], a[128:131]
v_accvgpr_read_b32 v209, a105
v_accvgpr_read_b32 v210, a106
v_mfma_f32_16x16x32_bf16 a[132:135], v[240:243], v[132:135], a[132:135]
v_accvgpr_read_b32 v211, a107
v_cvt_pk_bf16_f32 v92, v208, v209
v_mfma_f32_16x16x32_bf16 a[132:135], v[244:247], v[148:151], a[132:135]
v_cvt_pk_bf16_f32 v93, v210, v211
v_accvgpr_read_b32 v216, a108
v_mfma_f32_16x16x32_bf16 a[136:139], v[240:243], v[136:139], a[136:139]
ds_read_b64_tr_b16 v[236:237], v250 offset:57344
ds_read_b64_tr_b16 v[238:239], v250 offset:59392
v_mfma_f32_16x16x32_bf16 a[136:139], v[244:247], v[152:155], a[136:139]
v_accvgpr_read_b32 v217, a109
v_accvgpr_read_b32 v218, a110
v_mfma_f32_16x16x32_bf16 a[140:143], v[240:243], v[140:143], a[140:143]
v_accvgpr_read_b32 v219, a111
v_cvt_pk_bf16_f32 v124, v216, v217
v_mfma_f32_16x16x32_bf16 a[140:143], v[244:247], v[156:159], a[140:143]
s_waitcnt lgkmcnt(4)
v_cvt_pk_bf16_f32 v125, v218, v219
v_mfma_f32_16x16x32_bf16 a[128:131], v[224:227], v[160:163], a[128:131]
ds_read_b64_tr_b16 v[240:241], v13 offset:8192
ds_read_b64_tr_b16 v[242:243], v13 offset:10240
v_mfma_f32_16x16x32_bf16 a[128:131], v[228:231], v[0:3], a[128:131]
v_accvgpr_read_b32 v196, a112
v_accvgpr_read_b32 v197, a113
v_mfma_f32_16x16x32_bf16 a[132:135], v[224:227], v[164:167], a[132:135]
v_accvgpr_read_b32 v198, a114
v_accvgpr_read_b32 v199, a115
v_mfma_f32_16x16x32_bf16 a[132:135], v[228:231], v[32:35], a[132:135]
v_cvt_pk_bf16_f32 v30, v196, v197
v_cvt_pk_bf16_f32 v31, v198, v199
v_mfma_f32_16x16x32_bf16 a[136:139], v[224:227], v[168:171], a[136:139]
ds_read_b64_tr_b16 v[244:245], v13 offset:24576
ds_read_b64_tr_b16 v[246:247], v13 offset:26624
v_mfma_f32_16x16x32_bf16 a[136:139], v[228:231], v[64:67], a[136:139]
buffer_store_dwordx4 v[28:31], v252, s[20:23], s40 offen offset:3072 sc1
ds_write_b128 v255, v[28:31] offset:3072
v_mfma_f32_16x16x32_bf16 a[140:143], v[224:227], v[172:175], a[140:143]
v_accvgpr_read_b32 v204, a116
v_accvgpr_read_b32 v205, a117
v_mfma_f32_16x16x32_bf16 a[140:143], v[228:231], v[96:99], a[140:143]
s_waitcnt lgkmcnt(5)
v_accvgpr_read_b32 v206, a118
v_mfma_f32_16x16x32_bf16 a[144:147], v[232:235], v[4:7], a[144:147]
ds_read_b64_tr_b16 v[224:225], v13 offset:40960
ds_read_b64_tr_b16 v[226:227], v13 offset:43008
v_mfma_f32_16x16x32_bf16 a[144:147], v[236:239], v[176:179], a[144:147]
v_accvgpr_read_b32 v207, a119
v_cvt_pk_bf16_f32 v62, v204, v205
v_mfma_f32_16x16x32_bf16 a[148:151], v[232:235], v[36:39], a[148:151]
v_cvt_pk_bf16_f32 v63, v206, v207
buffer_store_dwordx4 v[60:63], v252, s[20:23], s41 offen offset:3072 sc1
v_mfma_f32_16x16x32_bf16 a[148:151], v[236:239], v[180:183], a[148:151]
v_accvgpr_read_b32 v212, a120
v_accvgpr_read_b32 v213, a121
v_mfma_f32_16x16x32_bf16 a[152:155], v[232:235], v[68:71], a[152:155]
ds_read_b64_tr_b16 v[228:229], v13 offset:57344
ds_read_b64_tr_b16 v[230:231], v13 offset:59392
v_mfma_f32_16x16x32_bf16 a[152:155], v[236:239], v[184:187], a[152:155]
v_accvgpr_read_b32 v214, a122
v_accvgpr_read_b32 v215, a123
v_mfma_f32_16x16x32_bf16 a[156:159], v[232:235], v[100:103], a[156:159]
v_cvt_pk_bf16_f32 v94, v212, v213
v_cvt_pk_bf16_f32 v95, v214, v215
v_mfma_f32_16x16x32_bf16 a[156:159], v[236:239], v[188:191], a[156:159]
s_waitcnt lgkmcnt(5)
buffer_store_dwordx4 v[92:95], v252, s[20:23], s42 offen offset:3072 sc1
v_mfma_f32_16x16x32_bf16 a[144:147], v[240:243], v[128:131], a[144:147]
ds_read_b64_tr_b16 v[232:233], v249 offset:41472
ds_read_b64_tr_b16 v[234:235], v249 offset:43520
v_mfma_f32_16x16x32_bf16 a[144:147], v[244:247], v[144:147], a[144:147]
v_accvgpr_read_b32 v220, a124
v_accvgpr_read_b32 v221, a125
v_mfma_f32_16x16x32_bf16 a[148:151], v[240:243], v[132:135], a[148:151]
v_accvgpr_read_b32 v222, a126
v_accvgpr_read_b32 v223, a127
v_mfma_f32_16x16x32_bf16 a[148:151], v[244:247], v[148:151], a[148:151]
v_cvt_pk_bf16_f32 v126, v220, v221
v_cvt_pk_bf16_f32 v127, v222, v223
v_mfma_f32_16x16x32_bf16 a[152:155], v[240:243], v[136:139], a[152:155]
ds_read_b64_tr_b16 v[236:237], v249 offset:57856
ds_read_b64_tr_b16 v[238:239], v249 offset:59904
v_mfma_f32_16x16x32_bf16 a[152:155], v[244:247], v[152:155], a[152:155]
buffer_store_dwordx4 v[124:127], v252, s[20:23], s43 offen offset:3072 sc1
v_accvgpr_read_b32 v192, a128
v_mfma_f32_16x16x32_bf16 a[156:159], v[240:243], v[140:143], a[156:159]
v_accvgpr_read_b32 v193, a129
v_accvgpr_read_b32 v194, a130
v_mfma_f32_16x16x32_bf16 a[156:159], v[244:247], v[156:159], a[156:159]
s_waitcnt lgkmcnt(4)
v_accvgpr_read_b32 v195, a131
v_mfma_f32_16x16x32_bf16 a[144:147], v[224:227], v[160:163], a[144:147]
ds_read_b64_tr_b16 v[240:241], v12 offset:8704
ds_read_b64_tr_b16 v[242:243], v12 offset:10752
v_mfma_f32_16x16x32_bf16 a[144:147], v[228:231], v[0:3], a[144:147]
v_cvt_pk_bf16_f32 v16, v192, v193
v_cvt_pk_bf16_f32 v17, v194, v195
v_mfma_f32_16x16x32_bf16 a[148:151], v[224:227], v[164:167], a[148:151]
v_accvgpr_read_b32 v200, a132
v_accvgpr_read_b32 v201, a133
v_mfma_f32_16x16x32_bf16 a[148:151], v[228:231], v[32:35], a[148:151]
v_accvgpr_read_b32 v202, a134
v_accvgpr_read_b32 v203, a135
v_mfma_f32_16x16x32_bf16 a[152:155], v[224:227], v[168:171], a[152:155]
ds_read_b64_tr_b16 v[244:245], v12 offset:25088
ds_read_b64_tr_b16 v[246:247], v12 offset:27136
v_mfma_f32_16x16x32_bf16 a[152:155], v[228:231], v[64:67], a[152:155]
v_cvt_pk_bf16_f32 v48, v200, v201
v_cvt_pk_bf16_f32 v49, v202, v203
v_mfma_f32_16x16x32_bf16 a[156:159], v[224:227], v[172:175], a[156:159]
v_accvgpr_read_b32 v208, a136
v_accvgpr_read_b32 v209, a137
v_mfma_f32_16x16x32_bf16 a[156:159], v[228:231], v[96:99], a[156:159]
s_waitcnt lgkmcnt(4)
v_accvgpr_read_b32 v210, a138
v_mfma_f32_16x16x32_bf16 a[160:163], v[232:235], v[4:7], a[160:163]
ds_read_b64_tr_b16 v[224:225], v12 offset:41472
ds_read_b64_tr_b16 v[226:227], v12 offset:43520
v_mfma_f32_16x16x32_bf16 a[160:163], v[236:239], v[176:179], a[160:163]
v_accvgpr_read_b32 v211, a139
v_cvt_pk_bf16_f32 v80, v208, v209
v_mfma_f32_16x16x32_bf16 a[164:167], v[232:235], v[36:39], a[164:167]
v_cvt_pk_bf16_f32 v81, v210, v211
v_accvgpr_read_b32 v216, a140
v_mfma_f32_16x16x32_bf16 a[164:167], v[236:239], v[180:183], a[164:167]
v_accvgpr_read_b32 v217, a141
v_accvgpr_read_b32 v218, a142
v_mfma_f32_16x16x32_bf16 a[168:171], v[232:235], v[68:71], a[168:171]
ds_read_b64_tr_b16 v[228:229], v12 offset:57856
ds_read_b64_tr_b16 v[230:231], v12 offset:59904
v_mfma_f32_16x16x32_bf16 a[168:171], v[236:239], v[184:187], a[168:171]
v_accvgpr_read_b32 v219, a143
v_cvt_pk_bf16_f32 v112, v216, v217
v_mfma_f32_16x16x32_bf16 a[172:175], v[232:235], v[100:103], a[172:175]
v_cvt_pk_bf16_f32 v113, v218, v219
v_accvgpr_read_b32 v196, a144
v_mfma_f32_16x16x32_bf16 a[172:175], v[236:239], v[188:191], a[172:175]
s_waitcnt lgkmcnt(4)
v_accvgpr_read_b32 v197, a145
v_mfma_f32_16x16x32_bf16 a[160:163], v[240:243], v[128:131], a[160:163]
ds_read_b64_tr_b16 v[232:233], v250 offset:41472
ds_read_b64_tr_b16 v[234:235], v250 offset:43520
v_mfma_f32_16x16x32_bf16 a[160:163], v[244:247], v[144:147], a[160:163]
v_accvgpr_read_b32 v198, a146
v_accvgpr_read_b32 v199, a147
v_mfma_f32_16x16x32_bf16 a[164:167], v[240:243], v[132:135], a[164:167]
v_cvt_pk_bf16_f32 v18, v196, v197
v_cvt_pk_bf16_f32 v19, v198, v199
v_mfma_f32_16x16x32_bf16 a[164:167], v[244:247], v[148:151], a[164:167]
buffer_store_dwordx4 v[16:19], v252, s[20:23], s44 offen offset:0 sc1
v_accvgpr_read_b32 v204, a148
v_mfma_f32_16x16x32_bf16 a[168:171], v[240:243], v[136:139], a[168:171]
ds_read_b64_tr_b16 v[236:237], v250 offset:57856
ds_read_b64_tr_b16 v[238:239], v250 offset:59904
v_mfma_f32_16x16x32_bf16 a[168:171], v[244:247], v[152:155], a[168:171]
v_accvgpr_read_b32 v205, a149
v_accvgpr_read_b32 v206, a150
v_mfma_f32_16x16x32_bf16 a[172:175], v[240:243], v[140:143], a[172:175]
v_accvgpr_read_b32 v207, a151
v_cvt_pk_bf16_f32 v50, v204, v205
s_mov_b32 s33, 0x6c01400
v_mfma_f32_16x16x32_bf16 a[172:175], v[244:247], v[156:159], a[172:175]
s_waitcnt lgkmcnt(4)
v_cvt_pk_bf16_f32 v51, v206, v207
buffer_load_dword v254, off, s[56:59], s33 sc1
v_mfma_f32_16x16x32_bf16 a[160:163], v[224:227], v[160:163], a[160:163]
ds_read_b64_tr_b16 v[240:241], v13 offset:8704
ds_read_b64_tr_b16 v[242:243], v13 offset:10752
v_mfma_f32_16x16x32_bf16 a[160:163], v[228:231], v[0:3], a[160:163]
buffer_store_dwordx4 v[48:51], v252, s[20:23], s45 offen offset:0 sc1
v_accvgpr_read_b32 v212, a152
v_mfma_f32_16x16x32_bf16 a[164:167], v[224:227], v[164:167], a[164:167]
v_accvgpr_read_b32 v213, a153
v_accvgpr_read_b32 v214, a154
v_mfma_f32_16x16x32_bf16 a[164:167], v[228:231], v[32:35], a[164:167]
v_accvgpr_read_b32 v215, a155
v_cvt_pk_bf16_f32 v82, v212, v213
v_mfma_f32_16x16x32_bf16 a[168:171], v[224:227], v[168:171], a[168:171]
ds_read_b64_tr_b16 v[244:245], v13 offset:25088
ds_read_b64_tr_b16 v[246:247], v13 offset:27136
v_mfma_f32_16x16x32_bf16 a[168:171], v[228:231], v[64:67], a[168:171]
v_cvt_pk_bf16_f32 v83, v214, v215
buffer_store_dwordx4 v[80:83], v252, s[20:23], s46 offen offset:0 sc1
v_mfma_f32_16x16x32_bf16 a[172:175], v[224:227], v[172:175], a[172:175]
v_accvgpr_read_b32 v220, a156
v_accvgpr_read_b32 v221, a157
v_mfma_f32_16x16x32_bf16 a[172:175], v[228:231], v[96:99], a[172:175]
s_waitcnt lgkmcnt(4)
v_accvgpr_read_b32 v222, a158
v_mfma_f32_16x16x32_bf16 a[176:179], v[232:235], v[4:7], a[176:179]
ds_read_b64_tr_b16 v[224:225], v13 offset:41472
ds_read_b64_tr_b16 v[226:227], v13 offset:43520
v_mfma_f32_16x16x32_bf16 a[176:179], v[236:239], v[176:179], a[176:179]
v_accvgpr_read_b32 v223, a159
v_cvt_pk_bf16_f32 v114, v220, v221
v_mfma_f32_16x16x32_bf16 a[180:183], v[232:235], v[36:39], a[180:183]
v_cvt_pk_bf16_f32 v115, v222, v223
buffer_store_dwordx4 v[112:115], v252, s[20:23], s47 offen offset:0 sc1
v_mfma_f32_16x16x32_bf16 a[180:183], v[236:239], v[180:183], a[180:183]
v_accvgpr_read_b32 v192, a160
v_accvgpr_read_b32 v193, a161
v_mfma_f32_16x16x32_bf16 a[184:187], v[232:235], v[68:71], a[184:187]
ds_read_b64_tr_b16 v[228:229], v13 offset:57856
ds_read_b64_tr_b16 v[230:231], v13 offset:59904
v_mfma_f32_16x16x32_bf16 a[184:187], v[236:239], v[184:187], a[184:187]
v_accvgpr_read_b32 v194, a162
v_accvgpr_read_b32 v195, a163
v_mfma_f32_16x16x32_bf16 a[188:191], v[232:235], v[100:103], a[188:191]
v_cvt_pk_bf16_f32 v20, v192, v193
v_cvt_pk_bf16_f32 v21, v194, v195
v_mfma_f32_16x16x32_bf16 a[188:191], v[236:239], v[188:191], a[188:191]
s_waitcnt lgkmcnt(4)
v_accvgpr_read_b32 v200, a164
v_mfma_f32_16x16x32_bf16 a[176:179], v[240:243], v[128:131], a[176:179]
ds_read_b64_tr_b16 v[232:233], v249 offset:45056
ds_read_b64_tr_b16 v[234:235], v249 offset:47104
v_mfma_f32_16x16x32_bf16 a[176:179], v[244:247], v[144:147], a[176:179]
v_accvgpr_read_b32 v201, a165
v_accvgpr_read_b32 v202, a166
v_mfma_f32_16x16x32_bf16 a[180:183], v[240:243], v[132:135], a[180:183]
v_accvgpr_read_b32 v203, a167
v_cvt_pk_bf16_f32 v52, v200, v201
v_mfma_f32_16x16x32_bf16 a[180:183], v[244:247], v[148:151], a[180:183]
v_cvt_pk_bf16_f32 v53, v202, v203
v_accvgpr_read_b32 v208, a168
v_mfma_f32_16x16x32_bf16 a[184:187], v[240:243], v[136:139], a[184:187]
ds_read_b64_tr_b16 v[236:237], v249 offset:61440
ds_read_b64_tr_b16 v[238:239], v249 offset:63488
v_mfma_f32_16x16x32_bf16 a[184:187], v[244:247], v[152:155], a[184:187]
v_accvgpr_read_b32 v209, a169
v_accvgpr_read_b32 v210, a170
v_mfma_f32_16x16x32_bf16 a[188:191], v[240:243], v[140:143], a[188:191]
v_accvgpr_read_b32 v211, a171
v_cvt_pk_bf16_f32 v84, v208, v209
v_mfma_f32_16x16x32_bf16 a[188:191], v[244:247], v[156:159], a[188:191]
s_waitcnt lgkmcnt(4)
v_cvt_pk_bf16_f32 v85, v210, v211
v_mfma_f32_16x16x32_bf16 a[176:179], v[224:227], v[160:163], a[176:179]
ds_read_b64_tr_b16 v[240:241], v12 offset:12288
ds_read_b64_tr_b16 v[242:243], v12 offset:14336
v_mfma_f32_16x16x32_bf16 a[176:179], v[228:231], v[0:3], a[176:179]
v_accvgpr_read_b32 v216, a172
v_accvgpr_read_b32 v217, a173
v_mfma_f32_16x16x32_bf16 a[180:183], v[224:227], v[164:167], a[180:183]
v_accvgpr_read_b32 v218, a174
v_accvgpr_read_b32 v219, a175
v_mfma_f32_16x16x32_bf16 a[180:183], v[228:231], v[32:35], a[180:183]
v_cvt_pk_bf16_f32 v116, v216, v217
v_cvt_pk_bf16_f32 v117, v218, v219
v_mfma_f32_16x16x32_bf16 a[184:187], v[224:227], v[168:171], a[184:187]
ds_read_b64_tr_b16 v[244:245], v12 offset:28672
ds_read_b64_tr_b16 v[246:247], v12 offset:30720
v_mfma_f32_16x16x32_bf16 a[184:187], v[228:231], v[64:67], a[184:187]
v_mfma_f32_16x16x32_bf16 a[188:191], v[224:227], v[172:175], a[188:191]
v_accvgpr_read_b32 v196, a176
v_accvgpr_read_b32 v197, a177
v_mfma_f32_16x16x32_bf16 a[188:191], v[228:231], v[96:99], a[188:191]
s_waitcnt lgkmcnt(4)
v_accvgpr_read_b32 v198, a178
v_mfma_f32_16x16x32_bf16 a[192:195], v[232:235], v[4:7], a[192:195]
ds_read_b64_tr_b16 v[224:225], v12 offset:45056
ds_read_b64_tr_b16 v[226:227], v12 offset:47104
v_mfma_f32_16x16x32_bf16 a[192:195], v[236:239], v[176:179], a[192:195]
v_accvgpr_read_b32 v199, a179
v_cvt_pk_bf16_f32 v22, v196, v197
v_mfma_f32_16x16x32_bf16 a[196:199], v[232:235], v[36:39], a[196:199]
v_cvt_pk_bf16_f32 v23, v198, v199
buffer_store_dwordx4 v[20:23], v252, s[20:23], s44 offen offset:1024 sc1
v_mfma_f32_16x16x32_bf16 a[196:199], v[236:239], v[180:183], a[196:199]
v_accvgpr_read_b32 v204, a180
v_accvgpr_read_b32 v205, a181
v_mfma_f32_16x16x32_bf16 a[200:203], v[232:235], v[68:71], a[200:203]
ds_read_b64_tr_b16 v[228:229], v12 offset:61440
ds_read_b64_tr_b16 v[230:231], v12 offset:63488
v_mfma_f32_16x16x32_bf16 a[200:203], v[236:239], v[184:187], a[200:203]
v_accvgpr_read_b32 v206, a182
v_accvgpr_read_b32 v207, a183
v_mfma_f32_16x16x32_bf16 a[204:207], v[232:235], v[100:103], a[204:207]
v_cvt_pk_bf16_f32 v54, v204, v205
v_cvt_pk_bf16_f32 v55, v206, v207
v_mfma_f32_16x16x32_bf16 a[204:207], v[236:239], v[188:191], a[204:207]
s_waitcnt lgkmcnt(4)
buffer_store_dwordx4 v[52:55], v252, s[20:23], s45 offen offset:1024 sc1
v_mfma_f32_16x16x32_bf16 a[192:195], v[240:243], v[128:131], a[192:195]
ds_read_b64_tr_b16 v[232:233], v250 offset:45056
ds_read_b64_tr_b16 v[234:235], v250 offset:47104
v_mfma_f32_16x16x32_bf16 a[192:195], v[244:247], v[144:147], a[192:195]
v_accvgpr_read_b32 v212, a184
v_accvgpr_read_b32 v213, a185
v_mfma_f32_16x16x32_bf16 a[196:199], v[240:243], v[132:135], a[196:199]
v_accvgpr_read_b32 v214, a186
v_accvgpr_read_b32 v215, a187
v_mfma_f32_16x16x32_bf16 a[196:199], v[244:247], v[148:151], a[196:199]
v_cvt_pk_bf16_f32 v86, v212, v213
v_cvt_pk_bf16_f32 v87, v214, v215
v_mfma_f32_16x16x32_bf16 a[200:203], v[240:243], v[136:139], a[200:203]
ds_read_b64_tr_b16 v[236:237], v250 offset:61440
ds_read_b64_tr_b16 v[238:239], v250 offset:63488
v_mfma_f32_16x16x32_bf16 a[200:203], v[244:247], v[152:155], a[200:203]
buffer_store_dwordx4 v[84:87], v252, s[20:23], s46 offen offset:1024 sc1
v_accvgpr_read_b32 v220, a188
v_mfma_f32_16x16x32_bf16 a[204:207], v[240:243], v[140:143], a[204:207]
v_accvgpr_read_b32 v221, a189
v_accvgpr_read_b32 v222, a190
v_mfma_f32_16x16x32_bf16 a[204:207], v[244:247], v[156:159], a[204:207]
s_waitcnt lgkmcnt(4)
v_accvgpr_read_b32 v223, a191
v_mfma_f32_16x16x32_bf16 a[192:195], v[224:227], v[160:163], a[192:195]
ds_read_b64_tr_b16 v[240:241], v13 offset:12288
ds_read_b64_tr_b16 v[242:243], v13 offset:14336
v_mfma_f32_16x16x32_bf16 a[192:195], v[228:231], v[0:3], a[192:195]
v_cvt_pk_bf16_f32 v118, v220, v221
v_cvt_pk_bf16_f32 v119, v222, v223
v_mfma_f32_16x16x32_bf16 a[196:199], v[224:227], v[164:167], a[196:199]
buffer_store_dwordx4 v[116:119], v252, s[20:23], s47 offen offset:1024 sc1
v_mfma_f32_16x16x32_bf16 a[196:199], v[228:231], v[32:35], a[196:199]
v_mfma_f32_16x16x32_bf16 a[200:203], v[224:227], v[168:171], a[200:203]
ds_read_b64_tr_b16 v[244:245], v13 offset:28672
ds_read_b64_tr_b16 v[246:247], v13 offset:30720
v_mfma_f32_16x16x32_bf16 a[200:203], v[228:231], v[64:67], a[200:203]
v_mfma_f32_16x16x32_bf16 a[204:207], v[224:227], v[172:175], a[204:207]
v_accvgpr_read_b32 v192, a192
v_accvgpr_read_b32 v193, a193
v_mfma_f32_16x16x32_bf16 a[204:207], v[228:231], v[96:99], a[204:207]
s_waitcnt lgkmcnt(4)
v_accvgpr_read_b32 v194, a194
v_mfma_f32_16x16x32_bf16 a[208:211], v[232:235], v[4:7], a[208:211]
ds_read_b64_tr_b16 v[224:225], v13 offset:45056
ds_read_b64_tr_b16 v[226:227], v13 offset:47104
v_mfma_f32_16x16x32_bf16 a[208:211], v[236:239], v[176:179], a[208:211]
v_accvgpr_read_b32 v195, a195
v_cvt_pk_bf16_f32 v24, v192, v193
v_mfma_f32_16x16x32_bf16 a[212:215], v[232:235], v[36:39], a[212:215]
v_cvt_pk_bf16_f32 v25, v194, v195
v_accvgpr_read_b32 v200, a196
v_mfma_f32_16x16x32_bf16 a[212:215], v[236:239], v[180:183], a[212:215]
v_accvgpr_read_b32 v201, a197
v_accvgpr_read_b32 v202, a198
v_mfma_f32_16x16x32_bf16 a[216:219], v[232:235], v[68:71], a[216:219]
ds_read_b64_tr_b16 v[228:229], v13 offset:61440
ds_read_b64_tr_b16 v[230:231], v13 offset:63488
v_mfma_f32_16x16x32_bf16 a[216:219], v[236:239], v[184:187], a[216:219]
v_accvgpr_read_b32 v203, a199
v_cvt_pk_bf16_f32 v56, v200, v201
v_mfma_f32_16x16x32_bf16 a[220:223], v[232:235], v[100:103], a[220:223]
v_cvt_pk_bf16_f32 v57, v202, v203
v_accvgpr_read_b32 v208, a200
v_mfma_f32_16x16x32_bf16 a[220:223], v[236:239], v[188:191], a[220:223]
s_waitcnt lgkmcnt(4)
v_accvgpr_read_b32 v209, a201
v_mfma_f32_16x16x32_bf16 a[208:211], v[240:243], v[128:131], a[208:211]
ds_read_b64_tr_b16 v[232:233], v249 offset:45568
ds_read_b64_tr_b16 v[234:235], v249 offset:47616
v_mfma_f32_16x16x32_bf16 a[208:211], v[244:247], v[144:147], a[208:211]
v_accvgpr_read_b32 v210, a202
v_accvgpr_read_b32 v211, a203
v_mfma_f32_16x16x32_bf16 a[212:215], v[240:243], v[132:135], a[212:215]
v_cvt_pk_bf16_f32 v88, v208, v209
v_cvt_pk_bf16_f32 v89, v210, v211
v_mfma_f32_16x16x32_bf16 a[212:215], v[244:247], v[148:151], a[212:215]
v_accvgpr_read_b32 v216, a204
v_accvgpr_read_b32 v217, a205
v_mfma_f32_16x16x32_bf16 a[216:219], v[240:243], v[136:139], a[216:219]
ds_read_b64_tr_b16 v[236:237], v249 offset:61952
ds_read_b64_tr_b16 v[238:239], v249 offset:64000
v_mfma_f32_16x16x32_bf16 a[216:219], v[244:247], v[152:155], a[216:219]
v_accvgpr_read_b32 v218, a206
v_accvgpr_read_b32 v219, a207
v_mfma_f32_16x16x32_bf16 a[220:223], v[240:243], v[140:143], a[220:223]
v_cvt_pk_bf16_f32 v120, v216, v217
v_cvt_pk_bf16_f32 v121, v218, v219
v_mfma_f32_16x16x32_bf16 a[220:223], v[244:247], v[156:159], a[220:223]
s_waitcnt lgkmcnt(4)
v_mfma_f32_16x16x32_bf16 a[208:211], v[224:227], v[160:163], a[208:211]
ds_read_b64_tr_b16 v[240:241], v12 offset:12800
ds_read_b64_tr_b16 v[242:243], v12 offset:14848
v_mfma_f32_16x16x32_bf16 a[208:211], v[228:231], v[0:3], a[208:211]
v_mfma_f32_16x16x32_bf16 a[212:215], v[224:227], v[164:167], a[212:215]
v_mfma_f32_16x16x32_bf16 a[212:215], v[228:231], v[32:35], a[212:215]
v_mfma_f32_16x16x32_bf16 a[216:219], v[224:227], v[168:171], a[216:219]
ds_read_b64_tr_b16 v[244:245], v12 offset:29184
ds_read_b64_tr_b16 v[246:247], v12 offset:31232
v_mfma_f32_16x16x32_bf16 a[216:219], v[228:231], v[64:67], a[216:219]
v_mfma_f32_16x16x32_bf16 a[220:223], v[224:227], v[172:175], a[220:223]
s_nop 0
v_accvgpr_read_b32 v196, a208
v_accvgpr_read_b32 v197, a209
v_mfma_f32_16x16x32_bf16 a[220:223], v[228:231], v[96:99], a[220:223]
s_waitcnt lgkmcnt(4)
v_accvgpr_read_b32 v198, a210
v_mfma_f32_16x16x32_bf16 a[224:227], v[232:235], v[4:7], a[224:227]
ds_read_b64_tr_b16 v[224:225], v12 offset:45568
ds_read_b64_tr_b16 v[226:227], v12 offset:47616
v_mfma_f32_16x16x32_bf16 a[224:227], v[236:239], v[176:179], a[224:227]
v_accvgpr_read_b32 v199, a211
v_cvt_pk_bf16_f32 v26, v196, v197
v_mfma_f32_16x16x32_bf16 a[228:231], v[232:235], v[36:39], a[228:231]
v_cvt_pk_bf16_f32 v27, v198, v199
buffer_store_dwordx4 v[24:27], v252, s[20:23], s44 offen offset:2048 sc1
v_mfma_f32_16x16x32_bf16 a[228:231], v[236:239], v[180:183], a[228:231]
v_accvgpr_read_b32 v204, a212
v_accvgpr_read_b32 v205, a213
v_mfma_f32_16x16x32_bf16 a[232:235], v[232:235], v[68:71], a[232:235]
ds_read_b64_tr_b16 v[228:229], v12 offset:61952
ds_read_b64_tr_b16 v[230:231], v12 offset:64000
v_mfma_f32_16x16x32_bf16 a[232:235], v[236:239], v[184:187], a[232:235]
v_accvgpr_read_b32 v206, a214
v_accvgpr_read_b32 v207, a215
v_mfma_f32_16x16x32_bf16 a[236:239], v[232:235], v[100:103], a[236:239]
v_cvt_pk_bf16_f32 v58, v204, v205
v_cvt_pk_bf16_f32 v59, v206, v207
v_mfma_f32_16x16x32_bf16 a[236:239], v[236:239], v[188:191], a[236:239]
s_waitcnt lgkmcnt(4)
buffer_store_dwordx4 v[56:59], v252, s[20:23], s45 offen offset:2048 sc1
v_mfma_f32_16x16x32_bf16 a[224:227], v[240:243], v[128:131], a[224:227]
ds_read_b64_tr_b16 v[232:233], v250 offset:45568
ds_read_b64_tr_b16 v[234:235], v250 offset:47616
v_mfma_f32_16x16x32_bf16 a[224:227], v[244:247], v[144:147], a[224:227]
v_accvgpr_read_b32 v212, a216
v_accvgpr_read_b32 v213, a217
v_mfma_f32_16x16x32_bf16 a[228:231], v[240:243], v[132:135], a[228:231]
v_accvgpr_read_b32 v214, a218
v_accvgpr_read_b32 v215, a219
v_mfma_f32_16x16x32_bf16 a[228:231], v[244:247], v[148:151], a[228:231]
v_cvt_pk_bf16_f32 v90, v212, v213
v_cvt_pk_bf16_f32 v91, v214, v215
v_mfma_f32_16x16x32_bf16 a[232:235], v[240:243], v[136:139], a[232:235]
ds_read_b64_tr_b16 v[236:237], v250 offset:61952
ds_read_b64_tr_b16 v[238:239], v250 offset:64000
v_mfma_f32_16x16x32_bf16 a[232:235], v[244:247], v[152:155], a[232:235]
buffer_store_dwordx4 v[88:91], v252, s[20:23], s46 offen offset:2048 sc1
v_accvgpr_read_b32 v220, a220
v_mfma_f32_16x16x32_bf16 a[236:239], v[240:243], v[140:143], a[236:239]
v_accvgpr_read_b32 v221, a221
v_accvgpr_read_b32 v222, a222
v_mfma_f32_16x16x32_bf16 a[236:239], v[244:247], v[156:159], a[236:239]
s_waitcnt lgkmcnt(4)
v_accvgpr_read_b32 v223, a223
v_mfma_f32_16x16x32_bf16 a[224:227], v[224:227], v[160:163], a[224:227]
ds_read_b64_tr_b16 v[240:241], v13 offset:12800
ds_read_b64_tr_b16 v[242:243], v13 offset:14848
v_mfma_f32_16x16x32_bf16 a[224:227], v[228:231], v[0:3], a[224:227]
v_cvt_pk_bf16_f32 v122, v220, v221
v_cvt_pk_bf16_f32 v123, v222, v223
v_mfma_f32_16x16x32_bf16 a[228:231], v[224:227], v[164:167], a[228:231]
buffer_store_dwordx4 v[120:123], v252, s[20:23], s47 offen offset:2048 sc1
v_mfma_f32_16x16x32_bf16 a[228:231], v[228:231], v[32:35], a[228:231]
v_mfma_f32_16x16x32_bf16 a[232:235], v[224:227], v[168:171], a[232:235]
ds_read_b64_tr_b16 v[244:245], v13 offset:29184
ds_read_b64_tr_b16 v[246:247], v13 offset:31232
v_mfma_f32_16x16x32_bf16 a[232:235], v[228:231], v[64:67], a[232:235]
v_mfma_f32_16x16x32_bf16 a[236:239], v[224:227], v[172:175], a[236:239]
v_accvgpr_read_b32 v192, a224
v_accvgpr_read_b32 v193, a225
v_mfma_f32_16x16x32_bf16 a[236:239], v[228:231], v[96:99], a[236:239]
s_waitcnt lgkmcnt(4)
v_accvgpr_read_b32 v194, a226
v_mfma_f32_16x16x32_bf16 a[240:243], v[232:235], v[4:7], a[240:243]
ds_read_b64_tr_b16 v[224:225], v13 offset:45568
ds_read_b64_tr_b16 v[226:227], v13 offset:47616
v_mfma_f32_16x16x32_bf16 a[240:243], v[236:239], v[176:179], a[240:243]
v_accvgpr_read_b32 v195, a227
v_cvt_pk_bf16_f32 v28, v192, v193
v_mfma_f32_16x16x32_bf16 a[244:247], v[232:235], v[36:39], a[244:247]
v_cvt_pk_bf16_f32 v29, v194, v195
v_accvgpr_read_b32 v200, a228
v_mfma_f32_16x16x32_bf16 a[244:247], v[236:239], v[180:183], a[244:247]
v_accvgpr_read_b32 v201, a229
v_accvgpr_read_b32 v202, a230
v_mfma_f32_16x16x32_bf16 a[248:251], v[232:235], v[68:71], a[248:251]
ds_read_b64_tr_b16 v[228:229], v13 offset:61952
ds_read_b64_tr_b16 v[230:231], v13 offset:64000
v_mfma_f32_16x16x32_bf16 a[248:251], v[236:239], v[184:187], a[248:251]
v_accvgpr_read_b32 v203, a231
v_cvt_pk_bf16_f32 v60, v200, v201
v_mfma_f32_16x16x32_bf16 a[252:255], v[232:235], v[100:103], a[252:255]
v_cvt_pk_bf16_f32 v61, v202, v203
v_accvgpr_read_b32 v208, a232
v_mfma_f32_16x16x32_bf16 a[252:255], v[236:239], v[188:191], a[252:255]
s_waitcnt lgkmcnt(4)
v_accvgpr_read_b32 v209, a233
v_mfma_f32_16x16x32_bf16 a[240:243], v[240:243], v[128:131], a[240:243]
v_accvgpr_read_b32 v210, a234
v_accvgpr_read_b32 v211, a235
v_mfma_f32_16x16x32_bf16 a[240:243], v[244:247], v[144:147], a[240:243]
v_cvt_pk_bf16_f32 v92, v208, v209
v_cvt_pk_bf16_f32 v93, v210, v211
v_mfma_f32_16x16x32_bf16 a[244:247], v[240:243], v[132:135], a[244:247]
v_accvgpr_read_b32 v216, a236
v_accvgpr_read_b32 v217, a237
v_mfma_f32_16x16x32_bf16 a[244:247], v[244:247], v[148:151], a[244:247]
v_accvgpr_read_b32 v218, a238
v_accvgpr_read_b32 v219, a239
v_mfma_f32_16x16x32_bf16 a[248:251], v[240:243], v[136:139], a[248:251]
v_cvt_pk_bf16_f32 v124, v216, v217
v_cvt_pk_bf16_f32 v125, v218, v219
v_mfma_f32_16x16x32_bf16 a[248:251], v[244:247], v[152:155], a[248:251]
v_mfma_f32_16x16x32_bf16 a[252:255], v[240:243], v[140:143], a[252:255]
v_mfma_f32_16x16x32_bf16 a[252:255], v[244:247], v[156:159], a[252:255]
s_waitcnt lgkmcnt(0)
v_mfma_f32_16x16x32_bf16 a[240:243], v[224:227], v[160:163], a[240:243]
v_mfma_f32_16x16x32_bf16 a[240:243], v[228:231], v[0:3], a[240:243]
v_mfma_f32_16x16x32_bf16 a[244:247], v[224:227], v[164:167], a[244:247]
v_mfma_f32_16x16x32_bf16 a[244:247], v[228:231], v[32:35], a[244:247]
v_mfma_f32_16x16x32_bf16 a[248:251], v[224:227], v[168:171], a[248:251]
v_mfma_f32_16x16x32_bf16 a[248:251], v[228:231], v[64:67], a[248:251]
v_mfma_f32_16x16x32_bf16 a[252:255], v[224:227], v[172:175], a[252:255]
s_nop 2
v_accvgpr_read_b32 v196, a240
v_accvgpr_read_b32 v197, a241
v_accvgpr_read_b32 v198, a242
v_accvgpr_read_b32 v199, a243
v_mfma_f32_16x16x32_bf16 a[252:255], v[228:231], v[96:99], a[252:255]
v_cvt_pk_bf16_f32 v30, v196, v197
v_cvt_pk_bf16_f32 v31, v198, v199
buffer_store_dwordx4 v[28:31], v252, s[20:23], s44 offen offset:3072 sc1
v_accvgpr_read_b32 v204, a244
v_accvgpr_read_b32 v205, a245
v_accvgpr_read_b32 v206, a246
v_accvgpr_read_b32 v207, a247
v_cvt_pk_bf16_f32 v62, v204, v205
v_cvt_pk_bf16_f32 v63, v206, v207
buffer_store_dwordx4 v[60:63], v252, s[20:23], s45 offen offset:3072 sc1
v_accvgpr_read_b32 v212, a248
v_accvgpr_read_b32 v213, a249
v_accvgpr_read_b32 v214, a250
v_accvgpr_read_b32 v215, a251
v_cvt_pk_bf16_f32 v94, v212, v213
v_cvt_pk_bf16_f32 v95, v214, v215
buffer_store_dwordx4 v[92:95], v252, s[20:23], s46 offen offset:3072 sc1
v_accvgpr_read_b32 v220, a252
v_accvgpr_read_b32 v221, a253
v_accvgpr_read_b32 v222, a254
v_accvgpr_read_b32 v223, a255
v_cvt_pk_bf16_f32 v126, v220, v221
v_cvt_pk_bf16_f32 v127, v222, v223
buffer_store_dwordx4 v[124:127], v252, s[20:23], s47 offen offset:3072 sc1
s_waitcnt vmcnt(15)
v_readfirstlane_b32 s99, v254
s_branch L2_chk
L2_tail_1_7:
s_waitcnt lgkmcnt(4)
v_mfma_f32_16x16x32_bf16 a[0:3], v[224:227], v[160:163], a[0:3]
ds_read_b128 v[240:243], v248 offset:2048
v_mfma_f32_16x16x32_bf16 a[0:3], v[228:231], v[176:179], a[0:3]
s_lshl_b32 s36, s34, 13
v_mfma_f32_16x16x32_bf16 a[4:7], v[224:227], v[164:167], a[4:7]
s_add_u32 s56, s4, 0x1000000
s_addc_u32 s57, s5, 0
v_mfma_f32_16x16x32_bf16 a[4:7], v[228:231], v[180:183], a[4:7]
s_add_u32 s36, s36, 0x20000
s_mov_b32 s58, 0x6c02000
v_mfma_f32_16x16x32_bf16 a[8:11], v[224:227], v[168:171], a[8:11]
ds_read_b128 v[244:247], v248 offset:2560
s_mov_b32 s59, 0x00020000
v_mfma_f32_16x16x32_bf16 a[8:11], v[228:231], v[184:187], a[8:11]
v_add_u32 v255, s36, v252
s_lshr_b32 s35, s2, 1
v_mfma_f32_16x16x32_bf16 a[12:15], v[224:227], v[172:175], a[12:15]
s_and_b32 s35, s35, 28
s_add_u32 s35, s35, s34
v_mfma_f32_16x16x32_bf16 a[12:15], v[228:231], v[188:191], a[12:15]
s_waitcnt lgkmcnt(2)
s_lshl_b32 s35, s35, 13
v_mfma_f32_16x16x32_bf16 a[16:19], v[232:235], v[160:163], a[16:19]
ds_read_b128 v[224:227], v248 offset:6144
v_lshlrev_b32 v253, 3, v252
v_mfma_f32_16x16x32_bf16 a[16:19], v[236:239], v[176:179], a[16:19]
buffer_load_dword v253, v253, s[56:59], s35 offen
ds_write_b128 v255, v[160:163] offset:0
v_mfma_f32_16x16x32_bf16 a[20:23], v[232:235], v[164:167], a[20:23]
v_exp_f32 v192, v192
v_mfma_f32_16x16x32_bf16 a[20:23], v[236:239], v[180:183], a[20:23]
v_exp_f32 v193, v193
v_mfma_f32_16x16x32_bf16 a[24:27], v[232:235], v[168:171], a[24:27]
ds_read_b128 v[228:231], v248 offset:6656
v_cvt_pk_bf16_f32 v128, v192, v193
v_mfma_f32_16x16x32_bf16 a[24:27], v[236:239], v[184:187], a[24:27]
v_exp_f32 v194, v194
v_mfma_f32_16x16x32_bf16 a[28:31], v[232:235], v[172:175], a[28:31]
v_exp_f32 v195, v195
v_mfma_f32_16x16x32_bf16 a[28:31], v[236:239], v[188:191], a[28:31]
s_waitcnt lgkmcnt(3)
v_cvt_pk_bf16_f32 v129, v194, v195
v_mfma_f32_16x16x32_bf16 v[208:211], v[240:243], v[0:3], 0
ds_read_b128 v[232:235], v248 offset:10240
ds_write_b128 v255, v[164:167] offset:1024
v_mfma_f32_16x16x32_bf16 v[208:211], v[244:247], v[4:7], v[208:211]
v_exp_f32 v196, v196
v_mfma_f32_16x16x32_bf16 v[212:215], v[240:243], v[32:35], 0
v_exp_f32 v197, v197
v_mfma_f32_16x16x32_bf16 v[212:215], v[244:247], v[36:39], v[212:215]
v_exp_f32 v198, v198
v_mfma_f32_16x16x32_bf16 v[216:219], v[240:243], v[64:67], 0
ds_read_b128 v[236:239], v248 offset:10752
v_cvt_pk_bf16_f32 v132, v196, v197
v_mfma_f32_16x16x32_bf16 v[216:219], v[244:247], v[68:71], v[216:219]
v_exp_f32 v199, v199
v_mfma_f32_16x16x32_bf16 v[220:223], v[240:243], v[96:99], 0
v_exp_f32 v200, v200
v_mfma_f32_16x16x32_bf16 v[220:223], v[244:247], v[100:103], v[220:223]
s_waitcnt lgkmcnt(3)
v_cvt_pk_bf16_f32 v133, v198, v199
v_mfma_f32_16x16x32_bf16 v[208:211], v[224:227], v[8:11], v[208:211]
ds_read_b128 v[240:243], v248 offset:14336
ds_write_b128 v255, v[168:171] offset:2048
v_mfma_f32_16x16x32_bf16 v[208:211], v[228:231], v[12:15], v[208:211]
v_exp_f32 v201, v201
v_mfma_f32_16x16x32_bf16 v[212:215], v[224:227], v[40:43], v[212:215]
v_exp_f32 v202, v202
v_mfma_f32_16x16x32_bf16 v[212:215], v[228:231], v[44:47], v[212:215]
v_exp_f32 v203, v203
v_mfma_f32_16x16x32_bf16 v[216:219], v[224:227], v[72:75], v[216:219]
ds_read_b128 v[244:247], v248 offset:14848
v_cvt_pk_bf16_f32 v136, v200, v201
v_mfma_f32_16x16x32_bf16 v[216:219], v[228:231], v[76:79], v[216:219]
v_cvt_pk_bf16_f32 v137, v202, v203
ds_write_b128 v255, v[172:175] offset:3072
v_mfma_f32_16x16x32_bf16 v[220:223], v[224:227], v[104:107], v[220:223]
v_exp_f32 v204, v204
v_mfma_f32_16x16x32_bf16 v[220:223], v[228:231], v[108:111], v[220:223]
s_waitcnt lgkmcnt(4)
s_waitcnt vmcnt(1)
s_barrier
v_mfma_f32_16x16x32_bf16 v[208:211], v[232:235], v[16:19], v[208:211]
ds_read_b128 v[224:227], v248 offset:16384
s_add_u32 m0, s30, 0xc000
v_mfma_f32_16x16x32_bf16 v[208:211], v[236:239], v[20:23], v[208:211]
s_and_b32 s100, s30, 0x10000
buffer_load_dwordx4 v251, s[12:15], s28 offen offset:0 lds
v_mfma_f32_16x16x32_bf16 v[212:215], v[232:235], v[48:51], v[212:215]
s_xor_b32 s100, s100, 0x10000
ds_write_b128 v255, v[176:179] offset:4096
v_mfma_f32_16x16x32_bf16 v[212:215], v[236:239], v[52:55], v[212:215]
s_mov_b32 s99, 0
buffer_load_dwordx4 v251, s[12:15], s28 offen offset:1024 lds
v_mfma_f32_16x16x32_bf16 v[216:219], v[232:235], v[80:83], v[216:219]
ds_read_b128 v[228:231], v248 offset:16896
ds_write_b128 v255, v[180:183] offset:5120
v_mfma_f32_16x16x32_bf16 v[216:219], v[236:239], v[84:87], v[216:219]
v_exp_f32 v205, v205
v_mfma_f32_16x16x32_bf16 v[220:223], v[232:235], v[112:115], v[220:223]
v_exp_f32 v206, v206
v_mfma_f32_16x16x32_bf16 v[220:223], v[236:239], v[116:119], v[220:223]
s_waitcnt lgkmcnt(5)
v_cvt_pk_bf16_f32 v140, v204, v205
v_mfma_f32_16x16x32_bf16 v[208:211], v[240:243], v[24:27], v[208:211]
ds_read_b128 v[232:235], v248 offset:20480
buffer_load_dwordx4 v251, s[12:15], s28 offen offset:2048 lds
v_mfma_f32_16x16x32_bf16 v[208:211], v[244:247], v[28:31], v[208:211]
v_exp_f32 v207, v207
v_mfma_f32_16x16x32_bf16 v[212:215], v[240:243], v[56:59], v[212:215]
buffer_load_dwordx4 v251, s[12:15], s28 offen offset:3072 lds
ds_write_b128 v255, v[184:187] offset:6144
v_mfma_f32_16x16x32_bf16 v[212:215], v[244:247], v[60:63], v[212:215]
ds_write_b128 v255, v[188:191] offset:7168
v_mfma_f32_16x16x32_bf16 v[216:219], v[240:243], v[88:91], v[216:219]
ds_read_b128 v[236:239], v248 offset:20992
v_cvt_pk_bf16_f32 v141, v206, v207
v_mfma_f32_16x16x32_bf16 v[216:219], v[244:247], v[92:95], v[216:219]
s_add_u32 s28, s28, 0x4000
s_xor_b32 s30, s30, 0x10000
v_mfma_f32_16x16x32_bf16 v[220:223], v[240:243], v[120:123], v[220:223]
s_add_u32 m0, s30, 0x0
v_mfma_f32_16x16x32_bf16 v[220:223], v[244:247], v[124:127], v[220:223]
s_waitcnt lgkmcnt(5)
v_lshrrev_b32 v254, 1, v251
v_mfma_f32_16x16x32_bf16 v[192:195], v[224:227], v[0:3], 0
ds_read_b128 v[240:243], v248 offset:24576
v_and_b32 v254, 0x1800, v254
v_mfma_f32_16x16x32_bf16 v[192:195], v[228:231], v[4:7], v[192:195]
v_exp_f32 v208, v208
v_mfma_f32_16x16x32_bf16 v[196:199], v[224:227], v[32:35], 0
v_exp_f32 v209, v209
v_mfma_f32_16x16x32_bf16 v[196:199], v[228:231], v[36:39], v[196:199]
v_exp_f32 v210, v210
v_mfma_f32_16x16x32_bf16 v[200:203], v[224:227], v[64:67], 0
ds_read_b128 v[244:247], v248 offset:25088
v_cvt_pk_bf16_f32 v130, v208, v209
v_mfma_f32_16x16x32_bf16 v[200:203], v[228:231], v[68:71], v[200:203]
v_exp_f32 v211, v211
v_mfma_f32_16x16x32_bf16 v[204:207], v[224:227], v[96:99], 0
v_exp_f32 v212, v212
v_mfma_f32_16x16x32_bf16 v[204:207], v[228:231], v[100:103], v[204:207]
s_waitcnt lgkmcnt(2)
v_cvt_pk_bf16_f32 v131, v210, v211
v_mfma_f32_16x16x32_bf16 v[192:195], v[232:235], v[8:11], v[192:195]
ds_read_b128 v[224:227], v248 offset:28672
s_movk_i32 s35, 0x3ff
v_mfma_f32_16x16x32_bf16 v[192:195], v[236:239], v[12:15], v[192:195]
v_exp_f32 v213, v213
v_mfma_f32_16x16x32_bf16 v[196:199], v[232:235], v[40:43], v[196:199]
v_exp_f32 v214, v214
v_mfma_f32_16x16x32_bf16 v[196:199], v[236:239], v[44:47], v[196:199]
v_exp_f32 v215, v215
v_mfma_f32_16x16x32_bf16 v[200:203], v[232:235], v[72:75], v[200:203]
ds_read_b128 v[228:231], v248 offset:29184
v_cvt_pk_bf16_f32 v134, v212, v213
v_mfma_f32_16x16x32_bf16 v[200:203], v[236:239], v[76:79], v[200:203]
v_cvt_pk_bf16_f32 v135, v214, v215
v_and_or_b32 v254, v251, s35, v254
v_mfma_f32_16x16x32_bf16 v[204:207], v[232:235], v[104:107], v[204:207]
v_exp_f32 v216, v216
v_mfma_f32_16x16x32_bf16 v[204:207], v[236:239], v[108:111], v[204:207]
s_waitcnt lgkmcnt(2)
s_add_u32 s35, s28, 6144
v_mfma_f32_16x16x32_bf16 v[192:195], v[240:243], v[16:19], v[192:195]
ds_read_b128 v[232:235], v248 offset:18432
buffer_load_dwordx4 v254, s[12:15], s28 offen offset:0 lds
v_mfma_f32_16x16x32_bf16 v[192:195], v[244:247], v[20:23], v[192:195]
v_exp_f32 v217, v217
v_mfma_f32_16x16x32_bf16 v[196:199], v[240:243], v[48:51], v[196:199]
v_exp_f32 v218, v218
v_mfma_f32_16x16x32_bf16 v[196:199], v[244:247], v[52:55], v[196:199]
v_exp_f32 v219, v219
v_mfma_f32_16x16x32_bf16 v[200:203], v[240:243], v[80:83], v[200:203]
ds_read_b128 v[236:239], v248 offset:18944
v_cvt_pk_bf16_f32 v138, v216, v217
v_mfma_f32_16x16x32_bf16 v[200:203], v[244:247], v[84:87], v[200:203]
v_cvt_pk_bf16_f32 v139, v218, v219
buffer_load_dwordx4 v254, s[12:15], s28 offen offset:1024 lds
v_mfma_f32_16x16x32_bf16 v[204:207], v[240:243], v[112:115], v[204:207]
v_exp_f32 v220, v220
v_mfma_f32_16x16x32_bf16 v[204:207], v[244:247], v[116:119], v[204:207]
s_waitcnt lgkmcnt(2)
buffer_load_dwordx4 v254, s[12:15], s35 offen offset:2048 lds
v_mfma_f32_16x16x32_bf16 v[192:195], v[224:227], v[24:27], v[192:195]
ds_read_b128 v[240:243], v248 offset:22528
v_mfma_f32_16x16x32_bf16 v[192:195], v[228:231], v[28:31], v[192:195]
v_exp_f32 v221, v221
v_mfma_f32_16x16x32_bf16 v[196:199], v[224:227], v[56:59], v[196:199]
v_exp_f32 v222, v222
v_mfma_f32_16x16x32_bf16 v[196:199], v[228:231], v[60:63], v[196:199]
v_exp_f32 v223, v223
v_mfma_f32_16x16x32_bf16 v[200:203], v[224:227], v[88:91], v[200:203]
ds_read_b128 v[244:247], v248 offset:23040
v_cvt_pk_bf16_f32 v142, v220, v221
v_mfma_f32_16x16x32_bf16 v[200:203], v[228:231], v[92:95], v[200:203]
v_cvt_pk_bf16_f32 v143, v222, v223
buffer_load_dwordx4 v254, s[12:15], s35 offen offset:3072 lds
v_mfma_f32_16x16x32_bf16 v[204:207], v[224:227], v[120:123], v[204:207]
v_mfma_f32_16x16x32_bf16 v[204:207], v[228:231], v[124:127], v[204:207]
s_waitcnt lgkmcnt(2)
v_mfma_f32_16x16x32_bf16 v[208:211], v[232:235], v[0:3], 0
ds_read_b128 v[224:227], v248 offset:26624
v_mfma_f32_16x16x32_bf16 v[208:211], v[236:239], v[4:7], v[208:211]
v_exp_f32 v192, v192
v_mfma_f32_16x16x32_bf16 v[212:215], v[232:235], v[32:35], 0
v_exp_f32 v193, v193
v_mfma_f32_16x16x32_bf16 v[212:215], v[236:239], v[36:39], v[212:215]
v_exp_f32 v194, v194
v_mfma_f32_16x16x32_bf16 v[216:219], v[232:235], v[64:67], 0
ds_read_b128 v[228:231], v248 offset:27136
v_cvt_pk_bf16_f32 v144, v192, v193
v_mfma_f32_16x16x32_bf16 v[216:219], v[236:239], v[68:71], v[216:219]
v_exp_f32 v195, v195
v_mfma_f32_16x16x32_bf16 v[220:223], v[232:235], v[96:99], 0
v_exp_f32 v196, v196
v_mfma_f32_16x16x32_bf16 v[220:223], v[236:239], v[100:103], v[220:223]
s_waitcnt lgkmcnt(2)
v_cvt_pk_bf16_f32 v145, v194, v195
v_mfma_f32_16x16x32_bf16 v[208:211], v[240:243], v[8:11], v[208:211]
ds_read_b128 v[232:235], v248 offset:30720
v_mfma_f32_16x16x32_bf16 v[208:211], v[244:247], v[12:15], v[208:211]
v_exp_f32 v197, v197
v_mfma_f32_16x16x32_bf16 v[212:215], v[240:243], v[40:43], v[212:215]
v_exp_f32 v198, v198
v_mfma_f32_16x16x32_bf16 v[212:215], v[244:247], v[44:47], v[212:215]
v_exp_f32 v199, v199
v_mfma_f32_16x16x32_bf16 v[216:219], v[240:243], v[72:75], v[216:219]
ds_read_b128 v[236:239], v248 offset:31232
v_cvt_pk_bf16_f32 v148, v196, v197
v_mfma_f32_16x16x32_bf16 v[216:219], v[244:247], v[76:79], v[216:219]
v_cvt_pk_bf16_f32 v149, v198, v199
v_mfma_f32_16x16x32_bf16 v[220:223], v[240:243], v[104:107], v[220:223]
v_exp_f32 v200, v200
v_mfma_f32_16x16x32_bf16 v[220:223], v[244:247], v[108:111], v[220:223]
s_waitcnt lgkmcnt(2)
v_mfma_f32_16x16x32_bf16 v[208:211], v[224:227], v[16:19], v[208:211]
ds_read_b128 v[240:243], v248 offset:32768
v_mfma_f32_16x16x32_bf16 v[208:211], v[228:231], v[20:23], v[208:211]
v_exp_f32 v201, v201
v_mfma_f32_16x16x32_bf16 v[212:215], v[224:227], v[48:51], v[212:215]
v_exp_f32 v202, v202
v_mfma_f32_16x16x32_bf16 v[212:215], v[228:231], v[52:55], v[212:215]
v_exp_f32 v203, v203
v_mfma_f32_16x16x32_bf16 v[216:219], v[224:227], v[80:83], v[216:219]
ds_read_b128 v[244:247], v248 offset:33280
v_cvt_pk_bf16_f32 v152, v200, v201
v_mfma_f32_16x16x32_bf16 v[216:219], v[228:231], v[84:87], v[216:219]
v_cvt_pk_bf16_f32 v153, v202, v203
v_mfma_f32_16x16x32_bf16 v[220:223], v[224:227], v[112:115], v[220:223]
v_exp_f32 v204, v204
v_mfma_f32_16x16x32_bf16 v[220:223], v[228:231], v[116:119], v[220:223]
s_waitcnt lgkmcnt(2)
v_mfma_f32_16x16x32_bf16 v[208:211], v[232:235], v[24:27], v[208:211]
ds_read_b128 v[224:227], v248 offset:36864
v_mfma_f32_16x16x32_bf16 v[208:211], v[236:239], v[28:31], v[208:211]
v_exp_f32 v205, v205
v_mfma_f32_16x16x32_bf16 v[212:215], v[232:235], v[56:59], v[212:215]
v_exp_f32 v206, v206
v_mfma_f32_16x16x32_bf16 v[212:215], v[236:239], v[60:63], v[212:215]
v_exp_f32 v207, v207
v_mfma_f32_16x16x32_bf16 v[216:219], v[232:235], v[88:91], v[216:219]
ds_read_b128 v[228:231], v248 offset:37376
v_cvt_pk_bf16_f32 v156, v204, v205
v_mfma_f32_16x16x32_bf16 v[216:219], v[236:239], v[92:95], v[216:219]
v_cvt_pk_bf16_f32 v157, v206, v207
v_mfma_f32_16x16x32_bf16 v[220:223], v[232:235], v[120:123], v[220:223]
v_mfma_f32_16x16x32_bf16 v[220:223], v[236:239], v[124:127], v[220:223]
s_waitcnt lgkmcnt(2)
v_mfma_f32_16x16x32_bf16 v[192:195], v[240:243], v[0:3], 0
ds_read_b128 v[232:235], v248 offset:40960
v_mfma_f32_16x16x32_bf16 v[192:195], v[244:247], v[4:7], v[192:195]
v_exp_f32 v208, v208
v_mfma_f32_16x16x32_bf16 v[196:199], v[240:243], v[32:35], 0
v_exp_f32 v209, v209
v_mfma_f32_16x16x32_bf16 v[196:199], v[244:247], v[36:39], v[196:199]
v_exp_f32 v210, v210
v_mfma_f32_16x16x32_bf16 v[200:203], v[240:243], v[64:67], 0
ds_read_b128 v[236:239], v248 offset:41472
v_cvt_pk_bf16_f32 v146, v208, v209
v_mfma_f32_16x16x32_bf16 v[200:203], v[244:247], v[68:71], v[200:203]
v_exp_f32 v211, v211
v_mfma_f32_16x16x32_bf16 v[204:207], v[240:243], v[96:99], 0
v_exp_f32 v212, v212
v_mfma_f32_16x16x32_bf16 v[204:207], v[244:247], v[100:103], v[204:207]
s_waitcnt lgkmcnt(2)
v_cvt_pk_bf16_f32 v147, v210, v211
v_mfma_f32_16x16x32_bf16 v[192:195], v[224:227], v[8:11], v[192:195]
ds_read_b128 v[240:243], v248 offset:45056
v_mfma_f32_16x16x32_bf16 v[192:195], v[228:231], v[12:15], v[192:195]
v_exp_f32 v213, v213
v_mfma_f32_16x16x32_bf16 v[196:199], v[224:227], v[40:43], v[196:199]
v_exp_f32 v214, v214
v_mfma_f32_16x16x32_bf16 v[196:199], v[228:231], v[44:47], v[196:199]
v_exp_f32 v215, v215
v_mfma_f32_16x16x32_bf16 v[200:203], v[224:227], v[72:75], v[200:203]
ds_read_b128 v[244:247], v248 offset:45568
v_cvt_pk_bf16_f32 v150, v212, v213
v_mfma_f32_16x16x32_bf16 v[200:203], v[228:231], v[76:79], v[200:203]
v_cvt_pk_bf16_f32 v151, v214, v215
v_mfma_f32_16x16x32_bf16 v[204:207], v[224:227], v[104:107], v[204:207]
v_exp_f32 v216, v216
v_mfma_f32_16x16x32_bf16 v[204:207], v[228:231], v[108:111], v[204:207]
s_waitcnt lgkmcnt(2)
v_mfma_f32_16x16x32_bf16 v[192:195], v[232:235], v[16:19], v[192:195]
ds_read_b128 v[224:227], v248 offset:34816
v_mfma_f32_16x16x32_bf16 v[192:195], v[236:239], v[20:23], v[192:195]
v_exp_f32 v217, v217
v_mfma_f32_16x16x32_bf16 v[196:199], v[232:235], v[48:51], v[196:199]
v_exp_f32 v218, v218
v_mfma_f32_16x16x32_bf16 v[196:199], v[236:239], v[52:55], v[196:199]
v_exp_f32 v219, v219
v_mfma_f32_16x16x32_bf16 v[200:203], v[232:235], v[80:83], v[200:203]
ds_read_b128 v[228:231], v248 offset:35328
v_cvt_pk_bf16_f32 v154, v216, v217
v_mfma_f32_16x16x32_bf16 v[200:203], v[236:239], v[84:87], v[200:203]
v_cvt_pk_bf16_f32 v155, v218, v219
v_mfma_f32_16x16x32_bf16 v[204:207], v[232:235], v[112:115], v[204:207]
v_exp_f32 v220, v220
v_mfma_f32_16x16x32_bf16 v[204:207], v[236:239], v[116:119], v[204:207]
s_waitcnt lgkmcnt(2)
v_mfma_f32_16x16x32_bf16 v[192:195], v[240:243], v[24:27], v[192:195]
ds_read_b128 v[232:235], v248 offset:38912
v_mfma_f32_16x16x32_bf16 v[192:195], v[244:247], v[28:31], v[192:195]
v_exp_f32 v221, v221
v_mfma_f32_16x16x32_bf16 v[196:199], v[240:243], v[56:59], v[196:199]
v_exp_f32 v222, v222
v_mfma_f32_16x16x32_bf16 v[196:199], v[244:247], v[60:63], v[196:199]
v_exp_f32 v223, v223
v_mfma_f32_16x16x32_bf16 v[200:203], v[240:243], v[88:91], v[200:203]
ds_read_b128 v[236:239], v248 offset:39424
v_cvt_pk_bf16_f32 v158, v220, v221
v_mfma_f32_16x16x32_bf16 v[200:203], v[244:247], v[92:95], v[200:203]
v_cvt_pk_bf16_f32 v159, v222, v223
v_mfma_f32_16x16x32_bf16 v[204:207], v[240:243], v[120:123], v[204:207]
v_mfma_f32_16x16x32_bf16 v[204:207], v[244:247], v[124:127], v[204:207]
s_waitcnt lgkmcnt(2)
v_mfma_f32_16x16x32_bf16 v[208:211], v[224:227], v[0:3], 0
ds_read_b128 v[240:243], v248 offset:43008
v_mfma_f32_16x16x32_bf16 v[208:211], v[228:231], v[4:7], v[208:211]
v_exp_f32 v192, v192
v_mfma_f32_16x16x32_bf16 v[212:215], v[224:227], v[32:35], 0
v_exp_f32 v193, v193
v_mfma_f32_16x16x32_bf16 v[212:215], v[228:231], v[36:39], v[212:215]
v_exp_f32 v194, v194
v_mfma_f32_16x16x32_bf16 v[216:219], v[224:227], v[64:67], 0
ds_read_b128 v[244:247], v248 offset:43520
v_cvt_pk_bf16_f32 v160, v192, v193
v_mfma_f32_16x16x32_bf16 v[216:219], v[228:231], v[68:71], v[216:219]
v_exp_f32 v195, v195
v_mfma_f32_16x16x32_bf16 v[220:223], v[224:227], v[96:99], 0
v_exp_f32 v196, v196
v_mfma_f32_16x16x32_bf16 v[220:223], v[228:231], v[100:103], v[220:223]
s_waitcnt lgkmcnt(2)
v_cvt_pk_bf16_f32 v161, v194, v195
v_mfma_f32_16x16x32_bf16 v[208:211], v[232:235], v[8:11], v[208:211]
ds_read_b128 v[224:227], v248 offset:47104
v_mfma_f32_16x16x32_bf16 v[208:211], v[236:239], v[12:15], v[208:211]
v_exp_f32 v197, v197
v_mfma_f32_16x16x32_bf16 v[212:215], v[232:235], v[40:43], v[212:215]
v_exp_f32 v198, v198
v_mfma_f32_16x16x32_bf16 v[212:215], v[236:239], v[44:47], v[212:215]
v_exp_f32 v199, v199
v_mfma_f32_16x16x32_bf16 v[216:219], v[232:235], v[72:75], v[216:219]
ds_read_b128 v[228:231], v248 offset:47616
v_cvt_pk_bf16_f32 v164, v196, v197
v_mfma_f32_16x16x32_bf16 v[216:219], v[236:239], v[76:79], v[216:219]
v_cvt_pk_bf16_f32 v165, v198, v199
v_mfma_f32_16x16x32_bf16 v[220:223], v[232:235], v[104:107], v[220:223]
v_exp_f32 v200, v200
v_mfma_f32_16x16x32_bf16 v[220:223], v[236:239], v[108:111], v[220:223]
s_waitcnt lgkmcnt(2)
s_waitcnt vmcnt(0)
s_barrier
v_mfma_f32_16x16x32_bf16 v[208:211], v[240:243], v[16:19], v[208:211]
ds_read_b128 v[232:235], v248 offset:49152
v_mfma_f32_16x16x32_bf16 v[208:211], v[244:247], v[20:23], v[208:211]
v_exp_f32 v201, v201
v_mfma_f32_16x16x32_bf16 v[212:215], v[240:243], v[48:51], v[212:215]
v_exp_f32 v202, v202
v_mfma_f32_16x16x32_bf16 v[212:215], v[244:247], v[52:55], v[212:215]
v_exp_f32 v203, v203
v_mfma_f32_16x16x32_bf16 v[216:219], v[240:243], v[80:83], v[216:219]
ds_read_b128 v[236:239], v248 offset:49664
v_cvt_pk_bf16_f32 v168, v200, v201
v_mfma_f32_16x16x32_bf16 v[216:219], v[244:247], v[84:87], v[216:219]
v_cvt_pk_bf16_f32 v169, v202, v203
v_mfma_f32_16x16x32_bf16 v[220:223], v[240:243], v[112:115], v[220:223]
v_exp_f32 v204, v204
v_mfma_f32_16x16x32_bf16 v[220:223], v[244:247], v[116:119], v[220:223]
s_waitcnt lgkmcnt(2)
v_mfma_f32_16x16x32_bf16 v[208:211], v[224:227], v[24:27], v[208:211]
ds_read_b128 v[240:243], v248 offset:53248
v_mfma_f32_16x16x32_bf16 v[208:211], v[228:231], v[28:31], v[208:211]
v_exp_f32 v205, v205
v_mfma_f32_16x16x32_bf16 v[212:215], v[224:227], v[56:59], v[212:215]
v_exp_f32 v206, v206
v_mfma_f32_16x16x32_bf16 v[212:215], v[228:231], v[60:63], v[212:215]
v_exp_f32 v207, v207
v_mfma_f32_16x16x32_bf16 v[216:219], v[224:227], v[88:91], v[216:219]
ds_read_b128 v[244:247], v248 offset:53760
v_cvt_pk_bf16_f32 v172, v204, v205
v_mfma_f32_16x16x32_bf16 v[216:219], v[228:231], v[92:95], v[216:219]
v_cvt_pk_bf16_f32 v173, v206, v207
v_mfma_f32_16x16x32_bf16 v[220:223], v[224:227], v[120:123], v[220:223]
v_mfma_f32_16x16x32_bf16 v[220:223], v[228:231], v[124:127], v[220:223]
s_waitcnt lgkmcnt(2)
v_mfma_f32_16x16x32_bf16 v[192:195], v[232:235], v[0:3], 0
ds_read_b128 v[224:227], v248 offset:57344
v_mfma_f32_16x16x32_bf16 v[192:195], v[236:239], v[4:7], v[192:195]
v_exp_f32 v208, v208
v_mfma_f32_16x16x32_bf16 v[196:199], v[232:235], v[32:35], 0
v_exp_f32 v209, v209
v_mfma_f32_16x16x32_bf16 v[196:199], v[236:239], v[36:39], v[196:199]
v_exp_f32 v210, v210
v_mfma_f32_16x16x32_bf16 v[200:203], v[232:235], v[64:67], 0
ds_read_b128 v[228:231], v248 offset:57856
v_cvt_pk_bf16_f32 v162, v208, v209
v_mfma_f32_16x16x32_bf16 v[200:203], v[236:239], v[68:71], v[200:203]
v_exp_f32 v211, v211
v_mfma_f32_16x16x32_bf16 v[204:207], v[232:235], v[96:99], 0
v_exp_f32 v212, v212
v_mfma_f32_16x16x32_bf16 v[204:207], v[236:239], v[100:103], v[204:207]
s_waitcnt lgkmcnt(2)
v_cvt_pk_bf16_f32 v163, v210, v211
v_mfma_f32_16x16x32_bf16 v[192:195], v[240:243], v[8:11], v[192:195]
ds_read_b128 v[232:235], v248 offset:61440
v_mfma_f32_16x16x32_bf16 v[192:195], v[244:247], v[12:15], v[192:195]
v_exp_f32 v213, v213
v_mfma_f32_16x16x32_bf16 v[196:199], v[240:243], v[40:43], v[196:199]
v_exp_f32 v214, v214
v_mfma_f32_16x16x32_bf16 v[196:199], v[244:247], v[44:47], v[196:199]
v_exp_f32 v215, v215
v_mfma_f32_16x16x32_bf16 v[200:203], v[240:243], v[72:75], v[200:203]
ds_read_b128 v[236:239], v248 offset:61952
v_cvt_pk_bf16_f32 v166, v212, v213
v_mfma_f32_16x16x32_bf16 v[200:203], v[244:247], v[76:79], v[200:203]
v_cvt_pk_bf16_f32 v167, v214, v215
v_mfma_f32_16x16x32_bf16 v[204:207], v[240:243], v[104:107], v[204:207]
v_exp_f32 v216, v216
v_mfma_f32_16x16x32_bf16 v[204:207], v[244:247], v[108:111], v[204:207]
s_waitcnt lgkmcnt(2)
v_mfma_f32_16x16x32_bf16 v[192:195], v[224:227], v[16:19], v[192:195]
ds_read_b128 v[240:243], v248 offset:51200
v_mfma_f32_16x16x32_bf16 v[192:195], v[228:231], v[20:23], v[192:195]
v_exp_f32 v217, v217
v_mfma_f32_16x16x32_bf16 v[196:199], v[224:227], v[48:51], v[196:199]
v_exp_f32 v218, v218
v_mfma_f32_16x16x32_bf16 v[196:199], v[228:231], v[52:55], v[196:199]
v_exp_f32 v219, v219
v_mfma_f32_16x16x32_bf16 v[200:203], v[224:227], v[80:83], v[200:203]
ds_read_b128 v[244:247], v248 offset:51712
v_cvt_pk_bf16_f32 v170, v216, v217
v_mfma_f32_16x16x32_bf16 v[200:203], v[228:231], v[84:87], v[200:203]
v_cvt_pk_bf16_f32 v171, v218, v219
v_mfma_f32_16x16x32_bf16 v[204:207], v[224:227], v[112:115], v[204:207]
v_exp_f32 v220, v220
v_mfma_f32_16x16x32_bf16 v[204:207], v[228:231], v[116:119], v[204:207]
s_waitcnt lgkmcnt(2)
v_mfma_f32_16x16x32_bf16 v[192:195], v[232:235], v[24:27], v[192:195]
ds_read_b128 v[224:227], v248 offset:55296
v_mfma_f32_16x16x32_bf16 v[192:195], v[236:239], v[28:31], v[192:195]
v_exp_f32 v221, v221
v_mfma_f32_16x16x32_bf16 v[196:199], v[232:235], v[56:59], v[196:199]
v_exp_f32 v222, v222
v_mfma_f32_16x16x32_bf16 v[196:199], v[236:239], v[60:63], v[196:199]
v_exp_f32 v223, v223
v_mfma_f32_16x16x32_bf16 v[200:203], v[232:235], v[88:91], v[200:203]
ds_read_b128 v[228:231], v248 offset:55808
v_cvt_pk_bf16_f32 v174, v220, v221
v_mfma_f32_16x16x32_bf16 v[200:203], v[236:239], v[92:95], v[200:203]
v_cvt_pk_bf16_f32 v175, v222, v223
v_mfma_f32_16x16x32_bf16 v[204:207], v[232:235], v[120:123], v[204:207]
v_mfma_f32_16x16x32_bf16 v[204:207], v[236:239], v[124:127], v[204:207]
s_waitcnt lgkmcnt(2)
v_mfma_f32_16x16x32_bf16 v[208:211], v[240:243], v[0:3], 0
ds_read_b128 v[232:235], v248 offset:59392
v_mfma_f32_16x16x32_bf16 v[208:211], v[244:247], v[4:7], v[208:211]
v_exp_f32 v192, v192
v_mfma_f32_16x16x32_bf16 v[212:215], v[240:243], v[32:35], 0
v_exp_f32 v193, v193
v_mfma_f32_16x16x32_bf16 v[212:215], v[244:247], v[36:39], v[212:215]
v_exp_f32 v194, v194
v_mfma_f32_16x16x32_bf16 v[216:219], v[240:243], v[64:67], 0
ds_read_b128 v[236:239], v248 offset:59904
v_cvt_pk_bf16_f32 v176, v192, v193
v_mfma_f32_16x16x32_bf16 v[216:219], v[244:247], v[68:71], v[216:219]
v_exp_f32 v195, v195
v_mfma_f32_16x16x32_bf16 v[220:223], v[240:243], v[96:99], 0
v_exp_f32 v196, v196
v_mfma_f32_16x16x32_bf16 v[220:223], v[244:247], v[100:103], v[220:223]
s_waitcnt lgkmcnt(2)
v_cvt_pk_bf16_f32 v177, v194, v195
v_mfma_f32_16x16x32_bf16 v[208:211], v[224:227], v[8:11], v[208:211]
ds_read_b128 v[240:243], v248 offset:63488
v_mfma_f32_16x16x32_bf16 v[208:211], v[228:231], v[12:15], v[208:211]
v_exp_f32 v197, v197
v_mfma_f32_16x16x32_bf16 v[212:215], v[224:227], v[40:43], v[212:215]
v_exp_f32 v198, v198
v_mfma_f32_16x16x32_bf16 v[212:215], v[228:231], v[44:47], v[212:215]
v_exp_f32 v199, v199
v_mfma_f32_16x16x32_bf16 v[216:219], v[224:227], v[72:75], v[216:219]
ds_read_b128 v[244:247], v248 offset:64000
v_cvt_pk_bf16_f32 v180, v196, v197
v_mfma_f32_16x16x32_bf16 v[216:219], v[228:231], v[76:79], v[216:219]
v_cvt_pk_bf16_f32 v181, v198, v199
v_mfma_f32_16x16x32_bf16 v[220:223], v[224:227], v[104:107], v[220:223]
v_exp_f32 v200, v200
v_mfma_f32_16x16x32_bf16 v[220:223], v[228:231], v[108:111], v[220:223]
s_waitcnt lgkmcnt(2)
v_xor_b32 v248, 0x10000, v248
v_mfma_f32_16x16x32_bf16 v[208:211], v[232:235], v[16:19], v[208:211]
ds_read_b128 v[224:227], v248 offset:0
v_mfma_f32_16x16x32_bf16 v[208:211], v[236:239], v[20:23], v[208:211]
v_exp_f32 v201, v201
v_mfma_f32_16x16x32_bf16 v[212:215], v[232:235], v[48:51], v[212:215]
v_exp_f32 v202, v202
v_mfma_f32_16x16x32_bf16 v[212:215], v[236:239], v[52:55], v[212:215]
v_exp_f32 v203, v203
v_mfma_f32_16x16x32_bf16 v[216:219], v[232:235], v[80:83], v[216:219]
ds_read_b128 v[228:231], v248 offset:512
v_cvt_pk_bf16_f32 v184, v200, v201
v_mfma_f32_16x16x32_bf16 v[216:219], v[236:239], v[84:87], v[216:219]
v_cvt_pk_bf16_f32 v185, v202, v203
v_mfma_f32_16x16x32_bf16 v[220:223], v[232:235], v[112:115], v[220:223]
v_exp_f32 v204, v204
v_mfma_f32_16x16x32_bf16 v[220:223], v[236:239], v[116:119], v[220:223]
s_waitcnt lgkmcnt(2)
v_mfma_f32_16x16x32_bf16 v[208:211], v[240:243], v[24:27], v[208:211]
ds_read_b128 v[232:235], v248 offset:4096
v_mfma_f32_16x16x32_bf16 v[208:211], v[244:247], v[28:31], v[208:211]
v_exp_f32 v205, v205
v_mfma_f32_16x16x32_bf16 v[212:215], v[240:243], v[56:59], v[212:215]
v_exp_f32 v206, v206
v_mfma_f32_16x16x32_bf16 v[212:215], v[244:247], v[60:63], v[212:215]
v_exp_f32 v207, v207
v_mfma_f32_16x16x32_bf16 v[216:219], v[240:243], v[88:91], v[216:219]
ds_read_b128 v[236:239], v248 offset:4608
v_cvt_pk_bf16_f32 v188, v204, v205
v_mfma_f32_16x16x32_bf16 v[216:219], v[244:247], v[92:95], v[216:219]
v_cvt_pk_bf16_f32 v189, v206, v207
v_mfma_f32_16x16x32_bf16 v[220:223], v[240:243], v[120:123], v[220:223]
v_mfma_f32_16x16x32_bf16 v[220:223], v[244:247], v[124:127], v[220:223]
s_waitcnt lgkmcnt(2)
v_mfma_f32_16x16x32_bf16 v[192:195], v[224:227], v[0:3], 0
ds_read_b128 v[240:243], v248 offset:8192
v_mfma_f32_16x16x32_bf16 v[192:195], v[228:231], v[4:7], v[192:195]
v_exp_f32 v208, v208
v_mfma_f32_16x16x32_bf16 v[196:199], v[224:227], v[32:35], 0
v_exp_f32 v209, v209
v_mfma_f32_16x16x32_bf16 v[196:199], v[228:231], v[36:39], v[196:199]
v_exp_f32 v210, v210
v_mfma_f32_16x16x32_bf16 v[200:203], v[224:227], v[64:67], 0
ds_read_b128 v[244:247], v248 offset:8704
v_cvt_pk_bf16_f32 v178, v208, v209
v_mfma_f32_16x16x32_bf16 v[200:203], v[228:231], v[68:71], v[200:203]
v_exp_f32 v211, v211
v_mfma_f32_16x16x32_bf16 v[204:207], v[224:227], v[96:99], 0
v_exp_f32 v212, v212
v_mfma_f32_16x16x32_bf16 v[204:207], v[228:231], v[100:103], v[204:207]
s_waitcnt lgkmcnt(2)
v_cvt_pk_bf16_f32 v179, v210, v211
v_mfma_f32_16x16x32_bf16 v[192:195], v[232:235], v[8:11], v[192:195]
ds_read_b128 v[224:227], v248 offset:12288
v_mfma_f32_16x16x32_bf16 v[192:195], v[236:239], v[12:15], v[192:195]
v_exp_f32 v213, v213
v_mfma_f32_16x16x32_bf16 v[196:199], v[232:235], v[40:43], v[196:199]
ds_read_b128 v[4:7], v255 offset:0
ds_read_b128 v[36:39], v255 offset:1024
v_mfma_f32_16x16x32_bf16 v[196:199], v[236:239], v[44:47], v[196:199]
v_exp_f32 v214, v214
v_mfma_f32_16x16x32_bf16 v[200:203], v[232:235], v[72:75], v[200:203]
ds_read_b128 v[228:231], v248 offset:12800
v_xor_b32 v12, 0x10000, v249
v_mfma_f32_16x16x32_bf16 v[200:203], v[236:239], v[76:79], v[200:203]
v_xor_b32 v13, 0x10000, v250
v_cvt_pk_bf16_f32 v182, v212, v213
v_mfma_f32_16x16x32_bf16 v[204:207], v[232:235], v[104:107], v[204:207]
ds_read_b128 v[68:71], v255 offset:2048
ds_read_b128 v[100:103], v255 offset:3072
v_mfma_f32_16x16x32_bf16 v[204:207], v[236:239], v[108:111], v[204:207]
s_waitcnt lgkmcnt(6)
v_mov_b32 v2, 0
v_mfma_f32_16x16x32_bf16 v[192:195], v[240:243], v[16:19], v[192:195]
ds_read_b64_tr_b16 v[232:233], v12 offset:0
ds_read_b64_tr_b16 v[234:235], v12 offset:2048
v_mfma_f32_16x16x32_bf16 v[192:195], v[244:247], v[20:23], v[192:195]
v_exp_f32 v215, v215
v_mfma_f32_16x16x32_bf16 v[196:199], v[240:243], v[48:51], v[196:199]
ds_read_b128 v[8:11], v255 offset:4096
ds_read_b128 v[40:43], v255 offset:5120
v_mfma_f32_16x16x32_bf16 v[196:199], v[244:247], v[52:55], v[196:199]
v_cvt_pk_bf16_f32 v183, v214, v215
v_mov_b32 v3, 0
v_mfma_f32_16x16x32_bf16 v[200:203], v[240:243], v[80:83], v[200:203]
ds_read_b64_tr_b16 v[236:237], v12 offset:16384
ds_read_b64_tr_b16 v[238:239], v12 offset:18432
v_mfma_f32_16x16x32_bf16 v[200:203], v[244:247], v[84:87], v[200:203]
v_exp_f32 v216, v216
v_mfma_f32_16x16x32_bf16 v[204:207], v[240:243], v[112:115], v[204:207]
ds_read_b128 v[72:75], v255 offset:6144
ds_read_b128 v[104:107], v255 offset:7168
v_mfma_f32_16x16x32_bf16 v[204:207], v[244:247], v[116:119], v[204:207]
s_waitcnt lgkmcnt(10)
v_mov_b32 v34, 0
v_mfma_f32_16x16x32_bf16 v[192:195], v[224:227], v[24:27], v[192:195]
ds_read_b64_tr_b16 v[240:241], v12 offset:32768
ds_read_b64_tr_b16 v[242:243], v12 offset:34816
v_mfma_f32_16x16x32_bf16 v[192:195], v[228:231], v[28:31], v[192:195]
v_exp_f32 v217, v217
v_mfma_f32_16x16x32_bf16 v[196:199], v[224:227], v[56:59], v[196:199]
v_exp_f32 v218, v218
v_mfma_f32_16x16x32_bf16 v[196:199], v[228:231], v[60:63], v[196:199]
v_exp_f32 v219, v219
v_mfma_f32_16x16x32_bf16 v[200:203], v[224:227], v[88:91], v[200:203]
ds_read_b64_tr_b16 v[244:245], v12 offset:49152
ds_read_b64_tr_b16 v[246:247], v12 offset:51200
v_mfma_f32_16x16x32_bf16 v[200:203], v[228:231], v[92:95], v[200:203]
v_cvt_pk_bf16_f32 v186, v216, v217
v_cvt_pk_bf16_f32 v187, v218, v219
v_mfma_f32_16x16x32_bf16 v[204:207], v[224:227], v[120:123], v[204:207]
v_exp_f32 v220, v220
v_mfma_f32_16x16x32_bf16 v[204:207], v[228:231], v[124:127], v[204:207]
s_waitcnt lgkmcnt(6)
s_waitcnt lgkmcnt(4)
v_mfma_f32_16x16x32_bf16 a[0:3], v[232:235], v[128:131], a[0:3]
ds_read_b64_tr_b16 v[224:225], v13 offset:0
ds_read_b64_tr_b16 v[226:227], v13 offset:2048
v_mfma_f32_16x16x32_bf16 a[0:3], v[236:239], v[144:147], a[0:3]
v_exp_f32 v221, v221
v_mfma_f32_16x16x32_bf16 a[4:7], v[232:235], v[132:135], a[4:7]
v_exp_f32 v222, v222
v_mfma_f32_16x16x32_bf16 a[4:7], v[236:239], v[148:151], a[4:7]
v_exp_f32 v223, v223
v_mfma_f32_16x16x32_bf16 a[8:11], v[232:235], v[136:139], a[8:11]
ds_read_b64_tr_b16 v[228:229], v13 offset:16384
ds_read_b64_tr_b16 v[230:231], v13 offset:18432
v_mfma_f32_16x16x32_bf16 a[8:11], v[236:239], v[152:155], a[8:11]
v_cvt_pk_bf16_f32 v190, v220, v221
v_cvt_pk_bf16_f32 v191, v222, v223
v_mfma_f32_16x16x32_bf16 a[12:15], v[232:235], v[140:143], a[12:15]
v_exp_f32 v192, v192
v_mfma_f32_16x16x32_bf16 a[12:15], v[236:239], v[156:159], a[12:15]
s_waitcnt lgkmcnt(4)
v_mov_b32 v35, 0
v_mfma_f32_16x16x32_bf16 a[0:3], v[240:243], v[160:163], a[0:3]
ds_read_b64_tr_b16 v[232:233], v13 offset:32768
ds_read_b64_tr_b16 v[234:235], v13 offset:34816
v_mfma_f32_16x16x32_bf16 a[0:3], v[244:247], v[176:179], a[0:3]
v_exp_f32 v193, v193
v_mfma_f32_16x16x32_bf16 a[4:7], v[240:243], v[164:167], a[4:7]
v_exp_f32 v194, v194
v_mfma_f32_16x16x32_bf16 a[4:7], v[244:247], v[180:183], a[4:7]
v_exp_f32 v195, v195
v_mfma_f32_16x16x32_bf16 a[8:11], v[240:243], v[168:171], a[8:11]
ds_read_b64_tr_b16 v[236:237], v13 offset:49152
ds_read_b64_tr_b16 v[238:239], v13 offset:51200
v_mfma_f32_16x16x32_bf16 a[8:11], v[244:247], v[184:187], a[8:11]
v_cvt_pk_bf16_f32 v0, v192, v193
v_cvt_pk_bf16_f32 v1, v194, v195
v_mfma_f32_16x16x32_bf16 a[12:15], v[240:243], v[172:175], a[12:15]
v_exp_f32 v196, v196
v_mfma_f32_16x16x32_bf16 a[12:15], v[244:247], v[188:191], a[12:15]
s_waitcnt lgkmcnt(4)
v_mov_b32 v66, 0
v_mfma_f32_16x16x32_bf16 a[16:19], v[224:227], v[128:131], a[16:19]
ds_read_b64_tr_b16 v[240:241], v249 offset:33280
ds_read_b64_tr_b16 v[242:243], v249 offset:35328
v_mfma_f32_16x16x32_bf16 a[16:19], v[228:231], v[144:147], a[16:19]
v_exp_f32 v197, v197
v_mfma_f32_16x16x32_bf16 a[20:23], v[224:227], v[132:135], a[20:23]
v_exp_f32 v198, v198
v_mfma_f32_16x16x32_bf16 a[20:23], v[228:231], v[148:151], a[20:23]
v_exp_f32 v199, v199
v_mfma_f32_16x16x32_bf16 a[24:27], v[224:227], v[136:139], a[24:27]
ds_read_b64_tr_b16 v[244:245], v249 offset:49664
ds_read_b64_tr_b16 v[246:247], v249 offset:51712
v_mfma_f32_16x16x32_bf16 a[24:27], v[228:231], v[152:155], a[24:27]
v_cvt_pk_bf16_f32 v32, v196, v197
v_cvt_pk_bf16_f32 v33, v198, v199
v_mfma_f32_16x16x32_bf16 a[28:31], v[224:227], v[140:143], a[28:31]
v_exp_f32 v200, v200
v_mfma_f32_16x16x32_bf16 a[28:31], v[228:231], v[156:159], a[28:31]
s_waitcnt lgkmcnt(4)
v_mov_b32 v67, 0
v_mfma_f32_16x16x32_bf16 a[16:19], v[232:235], v[160:163], a[16:19]
ds_read_b64_tr_b16 v[224:225], v12 offset:512
ds_read_b64_tr_b16 v[226:227], v12 offset:2560
v_mfma_f32_16x16x32_bf16 a[16:19], v[236:239], v[176:179], a[16:19]
v_exp_f32 v201, v201
v_mfma_f32_16x16x32_bf16 a[20:23], v[232:235], v[164:167], a[20:23]
v_exp_f32 v202, v202
v_mfma_f32_16x16x32_bf16 a[20:23], v[236:239], v[180:183], a[20:23]
v_exp_f32 v203, v203
v_mfma_f32_16x16x32_bf16 a[24:27], v[232:235], v[168:171], a[24:27]
ds_read_b64_tr_b16 v[228:229], v12 offset:16896
ds_read_b64_tr_b16 v[230:231], v12 offset:18944
v_mfma_f32_16x16x32_bf16 a[24:27], v[236:239], v[184:187], a[24:27]
v_cvt_pk_bf16_f32 v64, v200, v201
v_cvt_pk_bf16_f32 v65, v202, v203
v_mfma_f32_16x16x32_bf16 a[28:31], v[232:235], v[172:175], a[28:31]
v_exp_f32 v204, v204
v_mfma_f32_16x16x32_bf16 a[28:31], v[236:239], v[188:191], a[28:31]
s_waitcnt lgkmcnt(4)
v_mov_b32 v98, 0
v_mfma_f32_16x16x32_bf16 a[32:35], v[240:243], v[4:7], a[32:35]
ds_read_b64_tr_b16 v[232:233], v249 offset:0
ds_read_b64_tr_b16 v[234:235], v249 offset:2048
v_mfma_f32_16x16x32_bf16 a[32:35], v[244:247], v[8:11], a[32:35]
v_exp_f32 v205, v205
v_mfma_f32_16x16x32_bf16 a[36:39], v[240:243], v[36:39], a[36:39]
v_exp_f32 v206, v206
v_mfma_f32_16x16x32_bf16 a[36:39], v[244:247], v[40:43], a[36:39]
v_exp_f32 v207, v207
v_mfma_f32_16x16x32_bf16 a[40:43], v[240:243], v[68:71], a[40:43]
ds_read_b64_tr_b16 v[236:237], v250 offset:0
ds_read_b64_tr_b16 v[238:239], v250 offset:2048
v_mfma_f32_16x16x32_bf16 a[40:43], v[244:247], v[72:75], a[40:43]
v_cvt_pk_bf16_f32 v96, v204, v205
v_cvt_pk_bf16_f32 v97, v206, v207
v_mfma_f32_16x16x32_bf16 a[44:47], v[240:243], v[100:103], a[44:47]
v_mov_b32 v99, 0
v_mfma_f32_16x16x32_bf16 a[44:47], v[244:247], v[104:107], a[44:47]
s_waitcnt lgkmcnt(4)
v_mfma_f32_16x16x32_bf16 a[32:35], v[224:227], v[128:131], a[32:35]
ds_read_b64_tr_b16 v[240:241], v12 offset:33280
ds_read_b64_tr_b16 v[242:243], v12 offset:35328
v_mfma_f32_16x16x32_bf16 a[32:35], v[228:231], v[144:147], a[32:35]
v_mfma_f32_16x16x32_bf16 a[36:39], v[224:227], v[132:135], a[36:39]
v_mfma_f32_16x16x32_bf16 a[36:39], v[228:231], v[148:151], a[36:39]
v_mfma_f32_16x16x32_bf16 a[40:43], v[224:227], v[136:139], a[40:43]
ds_read_b64_tr_b16 v[244:245], v12 offset:49664
ds_read_b64_tr_b16 v[246:247], v12 offset:51712
v_mfma_f32_16x16x32_bf16 a[40:43], v[228:231], v[152:155], a[40:43]
v_mfma_f32_16x16x32_bf16 a[44:47], v[224:227], v[140:143], a[44:47]
v_mfma_f32_16x16x32_bf16 a[44:47], v[228:231], v[156:159], a[44:47]
s_waitcnt lgkmcnt(4)
v_mfma_f32_16x16x32_bf16 a[0:3], v[232:235], v[0:3], a[0:3]
ds_read_b64_tr_b16 v[224:225], v249 offset:512
ds_read_b64_tr_b16 v[226:227], v249 offset:2560
v_mfma_f32_16x16x32_bf16 a[4:7], v[232:235], v[32:35], a[4:7]
v_mfma_f32_16x16x32_bf16 a[8:11], v[232:235], v[64:67], a[8:11]
v_mfma_f32_16x16x32_bf16 a[12:15], v[232:235], v[96:99], a[12:15]
v_mfma_f32_16x16x32_bf16 a[16:19], v[236:239], v[0:3], a[16:19]
ds_read_b64_tr_b16 v[228:229], v250 offset:512
ds_read_b64_tr_b16 v[230:231], v250 offset:2560
v_mfma_f32_16x16x32_bf16 a[20:23], v[236:239], v[32:35], a[20:23]
v_mfma_f32_16x16x32_bf16 a[24:27], v[236:239], v[64:67], a[24:27]
v_mfma_f32_16x16x32_bf16 a[28:31], v[236:239], v[96:99], a[28:31]
s_waitcnt lgkmcnt(4)
v_mfma_f32_16x16x32_bf16 a[32:35], v[240:243], v[160:163], a[32:35]
ds_read_b64_tr_b16 v[232:233], v250 offset:33280
ds_read_b64_tr_b16 v[234:235], v250 offset:35328
v_mfma_f32_16x16x32_bf16 a[32:35], v[244:247], v[176:179], a[32:35]
v_mfma_f32_16x16x32_bf16 a[36:39], v[240:243], v[164:167], a[36:39]
v_mfma_f32_16x16x32_bf16 a[36:39], v[244:247], v[180:183], a[36:39]
v_mfma_f32_16x16x32_bf16 a[40:43], v[240:243], v[168:171], a[40:43]
ds_read_b64_tr_b16 v[236:237], v250 offset:49664
ds_read_b64_tr_b16 v[238:239], v250 offset:51712
v_accvgpr_read_b32 v192, a0
v_mfma_f32_16x16x32_bf16 a[40:43], v[244:247], v[184:187], a[40:43]
v_accvgpr_read_b32 v193, a4
v_accvgpr_read_b32 v194, a8
v_accvgpr_read_b32 v195, a12
v_mfma_f32_16x16x32_bf16 a[44:47], v[240:243], v[172:175], a[44:47]
v_lshlrev_b32 v253, 2, v252
v_subrev_u32 v196, 0x0d800000, v192
v_subrev_u32 v197, 0x0d800000, v193
v_mfma_f32_16x16x32_bf16 a[44:47], v[244:247], v[188:191], a[44:47]
s_waitcnt lgkmcnt(4)
v_subrev_u32 v198, 0x0d800000, v194
v_subrev_u32 v199, 0x0d800000, v195
v_mfma_f32_16x16x32_bf16 a[32:35], v[224:227], v[0:3], a[32:35]
ds_read_b64_tr_b16 v[240:241], v13 offset:512
ds_read_b64_tr_b16 v[242:243], v13 offset:2560
v_max3_u32 v254, v196, v197, v198
v_mfma_f32_16x16x32_bf16 a[36:39], v[224:227], v[32:35], a[36:39]
v_max_u32 v254, v254, v199
v_mfma_f32_16x16x32_bf16 a[40:43], v[224:227], v[64:67], a[40:43]
s_mov_b64 exec, 0xffff
s_xor_b32 s35, s48, 0
buffer_store_dword v192, v253, s[24:27], s35 offen offset:4 sc1
s_xor_b32 s35, s48, 1024
buffer_store_dword v193, v253, s[24:27], s35 offen offset:4 sc1
s_xor_b32 s35, s48, 2048
buffer_store_dword v194, v253, s[24:27], s35 offen offset:4 sc1
s_xor_b32 s35, s48, 3072
buffer_store_dword v195, v253, s[24:27], s35 offen offset:4 sc1
v_cmp_le_u32 vcc, 0x64000000, v254
s_mov_b64 exec, -1
v_mfma_f32_16x16x32_bf16 a[44:47], v[224:227], v[96:99], a[44:47]
v_accvgpr_read_b32 v192, a0
v_accvgpr_read_b32 v193, a1
v_mfma_f32_16x16x32_bf16 a[48:51], v[228:231], v[0:3], a[48:51]
ds_read_b64_tr_b16 v[244:245], v13 offset:16896
ds_read_b64_tr_b16 v[246:247], v13 offset:18944
v_mfma_f32_16x16x32_bf16 a[52:55], v[228:231], v[32:35], a[52:55]
v_accvgpr_read_b32 v194, a2
v_accvgpr_read_b32 v195, a3
v_mfma_f32_16x16x32_bf16 a[56:59], v[228:231], v[64:67], a[56:59]
v_cvt_pk_bf16_f32 v16, v192, v193
v_cvt_pk_bf16_f32 v17, v194, v195
v_mfma_f32_16x16x32_bf16 a[60:63], v[228:231], v[96:99], a[60:63]
s_waitcnt lgkmcnt(4)
v_accvgpr_read_b32 v200, a4
v_mfma_f32_16x16x32_bf16 a[48:51], v[232:235], v[4:7], a[48:51]
ds_read_b64_tr_b16 v[224:225], v13 offset:33280
ds_read_b64_tr_b16 v[226:227], v13 offset:35328
v_mfma_f32_16x16x32_bf16 a[48:51], v[236:239], v[8:11], a[48:51]
v_accvgpr_read_b32 v201, a5
v_accvgpr_read_b32 v202, a6
v_mfma_f32_16x16x32_bf16 a[52:55], v[232:235], v[36:39], a[52:55]
v_accvgpr_read_b32 v203, a7
v_cvt_pk_bf16_f32 v48, v200, v201
v_mfma_f32_16x16x32_bf16 a[52:55], v[236:239], v[40:43], a[52:55]
v_cvt_pk_bf16_f32 v49, v202, v203
v_accvgpr_read_b32 v208, a8
v_mfma_f32_16x16x32_bf16 a[56:59], v[232:235], v[68:71], a[56:59]
ds_read_b64_tr_b16 v[228:229], v13 offset:49664
ds_read_b64_tr_b16 v[230:231], v13 offset:51712
v_mfma_f32_16x16x32_bf16 a[56:59], v[236:239], v[72:75], a[56:59]
v_accvgpr_read_b32 v209, a9
v_accvgpr_read_b32 v210, a10
v_mfma_f32_16x16x32_bf16 a[60:63], v[232:235], v[100:103], a[60:63]
v_accvgpr_read_b32 v211, a11
v_cvt_pk_bf16_f32 v80, v208, v209
v_mfma_f32_16x16x32_bf16 a[60:63], v[236:239], v[104:107], a[60:63]
s_waitcnt lgkmcnt(4)
v_cvt_pk_bf16_f32 v81, v210, v211
v_mfma_f32_16x16x32_bf16 a[48:51], v[240:243], v[128:131], a[48:51]
ds_read_b64_tr_b16 v[232:233], v249 offset:36864
ds_read_b64_tr_b16 v[234:235], v249 offset:38912
v_mfma_f32_16x16x32_bf16 a[48:51], v[244:247], v[144:147], a[48:51]
v_accvgpr_read_b32 v216, a12
v_accvgpr_read_b32 v217, a13
v_mfma_f32_16x16x32_bf16 a[52:55], v[240:243], v[132:135], a[52:55]
v_accvgpr_read_b32 v218, a14
v_accvgpr_read_b32 v219, a15
v_mfma_f32_16x16x32_bf16 a[52:55], v[244:247], v[148:151], a[52:55]
v_cvt_pk_bf16_f32 v112, v216, v217
v_cvt_pk_bf16_f32 v113, v218, v219
v_mfma_f32_16x16x32_bf16 a[56:59], v[240:243], v[136:139], a[56:59]
ds_read_b64_tr_b16 v[236:237], v249 offset:53248
ds_read_b64_tr_b16 v[238:239], v249 offset:55296
v_mfma_f32_16x16x32_bf16 a[56:59], v[244:247], v[152:155], a[56:59]
v_accvgpr_read_b32 v196, a16
v_accvgpr_read_b32 v197, a17
v_mfma_f32_16x16x32_bf16 a[60:63], v[240:243], v[140:143], a[60:63]
v_accvgpr_read_b32 v198, a18
v_accvgpr_read_b32 v199, a19
v_mfma_f32_16x16x32_bf16 a[60:63], v[244:247], v[156:159], a[60:63]
s_waitcnt lgkmcnt(4)
v_cvt_pk_bf16_f32 v18, v196, v197
v_mfma_f32_16x16x32_bf16 a[48:51], v[224:227], v[160:163], a[48:51]
ds_read_b64_tr_b16 v[240:241], v12 offset:4096
ds_read_b64_tr_b16 v[242:243], v12 offset:6144
v_mfma_f32_16x16x32_bf16 a[48:51], v[228:231], v[176:179], a[48:51]
v_cvt_pk_bf16_f32 v19, v198, v199
buffer_store_dwordx4 v[16:19], v252, s[20:23], s40 offen offset:0 sc1
v_mfma_f32_16x16x32_bf16 a[52:55], v[224:227], v[164:167], a[52:55]
v_accvgpr_read_b32 v204, a20
v_accvgpr_read_b32 v205, a21
v_mfma_f32_16x16x32_bf16 a[52:55], v[228:231], v[180:183], a[52:55]
v_accvgpr_read_b32 v206, a22
v_accvgpr_read_b32 v207, a23
v_mfma_f32_16x16x32_bf16 a[56:59], v[224:227], v[168:171], a[56:59]
ds_read_b64_tr_b16 v[244:245], v12 offset:20480
ds_read_b64_tr_b16 v[246:247], v12 offset:22528
v_mfma_f32_16x16x32_bf16 a[56:59], v[228:231], v[184:187], a[56:59]
v_cvt_pk_bf16_f32 v50, v204, v205
v_cvt_pk_bf16_f32 v51, v206, v207
v_mfma_f32_16x16x32_bf16 a[60:63], v[224:227], v[172:175], a[60:63]
buffer_store_dwordx4 v[48:51], v252, s[20:23], s41 offen offset:0 sc1
v_accvgpr_read_b32 v212, a24
v_mfma_f32_16x16x32_bf16 a[60:63], v[228:231], v[188:191], a[60:63]
s_waitcnt lgkmcnt(4)
v_accvgpr_read_b32 v213, a25
v_mfma_f32_16x16x32_bf16 a[64:67], v[232:235], v[4:7], a[64:67]
ds_read_b64_tr_b16 v[224:225], v12 offset:36864
ds_read_b64_tr_b16 v[226:227], v12 offset:38912
v_mfma_f32_16x16x32_bf16 a[64:67], v[236:239], v[8:11], a[64:67]
v_accvgpr_read_b32 v214, a26
v_accvgpr_read_b32 v215, a27
v_mfma_f32_16x16x32_bf16 a[68:71], v[232:235], v[36:39], a[68:71]
v_cvt_pk_bf16_f32 v82, v212, v213
v_cvt_pk_bf16_f32 v83, v214, v215
v_mfma_f32_16x16x32_bf16 a[68:71], v[236:239], v[40:43], a[68:71]
buffer_store_dwordx4 v[80:83], v252, s[20:23], s42 offen offset:0 sc1
v_accvgpr_read_b32 v220, a28
v_mfma_f32_16x16x32_bf16 a[72:75], v[232:235], v[68:71], a[72:75]
ds_read_b64_tr_b16 v[228:229], v12 offset:53248
ds_read_b64_tr_b16 v[230:231], v12 offset:55296
v_mfma_f32_16x16x32_bf16 a[72:75], v[236:239], v[72:75], a[72:75]
v_accvgpr_read_b32 v221, a29
v_accvgpr_read_b32 v222, a30
v_mfma_f32_16x16x32_bf16 a[76:79], v[232:235], v[100:103], a[76:79]
v_accvgpr_read_b32 v223, a31
v_cvt_pk_bf16_f32 v114, v220, v221
v_mfma_f32_16x16x32_bf16 a[76:79], v[236:239], v[104:107], a[76:79]
s_waitcnt lgkmcnt(4)
v_cvt_pk_bf16_f32 v115, v222, v223
v_mfma_f32_16x16x32_bf16 a[64:67], v[240:243], v[128:131], a[64:67]
ds_read_b64_tr_b16 v[232:233], v249 offset:4096
ds_read_b64_tr_b16 v[234:235], v249 offset:6144
v_mfma_f32_16x16x32_bf16 a[64:67], v[244:247], v[144:147], a[64:67]
buffer_store_dwordx4 v[112:115], v252, s[20:23], s43 offen offset:0 sc1
v_accvgpr_read_b32 v192, a32
v_mfma_f32_16x16x32_bf16 a[68:71], v[240:243], v[132:135], a[68:71]
v_accvgpr_read_b32 v193, a33
v_accvgpr_read_b32 v194, a34
v_mfma_f32_16x16x32_bf16 a[68:71], v[244:247], v[148:151], a[68:71]
v_accvgpr_read_b32 v195, a35
v_cvt_pk_bf16_f32 v20, v192, v193
v_mfma_f32_16x16x32_bf16 a[72:75], v[240:243], v[136:139], a[72:75]
ds_read_b64_tr_b16 v[236:237], v250 offset:4096
ds_read_b64_tr_b16 v[238:239], v250 offset:6144
v_mfma_f32_16x16x32_bf16 a[72:75], v[244:247], v[152:155], a[72:75]
v_cvt_pk_bf16_f32 v21, v194, v195
v_accvgpr_read_b32 v200, a36
v_mfma_f32_16x16x32_bf16 a[76:79], v[240:243], v[140:143], a[76:79]
v_accvgpr_read_b32 v201, a37
v_accvgpr_read_b32 v202, a38
v_mfma_f32_16x16x32_bf16 a[76:79], v[244:247], v[156:159], a[76:79]
s_waitcnt lgkmcnt(4)
v_accvgpr_read_b32 v203, a39
v_mfma_f32_16x16x32_bf16 a[64:67], v[224:227], v[160:163], a[64:67]
ds_read_b64_tr_b16 v[240:241], v250 offset:36864
ds_read_b64_tr_b16 v[242:243], v250 offset:38912
v_mfma_f32_16x16x32_bf16 a[64:67], v[228:231], v[176:179], a[64:67]
v_cvt_pk_bf16_f32 v52, v200, v201
v_cvt_pk_bf16_f32 v53, v202, v203
v_mfma_f32_16x16x32_bf16 a[68:71], v[224:227], v[164:167], a[68:71]
v_accvgpr_read_b32 v208, a40
v_accvgpr_read_b32 v209, a41
v_mfma_f32_16x16x32_bf16 a[68:71], v[228:231], v[180:183], a[68:71]
v_accvgpr_read_b32 v210, a42
v_accvgpr_read_b32 v211, a43
v_mfma_f32_16x16x32_bf16 a[72:75], v[224:227], v[168:171], a[72:75]
ds_read_b64_tr_b16 v[244:245], v250 offset:53248
ds_read_b64_tr_b16 v[246:247], v250 offset:55296
v_mfma_f32_16x16x32_bf16 a[72:75], v[228:231], v[184:187], a[72:75]
v_cvt_pk_bf16_f32 v84, v208, v209
v_cvt_pk_bf16_f32 v85, v210, v211
v_mfma_f32_16x16x32_bf16 a[76:79], v[224:227], v[172:175], a[76:79]
v_accvgpr_read_b32 v216, a44
v_accvgpr_read_b32 v217, a45
v_mfma_f32_16x16x32_bf16 a[76:79], v[228:231], v[188:191], a[76:79]
s_waitcnt lgkmcnt(4)
v_accvgpr_read_b32 v218, a46
v_mfma_f32_16x16x32_bf16 a[64:67], v[232:235], v[0:3], a[64:67]
ds_read_b64_tr_b16 v[224:225], v13 offset:4096
ds_read_b64_tr_b16 v[226:227], v13 offset:6144
v_mfma_f32_16x16x32_bf16 a[68:71], v[232:235], v[32:35], a[68:71]
v_accvgpr_read_b32 v219, a47
v_cvt_pk_bf16_f32 v116, v216, v217
v_mfma_f32_16x16x32_bf16 a[72:75], v[232:235], v[64:67], a[72:75]
v_cvt_pk_bf16_f32 v117, v218, v219
v_accvgpr_read_b32 v196, a48
v_mfma_f32_16x16x32_bf16 a[76:79], v[232:235], v[96:99], a[76:79]
v_accvgpr_read_b32 v197, a49
v_accvgpr_read_b32 v198, a50
v_mfma_f32_16x16x32_bf16 a[80:83], v[236:239], v[0:3], a[80:83]
ds_read_b64_tr_b16 v[228:229], v13 offset:20480
ds_read_b64_tr_b16 v[230:231], v13 offset:22528
v_mfma_f32_16x16x32_bf16 a[84:87], v[236:239], v[32:35], a[84:87]
v_accvgpr_read_b32 v199, a51
v_cvt_pk_bf16_f32 v22, v196, v197
v_mfma_f32_16x16x32_bf16 a[88:91], v[236:239], v[64:67], a[88:91]
v_cvt_pk_bf16_f32 v23, v198, v199
buffer_store_dwordx4 v[20:23], v252, s[20:23], s40 offen offset:1024 sc1
v_mfma_f32_16x16x32_bf16 a[92:95], v[236:239], v[96:99], a[92:95]
s_waitcnt lgkmcnt(4)
v_accvgpr_read_b32 v204, a52
v_mfma_f32_16x16x32_bf16 a[80:83], v[240:243], v[4:7], a[80:83]
ds_read_b64_tr_b16 v[232:233], v13 offset:36864
ds_read_b64_tr_b16 v[234:235], v13 offset:38912
v_mfma_f32_16x16x32_bf16 a[80:83], v[244:247], v[8:11], a[80:83]
v_accvgpr_read_b32 v205, a53
v_accvgpr_read_b32 v206, a54
v_mfma_f32_16x16x32_bf16 a[84:87], v[240:243], v[36:39], a[84:87]
v_accvgpr_read_b32 v207, a55
v_cvt_pk_bf16_f32 v54, v204, v205
v_mfma_f32_16x16x32_bf16 a[84:87], v[244:247], v[40:43], a[84:87]
v_cvt_pk_bf16_f32 v55, v206, v207
buffer_store_dwordx4 v[52:55], v252, s[20:23], s41 offen offset:1024 sc1
v_mfma_f32_16x16x32_bf16 a[88:91], v[240:243], v[68:71], a[88:91]
ds_read_b64_tr_b16 v[236:237], v13 offset:53248
ds_read_b64_tr_b16 v[238:239], v13 offset:55296
v_mfma_f32_16x16x32_bf16 a[88:91], v[244:247], v[72:75], a[88:91]
v_accvgpr_read_b32 v212, a56
v_accvgpr_read_b32 v213, a57
v_mfma_f32_16x16x32_bf16 a[92:95], v[240:243], v[100:103], a[92:95]
v_accvgpr_read_b32 v214, a58
v_accvgpr_read_b32 v215, a59
v_mfma_f32_16x16x32_bf16 a[92:95], v[244:247], v[104:107], a[92:95]
s_waitcnt lgkmcnt(4)
v_cvt_pk_bf16_f32 v86, v212, v213
v_mfma_f32_16x16x32_bf16 a[80:83], v[224:227], v[128:131], a[80:83]
ds_read_b64_tr_b16 v[240:241], v249 offset:37376
ds_read_b64_tr_b16 v[242:243], v249 offset:39424
v_mfma_f32_16x16x32_bf16 a[80:83], v[228:231], v[144:147], a[80:83]
v_cvt_pk_bf16_f32 v87, v214, v215
buffer_store_dwordx4 v[84:87], v252, s[20:23], s42 offen offset:1024 sc1
v_mfma_f32_16x16x32_bf16 a[84:87], v[224:227], v[132:135], a[84:87]
v_accvgpr_read_b32 v220, a60
v_accvgpr_read_b32 v221, a61
v_mfma_f32_16x16x32_bf16 a[84:87], v[228:231], v[148:151], a[84:87]
v_accvgpr_read_b32 v222, a62
v_accvgpr_read_b32 v223, a63
v_mfma_f32_16x16x32_bf16 a[88:91], v[224:227], v[136:139], a[88:91]
ds_read_b64_tr_b16 v[244:245], v249 offset:53760
ds_read_b64_tr_b16 v[246:247], v249 offset:55808
v_mfma_f32_16x16x32_bf16 a[88:91], v[228:231], v[152:155], a[88:91]
v_cvt_pk_bf16_f32 v118, v220, v221
v_cvt_pk_bf16_f32 v119, v222, v223
v_mfma_f32_16x16x32_bf16 a[92:95], v[224:227], v[140:143], a[92:95]
buffer_store_dwordx4 v[116:119], v252, s[20:23], s43 offen offset:1024 sc1
v_accvgpr_read_b32 v192, a64
v_mfma_f32_16x16x32_bf16 a[92:95], v[228:231], v[156:159], a[92:95]
s_waitcnt lgkmcnt(4)
v_accvgpr_read_b32 v193, a65
v_mfma_f32_16x16x32_bf16 a[80:83], v[232:235], v[160:163], a[80:83]
ds_read_b64_tr_b16 v[224:225], v12 offset:4608
ds_read_b64_tr_b16 v[226:227], v12 offset:6656
v_mfma_f32_16x16x32_bf16 a[80:83], v[236:239], v[176:179], a[80:83]
v_accvgpr_read_b32 v194, a66
v_accvgpr_read_b32 v195, a67
v_mfma_f32_16x16x32_bf16 a[84:87], v[232:235], v[164:167], a[84:87]
v_cvt_pk_bf16_f32 v24, v192, v193
v_cvt_pk_bf16_f32 v25, v194, v195
v_mfma_f32_16x16x32_bf16 a[84:87], v[236:239], v[180:183], a[84:87]
v_accvgpr_read_b32 v200, a68
v_accvgpr_read_b32 v201, a69
v_mfma_f32_16x16x32_bf16 a[88:91], v[232:235], v[168:171], a[88:91]
ds_read_b64_tr_b16 v[228:229], v12 offset:20992
ds_read_b64_tr_b16 v[230:231], v12 offset:23040
v_mfma_f32_16x16x32_bf16 a[88:91], v[236:239], v[184:187], a[88:91]
v_accvgpr_read_b32 v202, a70
v_accvgpr_read_b32 v203, a71
v_mfma_f32_16x16x32_bf16 a[92:95], v[232:235], v[172:175], a[92:95]
v_cvt_pk_bf16_f32 v56, v200, v201
v_cvt_pk_bf16_f32 v57, v202, v203
v_mfma_f32_16x16x32_bf16 a[92:95], v[236:239], v[188:191], a[92:95]
s_waitcnt lgkmcnt(4)
v_accvgpr_read_b32 v208, a72
v_mfma_f32_16x16x32_bf16 a[96:99], v[240:243], v[4:7], a[96:99]
ds_read_b64_tr_b16 v[232:233], v12 offset:37376
ds_read_b64_tr_b16 v[234:235], v12 offset:39424
v_mfma_f32_16x16x32_bf16 a[96:99], v[244:247], v[8:11], a[96:99]
v_accvgpr_read_b32 v209, a73
v_accvgpr_read_b32 v210, a74
v_mfma_f32_16x16x32_bf16 a[100:103], v[240:243], v[36:39], a[100:103]
v_accvgpr_read_b32 v211, a75
v_cvt_pk_bf16_f32 v88, v208, v209
v_mfma_f32_16x16x32_bf16 a[100:103], v[244:247], v[40:43], a[100:103]
v_cvt_pk_bf16_f32 v89, v210, v211
v_accvgpr_read_b32 v216, a76
v_mfma_f32_16x16x32_bf16 a[104:107], v[240:243], v[68:71], a[104:107]
ds_read_b64_tr_b16 v[236:237], v12 offset:53760
ds_read_b64_tr_b16 v[238:239], v12 offset:55808
v_mfma_f32_16x16x32_bf16 a[104:107], v[244:247], v[72:75], a[104:107]
v_accvgpr_read_b32 v217, a77
v_accvgpr_read_b32 v218, a78
v_mfma_f32_16x16x32_bf16 a[108:111], v[240:243], v[100:103], a[108:111]
v_accvgpr_read_b32 v219, a79
v_cvt_pk_bf16_f32 v120, v216, v217
v_mfma_f32_16x16x32_bf16 a[108:111], v[244:247], v[104:107], a[108:111]
s_waitcnt lgkmcnt(4)
v_cvt_pk_bf16_f32 v121, v218, v219
v_mfma_f32_16x16x32_bf16 a[96:99], v[224:227], v[128:131], a[96:99]
ds_read_b64_tr_b16 v[240:241], v249 offset:4608
ds_read_b64_tr_b16 v[242:243], v249 offset:6656
v_mfma_f32_16x16x32_bf16 a[96:99], v[228:231], v[144:147], a[96:99]
v_accvgpr_read_b32 v196, a80
v_accvgpr_read_b32 v197, a81
v_mfma_f32_16x16x32_bf16 a[100:103], v[224:227], v[132:135], a[100:103]
v_accvgpr_read_b32 v198, a82
v_accvgpr_read_b32 v199, a83
v_mfma_f32_16x16x32_bf16 a[100:103], v[228:231], v[148:151], a[100:103]
v_cvt_pk_bf16_f32 v26, v196, v197
v_cvt_pk_bf16_f32 v27, v198, v199
v_mfma_f32_16x16x32_bf16 a[104:107], v[224:227], v[136:139], a[104:107]
ds_read_b64_tr_b16 v[244:245], v250 offset:4608
ds_read_b64_tr_b16 v[246:247], v250 offset:6656
v_mfma_f32_16x16x32_bf16 a[104:107], v[228:231], v[152:155], a[104:107]
buffer_store_dwordx4 v[24:27], v252, s[20:23], s40 offen offset:2048 sc1
v_accvgpr_read_b32 v204, a84
v_mfma_f32_16x16x32_bf16 a[108:111], v[224:227], v[140:143], a[108:111]
v_accvgpr_read_b32 v205, a85
v_accvgpr_read_b32 v206, a86
v_mfma_f32_16x16x32_bf16 a[108:111], v[228:231], v[156:159], a[108:111]
s_waitcnt lgkmcnt(4)
v_accvgpr_read_b32 v207, a87
v_mfma_f32_16x16x32_bf16 a[96:99], v[232:235], v[160:163], a[96:99]
ds_read_b64_tr_b16 v[224:225], v250 offset:37376
ds_read_b64_tr_b16 v[226:227], v250 offset:39424
v_mfma_f32_16x16x32_bf16 a[96:99], v[236:239], v[176:179], a[96:99]
v_cvt_pk_bf16_f32 v58, v204, v205
v_cvt_pk_bf16_f32 v59, v206, v207
v_mfma_f32_16x16x32_bf16 a[100:103], v[232:235], v[164:167], a[100:103]
buffer_store_dwordx4 v[56:59], v252, s[20:23], s41 offen offset:2048 sc1
v_accvgpr_read_b32 v212, a88
v_mfma_f32_16x16x32_bf16 a[100:103], v[236:239], v[180:183], a[100:103]
v_accvgpr_read_b32 v213, a89
v_accvgpr_read_b32 v214, a90
v_mfma_f32_16x16x32_bf16 a[104:107], v[232:235], v[168:171], a[104:107]
ds_read_b64_tr_b16 v[228:229], v250 offset:53760
ds_read_b64_tr_b16 v[230:231], v250 offset:55808
v_mfma_f32_16x16x32_bf16 a[104:107], v[236:239], v[184:187], a[104:107]
v_accvgpr_read_b32 v215, a91
v_cvt_pk_bf16_f32 v90, v212, v213
v_mfma_f32_16x16x32_bf16 a[108:111], v[232:235], v[172:175], a[108:111]
v_cvt_pk_bf16_f32 v91, v214, v215
buffer_store_dwordx4 v[88:91], v252, s[20:23], s42 offen offset:2048 sc1
v_mfma_f32_16x16x32_bf16 a[108:111], v[236:239], v[188:191], a[108:111]
s_waitcnt lgkmcnt(4)
v_accvgpr_read_b32 v220, a92
v_mfma_f32_16x16x32_bf16 a[96:99], v[240:243], v[0:3], a[96:99]
ds_read_b64_tr_b16 v[232:233], v13 offset:4608
ds_read_b64_tr_b16 v[234:235], v13 offset:6656
v_mfma_f32_16x16x32_bf16 a[100:103], v[240:243], v[32:35], a[100:103]
v_accvgpr_read_b32 v221, a93
v_accvgpr_read_b32 v222, a94
v_mfma_f32_16x16x32_bf16 a[104:107], v[240:243], v[64:67], a[104:107]
v_accvgpr_read_b32 v223, a95
v_cvt_pk_bf16_f32 v122, v220, v221
v_mfma_f32_16x16x32_bf16 a[108:111], v[240:243], v[96:99], a[108:111]
v_cvt_pk_bf16_f32 v123, v222, v223
buffer_store_dwordx4 v[120:123], v252, s[20:23], s43 offen offset:2048 sc1
v_mfma_f32_16x16x32_bf16 a[112:115], v[244:247], v[0:3], a[112:115]
ds_read_b64_tr_b16 v[236:237], v13 offset:20992
ds_read_b64_tr_b16 v[238:239], v13 offset:23040
v_mfma_f32_16x16x32_bf16 a[116:119], v[244:247], v[32:35], a[116:119]
v_accvgpr_read_b32 v192, a96
v_accvgpr_read_b32 v193, a97
v_mfma_f32_16x16x32_bf16 a[120:123], v[244:247], v[64:67], a[120:123]
v_accvgpr_read_b32 v194, a98
v_accvgpr_read_b32 v195, a99
v_mfma_f32_16x16x32_bf16 a[124:127], v[244:247], v[96:99], a[124:127]
s_waitcnt lgkmcnt(4)
v_cvt_pk_bf16_f32 v28, v192, v193
v_mfma_f32_16x16x32_bf16 a[112:115], v[224:227], v[4:7], a[112:115]
ds_read_b64_tr_b16 v[240:241], v13 offset:37376
ds_read_b64_tr_b16 v[242:243], v13 offset:39424
v_mfma_f32_16x16x32_bf16 a[112:115], v[228:231], v[8:11], a[112:115]
v_cvt_pk_bf16_f32 v29, v194, v195
v_accvgpr_read_b32 v200, a100
v_mfma_f32_16x16x32_bf16 a[116:119], v[224:227], v[36:39], a[116:119]
v_accvgpr_read_b32 v201, a101
v_accvgpr_read_b32 v202, a102
v_mfma_f32_16x16x32_bf16 a[116:119], v[228:231], v[40:43], a[116:119]
v_accvgpr_read_b32 v203, a103
v_cvt_pk_bf16_f32 v60, v200, v201
v_mfma_f32_16x16x32_bf16 a[120:123], v[224:227], v[68:71], a[120:123]
ds_read_b64_tr_b16 v[244:245], v13 offset:53760
ds_read_b64_tr_b16 v[246:247], v13 offset:55808
v_mfma_f32_16x16x32_bf16 a[120:123], v[228:231], v[72:75], a[120:123]
v_cvt_pk_bf16_f32 v61, v202, v203
v_accvgpr_read_b32 v208, a104
v_mfma_f32_16x16x32_bf16 a[124:127], v[224:227], v[100:103], a[124:127]
v_accvgpr_read_b32 v209, a105
v_accvgpr_read_b32 v210, a106
v_mfma_f32_16x16x32_bf16 a[124:127], v[228:231], v[104:107], a[124:127]
s_waitcnt lgkmcnt(4)
v_accvgpr_read_b32 v211, a107
v_mfma_f32_16x16x32_bf16 a[112:115], v[232:235], v[128:131], a[112:115]
ds_read_b64_tr_b16 v[224:225], v249 offset:40960
ds_read_b64_tr_b16 v[226:227], v249 offset:43008
v_mfma_f32_16x16x32_bf16 a[112:115], v[236:239], v[144:147], a[112:115]
v_cvt_pk_bf16_f32 v92, v208, v209
v_cvt_pk_bf16_f32 v93, v210, v211
v_mfma_f32_16x16x32_bf16 a[116:119], v[232:235], v[132:135], a[116:119]
v_accvgpr_read_b32 v216, a108
v_accvgpr_read_b32 v217, a109
v_mfma_f32_16x16x32_bf16 a[116:119], v[236:239], v[148:151], a[116:119]
v_accvgpr_read_b32 v218, a110
v_accvgpr_read_b32 v219, a111
v_mfma_f32_16x16x32_bf16 a[120:123], v[232:235], v[136:139], a[120:123]
ds_read_b64_tr_b16 v[228:229], v249 offset:57344
ds_read_b64_tr_b16 v[230:231], v249 offset:59392
v_mfma_f32_16x16x32_bf16 a[120:123], v[236:239], v[152:155], a[120:123]
v_cvt_pk_bf16_f32 v124, v216, v217
v_cvt_pk_bf16_f32 v125, v218, v219
v_mfma_f32_16x16x32_bf16 a[124:127], v[232:235], v[140:143], a[124:127]
v_mfma_f32_16x16x32_bf16 a[124:127], v[236:239], v[156:159], a[124:127]
s_waitcnt lgkmcnt(4)
v_mfma_f32_16x16x32_bf16 a[112:115], v[240:243], v[160:163], a[112:115]
ds_read_b64_tr_b16 v[232:233], v12 offset:8192
ds_read_b64_tr_b16 v[234:235], v12 offset:10240
v_mfma_f32_16x16x32_bf16 a[112:115], v[244:247], v[176:179], a[112:115]
v_mfma_f32_16x16x32_bf16 a[116:119], v[240:243], v[164:167], a[116:119]
v_mfma_f32_16x16x32_bf16 a[116:119], v[244:247], v[180:183], a[116:119]
v_mfma_f32_16x16x32_bf16 a[120:123], v[240:243], v[168:171], a[120:123]
ds_read_b64_tr_b16 v[236:237], v12 offset:24576
ds_read_b64_tr_b16 v[238:239], v12 offset:26624
v_mfma_f32_16x16x32_bf16 a[120:123], v[244:247], v[184:187], a[120:123]
v_mfma_f32_16x16x32_bf16 a[124:127], v[240:243], v[172:175], a[124:127]
s_nop 0
v_accvgpr_read_b32 v196, a112
v_accvgpr_read_b32 v197, a113
v_mfma_f32_16x16x32_bf16 a[124:127], v[244:247], v[188:191], a[124:127]
s_waitcnt lgkmcnt(4)
v_accvgpr_read_b32 v198, a114
v_mfma_f32_16x16x32_bf16 a[128:131], v[224:227], v[4:7], a[128:131]
ds_read_b64_tr_b16 v[240:241], v12 offset:40960
ds_read_b64_tr_b16 v[242:243], v12 offset:43008
v_mfma_f32_16x16x32_bf16 a[128:131], v[228:231], v[8:11], a[128:131]
v_accvgpr_read_b32 v199, a115
v_cvt_pk_bf16_f32 v30, v196, v197
v_mfma_f32_16x16x32_bf16 a[132:135], v[224:227], v[36:39], a[132:135]
v_cvt_pk_bf16_f32 v31, v198, v199
buffer_store_dwordx4 v[28:31], v252, s[20:23], s40 offen offset:3072 sc1
v_mfma_f32_16x16x32_bf16 a[132:135], v[228:231], v[40:43], a[132:135]
v_accvgpr_read_b32 v204, a116
v_accvgpr_read_b32 v205, a117
v_mfma_f32_16x16x32_bf16 a[136:139], v[224:227], v[68:71], a[136:139]
ds_read_b64_tr_b16 v[244:245], v12 offset:57344
ds_read_b64_tr_b16 v[246:247], v12 offset:59392
v_mfma_f32_16x16x32_bf16 a[136:139], v[228:231], v[72:75], a[136:139]
v_accvgpr_read_b32 v206, a118
v_accvgpr_read_b32 v207, a119
v_mfma_f32_16x16x32_bf16 a[140:143], v[224:227], v[100:103], a[140:143]
v_cvt_pk_bf16_f32 v62, v204, v205
v_cvt_pk_bf16_f32 v63, v206, v207
v_mfma_f32_16x16x32_bf16 a[140:143], v[228:231], v[104:107], a[140:143]
s_waitcnt lgkmcnt(4)
buffer_store_dwordx4 v[60:63], v252, s[20:23], s41 offen offset:3072 sc1
v_mfma_f32_16x16x32_bf16 a[128:131], v[232:235], v[128:131], a[128:131]
ds_read_b64_tr_b16 v[224:225], v249 offset:8192
ds_read_b64_tr_b16 v[226:227], v249 offset:10240
v_mfma_f32_16x16x32_bf16 a[128:131], v[236:239], v[144:147], a[128:131]
v_accvgpr_read_b32 v212, a120
v_accvgpr_read_b32 v213, a121
v_mfma_f32_16x16x32_bf16 a[132:135], v[232:235], v[132:135], a[132:135]
v_accvgpr_read_b32 v214, a122
v_accvgpr_read_b32 v215, a123
v_mfma_f32_16x16x32_bf16 a[132:135], v[236:239], v[148:151], a[132:135]
v_cvt_pk_bf16_f32 v94, v212, v213
v_cvt_pk_bf16_f32 v95, v214, v215
v_mfma_f32_16x16x32_bf16 a[136:139], v[232:235], v[136:139], a[136:139]
ds_read_b64_tr_b16 v[228:229], v250 offset:8192
ds_read_b64_tr_b16 v[230:231], v250 offset:10240
v_mfma_f32_16x16x32_bf16 a[136:139], v[236:239], v[152:155], a[136:139]
buffer_store_dwordx4 v[92:95], v252, s[20:23], s42 offen offset:3072 sc1
v_accvgpr_read_b32 v220, a124
v_mfma_f32_16x16x32_bf16 a[140:143], v[232:235], v[140:143], a[140:143]
v_accvgpr_read_b32 v221, a125
v_accvgpr_read_b32 v222, a126
v_mfma_f32_16x16x32_bf16 a[140:143], v[236:239], v[156:159], a[140:143]
s_waitcnt lgkmcnt(4)
v_accvgpr_read_b32 v223, a127
v_mfma_f32_16x16x32_bf16 a[128:131], v[240:243], v[160:163], a[128:131]
ds_read_b64_tr_b16 v[232:233], v250 offset:40960
ds_read_b64_tr_b16 v[234:235], v250 offset:43008
v_mfma_f32_16x16x32_bf16 a[128:131], v[244:247], v[176:179], a[128:131]
v_cvt_pk_bf16_f32 v126, v220, v221
v_cvt_pk_bf16_f32 v127, v222, v223
v_mfma_f32_16x16x32_bf16 a[132:135], v[240:243], v[164:167], a[132:135]
buffer_store_dwordx4 v[124:127], v252, s[20:23], s43 offen offset:3072 sc1
v_mfma_f32_16x16x32_bf16 a[132:135], v[244:247], v[180:183], a[132:135]
v_mfma_f32_16x16x32_bf16 a[136:139], v[240:243], v[168:171], a[136:139]
ds_read_b64_tr_b16 v[236:237], v250 offset:57344
ds_read_b64_tr_b16 v[238:239], v250 offset:59392
v_mfma_f32_16x16x32_bf16 a[136:139], v[244:247], v[184:187], a[136:139]
v_mfma_f32_16x16x32_bf16 a[140:143], v[240:243], v[172:175], a[140:143]
v_mfma_f32_16x16x32_bf16 a[140:143], v[244:247], v[188:191], a[140:143]
s_waitcnt lgkmcnt(4)
v_mfma_f32_16x16x32_bf16 a[128:131], v[224:227], v[0:3], a[128:131]
ds_read_b64_tr_b16 v[240:241], v13 offset:8192
ds_read_b64_tr_b16 v[242:243], v13 offset:10240
v_mfma_f32_16x16x32_bf16 a[132:135], v[224:227], v[32:35], a[132:135]
v_mfma_f32_16x16x32_bf16 a[136:139], v[224:227], v[64:67], a[136:139]
v_mfma_f32_16x16x32_bf16 a[140:143], v[224:227], v[96:99], a[140:143]
v_mfma_f32_16x16x32_bf16 a[144:147], v[228:231], v[0:3], a[144:147]
ds_read_b64_tr_b16 v[244:245], v13 offset:24576
ds_read_b64_tr_b16 v[246:247], v13 offset:26624
v_mfma_f32_16x16x32_bf16 a[148:151], v[228:231], v[32:35], a[148:151]
v_accvgpr_read_b32 v192, a128
v_accvgpr_read_b32 v193, a129
v_mfma_f32_16x16x32_bf16 a[152:155], v[228:231], v[64:67], a[152:155]
v_accvgpr_read_b32 v194, a130
v_accvgpr_read_b32 v195, a131
v_mfma_f32_16x16x32_bf16 a[156:159], v[228:231], v[96:99], a[156:159]
s_waitcnt lgkmcnt(4)
v_cvt_pk_bf16_f32 v16, v192, v193
v_mfma_f32_16x16x32_bf16 a[144:147], v[232:235], v[4:7], a[144:147]
ds_read_b64_tr_b16 v[224:225], v13 offset:40960
ds_read_b64_tr_b16 v[226:227], v13 offset:43008
v_mfma_f32_16x16x32_bf16 a[144:147], v[236:239], v[8:11], a[144:147]
v_cvt_pk_bf16_f32 v17, v194, v195
v_accvgpr_read_b32 v200, a132
v_mfma_f32_16x16x32_bf16 a[148:151], v[232:235], v[36:39], a[148:151]
v_accvgpr_read_b32 v201, a133
v_accvgpr_read_b32 v202, a134
v_mfma_f32_16x16x32_bf16 a[148:151], v[236:239], v[40:43], a[148:151]
v_accvgpr_read_b32 v203, a135
v_cvt_pk_bf16_f32 v48, v200, v201
v_mfma_f32_16x16x32_bf16 a[152:155], v[232:235], v[68:71], a[152:155]
ds_read_b64_tr_b16 v[228:229], v13 offset:57344
ds_read_b64_tr_b16 v[230:231], v13 offset:59392
v_mfma_f32_16x16x32_bf16 a[152:155], v[236:239], v[72:75], a[152:155]
v_cvt_pk_bf16_f32 v49, v202, v203
v_accvgpr_read_b32 v208, a136
v_mfma_f32_16x16x32_bf16 a[156:159], v[232:235], v[100:103], a[156:159]
v_accvgpr_read_b32 v209, a137
v_accvgpr_read_b32 v210, a138
v_mfma_f32_16x16x32_bf16 a[156:159], v[236:239], v[104:107], a[156:159]
s_waitcnt lgkmcnt(4)
v_accvgpr_read_b32 v211, a139
v_mfma_f32_16x16x32_bf16 a[144:147], v[240:243], v[128:131], a[144:147]
ds_read_b64_tr_b16 v[232:233], v249 offset:41472
ds_read_b64_tr_b16 v[234:235], v249 offset:43520
v_mfma_f32_16x16x32_bf16 a[144:147], v[244:247], v[144:147], a[144:147]
v_cvt_pk_bf16_f32 v80, v208, v209
v_cvt_pk_bf16_f32 v81, v210, v211
v_mfma_f32_16x16x32_bf16 a[148:151], v[240:243], v[132:135], a[148:151]
v_accvgpr_read_b32 v216, a140
v_accvgpr_read_b32 v217, a141
v_mfma_f32_16x16x32_bf16 a[148:151], v[244:247], v[148:151], a[148:151]
v_accvgpr_read_b32 v218, a142
v_accvgpr_read_b32 v219, a143
v_mfma_f32_16x16x32_bf16 a[152:155], v[240:243], v[136:139], a[152:155]
ds_read_b64_tr_b16 v[236:237], v249 offset:57856
ds_read_b64_tr_b16 v[238:239], v249 offset:59904
v_mfma_f32_16x16x32_bf16 a[152:155], v[244:247], v[152:155], a[152:155]
v_cvt_pk_bf16_f32 v112, v216, v217
v_cvt_pk_bf16_f32 v113, v218, v219
v_mfma_f32_16x16x32_bf16 a[156:159], v[240:243], v[140:143], a[156:159]
v_mfma_f32_16x16x32_bf16 a[156:159], v[244:247], v[156:159], a[156:159]
s_waitcnt lgkmcnt(4)
v_mfma_f32_16x16x32_bf16 a[144:147], v[224:227], v[160:163], a[144:147]
ds_read_b64_tr_b16 v[240:241], v12 offset:8704
ds_read_b64_tr_b16 v[242:243], v12 offset:10752
v_mfma_f32_16x16x32_bf16 a[144:147], v[228:231], v[176:179], a[144:147]
v_mfma_f32_16x16x32_bf16 a[148:151], v[224:227], v[164:167], a[148:151]
v_mfma_f32_16x16x32_bf16 a[148:151], v[228:231], v[180:183], a[148:151]
v_mfma_f32_16x16x32_bf16 a[152:155], v[224:227], v[168:171], a[152:155]
ds_read_b64_tr_b16 v[244:245], v12 offset:25088
ds_read_b64_tr_b16 v[246:247], v12 offset:27136
v_mfma_f32_16x16x32_bf16 a[152:155], v[228:231], v[184:187], a[152:155]
v_mfma_f32_16x16x32_bf16 a[156:159], v[224:227], v[172:175], a[156:159]
s_nop 0
v_accvgpr_read_b32 v196, a144
v_accvgpr_read_b32 v197, a145
v_mfma_f32_16x16x32_bf16 a[156:159], v[228:231], v[188:191], a[156:159]
s_waitcnt lgkmcnt(4)
v_accvgpr_read_b32 v198, a146
v_mfma_f32_16x16x32_bf16 a[160:163], v[232:235], v[4:7], a[160:163]
ds_read_b64_tr_b16 v[224:225], v12 offset:41472
ds_read_b64_tr_b16 v[226:227], v12 offset:43520
v_mfma_f32_16x16x32_bf16 a[160:163], v[236:239], v[8:11], a[160:163]
v_accvgpr_read_b32 v199, a147
v_cvt_pk_bf16_f32 v18, v196, v197
v_mfma_f32_16x16x32_bf16 a[164:167], v[232:235], v[36:39], a[164:167]
v_cvt_pk_bf16_f32 v19, v198, v199
buffer_store_dwordx4 v[16:19], v252, s[20:23], s44 offen offset:0 sc1
v_mfma_f32_16x16x32_bf16 a[164:167], v[236:239], v[40:43], a[164:167]
v_accvgpr_read_b32 v204, a148
v_accvgpr_read_b32 v205, a149
v_mfma_f32_16x16x32_bf16 a[168:171], v[232:235], v[68:71], a[168:171]
ds_read_b64_tr_b16 v[228:229], v12 offset:57856
ds_read_b64_tr_b16 v[230:231], v12 offset:59904
v_mfma_f32_16x16x32_bf16 a[168:171], v[236:239], v[72:75], a[168:171]
v_accvgpr_read_b32 v206, a150
v_accvgpr_read_b32 v207, a151
v_mfma_f32_16x16x32_bf16 a[172:175], v[232:235], v[100:103], a[172:175]
v_cvt_pk_bf16_f32 v50, v204, v205
v_cvt_pk_bf16_f32 v51, v206, v207
v_mfma_f32_16x16x32_bf16 a[172:175], v[236:239], v[104:107], a[172:175]
s_waitcnt lgkmcnt(4)
buffer_store_dwordx4 v[48:51], v252, s[20:23], s45 offen offset:0 sc1
v_mfma_f32_16x16x32_bf16 a[160:163], v[240:243], v[128:131], a[160:163]
ds_read_b64_tr_b16 v[232:233], v249 offset:8704
ds_read_b64_tr_b16 v[234:235], v249 offset:10752
v_mfma_f32_16x16x32_bf16 a[160:163], v[244:247], v[144:147], a[160:163]
v_accvgpr_read_b32 v212, a152
v_accvgpr_read_b32 v213, a153
v_mfma_f32_16x16x32_bf16 a[164:167], v[240:243], v[132:135], a[164:167]
v_accvgpr_read_b32 v214, a154
v_accvgpr_read_b32 v215, a155
v_mfma_f32_16x16x32_bf16 a[164:167], v[244:247], v[148:151], a[164:167]
v_cvt_pk_bf16_f32 v82, v212, v213
v_cvt_pk_bf16_f32 v83, v214, v215
v_mfma_f32_16x16x32_bf16 a[168:171], v[240:243], v[136:139], a[168:171]
ds_read_b64_tr_b16 v[236:237], v250 offset:8704
ds_read_b64_tr_b16 v[238:239], v250 offset:10752
v_mfma_f32_16x16x32_bf16 a[168:171], v[244:247], v[152:155], a[168:171]
buffer_store_dwordx4 v[80:83], v252, s[20:23], s46 offen offset:0 sc1
v_accvgpr_read_b32 v220, a156
v_mfma_f32_16x16x32_bf16 a[172:175], v[240:243], v[140:143], a[172:175]
v_accvgpr_read_b32 v221, a157
v_accvgpr_read_b32 v222, a158
v_mfma_f32_16x16x32_bf16 a[172:175], v[244:247], v[156:159], a[172:175]
s_waitcnt lgkmcnt(4)
v_accvgpr_read_b32 v223, a159
v_mfma_f32_16x16x32_bf16 a[160:163], v[224:227], v[160:163], a[160:163]
ds_read_b64_tr_b16 v[240:241], v250 offset:41472
ds_read_b64_tr_b16 v[242:243], v250 offset:43520
v_mfma_f32_16x16x32_bf16 a[160:163], v[228:231], v[176:179], a[160:163]
v_cvt_pk_bf16_f32 v114, v220, v221
v_cvt_pk_bf16_f32 v115, v222, v223
v_mfma_f32_16x16x32_bf16 a[164:167], v[224:227], v[164:167], a[164:167]
buffer_store_dwordx4 v[112:115], v252, s[20:23], s47 offen offset:0 sc1
v_mfma_f32_16x16x32_bf16 a[164:167], v[228:231], v[180:183], a[164:167]
v_mfma_f32_16x16x32_bf16 a[168:171], v[224:227], v[168:171], a[168:171]
ds_read_b64_tr_b16 v[244:245], v250 offset:57856
ds_read_b64_tr_b16 v[246:247], v250 offset:59904
v_mfma_f32_16x16x32_bf16 a[168:171], v[228:231], v[184:187], a[168:171]
v_mfma_f32_16x16x32_bf16 a[172:175], v[224:227], v[172:175], a[172:175]
v_mfma_f32_16x16x32_bf16 a[172:175], v[228:231], v[188:191], a[172:175]
s_waitcnt lgkmcnt(4)
v_mfma_f32_16x16x32_bf16 a[160:163], v[232:235], v[0:3], a[160:163]
ds_read_b64_tr_b16 v[224:225], v13 offset:8704
ds_read_b64_tr_b16 v[226:227], v13 offset:10752
v_mfma_f32_16x16x32_bf16 a[164:167], v[232:235], v[32:35], a[164:167]
v_mfma_f32_16x16x32_bf16 a[168:171], v[232:235], v[64:67], a[168:171]
v_mfma_f32_16x16x32_bf16 a[172:175], v[232:235], v[96:99], a[172:175]
v_mfma_f32_16x16x32_bf16 a[176:179], v[236:239], v[0:3], a[176:179]
ds_read_b64_tr_b16 v[228:229], v13 offset:25088
ds_read_b64_tr_b16 v[230:231], v13 offset:27136
v_mfma_f32_16x16x32_bf16 a[180:183], v[236:239], v[32:35], a[180:183]
v_accvgpr_read_b32 v192, a160
v_accvgpr_read_b32 v193, a161
v_mfma_f32_16x16x32_bf16 a[184:187], v[236:239], v[64:67], a[184:187]
v_accvgpr_read_b32 v194, a162
v_accvgpr_read_b32 v195, a163
v_mfma_f32_16x16x32_bf16 a[188:191], v[236:239], v[96:99], a[188:191]
s_waitcnt lgkmcnt(4)
v_cvt_pk_bf16_f32 v20, v192, v193
v_mfma_f32_16x16x32_bf16 a[176:179], v[240:243], v[4:7], a[176:179]
ds_read_b64_tr_b16 v[232:233], v13 offset:41472
ds_read_b64_tr_b16 v[234:235], v13 offset:43520
v_mfma_f32_16x16x32_bf16 a[176:179], v[244:247], v[8:11], a[176:179]
v_cvt_pk_bf16_f32 v21, v194, v195
v_accvgpr_read_b32 v200, a164
v_mfma_f32_16x16x32_bf16 a[180:183], v[240:243], v[36:39], a[180:183]
v_accvgpr_read_b32 v201, a165
v_accvgpr_read_b32 v202, a166
v_mfma_f32_16x16x32_bf16 a[180:183], v[244:247], v[40:43], a[180:183]
v_accvgpr_read_b32 v203, a167
v_cvt_pk_bf16_f32 v52, v200, v201
v_mfma_f32_16x16x32_bf16 a[184:187], v[240:243], v[68:71], a[184:187]
ds_read_b64_tr_b16 v[236:237], v13 offset:57856
ds_read_b64_tr_b16 v[238:239], v13 offset:59904
v_mfma_f32_16x16x32_bf16 a[184:187], v[244:247], v[72:75], a[184:187]
v_cvt_pk_bf16_f32 v53, v202, v203
v_accvgpr_read_b32 v208, a168
v_mfma_f32_16x16x32_bf16 a[188:191], v[240:243], v[100:103], a[188:191]
v_accvgpr_read_b32 v209, a169
v_accvgpr_read_b32 v210, a170
v_mfma_f32_16x16x32_bf16 a[188:191], v[244:247], v[104:107], a[188:191]
s_waitcnt lgkmcnt(4)
v_accvgpr_read_b32 v211, a171
v_mfma_f32_16x16x32_bf16 a[176:179], v[224:227], v[128:131], a[176:179]
ds_read_b64_tr_b16 v[240:241], v249 offset:45056
ds_read_b64_tr_b16 v[242:243], v249 offset:47104
v_mfma_f32_16x16x32_bf16 a[176:179], v[228:231], v[144:147], a[176:179]
v_cvt_pk_bf16_f32 v84, v208, v209
v_cvt_pk_bf16_f32 v85, v210, v211
v_mfma_f32_16x16x32_bf16 a[180:183], v[224:227], v[132:135], a[180:183]
v_accvgpr_read_b32 v216, a172
v_accvgpr_read_b32 v217, a173
v_mfma_f32_16x16x32_bf16 a[180:183], v[228:231], v[148:151], a[180:183]
v_accvgpr_read_b32 v218, a174
v_accvgpr_read_b32 v219, a175
v_mfma_f32_16x16x32_bf16 a[184:187], v[224:227], v[136:139], a[184:187]
ds_read_b64_tr_b16 v[244:245], v249 offset:61440
ds_read_b64_tr_b16 v[246:247], v249 offset:63488
v_mfma_f32_16x16x32_bf16 a[184:187], v[228:231], v[152:155], a[184:187]
v_cvt_pk_bf16_f32 v116, v216, v217
v_cvt_pk_bf16_f32 v117, v218, v219
v_mfma_f32_16x16x32_bf16 a[188:191], v[224:227], v[140:143], a[188:191]
v_mfma_f32_16x16x32_bf16 a[188:191], v[228:231], v[156:159], a[188:191]
s_waitcnt lgkmcnt(4)
v_mfma_f32_16x16x32_bf16 a[176:179], v[232:235], v[160:163], a[176:179]
ds_read_b64_tr_b16 v[224:225], v12 offset:12288
ds_read_b64_tr_b16 v[226:227], v12 offset:14336
v_mfma_f32_16x16x32_bf16 a[176:179], v[236:239], v[176:179], a[176:179]
v_mfma_f32_16x16x32_bf16 a[180:183], v[232:235], v[164:167], a[180:183]
v_mfma_f32_16x16x32_bf16 a[180:183], v[236:239], v[180:183], a[180:183]
v_mfma_f32_16x16x32_bf16 a[184:187], v[232:235], v[168:171], a[184:187]
ds_read_b64_tr_b16 v[228:229], v12 offset:28672
ds_read_b64_tr_b16 v[230:231], v12 offset:30720
v_mfma_f32_16x16x32_bf16 a[184:187], v[236:239], v[184:187], a[184:187]
v_mfma_f32_16x16x32_bf16 a[188:191], v[232:235], v[172:175], a[188:191]
s_nop 0
v_accvgpr_read_b32 v196, a176
v_accvgpr_read_b32 v197, a177
v_mfma_f32_16x16x32_bf16 a[188:191], v[236:239], v[188:191], a[188:191]
s_waitcnt lgkmcnt(4)
v_accvgpr_read_b32 v198, a178
v_mfma_f32_16x16x32_bf16 a[192:195], v[240:243], v[4:7], a[192:195]
ds_read_b64_tr_b16 v[232:233], v12 offset:45056
ds_read_b64_tr_b16 v[234:235], v12 offset:47104
v_mfma_f32_16x16x32_bf16 a[192:195], v[244:247], v[8:11], a[192:195]
v_accvgpr_read_b32 v199, a179
v_cvt_pk_bf16_f32 v22, v196, v197
v_mfma_f32_16x16x32_bf16 a[196:199], v[240:243], v[36:39], a[196:199]
v_cvt_pk_bf16_f32 v23, v198, v199
buffer_store_dwordx4 v[20:23], v252, s[20:23], s44 offen offset:1024 sc1
v_mfma_f32_16x16x32_bf16 a[196:199], v[244:247], v[40:43], a[196:199]
v_accvgpr_read_b32 v204, a180
v_accvgpr_read_b32 v205, a181
v_mfma_f32_16x16x32_bf16 a[200:203], v[240:243], v[68:71], a[200:203]
ds_read_b64_tr_b16 v[236:237], v12 offset:61440
ds_read_b64_tr_b16 v[238:239], v12 offset:63488
v_mfma_f32_16x16x32_bf16 a[200:203], v[244:247], v[72:75], a[200:203]
v_accvgpr_read_b32 v206, a182
v_accvgpr_read_b32 v207, a183
v_mfma_f32_16x16x32_bf16 a[204:207], v[240:243], v[100:103], a[204:207]
v_cvt_pk_bf16_f32 v54, v204, v205
v_cvt_pk_bf16_f32 v55, v206, v207
v_mfma_f32_16x16x32_bf16 a[204:207], v[244:247], v[104:107], a[204:207]
s_waitcnt lgkmcnt(4)
buffer_store_dwordx4 v[52:55], v252, s[20:23], s45 offen offset:1024 sc1
v_mfma_f32_16x16x32_bf16 a[192:195], v[224:227], v[128:131], a[192:195]
ds_read_b64_tr_b16 v[240:241], v249 offset:12288
ds_read_b64_tr_b16 v[242:243], v249 offset:14336
v_mfma_f32_16x16x32_bf16 a[192:195], v[228:231], v[144:147], a[192:195]
v_accvgpr_read_b32 v212, a184
v_accvgpr_read_b32 v213, a185
v_mfma_f32_16x16x32_bf16 a[196:199], v[224:227], v[132:135], a[196:199]
v_accvgpr_read_b32 v214, a186
v_accvgpr_read_b32 v215, a187
v_mfma_f32_16x16x32_bf16 a[196:199], v[228:231], v[148:151], a[196:199]
v_cvt_pk_bf16_f32 v86, v212, v213
v_cvt_pk_bf16_f32 v87, v214, v215
v_mfma_f32_16x16x32_bf16 a[200:203], v[224:227], v[136:139], a[200:203]
ds_read_b64_tr_b16 v[244:245], v250 offset:12288
ds_read_b64_tr_b16 v[246:247], v250 offset:14336
v_mfma_f32_16x16x32_bf16 a[200:203], v[228:231], v[152:155], a[200:203]
buffer_store_dwordx4 v[84:87], v252, s[20:23], s46 offen offset:1024 sc1
v_accvgpr_read_b32 v220, a188
v_mfma_f32_16x16x32_bf16 a[204:207], v[224:227], v[140:143], a[204:207]
v_accvgpr_read_b32 v221, a189
v_accvgpr_read_b32 v222, a190
v_mfma_f32_16x16x32_bf16 a[204:207], v[228:231], v[156:159], a[204:207]
s_waitcnt lgkmcnt(4)
v_accvgpr_read_b32 v223, a191
v_mfma_f32_16x16x32_bf16 a[192:195], v[232:235], v[160:163], a[192:195]
ds_read_b64_tr_b16 v[224:225], v250 offset:45056
ds_read_b64_tr_b16 v[226:227], v250 offset:47104
v_mfma_f32_16x16x32_bf16 a[192:195], v[236:239], v[176:179], a[192:195]
v_cvt_pk_bf16_f32 v118, v220, v221
v_cvt_pk_bf16_f32 v119, v222, v223
v_mfma_f32_16x16x32_bf16 a[196:199], v[232:235], v[164:167], a[196:199]
buffer_store_dwordx4 v[116:119], v252, s[20:23], s47 offen offset:1024 sc1
v_mfma_f32_16x16x32_bf16 a[196:199], v[236:239], v[180:183], a[196:199]
v_mfma_f32_16x16x32_bf16 a[200:203], v[232:235], v[168:171], a[200:203]
ds_read_b64_tr_b16 v[228:229], v250 offset:61440
ds_read_b64_tr_b16 v[230:231], v250 offset:63488
v_mfma_f32_16x16x32_bf16 a[200:203], v[236:239], v[184:187], a[200:203]
v_mfma_f32_16x16x32_bf16 a[204:207], v[232:235], v[172:175], a[204:207]
v_mfma_f32_16x16x32_bf16 a[204:207], v[236:239], v[188:191], a[204:207]
s_waitcnt lgkmcnt(4)
v_mfma_f32_16x16x32_bf16 a[192:195], v[240:243], v[0:3], a[192:195]
ds_read_b64_tr_b16 v[232:233], v13 offset:12288
ds_read_b64_tr_b16 v[234:235], v13 offset:14336
v_mfma_f32_16x16x32_bf16 a[196:199], v[240:243], v[32:35], a[196:199]
v_mfma_f32_16x16x32_bf16 a[200:203], v[240:243], v[64:67], a[200:203]
v_mfma_f32_16x16x32_bf16 a[204:207], v[240:243], v[96:99], a[204:207]
v_mfma_f32_16x16x32_bf16 a[208:211], v[244:247], v[0:3], a[208:211]
ds_read_b64_tr_b16 v[236:237], v13 offset:28672
ds_read_b64_tr_b16 v[238:239], v13 offset:30720
v_mfma_f32_16x16x32_bf16 a[212:215], v[244:247], v[32:35], a[212:215]
v_accvgpr_read_b32 v192, a192
v_accvgpr_read_b32 v193, a193
v_mfma_f32_16x16x32_bf16 a[216:219], v[244:247], v[64:67], a[216:219]
v_accvgpr_read_b32 v194, a194
v_accvgpr_read_b32 v195, a195
v_mfma_f32_16x16x32_bf16 a[220:223], v[244:247], v[96:99], a[220:223]
s_waitcnt lgkmcnt(4)
v_cvt_pk_bf16_f32 v24, v192, v193
v_mfma_f32_16x16x32_bf16 a[208:211], v[224:227], v[4:7], a[208:211]
ds_read_b64_tr_b16 v[240:241], v13 offset:45056
ds_read_b64_tr_b16 v[242:243], v13 offset:47104
v_mfma_f32_16x16x32_bf16 a[208:211], v[228:231], v[8:11], a[208:211]
v_cvt_pk_bf16_f32 v25, v194, v195
v_accvgpr_read_b32 v200, a196
v_mfma_f32_16x16x32_bf16 a[212:215], v[224:227], v[36:39], a[212:215]
v_accvgpr_read_b32 v201, a197
v_accvgpr_read_b32 v202, a198
v_mfma_f32_16x16x32_bf16 a[212:215], v[228:231], v[40:43], a[212:215]
v_accvgpr_read_b32 v203, a199
v_cvt_pk_bf16_f32 v56, v200, v201
v_mfma_f32_16x16x32_bf16 a[216:219], v[224:227], v[68:71], a[216:219]
ds_read_b64_tr_b16 v[244:245], v13 offset:61440
ds_read_b64_tr_b16 v[246:247], v13 offset:63488
v_mfma_f32_16x16x32_bf16 a[216:219], v[228:231], v[72:75], a[216:219]
v_cvt_pk_bf16_f32 v57, v202, v203
v_accvgpr_read_b32 v208, a200
v_mfma_f32_16x16x32_bf16 a[220:223], v[224:227], v[100:103], a[220:223]
v_accvgpr_read_b32 v209, a201
v_accvgpr_read_b32 v210, a202
v_mfma_f32_16x16x32_bf16 a[220:223], v[228:231], v[104:107], a[220:223]
s_waitcnt lgkmcnt(4)
v_accvgpr_read_b32 v211, a203
v_mfma_f32_16x16x32_bf16 a[208:211], v[232:235], v[128:131], a[208:211]
ds_read_b64_tr_b16 v[224:225], v249 offset:45568
ds_read_b64_tr_b16 v[226:227], v249 offset:47616
v_mfma_f32_16x16x32_bf16 a[208:211], v[236:239], v[144:147], a[208:211]
v_cvt_pk_bf16_f32 v88, v208, v209
v_cvt_pk_bf16_f32 v89, v210, v211
v_mfma_f32_16x16x32_bf16 a[212:215], v[232:235], v[132:135], a[212:215]
v_accvgpr_read_b32 v216, a204
v_accvgpr_read_b32 v217, a205
v_mfma_f32_16x16x32_bf16 a[212:215], v[236:239], v[148:151], a[212:215]
v_accvgpr_read_b32 v218, a206
v_accvgpr_read_b32 v219, a207
v_mfma_f32_16x16x32_bf16 a[216:219], v[232:235], v[136:139], a[216:219]
ds_read_b64_tr_b16 v[228:229], v249 offset:61952
ds_read_b64_tr_b16 v[230:231], v249 offset:64000
v_mfma_f32_16x16x32_bf16 a[216:219], v[236:239], v[152:155], a[216:219]
v_cvt_pk_bf16_f32 v120, v216, v217
v_cvt_pk_bf16_f32 v121, v218, v219
v_mfma_f32_16x16x32_bf16 a[220:223], v[232:235], v[140:143], a[220:223]
v_mfma_f32_16x16x32_bf16 a[220:223], v[236:239], v[156:159], a[220:223]
s_waitcnt lgkmcnt(4)
v_mfma_f32_16x16x32_bf16 a[208:211], v[240:243], v[160:163], a[208:211]
ds_read_b64_tr_b16 v[232:233], v12 offset:12800
ds_read_b64_tr_b16 v[234:235], v12 offset:14848
v_mfma_f32_16x16x32_bf16 a[208:211], v[244:247], v[176:179], a[208:211]
v_mfma_f32_16x16x32_bf16 a[212:215], v[240:243], v[164:167], a[212:215]
v_mfma_f32_16x16x32_bf16 a[212:215], v[244:247], v[180:183], a[212:215]
v_mfma_f32_16x16x32_bf16 a[216:219], v[240:243], v[168:171], a[216:219]
ds_read_b64_tr_b16 v[236:237], v12 offset:29184
ds_read_b64_tr_b16 v[238:239], v12 offset:31232
v_mfma_f32_16x16x32_bf16 a[216:219], v[244:247], v[184:187], a[216:219]
v_mfma_f32_16x16x32_bf16 a[220:223], v[240:243], v[172:175], a[220:223]
s_nop 0
v_accvgpr_read_b32 v196, a208
v_accvgpr_read_b32 v197, a209
v_mfma_f32_16x16x32_bf16 a[220:223], v[244:247], v[188:191], a[220:223]
s_waitcnt lgkmcnt(4)
v_accvgpr_read_b32 v198, a210
v_mfma_f32_16x16x32_bf16 a[224:227], v[224:227], v[4:7], a[224:227]
ds_read_b64_tr_b16 v[240:241], v12 offset:45568
ds_read_b64_tr_b16 v[242:243], v12 offset:47616
v_mfma_f32_16x16x32_bf16 a[224:227], v[228:231], v[8:11], a[224:227]
v_accvgpr_read_b32 v199, a211
v_cvt_pk_bf16_f32 v26, v196, v197
v_mfma_f32_16x16x32_bf16 a[228:231], v[224:227], v[36:39], a[228:231]
v_cvt_pk_bf16_f32 v27, v198, v199
buffer_store_dwordx4 v[24:27], v252, s[20:23], s44 offen offset:2048 sc1
v_mfma_f32_16x16x32_bf16 a[228:231], v[228:231], v[40:43], a[228:231]
v_accvgpr_read_b32 v204, a212
v_accvgpr_read_b32 v205, a213
v_mfma_f32_16x16x32_bf16 a[232:235], v[224:227], v[68:71], a[232:235]
ds_read_b64_tr_b16 v[244:245], v12 offset:61952
ds_read_b64_tr_b16 v[246:247], v12 offset:64000
v_mfma_f32_16x16x32_bf16 a[232:235], v[228:231], v[72:75], a[232:235]
v_accvgpr_read_b32 v206, a214
v_accvgpr_read_b32 v207, a215
v_mfma_f32_16x16x32_bf16 a[236:239], v[224:227], v[100:103], a[236:239]
v_cvt_pk_bf16_f32 v58, v204, v205
v_cvt_pk_bf16_f32 v59, v206, v207
v_mfma_f32_16x16x32_bf16 a[236:239], v[228:231], v[104:107], a[236:239]
s_waitcnt lgkmcnt(4)
buffer_store_dwordx4 v[56:59], v252, s[20:23], s45 offen offset:2048 sc1
v_mfma_f32_16x16x32_bf16 a[224:227], v[232:235], v[128:131], a[224:227]
ds_read_b64_tr_b16 v[224:225], v249 offset:12800
ds_read_b64_tr_b16 v[226:227], v249 offset:14848
v_mfma_f32_16x16x32_bf16 a[224:227], v[236:239], v[144:147], a[224:227]
v_accvgpr_read_b32 v212, a216
v_accvgpr_read_b32 v213, a217
v_mfma_f32_16x16x32_bf16 a[228:231], v[232:235], v[132:135], a[228:231]
v_accvgpr_read_b32 v214, a218
v_accvgpr_read_b32 v215, a219
v_mfma_f32_16x16x32_bf16 a[228:231], v[236:239], v[148:151], a[228:231]
v_cvt_pk_bf16_f32 v90, v212, v213
v_cvt_pk_bf16_f32 v91, v214, v215
v_mfma_f32_16x16x32_bf16 a[232:235], v[232:235], v[136:139], a[232:235]
ds_read_b64_tr_b16 v[228:229], v250 offset:12800
ds_read_b64_tr_b16 v[230:231], v250 offset:14848
v_mfma_f32_16x16x32_bf16 a[232:235], v[236:239], v[152:155], a[232:235]
buffer_store_dwordx4 v[88:91], v252, s[20:23], s46 offen offset:2048 sc1
v_accvgpr_read_b32 v220, a220
v_mfma_f32_16x16x32_bf16 a[236:239], v[232:235], v[140:143], a[236:239]
v_accvgpr_read_b32 v221, a221
v_accvgpr_read_b32 v222, a222
v_mfma_f32_16x16x32_bf16 a[236:239], v[236:239], v[156:159], a[236:239]
s_waitcnt lgkmcnt(4)
v_accvgpr_read_b32 v223, a223
v_mfma_f32_16x16x32_bf16 a[224:227], v[240:243], v[160:163], a[224:227]
ds_read_b64_tr_b16 v[232:233], v250 offset:45568
ds_read_b64_tr_b16 v[234:235], v250 offset:47616
v_mfma_f32_16x16x32_bf16 a[224:227], v[244:247], v[176:179], a[224:227]
v_cvt_pk_bf16_f32 v122, v220, v221
v_cvt_pk_bf16_f32 v123, v222, v223
v_mfma_f32_16x16x32_bf16 a[228:231], v[240:243], v[164:167], a[228:231]
buffer_store_dwordx4 v[120:123], v252, s[20:23], s47 offen offset:2048 sc1
v_mfma_f32_16x16x32_bf16 a[228:231], v[244:247], v[180:183], a[228:231]
v_mfma_f32_16x16x32_bf16 a[232:235], v[240:243], v[168:171], a[232:235]
ds_read_b64_tr_b16 v[236:237], v250 offset:61952
ds_read_b64_tr_b16 v[238:239], v250 offset:64000
v_mfma_f32_16x16x32_bf16 a[232:235], v[244:247], v[184:187], a[232:235]
v_mfma_f32_16x16x32_bf16 a[236:239], v[240:243], v[172:175], a[236:239]
v_mfma_f32_16x16x32_bf16 a[236:239], v[244:247], v[188:191], a[236:239]
s_waitcnt lgkmcnt(4)
v_mfma_f32_16x16x32_bf16 a[224:227], v[224:227], v[0:3], a[224:227]
ds_read_b64_tr_b16 v[240:241], v13 offset:12800
ds_read_b64_tr_b16 v[242:243], v13 offset:14848
v_mfma_f32_16x16x32_bf16 a[228:231], v[224:227], v[32:35], a[228:231]
v_mfma_f32_16x16x32_bf16 a[232:235], v[224:227], v[64:67], a[232:235]
v_mfma_f32_16x16x32_bf16 a[236:239], v[224:227], v[96:99], a[236:239]
v_mfma_f32_16x16x32_bf16 a[240:243], v[228:231], v[0:3], a[240:243]
ds_read_b64_tr_b16 v[244:245], v13 offset:29184
ds_read_b64_tr_b16 v[246:247], v13 offset:31232
v_mfma_f32_16x16x32_bf16 a[244:247], v[228:231], v[32:35], a[244:247]
v_accvgpr_read_b32 v192, a224
v_accvgpr_read_b32 v193, a225
v_mfma_f32_16x16x32_bf16 a[248:251], v[228:231], v[64:67], a[248:251]
v_accvgpr_read_b32 v194, a226
v_accvgpr_read_b32 v195, a227
v_mfma_f32_16x16x32_bf16 a[252:255], v[228:231], v[96:99], a[252:255]
s_waitcnt lgkmcnt(4)
v_cvt_pk_bf16_f32 v28, v192, v193
v_mfma_f32_16x16x32_bf16 a[240:243], v[232:235], v[4:7], a[240:243]
ds_read_b64_tr_b16 v[224:225], v13 offset:45568
ds_read_b64_tr_b16 v[226:227], v13 offset:47616
v_mfma_f32_16x16x32_bf16 a[240:243], v[236:239], v[8:11], a[240:243]
v_cvt_pk_bf16_f32 v29, v194, v195
v_accvgpr_read_b32 v200, a228
v_mfma_f32_16x16x32_bf16 a[244:247], v[232:235], v[36:39], a[244:247]
v_accvgpr_read_b32 v201, a229
v_accvgpr_read_b32 v202, a230
v_mfma_f32_16x16x32_bf16 a[244:247], v[236:239], v[40:43], a[244:247]
v_accvgpr_read_b32 v203, a231
v_cvt_pk_bf16_f32 v60, v200, v201
v_mfma_f32_16x16x32_bf16 a[248:251], v[232:235], v[68:71], a[248:251]
ds_read_b64_tr_b16 v[228:229], v13 offset:61952
ds_read_b64_tr_b16 v[230:231], v13 offset:64000
v_mfma_f32_16x16x32_bf16 a[248:251], v[236:239], v[72:75], a[248:251]
v_cvt_pk_bf16_f32 v61, v202, v203
v_accvgpr_read_b32 v208, a232
v_mfma_f32_16x16x32_bf16 a[252:255], v[232:235], v[100:103], a[252:255]
v_accvgpr_read_b32 v209, a233
v_accvgpr_read_b32 v210, a234
v_mfma_f32_16x16x32_bf16 a[252:255], v[236:239], v[104:107], a[252:255]
s_waitcnt lgkmcnt(4)
v_accvgpr_read_b32 v211, a235
v_mfma_f32_16x16x32_bf16 a[240:243], v[240:243], v[128:131], a[240:243]
v_cvt_pk_bf16_f32 v92, v208, v209
v_cvt_pk_bf16_f32 v93, v210, v211
v_mfma_f32_16x16x32_bf16 a[240:243], v[244:247], v[144:147], a[240:243]
v_accvgpr_read_b32 v216, a236
v_accvgpr_read_b32 v217, a237
v_mfma_f32_16x16x32_bf16 a[244:247], v[240:243], v[132:135], a[244:247]
v_accvgpr_read_b32 v218, a238
v_accvgpr_read_b32 v219, a239
v_mfma_f32_16x16x32_bf16 a[244:247], v[244:247], v[148:151], a[244:247]
v_cvt_pk_bf16_f32 v124, v216, v217
v_cvt_pk_bf16_f32 v125, v218, v219
v_mfma_f32_16x16x32_bf16 a[248:251], v[240:243], v[136:139], a[248:251]
v_mfma_f32_16x16x32_bf16 a[248:251], v[244:247], v[152:155], a[248:251]
v_mfma_f32_16x16x32_bf16 a[252:255], v[240:243], v[140:143], a[252:255]
v_mfma_f32_16x16x32_bf16 a[252:255], v[244:247], v[156:159], a[252:255]
s_waitcnt lgkmcnt(0)
v_mfma_f32_16x16x32_bf16 a[240:243], v[224:227], v[160:163], a[240:243]
v_mfma_f32_16x16x32_bf16 a[240:243], v[228:231], v[176:179], a[240:243]
v_mfma_f32_16x16x32_bf16 a[244:247], v[224:227], v[164:167], a[244:247]
v_mfma_f32_16x16x32_bf16 a[244:247], v[228:231], v[180:183], a[244:247]
v_mfma_f32_16x16x32_bf16 a[248:251], v[224:227], v[168:171], a[248:251]
v_mfma_f32_16x16x32_bf16 a[248:251], v[228:231], v[184:187], a[248:251]
v_mfma_f32_16x16x32_bf16 a[252:255], v[224:227], v[172:175], a[252:255]
s_nop 2
v_accvgpr_read_b32 v196, a240
v_accvgpr_read_b32 v197, a241
v_accvgpr_read_b32 v198, a242
v_accvgpr_read_b32 v199, a243
v_mfma_f32_16x16x32_bf16 a[252:255], v[228:231], v[188:191], a[252:255]
v_cvt_pk_bf16_f32 v30, v196, v197
v_cvt_pk_bf16_f32 v31, v198, v199
buffer_store_dwordx4 v[28:31], v252, s[20:23], s44 offen offset:3072 sc1
v_accvgpr_read_b32 v204, a244
v_accvgpr_read_b32 v205, a245
v_accvgpr_read_b32 v206, a246
v_accvgpr_read_b32 v207, a247
v_cvt_pk_bf16_f32 v62, v204, v205
v_cvt_pk_bf16_f32 v63, v206, v207
buffer_store_dwordx4 v[60:63], v252, s[20:23], s45 offen offset:3072 sc1
v_accvgpr_read_b32 v212, a248
v_accvgpr_read_b32 v213, a249
v_accvgpr_read_b32 v214, a250
v_accvgpr_read_b32 v215, a251
v_cvt_pk_bf16_f32 v94, v212, v213
v_cvt_pk_bf16_f32 v95, v214, v215
buffer_store_dwordx4 v[92:95], v252, s[20:23], s46 offen offset:3072 sc1
v_accvgpr_read_b32 v220, a252
v_accvgpr_read_b32 v221, a253
v_accvgpr_read_b32 v222, a254
v_accvgpr_read_b32 v223, a255
v_cvt_pk_bf16_f32 v126, v220, v221
v_cvt_pk_bf16_f32 v127, v222, v223
buffer_store_dwordx4 v[124:127], v252, s[20:23], s47 offen offset:3072 sc1
s_branch L2_chk
L2_chk:
LC_start:
s_cmp_lg_u64 vcc, 0
s_cselect_b32 s98, 1, 0
LC_again:
s_lshl_b32 s48, s38, 7
s_lshl_b32 s49, s38, 7
s_lshl_b32 s50, s38, 7
s_mov_b32 s51, s37
s_cmp_eq_u32 s37, 5
s_cselect_b32 s14, 1, 0
s_cselect_b32 s52, 0x7fff0000, s52
s_cselect_b32 s53, 0x7fff0000, s53
s_cselect_b32 s54, 0x7fff0000, s54
s_cmp_eq_u32 s34, 0
s_cselect_b32 s15, 0x6c00000, s52
s_cselect_b32 s15, s15, 0x7fff0000
LC_common:
s_nop 0
s_bfe_u32 s3, s2, 0x30003
s_lshl_b32 s13, s34, 4
s_or_b32 s13, s13, s3
s_lshl_b32 s13, s13, 11
s_lshr_b32 s101, s3, 1
s_xor_b32 s101, s101, s34
s_lshl_b32 s101, s101, 10
s_add_u32 s101, s101, s100
s_cmp_eq_u32 s14, 1
s_cselect_b32 s13, 0x7fff0000, s13
s_add_u32 s28, s4, 0x7000000
s_addc_u32 s29, s5, 0
s_mov_b32 s30, 0x4e2000
s_mov_b32 s31, 0x00020000
s_lshl_b32 s33, s34, 7
v_bfe_u32 v5, v252, 4, 3
v_lshrrev_b32 v6, 8, v252
v_xor_b32 v5, v5, v6
v_lshrrev_b32 v6, 7, v252
v_lshl_add_u32 v6, v6, 9, s33
v_lshl_add_u32 v5, v5, 4, v6
v_xor_b32 v6, 64, v5
v_add_u32 v6, 0x1000, v6
s_cmp_ge_u32 s99, 60
s_cbranch_scc0 LC_side
LC_sideok:
s_add_u32 m0, s101, 0
s_nop 0
buffer_load_dwordx4 v5, s[28:31], s52 offen sc1 lds
s_add_u32 m0, s101, 4096
s_nop 0
buffer_load_dwordx4 v6, s[28:31], s52 offen sc1 lds
s_add_u32 m0, s101, 8192
s_nop 0
buffer_load_dwordx4 v5, s[28:31], s53 offen sc1 lds
s_add_u32 m0, s101, 12288
s_nop 0
buffer_load_dwordx4 v6, s[28:31], s53 offen sc1 lds
s_add_u32 m0, s101, 16384
s_nop 0
buffer_load_dwordx4 v5, s[28:31], s54 offen sc1 lds
s_add_u32 m0, s101, 20480
s_nop 0
buffer_load_dwordx4 v6, s[28:31], s54 offen sc1 lds
s_xor_b32 s33, s13, 0x0
buffer_load_dwordx4 a[0:3], v252, s[56:59], s33 offen offset:0
buffer_load_dwordx4 a[4:7], v252, s[56:59], s33 offen offset:1024
s_xor_b32 s35, s13, 0x4000
buffer_load_dwordx4 a[64:67], v252, s[56:59], s35 offen offset:0
buffer_load_dwordx4 a[68:71], v252, s[56:59], s35 offen offset:1024
s_xor_b32 s39, s13, 0x800
buffer_load_dwordx4 a[8:11], v252, s[56:59], s39 offen offset:0
buffer_load_dwordx4 a[12:15], v252, s[56:59], s39 offen offset:1024
s_xor_b32 s32, s13, 0x4800
buffer_load_dwordx4 a[72:75], v252, s[56:59], s32 offen offset:0
buffer_load_dwordx4 a[76:79], v252, s[56:59], s32 offen offset:1024
s_lshl_b32 s32, s34, 2
s_add_u32 s32, s32, s100
s_and_b32 s33, s98, 1
v_mov_b32 v42, s32
v_mov_b32 v43, s33
ds_write_b32 v42, v43 offset:24576
v_lshrrev_b32 v0, 4, v252
v_and_b32 v2, 15, v0
v_lshrrev_b32 v3, 4, v0
s_add_u32 s8, s6, 0x0
s_addc_u32 s9, s7, 0
s_mov_b32 s10, 0x4e2000
s_mov_b32 s11, 0x00020000
s_lshl_b32 s55, s34, 13
s_add_u32 s55, s55, 0x21000
s_lshl_b32 s33, s34, 7
v_bfe_u32 v9, v252, 4, 3
v_lshrrev_b32 v1, 7, v252
v_xor_b32 v9, v9, v1
v_lshl_add_u32 v1, v1, 9, s33
v_lshl_add_u32 v9, v9, 4, v1
s_and_b32 s72, s100, 0x8000
s_lshl_b32 s73, s34, 11
s_add_u32 s73, s73, 0xe000
s_xor_b32 s73, s73, s72
v_mov_b32 v4, 0x7fff0000
v_cmp_eq_u32 vcc, 0, v3
v_mov_b32 v1, s52
s_nop 0
v_cndmask_b32 v4, v4, v1, vcc
v_cmp_eq_u32 vcc, 1, v3
v_mov_b32 v1, s53
s_nop 0
v_cndmask_b32 v4, v4, v1, vcc
v_cmp_eq_u32 vcc, 2, v3
v_mov_b32 v1, s54
s_nop 0
v_cndmask_b32 v4, v4, v1, vcc
v_lshl_add_u32 v4, v2, 9, v4
v_lshrrev_b32 v7, 3, v4
s_add_u32 s20, s4, 0x2000000
s_addc_u32 s21, s5, 0
s_mov_b32 s22, 0x22e4000
s_mov_b32 s23, 0x00020000
s_add_u32 s40, s18, 0x0
s_addc_u32 s41, s19, 0
s_mov_b32 s42, 0x4e2000
s_mov_b32 s43, 0x00020000
s_add_u32 s60, s4, 0x7c00000
s_addc_u32 s61, s5, 0
s_mov_b32 s12, 0xffff0000
v_mov_b32 v40, s48
s_lshl_b32 s33, s34, 11
v_add_u32 v10, s33, v252
s_lshl_b32 s32, s3, 10
v_xor_b32 v38, s32, v10
s_xor_b32 s32, s72, 0x8000
v_add_u32 v38, s32, v38
v_add_u32 v15, s32, v252
v_xor_b32 v39, 0x400, v38
v_lshrrev_b32 v1, 1, v2
v_xor_b32 v1, v1, v3
v_lshrrev_b32 v11, 3, v2
v_lshlrev_b32 v11, 12, v11
v_lshl_add_u32 v11, v1, 4, v11
v_and_b32 v1, 7, v2
v_lshl_add_u32 v11, v1, 7, v11
s_and_b32 s32, s3, 1
s_lshl_b32 s32, s32, 6
v_xor_b32 v11, s32, v11
v_add_u32 v11, s100, v11
v_xor_b32 v12, 64, v11
s_lshl_b32 s33, s34, 12
s_add_u32 s33, s33, 0x18000
s_xor_b32 s33, s33, s72
v_mul_u32_u24 v13, 80, v0
v_add_u32 v13, s33, v13
v_cmp_eq_u32 vcc, 3, v3
v_mov_b32 v4, 0x100000
s_nop 0
v_cndmask_b32 v13, v13, v4, vcc
s_lshl_b32 s32, s51, 2
s_add_u32 s33, s33, s32
v_mul_u32_u24 v14, 80, v2
v_add_u32 v14, s33, v14
v_xor_b32 v1, v1, v3
v_lshlrev_b32 v1, 4, v1
v_lshl_add_u32 v1, v2, 7, v1
v_add_u32 v32, s55, v1
v_xor_b32 v33, 64, v32
v_add_u32 v35, s73, v1
v_xor_b32 v36, 64, v35
v_add_u32 v34, s55, v252
v_add_u32 v37, s73, v252
s_lshl_b32 s32, s34, 11
s_xor_b32 s33, s72, 0x1b000
s_cmp_lt_u32 s34, 2
s_cselect_b32 s33, 0x20000, s33
s_cselect_b32 s35, 13, 12
s_add_u32 s32, s32, s33
s_mul_i32 s33, s51, 3
s_add_u32 s39, s33, 0
s_and_b32 s39, s39, 3
s_lshl_b32 s39, s39, s35
s_add_u32 s39, s39, s32
v_add_u32 v44, s39, v252
s_add_u32 s39, s33, 1
s_and_b32 s39, s39, 3
s_lshl_b32 s39, s39, s35
s_add_u32 s39, s39, s32
v_add_u32 v45, s39, v252
s_add_u32 s39, s33, 2
s_and_b32 s39, s39, 3
s_lshl_b32 s39, s39, s35
s_add_u32 s39, s39, s32
v_add_u32 v46, s39, v252
s_add_u32 s32, s51, 1
s_sub_u32 s33, s32, 6
s_cselect_b32 s32, s32, s33
s_mul_i32 s44, s32, 0x600000
s_add_u32 s32, s51, 2
s_sub_u32 s33, s32, 6
s_cselect_b32 s32, s32, s33
s_mul_i32 s45, s32, 0x600000
s_add_u32 s32, s51, 3
s_sub_u32 s33, s32, 6
s_cselect_b32 s32, s32, s33
s_mul_i32 s46, s32, 0x600000
s_add_u32 s32, s51, 4
s_sub_u32 s33, s32, 6
s_cselect_b32 s32, s32, s33
s_mul_i32 s47, s32, 0x600000
v_mov_b32 v41, 1
v_and_b32 v42, 3, v0
v_lshl_add_u32 v42, v42, 2, s100
s_lshl_b32 s33, s34, 12
s_sub_u32 s33, s33, s72
s_cmp_lt_u32 s98, 2
s_cselect_b32 s33, s33, 0x100000
v_add_u32 v1, s33, v252
v_add_u32 v1, 0x1c000, v1
s_waitcnt vmcnt(14)
s_waitcnt lgkmcnt(0)
s_barrier
ds_read_b32 v43, v42 offset:24576
ds_write_b128 v1, v[16:19] offset:0
ds_write_b128 v1, v[20:23] offset:1024
ds_write_b128 v1, v[24:27] offset:2048
ds_write_b128 v1, v[28:31] offset:3072
s_waitcnt lgkmcnt(4)
v_cmp_ne_u32 vcc, 0, v43
s_cbranch_vccnz LC_slow
s_mov_b64 exec, 1
buffer_atomic_add v41, v40, s[56:59], s15 offen
s_mov_b64 exec, -1
s_cmp_eq_u32 s14, 1
s_cbranch_scc1 L2_fin
s_add_u32 s32, s51, 5
s_sub_u32 s33, s32, 6
s_cselect_b32 s32, s32, s33
s_mul_i32 s15, s32, 0x600000
s_add_u32 m0, s73, 0
s_add_u32 s33, s54, 0
buffer_load_dwordx4 v9, s[8:11], s33 offen lds
s_add_u32 m0, s73, 1024
s_add_u32 s35, s54, 4096
buffer_load_dwordx4 v9, s[8:11], s35 offen lds
s_xor_b32 s39, s13, 0x1000
buffer_load_dwordx4 a[16:19], v252, s[56:59], s39 offen offset:0
buffer_load_dwordx4 a[20:23], v252, s[56:59], s39 offen offset:1024
s_xor_b32 s32, s13, 0x5000
buffer_load_dwordx4 a[80:83], v252, s[56:59], s32 offen offset:0
buffer_load_dwordx4 a[84:87], v252, s[56:59], s32 offen offset:1024
s_xor_b32 s33, s13, 0x1800
buffer_load_dwordx4 a[24:27], v252, s[56:59], s33 offen offset:0
buffer_load_dwordx4 a[28:31], v252, s[56:59], s33 offen offset:1024
s_xor_b32 s35, s13, 0x5800
buffer_load_dwordx4 a[88:91], v252, s[56:59], s35 offen offset:0
buffer_load_dwordx4 a[92:95], v252, s[56:59], s35 offen offset:1024
s_xor_b32 s39, s13, 0x2000
buffer_load_dwordx4 a[32:35], v252, s[56:59], s39 offen offset:0
buffer_load_dwordx4 a[36:39], v252, s[56:59], s39 offen offset:1024
ds_read_b128 v[52:55], v32 offset:0
ds_read_b128 v[60:63], v33 offset:0
s_waitcnt lgkmcnt(1)
v_lshlrev_b32 v48, 16, v52
v_and_b32 v49, s12, v52
v_lshlrev_b32 v50, 16, v53
v_and_b32 v51, s12, v53
v_lshlrev_b32 v52, 16, v54
v_and_b32 v53, s12, v54
v_lshlrev_b32 v54, 16, v55
v_and_b32 v55, s12, v55
s_waitcnt lgkmcnt(0)
v_lshlrev_b32 v56, 16, v60
v_and_b32 v57, s12, v60
v_lshlrev_b32 v58, 16, v61
v_and_b32 v59, s12, v61
v_lshlrev_b32 v60, 16, v62
v_and_b32 v61, s12, v62
v_lshlrev_b32 v62, 16, v63
v_and_b32 v63, s12, v63
ds_read_b128 v[68:71], v32 offset:2048
ds_read_b128 v[76:79], v33 offset:2048
s_waitcnt lgkmcnt(1)
v_lshlrev_b32 v64, 16, v68
v_and_b32 v65, s12, v68
v_lshlrev_b32 v66, 16, v69
v_and_b32 v67, s12, v69
v_lshlrev_b32 v68, 16, v70
v_and_b32 v69, s12, v70
v_lshlrev_b32 v70, 16, v71
v_and_b32 v71, s12, v71
s_waitcnt lgkmcnt(0)
v_lshlrev_b32 v72, 16, v76
v_and_b32 v73, s12, v76
v_lshlrev_b32 v74, 16, v77
v_and_b32 v75, s12, v77
v_lshlrev_b32 v76, 16, v78
v_and_b32 v77, s12, v78
v_lshlrev_b32 v78, 16, v79
v_and_b32 v79, s12, v79
s_waitcnt vmcnt(11)
s_xor_b32 s32, s13, 0x6000
buffer_load_dwordx4 a[96:99], v252, s[56:59], s32 offen offset:0
s_waitcnt vmcnt(11)
buffer_load_dwordx4 a[100:103], v252, s[56:59], s32 offen offset:1024
s_waitcnt vmcnt(11)
s_xor_b32 s33, s13, 0x2800
buffer_load_dwordx4 a[40:43], v252, s[56:59], s33 offen offset:0
s_waitcnt vmcnt(11)
buffer_load_dwordx4 a[44:47], v252, s[56:59], s33 offen offset:1024
s_waitcnt vmcnt(11)
s_xor_b32 s35, s13, 0x6800
buffer_load_dwordx4 a[104:107], v252, s[56:59], s35 offen offset:0
s_waitcnt vmcnt(11)
buffer_load_dwordx4 a[108:111], v252, s[56:59], s35 offen offset:1024
s_waitcnt vmcnt(11)
s_xor_b32 s39, s13, 0x3000
buffer_load_dwordx4 a[48:51], v252, s[56:59], s39 offen offset:0
s_waitcnt vmcnt(11)
buffer_load_dwordx4 a[52:55], v252, s[56:59], s39 offen offset:1024
s_waitcnt vmcnt(11)
s_xor_b32 s32, s13, 0x7000
buffer_load_dwordx4 a[112:115], v252, s[56:59], s32 offen offset:0
s_waitcnt vmcnt(11)
buffer_load_dwordx4 a[116:119], v252, s[56:59], s32 offen offset:1024
s_waitcnt vmcnt(11)
s_xor_b32 s33, s13, 0x3800
buffer_load_dwordx4 a[56:59], v252, s[56:59], s33 offen offset:0
s_waitcnt vmcnt(11)
buffer_load_dwordx4 a[60:63], v252, s[56:59], s33 offen offset:1024
s_waitcnt vmcnt(11)
s_xor_b32 s35, s13, 0x7800
buffer_load_dwordx4 a[120:123], v252, s[56:59], s35 offen offset:0
s_waitcnt vmcnt(11)
buffer_load_dwordx4 a[124:127], v252, s[56:59], s35 offen offset:1024
s_waitcnt vmcnt(11)
s_xor_b32 s39, s13, 0x20000
buffer_load_dwordx4 a[128:131], v252, s[56:59], s39 offen offset:0
s_waitcnt vmcnt(11)
buffer_load_dwordx4 a[132:135], v252, s[56:59], s39 offen offset:1024
s_waitcnt vmcnt(11)
s_xor_b32 s32, s13, 0x24000
buffer_load_dwordx4 a[192:195], v252, s[56:59], s32 offen offset:0
s_waitcnt vmcnt(11)
buffer_load_dwordx4 a[196:199], v252, s[56:59], s32 offen offset:1024
s_waitcnt vmcnt(11)
s_xor_b32 s33, s13, 0x20800
buffer_load_dwordx4 a[136:139], v252, s[56:59], s33 offen offset:0
s_waitcnt vmcnt(11)
buffer_load_dwordx4 a[140:143], v252, s[56:59], s33 offen offset:1024
s_waitcnt vmcnt(11)
s_xor_b32 s35, s13, 0x24800
buffer_load_dwordx4 a[200:203], v252, s[56:59], s35 offen offset:0
s_waitcnt vmcnt(11)
buffer_load_dwordx4 a[204:207], v252, s[56:59], s35 offen offset:1024
s_waitcnt vmcnt(11)
s_xor_b32 s39, s13, 0x21000
buffer_load_dwordx4 a[144:147], v252, s[56:59], s39 offen offset:0
s_waitcnt vmcnt(11)
buffer_load_dwordx4 a[148:151], v252, s[56:59], s39 offen offset:1024
s_waitcnt vmcnt(11)
s_xor_b32 s32, s13, 0x25000
buffer_load_dwordx4 a[208:211], v252, s[56:59], s32 offen offset:0
s_waitcnt vmcnt(11)
buffer_load_dwordx4 a[212:215], v252, s[56:59], s32 offen offset:1024
s_waitcnt vmcnt(11)
s_xor_b32 s33, s13, 0x21800
buffer_load_dwordx4 a[152:155], v252, s[56:59], s33 offen offset:0
s_waitcnt vmcnt(11)
buffer_load_dwordx4 a[156:159], v252, s[56:59], s33 offen offset:1024
s_waitcnt vmcnt(11)
s_xor_b32 s35, s13, 0x25800
buffer_load_dwordx4 a[216:219], v252, s[56:59], s35 offen offset:0
s_waitcnt vmcnt(11)
buffer_load_dwordx4 a[220:223], v252, s[56:59], s35 offen offset:1024
s_waitcnt vmcnt(11)
s_mov_b32 s70, 0
s_atomic_add s70, s[60:61], s48 glc
s_waitcnt vmcnt(10)
s_xor_b32 s39, s13, 0x22000
buffer_load_dwordx4 a[160:163], v252, s[56:59], s39 offen offset:0
s_waitcnt vmcnt(10)
buffer_load_dwordx4 a[164:167], v252, s[56:59], s39 offen offset:1024
s_waitcnt vmcnt(10)
s_xor_b32 s32, s13, 0x26000
buffer_load_dwordx4 a[224:227], v252, s[56:59], s32 offen offset:0
s_waitcnt vmcnt(10)
buffer_load_dwordx4 a[228:231], v252, s[56:59], s32 offen offset:1024
s_waitcnt vmcnt(10)
s_xor_b32 s33, s13, 0x22800
buffer_load_dwordx4 a[168:171], v252, s[56:59], s33 offen offset:0
s_waitcnt vmcnt(10)
buffer_load_dwordx4 a[172:175], v252, s[56:59], s33 offen offset:1024
s_waitcnt vmcnt(10)
s_xor_b32 s35, s13, 0x26800
buffer_load_dwordx4 a[232:235], v252, s[56:59], s35 offen offset:0
s_waitcnt vmcnt(10)
buffer_load_dwordx4 a[236:239], v252, s[56:59], s35 offen offset:1024
ds_read_b128 v[84:87], v35 offset:0
ds_read_b128 v[92:95], v36 offset:0
s_waitcnt lgkmcnt(1)
v_lshlrev_b32 v80, 16, v84
v_and_b32 v81, s12, v84
v_lshlrev_b32 v82, 16, v85
v_and_b32 v83, s12, v85
v_lshlrev_b32 v84, 16, v86
v_and_b32 v85, s12, v86
v_lshlrev_b32 v86, 16, v87
v_and_b32 v87, s12, v87
s_waitcnt lgkmcnt(0)
v_lshlrev_b32 v88, 16, v92
v_and_b32 v89, s12, v92
v_lshlrev_b32 v90, 16, v93
v_and_b32 v91, s12, v93
v_lshlrev_b32 v92, 16, v94
v_and_b32 v93, s12, v94
v_lshlrev_b32 v94, 16, v95
v_and_b32 v95, s12, v95
s_waitcnt lgkmcnt(0)
s_cmp_lt_u32 s70, 6
s_cbranch_scc1 LC_poll
s_cmp_ge_u32 s98, 2
s_cbranch_scc1 LC_poll
LC_got:
buffer_load_dwordx4 v[156:159], v7, s[24:27], 0 offen offset:0 sc1
buffer_load_dwordx4 v[160:163], v7, s[24:27], 0 offen offset:16 sc1
buffer_load_dwordx4 v[164:167], v7, s[24:27], 0 offen offset:32 sc1
s_add_u32 s39, s52, s44
buffer_load_dwordx4 v[168:171], v10, s[20:23], s39 offen offset:0 sc1
s_add_u32 s32, s52, s45
buffer_load_dwordx4 v[172:175], v10, s[20:23], s32 offen offset:0 sc1
s_add_u32 s33, s52, s46
buffer_load_dwordx4 v[176:179], v10, s[20:23], s33 offen offset:0 sc1
s_add_u32 s35, s52, s47
buffer_load_dwordx4 v[180:183], v10, s[20:23], s35 offen offset:0 sc1
s_add_u32 s39, s52, s15
buffer_load_dwordx4 v[184:187], v10, s[20:23], s39 offen offset:0 sc1
s_add_u32 s32, s52, s44
buffer_load_dwordx4 v[188:191], v10, s[20:23], s32 offen offset:1024 sc1
s_add_u32 s33, s52, s45
buffer_load_dwordx4 v[192:195], v10, s[20:23], s33 offen offset:1024 sc1
s_add_u32 s35, s52, s46
buffer_load_dwordx4 v[196:199], v10, s[20:23], s35 offen offset:1024 sc1
s_add_u32 s39, s52, s47
buffer_load_dwordx4 v[200:203], v10, s[20:23], s39 offen offset:1024 sc1
s_add_u32 s32, s52, s15
buffer_load_dwordx4 v[204:207], v10, s[20:23], s32 offen offset:1024 sc1
s_add_u32 s33, s53, s44
buffer_load_dwordx4 v[208:211], v10, s[20:23], s33 offen offset:0 sc1
s_barrier
ds_read_b128 v[132:135], v11 offset:0
ds_read_b128 v[136:139], v11 offset:8192
ds_read_b128 v[140:143], v11 offset:16384
ds_read_b128 v[144:147], v12 offset:0
ds_read_b128 v[148:151], v12 offset:8192
s_waitcnt vmcnt(24)
s_waitcnt vmcnt(23)
s_waitcnt vmcnt(22)
s_waitcnt vmcnt(21)
s_waitcnt vmcnt(20)
s_waitcnt vmcnt(19)
s_waitcnt vmcnt(18)
s_waitcnt vmcnt(17)
s_waitcnt vmcnt(16)
s_waitcnt vmcnt(15)
s_waitcnt vmcnt(14)
s_waitcnt lgkmcnt(4)
v_mfma_f32_16x16x32_bf16 v[48:51], a[0:3], v[132:135], v[48:51]
ds_read_b128 v[152:155], v12 offset:16384
v_mfma_f32_16x16x32_bf16 v[52:55], a[4:7], v[132:135], v[52:55]
v_mfma_f32_16x16x32_bf16 v[56:59], a[64:67], v[132:135], v[56:59]
v_mfma_f32_16x16x32_bf16 v[60:63], a[68:71], v[132:135], v[60:63]
s_waitcnt lgkmcnt(4)
v_mfma_f32_16x16x32_bf16 v[64:67], a[0:3], v[136:139], v[64:67]
ds_read_b128 v[132:135], v11 offset:1024
v_mfma_f32_16x16x32_bf16 v[68:71], a[4:7], v[136:139], v[68:71]
v_mfma_f32_16x16x32_bf16 v[72:75], a[64:67], v[136:139], v[72:75]
v_mfma_f32_16x16x32_bf16 v[76:79], a[68:71], v[136:139], v[76:79]
s_waitcnt lgkmcnt(4)
v_mfma_f32_16x16x32_bf16 v[80:83], a[0:3], v[140:143], v[80:83]
ds_read_b128 v[136:139], v11 offset:9216
v_mfma_f32_16x16x32_bf16 v[84:87], a[4:7], v[140:143], v[84:87]
v_mfma_f32_16x16x32_bf16 v[88:91], a[64:67], v[140:143], v[88:91]
v_mfma_f32_16x16x32_bf16 v[92:95], a[68:71], v[140:143], v[92:95]
s_waitcnt lgkmcnt(4)
v_mfma_f32_16x16x32_bf16 v[48:51], a[8:11], v[144:147], v[48:51]
ds_read_b128 v[140:143], v11 offset:17408
v_mfma_f32_16x16x32_bf16 v[52:55], a[12:15], v[144:147], v[52:55]
v_mfma_f32_16x16x32_bf16 v[56:59], a[72:75], v[144:147], v[56:59]
v_mfma_f32_16x16x32_bf16 v[60:63], a[76:79], v[144:147], v[60:63]
s_waitcnt vmcnt(13)
s_xor_b32 s35, s13, 0x23000
buffer_load_dwordx4 a[176:179], v252, s[56:59], s35 offen offset:0
s_waitcnt vmcnt(13)
s_add_u32 s39, s53, s45
buffer_load_dwordx4 v[212:215], v10, s[20:23], s39 offen offset:0 sc1
s_waitcnt vmcnt(13)
s_xor_b32 s32, s13, 0x23000
buffer_load_dwordx4 a[180:183], v252, s[56:59], s32 offen offset:1024
s_waitcnt lgkmcnt(4)
v_mfma_f32_16x16x32_bf16 v[64:67], a[8:11], v[148:151], v[64:67]
ds_read_b128 v[144:147], v12 offset:1024
v_max3_f32 v1, v156, v158, v160
v_max3_f32 v117, v162, v164, v166
v_max_f32 v1, v1, v117
v_mfma_f32_16x16x32_bf16 v[68:71], a[12:15], v[148:151], v[68:71]
v_sub_f32 v156, v156, v1
v_sub_f32 v158, v158, v1
v_sub_f32 v160, v160, v1
v_mfma_f32_16x16x32_bf16 v[72:75], a[72:75], v[148:151], v[72:75]
v_sub_f32 v162, v162, v1
v_sub_f32 v164, v164, v1
v_sub_f32 v166, v166, v1
v_mfma_f32_16x16x32_bf16 v[76:79], a[76:79], v[148:151], v[76:79]
v_exp_f32 v156, v156
v_exp_f32 v158, v158
v_exp_f32 v160, v160
s_waitcnt lgkmcnt(4)
v_mfma_f32_16x16x32_bf16 v[80:83], a[8:11], v[152:155], v[80:83]
ds_read_b128 v[148:151], v12 offset:9216
v_exp_f32 v162, v162
v_exp_f32 v164, v164
v_exp_f32 v166, v166
v_mfma_f32_16x16x32_bf16 v[84:87], a[12:15], v[152:155], v[84:87]
s_nop 0
v_mul_f32 v1, v156, v157
v_fmac_f32 v1, v158, v159
v_mfma_f32_16x16x32_bf16 v[88:91], a[72:75], v[152:155], v[88:91]
v_fmac_f32 v1, v160, v161
v_fmac_f32 v1, v162, v163
v_fmac_f32 v1, v164, v165
v_mfma_f32_16x16x32_bf16 v[92:95], a[76:79], v[152:155], v[92:95]
v_fmac_f32 v1, v166, v167
v_rcp_f32 v1, v1
s_nop 0
s_waitcnt lgkmcnt(4)
v_mfma_f32_16x16x32_bf16 v[48:51], a[16:19], v[132:135], v[48:51]
ds_read_b128 v[152:155], v12 offset:17408
v_mul_f32 v108, v156, v1
v_mul_f32 v109, v158, v1
v_mul_f32 v110, v160, v1
v_mfma_f32_16x16x32_bf16 v[52:55], a[20:23], v[132:135], v[52:55]
v_mul_f32 v111, v162, v1
v_mul_f32 v112, v164, v1
v_mul_f32 v113, v166, v1
v_mfma_f32_16x16x32_bf16 v[56:59], a[80:83], v[132:135], v[56:59]
v_mul_f32 v114, v156, v1
v_mul_f32 v115, v158, v1
ds_write_b128 v13, v[108:111]
v_mfma_f32_16x16x32_bf16 v[60:63], a[84:87], v[132:135], v[60:63]
ds_write_b128 v13, v[112:115] offset:16
ds_write_b64 v13, v[110:111] offset:32
ds_write_b64 v13, v[112:113] offset:40
s_waitcnt lgkmcnt(8)
v_mfma_f32_16x16x32_bf16 v[64:67], a[16:19], v[136:139], v[64:67]
ds_read_b128 v[132:135], v11 offset:2048
ds_read2_b32 v[16:17], v14 offset0:1 offset1:1
ds_read2_b32 v[18:19], v14 offset0:2 offset1:2
ds_read2_b32 v[20:21], v14 offset0:3 offset1:3
v_mfma_f32_16x16x32_bf16 v[68:71], a[20:23], v[136:139], v[68:71]
ds_read2_b32 v[22:23], v14 offset0:4 offset1:4
ds_read2_b32 v[24:25], v14 offset0:5 offset1:5
ds_read2_b32 v[26:27], v14 offset0:6 offset1:6
v_mfma_f32_16x16x32_bf16 v[72:75], a[80:83], v[136:139], v[72:75]
v_add_u32 v14, 0x500, v14
v_mfma_f32_16x16x32_bf16 v[76:79], a[84:87], v[136:139], v[76:79]
s_waitcnt vmcnt(13)
s_add_u32 s33, s53, s46
buffer_load_dwordx4 v[216:219], v10, s[20:23], s33 offen offset:0 sc1
s_waitcnt lgkmcnt(14)
v_mfma_f32_16x16x32_bf16 v[80:83], a[16:19], v[140:143], v[80:83]
ds_read_b128 v[136:139], v11 offset:10240
ds_read_b128 v[96:99], v44 offset:0
s_waitcnt lgkmcnt(2)
v_lshlrev_b32 v116, 16, v168
v_and_b32 v117, s12, v168
v_mfma_f32_16x16x32_bf16 v[84:87], a[20:23], v[140:143], v[84:87]
v_lshlrev_b32 v118, 16, v169
v_and_b32 v119, s12, v169
v_lshlrev_b32 v120, 16, v170
v_mfma_f32_16x16x32_bf16 v[88:91], a[80:83], v[140:143], v[88:91]
v_and_b32 v121, s12, v170
v_lshlrev_b32 v122, 16, v171
v_and_b32 v123, s12, v171
v_mfma_f32_16x16x32_bf16 v[92:95], a[84:87], v[140:143], v[92:95]
v_mul_f32 v108, v116, v16
v_mul_f32 v109, v117, v16
v_mul_f32 v110, v118, v16
v_mfma_f32_16x16x32_bf16 v[48:51], a[24:27], v[144:147], v[48:51]
ds_read_b128 v[140:143], v11 offset:18432
v_mul_f32 v111, v119, v16
v_mul_f32 v112, v120, v16
v_mul_f32 v113, v121, v16
v_mfma_f32_16x16x32_bf16 v[52:55], a[28:31], v[144:147], v[52:55]
v_mul_f32 v114, v122, v16
v_mul_f32 v115, v123, v16
v_mfma_f32_16x16x32_bf16 v[56:59], a[88:91], v[144:147], v[56:59]
v_mfma_f32_16x16x32_bf16 v[60:63], a[92:95], v[144:147], v[60:63]
s_waitcnt vmcnt(13)
s_xor_b32 s35, s13, 0x27000
buffer_load_dwordx4 a[240:243], v252, s[56:59], s35 offen offset:0
v_mfma_f32_16x16x32_bf16 v[64:67], a[24:27], v[148:151], v[64:67]
ds_read_b128 v[144:147], v12 offset:2048
v_lshlrev_b32 v116, 16, v172
v_and_b32 v117, s12, v172
v_mfma_f32_16x16x32_bf16 v[68:71], a[28:31], v[148:151], v[68:71]
v_lshlrev_b32 v118, 16, v173
v_and_b32 v119, s12, v173
v_mfma_f32_16x16x32_bf16 v[72:75], a[88:91], v[148:151], v[72:75]
v_lshlrev_b32 v120, 16, v174
v_and_b32 v121, s12, v174
v_mfma_f32_16x16x32_bf16 v[76:79], a[92:95], v[148:151], v[76:79]
v_lshlrev_b32 v122, 16, v175
v_and_b32 v123, s12, v175
v_mfma_f32_16x16x32_bf16 v[80:83], a[24:27], v[152:155], v[80:83]
ds_read_b128 v[148:151], v12 offset:10240
v_fmac_f32 v108, v116, v18
v_fmac_f32 v109, v117, v18
v_mfma_f32_16x16x32_bf16 v[84:87], a[28:31], v[152:155], v[84:87]
v_fmac_f32 v110, v118, v18
v_fmac_f32 v111, v119, v18
v_mfma_f32_16x16x32_bf16 v[88:91], a[88:91], v[152:155], v[88:91]
v_fmac_f32 v112, v120, v18
v_fmac_f32 v113, v121, v18
v_mfma_f32_16x16x32_bf16 v[92:95], a[92:95], v[152:155], v[92:95]
v_fmac_f32 v114, v122, v18
v_fmac_f32 v115, v123, v18
s_waitcnt vmcnt(13)
s_add_u32 s39, s53, s47
buffer_load_dwordx4 v[220:223], v10, s[20:23], s39 offen offset:0 sc1
v_mfma_f32_16x16x32_bf16 v[48:51], a[32:35], v[132:135], v[48:51]
ds_read_b128 v[152:155], v12 offset:18432
v_lshlrev_b32 v116, 16, v176
v_and_b32 v117, s12, v176
v_mfma_f32_16x16x32_bf16 v[52:55], a[36:39], v[132:135], v[52:55]
v_lshlrev_b32 v118, 16, v177
v_and_b32 v119, s12, v177
v_mfma_f32_16x16x32_bf16 v[56:59], a[96:99], v[132:135], v[56:59]
v_lshlrev_b32 v120, 16, v178
v_and_b32 v121, s12, v178
v_mfma_f32_16x16x32_bf16 v[60:63], a[100:103], v[132:135], v[60:63]
v_lshlrev_b32 v122, 16, v179
v_and_b32 v123, s12, v179
s_waitcnt lgkmcnt(5)
v_mfma_f32_16x16x32_bf16 v[64:67], a[32:35], v[136:139], v[64:67]
ds_read_b128 v[132:135], v11 offset:3072
v_fmac_f32 v108, v116, v20
v_fmac_f32 v109, v117, v20
v_mfma_f32_16x16x32_bf16 v[68:71], a[36:39], v[136:139], v[68:71]
v_fmac_f32 v110, v118, v20
v_fmac_f32 v111, v119, v20
v_mfma_f32_16x16x32_bf16 v[72:75], a[96:99], v[136:139], v[72:75]
v_fmac_f32 v112, v120, v20
v_fmac_f32 v113, v121, v20
v_mfma_f32_16x16x32_bf16 v[76:79], a[100:103], v[136:139], v[76:79]
v_fmac_f32 v114, v122, v20
v_fmac_f32 v115, v123, v20
s_waitcnt vmcnt(13)
s_xor_b32 s32, s13, 0x27000
buffer_load_dwordx4 a[244:247], v252, s[56:59], s32 offen offset:1024
s_waitcnt lgkmcnt(4)
v_mfma_f32_16x16x32_bf16 v[80:83], a[32:35], v[140:143], v[80:83]
ds_read_b128 v[136:139], v11 offset:11264
v_lshlrev_b32 v116, 16, v180
v_and_b32 v117, s12, v180
v_mfma_f32_16x16x32_bf16 v[84:87], a[36:39], v[140:143], v[84:87]
v_lshlrev_b32 v118, 16, v181
v_and_b32 v119, s12, v181
v_mfma_f32_16x16x32_bf16 v[88:91], a[96:99], v[140:143], v[88:91]
v_lshlrev_b32 v120, 16, v182
v_and_b32 v121, s12, v182
v_mfma_f32_16x16x32_bf16 v[92:95], a[100:103], v[140:143], v[92:95]
v_lshlrev_b32 v122, 16, v183
v_and_b32 v123, s12, v183
s_waitcnt lgkmcnt(4)
v_mfma_f32_16x16x32_bf16 v[48:51], a[40:43], v[144:147], v[48:51]
ds_read_b128 v[140:143], v11 offset:19456
v_fmac_f32 v108, v116, v22
v_fmac_f32 v109, v117, v22
v_mfma_f32_16x16x32_bf16 v[52:55], a[44:47], v[144:147], v[52:55]
v_fmac_f32 v110, v118, v22
v_fmac_f32 v111, v119, v22
v_mfma_f32_16x16x32_bf16 v[56:59], a[104:107], v[144:147], v[56:59]
v_fmac_f32 v112, v120, v22
v_fmac_f32 v113, v121, v22
v_mfma_f32_16x16x32_bf16 v[60:63], a[108:111], v[144:147], v[60:63]
v_fmac_f32 v114, v122, v22
v_fmac_f32 v115, v123, v22
s_waitcnt lgkmcnt(4)
v_mfma_f32_16x16x32_bf16 v[64:67], a[40:43], v[148:151], v[64:67]
ds_read_b128 v[144:147], v12 offset:3072
v_lshlrev_b32 v116, 16, v96
v_and_b32 v117, s12, v96
v_mfma_f32_16x16x32_bf16 v[68:71], a[44:47], v[148:151], v[68:71]
v_lshlrev_b32 v118, 16, v97
v_and_b32 v119, s12, v97
v_mfma_f32_16x16x32_bf16 v[72:75], a[104:107], v[148:151], v[72:75]
v_lshlrev_b32 v120, 16, v98
v_and_b32 v121, s12, v98
v_mfma_f32_16x16x32_bf16 v[76:79], a[108:111], v[148:151], v[76:79]
v_lshlrev_b32 v122, 16, v99
v_and_b32 v123, s12, v99
s_waitcnt lgkmcnt(4)
v_mfma_f32_16x16x32_bf16 v[80:83], a[40:43], v[152:155], v[80:83]
ds_read_b128 v[148:151], v12 offset:11264
v_fmac_f32 v108, v116, v26
v_fmac_f32 v109, v117, v26
v_mfma_f32_16x16x32_bf16 v[84:87], a[44:47], v[152:155], v[84:87]
v_fmac_f32 v110, v118, v26
v_fmac_f32 v111, v119, v26
v_mfma_f32_16x16x32_bf16 v[88:91], a[104:107], v[152:155], v[88:91]
v_fmac_f32 v112, v120, v26
v_fmac_f32 v113, v121, v26
v_mfma_f32_16x16x32_bf16 v[92:95], a[108:111], v[152:155], v[92:95]
v_fmac_f32 v114, v122, v26
v_fmac_f32 v115, v123, v26
s_waitcnt vmcnt(13)
s_add_u32 s33, s53, s15
buffer_load_dwordx4 v[224:227], v10, s[20:23], s33 offen offset:0 sc1
s_waitcnt lgkmcnt(4)
v_mfma_f32_16x16x32_bf16 v[48:51], a[48:51], v[132:135], v[48:51]
ds_read_b128 v[152:155], v12 offset:19456
v_lshlrev_b32 v116, 16, v184
v_and_b32 v117, s12, v184
v_lshlrev_b32 v118, 16, v185
v_mfma_f32_16x16x32_bf16 v[52:55], a[52:55], v[132:135], v[52:55]
v_and_b32 v119, s12, v185
v_lshlrev_b32 v120, 16, v186
v_and_b32 v121, s12, v186
v_mfma_f32_16x16x32_bf16 v[56:59], a[112:115], v[132:135], v[56:59]
v_lshlrev_b32 v122, 16, v187
v_and_b32 v123, s12, v187
v_fmac_f32 v108, v116, v24
v_mfma_f32_16x16x32_bf16 v[60:63], a[116:119], v[132:135], v[60:63]
v_fmac_f32 v109, v117, v24
v_fmac_f32 v110, v118, v24
v_fmac_f32 v111, v119, v24
s_waitcnt lgkmcnt(4)
v_mfma_f32_16x16x32_bf16 v[64:67], a[48:51], v[136:139], v[64:67]
v_fmac_f32 v112, v120, v24
v_fmac_f32 v113, v121, v24
v_fmac_f32 v114, v122, v24
v_mfma_f32_16x16x32_bf16 v[68:71], a[52:55], v[136:139], v[68:71]
v_fmac_f32 v115, v123, v24
v_cvt_pk_bf16_f32 v116, v108, v109
v_cvt_pk_bf16_f32 v117, v110, v111
v_mfma_f32_16x16x32_bf16 v[72:75], a[112:115], v[136:139], v[72:75]
v_cvt_pk_bf16_f32 v118, v112, v113
v_cvt_pk_bf16_f32 v119, v114, v115
ds_write_b128 v38, v[116:119] offset:0
v_mfma_f32_16x16x32_bf16 v[76:79], a[116:119], v[136:139], v[76:79]
s_waitcnt vmcnt(13)
s_xor_b32 s35, s13, 0x23800
buffer_load_dwordx4 a[184:187], v252, s[56:59], s35 offen offset:0
s_waitcnt lgkmcnt(4)
v_mfma_f32_16x16x32_bf16 v[80:83], a[48:51], v[140:143], v[80:83]
ds_read_b128 v[96:99], v44 offset:1024
v_lshlrev_b32 v116, 16, v188
v_and_b32 v117, s12, v188
v_mfma_f32_16x16x32_bf16 v[84:87], a[52:55], v[140:143], v[84:87]
v_lshlrev_b32 v118, 16, v189
v_and_b32 v119, s12, v189
v_lshlrev_b32 v120, 16, v190
v_mfma_f32_16x16x32_bf16 v[88:91], a[112:115], v[140:143], v[88:91]
v_and_b32 v121, s12, v190
v_lshlrev_b32 v122, 16, v191
v_and_b32 v123, s12, v191
v_mfma_f32_16x16x32_bf16 v[92:95], a[116:119], v[140:143], v[92:95]
v_mul_f32 v108, v116, v16
v_mul_f32 v109, v117, v16
v_mul_f32 v110, v118, v16
s_waitcnt lgkmcnt(4)
v_mfma_f32_16x16x32_bf16 v[48:51], a[56:59], v[144:147], v[48:51]
v_mul_f32 v111, v119, v16
v_mul_f32 v112, v120, v16
v_mul_f32 v113, v121, v16
v_mfma_f32_16x16x32_bf16 v[52:55], a[60:63], v[144:147], v[52:55]
v_mul_f32 v114, v122, v16
v_mul_f32 v115, v123, v16
v_mfma_f32_16x16x32_bf16 v[56:59], a[120:123], v[144:147], v[56:59]
v_mfma_f32_16x16x32_bf16 v[60:63], a[124:127], v[144:147], v[60:63]
s_waitcnt vmcnt(13)
s_add_u32 s39, s53, s44
buffer_load_dwordx4 v[228:231], v10, s[20:23], s39 offen offset:1024 sc1
s_waitcnt lgkmcnt(3)
v_mfma_f32_16x16x32_bf16 v[64:67], a[56:59], v[148:151], v[64:67]
v_lshlrev_b32 v116, 16, v192
v_and_b32 v117, s12, v192
v_mfma_f32_16x16x32_bf16 v[68:71], a[60:63], v[148:151], v[68:71]
v_lshlrev_b32 v118, 16, v193
v_and_b32 v119, s12, v193
v_mfma_f32_16x16x32_bf16 v[72:75], a[120:123], v[148:151], v[72:75]
v_lshlrev_b32 v120, 16, v194
v_and_b32 v121, s12, v194
v_mfma_f32_16x16x32_bf16 v[76:79], a[124:127], v[148:151], v[76:79]
v_lshlrev_b32 v122, 16, v195
v_and_b32 v123, s12, v195
s_waitcnt lgkmcnt(2)
v_mfma_f32_16x16x32_bf16 v[80:83], a[56:59], v[152:155], v[80:83]
v_fmac_f32 v108, v116, v18
v_fmac_f32 v109, v117, v18
v_mfma_f32_16x16x32_bf16 v[84:87], a[60:63], v[152:155], v[84:87]
v_fmac_f32 v110, v118, v18
v_fmac_f32 v111, v119, v18
v_mfma_f32_16x16x32_bf16 v[88:91], a[120:123], v[152:155], v[88:91]
v_fmac_f32 v112, v120, v18
v_fmac_f32 v113, v121, v18
v_mfma_f32_16x16x32_bf16 v[92:95], a[124:127], v[152:155], v[92:95]
v_fmac_f32 v114, v122, v18
v_fmac_f32 v115, v123, v18
s_waitcnt vmcnt(13)
s_xor_b32 s32, s13, 0x23800
buffer_load_dwordx4 a[188:191], v252, s[56:59], s32 offen offset:1024
v_lshlrev_b32 v116, 16, v196
v_and_b32 v117, s12, v196
v_lshlrev_b32 v118, 16, v197
v_and_b32 v119, s12, v197
v_lshlrev_b32 v120, 16, v198
v_and_b32 v121, s12, v198
v_lshlrev_b32 v122, 16, v199
v_and_b32 v123, s12, v199
v_pk_fma_f32 v[108:109], v[116:117], v[20:21], v[108:109]
v_pk_fma_f32 v[110:111], v[118:119], v[20:21], v[110:111]
v_pk_fma_f32 v[112:113], v[120:121], v[20:21], v[112:113]
v_pk_fma_f32 v[114:115], v[122:123], v[20:21], v[114:115]
s_waitcnt vmcnt(13)
s_add_u32 s33, s53, s45
buffer_load_dwordx4 v[232:235], v10, s[20:23], s33 offen offset:1024 sc1
v_lshlrev_b32 v116, 16, v200
v_and_b32 v117, s12, v200
v_lshlrev_b32 v118, 16, v201
v_and_b32 v119, s12, v201
v_lshlrev_b32 v120, 16, v202
v_and_b32 v121, s12, v202
v_lshlrev_b32 v122, 16, v203
v_and_b32 v123, s12, v203
v_pk_fma_f32 v[108:109], v[116:117], v[22:23], v[108:109]
v_pk_fma_f32 v[110:111], v[118:119], v[22:23], v[110:111]
v_pk_fma_f32 v[112:113], v[120:121], v[22:23], v[112:113]
v_pk_fma_f32 v[114:115], v[122:123], v[22:23], v[114:115]
s_waitcnt lgkmcnt(0)
v_lshlrev_b32 v116, 16, v96
v_and_b32 v117, s12, v96
v_lshlrev_b32 v118, 16, v97
v_and_b32 v119, s12, v97
v_lshlrev_b32 v120, 16, v98
v_and_b32 v121, s12, v98
v_lshlrev_b32 v122, 16, v99
v_and_b32 v123, s12, v99
v_pk_fma_f32 v[108:109], v[116:117], v[26:27], v[108:109]
v_pk_fma_f32 v[110:111], v[118:119], v[26:27], v[110:111]
v_pk_fma_f32 v[112:113], v[120:121], v[26:27], v[112:113]
v_pk_fma_f32 v[114:115], v[122:123], v[26:27], v[114:115]
s_waitcnt vmcnt(13)
s_xor_b32 s35, s13, 0x27800
buffer_load_dwordx4 a[248:251], v252, s[56:59], s35 offen offset:0
v_lshlrev_b32 v116, 16, v204
v_and_b32 v117, s12, v204
v_lshlrev_b32 v118, 16, v205
v_and_b32 v119, s12, v205
v_lshlrev_b32 v120, 16, v206
v_and_b32 v121, s12, v206
v_lshlrev_b32 v122, 16, v207
v_and_b32 v123, s12, v207
v_pk_fma_f32 v[108:109], v[116:117], v[24:25], v[108:109]
v_pk_fma_f32 v[110:111], v[118:119], v[24:25], v[110:111]
v_pk_fma_f32 v[112:113], v[120:121], v[24:25], v[112:113]
v_pk_fma_f32 v[114:115], v[122:123], v[24:25], v[114:115]
ds_read2_b32 v[16:17], v14 offset0:1 offset1:1
ds_read2_b32 v[18:19], v14 offset0:2 offset1:2
ds_read2_b32 v[20:21], v14 offset0:3 offset1:3
ds_read2_b32 v[22:23], v14 offset0:4 offset1:4
ds_read2_b32 v[24:25], v14 offset0:5 offset1:5
ds_read2_b32 v[26:27], v14 offset0:6 offset1:6
v_add_u32 v14, 0x500, v14
v_cvt_pk_bf16_f32 v116, v108, v109
v_cvt_pk_bf16_f32 v117, v110, v111
v_cvt_pk_bf16_f32 v118, v112, v113
v_cvt_pk_bf16_f32 v119, v114, v115
ds_write_b128 v39, v[116:119] offset:0
s_waitcnt lgkmcnt(0)
s_barrier
ds_read_b128 v[132:135], v15 offset:0
ds_read_b128 v[136:139], v15 offset:1024
ds_read_b128 v[140:143], v15 offset:2048
ds_read_b128 v[144:147], v15 offset:3072
ds_read_b128 v[148:151], v15 offset:4096
s_waitcnt lgkmcnt(4)
v_mfma_f32_16x16x32_bf16 v[48:51], a[128:131], v[132:135], v[48:51]
ds_read_b128 v[152:155], v15 offset:5120
v_mfma_f32_16x16x32_bf16 v[52:55], a[132:135], v[132:135], v[52:55]
v_mfma_f32_16x16x32_bf16 v[56:59], a[192:195], v[132:135], v[56:59]
v_mfma_f32_16x16x32_bf16 v[60:63], a[196:199], v[132:135], v[60:63]
s_waitcnt vmcnt(13)
s_add_u32 s39, s53, s46
buffer_load_dwordx4 v[236:239], v10, s[20:23], s39 offen offset:1024 sc1
s_waitcnt lgkmcnt(4)
v_mfma_f32_16x16x32_bf16 v[48:51], a[136:139], v[136:139], v[48:51]
ds_read_b128 v[132:135], v15 offset:6144
ds_read_b128 v[96:99], v45 offset:0
v_lshlrev_b32 v116, 16, v208
v_and_b32 v117, s12, v208
v_mfma_f32_16x16x32_bf16 v[52:55], a[140:143], v[136:139], v[52:55]
v_lshlrev_b32 v118, 16, v209
v_and_b32 v119, s12, v209
v_lshlrev_b32 v120, 16, v210
v_mfma_f32_16x16x32_bf16 v[56:59], a[200:203], v[136:139], v[56:59]
v_and_b32 v121, s12, v210
v_lshlrev_b32 v122, 16, v211
v_and_b32 v123, s12, v211
v_mfma_f32_16x16x32_bf16 v[60:63], a[204:207], v[136:139], v[60:63]
v_mul_f32 v108, v116, v16
v_mul_f32 v109, v117, v16
v_mul_f32 v110, v118, v16
s_waitcnt lgkmcnt(5)
v_mfma_f32_16x16x32_bf16 v[48:51], a[144:147], v[140:143], v[48:51]
ds_read_b128 v[136:139], v15 offset:7168
v_mul_f32 v111, v119, v16
v_mul_f32 v112, v120, v16
v_mul_f32 v113, v121, v16
v_mfma_f32_16x16x32_bf16 v[52:55], a[148:151], v[140:143], v[52:55]
v_mul_f32 v114, v122, v16
v_mul_f32 v115, v123, v16
v_mfma_f32_16x16x32_bf16 v[56:59], a[208:211], v[140:143], v[56:59]
v_mfma_f32_16x16x32_bf16 v[60:63], a[212:215], v[140:143], v[60:63]
s_waitcnt vmcnt(13)
s_xor_b32 s32, s13, 0x27800
buffer_load_dwordx4 a[252:255], v252, s[56:59], s32 offen offset:1024
s_waitcnt vmcnt(13)
s_add_u32 s33, s53, s47
buffer_load_dwordx4 v[240:243], v10, s[20:23], s33 offen offset:1024 sc1
s_waitcnt lgkmcnt(5)
v_mfma_f32_16x16x32_bf16 v[48:51], a[152:155], v[144:147], v[48:51]
v_lshlrev_b32 v116, 16, v212
v_and_b32 v117, s12, v212
v_mfma_f32_16x16x32_bf16 v[52:55], a[156:159], v[144:147], v[52:55]
v_lshlrev_b32 v118, 16, v213
v_and_b32 v119, s12, v213
v_mfma_f32_16x16x32_bf16 v[56:59], a[216:219], v[144:147], v[56:59]
v_lshlrev_b32 v120, 16, v214
v_and_b32 v121, s12, v214
v_mfma_f32_16x16x32_bf16 v[60:63], a[220:223], v[144:147], v[60:63]
v_lshlrev_b32 v122, 16, v215
v_and_b32 v123, s12, v215
s_waitcnt lgkmcnt(4)
v_mfma_f32_16x16x32_bf16 v[48:51], a[160:163], v[148:151], v[48:51]
v_fmac_f32 v108, v116, v18
v_fmac_f32 v109, v117, v18
v_mfma_f32_16x16x32_bf16 v[52:55], a[164:167], v[148:151], v[52:55]
v_fmac_f32 v110, v118, v18
v_fmac_f32 v111, v119, v18
v_mfma_f32_16x16x32_bf16 v[56:59], a[224:227], v[148:151], v[56:59]
v_fmac_f32 v112, v120, v18
v_fmac_f32 v113, v121, v18
v_mfma_f32_16x16x32_bf16 v[60:63], a[228:231], v[148:151], v[60:63]
v_fmac_f32 v114, v122, v18
v_fmac_f32 v115, v123, v18
s_waitcnt vmcnt(13)
s_add_u32 s35, s53, s15
buffer_load_dwordx4 v[244:247], v10, s[20:23], s35 offen offset:1024 sc1
s_waitcnt vmcnt(13)
s_add_u32 s39, s54, s44
buffer_load_dwordx4 v[156:159], v10, s[20:23], s39 offen offset:0 sc1
s_waitcnt lgkmcnt(3)
v_mfma_f32_16x16x32_bf16 v[48:51], a[168:171], v[152:155], v[48:51]
v_lshlrev_b32 v116, 16, v216
v_and_b32 v117, s12, v216
v_lshlrev_b32 v118, 16, v217
v_and_b32 v119, s12, v217
v_mfma_f32_16x16x32_bf16 v[52:55], a[172:175], v[152:155], v[52:55]
v_lshlrev_b32 v120, 16, v218
v_and_b32 v121, s12, v218
v_lshlrev_b32 v122, 16, v219
v_and_b32 v123, s12, v219
v_mfma_f32_16x16x32_bf16 v[56:59], a[232:235], v[152:155], v[56:59]
v_fmac_f32 v108, v116, v20
v_fmac_f32 v109, v117, v20
v_fmac_f32 v110, v118, v20
v_fmac_f32 v111, v119, v20
v_mfma_f32_16x16x32_bf16 v[60:63], a[236:239], v[152:155], v[60:63]
v_fmac_f32 v112, v120, v20
v_fmac_f32 v113, v121, v20
v_fmac_f32 v114, v122, v20
v_fmac_f32 v115, v123, v20
s_waitcnt vmcnt(13)
s_add_u32 s32, s54, s45
buffer_load_dwordx4 v[160:163], v10, s[20:23], s32 offen offset:0 sc1
s_waitcnt vmcnt(13)
s_add_u32 s33, s54, s46
buffer_load_dwordx4 v[164:167], v10, s[20:23], s33 offen offset:0 sc1
v_lshlrev_b32 v116, 16, v220
v_and_b32 v117, s12, v220
v_lshlrev_b32 v118, 16, v221
v_and_b32 v119, s12, v221
v_lshlrev_b32 v120, 16, v222
v_and_b32 v121, s12, v222
v_lshlrev_b32 v122, 16, v223
v_and_b32 v123, s12, v223
v_pk_fma_f32 v[108:109], v[116:117], v[22:23], v[108:109]
v_pk_fma_f32 v[110:111], v[118:119], v[22:23], v[110:111]
v_pk_fma_f32 v[112:113], v[120:121], v[22:23], v[112:113]
v_pk_fma_f32 v[114:115], v[122:123], v[22:23], v[114:115]
s_waitcnt lgkmcnt(1)
v_lshlrev_b32 v116, 16, v96
v_and_b32 v117, s12, v96
v_lshlrev_b32 v118, 16, v97
v_and_b32 v119, s12, v97
v_lshlrev_b32 v120, 16, v98
v_and_b32 v121, s12, v98
v_lshlrev_b32 v122, 16, v99
v_and_b32 v123, s12, v99
v_pk_fma_f32 v[108:109], v[116:117], v[26:27], v[108:109]
v_pk_fma_f32 v[110:111], v[118:119], v[26:27], v[110:111]
v_pk_fma_f32 v[112:113], v[120:121], v[26:27], v[112:113]
v_pk_fma_f32 v[114:115], v[122:123], v[26:27], v[114:115]
s_waitcnt vmcnt(13)
s_add_u32 s35, s54, s47
buffer_load_dwordx4 v[168:171], v10, s[20:23], s35 offen offset:0 sc1
s_waitcnt vmcnt(13)
s_add_u32 s39, s54, s15
buffer_load_dwordx4 v[172:175], v10, s[20:23], s39 offen offset:0 sc1
v_mfma_f32_16x16x32_bf16 v[48:51], a[176:179], v[132:135], v[48:51]
v_lshlrev_b32 v116, 16, v224
v_and_b32 v117, s12, v224
v_lshlrev_b32 v118, 16, v225
v_and_b32 v119, s12, v225
v_lshlrev_b32 v120, 16, v226
v_and_b32 v121, s12, v226
v_mfma_f32_16x16x32_bf16 v[52:55], a[180:183], v[132:135], v[52:55]
v_lshlrev_b32 v122, 16, v227
v_and_b32 v123, s12, v227
v_fmac_f32 v108, v116, v24
v_fmac_f32 v109, v117, v24
v_fmac_f32 v110, v118, v24
v_fmac_f32 v111, v119, v24
v_mfma_f32_16x16x32_bf16 v[56:59], a[240:243], v[132:135], v[56:59]
v_fmac_f32 v112, v120, v24
v_fmac_f32 v113, v121, v24
v_fmac_f32 v114, v122, v24
v_fmac_f32 v115, v123, v24
v_cvt_pk_bf16_f32 v116, v108, v109
v_cvt_pk_bf16_f32 v117, v110, v111
v_mfma_f32_16x16x32_bf16 v[60:63], a[244:247], v[132:135], v[60:63]
v_cvt_pk_bf16_f32 v118, v112, v113
v_cvt_pk_bf16_f32 v119, v114, v115
ds_write_b128 v38, v[116:119] offset:8192
s_waitcnt vmcnt(13)
s_add_u32 s32, s54, s44
buffer_load_dwordx4 v[176:179], v10, s[20:23], s32 offen offset:1024 sc1
s_waitcnt vmcnt(13)
s_add_u32 s33, s54, s45
buffer_load_dwordx4 v[180:183], v10, s[20:23], s33 offen offset:1024 sc1
ds_read_b128 v[96:99], v45 offset:1024
v_lshlrev_b32 v116, 16, v228
v_and_b32 v117, s12, v228
v_lshlrev_b32 v118, 16, v229
v_and_b32 v119, s12, v229
v_lshlrev_b32 v120, 16, v230
v_and_b32 v121, s12, v230
v_lshlrev_b32 v122, 16, v231
v_and_b32 v123, s12, v231
v_pk_mul_f32 v[108:109], v[116:117], v[16:17]
v_pk_mul_f32 v[110:111], v[118:119], v[16:17]
v_pk_mul_f32 v[112:113], v[120:121], v[16:17]
v_pk_mul_f32 v[114:115], v[122:123], v[16:17]
s_waitcnt vmcnt(13)
s_add_u32 s35, s54, s46
buffer_load_dwordx4 v[184:187], v10, s[20:23], s35 offen offset:1024 sc1
s_waitcnt vmcnt(13)
s_add_u32 s39, s54, s47
buffer_load_dwordx4 v[188:191], v10, s[20:23], s39 offen offset:1024 sc1
v_lshlrev_b32 v116, 16, v232
v_and_b32 v117, s12, v232
v_lshlrev_b32 v118, 16, v233
v_and_b32 v119, s12, v233
v_lshlrev_b32 v120, 16, v234
v_and_b32 v121, s12, v234
v_lshlrev_b32 v122, 16, v235
v_and_b32 v123, s12, v235
v_pk_fma_f32 v[108:109], v[116:117], v[18:19], v[108:109]
v_pk_fma_f32 v[110:111], v[118:119], v[18:19], v[110:111]
v_pk_fma_f32 v[112:113], v[120:121], v[18:19], v[112:113]
v_pk_fma_f32 v[114:115], v[122:123], v[18:19], v[114:115]
s_waitcnt vmcnt(13)
s_add_u32 s32, s54, s15
buffer_load_dwordx4 v[192:195], v10, s[20:23], s32 offen offset:1024 sc1
s_waitcnt vmcnt(13)
v_lshlrev_b32 v116, 16, v236
v_and_b32 v117, s12, v236
v_lshlrev_b32 v118, 16, v237
v_and_b32 v119, s12, v237
v_lshlrev_b32 v120, 16, v238
v_and_b32 v121, s12, v238
v_lshlrev_b32 v122, 16, v239
v_and_b32 v123, s12, v239
v_pk_fma_f32 v[108:109], v[116:117], v[20:21], v[108:109]
v_pk_fma_f32 v[110:111], v[118:119], v[20:21], v[110:111]
v_pk_fma_f32 v[112:113], v[120:121], v[20:21], v[112:113]
v_pk_fma_f32 v[114:115], v[122:123], v[20:21], v[114:115]
s_waitcnt vmcnt(12)
s_waitcnt vmcnt(11)
s_waitcnt lgkmcnt(2)
v_mfma_f32_16x16x32_bf16 v[48:51], a[184:187], v[136:139], v[48:51]
v_lshlrev_b32 v116, 16, v240
v_and_b32 v117, s12, v240
v_lshlrev_b32 v118, 16, v241
v_and_b32 v119, s12, v241
v_lshlrev_b32 v120, 16, v242
v_and_b32 v121, s12, v242
v_lshlrev_b32 v122, 16, v243
v_and_b32 v123, s12, v243
v_mfma_f32_16x16x32_bf16 v[52:55], a[188:191], v[136:139], v[52:55]
v_fmac_f32 v108, v116, v22
v_fmac_f32 v109, v117, v22
v_fmac_f32 v110, v118, v22
v_fmac_f32 v111, v119, v22
v_fmac_f32 v112, v120, v22
v_fmac_f32 v113, v121, v22
v_fmac_f32 v114, v122, v22
v_fmac_f32 v115, v123, v22
v_mfma_f32_16x16x32_bf16 v[56:59], a[248:251], v[136:139], v[56:59]
s_waitcnt lgkmcnt(0)
v_lshlrev_b32 v116, 16, v96
v_and_b32 v117, s12, v96
v_lshlrev_b32 v118, 16, v97
v_and_b32 v119, s12, v97
v_lshlrev_b32 v120, 16, v98
v_and_b32 v121, s12, v98
v_lshlrev_b32 v122, 16, v99
v_and_b32 v123, s12, v99
v_mfma_f32_16x16x32_bf16 v[60:63], a[252:255], v[136:139], v[60:63]
v_fmac_f32 v108, v116, v26
v_fmac_f32 v109, v117, v26
v_fmac_f32 v110, v118, v26
v_fmac_f32 v111, v119, v26
v_fmac_f32 v112, v120, v26
v_fmac_f32 v113, v121, v26
v_fmac_f32 v114, v122, v26
v_fmac_f32 v115, v123, v26
s_waitcnt vmcnt(10)
v_lshlrev_b32 v116, 16, v244
v_and_b32 v117, s12, v244
v_lshlrev_b32 v118, 16, v245
v_and_b32 v119, s12, v245
v_lshlrev_b32 v120, 16, v246
v_and_b32 v121, s12, v246
v_lshlrev_b32 v122, 16, v247
v_and_b32 v123, s12, v247
v_pk_fma_f32 v[108:109], v[116:117], v[24:25], v[108:109]
v_pk_fma_f32 v[110:111], v[118:119], v[24:25], v[110:111]
v_pk_fma_f32 v[112:113], v[120:121], v[24:25], v[112:113]
v_pk_fma_f32 v[114:115], v[122:123], v[24:25], v[114:115]
ds_read2_b32 v[16:17], v14 offset0:1 offset1:1
ds_read2_b32 v[18:19], v14 offset0:2 offset1:2
ds_read2_b32 v[20:21], v14 offset0:3 offset1:3
ds_read2_b32 v[22:23], v14 offset0:4 offset1:4
ds_read2_b32 v[24:25], v14 offset0:5 offset1:5
ds_read2_b32 v[26:27], v14 offset0:6 offset1:6
v_cvt_pk_bf16_f32 v116, v108, v109
v_cvt_pk_bf16_f32 v117, v110, v111
v_cvt_pk_bf16_f32 v118, v112, v113
v_cvt_pk_bf16_f32 v119, v114, v115
ds_write_b128 v39, v[116:119] offset:8192
s_waitcnt lgkmcnt(0)
s_barrier
ds_read_b128 v[140:143], v15 offset:8192
ds_read_b128 v[144:147], v15 offset:9216
ds_read_b128 v[148:151], v15 offset:10240
ds_read_b128 v[152:155], v15 offset:11264
ds_read_b128 v[132:135], v15 offset:12288
v_cvt_pk_bf16_f32 v48, v48, v49
v_cvt_pk_bf16_f32 v49, v50, v51
v_cvt_pk_bf16_f32 v50, v52, v53
v_cvt_pk_bf16_f32 v51, v54, v55
ds_write_b128 v32, v[48:51] offset:0
v_cvt_pk_bf16_f32 v56, v56, v57
v_cvt_pk_bf16_f32 v57, v58, v59
v_cvt_pk_bf16_f32 v58, v60, v61
v_cvt_pk_bf16_f32 v59, v62, v63
ds_write_b128 v33, v[56:59] offset:0
ds_read_b128 v[52:55], v34 offset:0
ds_read_b128 v[60:63], v34 offset:1024
s_waitcnt lgkmcnt(8)
v_mfma_f32_16x16x32_bf16 v[64:67], a[128:131], v[140:143], v[64:67]
ds_read_b128 v[136:139], v15 offset:13312
v_mfma_f32_16x16x32_bf16 v[68:71], a[132:135], v[140:143], v[68:71]
v_mfma_f32_16x16x32_bf16 v[72:75], a[192:195], v[140:143], v[72:75]
v_mfma_f32_16x16x32_bf16 v[76:79], a[196:199], v[140:143], v[76:79]
s_waitcnt vmcnt(9)
s_add_u32 s33, s52, 0
s_waitcnt lgkmcnt(2)
buffer_store_dwordx4 v[52:55], v9, s[40:43], s33 offen sc1
s_add_u32 s35, s52, 4096
s_waitcnt lgkmcnt(1)
buffer_store_dwordx4 v[60:63], v9, s[40:43], s35 offen sc1
v_mfma_f32_16x16x32_bf16 v[64:67], a[136:139], v[144:147], v[64:67]
ds_read_b128 v[140:143], v15 offset:14336
ds_read_b128 v[96:99], v46 offset:0
v_lshlrev_b32 v116, 16, v156
v_and_b32 v117, s12, v156
v_mfma_f32_16x16x32_bf16 v[68:71], a[140:143], v[144:147], v[68:71]
v_lshlrev_b32 v118, 16, v157
v_and_b32 v119, s12, v157
v_lshlrev_b32 v120, 16, v158
v_mfma_f32_16x16x32_bf16 v[72:75], a[200:203], v[144:147], v[72:75]
v_and_b32 v121, s12, v158
v_lshlrev_b32 v122, 16, v159
v_and_b32 v123, s12, v159
v_mfma_f32_16x16x32_bf16 v[76:79], a[204:207], v[144:147], v[76:79]
v_mul_f32 v108, v116, v16
v_mul_f32 v109, v117, v16
v_mul_f32 v110, v118, v16
v_mfma_f32_16x16x32_bf16 v[64:67], a[144:147], v[148:151], v[64:67]
ds_read_b128 v[144:147], v15 offset:15360
v_mul_f32 v111, v119, v16
v_mul_f32 v112, v120, v16
v_mul_f32 v113, v121, v16
v_mfma_f32_16x16x32_bf16 v[68:71], a[148:151], v[148:151], v[68:71]
v_mul_f32 v114, v122, v16
v_mul_f32 v115, v123, v16
v_mfma_f32_16x16x32_bf16 v[72:75], a[208:211], v[148:151], v[72:75]
v_mfma_f32_16x16x32_bf16 v[76:79], a[212:215], v[148:151], v[76:79]
s_waitcnt vmcnt(10)
v_mfma_f32_16x16x32_bf16 v[64:67], a[152:155], v[152:155], v[64:67]
v_lshlrev_b32 v116, 16, v160
v_and_b32 v117, s12, v160
v_mfma_f32_16x16x32_bf16 v[68:71], a[156:159], v[152:155], v[68:71]
v_lshlrev_b32 v118, 16, v161
v_and_b32 v119, s12, v161
v_mfma_f32_16x16x32_bf16 v[72:75], a[216:219], v[152:155], v[72:75]
v_lshlrev_b32 v120, 16, v162
v_and_b32 v121, s12, v162
v_mfma_f32_16x16x32_bf16 v[76:79], a[220:223], v[152:155], v[76:79]
v_lshlrev_b32 v122, 16, v163
v_and_b32 v123, s12, v163
v_mfma_f32_16x16x32_bf16 v[64:67], a[160:163], v[132:135], v[64:67]
v_fmac_f32 v108, v116, v18
v_fmac_f32 v109, v117, v18
v_mfma_f32_16x16x32_bf16 v[68:71], a[164:167], v[132:135], v[68:71]
v_fmac_f32 v110, v118, v18
v_fmac_f32 v111, v119, v18
v_mfma_f32_16x16x32_bf16 v[72:75], a[224:227], v[132:135], v[72:75]
v_fmac_f32 v112, v120, v18
v_fmac_f32 v113, v121, v18
v_mfma_f32_16x16x32_bf16 v[76:79], a[228:231], v[132:135], v[76:79]
v_fmac_f32 v114, v122, v18
v_fmac_f32 v115, v123, v18
s_waitcnt vmcnt(9)
s_waitcnt lgkmcnt(3)
v_mfma_f32_16x16x32_bf16 v[64:67], a[168:171], v[136:139], v[64:67]
v_lshlrev_b32 v116, 16, v164
v_and_b32 v117, s12, v164
v_mfma_f32_16x16x32_bf16 v[68:71], a[172:175], v[136:139], v[68:71]
v_lshlrev_b32 v118, 16, v165
v_and_b32 v119, s12, v165
v_mfma_f32_16x16x32_bf16 v[72:75], a[232:235], v[136:139], v[72:75]
v_lshlrev_b32 v120, 16, v166
v_and_b32 v121, s12, v166
v_mfma_f32_16x16x32_bf16 v[76:79], a[236:239], v[136:139], v[76:79]
v_lshlrev_b32 v122, 16, v167
v_and_b32 v123, s12, v167
s_waitcnt lgkmcnt(2)
v_mfma_f32_16x16x32_bf16 v[64:67], a[176:179], v[140:143], v[64:67]
v_fmac_f32 v108, v116, v20
v_fmac_f32 v109, v117, v20
v_mfma_f32_16x16x32_bf16 v[68:71], a[180:183], v[140:143], v[68:71]
v_fmac_f32 v110, v118, v20
v_fmac_f32 v111, v119, v20
v_mfma_f32_16x16x32_bf16 v[72:75], a[240:243], v[140:143], v[72:75]
v_fmac_f32 v112, v120, v20
v_fmac_f32 v113, v121, v20
v_mfma_f32_16x16x32_bf16 v[76:79], a[244:247], v[140:143], v[76:79]
v_fmac_f32 v114, v122, v20
v_fmac_f32 v115, v123, v20
s_waitcnt vmcnt(8)
s_waitcnt lgkmcnt(0)
v_mfma_f32_16x16x32_bf16 v[64:67], a[184:187], v[144:147], v[64:67]
v_lshlrev_b32 v116, 16, v168
v_and_b32 v117, s12, v168
v_lshlrev_b32 v118, 16, v169
v_and_b32 v119, s12, v169
v_lshlrev_b32 v120, 16, v170
v_and_b32 v121, s12, v170
v_lshlrev_b32 v122, 16, v171
v_and_b32 v123, s12, v171
v_mfma_f32_16x16x32_bf16 v[68:71], a[188:191], v[144:147], v[68:71]
v_fmac_f32 v108, v116, v22
v_fmac_f32 v109, v117, v22
v_fmac_f32 v110, v118, v22
v_fmac_f32 v111, v119, v22
v_fmac_f32 v112, v120, v22
v_fmac_f32 v113, v121, v22
v_fmac_f32 v114, v122, v22
v_fmac_f32 v115, v123, v22
v_mfma_f32_16x16x32_bf16 v[72:75], a[248:251], v[144:147], v[72:75]
v_lshlrev_b32 v116, 16, v96
v_and_b32 v117, s12, v96
v_lshlrev_b32 v118, 16, v97
v_and_b32 v119, s12, v97
v_lshlrev_b32 v120, 16, v98
v_and_b32 v121, s12, v98
v_lshlrev_b32 v122, 16, v99
v_and_b32 v123, s12, v99
v_mfma_f32_16x16x32_bf16 v[76:79], a[252:255], v[144:147], v[76:79]
v_fmac_f32 v108, v116, v26
v_fmac_f32 v109, v117, v26
v_fmac_f32 v110, v118, v26
v_fmac_f32 v111, v119, v26
v_fmac_f32 v112, v120, v26
v_fmac_f32 v113, v121, v26
v_fmac_f32 v114, v122, v26
v_fmac_f32 v115, v123, v26
s_waitcnt vmcnt(7)
v_cvt_pk_bf16_f32 v64, v64, v65
v_cvt_pk_bf16_f32 v65, v66, v67
v_cvt_pk_bf16_f32 v66, v68, v69
v_cvt_pk_bf16_f32 v67, v70, v71
ds_write_b128 v32, v[64:67] offset:2048
v_cvt_pk_bf16_f32 v72, v72, v73
v_cvt_pk_bf16_f32 v73, v74, v75
v_cvt_pk_bf16_f32 v74, v76, v77
v_cvt_pk_bf16_f32 v75, v78, v79
ds_write_b128 v33, v[72:75] offset:2048
ds_read_b128 v[68:71], v34 offset:2048
ds_read_b128 v[76:79], v34 offset:3072
v_lshlrev_b32 v116, 16, v172
v_and_b32 v117, s12, v172
v_lshlrev_b32 v118, 16, v173
v_and_b32 v119, s12, v173
v_lshlrev_b32 v120, 16, v174
v_and_b32 v121, s12, v174
v_lshlrev_b32 v122, 16, v175
v_and_b32 v123, s12, v175
v_pk_fma_f32 v[108:109], v[116:117], v[24:25], v[108:109]
v_pk_fma_f32 v[110:111], v[118:119], v[24:25], v[110:111]
v_pk_fma_f32 v[112:113], v[120:121], v[24:25], v[112:113]
v_pk_fma_f32 v[114:115], v[122:123], v[24:25], v[114:115]
v_cvt_pk_bf16_f32 v116, v108, v109
v_cvt_pk_bf16_f32 v117, v110, v111
v_cvt_pk_bf16_f32 v118, v112, v113
v_cvt_pk_bf16_f32 v119, v114, v115
ds_write_b128 v38, v[116:119] offset:16384
s_waitcnt vmcnt(6)
s_add_u32 s39, s53, 0
s_waitcnt lgkmcnt(2)
buffer_store_dwordx4 v[68:71], v9, s[40:43], s39 offen sc1
s_add_u32 s32, s53, 4096
s_waitcnt lgkmcnt(1)
buffer_store_dwordx4 v[76:79], v9, s[40:43], s32 offen sc1
ds_read_b128 v[96:99], v46 offset:1024
v_lshlrev_b32 v116, 16, v176
v_and_b32 v117, s12, v176
v_lshlrev_b32 v118, 16, v177
v_and_b32 v119, s12, v177
v_lshlrev_b32 v120, 16, v178
v_and_b32 v121, s12, v178
v_lshlrev_b32 v122, 16, v179
v_and_b32 v123, s12, v179
v_pk_mul_f32 v[108:109], v[116:117], v[16:17]
v_pk_mul_f32 v[110:111], v[118:119], v[16:17]
v_pk_mul_f32 v[112:113], v[120:121], v[16:17]
v_pk_mul_f32 v[114:115], v[122:123], v[16:17]
s_waitcnt vmcnt(7)
v_lshlrev_b32 v116, 16, v180
v_and_b32 v117, s12, v180
v_lshlrev_b32 v118, 16, v181
v_and_b32 v119, s12, v181
v_lshlrev_b32 v120, 16, v182
v_and_b32 v121, s12, v182
v_lshlrev_b32 v122, 16, v183
v_and_b32 v123, s12, v183
v_pk_fma_f32 v[108:109], v[116:117], v[18:19], v[108:109]
v_pk_fma_f32 v[110:111], v[118:119], v[18:19], v[110:111]
v_pk_fma_f32 v[112:113], v[120:121], v[18:19], v[112:113]
v_pk_fma_f32 v[114:115], v[122:123], v[18:19], v[114:115]
s_waitcnt vmcnt(6)
v_lshlrev_b32 v116, 16, v184
v_and_b32 v117, s12, v184
v_lshlrev_b32 v118, 16, v185
v_and_b32 v119, s12, v185
v_lshlrev_b32 v120, 16, v186
v_and_b32 v121, s12, v186
v_lshlrev_b32 v122, 16, v187
v_and_b32 v123, s12, v187
v_pk_fma_f32 v[108:109], v[116:117], v[20:21], v[108:109]
v_pk_fma_f32 v[110:111], v[118:119], v[20:21], v[110:111]
v_pk_fma_f32 v[112:113], v[120:121], v[20:21], v[112:113]
v_pk_fma_f32 v[114:115], v[122:123], v[20:21], v[114:115]
s_waitcnt vmcnt(5)
v_lshlrev_b32 v116, 16, v188
v_and_b32 v117, s12, v188
v_lshlrev_b32 v118, 16, v189
v_and_b32 v119, s12, v189
v_lshlrev_b32 v120, 16, v190
v_and_b32 v121, s12, v190
v_lshlrev_b32 v122, 16, v191
v_and_b32 v123, s12, v191
v_pk_fma_f32 v[108:109], v[116:117], v[22:23], v[108:109]
v_pk_fma_f32 v[110:111], v[118:119], v[22:23], v[110:111]
v_pk_fma_f32 v[112:113], v[120:121], v[22:23], v[112:113]
v_pk_fma_f32 v[114:115], v[122:123], v[22:23], v[114:115]
s_waitcnt lgkmcnt(0)
v_lshlrev_b32 v116, 16, v96
v_and_b32 v117, s12, v96
v_lshlrev_b32 v118, 16, v97
v_and_b32 v119, s12, v97
v_lshlrev_b32 v120, 16, v98
v_and_b32 v121, s12, v98
v_lshlrev_b32 v122, 16, v99
v_and_b32 v123, s12, v99
v_pk_fma_f32 v[108:109], v[116:117], v[26:27], v[108:109]
v_pk_fma_f32 v[110:111], v[118:119], v[26:27], v[110:111]
v_pk_fma_f32 v[112:113], v[120:121], v[26:27], v[112:113]
v_pk_fma_f32 v[114:115], v[122:123], v[26:27], v[114:115]
s_waitcnt vmcnt(4)
v_lshlrev_b32 v116, 16, v192
v_and_b32 v117, s12, v192
v_lshlrev_b32 v118, 16, v193
v_and_b32 v119, s12, v193
v_lshlrev_b32 v120, 16, v194
v_and_b32 v121, s12, v194
v_lshlrev_b32 v122, 16, v195
v_and_b32 v123, s12, v195
v_pk_fma_f32 v[108:109], v[116:117], v[24:25], v[108:109]
v_pk_fma_f32 v[110:111], v[118:119], v[24:25], v[110:111]
v_pk_fma_f32 v[112:113], v[120:121], v[24:25], v[112:113]
v_pk_fma_f32 v[114:115], v[122:123], v[24:25], v[114:115]
v_cvt_pk_bf16_f32 v116, v108, v109
v_cvt_pk_bf16_f32 v117, v110, v111
v_cvt_pk_bf16_f32 v118, v112, v113
v_cvt_pk_bf16_f32 v119, v114, v115
ds_write_b128 v39, v[116:119] offset:16384
s_waitcnt lgkmcnt(0)
s_barrier
ds_read_b128 v[148:151], v15 offset:16384
ds_read_b128 v[152:155], v15 offset:17408
ds_read_b128 v[132:135], v15 offset:18432
ds_read_b128 v[136:139], v15 offset:19456
ds_read_b128 v[140:143], v15 offset:20480
s_waitcnt lgkmcnt(4)
v_mfma_f32_16x16x32_bf16 v[80:83], a[128:131], v[148:151], v[80:83]
ds_read_b128 v[144:147], v15 offset:21504
v_mfma_f32_16x16x32_bf16 v[84:87], a[132:135], v[148:151], v[84:87]
v_mfma_f32_16x16x32_bf16 v[88:91], a[192:195], v[148:151], v[88:91]
v_mfma_f32_16x16x32_bf16 v[92:95], a[196:199], v[148:151], v[92:95]
s_waitcnt lgkmcnt(4)
v_mfma_f32_16x16x32_bf16 v[80:83], a[136:139], v[152:155], v[80:83]
ds_read_b128 v[148:151], v15 offset:22528
v_mfma_f32_16x16x32_bf16 v[84:87], a[140:143], v[152:155], v[84:87]
v_mfma_f32_16x16x32_bf16 v[88:91], a[200:203], v[152:155], v[88:91]
v_mfma_f32_16x16x32_bf16 v[92:95], a[204:207], v[152:155], v[92:95]
s_waitcnt lgkmcnt(4)
v_mfma_f32_16x16x32_bf16 v[80:83], a[144:147], v[132:135], v[80:83]
ds_read_b128 v[152:155], v15 offset:23552
v_mfma_f32_16x16x32_bf16 v[84:87], a[148:151], v[132:135], v[84:87]
v_mfma_f32_16x16x32_bf16 v[88:91], a[208:211], v[132:135], v[88:91]
v_mfma_f32_16x16x32_bf16 v[92:95], a[212:215], v[132:135], v[92:95]
s_waitcnt lgkmcnt(4)
v_mfma_f32_16x16x32_bf16 v[80:83], a[152:155], v[136:139], v[80:83]
v_mfma_f32_16x16x32_bf16 v[84:87], a[156:159], v[136:139], v[84:87]
v_mfma_f32_16x16x32_bf16 v[88:91], a[216:219], v[136:139], v[88:91]
v_mfma_f32_16x16x32_bf16 v[92:95], a[220:223], v[136:139], v[92:95]
s_waitcnt lgkmcnt(3)
v_mfma_f32_16x16x32_bf16 v[80:83], a[160:163], v[140:143], v[80:83]
v_mfma_f32_16x16x32_bf16 v[84:87], a[164:167], v[140:143], v[84:87]
v_mfma_f32_16x16x32_bf16 v[88:91], a[224:227], v[140:143], v[88:91]
v_mfma_f32_16x16x32_bf16 v[92:95], a[228:231], v[140:143], v[92:95]
s_waitcnt lgkmcnt(2)
v_mfma_f32_16x16x32_bf16 v[80:83], a[168:171], v[144:147], v[80:83]
v_mfma_f32_16x16x32_bf16 v[84:87], a[172:175], v[144:147], v[84:87]
v_mfma_f32_16x16x32_bf16 v[88:91], a[232:235], v[144:147], v[88:91]
v_mfma_f32_16x16x32_bf16 v[92:95], a[236:239], v[144:147], v[92:95]
s_waitcnt lgkmcnt(1)
v_mfma_f32_16x16x32_bf16 v[80:83], a[176:179], v[148:151], v[80:83]
v_mfma_f32_16x16x32_bf16 v[84:87], a[180:183], v[148:151], v[84:87]
v_mfma_f32_16x16x32_bf16 v[88:91], a[240:243], v[148:151], v[88:91]
v_mfma_f32_16x16x32_bf16 v[92:95], a[244:247], v[148:151], v[92:95]
s_waitcnt lgkmcnt(0)
v_mfma_f32_16x16x32_bf16 v[80:83], a[184:187], v[152:155], v[80:83]
v_mfma_f32_16x16x32_bf16 v[84:87], a[188:191], v[152:155], v[84:87]
v_mfma_f32_16x16x32_bf16 v[88:91], a[248:251], v[152:155], v[88:91]
v_mfma_f32_16x16x32_bf16 v[92:95], a[252:255], v[152:155], v[92:95]
s_nop 4
v_cvt_pk_bf16_f32 v80, v80, v81
v_cvt_pk_bf16_f32 v81, v82, v83
v_cvt_pk_bf16_f32 v82, v84, v85
v_cvt_pk_bf16_f32 v83, v86, v87
ds_write_b128 v35, v[80:83] offset:0
v_cvt_pk_bf16_f32 v88, v88, v89
v_cvt_pk_bf16_f32 v89, v90, v91
v_cvt_pk_bf16_f32 v90, v92, v93
v_cvt_pk_bf16_f32 v91, v94, v95
ds_write_b128 v36, v[88:91] offset:0
ds_read_b128 v[84:87], v37 offset:0
ds_read_b128 v[92:95], v37 offset:1024
s_add_u32 s33, s54, 0
s_waitcnt lgkmcnt(1)
buffer_store_dwordx4 v[84:87], v9, s[40:43], s33 offen sc1
s_add_u32 s35, s54, 4096
s_waitcnt lgkmcnt(0)
buffer_store_dwordx4 v[92:95], v9, s[40:43], s35 offen sc1
s_branch L2_fin
LC_poll:
s_mov_b32 s36, 0
s_cmp_lt_u32 s98, 2
s_cselect_b32 s33, 0xfff, -1
s_cselect_b32 s35, 6, 0x6
LC_poll2:
s_mov_b32 s70, 0
s_atomic_add s70, s[60:61], s48 glc
s_cmp_lt_u32 s2, 240
s_cbranch_scc1 LC_poll3
s_mov_b32 s71, 0
s_atomic_add s71, s[60:61], s49 glc
s_mov_b32 s72, 0
s_atomic_add s72, s[60:61], s50 glc
s_waitcnt lgkmcnt(0)
s_min_u32 s70, s70, s71
s_min_u32 s70, s70, s72
LC_poll3:
s_waitcnt lgkmcnt(0)
s_and_b32 s70, s70, s33
s_cmp_ge_u32 s70, s35
s_cbranch_scc1 LC_poll4
s_sleep 2
s_add_u32 s36, s36, 1
s_cmp_gt_u32 s36, 0x40000
s_cbranch_scc0 LC_poll2
LC_poll4:
s_cmp_lt_u32 s98, 2
s_cbranch_scc1 LC_got
s_mul_i32 s33, s51, 0x600000
v_readfirstlane_b32 s32, v44
s_add_u32 s35, s33, s52
s_mov_b32 m0, s32
s_nop 0
buffer_load_dwordx4 v10, s[20:23], s35 offen offset:0 sc1 lds
buffer_load_dwordx4 v10, s[20:23], s35 offen offset:1024 sc1 lds
v_readfirstlane_b32 s32, v45
s_add_u32 s35, s33, s53
s_mov_b32 m0, s32
s_nop 0
buffer_load_dwordx4 v10, s[20:23], s35 offen offset:0 sc1 lds
buffer_load_dwordx4 v10, s[20:23], s35 offen offset:1024 sc1 lds
v_readfirstlane_b32 s32, v46
s_add_u32 s35, s33, s54
s_mov_b32 m0, s32
s_nop 0
buffer_load_dwordx4 v10, s[20:23], s35 offen offset:0 sc1 lds
buffer_load_dwordx4 v10, s[20:23], s35 offen offset:1024 sc1 lds
s_waitcnt vmcnt(0)
s_branch LC_got
LC_side:
s_cmp_eq_u32 s14, 1
s_cbranch_scc1 LC_sideok
s_cmp_lt_u32 s2, 240
s_cbranch_scc1 LC_side1
s_barrier
LC_side1:
s_mov_b32 s36, 0
s_mov_b32 s33, 0x6c01400
LC_side2:
buffer_load_dword v1, off, s[56:59], s33 sc1
s_waitcnt vmcnt(0)
v_readfirstlane_b32 s99, v1
s_add_u32 s36, s36, 1
s_cmp_gt_u32 s36, 0x40000
s_cbranch_scc1 LC_side3
s_cmp_ge_u32 s99, 60
s_cbranch_scc1 LC_side3
s_sleep 8
s_branch LC_side2
LC_side3:
s_cmp_lt_u32 s98, 2
s_cbranch_scc1 LC_sideok
s_add_u32 s8, s6, 0x0
s_addc_u32 s9, s7, 0
s_mov_b32 s10, 0x4e2000
s_mov_b32 s11, 0x00020000
s_lshl_b32 s55, s34, 13
s_add_u32 s55, s55, 0x21000
s_lshl_b32 s33, s34, 7
v_bfe_u32 v9, v252, 4, 3
v_lshrrev_b32 v1, 7, v252
v_xor_b32 v9, v9, v1
v_lshl_add_u32 v1, v1, 9, s33
v_lshl_add_u32 v9, v9, 4, v1
s_add_u32 m0, s55, 0
s_add_u32 s39, s52, 0
buffer_load_dwordx4 v9, s[8:11], s39 offen lds
s_add_u32 m0, s55, 1024
s_add_u32 s32, s52, 4096
buffer_load_dwordx4 v9, s[8:11], s32 offen lds
s_add_u32 m0, s55, 2048
s_add_u32 s33, s53, 0
buffer_load_dwordx4 v9, s[8:11], s33 offen lds
s_add_u32 m0, s55, 3072
s_add_u32 s35, s53, 4096
buffer_load_dwordx4 v9, s[8:11], s35 offen lds
s_waitcnt vmcnt(0)
s_branch LC_sideok
LC_slow:
s_waitcnt vmcnt(0) lgkmcnt(0)
s_barrier
s_mov_b32 s50, 0xe1a06800
s_mov_b32 s51, 0x4e608d04
s_mul_i32 s39, s37, 9
s_lshr_b64 s[50:51], s[50:51], s39
s_and_b32 s39, s50, 0x1ff
s_bfe_u32 s49, s50, 0x90009
s_sub_u32 s29, s49, s39
s_lshl_b32 s50, s37, 2
s_lshr_b32 s59, 0x766666, s50
s_and_b32 s59, s59, 15
s_sub_u32 s31, s29, s59
s_lshr_b32 s31, s31, 1
s_sub_u32 s31, s31, 1
s_lshl_b32 s39, s39, 14
s_lshl_b32 s49, s49, 14
s_add_u32 s28, s39, 0x4000
s_cmp_eq_u32 s37, 5
s_cselect_b32 s33, 0xff800000, 0
s_mov_b32 s32, 0xffff
s_add_u32 s12, s4, 0x6800000
s_addc_u32 s13, s5, 0
s_mov_b32 s14, s49
s_mov_b32 s15, 0x00020000
s_add_u32 s8, s4, 0x0
s_addc_u32 s9, s5, 0
s_mov_b32 s10, 0x4e4000
s_mov_b32 s11, 0x00020000
s_mul_i32 s35, s37, 0x600000
s_add_u32 s20, s4, 0x2000000
s_addc_u32 s21, s5, 0
s_add_u32 s20, s20, s35
s_addc_u32 s21, s21, 0
s_mov_b32 s22, 0x4e4000
s_mov_b32 s23, 0x00020000
s_add_u32 s24, s4, 0x6000000
s_addc_u32 s25, s5, 0
s_mov_b32 s26, 0x9c800
s_mov_b32 s27, 0x00020000
s_lshl_b32 s35, s38, 4
s_lshl_b32 s41, s34, 2
s_add_u32 s35, s35, s41
s_lshl_b32 s40, s35, 13
s_lshl_b32 s48, s35, 10
s_lshl_b32 s35, s37, 3
s_add_u32 s48, s48, s35
v_bfe_u32 v248, v252, 4, 3
v_lshlrev_b32 v248, 6, v248
v_bfe_u32 v253, v252, 7, 1
v_lshl_or_b32 v248, v253, 10, v248
v_bfe_u32 v253, v252, 8, 2
v_lshl_or_b32 v248, v253, 4, v248
v_bfe_u32 v253, v252, 6, 1
v_lshlrev_b32 v253, 5, v253
v_xor_b32 v248, v248, v253
v_and_b32 v249, 0x1c0, v252
v_bfe_u32 v253, v252, 9, 1
v_lshl_or_b32 v249, v253, 10, v249
v_bfe_u32 v253, v252, 8, 1
v_lshl_or_b32 v249, v253, 5, v249
v_bfe_u32 v253, v252, 4, 2
v_lshl_or_b32 v249, v253, 3, v249
v_xor_b32 v250, 32, v249
v_and_b32 v251, 0xfffffe7f, v251
s_mul_i32 s36, s34, 0xa000
s_mov_b32 s56, s36
s_add_u32 s57, s56, 32768
s_mov_b32 s55, 4
v_bfe_i32 v188, v252, 8, 1
LS_q:
s_add_u32 s44, s40, 4096
buffer_load_dwordx4 v[0:3], v252, s[8:11], s40 offen offset:0
buffer_load_dwordx4 v[4:7], v252, s[8:11], s40 offen offset:1024
buffer_load_dwordx4 v[8:11], v252, s[8:11], s40 offen offset:2048
buffer_load_dwordx4 v[12:15], v252, s[8:11], s40 offen offset:3072
buffer_load_dwordx4 v[16:19], v252, s[8:11], s44 offen offset:0
buffer_load_dwordx4 v[20:23], v252, s[8:11], s44 offen offset:1024
buffer_load_dwordx4 v[24:27], v252, s[8:11], s44 offen offset:2048
buffer_load_dwordx4 v[28:31], v252, s[8:11], s44 offen offset:3072
s_mov_b32 s53, s56
s_mov_b32 s58, s39
s_add_u32 m0, s53, 0
s_add_u32 s54, s58, 0
buffer_load_dwordx4 v251, s[12:15], s54 offen offset:0 lds
buffer_load_dwordx4 v251, s[12:15], s54 offen offset:1024 lds
buffer_load_dwordx4 v251, s[12:15], s54 offen offset:2048 lds
buffer_load_dwordx4 v251, s[12:15], s54 offen offset:3072 lds
s_add_u32 m0, s53, 4096
s_add_u32 s54, s58, 128
buffer_load_dwordx4 v251, s[12:15], s54 offen offset:0 lds
buffer_load_dwordx4 v251, s[12:15], s54 offen offset:1024 lds
buffer_load_dwordx4 v251, s[12:15], s54 offen offset:2048 lds
buffer_load_dwordx4 v251, s[12:15], s54 offen offset:3072 lds
s_add_u32 m0, s53, 8192
s_add_u32 s54, s58, 256
buffer_load_dwordx4 v251, s[12:15], s54 offen offset:0 lds
buffer_load_dwordx4 v251, s[12:15], s54 offen offset:1024 lds
buffer_load_dwordx4 v251, s[12:15], s54 offen offset:2048 lds
buffer_load_dwordx4 v251, s[12:15], s54 offen offset:3072 lds
s_add_u32 m0, s53, 12288
s_add_u32 s54, s58, 384
buffer_load_dwordx4 v251, s[12:15], s54 offen offset:0 lds
buffer_load_dwordx4 v251, s[12:15], s54 offen offset:1024 lds
buffer_load_dwordx4 v251, s[12:15], s54 offen offset:2048 lds
buffer_load_dwordx4 v251, s[12:15], s54 offen offset:3072 lds
s_add_u32 s53, s53, 0x4000
s_cmp_eq_u32 s53, s57
s_cselect_b32 s53, s56, s53
s_add_u32 s58, s58, 0x4000
s_mov_b32 s51, s29
s_mov_b32 s52, s56
v_mov_b32 v172, 0xff800000
v_accvgpr_write_b32 a0, 0
v_accvgpr_write_b32 a1, 0
v_accvgpr_write_b32 a2, 0
v_accvgpr_write_b32 a3, 0
v_accvgpr_write_b32 a4, 0
v_accvgpr_write_b32 a5, 0
v_accvgpr_write_b32 a6, 0
v_accvgpr_write_b32 a7, 0
v_accvgpr_write_b32 a8, 0
v_accvgpr_write_b32 a9, 0
v_accvgpr_write_b32 a10, 0
v_accvgpr_write_b32 a11, 0
v_accvgpr_write_b32 a12, 0
v_accvgpr_write_b32 a13, 0
v_accvgpr_write_b32 a14, 0
v_accvgpr_write_b32 a15, 0
v_accvgpr_write_b32 a16, 0
v_accvgpr_write_b32 a17, 0
v_accvgpr_write_b32 a18, 0
v_accvgpr_write_b32 a19, 0
v_accvgpr_write_b32 a20, 0
v_accvgpr_write_b32 a21, 0
v_accvgpr_write_b32 a22, 0
v_accvgpr_write_b32 a23, 0
v_accvgpr_write_b32 a24, 0
v_accvgpr_write_b32 a25, 0
v_accvgpr_write_b32 a26, 0
v_accvgpr_write_b32 a27, 0
v_accvgpr_write_b32 a28, 0
v_accvgpr_write_b32 a29, 0
v_accvgpr_write_b32 a30, 0
v_accvgpr_write_b32 a31, 0
v_accvgpr_write_b32 a32, 0
v_accvgpr_write_b32 a33, 0
v_accvgpr_write_b32 a34, 0
v_accvgpr_write_b32 a35, 0
v_accvgpr_write_b32 a36, 0
v_accvgpr_write_b32 a37, 0
v_accvgpr_write_b32 a38, 0
v_accvgpr_write_b32 a39, 0
v_accvgpr_write_b32 a40, 0
v_accvgpr_write_b32 a41, 0
v_accvgpr_write_b32 a42, 0
v_accvgpr_write_b32 a43, 0
v_accvgpr_write_b32 a44, 0
v_accvgpr_write_b32 a45, 0
v_accvgpr_write_b32 a46, 0
v_accvgpr_write_b32 a47, 0
v_accvgpr_write_b32 a48, 0
v_accvgpr_write_b32 a49, 0
v_accvgpr_write_b32 a50, 0
v_accvgpr_write_b32 a51, 0
v_accvgpr_write_b32 a52, 0
v_accvgpr_write_b32 a53, 0
v_accvgpr_write_b32 a54, 0
v_accvgpr_write_b32 a55, 0
v_accvgpr_write_b32 a56, 0
v_accvgpr_write_b32 a57, 0
v_accvgpr_write_b32 a58, 0
v_accvgpr_write_b32 a59, 0
v_accvgpr_write_b32 a60, 0
v_accvgpr_write_b32 a61, 0
v_accvgpr_write_b32 a62, 0
v_accvgpr_write_b32 a63, 0
LS_loop:
s_add_u32 m0, s53, 0
s_add_u32 s54, s58, 0
buffer_load_dwordx4 v251, s[12:15], s54 offen offset:0 lds
buffer_load_dwordx4 v251, s[12:15], s54 offen offset:1024 lds
buffer_load_dwordx4 v251, s[12:15], s54 offen offset:2048 lds
buffer_load_dwordx4 v251, s[12:15], s54 offen offset:3072 lds
s_add_u32 m0, s53, 4096
s_add_u32 s54, s58, 128
buffer_load_dwordx4 v251, s[12:15], s54 offen offset:0 lds
buffer_load_dwordx4 v251, s[12:15], s54 offen offset:1024 lds
buffer_load_dwordx4 v251, s[12:15], s54 offen offset:2048 lds
buffer_load_dwordx4 v251, s[12:15], s54 offen offset:3072 lds
s_add_u32 m0, s53, 8192
s_add_u32 s54, s58, 256
buffer_load_dwordx4 v251, s[12:15], s54 offen offset:0 lds
buffer_load_dwordx4 v251, s[12:15], s54 offen offset:1024 lds
buffer_load_dwordx4 v251, s[12:15], s54 offen offset:2048 lds
buffer_load_dwordx4 v251, s[12:15], s54 offen offset:3072 lds
s_add_u32 m0, s53, 12288
s_add_u32 s54, s58, 384
buffer_load_dwordx4 v251, s[12:15], s54 offen offset:0 lds
buffer_load_dwordx4 v251, s[12:15], s54 offen offset:1024 lds
buffer_load_dwordx4 v251, s[12:15], s54 offen offset:2048 lds
buffer_load_dwordx4 v251, s[12:15], s54 offen offset:3072 lds
s_add_u32 s53, s53, 0x4000
s_cmp_eq_u32 s53, s57
s_cselect_b32 s53, s56, s53
s_add_u32 s58, s58, 0x4000
v_add_u32 v177, s52, v248
v_add_u32 v178, s52, v249
v_add_u32 v179, s52, v250
s_add_u32 s52, s52, 0x4000
s_cmp_eq_u32 s52, s57
s_cselect_b32 s52, s56, s52
s_cmp_eq_u32 s51, 1
s_cselect_b32 s54, s33, 0
v_and_b32 v192, s54, v188
v_and_b32 v193, s54, v188
v_and_b32 v194, s54, v188
v_and_b32 v195, s54, v188
s_waitcnt vmcnt(16)
ds_read_b128 v[32:35], v177 offset:0
ds_read_b128 v[64:67], v177 offset:2048
ds_read_b128 v[36:39], v177 offset:512
ds_read_b128 v[68:71], v177 offset:2560
ds_read_b128 v[40:43], v177 offset:4096
ds_read_b128 v[72:75], v177 offset:6144
ds_read_b128 v[44:47], v177 offset:4608
ds_read_b128 v[76:79], v177 offset:6656
ds_read_b128 v[48:51], v177 offset:8192
ds_read_b128 v[80:83], v177 offset:10240
ds_read_b128 v[52:55], v177 offset:8704
ds_read_b128 v[84:87], v177 offset:10752
ds_read_b128 v[56:59], v177 offset:12288
ds_read_b128 v[88:91], v177 offset:14336
ds_read_b128 v[60:63], v177 offset:12800
ds_read_b128 v[92:95], v177 offset:14848
s_waitcnt lgkmcnt(14)
v_mfma_f32_16x16x32_bf16 v[160:163], v[32:35], v[0:3], v[192:195]
v_mfma_f32_16x16x32_bf16 v[164:167], v[64:67], v[0:3], v[192:195]
s_waitcnt lgkmcnt(12)
v_mfma_f32_16x16x32_bf16 v[160:163], v[36:39], v[4:7], v[160:163]
v_mfma_f32_16x16x32_bf16 v[164:167], v[68:71], v[4:7], v[164:167]
s_waitcnt lgkmcnt(10)
v_mfma_f32_16x16x32_bf16 v[160:163], v[40:43], v[8:11], v[160:163]
v_mfma_f32_16x16x32_bf16 v[164:167], v[72:75], v[8:11], v[164:167]
s_waitcnt lgkmcnt(8)
v_mfma_f32_16x16x32_bf16 v[160:163], v[44:47], v[12:15], v[160:163]
v_mfma_f32_16x16x32_bf16 v[164:167], v[76:79], v[12:15], v[164:167]
s_waitcnt lgkmcnt(6)
v_mfma_f32_16x16x32_bf16 v[160:163], v[48:51], v[16:19], v[160:163]
v_mfma_f32_16x16x32_bf16 v[164:167], v[80:83], v[16:19], v[164:167]
s_waitcnt lgkmcnt(4)
v_mfma_f32_16x16x32_bf16 v[160:163], v[52:55], v[20:23], v[160:163]
v_mfma_f32_16x16x32_bf16 v[164:167], v[84:87], v[20:23], v[164:167]
s_waitcnt lgkmcnt(2)
v_mfma_f32_16x16x32_bf16 v[160:163], v[56:59], v[24:27], v[160:163]
v_mfma_f32_16x16x32_bf16 v[164:167], v[88:91], v[24:27], v[164:167]
s_waitcnt lgkmcnt(0)
v_mfma_f32_16x16x32_bf16 v[160:163], v[60:63], v[28:31], v[160:163]
v_mfma_f32_16x16x32_bf16 v[164:167], v[92:95], v[28:31], v[164:167]
ds_read_b64_tr_b16 v[96:97], v178 offset:0
ds_read_b64_tr_b16 v[98:99], v178 offset:2048
ds_read_b64_tr_b16 v[100:101], v179 offset:0
ds_read_b64_tr_b16 v[102:103], v179 offset:2048
ds_read_b64_tr_b16 v[104:105], v178 offset:512
ds_read_b64_tr_b16 v[106:107], v178 offset:2560
ds_read_b64_tr_b16 v[108:109], v179 offset:512
ds_read_b64_tr_b16 v[110:111], v179 offset:2560
ds_read_b64_tr_b16 v[112:113], v178 offset:4096
ds_read_b64_tr_b16 v[114:115], v178 offset:6144
ds_read_b64_tr_b16 v[116:117], v179 offset:4096
ds_read_b64_tr_b16 v[118:119], v179 offset:6144
ds_read_b64_tr_b16 v[120:121], v178 offset:4608
ds_read_b64_tr_b16 v[122:123], v178 offset:6656
ds_read_b64_tr_b16 v[124:125], v179 offset:4608
ds_read_b64_tr_b16 v[126:127], v179 offset:6656
ds_read_b64_tr_b16 v[128:129], v178 offset:8192
ds_read_b64_tr_b16 v[130:131], v178 offset:10240
ds_read_b64_tr_b16 v[132:133], v179 offset:8192
ds_read_b64_tr_b16 v[134:135], v179 offset:10240
ds_read_b64_tr_b16 v[136:137], v178 offset:8704
ds_read_b64_tr_b16 v[138:139], v178 offset:10752
ds_read_b64_tr_b16 v[140:141], v179 offset:8704
ds_read_b64_tr_b16 v[142:143], v179 offset:10752
ds_read_b64_tr_b16 v[144:145], v178 offset:12288
ds_read_b64_tr_b16 v[146:147], v178 offset:14336
ds_read_b64_tr_b16 v[148:149], v179 offset:12288
ds_read_b64_tr_b16 v[150:151], v179 offset:14336
ds_read_b64_tr_b16 v[152:153], v178 offset:12800
ds_read_b64_tr_b16 v[154:155], v178 offset:14848
ds_read_b64_tr_b16 v[156:157], v179 offset:12800
ds_read_b64_tr_b16 v[158:159], v179 offset:14848
s_nop 7
v_max3_f32 v175, v160, v161, v162
v_max3_f32 v175, v175, v163, v164
v_max3_f32 v175, v175, v165, v166
v_max3_f32 v175, v175, v167, v172
v_mov_b32 v176, v175
s_nop 1
v_permlane32_swap_b32 v175, v176
s_nop 1
v_max_f32 v175, v175, v176
v_mov_b32 v176, v175
s_nop 1
v_permlane16_swap_b32 v175, v176
s_nop 1
v_max_f32 v175, v175, v176
v_sub_f32 v174, v172, v175
v_exp_f32 v174, v174
v_mov_b32 v172, v175
v_sub_f32 v160, v160, v172
v_sub_f32 v161, v161, v172
v_sub_f32 v162, v162, v172
v_sub_f32 v163, v163, v172
v_sub_f32 v164, v164, v172
v_sub_f32 v165, v165, v172
v_sub_f32 v166, v166, v172
v_sub_f32 v167, v167, v172
v_exp_f32 v160, v160
v_exp_f32 v161, v161
v_exp_f32 v162, v162
v_exp_f32 v163, v163
v_exp_f32 v164, v164
v_exp_f32 v165, v165
v_exp_f32 v166, v166
v_exp_f32 v167, v167
v_cmp_neq_f32 vcc, 1.0, v174
v_cvt_pk_bf16_f32 v168, v160, v161
v_cvt_pk_bf16_f32 v169, v162, v163
v_cvt_pk_bf16_f32 v170, v164, v165
v_cvt_pk_bf16_f32 v171, v166, v167
s_cbranch_vccz LS_nors
v_accvgpr_read_b32 v180, a0
v_accvgpr_read_b32 v181, a1
v_accvgpr_read_b32 v182, a2
v_accvgpr_read_b32 v183, a3
v_accvgpr_read_b32 v184, a4
v_accvgpr_read_b32 v185, a5
v_accvgpr_read_b32 v186, a6
v_accvgpr_read_b32 v187, a7
v_mul_f32 v180, v180, v174
v_mul_f32 v181, v181, v174
v_mul_f32 v182, v182, v174
v_mul_f32 v183, v183, v174
v_mul_f32 v184, v184, v174
v_mul_f32 v185, v185, v174
v_mul_f32 v186, v186, v174
v_mul_f32 v187, v187, v174
v_accvgpr_write_b32 a0, v180
v_accvgpr_write_b32 a1, v181
v_accvgpr_write_b32 a2, v182
v_accvgpr_write_b32 a3, v183
v_accvgpr_write_b32 a4, v184
v_accvgpr_write_b32 a5, v185
v_accvgpr_write_b32 a6, v186
v_accvgpr_write_b32 a7, v187
v_accvgpr_read_b32 v180, a8
v_accvgpr_read_b32 v181, a9
v_accvgpr_read_b32 v182, a10
v_accvgpr_read_b32 v183, a11
v_accvgpr_read_b32 v184, a12
v_accvgpr_read_b32 v185, a13
v_accvgpr_read_b32 v186, a14
v_accvgpr_read_b32 v187, a15
v_mul_f32 v180, v180, v174
v_mul_f32 v181, v181, v174
v_mul_f32 v182, v182, v174
v_mul_f32 v183, v183, v174
v_mul_f32 v184, v184, v174
v_mul_f32 v185, v185, v174
v_mul_f32 v186, v186, v174
v_mul_f32 v187, v187, v174
v_accvgpr_write_b32 a8, v180
v_accvgpr_write_b32 a9, v181
v_accvgpr_write_b32 a10, v182
v_accvgpr_write_b32 a11, v183
v_accvgpr_write_b32 a12, v184
v_accvgpr_write_b32 a13, v185
v_accvgpr_write_b32 a14, v186
v_accvgpr_write_b32 a15, v187
v_accvgpr_read_b32 v180, a16
v_accvgpr_read_b32 v181, a17
v_accvgpr_read_b32 v182, a18
v_accvgpr_read_b32 v183, a19
v_accvgpr_read_b32 v184, a20
v_accvgpr_read_b32 v185, a21
v_accvgpr_read_b32 v186, a22
v_accvgpr_read_b32 v187, a23
v_mul_f32 v180, v180, v174
v_mul_f32 v181, v181, v174
v_mul_f32 v182, v182, v174
v_mul_f32 v183, v183, v174
v_mul_f32 v184, v184, v174
v_mul_f32 v185, v185, v174
v_mul_f32 v186, v186, v174
v_mul_f32 v187, v187, v174
v_accvgpr_write_b32 a16, v180
v_accvgpr_write_b32 a17, v181
v_accvgpr_write_b32 a18, v182
v_accvgpr_write_b32 a19, v183
v_accvgpr_write_b32 a20, v184
v_accvgpr_write_b32 a21, v185
v_accvgpr_write_b32 a22, v186
v_accvgpr_write_b32 a23, v187
v_accvgpr_read_b32 v180, a24
v_accvgpr_read_b32 v181, a25
v_accvgpr_read_b32 v182, a26
v_accvgpr_read_b32 v183, a27
v_accvgpr_read_b32 v184, a28
v_accvgpr_read_b32 v185, a29
v_accvgpr_read_b32 v186, a30
v_accvgpr_read_b32 v187, a31
v_mul_f32 v180, v180, v174
v_mul_f32 v181, v181, v174
v_mul_f32 v182, v182, v174
v_mul_f32 v183, v183, v174
v_mul_f32 v184, v184, v174
v_mul_f32 v185, v185, v174
v_mul_f32 v186, v186, v174
v_mul_f32 v187, v187, v174
v_accvgpr_write_b32 a24, v180
v_accvgpr_write_b32 a25, v181
v_accvgpr_write_b32 a26, v182
v_accvgpr_write_b32 a27, v183
v_accvgpr_write_b32 a28, v184
v_accvgpr_write_b32 a29, v185
v_accvgpr_write_b32 a30, v186
v_accvgpr_write_b32 a31, v187
v_accvgpr_read_b32 v180, a32
v_accvgpr_read_b32 v181, a33
v_accvgpr_read_b32 v182, a34
v_accvgpr_read_b32 v183, a35
v_accvgpr_read_b32 v184, a36
v_accvgpr_read_b32 v185, a37
v_accvgpr_read_b32 v186, a38
v_accvgpr_read_b32 v187, a39
v_mul_f32 v180, v180, v174
v_mul_f32 v181, v181, v174
v_mul_f32 v182, v182, v174
v_mul_f32 v183, v183, v174
v_mul_f32 v184, v184, v174
v_mul_f32 v185, v185, v174
v_mul_f32 v186, v186, v174
v_mul_f32 v187, v187, v174
v_accvgpr_write_b32 a32, v180
v_accvgpr_write_b32 a33, v181
v_accvgpr_write_b32 a34, v182
v_accvgpr_write_b32 a35, v183
v_accvgpr_write_b32 a36, v184
v_accvgpr_write_b32 a37, v185
v_accvgpr_write_b32 a38, v186
v_accvgpr_write_b32 a39, v187
v_accvgpr_read_b32 v180, a40
v_accvgpr_read_b32 v181, a41
v_accvgpr_read_b32 v182, a42
v_accvgpr_read_b32 v183, a43
v_accvgpr_read_b32 v184, a44
v_accvgpr_read_b32 v185, a45
v_accvgpr_read_b32 v186, a46
v_accvgpr_read_b32 v187, a47
v_mul_f32 v180, v180, v174
v_mul_f32 v181, v181, v174
v_mul_f32 v182, v182, v174
v_mul_f32 v183, v183, v174
v_mul_f32 v184, v184, v174
v_mul_f32 v185, v185, v174
v_mul_f32 v186, v186, v174
v_mul_f32 v187, v187, v174
v_accvgpr_write_b32 a40, v180
v_accvgpr_write_b32 a41, v181
v_accvgpr_write_b32 a42, v182
v_accvgpr_write_b32 a43, v183
v_accvgpr_write_b32 a44, v184
v_accvgpr_write_b32 a45, v185
v_accvgpr_write_b32 a46, v186
v_accvgpr_write_b32 a47, v187
v_accvgpr_read_b32 v180, a48
v_accvgpr_read_b32 v181, a49
v_accvgpr_read_b32 v182, a50
v_accvgpr_read_b32 v183, a51
v_accvgpr_read_b32 v184, a52
v_accvgpr_read_b32 v185, a53
v_accvgpr_read_b32 v186, a54
v_accvgpr_read_b32 v187, a55
v_mul_f32 v180, v180, v174
v_mul_f32 v181, v181, v174
v_mul_f32 v182, v182, v174
v_mul_f32 v183, v183, v174
v_mul_f32 v184, v184, v174
v_mul_f32 v185, v185, v174
v_mul_f32 v186, v186, v174
v_mul_f32 v187, v187, v174
v_accvgpr_write_b32 a48, v180
v_accvgpr_write_b32 a49, v181
v_accvgpr_write_b32 a50, v182
v_accvgpr_write_b32 a51, v183
v_accvgpr_write_b32 a52, v184
v_accvgpr_write_b32 a53, v185
v_accvgpr_write_b32 a54, v186
v_accvgpr_write_b32 a55, v187
v_accvgpr_read_b32 v180, a56
v_accvgpr_read_b32 v181, a57
v_accvgpr_read_b32 v182, a58
v_accvgpr_read_b32 v183, a59
v_accvgpr_read_b32 v184, a60
v_accvgpr_read_b32 v185, a61
v_accvgpr_read_b32 v186, a62
v_accvgpr_read_b32 v187, a63
v_mul_f32 v180, v180, v174
v_mul_f32 v181, v181, v174
v_mul_f32 v182, v182, v174
v_mul_f32 v183, v183, v174
v_mul_f32 v184, v184, v174
v_mul_f32 v185, v185, v174
v_mul_f32 v186, v186, v174
v_mul_f32 v187, v187, v174
v_accvgpr_write_b32 a56, v180
v_accvgpr_write_b32 a57, v181
v_accvgpr_write_b32 a58, v182
v_accvgpr_write_b32 a59, v183
v_accvgpr_write_b32 a60, v184
v_accvgpr_write_b32 a61, v185
v_accvgpr_write_b32 a62, v186
v_accvgpr_write_b32 a63, v187
LS_nors:
s_waitcnt lgkmcnt(0)
s_nop 1
v_mfma_f32_16x16x32_bf16 a[0:3], v[96:99], v[168:171], a[0:3]
v_mfma_f32_16x16x32_bf16 a[4:7], v[100:103], v[168:171], a[4:7]
v_mfma_f32_16x16x32_bf16 a[8:11], v[104:107], v[168:171], a[8:11]
v_mfma_f32_16x16x32_bf16 a[12:15], v[108:111], v[168:171], a[12:15]
v_mfma_f32_16x16x32_bf16 a[16:19], v[112:115], v[168:171], a[16:19]
v_mfma_f32_16x16x32_bf16 a[20:23], v[116:119], v[168:171], a[20:23]
v_mfma_f32_16x16x32_bf16 a[24:27], v[120:123], v[168:171], a[24:27]
v_mfma_f32_16x16x32_bf16 a[28:31], v[124:127], v[168:171], a[28:31]
v_mfma_f32_16x16x32_bf16 a[32:35], v[128:131], v[168:171], a[32:35]
v_mfma_f32_16x16x32_bf16 a[36:39], v[132:135], v[168:171], a[36:39]
v_mfma_f32_16x16x32_bf16 a[40:43], v[136:139], v[168:171], a[40:43]
v_mfma_f32_16x16x32_bf16 a[44:47], v[140:143], v[168:171], a[44:47]
v_mfma_f32_16x16x32_bf16 a[48:51], v[144:147], v[168:171], a[48:51]
v_mfma_f32_16x16x32_bf16 a[52:55], v[148:151], v[168:171], a[52:55]
v_mfma_f32_16x16x32_bf16 a[56:59], v[152:155], v[168:171], a[56:59]
v_mfma_f32_16x16x32_bf16 a[60:63], v[156:159], v[168:171], a[60:63]
s_sub_u32 s51, s51, 1
s_cmp_lg_u32 s51, 0
s_cbranch_scc1 LS_loop
s_nop 15
v_accvgpr_read_b32 v173, a0
v_accvgpr_read_b32 v180, a0
v_accvgpr_read_b32 v181, a1
v_accvgpr_read_b32 v182, a2
v_accvgpr_read_b32 v183, a3
v_accvgpr_read_b32 v184, a4
v_accvgpr_read_b32 v185, a5
v_accvgpr_read_b32 v186, a6
v_accvgpr_read_b32 v187, a7
v_cvt_pk_bf16_f32 v32, v180, v181
v_cvt_pk_bf16_f32 v33, v182, v183
v_cvt_pk_bf16_f32 v34, v184, v185
v_cvt_pk_bf16_f32 v35, v186, v187
buffer_store_dwordx4 v[32:35], v252, s[20:23], s40 offen offset:0 sc1
v_accvgpr_read_b32 v180, a8
v_accvgpr_read_b32 v181, a9
v_accvgpr_read_b32 v182, a10
v_accvgpr_read_b32 v183, a11
v_accvgpr_read_b32 v184, a12
v_accvgpr_read_b32 v185, a13
v_accvgpr_read_b32 v186, a14
v_accvgpr_read_b32 v187, a15
v_cvt_pk_bf16_f32 v36, v180, v181
v_cvt_pk_bf16_f32 v37, v182, v183
v_cvt_pk_bf16_f32 v38, v184, v185
v_cvt_pk_bf16_f32 v39, v186, v187
buffer_store_dwordx4 v[36:39], v252, s[20:23], s40 offen offset:1024 sc1
v_accvgpr_read_b32 v180, a16
v_accvgpr_read_b32 v181, a17
v_accvgpr_read_b32 v182, a18
v_accvgpr_read_b32 v183, a19
v_accvgpr_read_b32 v184, a20
v_accvgpr_read_b32 v185, a21
v_accvgpr_read_b32 v186, a22
v_accvgpr_read_b32 v187, a23
v_cvt_pk_bf16_f32 v40, v180, v181
v_cvt_pk_bf16_f32 v41, v182, v183
v_cvt_pk_bf16_f32 v42, v184, v185
v_cvt_pk_bf16_f32 v43, v186, v187
buffer_store_dwordx4 v[40:43], v252, s[20:23], s40 offen offset:2048 sc1
v_accvgpr_read_b32 v180, a24
v_accvgpr_read_b32 v181, a25
v_accvgpr_read_b32 v182, a26
v_accvgpr_read_b32 v183, a27
v_accvgpr_read_b32 v184, a28
v_accvgpr_read_b32 v185, a29
v_accvgpr_read_b32 v186, a30
v_accvgpr_read_b32 v187, a31
v_cvt_pk_bf16_f32 v44, v180, v181
v_cvt_pk_bf16_f32 v45, v182, v183
v_cvt_pk_bf16_f32 v46, v184, v185
v_cvt_pk_bf16_f32 v47, v186, v187
buffer_store_dwordx4 v[44:47], v252, s[20:23], s40 offen offset:3072 sc1
v_accvgpr_read_b32 v180, a32
v_accvgpr_read_b32 v181, a33
v_accvgpr_read_b32 v182, a34
v_accvgpr_read_b32 v183, a35
v_accvgpr_read_b32 v184, a36
v_accvgpr_read_b32 v185, a37
v_accvgpr_read_b32 v186, a38
v_accvgpr_read_b32 v187, a39
v_cvt_pk_bf16_f32 v48, v180, v181
v_cvt_pk_bf16_f32 v49, v182, v183
v_cvt_pk_bf16_f32 v50, v184, v185
v_cvt_pk_bf16_f32 v51, v186, v187
buffer_store_dwordx4 v[48:51], v252, s[20:23], s44 offen offset:0 sc1
v_accvgpr_read_b32 v180, a40
v_accvgpr_read_b32 v181, a41
v_accvgpr_read_b32 v182, a42
v_accvgpr_read_b32 v183, a43
v_accvgpr_read_b32 v184, a44
v_accvgpr_read_b32 v185, a45
v_accvgpr_read_b32 v186, a46
v_accvgpr_read_b32 v187, a47
v_cvt_pk_bf16_f32 v52, v180, v181
v_cvt_pk_bf16_f32 v53, v182, v183
v_cvt_pk_bf16_f32 v54, v184, v185
v_cvt_pk_bf16_f32 v55, v186, v187
buffer_store_dwordx4 v[52:55], v252, s[20:23], s44 offen offset:1024 sc1
v_accvgpr_read_b32 v180, a48
v_accvgpr_read_b32 v181, a49
v_accvgpr_read_b32 v182, a50
v_accvgpr_read_b32 v183, a51
v_accvgpr_read_b32 v184, a52
v_accvgpr_read_b32 v185, a53
v_accvgpr_read_b32 v186, a54
v_accvgpr_read_b32 v187, a55
v_cvt_pk_bf16_f32 v56, v180, v181
v_cvt_pk_bf16_f32 v57, v182, v183
v_cvt_pk_bf16_f32 v58, v184, v185
v_cvt_pk_bf16_f32 v59, v186, v187
buffer_store_dwordx4 v[56:59], v252, s[20:23], s44 offen offset:2048 sc1
v_accvgpr_read_b32 v180, a56
v_accvgpr_read_b32 v181, a57
v_accvgpr_read_b32 v182, a58
v_accvgpr_read_b32 v183, a59
v_accvgpr_read_b32 v184, a60
v_accvgpr_read_b32 v185, a61
v_accvgpr_read_b32 v186, a62
v_accvgpr_read_b32 v187, a63
v_cvt_pk_bf16_f32 v60, v180, v181
v_cvt_pk_bf16_f32 v61, v182, v183
v_cvt_pk_bf16_f32 v62, v184, v185
v_cvt_pk_bf16_f32 v63, v186, v187
buffer_store_dwordx4 v[60:63], v252, s[20:23], s44 offen offset:3072 sc1
v_lshlrev_b32 v175, 2, v252
s_mov_b64 exec, 0xffff
buffer_store_dwordx2 v[172:173], v175, s[24:27], s48 offen sc1
s_mov_b64 exec, -1
s_waitcnt vmcnt(0)
s_add_u32 s40, s40, 8192
s_add_u32 s48, s48, 1024
s_sub_u32 s55, s55, 1
s_cmp_lg_u32 s55, 0
s_cbranch_scc1 LS_q
s_barrier
s_add_u32 s56, s4, 0x1000000
s_addc_u32 s57, s5, 0
s_mov_b32 s58, 0x6c02000
s_mov_b32 s59, 0x00020000
s_mul_i32 s35, s37, 3
s_and_b32 s36, s35, 3
s_lshl_b32 s36, s36, 2
s_lshr_b32 s52, s35, 2
s_add_u32 s36, s36, s52
s_lshl_b32 s52, s38, 4
s_add_u32 s52, s52, s36
s_lshl_b32 s52, s52, 13
s_add_u32 s35, s35, 1
s_and_b32 s36, s35, 3
s_lshl_b32 s36, s36, 2
s_lshr_b32 s53, s35, 2
s_add_u32 s36, s36, s53
s_lshl_b32 s53, s38, 4
s_add_u32 s53, s53, s36
s_lshl_b32 s53, s53, 13
s_add_u32 s35, s35, 1
s_and_b32 s36, s35, 3
s_lshl_b32 s36, s36, 2
s_lshr_b32 s54, s35, 2
s_add_u32 s36, s36, s54
s_lshl_b32 s54, s38, 4
s_add_u32 s54, s54, s36
s_lshl_b32 s54, s54, 13
s_mov_b32 s99, 0
s_mov_b32 s98, 2
s_branch LC_again
LT_disp:
s_cmp_eq_u32 s34, 0
s_cbranch_scc1 LT_start
s_mov_b32 s41, s34
s_mul_i32 s40, s34, 6
s_add_u32 s40, s40, s37
s_add_u32 s40, s40, 42
s_cmp_lt_u32 s40, 60
s_cbranch_scc1 LE_common
s_branch L2_end
LT_start:
s_waitcnt lgkmcnt(0)
s_add_u32 s12, s4, 0x6800000
s_addc_u32 s13, s5, 0
s_mov_b32 s14, s49
s_mov_b32 s15, 0x00020000
s_add_u32 s8, s4, 0x0
s_addc_u32 s9, s5, 0
s_mov_b32 s10, 0x4e4000
s_mov_b32 s11, 0x00020000
s_mul_i32 s35, s37, 0x600000
s_add_u32 s20, s4, 0x2000000
s_addc_u32 s21, s5, 0
s_add_u32 s20, s20, s35
s_addc_u32 s21, s21, 0
s_mov_b32 s22, 0x4e4000
s_mov_b32 s23, 0x00020000
s_add_u32 s24, s4, 0x6000000
s_addc_u32 s25, s5, 0
s_mov_b32 s26, 0x9c800
s_mov_b32 s27, 0x00020000
s_lshl_b32 s35, s38, 4
s_lshl_b32 s41, s34, 2
s_add_u32 s35, s35, s41
s_lshl_b32 s40, s35, 13
s_lshl_b32 s48, s35, 10
s_lshl_b32 s35, s37, 3
s_add_u32 s48, s48, s35
v_bfe_u32 v248, v252, 4, 3
v_lshlrev_b32 v248, 6, v248
v_bfe_u32 v253, v252, 7, 1
v_lshl_or_b32 v248, v253, 10, v248
v_bfe_u32 v253, v252, 8, 2
v_lshl_or_b32 v248, v253, 4, v248
v_bfe_u32 v253, v252, 6, 1
v_lshlrev_b32 v253, 5, v253
v_xor_b32 v248, v248, v253
v_and_b32 v249, 0x1c0, v252
v_bfe_u32 v253, v252, 9, 1
v_lshl_or_b32 v249, v253, 10, v249
v_bfe_u32 v253, v252, 8, 1
v_lshl_or_b32 v249, v253, 5, v249
v_bfe_u32 v253, v252, 4, 2
v_lshl_or_b32 v249, v253, 3, v249
v_xor_b32 v250, 32, v249
s_mov_b32 s56, 90112
s_add_u32 s57, s56, 65536
s_mov_b32 s55, 1
v_bfe_i32 v188, v252, 8, 1
LT_q:
s_add_u32 s44, s40, 4096
buffer_load_dwordx4 v[0:3], v252, s[8:11], s40 offen offset:0
buffer_load_dwordx4 v[4:7], v252, s[8:11], s40 offen offset:1024
buffer_load_dwordx4 v[8:11], v252, s[8:11], s40 offen offset:2048
buffer_load_dwordx4 v[12:15], v252, s[8:11], s40 offen offset:3072
buffer_load_dwordx4 v[16:19], v252, s[8:11], s44 offen offset:0
buffer_load_dwordx4 v[20:23], v252, s[8:11], s44 offen offset:1024
buffer_load_dwordx4 v[24:27], v252, s[8:11], s44 offen offset:2048
buffer_load_dwordx4 v[28:31], v252, s[8:11], s44 offen offset:3072
s_mov_b32 s53, s56
s_mov_b32 s58, s39
s_add_u32 m0, s53, 0
s_add_u32 s54, s58, 0
buffer_load_dwordx4 v251, s[12:15], s54 offen offset:0 lds
buffer_load_dwordx4 v251, s[12:15], s54 offen offset:1024 lds
buffer_load_dwordx4 v251, s[12:15], s54 offen offset:2048 lds
buffer_load_dwordx4 v251, s[12:15], s54 offen offset:3072 lds
s_add_u32 m0, s53, 4096
s_add_u32 s54, s58, 128
buffer_load_dwordx4 v251, s[12:15], s54 offen offset:0 lds
buffer_load_dwordx4 v251, s[12:15], s54 offen offset:1024 lds
buffer_load_dwordx4 v251, s[12:15], s54 offen offset:2048 lds
buffer_load_dwordx4 v251, s[12:15], s54 offen offset:3072 lds
s_add_u32 m0, s53, 8192
s_add_u32 s54, s58, 256
buffer_load_dwordx4 v251, s[12:15], s54 offen offset:0 lds
buffer_load_dwordx4 v251, s[12:15], s54 offen offset:1024 lds
buffer_load_dwordx4 v251, s[12:15], s54 offen offset:2048 lds
buffer_load_dwordx4 v251, s[12:15], s54 offen offset:3072 lds
s_add_u32 m0, s53, 12288
s_add_u32 s54, s58, 384
buffer_load_dwordx4 v251, s[12:15], s54 offen offset:0 lds
buffer_load_dwordx4 v251, s[12:15], s54 offen offset:1024 lds
buffer_load_dwordx4 v251, s[12:15], s54 offen offset:2048 lds
buffer_load_dwordx4 v251, s[12:15], s54 offen offset:3072 lds
s_add_u32 s53, s53, 0x4000
s_cmp_eq_u32 s53, s57
s_cselect_b32 s53, s56, s53
s_add_u32 s58, s58, 0x4000
s_add_u32 m0, s53, 0
s_add_u32 s54, s58, 0
buffer_load_dwordx4 v251, s[12:15], s54 offen offset:0 lds
buffer_load_dwordx4 v251, s[12:15], s54 offen offset:1024 lds
buffer_load_dwordx4 v251, s[12:15], s54 offen offset:2048 lds
buffer_load_dwordx4 v251, s[12:15], s54 offen offset:3072 lds
s_add_u32 m0, s53, 4096
s_add_u32 s54, s58, 128
buffer_load_dwordx4 v251, s[12:15], s54 offen offset:0 lds
buffer_load_dwordx4 v251, s[12:15], s54 offen offset:1024 lds
buffer_load_dwordx4 v251, s[12:15], s54 offen offset:2048 lds
buffer_load_dwordx4 v251, s[12:15], s54 offen offset:3072 lds
s_add_u32 m0, s53, 8192
s_add_u32 s54, s58, 256
buffer_load_dwordx4 v251, s[12:15], s54 offen offset:0 lds
buffer_load_dwordx4 v251, s[12:15], s54 offen offset:1024 lds
buffer_load_dwordx4 v251, s[12:15], s54 offen offset:2048 lds
buffer_load_dwordx4 v251, s[12:15], s54 offen offset:3072 lds
s_add_u32 m0, s53, 12288
s_add_u32 s54, s58, 384
buffer_load_dwordx4 v251, s[12:15], s54 offen offset:0 lds
buffer_load_dwordx4 v251, s[12:15], s54 offen offset:1024 lds
buffer_load_dwordx4 v251, s[12:15], s54 offen offset:2048 lds
buffer_load_dwordx4 v251, s[12:15], s54 offen offset:3072 lds
s_add_u32 s53, s53, 0x4000
s_cmp_eq_u32 s53, s57
s_cselect_b32 s53, s56, s53
s_add_u32 s58, s58, 0x4000
s_add_u32 m0, s53, 0
s_add_u32 s54, s58, 0
buffer_load_dwordx4 v251, s[12:15], s54 offen offset:0 lds
buffer_load_dwordx4 v251, s[12:15], s54 offen offset:1024 lds
buffer_load_dwordx4 v251, s[12:15], s54 offen offset:2048 lds
buffer_load_dwordx4 v251, s[12:15], s54 offen offset:3072 lds
s_add_u32 m0, s53, 4096
s_add_u32 s54, s58, 128
buffer_load_dwordx4 v251, s[12:15], s54 offen offset:0 lds
buffer_load_dwordx4 v251, s[12:15], s54 offen offset:1024 lds
buffer_load_dwordx4 v251, s[12:15], s54 offen offset:2048 lds
buffer_load_dwordx4 v251, s[12:15], s54 offen offset:3072 lds
s_add_u32 m0, s53, 8192
s_add_u32 s54, s58, 256
buffer_load_dwordx4 v251, s[12:15], s54 offen offset:0 lds
buffer_load_dwordx4 v251, s[12:15], s54 offen offset:1024 lds
buffer_load_dwordx4 v251, s[12:15], s54 offen offset:2048 lds
buffer_load_dwordx4 v251, s[12:15], s54 offen offset:3072 lds
s_add_u32 m0, s53, 12288
s_add_u32 s54, s58, 384
buffer_load_dwordx4 v251, s[12:15], s54 offen offset:0 lds
buffer_load_dwordx4 v251, s[12:15], s54 offen offset:1024 lds
buffer_load_dwordx4 v251, s[12:15], s54 offen offset:2048 lds
buffer_load_dwordx4 v251, s[12:15], s54 offen offset:3072 lds
s_add_u32 s53, s53, 0x4000
s_cmp_eq_u32 s53, s57
s_cselect_b32 s53, s56, s53
s_add_u32 s58, s58, 0x4000
s_mov_b32 s51, s29
s_mov_b32 s52, s56
v_mov_b32 v172, 0xff800000
v_accvgpr_write_b32 a0, 0
v_accvgpr_write_b32 a1, 0
v_accvgpr_write_b32 a2, 0
v_accvgpr_write_b32 a3, 0
v_accvgpr_write_b32 a4, 0
v_accvgpr_write_b32 a5, 0
v_accvgpr_write_b32 a6, 0
v_accvgpr_write_b32 a7, 0
v_accvgpr_write_b32 a8, 0
v_accvgpr_write_b32 a9, 0
v_accvgpr_write_b32 a10, 0
v_accvgpr_write_b32 a11, 0
v_accvgpr_write_b32 a12, 0
v_accvgpr_write_b32 a13, 0
v_accvgpr_write_b32 a14, 0
v_accvgpr_write_b32 a15, 0
v_accvgpr_write_b32 a16, 0
v_accvgpr_write_b32 a17, 0
v_accvgpr_write_b32 a18, 0
v_accvgpr_write_b32 a19, 0
v_accvgpr_write_b32 a20, 0
v_accvgpr_write_b32 a21, 0
v_accvgpr_write_b32 a22, 0
v_accvgpr_write_b32 a23, 0
v_accvgpr_write_b32 a24, 0
v_accvgpr_write_b32 a25, 0
v_accvgpr_write_b32 a26, 0
v_accvgpr_write_b32 a27, 0
v_accvgpr_write_b32 a28, 0
v_accvgpr_write_b32 a29, 0
v_accvgpr_write_b32 a30, 0
v_accvgpr_write_b32 a31, 0
v_accvgpr_write_b32 a32, 0
v_accvgpr_write_b32 a33, 0
v_accvgpr_write_b32 a34, 0
v_accvgpr_write_b32 a35, 0
v_accvgpr_write_b32 a36, 0
v_accvgpr_write_b32 a37, 0
v_accvgpr_write_b32 a38, 0
v_accvgpr_write_b32 a39, 0
v_accvgpr_write_b32 a40, 0
v_accvgpr_write_b32 a41, 0
v_accvgpr_write_b32 a42, 0
v_accvgpr_write_b32 a43, 0
v_accvgpr_write_b32 a44, 0
v_accvgpr_write_b32 a45, 0
v_accvgpr_write_b32 a46, 0
v_accvgpr_write_b32 a47, 0
v_accvgpr_write_b32 a48, 0
v_accvgpr_write_b32 a49, 0
v_accvgpr_write_b32 a50, 0
v_accvgpr_write_b32 a51, 0
v_accvgpr_write_b32 a52, 0
v_accvgpr_write_b32 a53, 0
v_accvgpr_write_b32 a54, 0
v_accvgpr_write_b32 a55, 0
v_accvgpr_write_b32 a56, 0
v_accvgpr_write_b32 a57, 0
v_accvgpr_write_b32 a58, 0
v_accvgpr_write_b32 a59, 0
v_accvgpr_write_b32 a60, 0
v_accvgpr_write_b32 a61, 0
v_accvgpr_write_b32 a62, 0
v_accvgpr_write_b32 a63, 0
LT_loop:
s_add_u32 m0, s53, 0
s_add_u32 s54, s58, 0
buffer_load_dwordx4 v251, s[12:15], s54 offen offset:0 lds
buffer_load_dwordx4 v251, s[12:15], s54 offen offset:1024 lds
buffer_load_dwordx4 v251, s[12:15], s54 offen offset:2048 lds
buffer_load_dwordx4 v251, s[12:15], s54 offen offset:3072 lds
s_add_u32 m0, s53, 4096
s_add_u32 s54, s58, 128
buffer_load_dwordx4 v251, s[12:15], s54 offen offset:0 lds
buffer_load_dwordx4 v251, s[12:15], s54 offen offset:1024 lds
buffer_load_dwordx4 v251, s[12:15], s54 offen offset:2048 lds
buffer_load_dwordx4 v251, s[12:15], s54 offen offset:3072 lds
s_add_u32 m0, s53, 8192
s_add_u32 s54, s58, 256
buffer_load_dwordx4 v251, s[12:15], s54 offen offset:0 lds
buffer_load_dwordx4 v251, s[12:15], s54 offen offset:1024 lds
buffer_load_dwordx4 v251, s[12:15], s54 offen offset:2048 lds
buffer_load_dwordx4 v251, s[12:15], s54 offen offset:3072 lds
s_add_u32 m0, s53, 12288
s_add_u32 s54, s58, 384
buffer_load_dwordx4 v251, s[12:15], s54 offen offset:0 lds
buffer_load_dwordx4 v251, s[12:15], s54 offen offset:1024 lds
buffer_load_dwordx4 v251, s[12:15], s54 offen offset:2048 lds
buffer_load_dwordx4 v251, s[12:15], s54 offen offset:3072 lds
s_add_u32 s53, s53, 0x4000
s_cmp_eq_u32 s53, s57
s_cselect_b32 s53, s56, s53
s_add_u32 s58, s58, 0x4000
v_add_u32 v177, s52, v248
v_add_u32 v178, s52, v249
v_add_u32 v179, s52, v250
s_add_u32 s52, s52, 0x4000
s_cmp_eq_u32 s52, s57
s_cselect_b32 s52, s56, s52
s_cmp_eq_u32 s51, 1
s_cselect_b32 s54, s33, 0
v_and_b32 v192, s54, v188
v_and_b32 v193, s54, v188
v_and_b32 v194, s54, v188
v_and_b32 v195, s54, v188
s_waitcnt vmcnt(48)
ds_read_b128 v[32:35], v177 offset:0
ds_read_b128 v[64:67], v177 offset:2048
ds_read_b128 v[36:39], v177 offset:512
ds_read_b128 v[68:71], v177 offset:2560
ds_read_b128 v[40:43], v177 offset:4096
ds_read_b128 v[72:75], v177 offset:6144
ds_read_b128 v[44:47], v177 offset:4608
ds_read_b128 v[76:79], v177 offset:6656
ds_read_b128 v[48:51], v177 offset:8192
ds_read_b128 v[80:83], v177 offset:10240
ds_read_b128 v[52:55], v177 offset:8704
ds_read_b128 v[84:87], v177 offset:10752
ds_read_b128 v[56:59], v177 offset:12288
ds_read_b128 v[88:91], v177 offset:14336
ds_read_b128 v[60:63], v177 offset:12800
ds_read_b128 v[92:95], v177 offset:14848
s_waitcnt lgkmcnt(14)
v_mfma_f32_16x16x32_bf16 v[160:163], v[32:35], v[0:3], v[192:195]
v_mfma_f32_16x16x32_bf16 v[164:167], v[64:67], v[0:3], v[192:195]
s_waitcnt lgkmcnt(12)
v_mfma_f32_16x16x32_bf16 v[160:163], v[36:39], v[4:7], v[160:163]
v_mfma_f32_16x16x32_bf16 v[164:167], v[68:71], v[4:7], v[164:167]
s_waitcnt lgkmcnt(10)
v_mfma_f32_16x16x32_bf16 v[160:163], v[40:43], v[8:11], v[160:163]
v_mfma_f32_16x16x32_bf16 v[164:167], v[72:75], v[8:11], v[164:167]
s_waitcnt lgkmcnt(8)
v_mfma_f32_16x16x32_bf16 v[160:163], v[44:47], v[12:15], v[160:163]
v_mfma_f32_16x16x32_bf16 v[164:167], v[76:79], v[12:15], v[164:167]
s_waitcnt lgkmcnt(6)
v_mfma_f32_16x16x32_bf16 v[160:163], v[48:51], v[16:19], v[160:163]
v_mfma_f32_16x16x32_bf16 v[164:167], v[80:83], v[16:19], v[164:167]
s_waitcnt lgkmcnt(4)
v_mfma_f32_16x16x32_bf16 v[160:163], v[52:55], v[20:23], v[160:163]
v_mfma_f32_16x16x32_bf16 v[164:167], v[84:87], v[20:23], v[164:167]
s_waitcnt lgkmcnt(2)
v_mfma_f32_16x16x32_bf16 v[160:163], v[56:59], v[24:27], v[160:163]
v_mfma_f32_16x16x32_bf16 v[164:167], v[88:91], v[24:27], v[164:167]
s_waitcnt lgkmcnt(0)
v_mfma_f32_16x16x32_bf16 v[160:163], v[60:63], v[28:31], v[160:163]
v_mfma_f32_16x16x32_bf16 v[164:167], v[92:95], v[28:31], v[164:167]
ds_read_b64_tr_b16 v[96:97], v178 offset:0
ds_read_b64_tr_b16 v[98:99], v178 offset:2048
ds_read_b64_tr_b16 v[100:101], v179 offset:0
ds_read_b64_tr_b16 v[102:103], v179 offset:2048
ds_read_b64_tr_b16 v[104:105], v178 offset:512
ds_read_b64_tr_b16 v[106:107], v178 offset:2560
ds_read_b64_tr_b16 v[108:109], v179 offset:512
ds_read_b64_tr_b16 v[110:111], v179 offset:2560
ds_read_b64_tr_b16 v[112:113], v178 offset:4096
ds_read_b64_tr_b16 v[114:115], v178 offset:6144
ds_read_b64_tr_b16 v[116:117], v179 offset:4096
ds_read_b64_tr_b16 v[118:119], v179 offset:6144
ds_read_b64_tr_b16 v[120:121], v178 offset:4608
ds_read_b64_tr_b16 v[122:123], v178 offset:6656
ds_read_b64_tr_b16 v[124:125], v179 offset:4608
ds_read_b64_tr_b16 v[126:127], v179 offset:6656
ds_read_b64_tr_b16 v[128:129], v178 offset:8192
ds_read_b64_tr_b16 v[130:131], v178 offset:10240
ds_read_b64_tr_b16 v[132:133], v179 offset:8192
ds_read_b64_tr_b16 v[134:135], v179 offset:10240
ds_read_b64_tr_b16 v[136:137], v178 offset:8704
ds_read_b64_tr_b16 v[138:139], v178 offset:10752
ds_read_b64_tr_b16 v[140:141], v179 offset:8704
ds_read_b64_tr_b16 v[142:143], v179 offset:10752
ds_read_b64_tr_b16 v[144:145], v178 offset:12288
ds_read_b64_tr_b16 v[146:147], v178 offset:14336
ds_read_b64_tr_b16 v[148:149], v179 offset:12288
ds_read_b64_tr_b16 v[150:151], v179 offset:14336
ds_read_b64_tr_b16 v[152:153], v178 offset:12800
ds_read_b64_tr_b16 v[154:155], v178 offset:14848
ds_read_b64_tr_b16 v[156:157], v179 offset:12800
ds_read_b64_tr_b16 v[158:159], v179 offset:14848
s_nop 7
v_max3_f32 v175, v160, v161, v162
v_max3_f32 v175, v175, v163, v164
v_max3_f32 v175, v175, v165, v166
v_max3_f32 v175, v175, v167, v172
v_mov_b32 v176, v175
s_nop 1
v_permlane32_swap_b32 v175, v176
s_nop 1
v_max_f32 v175, v175, v176
v_mov_b32 v176, v175
s_nop 1
v_permlane16_swap_b32 v175, v176
s_nop 1
v_max_f32 v175, v175, v176
v_sub_f32 v174, v172, v175
v_exp_f32 v174, v174
v_mov_b32 v172, v175
v_sub_f32 v160, v160, v172
v_sub_f32 v161, v161, v172
v_sub_f32 v162, v162, v172
v_sub_f32 v163, v163, v172
v_sub_f32 v164, v164, v172
v_sub_f32 v165, v165, v172
v_sub_f32 v166, v166, v172
v_sub_f32 v167, v167, v172
v_exp_f32 v160, v160
v_exp_f32 v161, v161
v_exp_f32 v162, v162
v_exp_f32 v163, v163
v_exp_f32 v164, v164
v_exp_f32 v165, v165
v_exp_f32 v166, v166
v_exp_f32 v167, v167
v_cmp_neq_f32 vcc, 1.0, v174
v_cvt_pk_bf16_f32 v168, v160, v161
v_cvt_pk_bf16_f32 v169, v162, v163
v_cvt_pk_bf16_f32 v170, v164, v165
v_cvt_pk_bf16_f32 v171, v166, v167
s_cbranch_vccz LT_nors
v_accvgpr_read_b32 v180, a0
v_accvgpr_read_b32 v181, a1
v_accvgpr_read_b32 v182, a2
v_accvgpr_read_b32 v183, a3
v_accvgpr_read_b32 v184, a4
v_accvgpr_read_b32 v185, a5
v_accvgpr_read_b32 v186, a6
v_accvgpr_read_b32 v187, a7
v_mul_f32 v180, v180, v174
v_mul_f32 v181, v181, v174
v_mul_f32 v182, v182, v174
v_mul_f32 v183, v183, v174
v_mul_f32 v184, v184, v174
v_mul_f32 v185, v185, v174
v_mul_f32 v186, v186, v174
v_mul_f32 v187, v187, v174
v_accvgpr_write_b32 a0, v180
v_accvgpr_write_b32 a1, v181
v_accvgpr_write_b32 a2, v182
v_accvgpr_write_b32 a3, v183
v_accvgpr_write_b32 a4, v184
v_accvgpr_write_b32 a5, v185
v_accvgpr_write_b32 a6, v186
v_accvgpr_write_b32 a7, v187
v_accvgpr_read_b32 v180, a8
v_accvgpr_read_b32 v181, a9
v_accvgpr_read_b32 v182, a10
v_accvgpr_read_b32 v183, a11
v_accvgpr_read_b32 v184, a12
v_accvgpr_read_b32 v185, a13
v_accvgpr_read_b32 v186, a14
v_accvgpr_read_b32 v187, a15
v_mul_f32 v180, v180, v174
v_mul_f32 v181, v181, v174
v_mul_f32 v182, v182, v174
v_mul_f32 v183, v183, v174
v_mul_f32 v184, v184, v174
v_mul_f32 v185, v185, v174
v_mul_f32 v186, v186, v174
v_mul_f32 v187, v187, v174
v_accvgpr_write_b32 a8, v180
v_accvgpr_write_b32 a9, v181
v_accvgpr_write_b32 a10, v182
v_accvgpr_write_b32 a11, v183
v_accvgpr_write_b32 a12, v184
v_accvgpr_write_b32 a13, v185
v_accvgpr_write_b32 a14, v186
v_accvgpr_write_b32 a15, v187
v_accvgpr_read_b32 v180, a16
v_accvgpr_read_b32 v181, a17
v_accvgpr_read_b32 v182, a18
v_accvgpr_read_b32 v183, a19
v_accvgpr_read_b32 v184, a20
v_accvgpr_read_b32 v185, a21
v_accvgpr_read_b32 v186, a22
v_accvgpr_read_b32 v187, a23
v_mul_f32 v180, v180, v174
v_mul_f32 v181, v181, v174
v_mul_f32 v182, v182, v174
v_mul_f32 v183, v183, v174
v_mul_f32 v184, v184, v174
v_mul_f32 v185, v185, v174
v_mul_f32 v186, v186, v174
v_mul_f32 v187, v187, v174
v_accvgpr_write_b32 a16, v180
v_accvgpr_write_b32 a17, v181
v_accvgpr_write_b32 a18, v182
v_accvgpr_write_b32 a19, v183
v_accvgpr_write_b32 a20, v184
v_accvgpr_write_b32 a21, v185
v_accvgpr_write_b32 a22, v186
v_accvgpr_write_b32 a23, v187
v_accvgpr_read_b32 v180, a24
v_accvgpr_read_b32 v181, a25
v_accvgpr_read_b32 v182, a26
v_accvgpr_read_b32 v183, a27
v_accvgpr_read_b32 v184, a28
v_accvgpr_read_b32 v185, a29
v_accvgpr_read_b32 v186, a30
v_accvgpr_read_b32 v187, a31
v_mul_f32 v180, v180, v174
v_mul_f32 v181, v181, v174
v_mul_f32 v182, v182, v174
v_mul_f32 v183, v183, v174
v_mul_f32 v184, v184, v174
v_mul_f32 v185, v185, v174
v_mul_f32 v186, v186, v174
v_mul_f32 v187, v187, v174
v_accvgpr_write_b32 a24, v180
v_accvgpr_write_b32 a25, v181
v_accvgpr_write_b32 a26, v182
v_accvgpr_write_b32 a27, v183
v_accvgpr_write_b32 a28, v184
v_accvgpr_write_b32 a29, v185
v_accvgpr_write_b32 a30, v186
v_accvgpr_write_b32 a31, v187
v_accvgpr_read_b32 v180, a32
v_accvgpr_read_b32 v181, a33
v_accvgpr_read_b32 v182, a34
v_accvgpr_read_b32 v183, a35
v_accvgpr_read_b32 v184, a36
v_accvgpr_read_b32 v185, a37
v_accvgpr_read_b32 v186, a38
v_accvgpr_read_b32 v187, a39
v_mul_f32 v180, v180, v174
v_mul_f32 v181, v181, v174
v_mul_f32 v182, v182, v174
v_mul_f32 v183, v183, v174
v_mul_f32 v184, v184, v174
v_mul_f32 v185, v185, v174
v_mul_f32 v186, v186, v174
v_mul_f32 v187, v187, v174
v_accvgpr_write_b32 a32, v180
v_accvgpr_write_b32 a33, v181
v_accvgpr_write_b32 a34, v182
v_accvgpr_write_b32 a35, v183
v_accvgpr_write_b32 a36, v184
v_accvgpr_write_b32 a37, v185
v_accvgpr_write_b32 a38, v186
v_accvgpr_write_b32 a39, v187
v_accvgpr_read_b32 v180, a40
v_accvgpr_read_b32 v181, a41
v_accvgpr_read_b32 v182, a42
v_accvgpr_read_b32 v183, a43
v_accvgpr_read_b32 v184, a44
v_accvgpr_read_b32 v185, a45
v_accvgpr_read_b32 v186, a46
v_accvgpr_read_b32 v187, a47
v_mul_f32 v180, v180, v174
v_mul_f32 v181, v181, v174
v_mul_f32 v182, v182, v174
v_mul_f32 v183, v183, v174
v_mul_f32 v184, v184, v174
v_mul_f32 v185, v185, v174
v_mul_f32 v186, v186, v174
v_mul_f32 v187, v187, v174
v_accvgpr_write_b32 a40, v180
v_accvgpr_write_b32 a41, v181
v_accvgpr_write_b32 a42, v182
v_accvgpr_write_b32 a43, v183
v_accvgpr_write_b32 a44, v184
v_accvgpr_write_b32 a45, v185
v_accvgpr_write_b32 a46, v186
v_accvgpr_write_b32 a47, v187
v_accvgpr_read_b32 v180, a48
v_accvgpr_read_b32 v181, a49
v_accvgpr_read_b32 v182, a50
v_accvgpr_read_b32 v183, a51
v_accvgpr_read_b32 v184, a52
v_accvgpr_read_b32 v185, a53
v_accvgpr_read_b32 v186, a54
v_accvgpr_read_b32 v187, a55
v_mul_f32 v180, v180, v174
v_mul_f32 v181, v181, v174
v_mul_f32 v182, v182, v174
v_mul_f32 v183, v183, v174
v_mul_f32 v184, v184, v174
v_mul_f32 v185, v185, v174
v_mul_f32 v186, v186, v174
v_mul_f32 v187, v187, v174
v_accvgpr_write_b32 a48, v180
v_accvgpr_write_b32 a49, v181
v_accvgpr_write_b32 a50, v182
v_accvgpr_write_b32 a51, v183
v_accvgpr_write_b32 a52, v184
v_accvgpr_write_b32 a53, v185
v_accvgpr_write_b32 a54, v186
v_accvgpr_write_b32 a55, v187
v_accvgpr_read_b32 v180, a56
v_accvgpr_read_b32 v181, a57
v_accvgpr_read_b32 v182, a58
v_accvgpr_read_b32 v183, a59
v_accvgpr_read_b32 v184, a60
v_accvgpr_read_b32 v185, a61
v_accvgpr_read_b32 v186, a62
v_accvgpr_read_b32 v187, a63
v_mul_f32 v180, v180, v174
v_mul_f32 v181, v181, v174
v_mul_f32 v182, v182, v174
v_mul_f32 v183, v183, v174
v_mul_f32 v184, v184, v174
v_mul_f32 v185, v185, v174
v_mul_f32 v186, v186, v174
v_mul_f32 v187, v187, v174
v_accvgpr_write_b32 a56, v180
v_accvgpr_write_b32 a57, v181
v_accvgpr_write_b32 a58, v182
v_accvgpr_write_b32 a59, v183
v_accvgpr_write_b32 a60, v184
v_accvgpr_write_b32 a61, v185
v_accvgpr_write_b32 a62, v186
v_accvgpr_write_b32 a63, v187
LT_nors:
s_waitcnt lgkmcnt(0)
s_nop 1
v_mfma_f32_16x16x32_bf16 a[0:3], v[96:99], v[168:171], a[0:3]
v_mfma_f32_16x16x32_bf16 a[4:7], v[100:103], v[168:171], a[4:7]
v_mfma_f32_16x16x32_bf16 a[8:11], v[104:107], v[168:171], a[8:11]
v_mfma_f32_16x16x32_bf16 a[12:15], v[108:111], v[168:171], a[12:15]
v_mfma_f32_16x16x32_bf16 a[16:19], v[112:115], v[168:171], a[16:19]
v_mfma_f32_16x16x32_bf16 a[20:23], v[116:119], v[168:171], a[20:23]
v_mfma_f32_16x16x32_bf16 a[24:27], v[120:123], v[168:171], a[24:27]
v_mfma_f32_16x16x32_bf16 a[28:31], v[124:127], v[168:171], a[28:31]
v_mfma_f32_16x16x32_bf16 a[32:35], v[128:131], v[168:171], a[32:35]
v_mfma_f32_16x16x32_bf16 a[36:39], v[132:135], v[168:171], a[36:39]
v_mfma_f32_16x16x32_bf16 a[40:43], v[136:139], v[168:171], a[40:43]
v_mfma_f32_16x16x32_bf16 a[44:47], v[140:143], v[168:171], a[44:47]
v_mfma_f32_16x16x32_bf16 a[48:51], v[144:147], v[168:171], a[48:51]
v_mfma_f32_16x16x32_bf16 a[52:55], v[148:151], v[168:171], a[52:55]
v_mfma_f32_16x16x32_bf16 a[56:59], v[152:155], v[168:171], a[56:59]
v_mfma_f32_16x16x32_bf16 a[60:63], v[156:159], v[168:171], a[60:63]
s_sub_u32 s51, s51, 1
s_cmp_lg_u32 s51, 0
s_cbranch_scc1 LT_loop
s_nop 15
v_accvgpr_read_b32 v173, a0
v_accvgpr_read_b32 v180, a0
v_accvgpr_read_b32 v181, a1
v_accvgpr_read_b32 v182, a2
v_accvgpr_read_b32 v183, a3
v_accvgpr_read_b32 v184, a4
v_accvgpr_read_b32 v185, a5
v_accvgpr_read_b32 v186, a6
v_accvgpr_read_b32 v187, a7
v_cvt_pk_bf16_f32 v32, v180, v181
v_cvt_pk_bf16_f32 v33, v182, v183
v_cvt_pk_bf16_f32 v34, v184, v185
v_cvt_pk_bf16_f32 v35, v186, v187
buffer_store_dwordx4 v[32:35], v252, s[20:23], s40 offen offset:0 sc1
v_accvgpr_read_b32 v180, a8
v_accvgpr_read_b32 v181, a9
v_accvgpr_read_b32 v182, a10
v_accvgpr_read_b32 v183, a11
v_accvgpr_read_b32 v184, a12
v_accvgpr_read_b32 v185, a13
v_accvgpr_read_b32 v186, a14
v_accvgpr_read_b32 v187, a15
v_cvt_pk_bf16_f32 v36, v180, v181
v_cvt_pk_bf16_f32 v37, v182, v183
v_cvt_pk_bf16_f32 v38, v184, v185
v_cvt_pk_bf16_f32 v39, v186, v187
buffer_store_dwordx4 v[36:39], v252, s[20:23], s40 offen offset:1024 sc1
v_accvgpr_read_b32 v180, a16
v_accvgpr_read_b32 v181, a17
v_accvgpr_read_b32 v182, a18
v_accvgpr_read_b32 v183, a19
v_accvgpr_read_b32 v184, a20
v_accvgpr_read_b32 v185, a21
v_accvgpr_read_b32 v186, a22
v_accvgpr_read_b32 v187, a23
v_cvt_pk_bf16_f32 v40, v180, v181
v_cvt_pk_bf16_f32 v41, v182, v183
v_cvt_pk_bf16_f32 v42, v184, v185
v_cvt_pk_bf16_f32 v43, v186, v187
buffer_store_dwordx4 v[40:43], v252, s[20:23], s40 offen offset:2048 sc1
v_accvgpr_read_b32 v180, a24
v_accvgpr_read_b32 v181, a25
v_accvgpr_read_b32 v182, a26
v_accvgpr_read_b32 v183, a27
v_accvgpr_read_b32 v184, a28
v_accvgpr_read_b32 v185, a29
v_accvgpr_read_b32 v186, a30
v_accvgpr_read_b32 v187, a31
v_cvt_pk_bf16_f32 v44, v180, v181
v_cvt_pk_bf16_f32 v45, v182, v183
v_cvt_pk_bf16_f32 v46, v184, v185
v_cvt_pk_bf16_f32 v47, v186, v187
buffer_store_dwordx4 v[44:47], v252, s[20:23], s40 offen offset:3072 sc1
v_accvgpr_read_b32 v180, a32
v_accvgpr_read_b32 v181, a33
v_accvgpr_read_b32 v182, a34
v_accvgpr_read_b32 v183, a35
v_accvgpr_read_b32 v184, a36
v_accvgpr_read_b32 v185, a37
v_accvgpr_read_b32 v186, a38
v_accvgpr_read_b32 v187, a39
v_cvt_pk_bf16_f32 v48, v180, v181
v_cvt_pk_bf16_f32 v49, v182, v183
v_cvt_pk_bf16_f32 v50, v184, v185
v_cvt_pk_bf16_f32 v51, v186, v187
buffer_store_dwordx4 v[48:51], v252, s[20:23], s44 offen offset:0 sc1
v_accvgpr_read_b32 v180, a40
v_accvgpr_read_b32 v181, a41
v_accvgpr_read_b32 v182, a42
v_accvgpr_read_b32 v183, a43
v_accvgpr_read_b32 v184, a44
v_accvgpr_read_b32 v185, a45
v_accvgpr_read_b32 v186, a46
v_accvgpr_read_b32 v187, a47
v_cvt_pk_bf16_f32 v52, v180, v181
v_cvt_pk_bf16_f32 v53, v182, v183
v_cvt_pk_bf16_f32 v54, v184, v185
v_cvt_pk_bf16_f32 v55, v186, v187
buffer_store_dwordx4 v[52:55], v252, s[20:23], s44 offen offset:1024 sc1
v_accvgpr_read_b32 v180, a48
v_accvgpr_read_b32 v181, a49
v_accvgpr_read_b32 v182, a50
v_accvgpr_read_b32 v183, a51
v_accvgpr_read_b32 v184, a52
v_accvgpr_read_b32 v185, a53
v_accvgpr_read_b32 v186, a54
v_accvgpr_read_b32 v187, a55
v_cvt_pk_bf16_f32 v56, v180, v181
v_cvt_pk_bf16_f32 v57, v182, v183
v_cvt_pk_bf16_f32 v58, v184, v185
v_cvt_pk_bf16_f32 v59, v186, v187
buffer_store_dwordx4 v[56:59], v252, s[20:23], s44 offen offset:2048 sc1
v_accvgpr_read_b32 v180, a56
v_accvgpr_read_b32 v181, a57
v_accvgpr_read_b32 v182, a58
v_accvgpr_read_b32 v183, a59
v_accvgpr_read_b32 v184, a60
v_accvgpr_read_b32 v185, a61
v_accvgpr_read_b32 v186, a62
v_accvgpr_read_b32 v187, a63
v_cvt_pk_bf16_f32 v60, v180, v181
v_cvt_pk_bf16_f32 v61, v182, v183
v_cvt_pk_bf16_f32 v62, v184, v185
v_cvt_pk_bf16_f32 v63, v186, v187
buffer_store_dwordx4 v[60:63], v252, s[20:23], s44 offen offset:3072 sc1
v_lshlrev_b32 v175, 2, v252
s_mov_b64 exec, 0xffff
buffer_store_dwordx2 v[172:173], v175, s[24:27], s48 offen sc1
s_mov_b64 exec, -1
s_waitcnt vmcnt(0)
s_add_u32 s40, s40, 8192
s_add_u32 s48, s48, 1024
s_sub_u32 s55, s55, 1
s_cmp_lg_u32 s55, 0
s_cbranch_scc1 LT_q
s_add_u32 s52, s4, 0x7c00000
s_addc_u32 s53, s5, 0
s_mov_b32 s54, 0x2000
s_mov_b32 s55, 0x00020000
v_mov_b32 v1, 4992
v_mov_b32 v2, 1
s_mov_b64 exec, 1
s_waitcnt vmcnt(0)
buffer_atomic_add v2, v1, s[52:55], 0 offen
s_mov_b64 exec, -1
s_branch L2_fin
LE_start:
s_cmp_ge_u32 s37, 32
s_cbranch_scc1 L2_end
v_lshrrev_b32 v1, 6, v0
s_sub_u32 s37, s37, 30
s_lshl_b32 s35, s35, 1
v_readfirstlane_b32 s41, v1
s_add_u32 s35, s35, s37
s_mul_i32 s35, s35, 3
s_add_u32 s40, s35, s41
s_cmp_ge_u32 s41, 3
s_cbranch_scc1 LC_help
LE_common:
v_and_b32 v1, 63, v0
s_mul_i32 s58, s40, 167
s_mov_b32 s59, 167
s_mov_b32 s42, 0
s_mov_b32 s49, 512
v_lshrrev_b32 v33, 1, v1
v_and_b32 v34, 1, v1
v_mul_u32_u24 v6, 0x5000, v33
v_lshl_add_u32 v6, v34, 4, v6
v_lshlrev_b32 v33, 2, v33
s_mul_i32 s50, s40, 655360
s_mul_i32 s48, s40, 128
s_waitcnt lgkmcnt(0)
s_add_u32 s8, s4, 0x7800000
s_addc_u32 s9, s5, 0
s_mov_b32 s10, 0x2000
s_mov_b32 s11, 0x00020000
s_add_u32 s12, s4, 0x8000000
s_addc_u32 s13, s5, 0
s_mov_b32 s14, 0x2800000
s_mov_b32 s15, 0x00020000
buffer_load_dword v4, v33, s[8:11], s48 offen
buffer_load_dwordx4 v[192:195], v6, s[12:15], s50 offen offset:0
buffer_load_dwordx4 v[196:199], v6, s[12:15], s50 offen offset:32
buffer_load_dwordx4 v[200:203], v6, s[12:15], s50 offen offset:64
buffer_load_dwordx4 v[204:207], v6, s[12:15], s50 offen offset:96
buffer_load_dwordx4 v[208:211], v6, s[12:15], s50 offen offset:128
buffer_load_dwordx4 v[212:215], v6, s[12:15], s50 offen offset:160
buffer_load_dwordx4 v[216:219], v6, s[12:15], s50 offen offset:192
buffer_load_dwordx4 v[220:223], v6, s[12:15], s50 offen offset:224
buffer_load_dwordx4 v[224:227], v6, s[12:15], s50 offen offset:256
buffer_load_dwordx4 v[228:231], v6, s[12:15], s50 offen offset:288
buffer_load_dwordx4 v[232:235], v6, s[12:15], s50 offen offset:320
buffer_load_dwordx4 v[236:239], v6, s[12:15], s50 offen offset:352
buffer_load_dwordx4 v[240:243], v6, s[12:15], s50 offen offset:384
buffer_load_dwordx4 v[244:247], v6, s[12:15], s50 offen offset:416
buffer_load_dwordx4 v[248:251], v6, s[12:15], s50 offen offset:448
buffer_load_dwordx4 v[252:255], v6, s[12:15], s50 offen offset:480
s_add_u32 s16, s16, 0x0
s_addc_u32 s17, s17, 0
s_mov_b32 s18, 0x4e20
s_mov_b32 s19, 0x00020000
v_lshlrev_b32 v35, 1, v1
s_lshl_b32 s48, s58, 1
buffer_load_ushort v76, v35, s[16:19], s48 offen offset:0
buffer_load_ushort v77, v35, s[16:19], s48 offen offset:128
buffer_load_ushort v78, v35, s[16:19], s48 offen offset:256
s_add_u32 s16, s4, 0x6800000
s_addc_u32 s17, s5, 0
s_mov_b32 s18, 0x4e2000
s_mov_b32 s19, 0x00020000
s_add_u32 s20, s4, 0x7000000
s_addc_u32 s21, s5, 0
s_mov_b32 s22, 0x4e2000
s_mov_b32 s23, 0x00020000
v_lshlrev_b32 v5, 2, v34
v_and_b32 v2, 15, v1
v_lshrrev_b32 v3, 4, v1
v_mov_b32 v16, 1
v_mov_b32 v17, 4
v_and_b32 v33, 1, v2
v_lshlrev_b32 v33, 4, v33
v_lshlrev_b32 v33, v33, v16
v_mul_u32_u24 v33, 0x3f80, v33
v_lshrrev_b32 v34, 1, v2
v_cmp_eq_u32 vcc, 0, v34
s_nop 1
v_cndmask_b32 v40, 0, v33, vcc
v_cmp_eq_u32 vcc, 1, v34
s_nop 1
v_cndmask_b32 v41, 0, v33, vcc
v_cmp_eq_u32 vcc, 2, v34
s_nop 1
v_cndmask_b32 v42, 0, v33, vcc
v_cmp_eq_u32 vcc, 3, v34
s_nop 1
v_cndmask_b32 v43, 0, v33, vcc
v_cmp_eq_u32 vcc, 4, v34
s_nop 1
v_cndmask_b32 v44, 0, v33, vcc
v_cmp_eq_u32 vcc, 5, v34
s_nop 1
v_cndmask_b32 v45, 0, v33, vcc
v_cmp_eq_u32 vcc, 6, v34
s_nop 1
v_cndmask_b32 v46, 0, v33, vcc
v_cmp_eq_u32 vcc, 7, v34
s_nop 1
v_cndmask_b32 v47, 0, v33, vcc
v_lshlrev_b32 v39, 5, v2
v_lshl_add_u32 v39, v3, 3, v39
v_lshlrev_b32 v2, 4, v2
s_mul_i32 s48, s41, 21504
s_add_u32 s48, s48, 4096
v_mov_b32 v36, s48
v_lshl_add_u32 v38, v3, 2, v36
s_lshl_b32 s36, s41, 10
v_mov_b32 v7, s36
v_lshlrev_b32 v35, 4, v1
v_add_u32 v68, s48, v35
v_add_u32 v35, s36, v35
v_lshlrev_b32 v33, 2, v1
v_mov_b32 v72, 0xffff
v_mov_b32 v73, 0xffff
v_mov_b32 v74, 0xffff
v_mov_b32 v75, 0xffff
s_sub_u32 s36, s59, 0
v_cmp_gt_u32 vcc, s36, v33
v_mov_b32 v48, 0
s_nop 0
v_cndmask_b32 v18, 0, v16, vcc
s_sub_u32 s36, s59, 1
v_cmp_gt_u32 vcc, s36, v33
v_mov_b32 v49, 0
s_nop 0
v_cndmask_b32 v19, 0, v16, vcc
s_sub_u32 s36, s59, 2
v_cmp_gt_u32 vcc, s36, v33
v_mov_b32 v50, 0
s_nop 0
v_cndmask_b32 v20, 0, v16, vcc
s_sub_u32 s36, s59, 3
v_cmp_gt_u32 vcc, s36, v33
v_mov_b32 v51, 0
s_nop 0
v_cndmask_b32 v21, 0, v16, vcc
LE_pass:
ds_write_b128 v35, v[48:51]
ds_write_b128 v68, v[72:75] offset:0
ds_write_b128 v68, v[72:75] offset:1024
ds_write_b128 v68, v[72:75] offset:2048
ds_write_b128 v68, v[72:75] offset:3072
ds_write_b128 v68, v[72:75] offset:4096
ds_write_b128 v68, v[72:75] offset:5120
ds_write_b128 v68, v[72:75] offset:6144
ds_write_b128 v68, v[72:75] offset:7168
ds_write_b128 v68, v[72:75] offset:8192
ds_write_b128 v68, v[72:75] offset:9216
ds_write_b128 v68, v[72:75] offset:10240
ds_write_b128 v68, v[72:75] offset:11264
ds_write_b128 v68, v[72:75] offset:12288
ds_write_b128 v68, v[72:75] offset:13312
ds_write_b128 v68, v[72:75] offset:14336
ds_write_b128 v68, v[72:75] offset:15360
ds_write_b128 v68, v[72:75] offset:16384
ds_write_b128 v68, v[72:75] offset:17408
ds_write_b128 v68, v[72:75] offset:18432
ds_write_b128 v68, v[72:75] offset:19456
v_lshl_add_u32 v32, v1, 2, v36
ds_write_b32 v32, v48 offset:20480
s_waitcnt vmcnt(19)
v_sub_u32 v32, v4, v5
s_waitcnt vmcnt(15)
v_cmpx_lt_i32 vcc, 0, v32
s_cbranch_execz LE_c
v_mad_u32_u16 v128, v192, 1, v7 op_sel:[1,0,0,0]
ds_add_u32 v128, v16
v_cmpx_lt_i32 vcc, 1, v32
v_mad_u32_u16 v129, v193, 1, v7 op_sel:[1,0,0,0]
ds_add_u32 v129, v16
v_cmpx_lt_i32 vcc, 2, v32
v_mad_u32_u16 v130, v194, 1, v7 op_sel:[1,0,0,0]
ds_add_u32 v130, v16
v_cmpx_lt_i32 vcc, 3, v32
v_mad_u32_u16 v131, v195, 1, v7 op_sel:[1,0,0,0]
ds_add_u32 v131, v16
s_waitcnt vmcnt(14)
v_cmpx_lt_i32 vcc, 8, v32
s_cbranch_execz LE_c
v_mad_u32_u16 v132, v196, 1, v7 op_sel:[1,0,0,0]
ds_add_u32 v132, v16
v_cmpx_lt_i32 vcc, 9, v32
v_mad_u32_u16 v133, v197, 1, v7 op_sel:[1,0,0,0]
ds_add_u32 v133, v16
v_cmpx_lt_i32 vcc, 10, v32
v_mad_u32_u16 v134, v198, 1, v7 op_sel:[1,0,0,0]
ds_add_u32 v134, v16
v_cmpx_lt_i32 vcc, 11, v32
v_mad_u32_u16 v135, v199, 1, v7 op_sel:[1,0,0,0]
ds_add_u32 v135, v16
s_waitcnt vmcnt(13)
v_cmpx_lt_i32 vcc, 16, v32
s_cbranch_execz LE_c
v_mad_u32_u16 v136, v200, 1, v7 op_sel:[1,0,0,0]
ds_add_u32 v136, v16
v_cmpx_lt_i32 vcc, 17, v32
v_mad_u32_u16 v137, v201, 1, v7 op_sel:[1,0,0,0]
ds_add_u32 v137, v16
v_cmpx_lt_i32 vcc, 18, v32
v_mad_u32_u16 v138, v202, 1, v7 op_sel:[1,0,0,0]
ds_add_u32 v138, v16
v_cmpx_lt_i32 vcc, 19, v32
v_mad_u32_u16 v139, v203, 1, v7 op_sel:[1,0,0,0]
ds_add_u32 v139, v16
s_waitcnt vmcnt(12)
v_cmpx_lt_i32 vcc, 24, v32
s_cbranch_execz LE_c
v_mad_u32_u16 v140, v204, 1, v7 op_sel:[1,0,0,0]
ds_add_u32 v140, v16
v_cmpx_lt_i32 vcc, 25, v32
v_mad_u32_u16 v141, v205, 1, v7 op_sel:[1,0,0,0]
ds_add_u32 v141, v16
v_cmpx_lt_i32 vcc, 26, v32
v_mad_u32_u16 v142, v206, 1, v7 op_sel:[1,0,0,0]
ds_add_u32 v142, v16
v_cmpx_lt_i32 vcc, 27, v32
v_mad_u32_u16 v143, v207, 1, v7 op_sel:[1,0,0,0]
ds_add_u32 v143, v16
s_waitcnt vmcnt(11)
v_cmpx_lt_i32 vcc, 32, v32
s_cbranch_execz LE_c
v_mad_u32_u16 v144, v208, 1, v7 op_sel:[1,0,0,0]
ds_add_u32 v144, v16
v_cmpx_lt_i32 vcc, 33, v32
v_mad_u32_u16 v145, v209, 1, v7 op_sel:[1,0,0,0]
ds_add_u32 v145, v16
v_cmpx_lt_i32 vcc, 34, v32
v_mad_u32_u16 v146, v210, 1, v7 op_sel:[1,0,0,0]
ds_add_u32 v146, v16
v_cmpx_lt_i32 vcc, 35, v32
v_mad_u32_u16 v147, v211, 1, v7 op_sel:[1,0,0,0]
ds_add_u32 v147, v16
s_waitcnt vmcnt(10)
v_cmpx_lt_i32 vcc, 40, v32
s_cbranch_execz LE_c
v_mad_u32_u16 v148, v212, 1, v7 op_sel:[1,0,0,0]
ds_add_u32 v148, v16
v_cmpx_lt_i32 vcc, 41, v32
v_mad_u32_u16 v149, v213, 1, v7 op_sel:[1,0,0,0]
ds_add_u32 v149, v16
v_cmpx_lt_i32 vcc, 42, v32
v_mad_u32_u16 v150, v214, 1, v7 op_sel:[1,0,0,0]
ds_add_u32 v150, v16
v_cmpx_lt_i32 vcc, 43, v32
v_mad_u32_u16 v151, v215, 1, v7 op_sel:[1,0,0,0]
ds_add_u32 v151, v16
s_waitcnt vmcnt(9)
v_cmpx_lt_i32 vcc, 48, v32
s_cbranch_execz LE_c
v_mad_u32_u16 v152, v216, 1, v7 op_sel:[1,0,0,0]
ds_add_u32 v152, v16
v_cmpx_lt_i32 vcc, 49, v32
v_mad_u32_u16 v153, v217, 1, v7 op_sel:[1,0,0,0]
ds_add_u32 v153, v16
v_cmpx_lt_i32 vcc, 50, v32
v_mad_u32_u16 v154, v218, 1, v7 op_sel:[1,0,0,0]
ds_add_u32 v154, v16
v_cmpx_lt_i32 vcc, 51, v32
v_mad_u32_u16 v155, v219, 1, v7 op_sel:[1,0,0,0]
ds_add_u32 v155, v16
s_waitcnt vmcnt(8)
v_cmpx_lt_i32 vcc, 56, v32
s_cbranch_execz LE_c
v_mad_u32_u16 v156, v220, 1, v7 op_sel:[1,0,0,0]
ds_add_u32 v156, v16
v_cmpx_lt_i32 vcc, 57, v32
v_mad_u32_u16 v157, v221, 1, v7 op_sel:[1,0,0,0]
ds_add_u32 v157, v16
v_cmpx_lt_i32 vcc, 58, v32
v_mad_u32_u16 v158, v222, 1, v7 op_sel:[1,0,0,0]
ds_add_u32 v158, v16
v_cmpx_lt_i32 vcc, 59, v32
v_mad_u32_u16 v159, v223, 1, v7 op_sel:[1,0,0,0]
ds_add_u32 v159, v16
s_waitcnt vmcnt(7)
v_cmpx_lt_i32 vcc, 64, v32
s_cbranch_execz LE_c
v_mad_u32_u16 v160, v224, 1, v7 op_sel:[1,0,0,0]
ds_add_u32 v160, v16
v_cmpx_lt_i32 vcc, 65, v32
v_mad_u32_u16 v161, v225, 1, v7 op_sel:[1,0,0,0]
ds_add_u32 v161, v16
v_cmpx_lt_i32 vcc, 66, v32
v_mad_u32_u16 v162, v226, 1, v7 op_sel:[1,0,0,0]
ds_add_u32 v162, v16
v_cmpx_lt_i32 vcc, 67, v32
v_mad_u32_u16 v163, v227, 1, v7 op_sel:[1,0,0,0]
ds_add_u32 v163, v16
s_waitcnt vmcnt(6)
v_cmpx_lt_i32 vcc, 72, v32
s_cbranch_execz LE_c
v_mad_u32_u16 v164, v228, 1, v7 op_sel:[1,0,0,0]
ds_add_u32 v164, v16
v_cmpx_lt_i32 vcc, 73, v32
v_mad_u32_u16 v165, v229, 1, v7 op_sel:[1,0,0,0]
ds_add_u32 v165, v16
v_cmpx_lt_i32 vcc, 74, v32
v_mad_u32_u16 v166, v230, 1, v7 op_sel:[1,0,0,0]
ds_add_u32 v166, v16
v_cmpx_lt_i32 vcc, 75, v32
v_mad_u32_u16 v167, v231, 1, v7 op_sel:[1,0,0,0]
ds_add_u32 v167, v16
s_waitcnt vmcnt(5)
v_cmpx_lt_i32 vcc, 80, v32
s_cbranch_execz LE_c
v_mad_u32_u16 v168, v232, 1, v7 op_sel:[1,0,0,0]
ds_add_u32 v168, v16
v_cmpx_lt_i32 vcc, 81, v32
v_mad_u32_u16 v169, v233, 1, v7 op_sel:[1,0,0,0]
ds_add_u32 v169, v16
v_cmpx_lt_i32 vcc, 82, v32
v_mad_u32_u16 v170, v234, 1, v7 op_sel:[1,0,0,0]
ds_add_u32 v170, v16
v_cmpx_lt_i32 vcc, 83, v32
v_mad_u32_u16 v171, v235, 1, v7 op_sel:[1,0,0,0]
ds_add_u32 v171, v16
s_waitcnt vmcnt(4)
v_cmpx_lt_i32 vcc, 88, v32
s_cbranch_execz LE_c
v_mad_u32_u16 v172, v236, 1, v7 op_sel:[1,0,0,0]
ds_add_u32 v172, v16
v_cmpx_lt_i32 vcc, 89, v32
v_mad_u32_u16 v173, v237, 1, v7 op_sel:[1,0,0,0]
ds_add_u32 v173, v16
v_cmpx_lt_i32 vcc, 90, v32
v_mad_u32_u16 v174, v238, 1, v7 op_sel:[1,0,0,0]
ds_add_u32 v174, v16
v_cmpx_lt_i32 vcc, 91, v32
v_mad_u32_u16 v175, v239, 1, v7 op_sel:[1,0,0,0]
ds_add_u32 v175, v16
s_waitcnt vmcnt(3)
v_cmpx_lt_i32 vcc, 96, v32
s_cbranch_execz LE_c
v_mad_u32_u16 v176, v240, 1, v7 op_sel:[1,0,0,0]
ds_add_u32 v176, v16
v_cmpx_lt_i32 vcc, 97, v32
v_mad_u32_u16 v177, v241, 1, v7 op_sel:[1,0,0,0]
ds_add_u32 v177, v16
v_cmpx_lt_i32 vcc, 98, v32
v_mad_u32_u16 v178, v242, 1, v7 op_sel:[1,0,0,0]
ds_add_u32 v178, v16
v_cmpx_lt_i32 vcc, 99, v32
v_mad_u32_u16 v179, v243, 1, v7 op_sel:[1,0,0,0]
ds_add_u32 v179, v16
s_waitcnt vmcnt(2)
v_cmpx_lt_i32 vcc, 104, v32
s_cbranch_execz LE_c
v_mad_u32_u16 v180, v244, 1, v7 op_sel:[1,0,0,0]
ds_add_u32 v180, v16
v_cmpx_lt_i32 vcc, 105, v32
v_mad_u32_u16 v181, v245, 1, v7 op_sel:[1,0,0,0]
ds_add_u32 v181, v16
v_cmpx_lt_i32 vcc, 106, v32
v_mad_u32_u16 v182, v246, 1, v7 op_sel:[1,0,0,0]
ds_add_u32 v182, v16
v_cmpx_lt_i32 vcc, 107, v32
v_mad_u32_u16 v183, v247, 1, v7 op_sel:[1,0,0,0]
ds_add_u32 v183, v16
s_waitcnt vmcnt(1)
v_cmpx_lt_i32 vcc, 112, v32
s_cbranch_execz LE_c
v_mad_u32_u16 v184, v248, 1, v7 op_sel:[1,0,0,0]
ds_add_u32 v184, v16
v_cmpx_lt_i32 vcc, 113, v32
v_mad_u32_u16 v185, v249, 1, v7 op_sel:[1,0,0,0]
ds_add_u32 v185, v16
v_cmpx_lt_i32 vcc, 114, v32
v_mad_u32_u16 v186, v250, 1, v7 op_sel:[1,0,0,0]
ds_add_u32 v186, v16
v_cmpx_lt_i32 vcc, 115, v32
v_mad_u32_u16 v187, v251, 1, v7 op_sel:[1,0,0,0]
ds_add_u32 v187, v16
s_waitcnt vmcnt(0)
v_cmpx_lt_i32 vcc, 120, v32
s_cbranch_execz LE_c
v_mad_u32_u16 v188, v252, 1, v7 op_sel:[1,0,0,0]
ds_add_u32 v188, v16
v_cmpx_lt_i32 vcc, 121, v32
v_mad_u32_u16 v189, v253, 1, v7 op_sel:[1,0,0,0]
ds_add_u32 v189, v16
v_cmpx_lt_i32 vcc, 122, v32
v_mad_u32_u16 v190, v254, 1, v7 op_sel:[1,0,0,0]
ds_add_u32 v190, v16
v_cmpx_lt_i32 vcc, 123, v32
v_mad_u32_u16 v191, v255, 1, v7 op_sel:[1,0,0,0]
ds_add_u32 v191, v16
LE_c:
s_mov_b64 exec, -1
ds_read_b128 v[24:27], v35
s_waitcnt lgkmcnt(0)
v_add_u32 v24, 3, v24
v_lshrrev_b32 v24, 2, v24
v_max_u32 v24, v24, v18
v_add_u32 v25, 3, v25
v_lshrrev_b32 v25, 2, v25
v_max_u32 v25, v25, v19
v_add_u32 v26, 3, v26
v_lshrrev_b32 v26, 2, v26
v_max_u32 v26, v26, v20
v_add_u32 v27, 3, v27
v_lshrrev_b32 v27, 2, v27
v_max_u32 v27, v27, v21
v_add_u32 v33, v24, v25
v_add3_u32 v33, v33, v26, v27
v_mov_b32 v64, v33
s_nop 1
v_add_u32_dpp v64, v64, v64 row_shr:1 row_mask:0xf bank_mask:0xf
s_nop 1
v_add_u32_dpp v64, v64, v64 row_shr:2 row_mask:0xf bank_mask:0xf
s_nop 1
v_add_u32_dpp v64, v64, v64 row_shr:4 row_mask:0xf bank_mask:0xf
s_nop 1
v_add_u32_dpp v64, v64, v64 row_shr:8 row_mask:0xf bank_mask:0xf
s_nop 1
v_add_u32_dpp v64, v64, v64 row_bcast:15 row_mask:0xa bank_mask:0xf
s_nop 1
v_add_u32_dpp v64, v64, v64 row_bcast:31 row_mask:0xc bank_mask:0xf
s_nop 1
v_readlane_b32 s44, v64, 63
v_sub_u32 v28, v64, v33
v_add_u32 v29, v28, v24
v_add_u32 v30, v29, v25
v_add_u32 v31, v30, v26
v_add3_u32 v33, v28, v24, -1
v_lshlrev_b32 v34, v33, v18
v_lshrrev_b32 v33, 5, v33
v_lshl_add_u32 v33, v33, 2, v36
ds_or_b32 v33, v34 offset:20480
v_lshl_add_u32 v28, v28, 4, v36
v_add3_u32 v33, v29, v25, -1
v_lshlrev_b32 v34, v33, v19
v_lshrrev_b32 v33, 5, v33
v_lshl_add_u32 v33, v33, 2, v36
ds_or_b32 v33, v34 offset:20480
v_lshl_add_u32 v29, v29, 4, v36
v_add3_u32 v33, v30, v26, -1
v_lshlrev_b32 v34, v33, v20
v_lshrrev_b32 v33, 5, v33
v_lshl_add_u32 v33, v33, 2, v36
ds_or_b32 v33, v34 offset:20480
v_lshl_add_u32 v30, v30, 4, v36
v_add3_u32 v33, v31, v27, -1
v_lshlrev_b32 v34, v33, v21
v_lshrrev_b32 v33, 5, v33
v_lshl_add_u32 v33, v33, 2, v36
ds_or_b32 v33, v34 offset:20480
v_lshl_add_u32 v31, v31, 4, v36
ds_write_b128 v35, v[28:31]
s_add_u32 s44, s44, 31
s_lshr_b32 s44, s44, 5
v_cmpx_lt_i32 vcc, 0, v32
s_cbranch_execz LE_p
ds_add_rtn_u32 v128, v128, v17
v_cmpx_lt_i32 vcc, 1, v32
ds_add_rtn_u32 v129, v129, v17
v_cmpx_lt_i32 vcc, 2, v32
ds_add_rtn_u32 v130, v130, v17
v_cmpx_lt_i32 vcc, 3, v32
ds_add_rtn_u32 v131, v131, v17
v_cmpx_lt_i32 vcc, 8, v32
s_cbranch_execz LE_p
ds_add_rtn_u32 v132, v132, v17
v_cmpx_lt_i32 vcc, 9, v32
ds_add_rtn_u32 v133, v133, v17
v_cmpx_lt_i32 vcc, 10, v32
ds_add_rtn_u32 v134, v134, v17
v_cmpx_lt_i32 vcc, 11, v32
ds_add_rtn_u32 v135, v135, v17
v_cmpx_lt_i32 vcc, 16, v32
s_cbranch_execz LE_p
ds_add_rtn_u32 v136, v136, v17
v_cmpx_lt_i32 vcc, 17, v32
ds_add_rtn_u32 v137, v137, v17
v_cmpx_lt_i32 vcc, 18, v32
ds_add_rtn_u32 v138, v138, v17
v_cmpx_lt_i32 vcc, 19, v32
ds_add_rtn_u32 v139, v139, v17
v_cmpx_lt_i32 vcc, 24, v32
s_cbranch_execz LE_p
ds_add_rtn_u32 v140, v140, v17
v_cmpx_lt_i32 vcc, 25, v32
ds_add_rtn_u32 v141, v141, v17
v_cmpx_lt_i32 vcc, 26, v32
ds_add_rtn_u32 v142, v142, v17
v_cmpx_lt_i32 vcc, 27, v32
ds_add_rtn_u32 v143, v143, v17
v_cmpx_lt_i32 vcc, 32, v32
s_cbranch_execz LE_p
ds_add_rtn_u32 v144, v144, v17
v_cmpx_lt_i32 vcc, 33, v32
ds_add_rtn_u32 v145, v145, v17
v_cmpx_lt_i32 vcc, 34, v32
ds_add_rtn_u32 v146, v146, v17
v_cmpx_lt_i32 vcc, 35, v32
ds_add_rtn_u32 v147, v147, v17
v_cmpx_lt_i32 vcc, 40, v32
s_cbranch_execz LE_p
ds_add_rtn_u32 v148, v148, v17
v_cmpx_lt_i32 vcc, 41, v32
ds_add_rtn_u32 v149, v149, v17
v_cmpx_lt_i32 vcc, 42, v32
ds_add_rtn_u32 v150, v150, v17
v_cmpx_lt_i32 vcc, 43, v32
ds_add_rtn_u32 v151, v151, v17
v_cmpx_lt_i32 vcc, 48, v32
s_cbranch_execz LE_p
ds_add_rtn_u32 v152, v152, v17
v_cmpx_lt_i32 vcc, 49, v32
ds_add_rtn_u32 v153, v153, v17
v_cmpx_lt_i32 vcc, 50, v32
ds_add_rtn_u32 v154, v154, v17
v_cmpx_lt_i32 vcc, 51, v32
ds_add_rtn_u32 v155, v155, v17
v_cmpx_lt_i32 vcc, 56, v32
s_cbranch_execz LE_p
ds_add_rtn_u32 v156, v156, v17
v_cmpx_lt_i32 vcc, 57, v32
ds_add_rtn_u32 v157, v157, v17
v_cmpx_lt_i32 vcc, 58, v32
ds_add_rtn_u32 v158, v158, v17
v_cmpx_lt_i32 vcc, 59, v32
ds_add_rtn_u32 v159, v159, v17
v_cmpx_lt_i32 vcc, 64, v32
s_cbranch_execz LE_p
ds_add_rtn_u32 v160, v160, v17
v_cmpx_lt_i32 vcc, 65, v32
ds_add_rtn_u32 v161, v161, v17
v_cmpx_lt_i32 vcc, 66, v32
ds_add_rtn_u32 v162, v162, v17
v_cmpx_lt_i32 vcc, 67, v32
ds_add_rtn_u32 v163, v163, v17
v_cmpx_lt_i32 vcc, 72, v32
s_cbranch_execz LE_p
ds_add_rtn_u32 v164, v164, v17
v_cmpx_lt_i32 vcc, 73, v32
ds_add_rtn_u32 v165, v165, v17
v_cmpx_lt_i32 vcc, 74, v32
ds_add_rtn_u32 v166, v166, v17
v_cmpx_lt_i32 vcc, 75, v32
ds_add_rtn_u32 v167, v167, v17
v_cmpx_lt_i32 vcc, 80, v32
s_cbranch_execz LE_p
ds_add_rtn_u32 v168, v168, v17
v_cmpx_lt_i32 vcc, 81, v32
ds_add_rtn_u32 v169, v169, v17
v_cmpx_lt_i32 vcc, 82, v32
ds_add_rtn_u32 v170, v170, v17
v_cmpx_lt_i32 vcc, 83, v32
ds_add_rtn_u32 v171, v171, v17
v_cmpx_lt_i32 vcc, 88, v32
s_cbranch_execz LE_p
ds_add_rtn_u32 v172, v172, v17
v_cmpx_lt_i32 vcc, 89, v32
ds_add_rtn_u32 v173, v173, v17
v_cmpx_lt_i32 vcc, 90, v32
ds_add_rtn_u32 v174, v174, v17
v_cmpx_lt_i32 vcc, 91, v32
ds_add_rtn_u32 v175, v175, v17
v_cmpx_lt_i32 vcc, 96, v32
s_cbranch_execz LE_p
ds_add_rtn_u32 v176, v176, v17
v_cmpx_lt_i32 vcc, 97, v32
ds_add_rtn_u32 v177, v177, v17
v_cmpx_lt_i32 vcc, 98, v32
ds_add_rtn_u32 v178, v178, v17
v_cmpx_lt_i32 vcc, 99, v32
ds_add_rtn_u32 v179, v179, v17
v_cmpx_lt_i32 vcc, 104, v32
s_cbranch_execz LE_p
ds_add_rtn_u32 v180, v180, v17
v_cmpx_lt_i32 vcc, 105, v32
ds_add_rtn_u32 v181, v181, v17
v_cmpx_lt_i32 vcc, 106, v32
ds_add_rtn_u32 v182, v182, v17
v_cmpx_lt_i32 vcc, 107, v32
ds_add_rtn_u32 v183, v183, v17
v_cmpx_lt_i32 vcc, 112, v32
s_cbranch_execz LE_p
ds_add_rtn_u32 v184, v184, v17
v_cmpx_lt_i32 vcc, 113, v32
ds_add_rtn_u32 v185, v185, v17
v_cmpx_lt_i32 vcc, 114, v32
ds_add_rtn_u32 v186, v186, v17
v_cmpx_lt_i32 vcc, 115, v32
ds_add_rtn_u32 v187, v187, v17
v_cmpx_lt_i32 vcc, 120, v32
s_cbranch_execz LE_p
ds_add_rtn_u32 v188, v188, v17
v_cmpx_lt_i32 vcc, 121, v32
ds_add_rtn_u32 v189, v189, v17
v_cmpx_lt_i32 vcc, 122, v32
ds_add_rtn_u32 v190, v190, v17
v_cmpx_lt_i32 vcc, 123, v32
ds_add_rtn_u32 v191, v191, v17
LE_p:
s_mov_b64 exec, -1
v_lshl_add_u32 v33, v1, 2, v36
ds_read_b32 v37, v33 offset:20480
s_waitcnt lgkmcnt(0)
v_cmpx_lt_i32 vcc, 0, v32
s_cbranch_execz LE_w
ds_write_b32 v128, v192
v_cmpx_lt_i32 vcc, 1, v32
ds_write_b32 v129, v193
v_cmpx_lt_i32 vcc, 2, v32
ds_write_b32 v130, v194
v_cmpx_lt_i32 vcc, 3, v32
ds_write_b32 v131, v195
v_cmpx_lt_i32 vcc, 8, v32
s_cbranch_execz LE_w
ds_write_b32 v132, v196
v_cmpx_lt_i32 vcc, 9, v32
ds_write_b32 v133, v197
v_cmpx_lt_i32 vcc, 10, v32
ds_write_b32 v134, v198
v_cmpx_lt_i32 vcc, 11, v32
ds_write_b32 v135, v199
v_cmpx_lt_i32 vcc, 16, v32
s_cbranch_execz LE_w
ds_write_b32 v136, v200
v_cmpx_lt_i32 vcc, 17, v32
ds_write_b32 v137, v201
v_cmpx_lt_i32 vcc, 18, v32
ds_write_b32 v138, v202
v_cmpx_lt_i32 vcc, 19, v32
ds_write_b32 v139, v203
v_cmpx_lt_i32 vcc, 24, v32
s_cbranch_execz LE_w
ds_write_b32 v140, v204
v_cmpx_lt_i32 vcc, 25, v32
ds_write_b32 v141, v205
v_cmpx_lt_i32 vcc, 26, v32
ds_write_b32 v142, v206
v_cmpx_lt_i32 vcc, 27, v32
ds_write_b32 v143, v207
v_cmpx_lt_i32 vcc, 32, v32
s_cbranch_execz LE_w
ds_write_b32 v144, v208
v_cmpx_lt_i32 vcc, 33, v32
ds_write_b32 v145, v209
v_cmpx_lt_i32 vcc, 34, v32
ds_write_b32 v146, v210
v_cmpx_lt_i32 vcc, 35, v32
ds_write_b32 v147, v211
v_cmpx_lt_i32 vcc, 40, v32
s_cbranch_execz LE_w
ds_write_b32 v148, v212
v_cmpx_lt_i32 vcc, 41, v32
ds_write_b32 v149, v213
v_cmpx_lt_i32 vcc, 42, v32
ds_write_b32 v150, v214
v_cmpx_lt_i32 vcc, 43, v32
ds_write_b32 v151, v215
v_cmpx_lt_i32 vcc, 48, v32
s_cbranch_execz LE_w
ds_write_b32 v152, v216
v_cmpx_lt_i32 vcc, 49, v32
ds_write_b32 v153, v217
v_cmpx_lt_i32 vcc, 50, v32
ds_write_b32 v154, v218
v_cmpx_lt_i32 vcc, 51, v32
ds_write_b32 v155, v219
v_cmpx_lt_i32 vcc, 56, v32
s_cbranch_execz LE_w
ds_write_b32 v156, v220
v_cmpx_lt_i32 vcc, 57, v32
ds_write_b32 v157, v221
v_cmpx_lt_i32 vcc, 58, v32
ds_write_b32 v158, v222
v_cmpx_lt_i32 vcc, 59, v32
ds_write_b32 v159, v223
v_cmpx_lt_i32 vcc, 64, v32
s_cbranch_execz LE_w
ds_write_b32 v160, v224
v_cmpx_lt_i32 vcc, 65, v32
ds_write_b32 v161, v225
v_cmpx_lt_i32 vcc, 66, v32
ds_write_b32 v162, v226
v_cmpx_lt_i32 vcc, 67, v32
ds_write_b32 v163, v227
v_cmpx_lt_i32 vcc, 72, v32
s_cbranch_execz LE_w
ds_write_b32 v164, v228
v_cmpx_lt_i32 vcc, 73, v32
ds_write_b32 v165, v229
v_cmpx_lt_i32 vcc, 74, v32
ds_write_b32 v166, v230
v_cmpx_lt_i32 vcc, 75, v32
ds_write_b32 v167, v231
v_cmpx_lt_i32 vcc, 80, v32
s_cbranch_execz LE_w
ds_write_b32 v168, v232
v_cmpx_lt_i32 vcc, 81, v32
ds_write_b32 v169, v233
v_cmpx_lt_i32 vcc, 82, v32
ds_write_b32 v170, v234
v_cmpx_lt_i32 vcc, 83, v32
ds_write_b32 v171, v235
v_cmpx_lt_i32 vcc, 88, v32
s_cbranch_execz LE_w
ds_write_b32 v172, v236
v_cmpx_lt_i32 vcc, 89, v32
ds_write_b32 v173, v237
v_cmpx_lt_i32 vcc, 90, v32
ds_write_b32 v174, v238
v_cmpx_lt_i32 vcc, 91, v32
ds_write_b32 v175, v239
v_cmpx_lt_i32 vcc, 96, v32
s_cbranch_execz LE_w
ds_write_b32 v176, v240
v_cmpx_lt_i32 vcc, 97, v32
ds_write_b32 v177, v241
v_cmpx_lt_i32 vcc, 98, v32
ds_write_b32 v178, v242
v_cmpx_lt_i32 vcc, 99, v32
ds_write_b32 v179, v243
v_cmpx_lt_i32 vcc, 104, v32
s_cbranch_execz LE_w
ds_write_b32 v180, v244
v_cmpx_lt_i32 vcc, 105, v32
ds_write_b32 v181, v245
v_cmpx_lt_i32 vcc, 106, v32
ds_write_b32 v182, v246
v_cmpx_lt_i32 vcc, 107, v32
ds_write_b32 v183, v247
v_cmpx_lt_i32 vcc, 112, v32
s_cbranch_execz LE_w
ds_write_b32 v184, v248
v_cmpx_lt_i32 vcc, 113, v32
ds_write_b32 v185, v249
v_cmpx_lt_i32 vcc, 114, v32
ds_write_b32 v186, v250
v_cmpx_lt_i32 vcc, 115, v32
ds_write_b32 v187, v251
v_cmpx_lt_i32 vcc, 120, v32
s_cbranch_execz LE_w
ds_write_b32 v188, v252
v_cmpx_lt_i32 vcc, 121, v32
ds_write_b32 v189, v253
v_cmpx_lt_i32 vcc, 122, v32
ds_write_b32 v190, v254
v_cmpx_lt_i32 vcc, 123, v32
ds_write_b32 v191, v255
LE_w:
s_mov_b64 exec, -1
s_waitcnt vmcnt(0)
s_mov_b32 s51, 0
v_lshlrev_b32 v80, 16, v76
v_lshlrev_b32 v81, 16, v77
v_lshlrev_b32 v82, 16, v78
v_mov_b32 v34, v38
ds_read2_b32 v[52:53], v34 offset0:0 offset1:4
ds_read2_b32 v[54:55], v34 offset0:8 offset1:12
s_waitcnt lgkmcnt(0)
ds_read2_b32 v[56:57], v34 offset0:16 offset1:20
ds_read2_b32 v[58:59], v34 offset0:24 offset1:28
v_mad_u32_u16 v60, v52, s49, v2
v_mad_u32_u16 v61, v53, s49, v2
v_mad_u32_u16 v62, v54, s49, v2
v_mad_u32_u16 v63, v55, s49, v2
buffer_load_dwordx4 a[0:3], v60, s[16:19], 0 offen
buffer_load_dwordx4 a[4:7], v60, s[16:19], 0 offen offset:256
buffer_load_dwordx4 a[8:11], v61, s[16:19], 0 offen
buffer_load_dwordx4 a[12:15], v61, s[16:19], 0 offen offset:256
buffer_load_dwordx4 a[16:19], v62, s[16:19], 0 offen
buffer_load_dwordx4 a[20:23], v62, s[16:19], 0 offen offset:256
buffer_load_dwordx4 a[24:27], v63, s[16:19], 0 offen
buffer_load_dwordx4 a[28:31], v63, s[16:19], 0 offen offset:256
s_waitcnt lgkmcnt(0)
ds_read2_b32 v[52:53], v34 offset0:32 offset1:36
ds_read2_b32 v[54:55], v34 offset0:40 offset1:44
v_mad_u32_u16 v60, v56, s49, v2
v_mad_u32_u16 v61, v57, s49, v2
v_mad_u32_u16 v62, v58, s49, v2
v_mad_u32_u16 v63, v59, s49, v2
buffer_load_dwordx4 a[32:35], v60, s[16:19], 0 offen
buffer_load_dwordx4 a[36:39], v60, s[16:19], 0 offen offset:256
buffer_load_dwordx4 a[40:43], v61, s[16:19], 0 offen
buffer_load_dwordx4 a[44:47], v61, s[16:19], 0 offen offset:256
buffer_load_dwordx4 a[48:51], v62, s[16:19], 0 offen
buffer_load_dwordx4 a[52:55], v62, s[16:19], 0 offen offset:256
buffer_load_dwordx4 a[56:59], v63, s[16:19], 0 offen
buffer_load_dwordx4 a[60:63], v63, s[16:19], 0 offen offset:256
s_waitcnt lgkmcnt(0)
ds_read2_b32 v[56:57], v34 offset0:48 offset1:52
ds_read2_b32 v[58:59], v34 offset0:56 offset1:60
v_mad_u32_u16 v60, v52, s49, v2
v_mad_u32_u16 v61, v53, s49, v2
v_mad_u32_u16 v62, v54, s49, v2
v_mad_u32_u16 v63, v55, s49, v2
buffer_load_dwordx4 a[64:67], v60, s[16:19], 0 offen
buffer_load_dwordx4 a[68:71], v60, s[16:19], 0 offen offset:256
buffer_load_dwordx4 a[72:75], v61, s[16:19], 0 offen
buffer_load_dwordx4 a[76:79], v61, s[16:19], 0 offen offset:256
buffer_load_dwordx4 a[80:83], v62, s[16:19], 0 offen
buffer_load_dwordx4 a[84:87], v62, s[16:19], 0 offen offset:256
buffer_load_dwordx4 a[88:91], v63, s[16:19], 0 offen
buffer_load_dwordx4 a[92:95], v63, s[16:19], 0 offen offset:256
s_waitcnt lgkmcnt(0)
ds_read2_b32 v[52:53], v34 offset0:64 offset1:68
ds_read2_b32 v[54:55], v34 offset0:72 offset1:76
v_mad_u32_u16 v60, v56, s49, v2
v_mad_u32_u16 v61, v57, s49, v2
v_mad_u32_u16 v62, v58, s49, v2
v_mad_u32_u16 v63, v59, s49, v2
buffer_load_dwordx4 a[96:99], v60, s[16:19], 0 offen
buffer_load_dwordx4 a[100:103], v60, s[16:19], 0 offen offset:256
buffer_load_dwordx4 a[104:107], v61, s[16:19], 0 offen
buffer_load_dwordx4 a[108:111], v61, s[16:19], 0 offen offset:256
buffer_load_dwordx4 a[112:115], v62, s[16:19], 0 offen
buffer_load_dwordx4 a[116:119], v62, s[16:19], 0 offen offset:256
buffer_load_dwordx4 a[120:123], v63, s[16:19], 0 offen
buffer_load_dwordx4 a[124:127], v63, s[16:19], 0 offen offset:256
s_waitcnt lgkmcnt(0)
ds_read2_b32 v[56:57], v34 offset0:80 offset1:84
ds_read2_b32 v[58:59], v34 offset0:88 offset1:92
v_mad_u32_u16 v60, v52, s49, v2
v_mad_u32_u16 v61, v53, s49, v2
v_mad_u32_u16 v62, v54, s49, v2
v_mad_u32_u16 v63, v55, s49, v2
buffer_load_dwordx4 a[128:131], v60, s[16:19], 0 offen
buffer_load_dwordx4 a[132:135], v60, s[16:19], 0 offen offset:256
buffer_load_dwordx4 a[136:139], v61, s[16:19], 0 offen
buffer_load_dwordx4 a[140:143], v61, s[16:19], 0 offen offset:256
buffer_load_dwordx4 a[144:147], v62, s[16:19], 0 offen
buffer_load_dwordx4 a[148:151], v62, s[16:19], 0 offen offset:256
buffer_load_dwordx4 a[152:155], v63, s[16:19], 0 offen
buffer_load_dwordx4 a[156:159], v63, s[16:19], 0 offen offset:256
s_waitcnt lgkmcnt(0)
ds_read2_b32 v[52:53], v34 offset0:96 offset1:100
ds_read2_b32 v[54:55], v34 offset0:104 offset1:108
v_mad_u32_u16 v60, v56, s49, v2
v_mad_u32_u16 v61, v57, s49, v2
v_mad_u32_u16 v62, v58, s49, v2
v_mad_u32_u16 v63, v59, s49, v2
buffer_load_dwordx4 a[160:163], v60, s[16:19], 0 offen
buffer_load_dwordx4 a[164:167], v60, s[16:19], 0 offen offset:256
buffer_load_dwordx4 a[168:171], v61, s[16:19], 0 offen
buffer_load_dwordx4 a[172:175], v61, s[16:19], 0 offen offset:256
buffer_load_dwordx4 a[176:179], v62, s[16:19], 0 offen
buffer_load_dwordx4 a[180:183], v62, s[16:19], 0 offen offset:256
buffer_load_dwordx4 a[184:187], v63, s[16:19], 0 offen
buffer_load_dwordx4 a[188:191], v63, s[16:19], 0 offen offset:256
s_waitcnt lgkmcnt(0)
ds_read2_b32 v[56:57], v34 offset0:112 offset1:116
ds_read2_b32 v[58:59], v34 offset0:120 offset1:124
v_mad_u32_u16 v60, v52, s49, v2
v_mad_u32_u16 v61, v53, s49, v2
v_mad_u32_u16 v62, v54, s49, v2
v_mad_u32_u16 v63, v55, s49, v2
buffer_load_dwordx4 a[192:195], v60, s[16:19], 0 offen
buffer_load_dwordx4 a[196:199], v60, s[16:19], 0 offen offset:256
buffer_load_dwordx4 a[200:203], v61, s[16:19], 0 offen
buffer_load_dwordx4 a[204:207], v61, s[16:19], 0 offen offset:256
buffer_load_dwordx4 a[208:211], v62, s[16:19], 0 offen
buffer_load_dwordx4 a[212:215], v62, s[16:19], 0 offen offset:256
buffer_load_dwordx4 a[216:219], v63, s[16:19], 0 offen
buffer_load_dwordx4 a[220:223], v63, s[16:19], 0 offen offset:256
s_waitcnt lgkmcnt(0)
ds_read2_b32 v[52:53], v34 offset0:128 offset1:132
ds_read2_b32 v[54:55], v34 offset0:136 offset1:140
v_mad_u32_u16 v60, v56, s49, v2
v_mad_u32_u16 v61, v57, s49, v2
v_mad_u32_u16 v62, v58, s49, v2
v_mad_u32_u16 v63, v59, s49, v2
buffer_load_dwordx4 a[224:227], v60, s[16:19], 0 offen
buffer_load_dwordx4 a[228:231], v60, s[16:19], 0 offen offset:256
buffer_load_dwordx4 a[232:235], v61, s[16:19], 0 offen
buffer_load_dwordx4 a[236:239], v61, s[16:19], 0 offen offset:256
buffer_load_dwordx4 a[240:243], v62, s[16:19], 0 offen
buffer_load_dwordx4 a[244:247], v62, s[16:19], 0 offen offset:256
buffer_load_dwordx4 a[248:251], v63, s[16:19], 0 offen
buffer_load_dwordx4 a[252:255], v63, s[16:19], 0 offen offset:256
v_add_u32 v34, 512, v34
s_mov_b32 s45, 0
s_lshl_b32 s47, s58, 9
LE_loop:
v_readlane_b32 s46, v37, s45
s_add_u32 s45, s45, 1
s_waitcnt vmcnt(56)
v_mfma_f32_16x16x32_bf16 v[48:51], a[0:3], v[40:43], v[48:51]
v_mfma_f32_16x16x32_bf16 v[48:51], a[4:7], v[44:47], v[48:51]
s_bitcmp1_b32 s46, 0
s_cbranch_scc0 LE_nf0
v_readlane_b32 s57, v80, s51
s_add_u32 s51, s51, 1
s_and_b32 s51, s51, 63
s_cbranch_scc1 LE_dg0
v_mov_b32 v80, v81
v_mov_b32 v81, v82
LE_dg0:
s_nop 3
v_mul_f32 v48, s57, v48
v_mul_f32 v49, s57, v49
v_mul_f32 v50, s57, v50
v_mul_f32 v51, s57, v51
s_cmp_eq_u32 s42, 0
s_cbranch_scc1 LE_fl0
buffer_load_dwordx2 v[66:67], v39, s[20:23], s47 offen sc1
s_waitcnt vmcnt(0)
v_lshlrev_b32 v64, 16, v66
v_and_b32 v65, 0xffff0000, v66
v_add_f32 v48, v48, v64
v_add_f32 v49, v49, v65
v_lshlrev_b32 v64, 16, v67
v_and_b32 v65, 0xffff0000, v67
v_add_f32 v50, v50, v64
v_add_f32 v51, v51, v65
LE_fl0:
v_cvt_pk_bf16_f32 v64, v48, v49
v_cvt_pk_bf16_f32 v65, v50, v51
v_mov_b32 v48, 0
v_mov_b32 v49, 0
v_mov_b32 v50, 0
v_mov_b32 v51, 0
buffer_store_dwordx2 v[64:65], v39, s[20:23], s47 offen sc1
s_add_u32 s47, s47, 512
LE_nf0:
v_mfma_f32_16x16x32_bf16 v[48:51], a[8:11], v[40:43], v[48:51]
v_mfma_f32_16x16x32_bf16 v[48:51], a[12:15], v[44:47], v[48:51]
s_bitcmp1_b32 s46, 1
s_cbranch_scc0 LE_nf1
v_readlane_b32 s57, v80, s51
s_add_u32 s51, s51, 1
s_and_b32 s51, s51, 63
s_cbranch_scc1 LE_dg1
v_mov_b32 v80, v81
v_mov_b32 v81, v82
LE_dg1:
s_nop 3
v_mul_f32 v48, s57, v48
v_mul_f32 v49, s57, v49
v_mul_f32 v50, s57, v50
v_mul_f32 v51, s57, v51
s_cmp_eq_u32 s42, 0
s_cbranch_scc1 LE_fl1
buffer_load_dwordx2 v[66:67], v39, s[20:23], s47 offen sc1
s_waitcnt vmcnt(0)
v_lshlrev_b32 v64, 16, v66
v_and_b32 v65, 0xffff0000, v66
v_add_f32 v48, v48, v64
v_add_f32 v49, v49, v65
v_lshlrev_b32 v64, 16, v67
v_and_b32 v65, 0xffff0000, v67
v_add_f32 v50, v50, v64
v_add_f32 v51, v51, v65
LE_fl1:
v_cvt_pk_bf16_f32 v64, v48, v49
v_cvt_pk_bf16_f32 v65, v50, v51
v_mov_b32 v48, 0
v_mov_b32 v49, 0
v_mov_b32 v50, 0
v_mov_b32 v51, 0
buffer_store_dwordx2 v[64:65], v39, s[20:23], s47 offen sc1
s_add_u32 s47, s47, 512
LE_nf1:
v_mfma_f32_16x16x32_bf16 v[48:51], a[16:19], v[40:43], v[48:51]
v_mfma_f32_16x16x32_bf16 v[48:51], a[20:23], v[44:47], v[48:51]
s_bitcmp1_b32 s46, 2
s_cbranch_scc0 LE_nf2
v_readlane_b32 s57, v80, s51
s_add_u32 s51, s51, 1
s_and_b32 s51, s51, 63
s_cbranch_scc1 LE_dg2
v_mov_b32 v80, v81
v_mov_b32 v81, v82
LE_dg2:
s_nop 3
v_mul_f32 v48, s57, v48
v_mul_f32 v49, s57, v49
v_mul_f32 v50, s57, v50
v_mul_f32 v51, s57, v51
s_cmp_eq_u32 s42, 0
s_cbranch_scc1 LE_fl2
buffer_load_dwordx2 v[66:67], v39, s[20:23], s47 offen sc1
s_waitcnt vmcnt(0)
v_lshlrev_b32 v64, 16, v66
v_and_b32 v65, 0xffff0000, v66
v_add_f32 v48, v48, v64
v_add_f32 v49, v49, v65
v_lshlrev_b32 v64, 16, v67
v_and_b32 v65, 0xffff0000, v67
v_add_f32 v50, v50, v64
v_add_f32 v51, v51, v65
LE_fl2:
v_cvt_pk_bf16_f32 v64, v48, v49
v_cvt_pk_bf16_f32 v65, v50, v51
v_mov_b32 v48, 0
v_mov_b32 v49, 0
v_mov_b32 v50, 0
v_mov_b32 v51, 0
buffer_store_dwordx2 v[64:65], v39, s[20:23], s47 offen sc1
s_add_u32 s47, s47, 512
LE_nf2:
v_mfma_f32_16x16x32_bf16 v[48:51], a[24:27], v[40:43], v[48:51]
v_mfma_f32_16x16x32_bf16 v[48:51], a[28:31], v[44:47], v[48:51]
s_bitcmp1_b32 s46, 3
s_cbranch_scc0 LE_nf3
v_readlane_b32 s57, v80, s51
s_add_u32 s51, s51, 1
s_and_b32 s51, s51, 63
s_cbranch_scc1 LE_dg3
v_mov_b32 v80, v81
v_mov_b32 v81, v82
LE_dg3:
s_nop 3
v_mul_f32 v48, s57, v48
v_mul_f32 v49, s57, v49
v_mul_f32 v50, s57, v50
v_mul_f32 v51, s57, v51
s_cmp_eq_u32 s42, 0
s_cbranch_scc1 LE_fl3
buffer_load_dwordx2 v[66:67], v39, s[20:23], s47 offen sc1
s_waitcnt vmcnt(0)
v_lshlrev_b32 v64, 16, v66
v_and_b32 v65, 0xffff0000, v66
v_add_f32 v48, v48, v64
v_add_f32 v49, v49, v65
v_lshlrev_b32 v64, 16, v67
v_and_b32 v65, 0xffff0000, v67
v_add_f32 v50, v50, v64
v_add_f32 v51, v51, v65
LE_fl3:
v_cvt_pk_bf16_f32 v64, v48, v49
v_cvt_pk_bf16_f32 v65, v50, v51
v_mov_b32 v48, 0
v_mov_b32 v49, 0
v_mov_b32 v50, 0
v_mov_b32 v51, 0
buffer_store_dwordx2 v[64:65], v39, s[20:23], s47 offen sc1
s_add_u32 s47, s47, 512
LE_nf3:
s_waitcnt lgkmcnt(0)
ds_read2_b32 v[56:57], v34 offset0:16 offset1:20
ds_read2_b32 v[58:59], v34 offset0:24 offset1:28
v_mad_u32_u16 v60, v52, s49, v2
v_mad_u32_u16 v61, v53, s49, v2
v_mad_u32_u16 v62, v54, s49, v2
v_mad_u32_u16 v63, v55, s49, v2
buffer_load_dwordx4 a[0:3], v60, s[16:19], 0 offen
buffer_load_dwordx4 a[4:7], v60, s[16:19], 0 offen offset:256
buffer_load_dwordx4 a[8:11], v61, s[16:19], 0 offen
buffer_load_dwordx4 a[12:15], v61, s[16:19], 0 offen offset:256
buffer_load_dwordx4 a[16:19], v62, s[16:19], 0 offen
buffer_load_dwordx4 a[20:23], v62, s[16:19], 0 offen offset:256
buffer_load_dwordx4 a[24:27], v63, s[16:19], 0 offen
buffer_load_dwordx4 a[28:31], v63, s[16:19], 0 offen offset:256
s_waitcnt vmcnt(56)
v_mfma_f32_16x16x32_bf16 v[48:51], a[32:35], v[40:43], v[48:51]
v_mfma_f32_16x16x32_bf16 v[48:51], a[36:39], v[44:47], v[48:51]
s_bitcmp1_b32 s46, 4
s_cbranch_scc0 LE_nf4
v_readlane_b32 s57, v80, s51
s_add_u32 s51, s51, 1
s_and_b32 s51, s51, 63
s_cbranch_scc1 LE_dg4
v_mov_b32 v80, v81
v_mov_b32 v81, v82
LE_dg4:
s_nop 3
v_mul_f32 v48, s57, v48
v_mul_f32 v49, s57, v49
v_mul_f32 v50, s57, v50
v_mul_f32 v51, s57, v51
s_cmp_eq_u32 s42, 0
s_cbranch_scc1 LE_fl4
buffer_load_dwordx2 v[66:67], v39, s[20:23], s47 offen sc1
s_waitcnt vmcnt(0)
v_lshlrev_b32 v64, 16, v66
v_and_b32 v65, 0xffff0000, v66
v_add_f32 v48, v48, v64
v_add_f32 v49, v49, v65
v_lshlrev_b32 v64, 16, v67
v_and_b32 v65, 0xffff0000, v67
v_add_f32 v50, v50, v64
v_add_f32 v51, v51, v65
LE_fl4:
v_cvt_pk_bf16_f32 v64, v48, v49
v_cvt_pk_bf16_f32 v65, v50, v51
v_mov_b32 v48, 0
v_mov_b32 v49, 0
v_mov_b32 v50, 0
v_mov_b32 v51, 0
buffer_store_dwordx2 v[64:65], v39, s[20:23], s47 offen sc1
s_add_u32 s47, s47, 512
LE_nf4:
v_mfma_f32_16x16x32_bf16 v[48:51], a[40:43], v[40:43], v[48:51]
v_mfma_f32_16x16x32_bf16 v[48:51], a[44:47], v[44:47], v[48:51]
s_bitcmp1_b32 s46, 5
s_cbranch_scc0 LE_nf5
v_readlane_b32 s57, v80, s51
s_add_u32 s51, s51, 1
s_and_b32 s51, s51, 63
s_cbranch_scc1 LE_dg5
v_mov_b32 v80, v81
v_mov_b32 v81, v82
LE_dg5:
s_nop 3
v_mul_f32 v48, s57, v48
v_mul_f32 v49, s57, v49
v_mul_f32 v50, s57, v50
v_mul_f32 v51, s57, v51
s_cmp_eq_u32 s42, 0
s_cbranch_scc1 LE_fl5
buffer_load_dwordx2 v[66:67], v39, s[20:23], s47 offen sc1
s_waitcnt vmcnt(0)
v_lshlrev_b32 v64, 16, v66
v_and_b32 v65, 0xffff0000, v66
v_add_f32 v48, v48, v64
v_add_f32 v49, v49, v65
v_lshlrev_b32 v64, 16, v67
v_and_b32 v65, 0xffff0000, v67
v_add_f32 v50, v50, v64
v_add_f32 v51, v51, v65
LE_fl5:
v_cvt_pk_bf16_f32 v64, v48, v49
v_cvt_pk_bf16_f32 v65, v50, v51
v_mov_b32 v48, 0
v_mov_b32 v49, 0
v_mov_b32 v50, 0
v_mov_b32 v51, 0
buffer_store_dwordx2 v[64:65], v39, s[20:23], s47 offen sc1
s_add_u32 s47, s47, 512
LE_nf5:
v_mfma_f32_16x16x32_bf16 v[48:51], a[48:51], v[40:43], v[48:51]
v_mfma_f32_16x16x32_bf16 v[48:51], a[52:55], v[44:47], v[48:51]
s_bitcmp1_b32 s46, 6
s_cbranch_scc0 LE_nf6
v_readlane_b32 s57, v80, s51
s_add_u32 s51, s51, 1
s_and_b32 s51, s51, 63
s_cbranch_scc1 LE_dg6
v_mov_b32 v80, v81
v_mov_b32 v81, v82
LE_dg6:
s_nop 3
v_mul_f32 v48, s57, v48
v_mul_f32 v49, s57, v49
v_mul_f32 v50, s57, v50
v_mul_f32 v51, s57, v51
s_cmp_eq_u32 s42, 0
s_cbranch_scc1 LE_fl6
buffer_load_dwordx2 v[66:67], v39, s[20:23], s47 offen sc1
s_waitcnt vmcnt(0)
v_lshlrev_b32 v64, 16, v66
v_and_b32 v65, 0xffff0000, v66
v_add_f32 v48, v48, v64
v_add_f32 v49, v49, v65
v_lshlrev_b32 v64, 16, v67
v_and_b32 v65, 0xffff0000, v67
v_add_f32 v50, v50, v64
v_add_f32 v51, v51, v65
LE_fl6:
v_cvt_pk_bf16_f32 v64, v48, v49
v_cvt_pk_bf16_f32 v65, v50, v51
v_mov_b32 v48, 0
v_mov_b32 v49, 0
v_mov_b32 v50, 0
v_mov_b32 v51, 0
buffer_store_dwordx2 v[64:65], v39, s[20:23], s47 offen sc1
s_add_u32 s47, s47, 512
LE_nf6:
v_mfma_f32_16x16x32_bf16 v[48:51], a[56:59], v[40:43], v[48:51]
v_mfma_f32_16x16x32_bf16 v[48:51], a[60:63], v[44:47], v[48:51]
s_bitcmp1_b32 s46, 7
s_cbranch_scc0 LE_nf7
v_readlane_b32 s57, v80, s51
s_add_u32 s51, s51, 1
s_and_b32 s51, s51, 63
s_cbranch_scc1 LE_dg7
v_mov_b32 v80, v81
v_mov_b32 v81, v82
LE_dg7:
s_nop 3
v_mul_f32 v48, s57, v48
v_mul_f32 v49, s57, v49
v_mul_f32 v50, s57, v50
v_mul_f32 v51, s57, v51
s_cmp_eq_u32 s42, 0
s_cbranch_scc1 LE_fl7
buffer_load_dwordx2 v[66:67], v39, s[20:23], s47 offen sc1
s_waitcnt vmcnt(0)
v_lshlrev_b32 v64, 16, v66
v_and_b32 v65, 0xffff0000, v66
v_add_f32 v48, v48, v64
v_add_f32 v49, v49, v65
v_lshlrev_b32 v64, 16, v67
v_and_b32 v65, 0xffff0000, v67
v_add_f32 v50, v50, v64
v_add_f32 v51, v51, v65
LE_fl7:
v_cvt_pk_bf16_f32 v64, v48, v49
v_cvt_pk_bf16_f32 v65, v50, v51
v_mov_b32 v48, 0
v_mov_b32 v49, 0
v_mov_b32 v50, 0
v_mov_b32 v51, 0
buffer_store_dwordx2 v[64:65], v39, s[20:23], s47 offen sc1
s_add_u32 s47, s47, 512
LE_nf7:
s_waitcnt lgkmcnt(0)
ds_read2_b32 v[52:53], v34 offset0:32 offset1:36
ds_read2_b32 v[54:55], v34 offset0:40 offset1:44
v_mad_u32_u16 v60, v56, s49, v2
v_mad_u32_u16 v61, v57, s49, v2
v_mad_u32_u16 v62, v58, s49, v2
v_mad_u32_u16 v63, v59, s49, v2
buffer_load_dwordx4 a[32:35], v60, s[16:19], 0 offen
buffer_load_dwordx4 a[36:39], v60, s[16:19], 0 offen offset:256
buffer_load_dwordx4 a[40:43], v61, s[16:19], 0 offen
buffer_load_dwordx4 a[44:47], v61, s[16:19], 0 offen offset:256
buffer_load_dwordx4 a[48:51], v62, s[16:19], 0 offen
buffer_load_dwordx4 a[52:55], v62, s[16:19], 0 offen offset:256
buffer_load_dwordx4 a[56:59], v63, s[16:19], 0 offen
buffer_load_dwordx4 a[60:63], v63, s[16:19], 0 offen offset:256
s_waitcnt vmcnt(56)
v_mfma_f32_16x16x32_bf16 v[48:51], a[64:67], v[40:43], v[48:51]
v_mfma_f32_16x16x32_bf16 v[48:51], a[68:71], v[44:47], v[48:51]
s_bitcmp1_b32 s46, 8
s_cbranch_scc0 LE_nf8
v_readlane_b32 s57, v80, s51
s_add_u32 s51, s51, 1
s_and_b32 s51, s51, 63
s_cbranch_scc1 LE_dg8
v_mov_b32 v80, v81
v_mov_b32 v81, v82
LE_dg8:
s_nop 3
v_mul_f32 v48, s57, v48
v_mul_f32 v49, s57, v49
v_mul_f32 v50, s57, v50
v_mul_f32 v51, s57, v51
s_cmp_eq_u32 s42, 0
s_cbranch_scc1 LE_fl8
buffer_load_dwordx2 v[66:67], v39, s[20:23], s47 offen sc1
s_waitcnt vmcnt(0)
v_lshlrev_b32 v64, 16, v66
v_and_b32 v65, 0xffff0000, v66
v_add_f32 v48, v48, v64
v_add_f32 v49, v49, v65
v_lshlrev_b32 v64, 16, v67
v_and_b32 v65, 0xffff0000, v67
v_add_f32 v50, v50, v64
v_add_f32 v51, v51, v65
LE_fl8:
v_cvt_pk_bf16_f32 v64, v48, v49
v_cvt_pk_bf16_f32 v65, v50, v51
v_mov_b32 v48, 0
v_mov_b32 v49, 0
v_mov_b32 v50, 0
v_mov_b32 v51, 0
buffer_store_dwordx2 v[64:65], v39, s[20:23], s47 offen sc1
s_add_u32 s47, s47, 512
LE_nf8:
v_mfma_f32_16x16x32_bf16 v[48:51], a[72:75], v[40:43], v[48:51]
v_mfma_f32_16x16x32_bf16 v[48:51], a[76:79], v[44:47], v[48:51]
s_bitcmp1_b32 s46, 9
s_cbranch_scc0 LE_nf9
v_readlane_b32 s57, v80, s51
s_add_u32 s51, s51, 1
s_and_b32 s51, s51, 63
s_cbranch_scc1 LE_dg9
v_mov_b32 v80, v81
v_mov_b32 v81, v82
LE_dg9:
s_nop 3
v_mul_f32 v48, s57, v48
v_mul_f32 v49, s57, v49
v_mul_f32 v50, s57, v50
v_mul_f32 v51, s57, v51
s_cmp_eq_u32 s42, 0
s_cbranch_scc1 LE_fl9
buffer_load_dwordx2 v[66:67], v39, s[20:23], s47 offen sc1
s_waitcnt vmcnt(0)
v_lshlrev_b32 v64, 16, v66
v_and_b32 v65, 0xffff0000, v66
v_add_f32 v48, v48, v64
v_add_f32 v49, v49, v65
v_lshlrev_b32 v64, 16, v67
v_and_b32 v65, 0xffff0000, v67
v_add_f32 v50, v50, v64
v_add_f32 v51, v51, v65
LE_fl9:
v_cvt_pk_bf16_f32 v64, v48, v49
v_cvt_pk_bf16_f32 v65, v50, v51
v_mov_b32 v48, 0
v_mov_b32 v49, 0
v_mov_b32 v50, 0
v_mov_b32 v51, 0
buffer_store_dwordx2 v[64:65], v39, s[20:23], s47 offen sc1
s_add_u32 s47, s47, 512
LE_nf9:
v_mfma_f32_16x16x32_bf16 v[48:51], a[80:83], v[40:43], v[48:51]
v_mfma_f32_16x16x32_bf16 v[48:51], a[84:87], v[44:47], v[48:51]
s_bitcmp1_b32 s46, 10
s_cbranch_scc0 LE_nf10
v_readlane_b32 s57, v80, s51
s_add_u32 s51, s51, 1
s_and_b32 s51, s51, 63
s_cbranch_scc1 LE_dg10
v_mov_b32 v80, v81
v_mov_b32 v81, v82
LE_dg10:
s_nop 3
v_mul_f32 v48, s57, v48
v_mul_f32 v49, s57, v49
v_mul_f32 v50, s57, v50
v_mul_f32 v51, s57, v51
s_cmp_eq_u32 s42, 0
s_cbranch_scc1 LE_fl10
buffer_load_dwordx2 v[66:67], v39, s[20:23], s47 offen sc1
s_waitcnt vmcnt(0)
v_lshlrev_b32 v64, 16, v66
v_and_b32 v65, 0xffff0000, v66
v_add_f32 v48, v48, v64
v_add_f32 v49, v49, v65
v_lshlrev_b32 v64, 16, v67
v_and_b32 v65, 0xffff0000, v67
v_add_f32 v50, v50, v64
v_add_f32 v51, v51, v65
LE_fl10:
v_cvt_pk_bf16_f32 v64, v48, v49
v_cvt_pk_bf16_f32 v65, v50, v51
v_mov_b32 v48, 0
v_mov_b32 v49, 0
v_mov_b32 v50, 0
v_mov_b32 v51, 0
buffer_store_dwordx2 v[64:65], v39, s[20:23], s47 offen sc1
s_add_u32 s47, s47, 512
LE_nf10:
v_mfma_f32_16x16x32_bf16 v[48:51], a[88:91], v[40:43], v[48:51]
v_mfma_f32_16x16x32_bf16 v[48:51], a[92:95], v[44:47], v[48:51]
s_bitcmp1_b32 s46, 11
s_cbranch_scc0 LE_nf11
v_readlane_b32 s57, v80, s51
s_add_u32 s51, s51, 1
s_and_b32 s51, s51, 63
s_cbranch_scc1 LE_dg11
v_mov_b32 v80, v81
v_mov_b32 v81, v82
LE_dg11:
s_nop 3
v_mul_f32 v48, s57, v48
v_mul_f32 v49, s57, v49
v_mul_f32 v50, s57, v50
v_mul_f32 v51, s57, v51
s_cmp_eq_u32 s42, 0
s_cbranch_scc1 LE_fl11
buffer_load_dwordx2 v[66:67], v39, s[20:23], s47 offen sc1
s_waitcnt vmcnt(0)
v_lshlrev_b32 v64, 16, v66
v_and_b32 v65, 0xffff0000, v66
v_add_f32 v48, v48, v64
v_add_f32 v49, v49, v65
v_lshlrev_b32 v64, 16, v67
v_and_b32 v65, 0xffff0000, v67
v_add_f32 v50, v50, v64
v_add_f32 v51, v51, v65
LE_fl11:
v_cvt_pk_bf16_f32 v64, v48, v49
v_cvt_pk_bf16_f32 v65, v50, v51
v_mov_b32 v48, 0
v_mov_b32 v49, 0
v_mov_b32 v50, 0
v_mov_b32 v51, 0
buffer_store_dwordx2 v[64:65], v39, s[20:23], s47 offen sc1
s_add_u32 s47, s47, 512
LE_nf11:
s_waitcnt lgkmcnt(0)
ds_read2_b32 v[56:57], v34 offset0:48 offset1:52
ds_read2_b32 v[58:59], v34 offset0:56 offset1:60
v_mad_u32_u16 v60, v52, s49, v2
v_mad_u32_u16 v61, v53, s49, v2
v_mad_u32_u16 v62, v54, s49, v2
v_mad_u32_u16 v63, v55, s49, v2
buffer_load_dwordx4 a[64:67], v60, s[16:19], 0 offen
buffer_load_dwordx4 a[68:71], v60, s[16:19], 0 offen offset:256
buffer_load_dwordx4 a[72:75], v61, s[16:19], 0 offen
buffer_load_dwordx4 a[76:79], v61, s[16:19], 0 offen offset:256
buffer_load_dwordx4 a[80:83], v62, s[16:19], 0 offen
buffer_load_dwordx4 a[84:87], v62, s[16:19], 0 offen offset:256
buffer_load_dwordx4 a[88:91], v63, s[16:19], 0 offen
buffer_load_dwordx4 a[92:95], v63, s[16:19], 0 offen offset:256
s_waitcnt vmcnt(56)
v_mfma_f32_16x16x32_bf16 v[48:51], a[96:99], v[40:43], v[48:51]
v_mfma_f32_16x16x32_bf16 v[48:51], a[100:103], v[44:47], v[48:51]
s_bitcmp1_b32 s46, 12
s_cbranch_scc0 LE_nf12
v_readlane_b32 s57, v80, s51
s_add_u32 s51, s51, 1
s_and_b32 s51, s51, 63
s_cbranch_scc1 LE_dg12
v_mov_b32 v80, v81
v_mov_b32 v81, v82
LE_dg12:
s_nop 3
v_mul_f32 v48, s57, v48
v_mul_f32 v49, s57, v49
v_mul_f32 v50, s57, v50
v_mul_f32 v51, s57, v51
s_cmp_eq_u32 s42, 0
s_cbranch_scc1 LE_fl12
buffer_load_dwordx2 v[66:67], v39, s[20:23], s47 offen sc1
s_waitcnt vmcnt(0)
v_lshlrev_b32 v64, 16, v66
v_and_b32 v65, 0xffff0000, v66
v_add_f32 v48, v48, v64
v_add_f32 v49, v49, v65
v_lshlrev_b32 v64, 16, v67
v_and_b32 v65, 0xffff0000, v67
v_add_f32 v50, v50, v64
v_add_f32 v51, v51, v65
LE_fl12:
v_cvt_pk_bf16_f32 v64, v48, v49
v_cvt_pk_bf16_f32 v65, v50, v51
v_mov_b32 v48, 0
v_mov_b32 v49, 0
v_mov_b32 v50, 0
v_mov_b32 v51, 0
buffer_store_dwordx2 v[64:65], v39, s[20:23], s47 offen sc1
s_add_u32 s47, s47, 512
LE_nf12:
v_mfma_f32_16x16x32_bf16 v[48:51], a[104:107], v[40:43], v[48:51]
v_mfma_f32_16x16x32_bf16 v[48:51], a[108:111], v[44:47], v[48:51]
s_bitcmp1_b32 s46, 13
s_cbranch_scc0 LE_nf13
v_readlane_b32 s57, v80, s51
s_add_u32 s51, s51, 1
s_and_b32 s51, s51, 63
s_cbranch_scc1 LE_dg13
v_mov_b32 v80, v81
v_mov_b32 v81, v82
LE_dg13:
s_nop 3
v_mul_f32 v48, s57, v48
v_mul_f32 v49, s57, v49
v_mul_f32 v50, s57, v50
v_mul_f32 v51, s57, v51
s_cmp_eq_u32 s42, 0
s_cbranch_scc1 LE_fl13
buffer_load_dwordx2 v[66:67], v39, s[20:23], s47 offen sc1
s_waitcnt vmcnt(0)
v_lshlrev_b32 v64, 16, v66
v_and_b32 v65, 0xffff0000, v66
v_add_f32 v48, v48, v64
v_add_f32 v49, v49, v65
v_lshlrev_b32 v64, 16, v67
v_and_b32 v65, 0xffff0000, v67
v_add_f32 v50, v50, v64
v_add_f32 v51, v51, v65
LE_fl13:
v_cvt_pk_bf16_f32 v64, v48, v49
v_cvt_pk_bf16_f32 v65, v50, v51
v_mov_b32 v48, 0
v_mov_b32 v49, 0
v_mov_b32 v50, 0
v_mov_b32 v51, 0
buffer_store_dwordx2 v[64:65], v39, s[20:23], s47 offen sc1
s_add_u32 s47, s47, 512
LE_nf13:
v_mfma_f32_16x16x32_bf16 v[48:51], a[112:115], v[40:43], v[48:51]
v_mfma_f32_16x16x32_bf16 v[48:51], a[116:119], v[44:47], v[48:51]
s_bitcmp1_b32 s46, 14
s_cbranch_scc0 LE_nf14
v_readlane_b32 s57, v80, s51
s_add_u32 s51, s51, 1
s_and_b32 s51, s51, 63
s_cbranch_scc1 LE_dg14
v_mov_b32 v80, v81
v_mov_b32 v81, v82
LE_dg14:
s_nop 3
v_mul_f32 v48, s57, v48
v_mul_f32 v49, s57, v49
v_mul_f32 v50, s57, v50
v_mul_f32 v51, s57, v51
s_cmp_eq_u32 s42, 0
s_cbranch_scc1 LE_fl14
buffer_load_dwordx2 v[66:67], v39, s[20:23], s47 offen sc1
s_waitcnt vmcnt(0)
v_lshlrev_b32 v64, 16, v66
v_and_b32 v65, 0xffff0000, v66
v_add_f32 v48, v48, v64
v_add_f32 v49, v49, v65
v_lshlrev_b32 v64, 16, v67
v_and_b32 v65, 0xffff0000, v67
v_add_f32 v50, v50, v64
v_add_f32 v51, v51, v65
LE_fl14:
v_cvt_pk_bf16_f32 v64, v48, v49
v_cvt_pk_bf16_f32 v65, v50, v51
v_mov_b32 v48, 0
v_mov_b32 v49, 0
v_mov_b32 v50, 0
v_mov_b32 v51, 0
buffer_store_dwordx2 v[64:65], v39, s[20:23], s47 offen sc1
s_add_u32 s47, s47, 512
LE_nf14:
v_mfma_f32_16x16x32_bf16 v[48:51], a[120:123], v[40:43], v[48:51]
v_mfma_f32_16x16x32_bf16 v[48:51], a[124:127], v[44:47], v[48:51]
s_bitcmp1_b32 s46, 15
s_cbranch_scc0 LE_nf15
v_readlane_b32 s57, v80, s51
s_add_u32 s51, s51, 1
s_and_b32 s51, s51, 63
s_cbranch_scc1 LE_dg15
v_mov_b32 v80, v81
v_mov_b32 v81, v82
LE_dg15:
s_nop 3
v_mul_f32 v48, s57, v48
v_mul_f32 v49, s57, v49
v_mul_f32 v50, s57, v50
v_mul_f32 v51, s57, v51
s_cmp_eq_u32 s42, 0
s_cbranch_scc1 LE_fl15
buffer_load_dwordx2 v[66:67], v39, s[20:23], s47 offen sc1
s_waitcnt vmcnt(0)
v_lshlrev_b32 v64, 16, v66
v_and_b32 v65, 0xffff0000, v66
v_add_f32 v48, v48, v64
v_add_f32 v49, v49, v65
v_lshlrev_b32 v64, 16, v67
v_and_b32 v65, 0xffff0000, v67
v_add_f32 v50, v50, v64
v_add_f32 v51, v51, v65
LE_fl15:
v_cvt_pk_bf16_f32 v64, v48, v49
v_cvt_pk_bf16_f32 v65, v50, v51
v_mov_b32 v48, 0
v_mov_b32 v49, 0
v_mov_b32 v50, 0
v_mov_b32 v51, 0
buffer_store_dwordx2 v[64:65], v39, s[20:23], s47 offen sc1
s_add_u32 s47, s47, 512
LE_nf15:
s_waitcnt lgkmcnt(0)
ds_read2_b32 v[52:53], v34 offset0:64 offset1:68
ds_read2_b32 v[54:55], v34 offset0:72 offset1:76
v_mad_u32_u16 v60, v56, s49, v2
v_mad_u32_u16 v61, v57, s49, v2
v_mad_u32_u16 v62, v58, s49, v2
v_mad_u32_u16 v63, v59, s49, v2
buffer_load_dwordx4 a[96:99], v60, s[16:19], 0 offen
buffer_load_dwordx4 a[100:103], v60, s[16:19], 0 offen offset:256
buffer_load_dwordx4 a[104:107], v61, s[16:19], 0 offen
buffer_load_dwordx4 a[108:111], v61, s[16:19], 0 offen offset:256
buffer_load_dwordx4 a[112:115], v62, s[16:19], 0 offen
buffer_load_dwordx4 a[116:119], v62, s[16:19], 0 offen offset:256
buffer_load_dwordx4 a[120:123], v63, s[16:19], 0 offen
buffer_load_dwordx4 a[124:127], v63, s[16:19], 0 offen offset:256
s_waitcnt vmcnt(56)
v_mfma_f32_16x16x32_bf16 v[48:51], a[128:131], v[40:43], v[48:51]
v_mfma_f32_16x16x32_bf16 v[48:51], a[132:135], v[44:47], v[48:51]
s_bitcmp1_b32 s46, 16
s_cbranch_scc0 LE_nf16
v_readlane_b32 s57, v80, s51
s_add_u32 s51, s51, 1
s_and_b32 s51, s51, 63
s_cbranch_scc1 LE_dg16
v_mov_b32 v80, v81
v_mov_b32 v81, v82
LE_dg16:
s_nop 3
v_mul_f32 v48, s57, v48
v_mul_f32 v49, s57, v49
v_mul_f32 v50, s57, v50
v_mul_f32 v51, s57, v51
s_cmp_eq_u32 s42, 0
s_cbranch_scc1 LE_fl16
buffer_load_dwordx2 v[66:67], v39, s[20:23], s47 offen sc1
s_waitcnt vmcnt(0)
v_lshlrev_b32 v64, 16, v66
v_and_b32 v65, 0xffff0000, v66
v_add_f32 v48, v48, v64
v_add_f32 v49, v49, v65
v_lshlrev_b32 v64, 16, v67
v_and_b32 v65, 0xffff0000, v67
v_add_f32 v50, v50, v64
v_add_f32 v51, v51, v65
LE_fl16:
v_cvt_pk_bf16_f32 v64, v48, v49
v_cvt_pk_bf16_f32 v65, v50, v51
v_mov_b32 v48, 0
v_mov_b32 v49, 0
v_mov_b32 v50, 0
v_mov_b32 v51, 0
buffer_store_dwordx2 v[64:65], v39, s[20:23], s47 offen sc1
s_add_u32 s47, s47, 512
LE_nf16:
v_mfma_f32_16x16x32_bf16 v[48:51], a[136:139], v[40:43], v[48:51]
v_mfma_f32_16x16x32_bf16 v[48:51], a[140:143], v[44:47], v[48:51]
s_bitcmp1_b32 s46, 17
s_cbranch_scc0 LE_nf17
v_readlane_b32 s57, v80, s51
s_add_u32 s51, s51, 1
s_and_b32 s51, s51, 63
s_cbranch_scc1 LE_dg17
v_mov_b32 v80, v81
v_mov_b32 v81, v82
LE_dg17:
s_nop 3
v_mul_f32 v48, s57, v48
v_mul_f32 v49, s57, v49
v_mul_f32 v50, s57, v50
v_mul_f32 v51, s57, v51
s_cmp_eq_u32 s42, 0
s_cbranch_scc1 LE_fl17
buffer_load_dwordx2 v[66:67], v39, s[20:23], s47 offen sc1
s_waitcnt vmcnt(0)
v_lshlrev_b32 v64, 16, v66
v_and_b32 v65, 0xffff0000, v66
v_add_f32 v48, v48, v64
v_add_f32 v49, v49, v65
v_lshlrev_b32 v64, 16, v67
v_and_b32 v65, 0xffff0000, v67
v_add_f32 v50, v50, v64
v_add_f32 v51, v51, v65
LE_fl17:
v_cvt_pk_bf16_f32 v64, v48, v49
v_cvt_pk_bf16_f32 v65, v50, v51
v_mov_b32 v48, 0
v_mov_b32 v49, 0
v_mov_b32 v50, 0
v_mov_b32 v51, 0
buffer_store_dwordx2 v[64:65], v39, s[20:23], s47 offen sc1
s_add_u32 s47, s47, 512
LE_nf17:
v_mfma_f32_16x16x32_bf16 v[48:51], a[144:147], v[40:43], v[48:51]
v_mfma_f32_16x16x32_bf16 v[48:51], a[148:151], v[44:47], v[48:51]
s_bitcmp1_b32 s46, 18
s_cbranch_scc0 LE_nf18
v_readlane_b32 s57, v80, s51
s_add_u32 s51, s51, 1
s_and_b32 s51, s51, 63
s_cbranch_scc1 LE_dg18
v_mov_b32 v80, v81
v_mov_b32 v81, v82
LE_dg18:
s_nop 3
v_mul_f32 v48, s57, v48
v_mul_f32 v49, s57, v49
v_mul_f32 v50, s57, v50
v_mul_f32 v51, s57, v51
s_cmp_eq_u32 s42, 0
s_cbranch_scc1 LE_fl18
buffer_load_dwordx2 v[66:67], v39, s[20:23], s47 offen sc1
s_waitcnt vmcnt(0)
v_lshlrev_b32 v64, 16, v66
v_and_b32 v65, 0xffff0000, v66
v_add_f32 v48, v48, v64
v_add_f32 v49, v49, v65
v_lshlrev_b32 v64, 16, v67
v_and_b32 v65, 0xffff0000, v67
v_add_f32 v50, v50, v64
v_add_f32 v51, v51, v65
LE_fl18:
v_cvt_pk_bf16_f32 v64, v48, v49
v_cvt_pk_bf16_f32 v65, v50, v51
v_mov_b32 v48, 0
v_mov_b32 v49, 0
v_mov_b32 v50, 0
v_mov_b32 v51, 0
buffer_store_dwordx2 v[64:65], v39, s[20:23], s47 offen sc1
s_add_u32 s47, s47, 512
LE_nf18:
v_mfma_f32_16x16x32_bf16 v[48:51], a[152:155], v[40:43], v[48:51]
v_mfma_f32_16x16x32_bf16 v[48:51], a[156:159], v[44:47], v[48:51]
s_bitcmp1_b32 s46, 19
s_cbranch_scc0 LE_nf19
v_readlane_b32 s57, v80, s51
s_add_u32 s51, s51, 1
s_and_b32 s51, s51, 63
s_cbranch_scc1 LE_dg19
v_mov_b32 v80, v81
v_mov_b32 v81, v82
LE_dg19:
s_nop 3
v_mul_f32 v48, s57, v48
v_mul_f32 v49, s57, v49
v_mul_f32 v50, s57, v50
v_mul_f32 v51, s57, v51
s_cmp_eq_u32 s42, 0
s_cbranch_scc1 LE_fl19
buffer_load_dwordx2 v[66:67], v39, s[20:23], s47 offen sc1
s_waitcnt vmcnt(0)
v_lshlrev_b32 v64, 16, v66
v_and_b32 v65, 0xffff0000, v66
v_add_f32 v48, v48, v64
v_add_f32 v49, v49, v65
v_lshlrev_b32 v64, 16, v67
v_and_b32 v65, 0xffff0000, v67
v_add_f32 v50, v50, v64
v_add_f32 v51, v51, v65
LE_fl19:
v_cvt_pk_bf16_f32 v64, v48, v49
v_cvt_pk_bf16_f32 v65, v50, v51
v_mov_b32 v48, 0
v_mov_b32 v49, 0
v_mov_b32 v50, 0
v_mov_b32 v51, 0
buffer_store_dwordx2 v[64:65], v39, s[20:23], s47 offen sc1
s_add_u32 s47, s47, 512
LE_nf19:
s_waitcnt lgkmcnt(0)
ds_read2_b32 v[56:57], v34 offset0:80 offset1:84
ds_read2_b32 v[58:59], v34 offset0:88 offset1:92
v_mad_u32_u16 v60, v52, s49, v2
v_mad_u32_u16 v61, v53, s49, v2
v_mad_u32_u16 v62, v54, s49, v2
v_mad_u32_u16 v63, v55, s49, v2
buffer_load_dwordx4 a[128:131], v60, s[16:19], 0 offen
buffer_load_dwordx4 a[132:135], v60, s[16:19], 0 offen offset:256
buffer_load_dwordx4 a[136:139], v61, s[16:19], 0 offen
buffer_load_dwordx4 a[140:143], v61, s[16:19], 0 offen offset:256
buffer_load_dwordx4 a[144:147], v62, s[16:19], 0 offen
buffer_load_dwordx4 a[148:151], v62, s[16:19], 0 offen offset:256
buffer_load_dwordx4 a[152:155], v63, s[16:19], 0 offen
buffer_load_dwordx4 a[156:159], v63, s[16:19], 0 offen offset:256
s_waitcnt vmcnt(56)
v_mfma_f32_16x16x32_bf16 v[48:51], a[160:163], v[40:43], v[48:51]
v_mfma_f32_16x16x32_bf16 v[48:51], a[164:167], v[44:47], v[48:51]
s_bitcmp1_b32 s46, 20
s_cbranch_scc0 LE_nf20
v_readlane_b32 s57, v80, s51
s_add_u32 s51, s51, 1
s_and_b32 s51, s51, 63
s_cbranch_scc1 LE_dg20
v_mov_b32 v80, v81
v_mov_b32 v81, v82
LE_dg20:
s_nop 3
v_mul_f32 v48, s57, v48
v_mul_f32 v49, s57, v49
v_mul_f32 v50, s57, v50
v_mul_f32 v51, s57, v51
s_cmp_eq_u32 s42, 0
s_cbranch_scc1 LE_fl20
buffer_load_dwordx2 v[66:67], v39, s[20:23], s47 offen sc1
s_waitcnt vmcnt(0)
v_lshlrev_b32 v64, 16, v66
v_and_b32 v65, 0xffff0000, v66
v_add_f32 v48, v48, v64
v_add_f32 v49, v49, v65
v_lshlrev_b32 v64, 16, v67
v_and_b32 v65, 0xffff0000, v67
v_add_f32 v50, v50, v64
v_add_f32 v51, v51, v65
LE_fl20:
v_cvt_pk_bf16_f32 v64, v48, v49
v_cvt_pk_bf16_f32 v65, v50, v51
v_mov_b32 v48, 0
v_mov_b32 v49, 0
v_mov_b32 v50, 0
v_mov_b32 v51, 0
buffer_store_dwordx2 v[64:65], v39, s[20:23], s47 offen sc1
s_add_u32 s47, s47, 512
LE_nf20:
v_mfma_f32_16x16x32_bf16 v[48:51], a[168:171], v[40:43], v[48:51]
v_mfma_f32_16x16x32_bf16 v[48:51], a[172:175], v[44:47], v[48:51]
s_bitcmp1_b32 s46, 21
s_cbranch_scc0 LE_nf21
v_readlane_b32 s57, v80, s51
s_add_u32 s51, s51, 1
s_and_b32 s51, s51, 63
s_cbranch_scc1 LE_dg21
v_mov_b32 v80, v81
v_mov_b32 v81, v82
LE_dg21:
s_nop 3
v_mul_f32 v48, s57, v48
v_mul_f32 v49, s57, v49
v_mul_f32 v50, s57, v50
v_mul_f32 v51, s57, v51
s_cmp_eq_u32 s42, 0
s_cbranch_scc1 LE_fl21
buffer_load_dwordx2 v[66:67], v39, s[20:23], s47 offen sc1
s_waitcnt vmcnt(0)
v_lshlrev_b32 v64, 16, v66
v_and_b32 v65, 0xffff0000, v66
v_add_f32 v48, v48, v64
v_add_f32 v49, v49, v65
v_lshlrev_b32 v64, 16, v67
v_and_b32 v65, 0xffff0000, v67
v_add_f32 v50, v50, v64
v_add_f32 v51, v51, v65
LE_fl21:
v_cvt_pk_bf16_f32 v64, v48, v49
v_cvt_pk_bf16_f32 v65, v50, v51
v_mov_b32 v48, 0
v_mov_b32 v49, 0
v_mov_b32 v50, 0
v_mov_b32 v51, 0
buffer_store_dwordx2 v[64:65], v39, s[20:23], s47 offen sc1
s_add_u32 s47, s47, 512
LE_nf21:
v_mfma_f32_16x16x32_bf16 v[48:51], a[176:179], v[40:43], v[48:51]
v_mfma_f32_16x16x32_bf16 v[48:51], a[180:183], v[44:47], v[48:51]
s_bitcmp1_b32 s46, 22
s_cbranch_scc0 LE_nf22
v_readlane_b32 s57, v80, s51
s_add_u32 s51, s51, 1
s_and_b32 s51, s51, 63
s_cbranch_scc1 LE_dg22
v_mov_b32 v80, v81
v_mov_b32 v81, v82
LE_dg22:
s_nop 3
v_mul_f32 v48, s57, v48
v_mul_f32 v49, s57, v49
v_mul_f32 v50, s57, v50
v_mul_f32 v51, s57, v51
s_cmp_eq_u32 s42, 0
s_cbranch_scc1 LE_fl22
buffer_load_dwordx2 v[66:67], v39, s[20:23], s47 offen sc1
s_waitcnt vmcnt(0)
v_lshlrev_b32 v64, 16, v66
v_and_b32 v65, 0xffff0000, v66
v_add_f32 v48, v48, v64
v_add_f32 v49, v49, v65
v_lshlrev_b32 v64, 16, v67
v_and_b32 v65, 0xffff0000, v67
v_add_f32 v50, v50, v64
v_add_f32 v51, v51, v65
LE_fl22:
v_cvt_pk_bf16_f32 v64, v48, v49
v_cvt_pk_bf16_f32 v65, v50, v51
v_mov_b32 v48, 0
v_mov_b32 v49, 0
v_mov_b32 v50, 0
v_mov_b32 v51, 0
buffer_store_dwordx2 v[64:65], v39, s[20:23], s47 offen sc1
s_add_u32 s47, s47, 512
LE_nf22:
v_mfma_f32_16x16x32_bf16 v[48:51], a[184:187], v[40:43], v[48:51]
v_mfma_f32_16x16x32_bf16 v[48:51], a[188:191], v[44:47], v[48:51]
s_bitcmp1_b32 s46, 23
s_cbranch_scc0 LE_nf23
v_readlane_b32 s57, v80, s51
s_add_u32 s51, s51, 1
s_and_b32 s51, s51, 63
s_cbranch_scc1 LE_dg23
v_mov_b32 v80, v81
v_mov_b32 v81, v82
LE_dg23:
s_nop 3
v_mul_f32 v48, s57, v48
v_mul_f32 v49, s57, v49
v_mul_f32 v50, s57, v50
v_mul_f32 v51, s57, v51
s_cmp_eq_u32 s42, 0
s_cbranch_scc1 LE_fl23
buffer_load_dwordx2 v[66:67], v39, s[20:23], s47 offen sc1
s_waitcnt vmcnt(0)
v_lshlrev_b32 v64, 16, v66
v_and_b32 v65, 0xffff0000, v66
v_add_f32 v48, v48, v64
v_add_f32 v49, v49, v65
v_lshlrev_b32 v64, 16, v67
v_and_b32 v65, 0xffff0000, v67
v_add_f32 v50, v50, v64
v_add_f32 v51, v51, v65
LE_fl23:
v_cvt_pk_bf16_f32 v64, v48, v49
v_cvt_pk_bf16_f32 v65, v50, v51
v_mov_b32 v48, 0
v_mov_b32 v49, 0
v_mov_b32 v50, 0
v_mov_b32 v51, 0
buffer_store_dwordx2 v[64:65], v39, s[20:23], s47 offen sc1
s_add_u32 s47, s47, 512
LE_nf23:
s_waitcnt lgkmcnt(0)
ds_read2_b32 v[52:53], v34 offset0:96 offset1:100
ds_read2_b32 v[54:55], v34 offset0:104 offset1:108
v_mad_u32_u16 v60, v56, s49, v2
v_mad_u32_u16 v61, v57, s49, v2
v_mad_u32_u16 v62, v58, s49, v2
v_mad_u32_u16 v63, v59, s49, v2
buffer_load_dwordx4 a[160:163], v60, s[16:19], 0 offen
buffer_load_dwordx4 a[164:167], v60, s[16:19], 0 offen offset:256
buffer_load_dwordx4 a[168:171], v61, s[16:19], 0 offen
buffer_load_dwordx4 a[172:175], v61, s[16:19], 0 offen offset:256
buffer_load_dwordx4 a[176:179], v62, s[16:19], 0 offen
buffer_load_dwordx4 a[180:183], v62, s[16:19], 0 offen offset:256
buffer_load_dwordx4 a[184:187], v63, s[16:19], 0 offen
buffer_load_dwordx4 a[188:191], v63, s[16:19], 0 offen offset:256
s_waitcnt vmcnt(56)
v_mfma_f32_16x16x32_bf16 v[48:51], a[192:195], v[40:43], v[48:51]
v_mfma_f32_16x16x32_bf16 v[48:51], a[196:199], v[44:47], v[48:51]
s_bitcmp1_b32 s46, 24
s_cbranch_scc0 LE_nf24
v_readlane_b32 s57, v80, s51
s_add_u32 s51, s51, 1
s_and_b32 s51, s51, 63
s_cbranch_scc1 LE_dg24
v_mov_b32 v80, v81
v_mov_b32 v81, v82
LE_dg24:
s_nop 3
v_mul_f32 v48, s57, v48
v_mul_f32 v49, s57, v49
v_mul_f32 v50, s57, v50
v_mul_f32 v51, s57, v51
s_cmp_eq_u32 s42, 0
s_cbranch_scc1 LE_fl24
buffer_load_dwordx2 v[66:67], v39, s[20:23], s47 offen sc1
s_waitcnt vmcnt(0)
v_lshlrev_b32 v64, 16, v66
v_and_b32 v65, 0xffff0000, v66
v_add_f32 v48, v48, v64
v_add_f32 v49, v49, v65
v_lshlrev_b32 v64, 16, v67
v_and_b32 v65, 0xffff0000, v67
v_add_f32 v50, v50, v64
v_add_f32 v51, v51, v65
LE_fl24:
v_cvt_pk_bf16_f32 v64, v48, v49
v_cvt_pk_bf16_f32 v65, v50, v51
v_mov_b32 v48, 0
v_mov_b32 v49, 0
v_mov_b32 v50, 0
v_mov_b32 v51, 0
buffer_store_dwordx2 v[64:65], v39, s[20:23], s47 offen sc1
s_add_u32 s47, s47, 512
LE_nf24:
v_mfma_f32_16x16x32_bf16 v[48:51], a[200:203], v[40:43], v[48:51]
v_mfma_f32_16x16x32_bf16 v[48:51], a[204:207], v[44:47], v[48:51]
s_bitcmp1_b32 s46, 25
s_cbranch_scc0 LE_nf25
v_readlane_b32 s57, v80, s51
s_add_u32 s51, s51, 1
s_and_b32 s51, s51, 63
s_cbranch_scc1 LE_dg25
v_mov_b32 v80, v81
v_mov_b32 v81, v82
LE_dg25:
s_nop 3
v_mul_f32 v48, s57, v48
v_mul_f32 v49, s57, v49
v_mul_f32 v50, s57, v50
v_mul_f32 v51, s57, v51
s_cmp_eq_u32 s42, 0
s_cbranch_scc1 LE_fl25
buffer_load_dwordx2 v[66:67], v39, s[20:23], s47 offen sc1
s_waitcnt vmcnt(0)
v_lshlrev_b32 v64, 16, v66
v_and_b32 v65, 0xffff0000, v66
v_add_f32 v48, v48, v64
v_add_f32 v49, v49, v65
v_lshlrev_b32 v64, 16, v67
v_and_b32 v65, 0xffff0000, v67
v_add_f32 v50, v50, v64
v_add_f32 v51, v51, v65
LE_fl25:
v_cvt_pk_bf16_f32 v64, v48, v49
v_cvt_pk_bf16_f32 v65, v50, v51
v_mov_b32 v48, 0
v_mov_b32 v49, 0
v_mov_b32 v50, 0
v_mov_b32 v51, 0
buffer_store_dwordx2 v[64:65], v39, s[20:23], s47 offen sc1
s_add_u32 s47, s47, 512
LE_nf25:
v_mfma_f32_16x16x32_bf16 v[48:51], a[208:211], v[40:43], v[48:51]
v_mfma_f32_16x16x32_bf16 v[48:51], a[212:215], v[44:47], v[48:51]
s_bitcmp1_b32 s46, 26
s_cbranch_scc0 LE_nf26
v_readlane_b32 s57, v80, s51
s_add_u32 s51, s51, 1
s_and_b32 s51, s51, 63
s_cbranch_scc1 LE_dg26
v_mov_b32 v80, v81
v_mov_b32 v81, v82
LE_dg26:
s_nop 3
v_mul_f32 v48, s57, v48
v_mul_f32 v49, s57, v49
v_mul_f32 v50, s57, v50
v_mul_f32 v51, s57, v51
s_cmp_eq_u32 s42, 0
s_cbranch_scc1 LE_fl26
buffer_load_dwordx2 v[66:67], v39, s[20:23], s47 offen sc1
s_waitcnt vmcnt(0)
v_lshlrev_b32 v64, 16, v66
v_and_b32 v65, 0xffff0000, v66
v_add_f32 v48, v48, v64
v_add_f32 v49, v49, v65
v_lshlrev_b32 v64, 16, v67
v_and_b32 v65, 0xffff0000, v67
v_add_f32 v50, v50, v64
v_add_f32 v51, v51, v65
LE_fl26:
v_cvt_pk_bf16_f32 v64, v48, v49
v_cvt_pk_bf16_f32 v65, v50, v51
v_mov_b32 v48, 0
v_mov_b32 v49, 0
v_mov_b32 v50, 0
v_mov_b32 v51, 0
buffer_store_dwordx2 v[64:65], v39, s[20:23], s47 offen sc1
s_add_u32 s47, s47, 512
LE_nf26:
v_mfma_f32_16x16x32_bf16 v[48:51], a[216:219], v[40:43], v[48:51]
v_mfma_f32_16x16x32_bf16 v[48:51], a[220:223], v[44:47], v[48:51]
s_bitcmp1_b32 s46, 27
s_cbranch_scc0 LE_nf27
v_readlane_b32 s57, v80, s51
s_add_u32 s51, s51, 1
s_and_b32 s51, s51, 63
s_cbranch_scc1 LE_dg27
v_mov_b32 v80, v81
v_mov_b32 v81, v82
LE_dg27:
s_nop 3
v_mul_f32 v48, s57, v48
v_mul_f32 v49, s57, v49
v_mul_f32 v50, s57, v50
v_mul_f32 v51, s57, v51
s_cmp_eq_u32 s42, 0
s_cbranch_scc1 LE_fl27
buffer_load_dwordx2 v[66:67], v39, s[20:23], s47 offen sc1
s_waitcnt vmcnt(0)
v_lshlrev_b32 v64, 16, v66
v_and_b32 v65, 0xffff0000, v66
v_add_f32 v48, v48, v64
v_add_f32 v49, v49, v65
v_lshlrev_b32 v64, 16, v67
v_and_b32 v65, 0xffff0000, v67
v_add_f32 v50, v50, v64
v_add_f32 v51, v51, v65
LE_fl27:
v_cvt_pk_bf16_f32 v64, v48, v49
v_cvt_pk_bf16_f32 v65, v50, v51
v_mov_b32 v48, 0
v_mov_b32 v49, 0
v_mov_b32 v50, 0
v_mov_b32 v51, 0
buffer_store_dwordx2 v[64:65], v39, s[20:23], s47 offen sc1
s_add_u32 s47, s47, 512
LE_nf27:
s_waitcnt lgkmcnt(0)
ds_read2_b32 v[56:57], v34 offset0:112 offset1:116
ds_read2_b32 v[58:59], v34 offset0:120 offset1:124
v_mad_u32_u16 v60, v52, s49, v2
v_mad_u32_u16 v61, v53, s49, v2
v_mad_u32_u16 v62, v54, s49, v2
v_mad_u32_u16 v63, v55, s49, v2
buffer_load_dwordx4 a[192:195], v60, s[16:19], 0 offen
buffer_load_dwordx4 a[196:199], v60, s[16:19], 0 offen offset:256
buffer_load_dwordx4 a[200:203], v61, s[16:19], 0 offen
buffer_load_dwordx4 a[204:207], v61, s[16:19], 0 offen offset:256
buffer_load_dwordx4 a[208:211], v62, s[16:19], 0 offen
buffer_load_dwordx4 a[212:215], v62, s[16:19], 0 offen offset:256
buffer_load_dwordx4 a[216:219], v63, s[16:19], 0 offen
buffer_load_dwordx4 a[220:223], v63, s[16:19], 0 offen offset:256
s_waitcnt vmcnt(56)
v_mfma_f32_16x16x32_bf16 v[48:51], a[224:227], v[40:43], v[48:51]
v_mfma_f32_16x16x32_bf16 v[48:51], a[228:231], v[44:47], v[48:51]
s_bitcmp1_b32 s46, 28
s_cbranch_scc0 LE_nf28
v_readlane_b32 s57, v80, s51
s_add_u32 s51, s51, 1
s_and_b32 s51, s51, 63
s_cbranch_scc1 LE_dg28
v_mov_b32 v80, v81
v_mov_b32 v81, v82
LE_dg28:
s_nop 3
v_mul_f32 v48, s57, v48
v_mul_f32 v49, s57, v49
v_mul_f32 v50, s57, v50
v_mul_f32 v51, s57, v51
s_cmp_eq_u32 s42, 0
s_cbranch_scc1 LE_fl28
buffer_load_dwordx2 v[66:67], v39, s[20:23], s47 offen sc1
s_waitcnt vmcnt(0)
v_lshlrev_b32 v64, 16, v66
v_and_b32 v65, 0xffff0000, v66
v_add_f32 v48, v48, v64
v_add_f32 v49, v49, v65
v_lshlrev_b32 v64, 16, v67
v_and_b32 v65, 0xffff0000, v67
v_add_f32 v50, v50, v64
v_add_f32 v51, v51, v65
LE_fl28:
v_cvt_pk_bf16_f32 v64, v48, v49
v_cvt_pk_bf16_f32 v65, v50, v51
v_mov_b32 v48, 0
v_mov_b32 v49, 0
v_mov_b32 v50, 0
v_mov_b32 v51, 0
buffer_store_dwordx2 v[64:65], v39, s[20:23], s47 offen sc1
s_add_u32 s47, s47, 512
LE_nf28:
v_mfma_f32_16x16x32_bf16 v[48:51], a[232:235], v[40:43], v[48:51]
v_mfma_f32_16x16x32_bf16 v[48:51], a[236:239], v[44:47], v[48:51]
s_bitcmp1_b32 s46, 29
s_cbranch_scc0 LE_nf29
v_readlane_b32 s57, v80, s51
s_add_u32 s51, s51, 1
s_and_b32 s51, s51, 63
s_cbranch_scc1 LE_dg29
v_mov_b32 v80, v81
v_mov_b32 v81, v82
LE_dg29:
s_nop 3
v_mul_f32 v48, s57, v48
v_mul_f32 v49, s57, v49
v_mul_f32 v50, s57, v50
v_mul_f32 v51, s57, v51
s_cmp_eq_u32 s42, 0
s_cbranch_scc1 LE_fl29
buffer_load_dwordx2 v[66:67], v39, s[20:23], s47 offen sc1
s_waitcnt vmcnt(0)
v_lshlrev_b32 v64, 16, v66
v_and_b32 v65, 0xffff0000, v66
v_add_f32 v48, v48, v64
v_add_f32 v49, v49, v65
v_lshlrev_b32 v64, 16, v67
v_and_b32 v65, 0xffff0000, v67
v_add_f32 v50, v50, v64
v_add_f32 v51, v51, v65
LE_fl29:
v_cvt_pk_bf16_f32 v64, v48, v49
v_cvt_pk_bf16_f32 v65, v50, v51
v_mov_b32 v48, 0
v_mov_b32 v49, 0
v_mov_b32 v50, 0
v_mov_b32 v51, 0
buffer_store_dwordx2 v[64:65], v39, s[20:23], s47 offen sc1
s_add_u32 s47, s47, 512
LE_nf29:
v_mfma_f32_16x16x32_bf16 v[48:51], a[240:243], v[40:43], v[48:51]
v_mfma_f32_16x16x32_bf16 v[48:51], a[244:247], v[44:47], v[48:51]
s_bitcmp1_b32 s46, 30
s_cbranch_scc0 LE_nf30
v_readlane_b32 s57, v80, s51
s_add_u32 s51, s51, 1
s_and_b32 s51, s51, 63
s_cbranch_scc1 LE_dg30
v_mov_b32 v80, v81
v_mov_b32 v81, v82
LE_dg30:
s_nop 3
v_mul_f32 v48, s57, v48
v_mul_f32 v49, s57, v49
v_mul_f32 v50, s57, v50
v_mul_f32 v51, s57, v51
s_cmp_eq_u32 s42, 0
s_cbranch_scc1 LE_fl30
buffer_load_dwordx2 v[66:67], v39, s[20:23], s47 offen sc1
s_waitcnt vmcnt(0)
v_lshlrev_b32 v64, 16, v66
v_and_b32 v65, 0xffff0000, v66
v_add_f32 v48, v48, v64
v_add_f32 v49, v49, v65
v_lshlrev_b32 v64, 16, v67
v_and_b32 v65, 0xffff0000, v67
v_add_f32 v50, v50, v64
v_add_f32 v51, v51, v65
LE_fl30:
v_cvt_pk_bf16_f32 v64, v48, v49
v_cvt_pk_bf16_f32 v65, v50, v51
v_mov_b32 v48, 0
v_mov_b32 v49, 0
v_mov_b32 v50, 0
v_mov_b32 v51, 0
buffer_store_dwordx2 v[64:65], v39, s[20:23], s47 offen sc1
s_add_u32 s47, s47, 512
LE_nf30:
v_mfma_f32_16x16x32_bf16 v[48:51], a[248:251], v[40:43], v[48:51]
v_mfma_f32_16x16x32_bf16 v[48:51], a[252:255], v[44:47], v[48:51]
s_bitcmp1_b32 s46, 31
s_cbranch_scc0 LE_nf31
v_readlane_b32 s57, v80, s51
s_add_u32 s51, s51, 1
s_and_b32 s51, s51, 63
s_cbranch_scc1 LE_dg31
v_mov_b32 v80, v81
v_mov_b32 v81, v82
LE_dg31:
s_nop 3
v_mul_f32 v48, s57, v48
v_mul_f32 v49, s57, v49
v_mul_f32 v50, s57, v50
v_mul_f32 v51, s57, v51
s_cmp_eq_u32 s42, 0
s_cbranch_scc1 LE_fl31
buffer_load_dwordx2 v[66:67], v39, s[20:23], s47 offen sc1
s_waitcnt vmcnt(0)
v_lshlrev_b32 v64, 16, v66
v_and_b32 v65, 0xffff0000, v66
v_add_f32 v48, v48, v64
v_add_f32 v49, v49, v65
v_lshlrev_b32 v64, 16, v67
v_and_b32 v65, 0xffff0000, v67
v_add_f32 v50, v50, v64
v_add_f32 v51, v51, v65
LE_fl31:
v_cvt_pk_bf16_f32 v64, v48, v49
v_cvt_pk_bf16_f32 v65, v50, v51
v_mov_b32 v48, 0
v_mov_b32 v49, 0
v_mov_b32 v50, 0
v_mov_b32 v51, 0
buffer_store_dwordx2 v[64:65], v39, s[20:23], s47 offen sc1
s_add_u32 s47, s47, 512
LE_nf31:
s_waitcnt lgkmcnt(0)
ds_read2_b32 v[52:53], v34 offset0:128 offset1:132
ds_read2_b32 v[54:55], v34 offset0:136 offset1:140
v_mad_u32_u16 v60, v56, s49, v2
v_mad_u32_u16 v61, v57, s49, v2
v_mad_u32_u16 v62, v58, s49, v2
v_mad_u32_u16 v63, v59, s49, v2
buffer_load_dwordx4 a[224:227], v60, s[16:19], 0 offen
buffer_load_dwordx4 a[228:231], v60, s[16:19], 0 offen offset:256
buffer_load_dwordx4 a[232:235], v61, s[16:19], 0 offen
buffer_load_dwordx4 a[236:239], v61, s[16:19], 0 offen offset:256
buffer_load_dwordx4 a[240:243], v62, s[16:19], 0 offen
buffer_load_dwordx4 a[244:247], v62, s[16:19], 0 offen offset:256
buffer_load_dwordx4 a[248:251], v63, s[16:19], 0 offen
buffer_load_dwordx4 a[252:255], v63, s[16:19], 0 offen offset:256
v_add_u32 v34, 512, v34
s_cmp_lt_u32 s45, s44
s_cbranch_scc1 LE_loop
s_add_u32 s42, s42, 1
s_mul_i32 s43, s42, 128
v_cmp_lt_u32 vcc, s43, v4
s_cbranch_vccz LE_done
s_cmp_ge_u32 s42, 40
s_cbranch_scc1 LE_done
s_waitcnt vmcnt(0) lgkmcnt(0)
s_add_u32 s50, s50, 512
v_add_u32 v5, 0x80, v5
buffer_load_dwordx4 v[192:195], v6, s[12:15], s50 offen offset:0
buffer_load_dwordx4 v[196:199], v6, s[12:15], s50 offen offset:32
buffer_load_dwordx4 v[200:203], v6, s[12:15], s50 offen offset:64
buffer_load_dwordx4 v[204:207], v6, s[12:15], s50 offen offset:96
buffer_load_dwordx4 v[208:211], v6, s[12:15], s50 offen offset:128
buffer_load_dwordx4 v[212:215], v6, s[12:15], s50 offen offset:160
buffer_load_dwordx4 v[216:219], v6, s[12:15], s50 offen offset:192
buffer_load_dwordx4 v[220:223], v6, s[12:15], s50 offen offset:224
buffer_load_dwordx4 v[224:227], v6, s[12:15], s50 offen offset:256
buffer_load_dwordx4 v[228:231], v6, s[12:15], s50 offen offset:288
buffer_load_dwordx4 v[232:235], v6, s[12:15], s50 offen offset:320
buffer_load_dwordx4 v[236:239], v6, s[12:15], s50 offen offset:352
buffer_load_dwordx4 v[240:243], v6, s[12:15], s50 offen offset:384
buffer_load_dwordx4 v[244:247], v6, s[12:15], s50 offen offset:416
buffer_load_dwordx4 v[248:251], v6, s[12:15], s50 offen offset:448
buffer_load_dwordx4 v[252:255], v6, s[12:15], s50 offen offset:480
s_branch LE_pass
LE_done:
s_add_u32 s52, s4, 0x7c00000
s_addc_u32 s53, s5, 0
s_mov_b32 s54, 0x2000
s_mov_b32 s55, 0x00020000
v_mov_b32 v20, 5120
v_mov_b32 v21, 1
s_mov_b64 exec, 1
s_waitcnt vmcnt(0)
buffer_atomic_add v21, v20, s[52:55], 0 offen
s_mov_b64 exec, -1
s_getpc_b64 s[52:53]
LE_pc:
s_sub_u32 s52, s52, LE_pc-L2_tails
s_subb_u32 s53, s53, 0
s_mov_b32 s54, LT_disp-L2_tails
s_mov_b32 s55, 0x00020000
s_mov_b64 exec, -1
v_lshlrev_b32 v30, 7, v1
s_mov_b32 s56, 0x0
buffer_load_dword v32, v30, s[52:55], s56 offen
s_mov_b32 s56, 0x2000
buffer_load_dword v33, v30, s[52:55], s56 offen
s_mov_b32 s56, 0x4000
buffer_load_dword v34, v30, s[52:55], s56 offen
s_mov_b32 s56, 0x6000
buffer_load_dword v35, v30, s[52:55], s56 offen
s_mov_b32 s56, 0x8000
buffer_load_dword v36, v30, s[52:55], s56 offen
s_mov_b32 s56, 0xa000
buffer_load_dword v37, v30, s[52:55], s56 offen
s_mov_b32 s56, 0xc000
buffer_load_dword v38, v30, s[52:55], s56 offen
s_cmp_ge_u32 s2, 240
s_cbranch_scc1 LC_help
s_branch L2_end
LC_help:
s_waitcnt vmcnt(0)
s_mov_b32 s100, 0
s_load_dwordx2 s[6:7], s[0:1], 0
s_load_dwordx2 s[18:19], s[0:1], 72
s_mov_b32 s34, s41
v_mbcnt_lo_u32_b32 v252, -1, 0
v_mbcnt_hi_u32_b32 v252, -1, v252
v_lshlrev_b32 v252, 4, v252
s_and_b32 s32, s2, 7
s_mul_i32 s32, s32, 5
s_bfe_u32 s33, s2, 0x10003
s_mul_i32 s35, s33, 3
s_add_u32 s32, s32, s35
s_add_u32 s35, s32, 0
s_lshl_b32 s48, s35, 7
s_lshl_b32 s52, s35, 17
s_add_u32 s52, s52, 122880
s_add_u32 s35, s32, 1
s_lshl_b32 s49, s35, 7
s_lshl_b32 s53, s35, 17
s_add_u32 s53, s53, 122880
s_add_u32 s35, s32, 2
s_lshl_b32 s50, s35, 7
s_lshl_b32 s54, s35, 17
s_add_u32 s54, s54, 122880
s_cmp_eq_u32 s49, 4992
s_cselect_b32 s53, 5111808, s53
s_cmp_eq_u32 s33, 1
s_cselect_b32 s54, 0x7fff0000, s54
s_cselect_b32 s50, s48, s50
s_mov_b32 s15, 0x7fff0000
s_mov_b32 s14, 0
s_mov_b32 s99, 0
s_mov_b32 s51, 0
s_mov_b32 s98, 2
s_waitcnt lgkmcnt(0)
s_add_u32 s24, s4, 0x6000000
s_addc_u32 s25, s5, 0
s_mov_b32 s26, 0x9c800
s_mov_b32 s27, 0x00020000
s_add_u32 s56, s4, 0x1000000
s_addc_u32 s57, s5, 0
s_mov_b32 s58, 0x6c02000
s_mov_b32 s59, 0x00020000
s_branch LC_common
L2_fin:
L2_end:
s_endpgm
.section .rodata,"a"
.p2align 6
.amdhsa_kernel k1_kernel
  .amdhsa_next_free_vgpr 256
  .amdhsa_next_free_sgpr 102
  .amdhsa_accum_offset 256
  .amdhsa_group_segment_fixed_size 0
  .amdhsa_kernarg_size 96
  .amdhsa_user_sgpr_count 2
  .amdhsa_user_sgpr_kernarg_segment_ptr 1
  .amdhsa_system_sgpr_workgroup_id_x 1
.end_amdhsa_kernel
.p2align 6
.amdhsa_kernel k2_kernel
  .amdhsa_next_free_vgpr 512
  .amdhsa_next_free_sgpr 102
  .amdhsa_accum_offset 256
  .amdhsa_group_segment_fixed_size 0
  .amdhsa_kernarg_size 96
  .amdhsa_user_sgpr_count 2
  .amdhsa_user_sgpr_kernarg_segment_ptr 1
  .amdhsa_system_sgpr_workgroup_id_x 1
.end_amdhsa_kernel
```

```asm
; @launch kernel=k1_kernel grid=(249,1,1) block=(512,1,1) lds=163840
; @launch kernel=k2_kernel grid=(256,1,1) block=(256,1,1) lds=163840
.amdgcn_target "amdgcn-amd-amdhsa--gfx950"
.text
.globl k1_kernel
.p2align 8
.type k1_kernel,@function
k1_kernel:
s_getpc_b64 s[56:57]
s_load_dwordx16 s[16:31], s[0:1], 0
s_load_dwordx8 s[32:39], s[0:1], 64
s_cmp_ge_u32 s2, 249
s_cbranch_scc1 L1_end
v_lshrrev_b32 v1, 6, v0
v_and_b32 v2, 63, v0
s_lshr_b32 s3, s2, 3
v_readfirstlane_b32 s60, v1
s_mul_i32 s5, s3, 8
s_add_u32 s5, s5, s60
s_and_b32 s56, s56, 0xffffff00
s_mov_b32 s58, L2_end-k1_kernel
s_mov_b32 s59, 0x00020000
s_and_b32 s6, s5, 15
s_lshl_b32 s6, s6, 13
v_lshlrev_b32 v10, 7, v2
buffer_load_dword v255, v10, s[56:59], s6 offen
v_and_b32 v3, 15, v2
v_lshrrev_b32 v4, 4, v2
s_and_b32 s62, s3, 7
s_mov_b32 s4, s2
s_cmp_ge_u32 s2, 209
s_cbranch_scc1 L1_notq
s_mov_b32 s61, 0
v_lshlrev_b32 v16, 4, v2
s_mul_i32 s63, s60, 6144
s_mul_i32 s6, s4, 24576
s_mul_i32 s7, s60, 3072
s_add_u32 s64, s6, s7
s_add_u32 s65, s64, 4096
s_lshl_b32 s7, s60, 6
v_lshrrev_b32 v5, 2, v2
v_and_b32 v6, 3, v2
v_lshrrev_b32 v7, 5, v2
v_lshlrev_b32 v7, 1, v7
v_xor_b32 v6, v6, v7
v_lshl_add_u32 v5, v5, 9, s7
v_lshl_add_u32 v17, v6, 4, v5
v_add_u32 v18, 0x1c00, v17
s_xor_b32 s6, s62, 0
s_lshl_b32 s66, s6, 14
s_xor_b32 s6, s62, 1
s_lshl_b32 s67, s6, 14
s_xor_b32 s6, s62, 2
s_lshl_b32 s68, s6, 14
s_xor_b32 s6, s62, 3
s_lshl_b32 s69, s6, 14
s_xor_b32 s6, s62, 4
s_lshl_b32 s70, s6, 14
s_xor_b32 s6, s62, 5
s_lshl_b32 s71, s6, 14
s_xor_b32 s6, s62, 6
s_lshl_b32 s72, s6, 14
s_xor_b32 s6, s62, 7
s_lshl_b32 s73, s6, 14
s_waitcnt lgkmcnt(0)
s_add_u32 s40, s16, 0x0
s_addc_u32 s41, s17, 0
s_mov_b32 s42, 0x4e2000
s_mov_b32 s43, 0x00020000
s_add_u32 s44, s26, 0x0
s_addc_u32 s45, s27, 0
s_mov_b32 s46, 0x20000
s_mov_b32 s47, 0x00020000
buffer_load_dwordx4 v[40:43], v16, s[40:43], s64 offen offset:0
buffer_load_dwordx4 v[44:47], v16, s[40:43], s64 offen offset:1024
buffer_load_dwordx4 v[48:51], v16, s[40:43], s64 offen offset:2048
s_add_u32 m0, s63, 0x0
s_nop 0
buffer_load_dwordx4 v17, s[44:47], s66 offen offset:0 lds
buffer_load_dwordx4 v18, s[44:47], s66 offen offset:1024 lds
s_add_u32 m0, s63, 0x800
s_nop 0
buffer_load_dwordx4 v17, s[44:47], s67 offen offset:0 lds
buffer_load_dwordx4 v18, s[44:47], s67 offen offset:1024 lds
v_bfe_u32 v5, v2, 2, 3
v_xor_b32 v5, s62, v5
v_and_b32 v6, 3, v2
v_lshlrev_b32 v7, 10, v5
v_lshl_add_u32 v7, v6, 8, v7
v_add_u32 v7, 0xc000, v7
v_and_b32 v5, 1, v5
v_lshl_or_b32 v6, v5, 2, v6
v_lshrrev_b32 v5, 5, v2
s_mul_i32 s6, s60, 6
v_add3_u32 v8, v5, s6, 0
v_lshrrev_b32 v9, 4, v8
v_lshl_add_u32 v9, v9, 13, v7
v_and_b32 v8, 15, v8
v_xor_b32 v8, v8, v6
v_lshl_add_u32 v36, v8, 4, v9
v_add3_u32 v8, v5, s6, 2
v_lshrrev_b32 v9, 4, v8
v_lshl_add_u32 v9, v9, 13, v7
v_and_b32 v8, 15, v8
v_xor_b32 v8, v8, v6
v_lshl_add_u32 v37, v8, 4, v9
v_add3_u32 v8, v5, s6, 4
v_lshrrev_b32 v9, 4, v8
v_lshl_add_u32 v9, v9, 13, v7
v_and_b32 v8, 15, v8
v_xor_b32 v8, v8, v6
v_lshl_add_u32 v38, v8, 4, v9
v_xor_b32 v5, v3, v4
v_lshlrev_b32 v5, 4, v5
v_lshl_add_u32 v5, v4, 8, v5
v_add_u32 v31, 0xc000, v5
v_xor_b32 v32, 64, v31
v_lshrrev_b32 v5, 2, v3
v_and_b32 v6, 3, v3
v_and_b32 v7, 1, v4
v_lshlrev_b32 v7, 1, v7
v_lshl_add_u32 v8, v4, 3, v5
v_lshlrev_b32 v8, 6, v8
v_add_u32 v8, s63, v8
v_and_b32 v9, 1, v6
v_lshl_add_u32 v8, v9, 3, v8
v_lshrrev_b32 v6, 1, v6
v_xor_b32 v6, v6, v7
v_xor_b32 v9, 0, v6
v_lshl_add_u32 v25, v9, 4, v8
v_xor_b32 v9, 2, v6
v_lshl_add_u32 v26, v9, 4, v8
v_lshrrev_b32 v5, 3, v2
v_and_b32 v6, 7, v2
v_lshrrev_b32 v7, 1, v5
v_xor_b32 v6, v6, v7
v_and_b32 v7, 4, v5
v_add_u32 v5, v5, v7
s_mul_i32 s6, s60, 16384
v_lshl_add_u32 v5, v5, 9, s6
v_lshl_add_u32 v21, v6, 4, v5
v_xor_b32 v6, 4, v6
v_lshl_add_u32 v22, v6, 4, v5
v_add_u32 v22, 0x1c00, v22
s_lshr_b32 s7, s62, 1
s_xor_b32 s6, s7, 0
s_lshl_b32 s74, s6, 7
s_add_u32 s75, s74, 2048
s_xor_b32 s6, s7, 1
s_lshl_b32 s76, s6, 7
s_add_u32 s77, s76, 2048
s_xor_b32 s6, s7, 2
s_lshl_b32 s78, s6, 7
s_add_u32 s79, s78, 2048
s_xor_b32 s6, s7, 3
s_lshl_b32 s80, s6, 7
s_add_u32 s81, s80, 2048
s_and_b32 s6, s62, 1
s_lshl_b32 s6, s6, 2
v_lshrrev_b32 v5, 1, v3
v_xor_b32 v5, v5, v4
v_xor_b32 v5, s6, v5
v_lshl_add_u32 v6, v3, 7, s63
v_lshl_add_u32 v29, v5, 4, v6
v_xor_b32 v30, 64, v29
s_mul_i32 s6, s60, 1
s_xor_b32 s6, s6, s62
s_lshl_b32 s6, s6, 10
s_add_u32 s6, s6, 0x12000
v_lshrrev_b32 v5, 1, v4
v_and_b32 v6, 1, v4
v_lshl_add_u32 v5, v5, 8, s6
v_lshl_add_u32 v5, v6, 3, v5
v_lshl_add_u32 v33, v3, 4, v5
v_xor_b32 v34, 0x400, v33
v_add_u32 v35, 0x12000, v16
s_mul_i32 s6, s4, 24576
s_mul_i32 s7, s60, 1024
s_add_u32 s82, s6, s7
s_add_u32 s83, s82, 8192
s_add_u32 s84, s82, 16384
s_mov_b32 s86, 0x3db8aa3b
s_mov_b32 s87, 0x3db8aa3b
s_mov_b32 s88, 0x3727c5ac
s_mov_b32 s89, 0x3b800000
s_mov_b32 s90, 0xffff0000
s_add_u32 s48, s28, 0x0
s_addc_u32 s49, s29, 0
s_mov_b32 s50, 0x20000
s_mov_b32 s51, 0x00020000
s_add_u32 s52, s38, 0x0
s_addc_u32 s53, s39, 0
s_mov_b32 s54, 0x4e4000
s_mov_b32 s55, 0x00020000
s_add_u32 s56, s38, 0x6800000
s_addc_u32 s57, s39, 0
s_mov_b32 s58, 0x4e4000
s_mov_b32 s59, 0x00020000
v_lshlrev_b32 v11, 4, v4
s_lshr_b32 s8, s66, 8
buffer_load_dwordx4 v[172:175], v11, s[48:51], s8 offen
s_lshr_b32 s8, s67, 8
buffer_load_dwordx4 v[176:179], v11, s[48:51], s8 offen
s_lshr_b32 s8, s68, 8
buffer_load_dwordx4 v[180:183], v11, s[48:51], s8 offen
s_lshr_b32 s8, s69, 8
buffer_load_dwordx4 v[184:187], v11, s[48:51], s8 offen
s_lshr_b32 s8, s70, 8
buffer_load_dwordx4 v[188:191], v11, s[48:51], s8 offen
s_lshr_b32 s8, s71, 8
buffer_load_dwordx4 v[192:195], v11, s[48:51], s8 offen
s_lshr_b32 s8, s72, 8
buffer_load_dwordx4 v[196:199], v11, s[48:51], s8 offen
s_lshr_b32 s8, s73, 8
buffer_load_dwordx4 v[200:203], v11, s[48:51], s8 offen
s_waitcnt vmcnt(14)
v_lshlrev_b32 v76, 16, v40
v_and_b32 v77, s90, v40
v_lshlrev_b32 v78, 16, v41
v_and_b32 v79, s90, v41
v_lshlrev_b32 v80, 16, v42
v_and_b32 v81, s90, v42
v_lshlrev_b32 v82, 16, v43
v_and_b32 v83, s90, v43
v_pk_add_f32 v[100:101], v[76:77], v[78:79]
v_pk_mul_f32 v[102:103], v[76:77], v[76:77]
v_pk_add_f32 v[40:41], v[80:81], v[82:83]
v_pk_fma_f32 v[102:103], v[78:79], v[78:79], v[102:103]
v_pk_add_f32 v[100:101], v[100:101], v[40:41]
v_pk_fma_f32 v[102:103], v[80:81], v[80:81], v[102:103]
v_add_f32 v100, v100, v101
v_pk_fma_f32 v[102:103], v[82:83], v[82:83], v[102:103]
v_add_f32 v102, v102, v103
s_waitcnt vmcnt(13)
v_lshlrev_b32 v84, 16, v44
v_and_b32 v85, s90, v44
v_lshlrev_b32 v86, 16, v45
v_and_b32 v87, s90, v45
v_lshlrev_b32 v88, 16, v46
v_and_b32 v89, s90, v46
v_lshlrev_b32 v90, 16, v47
v_and_b32 v91, s90, v47
v_pk_add_f32 v[104:105], v[84:85], v[86:87]
v_pk_mul_f32 v[106:107], v[84:85], v[84:85]
v_pk_add_f32 v[44:45], v[88:89], v[90:91]
v_pk_fma_f32 v[106:107], v[86:87], v[86:87], v[106:107]
v_pk_add_f32 v[104:105], v[104:105], v[44:45]
v_pk_fma_f32 v[106:107], v[88:89], v[88:89], v[106:107]
v_add_f32 v104, v104, v105
v_pk_fma_f32 v[106:107], v[90:91], v[90:91], v[106:107]
v_add_f32 v106, v106, v107
s_waitcnt vmcnt(12)
v_lshlrev_b32 v92, 16, v48
v_and_b32 v93, s90, v48
v_lshlrev_b32 v94, 16, v49
v_and_b32 v95, s90, v49
v_lshlrev_b32 v96, 16, v50
v_and_b32 v97, s90, v50
v_lshlrev_b32 v98, 16, v51
v_and_b32 v99, s90, v51
v_pk_add_f32 v[108:109], v[92:93], v[94:95]
v_pk_mul_f32 v[110:111], v[92:93], v[92:93]
v_pk_add_f32 v[48:49], v[96:97], v[98:99]
v_pk_fma_f32 v[110:111], v[94:95], v[94:95], v[110:111]
v_pk_add_f32 v[108:109], v[108:109], v[48:49]
v_pk_fma_f32 v[110:111], v[96:97], v[96:97], v[110:111]
v_add_f32 v108, v108, v109
v_pk_fma_f32 v[110:111], v[98:99], v[98:99], v[110:111]
v_add_f32 v110, v110, v111
v_permlane16_swap_b32 v100, v102
v_permlane16_swap_b32 v104, v106
v_permlane16_swap_b32 v108, v110
v_add_f32 v100, v100, v102
v_add_f32 v104, v104, v106
v_add_f32 v108, v108, v110
v_add_f32_dpp v101, v100, v100 row_ror:8 row_mask:0xf bank_mask:0x3
v_add_f32_dpp v101, v104, v104 row_ror:8 row_mask:0xf bank_mask:0xc
v_add_f32_dpp v109, v108, v108 row_ror:8 row_mask:0xf bank_mask:0xf
s_nop 0
v_add_f32_dpp v102, v101, v101 row_half_mirror row_mask:0xf bank_mask:0x5
v_add_f32_dpp v102, v109, v109 row_half_mirror row_mask:0xf bank_mask:0xa
s_nop 1
v_add_f32_dpp v102, v102, v102 quad_perm:[1,0,3,2] row_mask:0xf bank_mask:0xf
s_nop 1
v_add_f32_dpp v102, v102, v102 quad_perm:[2,3,0,1] row_mask:0xf bank_mask:0xf
v_mov_b32 v103, v102
s_nop 1
v_permlane16_swap_b32 v103, v102
v_mul_f32 v103, s89, v103
v_mul_f32 v102, s89, v102
v_fma_f32 v102, -v103, v103, v102
v_max_f32 v102, 0, v102
v_cvt_pk_bf16_f32 v102, v102, v102
v_and_b32 v102, s90, v102
v_add_f32 v102, s88, v102
v_cvt_pk_bf16_f32 v102, v102, v102
v_and_b32 v102, s90, v102
v_sqrt_f32 v102, v102
s_nop 0
v_cvt_pk_bf16_f32 v102, v102, v102
v_and_b32 v102, s90, v102
v_rcp_f32 v102, v102
s_nop 0
v_mul_f32 v103, -v103, v102
s_nop 1
v_mov_b64_dpp v[100:101], v[102:103] row_newbcast:0 row_mask:0xf bank_mask:0xf
v_mov_b64_dpp v[104:105], v[102:103] row_newbcast:8 row_mask:0xf bank_mask:0xf
v_mov_b64_dpp v[108:109], v[102:103] row_newbcast:4 row_mask:0xf bank_mask:0xf
v_fma_f32 v76, v76, v100, v101
v_fma_f32 v77, v77, v100, v101
v_fma_f32 v78, v78, v100, v101
v_fma_f32 v79, v79, v100, v101
v_fma_f32 v80, v80, v100, v101
v_fma_f32 v81, v81, v100, v101
v_fma_f32 v82, v82, v100, v101
v_fma_f32 v83, v83, v100, v101
v_cvt_pk_bf16_f32 v40, v76, v77
v_cvt_pk_bf16_f32 v41, v78, v79
v_cvt_pk_bf16_f32 v42, v80, v81
v_cvt_pk_bf16_f32 v43, v82, v83
ds_write_b128 v36, v[40:43]
v_fma_f32 v84, v84, v104, v105
v_fma_f32 v85, v85, v104, v105
v_fma_f32 v86, v86, v104, v105
v_fma_f32 v87, v87, v104, v105
v_fma_f32 v88, v88, v104, v105
v_fma_f32 v89, v89, v104, v105
v_fma_f32 v90, v90, v104, v105
v_fma_f32 v91, v91, v104, v105
v_cvt_pk_bf16_f32 v44, v84, v85
v_cvt_pk_bf16_f32 v45, v86, v87
v_cvt_pk_bf16_f32 v46, v88, v89
v_cvt_pk_bf16_f32 v47, v90, v91
ds_write_b128 v37, v[44:47]
v_fma_f32 v92, v92, v108, v109
v_fma_f32 v93, v93, v108, v109
v_fma_f32 v94, v94, v108, v109
v_fma_f32 v95, v95, v108, v109
v_fma_f32 v96, v96, v108, v109
v_fma_f32 v97, v97, v108, v109
v_fma_f32 v98, v98, v108, v109
v_fma_f32 v99, v99, v108, v109
v_cvt_pk_bf16_f32 v48, v92, v93
v_cvt_pk_bf16_f32 v49, v94, v95
v_cvt_pk_bf16_f32 v50, v96, v97
v_cvt_pk_bf16_f32 v51, v98, v99
ds_write_b128 v38, v[48:51]
s_add_u32 m0, s63, 0x1000
s_nop 0
buffer_load_dwordx4 v17, s[44:47], s68 offen offset:0 lds
buffer_load_dwordx4 v18, s[44:47], s68 offen offset:1024 lds
s_waitcnt vmcnt(12)
ds_read_b64_tr_b16 v[100:101], v25 offset:0
ds_read_b64_tr_b16 v[102:103], v25 offset:256
ds_read_b64_tr_b16 v[104:105], v26 offset:0
ds_read_b64_tr_b16 v[106:107], v26 offset:256
s_waitcnt lgkmcnt(4)
s_barrier
ds_read_b128 v[124:127], v31 offset:0
ds_read_b128 v[128:131], v31 offset:8192
ds_read_b128 v[132:135], v31 offset:16384
ds_read_b128 v[136:139], v32 offset:1024
s_waitcnt vmcnt(10)
ds_read_b64_tr_b16 v[108:109], v25 offset:2048
ds_read_b64_tr_b16 v[110:111], v25 offset:2304
s_waitcnt lgkmcnt(5)
v_mfma_f32_16x16x32_bf16 v[52:55], v[100:103], v[124:127], 0
ds_read_b128 v[140:143], v32 offset:9216
s_waitcnt lgkmcnt(5)
v_mfma_f32_16x16x32_bf16 v[56:59], v[100:103], v[128:131], 0
ds_read_b128 v[144:147], v32 offset:17408
s_waitcnt lgkmcnt(5)
v_mfma_f32_16x16x32_bf16 v[60:63], v[100:103], v[132:135], 0
ds_read_b64_tr_b16 v[112:113], v26 offset:2048
ds_read_b64_tr_b16 v[114:115], v26 offset:2304
v_mfma_f32_16x16x32_bf16 v[64:67], v[104:107], v[124:127], 0
s_add_u32 m0, s63, 0x0
s_nop 0
buffer_load_dwordx4 v17, s[44:47], s69 offen offset:0 lds
buffer_load_dwordx4 v18, s[44:47], s69 offen offset:1024 lds
v_mfma_f32_16x16x32_bf16 v[68:71], v[104:107], v[128:131], 0
v_and_b32 v5, 31, v2
v_lshrrev_b32 v6, 5, v2
v_mfma_f32_16x16x32_bf16 v[72:75], v[104:107], v[132:135], 0
ds_read_b128 v[148:151], v31 offset:2048
s_waitcnt vmcnt(2)
ds_read_b64_tr_b16 v[116:117], v25 offset:4096
ds_read_b64_tr_b16 v[118:119], v25 offset:4352
s_waitcnt lgkmcnt(7)
v_mfma_f32_16x16x32_bf16 v[52:55], v[108:111], v[136:139], v[52:55]
ds_read_b128 v[152:155], v31 offset:10240
s_lshr_b32 s6, s64, 9
s_waitcnt lgkmcnt(7)
v_mfma_f32_16x16x32_bf16 v[56:59], v[108:111], v[140:143], v[56:59]
ds_read_b128 v[156:159], v31 offset:18432
v_cmp_eq_u32 vcc, 0, v5
s_waitcnt lgkmcnt(7)
v_mfma_f32_16x16x32_bf16 v[60:63], v[108:111], v[144:147], v[60:63]
ds_read_b64_tr_b16 v[120:121], v26 offset:4096
ds_read_b64_tr_b16 v[122:123], v26 offset:4352
s_waitcnt lgkmcnt(7)
v_mfma_f32_16x16x32_bf16 v[64:67], v[112:115], v[136:139], v[64:67]
s_add_u32 m0, s63, 0x800
s_nop 0
buffer_load_dwordx4 v17, s[44:47], s70 offen offset:0 lds
buffer_load_dwordx4 v18, s[44:47], s70 offen offset:1024 lds
v_mfma_f32_16x16x32_bf16 v[68:71], v[112:115], v[140:143], v[68:71]
s_sub_u32 s6, 10000, s6
v_mov_b32 v7, 0x7fffffff
v_mfma_f32_16x16x32_bf16 v[72:75], v[112:115], v[144:147], v[72:75]
ds_read_b128 v[160:163], v32 offset:3072
s_waitcnt vmcnt(2)
ds_read_b64_tr_b16 v[100:101], v25 offset:0
ds_read_b64_tr_b16 v[102:103], v25 offset:256
s_waitcnt lgkmcnt(7)
v_mfma_f32_16x16x32_bf16 v[52:55], v[116:119], v[148:151], v[52:55]
ds_read_b128 v[164:167], v32 offset:11264
v_cndmask_b32 v6, v7, v6, vcc
s_waitcnt lgkmcnt(7)
v_mfma_f32_16x16x32_bf16 v[56:59], v[116:119], v[152:155], v[56:59]
ds_read_b128 v[168:171], v32 offset:19456
v_cmp_gt_i32 vcc, s6, v6
s_waitcnt lgkmcnt(7)
v_mfma_f32_16x16x32_bf16 v[60:63], v[116:119], v[156:159], v[60:63]
ds_read_b64_tr_b16 v[104:105], v26 offset:0
ds_read_b64_tr_b16 v[106:107], v26 offset:256
s_waitcnt lgkmcnt(7)
v_mfma_f32_16x16x32_bf16 v[64:67], v[120:123], v[148:151], v[64:67]
s_add_u32 m0, s63, 0x1000
s_nop 0
buffer_load_dwordx4 v17, s[44:47], s71 offen offset:0 lds
buffer_load_dwordx4 v18, s[44:47], s71 offen offset:1024 lds
v_mfma_f32_16x16x32_bf16 v[68:71], v[120:123], v[152:155], v[68:71]
v_and_b32 v5, s90, v40
v_or_b32 v5, 0x3f80, v5
v_mfma_f32_16x16x32_bf16 v[72:75], v[120:123], v[156:159], v[72:75]
ds_read_b128 v[124:127], v31 offset:4096
s_waitcnt vmcnt(2)
ds_read_b64_tr_b16 v[108:109], v25 offset:2048
ds_read_b64_tr_b16 v[110:111], v25 offset:2304
s_waitcnt lgkmcnt(7)
v_mfma_f32_16x16x32_bf16 v[52:55], v[100:103], v[160:163], v[52:55]
ds_read_b128 v[128:131], v31 offset:12288
s_sub_u32 s6, s6, 2
s_waitcnt lgkmcnt(7)
v_mfma_f32_16x16x32_bf16 v[56:59], v[100:103], v[164:167], v[56:59]
ds_read_b128 v[132:135], v31 offset:20480
v_cndmask_b32 v40, v40, v5, vcc
s_waitcnt lgkmcnt(7)
v_mfma_f32_16x16x32_bf16 v[60:63], v[100:103], v[168:171], v[60:63]
ds_read_b64_tr_b16 v[112:113], v26 offset:2048
ds_read_b64_tr_b16 v[114:115], v26 offset:2304
s_waitcnt lgkmcnt(7)
v_mfma_f32_16x16x32_bf16 v[64:67], v[104:107], v[160:163], v[64:67]
s_add_u32 m0, s63, 0x0
s_nop 0
buffer_load_dwordx4 v17, s[44:47], s72 offen offset:0 lds
buffer_load_dwordx4 v18, s[44:47], s72 offen offset:1024 lds
v_mfma_f32_16x16x32_bf16 v[68:71], v[104:107], v[164:167], v[68:71]
v_cmp_gt_i32 vcc, s6, v6
v_and_b32 v5, s90, v44
v_mfma_f32_16x16x32_bf16 v[72:75], v[104:107], v[168:171], v[72:75]
ds_read_b128 v[136:139], v32 offset:5120
s_waitcnt vmcnt(2)
ds_read_b64_tr_b16 v[116:117], v25 offset:4096
ds_read_b64_tr_b16 v[118:119], v25 offset:4352
s_waitcnt lgkmcnt(7)
v_mfma_f32_16x16x32_bf16 v[52:55], v[108:111], v[124:127], v[52:55]
ds_read_b128 v[140:143], v32 offset:13312
v_or_b32 v5, 0x3f80, v5
s_waitcnt lgkmcnt(7)
v_mfma_f32_16x16x32_bf16 v[56:59], v[108:111], v[128:131], v[56:59]
ds_read_b128 v[144:147], v32 offset:21504
s_sub_u32 s6, s6, 2
s_waitcnt lgkmcnt(7)
v_mfma_f32_16x16x32_bf16 v[60:63], v[108:111], v[132:135], v[60:63]
ds_read_b64_tr_b16 v[120:121], v26 offset:4096
ds_read_b64_tr_b16 v[122:123], v26 offset:4352
s_waitcnt lgkmcnt(7)
v_mfma_f32_16x16x32_bf16 v[64:67], v[112:115], v[124:127], v[64:67]
s_add_u32 m0, s63, 0x800
s_nop 0
buffer_load_dwordx4 v17, s[44:47], s73 offen offset:0 lds
buffer_load_dwordx4 v18, s[44:47], s73 offen offset:1024 lds
v_mfma_f32_16x16x32_bf16 v[68:71], v[112:115], v[128:131], v[68:71]
v_cndmask_b32 v44, v44, v5, vcc
v_cmp_gt_i32 vcc, s6, v6
v_mfma_f32_16x16x32_bf16 v[72:75], v[112:115], v[132:135], v[72:75]
ds_read_b128 v[148:151], v31 offset:6144
s_waitcnt vmcnt(2)
ds_read_b64_tr_b16 v[100:101], v25 offset:0
ds_read_b64_tr_b16 v[102:103], v25 offset:256
s_waitcnt lgkmcnt(7)
v_mfma_f32_16x16x32_bf16 v[52:55], v[116:119], v[136:139], v[52:55]
ds_read_b128 v[152:155], v31 offset:14336
v_and_b32 v5, s90, v48
s_waitcnt lgkmcnt(7)
v_mfma_f32_16x16x32_bf16 v[56:59], v[116:119], v[140:143], v[56:59]
ds_read_b128 v[156:159], v31 offset:22528
v_or_b32 v5, 0x3f80, v5
s_waitcnt lgkmcnt(7)
v_mfma_f32_16x16x32_bf16 v[60:63], v[116:119], v[144:147], v[60:63]
ds_read_b64_tr_b16 v[104:105], v26 offset:0
ds_read_b64_tr_b16 v[106:107], v26 offset:256
s_waitcnt lgkmcnt(7)
v_mfma_f32_16x16x32_bf16 v[64:67], v[120:123], v[136:139], v[64:67]
s_add_u32 m0, s63, 0x1000
s_nop 0
buffer_load_dwordx4 v21, s[48:51], s74 offen offset:0 lds
buffer_load_dwordx4 v22, s[48:51], s74 offen offset:1024 lds
v_mfma_f32_16x16x32_bf16 v[68:71], v[120:123], v[140:143], v[68:71]
s_sub_u32 s6, s6, 2
v_cndmask_b32 v48, v48, v5, vcc
v_mfma_f32_16x16x32_bf16 v[72:75], v[120:123], v[144:147], v[72:75]
ds_read_b128 v[160:163], v32 offset:7168
s_waitcnt vmcnt(2)
ds_read_b64_tr_b16 v[108:109], v25 offset:2048
ds_read_b64_tr_b16 v[110:111], v25 offset:2304
s_waitcnt lgkmcnt(7)
v_mfma_f32_16x16x32_bf16 v[52:55], v[100:103], v[148:151], v[52:55]
ds_read_b128 v[164:167], v32 offset:15360
s_waitcnt lgkmcnt(7)
v_mfma_f32_16x16x32_bf16 v[56:59], v[100:103], v[152:155], v[56:59]
ds_read_b128 v[168:171], v32 offset:23552
s_waitcnt lgkmcnt(7)
v_mfma_f32_16x16x32_bf16 v[60:63], v[100:103], v[156:159], v[60:63]
ds_read_b64_tr_b16 v[112:113], v26 offset:2048
ds_read_b64_tr_b16 v[114:115], v26 offset:2304
s_waitcnt lgkmcnt(7)
v_mfma_f32_16x16x32_bf16 v[64:67], v[104:107], v[148:151], v[64:67]
s_add_u32 m0, s63, 0x0
s_nop 0
buffer_load_dwordx4 v21, s[48:51], s75 offen offset:0 lds
buffer_load_dwordx4 v22, s[48:51], s75 offen offset:1024 lds
v_mfma_f32_16x16x32_bf16 v[68:71], v[104:107], v[152:155], v[68:71]
v_mfma_f32_16x16x32_bf16 v[72:75], v[104:107], v[156:159], v[72:75]
s_waitcnt lgkmcnt(4)
v_mfma_f32_16x16x32_bf16 v[52:55], v[108:111], v[160:163], v[52:55]
s_waitcnt lgkmcnt(3)
v_mfma_f32_16x16x32_bf16 v[56:59], v[108:111], v[164:167], v[56:59]
s_waitcnt lgkmcnt(2)
v_mfma_f32_16x16x32_bf16 v[60:63], v[108:111], v[168:171], v[60:63]
s_waitcnt lgkmcnt(0)
v_mfma_f32_16x16x32_bf16 v[64:67], v[112:115], v[160:163], v[64:67]
s_nop 1
v_cvt_pk_bf16_f32 v52, v52, v53
v_cvt_pk_bf16_f32 v53, v54, v55
ds_write_b64 v33, v[52:53] offset:0
s_add_u32 m0, s63, 0x800
s_nop 0
buffer_load_dwordx4 v21, s[48:51], s76 offen offset:0 lds
buffer_load_dwordx4 v22, s[48:51], s76 offen offset:1024 lds
v_mfma_f32_16x16x32_bf16 v[68:71], v[112:115], v[164:167], v[68:71]
v_cvt_pk_bf16_f32 v56, v56, v57
v_cvt_pk_bf16_f32 v57, v58, v59
ds_write_b64 v33, v[56:57] offset:8192
v_mfma_f32_16x16x32_bf16 v[72:75], v[112:115], v[168:171], v[72:75]
v_cvt_pk_bf16_f32 v60, v60, v61
v_cvt_pk_bf16_f32 v61, v62, v63
ds_write_b64 v33, v[60:61] offset:16384
v_cvt_pk_bf16_f32 v64, v64, v65
v_cvt_pk_bf16_f32 v65, v66, v67
ds_write_b64 v33, v[64:65] offset:512
v_cvt_pk_bf16_f32 v68, v68, v69
v_cvt_pk_bf16_f32 v69, v70, v71
ds_write_b64 v33, v[68:69] offset:8704
v_cvt_pk_bf16_f32 v72, v72, v73
v_cvt_pk_bf16_f32 v73, v74, v75
ds_write_b64 v33, v[72:73] offset:16896
s_waitcnt vmcnt(4)
ds_read_b128 v[116:119], v29 offset:4096
ds_read_b128 v[120:123], v30 offset:4096
s_waitcnt lgkmcnt(2)
s_barrier
ds_read_b128 v[124:127], v35 offset:0
ds_read_b128 v[128:131], v35 offset:8192
ds_read_b128 v[132:135], v35 offset:16384
ds_read_b128 v[136:139], v35 offset:1024
s_waitcnt lgkmcnt(3)
v_mfma_f32_16x16x32_bf16 v[76:79], v[116:119], v[124:127], 0
ds_read_b128 v[140:143], v35 offset:9216
s_waitcnt lgkmcnt(3)
v_mfma_f32_16x16x32_bf16 v[84:87], v[116:119], v[128:131], 0
ds_read_b128 v[144:147], v35 offset:17408
s_waitcnt lgkmcnt(3)
v_mfma_f32_16x16x32_bf16 v[92:95], v[116:119], v[132:135], 0
v_mfma_f32_16x16x32_bf16 v[204:207], v[172:175], v[124:127], 0
v_mfma_f32_16x16x32_bf16 v[208:211], v[172:175], v[128:131], 0
v_mfma_f32_16x16x32_bf16 v[212:215], v[172:175], v[132:135], 0
s_waitcnt vmcnt(2)
ds_read_b128 v[100:103], v29 offset:0
s_waitcnt lgkmcnt(3)
v_mfma_f32_16x16x32_bf16 v[76:79], v[120:123], v[136:139], v[76:79]
s_add_u32 m0, s63, 0x1000
s_nop 0
buffer_load_dwordx4 v21, s[48:51], s77 offen offset:0 lds
buffer_load_dwordx4 v22, s[48:51], s77 offen offset:1024 lds
s_waitcnt lgkmcnt(2)
v_mfma_f32_16x16x32_bf16 v[84:87], v[120:123], v[140:143], v[84:87]
s_waitcnt lgkmcnt(1)
v_mfma_f32_16x16x32_bf16 v[92:95], v[120:123], v[144:147], v[92:95]
ds_read_b128 v[104:107], v30 offset:0
v_mfma_f32_16x16x32_bf16 v[204:207], v[176:179], v[136:139], v[204:207]
v_mfma_f32_16x16x32_bf16 v[208:211], v[176:179], v[140:143], v[208:211]
v_mfma_f32_16x16x32_bf16 v[212:215], v[176:179], v[144:147], v[212:215]
ds_read_b128 v[148:151], v35 offset:2048
s_waitcnt vmcnt(2)
ds_read_b128 v[108:111], v29 offset:2048
s_waitcnt lgkmcnt(3)
v_mfma_f32_16x16x32_bf16 v[80:83], v[100:103], v[124:127], 0
ds_read_b128 v[152:155], v35 offset:10240
v_mfma_f32_16x16x32_bf16 v[88:91], v[100:103], v[128:131], 0
ds_read_b128 v[156:159], v35 offset:18432
v_mfma_f32_16x16x32_bf16 v[96:99], v[100:103], v[132:135], 0
s_waitcnt lgkmcnt(4)
v_mfma_f32_16x16x32_bf16 v[80:83], v[104:107], v[136:139], v[80:83]
s_add_u32 m0, s63, 0x0
s_nop 0
buffer_load_dwordx4 v21, s[48:51], s78 offen offset:0 lds
buffer_load_dwordx4 v22, s[48:51], s78 offen offset:1024 lds
v_mfma_f32_16x16x32_bf16 v[88:91], v[104:107], v[140:143], v[88:91]
v_mfma_f32_16x16x32_bf16 v[96:99], v[104:107], v[144:147], v[96:99]
ds_read_b128 v[160:163], v35 offset:3072
ds_read_b128 v[112:115], v30 offset:2048
s_waitcnt lgkmcnt(4)
v_mfma_f32_16x16x32_bf16 v[76:79], v[108:111], v[148:151], v[76:79]
ds_read_b128 v[164:167], v35 offset:11264
s_waitcnt lgkmcnt(4)
v_mfma_f32_16x16x32_bf16 v[84:87], v[108:111], v[152:155], v[84:87]
ds_read_b128 v[168:171], v35 offset:19456
s_waitcnt lgkmcnt(4)
v_mfma_f32_16x16x32_bf16 v[92:95], v[108:111], v[156:159], v[92:95]
v_mfma_f32_16x16x32_bf16 v[204:207], v[180:183], v[148:151], v[204:207]
v_mfma_f32_16x16x32_bf16 v[208:211], v[180:183], v[152:155], v[208:211]
v_mfma_f32_16x16x32_bf16 v[212:215], v[180:183], v[156:159], v[212:215]
s_waitcnt vmcnt(2)
ds_read_b128 v[116:119], v29 offset:4096
s_waitcnt lgkmcnt(3)
v_mfma_f32_16x16x32_bf16 v[76:79], v[112:115], v[160:163], v[76:79]
s_add_u32 m0, s63, 0x800
s_nop 0
buffer_load_dwordx4 v21, s[48:51], s79 offen offset:0 lds
buffer_load_dwordx4 v22, s[48:51], s79 offen offset:1024 lds
s_waitcnt lgkmcnt(2)
v_mfma_f32_16x16x32_bf16 v[84:87], v[112:115], v[164:167], v[84:87]
s_waitcnt lgkmcnt(1)
v_mfma_f32_16x16x32_bf16 v[92:95], v[112:115], v[168:171], v[92:95]
ds_read_b128 v[120:123], v30 offset:4096
v_mfma_f32_16x16x32_bf16 v[204:207], v[184:187], v[160:163], v[204:207]
v_mfma_f32_16x16x32_bf16 v[208:211], v[184:187], v[164:167], v[208:211]
v_mfma_f32_16x16x32_bf16 v[212:215], v[184:187], v[168:171], v[212:215]
ds_read_b128 v[124:127], v35 offset:4096
s_waitcnt vmcnt(2)
ds_read_b128 v[100:103], v29 offset:0
s_waitcnt lgkmcnt(3)
v_mfma_f32_16x16x32_bf16 v[80:83], v[116:119], v[148:151], v[80:83]
ds_read_b128 v[128:131], v35 offset:12288
v_mfma_f32_16x16x32_bf16 v[88:91], v[116:119], v[152:155], v[88:91]
ds_read_b128 v[132:135], v35 offset:20480
v_mfma_f32_16x16x32_bf16 v[96:99], v[116:119], v[156:159], v[96:99]
s_waitcnt lgkmcnt(4)
v_mfma_f32_16x16x32_bf16 v[80:83], v[120:123], v[160:163], v[80:83]
s_add_u32 m0, s63, 0x1000
s_nop 0
buffer_load_dwordx4 v21, s[48:51], s80 offen offset:0 lds
buffer_load_dwordx4 v22, s[48:51], s80 offen offset:1024 lds
v_mfma_f32_16x16x32_bf16 v[88:91], v[120:123], v[164:167], v[88:91]
v_mfma_f32_16x16x32_bf16 v[96:99], v[120:123], v[168:171], v[96:99]
ds_read_b128 v[136:139], v35 offset:5120
ds_read_b128 v[104:107], v30 offset:0
s_waitcnt lgkmcnt(4)
v_mfma_f32_16x16x32_bf16 v[76:79], v[100:103], v[124:127], v[76:79]
ds_read_b128 v[140:143], v35 offset:13312
s_waitcnt lgkmcnt(4)
v_mfma_f32_16x16x32_bf16 v[84:87], v[100:103], v[128:131], v[84:87]
ds_read_b128 v[144:147], v35 offset:21504
s_waitcnt lgkmcnt(4)
v_mfma_f32_16x16x32_bf16 v[92:95], v[100:103], v[132:135], v[92:95]
v_mfma_f32_16x16x32_bf16 v[204:207], v[188:191], v[124:127], v[204:207]
v_mfma_f32_16x16x32_bf16 v[208:211], v[188:191], v[128:131], v[208:211]
v_mfma_f32_16x16x32_bf16 v[212:215], v[188:191], v[132:135], v[212:215]
s_waitcnt vmcnt(2)
ds_read_b128 v[108:111], v29 offset:2048
s_waitcnt lgkmcnt(3)
v_mfma_f32_16x16x32_bf16 v[76:79], v[104:107], v[136:139], v[76:79]
s_add_u32 m0, s63, 0x0
s_nop 0
buffer_load_dwordx4 v21, s[48:51], s81 offen offset:0 lds
buffer_load_dwordx4 v22, s[48:51], s81 offen offset:1024 lds
s_waitcnt lgkmcnt(2)
v_mfma_f32_16x16x32_bf16 v[84:87], v[104:107], v[140:143], v[84:87]
buffer_store_dwordx4 v[40:43], v16, s[56:59], s64 offen offset:0 sc1
buffer_store_dwordx4 v[44:47], v16, s[56:59], s64 offen offset:1024 sc1
s_waitcnt lgkmcnt(1)
v_mfma_f32_16x16x32_bf16 v[92:95], v[104:107], v[144:147], v[92:95]
ds_read_b128 v[112:115], v30 offset:2048
buffer_store_dwordx4 v[48:51], v16, s[56:59], s64 offen offset:2048 sc1
v_mfma_f32_16x16x32_bf16 v[204:207], v[192:195], v[136:139], v[204:207]
v_mfma_f32_16x16x32_bf16 v[208:211], v[192:195], v[140:143], v[208:211]
v_mfma_f32_16x16x32_bf16 v[212:215], v[192:195], v[144:147], v[212:215]
ds_read_b128 v[148:151], v35 offset:6144
s_waitcnt vmcnt(5)
ds_read_b128 v[116:119], v29 offset:4096
s_waitcnt lgkmcnt(3)
v_mfma_f32_16x16x32_bf16 v[80:83], v[108:111], v[124:127], v[80:83]
ds_read_b128 v[152:155], v35 offset:14336
v_mfma_f32_16x16x32_bf16 v[88:91], v[108:111], v[128:131], v[88:91]
ds_read_b128 v[156:159], v35 offset:22528
v_mfma_f32_16x16x32_bf16 v[96:99], v[108:111], v[132:135], v[96:99]
s_waitcnt lgkmcnt(4)
v_mfma_f32_16x16x32_bf16 v[80:83], v[112:115], v[136:139], v[80:83]
v_mfma_f32_16x16x32_bf16 v[88:91], v[112:115], v[140:143], v[88:91]
v_mfma_f32_16x16x32_bf16 v[96:99], v[112:115], v[144:147], v[96:99]
ds_read_b128 v[160:163], v35 offset:7168
ds_read_b128 v[120:123], v30 offset:4096
s_waitcnt lgkmcnt(4)
v_mfma_f32_16x16x32_bf16 v[76:79], v[116:119], v[148:151], v[76:79]
ds_read_b128 v[164:167], v35 offset:15360
s_waitcnt lgkmcnt(4)
v_mfma_f32_16x16x32_bf16 v[84:87], v[116:119], v[152:155], v[84:87]
ds_read_b128 v[168:171], v35 offset:23552
s_waitcnt lgkmcnt(4)
v_mfma_f32_16x16x32_bf16 v[92:95], v[116:119], v[156:159], v[92:95]
v_mfma_f32_16x16x32_bf16 v[204:207], v[196:199], v[148:151], v[204:207]
v_mfma_f32_16x16x32_bf16 v[208:211], v[196:199], v[152:155], v[208:211]
v_mfma_f32_16x16x32_bf16 v[212:215], v[196:199], v[156:159], v[212:215]
s_waitcnt vmcnt(3)
ds_read_b128 v[100:103], v29 offset:0
s_waitcnt lgkmcnt(3)
v_mfma_f32_16x16x32_bf16 v[76:79], v[120:123], v[160:163], v[76:79]
s_waitcnt lgkmcnt(2)
v_mfma_f32_16x16x32_bf16 v[84:87], v[120:123], v[164:167], v[84:87]
s_waitcnt lgkmcnt(1)
v_mfma_f32_16x16x32_bf16 v[92:95], v[120:123], v[168:171], v[92:95]
ds_read_b128 v[104:107], v30 offset:0
v_mfma_f32_16x16x32_bf16 v[204:207], v[200:203], v[160:163], v[204:207]
v_mfma_f32_16x16x32_bf16 v[208:211], v[200:203], v[164:167], v[208:211]
v_mfma_f32_16x16x32_bf16 v[212:215], v[200:203], v[168:171], v[212:215]
s_waitcnt lgkmcnt(1)
v_mfma_f32_16x16x32_bf16 v[80:83], v[100:103], v[148:151], v[80:83]
s_nop 3
v_mul_f32 v204, -v204, s86
v_mfma_f32_16x16x32_bf16 v[88:91], v[100:103], v[152:155], v[88:91]
v_mul_f32 v208, -v208, s86
v_mfma_f32_16x16x32_bf16 v[96:99], v[100:103], v[156:159], v[96:99]
v_mul_f32 v212, -v212, s86
s_waitcnt lgkmcnt(0)
v_mfma_f32_16x16x32_bf16 v[80:83], v[104:107], v[160:163], v[80:83]
v_mfma_f32_16x16x32_bf16 v[88:91], v[104:107], v[164:167], v[88:91]
v_mfma_f32_16x16x32_bf16 v[96:99], v[104:107], v[168:171], v[96:99]
v_fma_f32 v76, v76, s86, v204
v_fma_f32 v77, v77, s86, v204
v_fma_f32 v78, v78, s86, v204
v_fma_f32 v79, v79, s86, v204
s_nop 1
v_fma_f32 v80, v80, s86, v204
v_fma_f32 v81, v81, s86, v204
v_fma_f32 v82, v82, s86, v204
v_fma_f32 v83, v83, s86, v204
v_cvt_pk_bf16_f32 v76, v76, v77
v_cvt_pk_bf16_f32 v77, v78, v79
v_cvt_pk_bf16_f32 v78, v80, v81
v_cvt_pk_bf16_f32 v79, v82, v83
buffer_store_dwordx4 v[76:79], v16, s[52:55], s82 offen offset:0 sc1
v_fma_f32 v84, v84, s86, v208
v_fma_f32 v85, v85, s86, v208
v_fma_f32 v86, v86, s86, v208
v_fma_f32 v87, v87, s86, v208
v_fma_f32 v88, v88, s86, v208
v_fma_f32 v89, v89, s86, v208
v_fma_f32 v90, v90, s86, v208
v_fma_f32 v91, v91, s86, v208
v_cvt_pk_bf16_f32 v84, v84, v85
v_cvt_pk_bf16_f32 v85, v86, v87
v_cvt_pk_bf16_f32 v86, v88, v89
v_cvt_pk_bf16_f32 v87, v90, v91
buffer_store_dwordx4 v[84:87], v16, s[52:55], s83 offen offset:0 sc1
v_fma_f32 v92, v92, s86, v212
v_fma_f32 v93, v93, s86, v212
v_fma_f32 v94, v94, s86, v212
v_fma_f32 v95, v95, s86, v212
v_fma_f32 v96, v96, s86, v212
v_fma_f32 v97, v97, s86, v212
v_fma_f32 v98, v98, s86, v212
v_fma_f32 v99, v99, s86, v212
v_cvt_pk_bf16_f32 v92, v92, v93
v_cvt_pk_bf16_f32 v93, v94, v95
v_cvt_pk_bf16_f32 v94, v96, v97
v_cvt_pk_bf16_f32 v95, v98, v99
buffer_store_dwordx4 v[92:95], v16, s[52:55], s84 offen offset:0 sc1
s_branch L1_fin
L1_notq:
s_sub_u32 s4, s2, 209
s_cmp_ge_u32 s2, 217
s_cbranch_scc1 L1_edge
s_mov_b32 s61, 1
v_lshlrev_b32 v16, 4, v2
s_mul_i32 s63, s60, 6144
s_and_b32 s6, s4, 3
s_lshl_b32 s6, s6, 6
s_mul_i32 s7, s60, 8
s_add_u32 s6, s6, s7
v_lshrrev_b32 v5, 5, v2
v_and_b32 v6, 31, v2
v_lshlrev_b32 v6, 4, v6
v_mov_b32 v176, v6
s_cmp_ge_u32 s4, 4
s_cselect_b64 vcc, -1, 0
v_add3_u32 v7, v5, s6, 0
v_and_b32 v8, 0x80, v7
v_bfe_u32 v9, v7, 2, 1
v_lshl_or_b32 v8, v9, 6, v8
v_bfe_u32 v9, v7, 4, 1
v_lshl_or_b32 v8, v9, 5, v8
v_and_b32 v9, 3, v7
v_lshl_or_b32 v8, v9, 3, v8
v_bfe_u32 v9, v7, 5, 2
v_lshl_or_b32 v8, v9, 1, v8
v_bfe_u32 v9, v7, 3, 1
v_or_b32 v8, v9, v8
v_cndmask_b32 v8, v8, v7, vcc
v_lshl_add_u32 v40, v8, 9, v6
v_add3_u32 v7, v5, s6, 2
v_and_b32 v8, 0x80, v7
v_bfe_u32 v9, v7, 2, 1
v_lshl_or_b32 v8, v9, 6, v8
v_bfe_u32 v9, v7, 4, 1
v_lshl_or_b32 v8, v9, 5, v8
v_and_b32 v9, 3, v7
v_lshl_or_b32 v8, v9, 3, v8
v_bfe_u32 v9, v7, 5, 2
v_lshl_or_b32 v8, v9, 1, v8
v_bfe_u32 v9, v7, 3, 1
v_or_b32 v8, v9, v8
v_cndmask_b32 v8, v8, v7, vcc
v_lshl_add_u32 v44, v8, 9, v6
v_add3_u32 v7, v5, s6, 4
v_and_b32 v8, 0x80, v7
v_bfe_u32 v9, v7, 2, 1
v_lshl_or_b32 v8, v9, 6, v8
v_bfe_u32 v9, v7, 4, 1
v_lshl_or_b32 v8, v9, 5, v8
v_and_b32 v9, 3, v7
v_lshl_or_b32 v8, v9, 3, v8
v_bfe_u32 v9, v7, 5, 2
v_lshl_or_b32 v8, v9, 1, v8
v_bfe_u32 v9, v7, 3, 1
v_or_b32 v8, v9, v8
v_cndmask_b32 v8, v8, v7, vcc
v_lshl_add_u32 v48, v8, 9, v6
v_add3_u32 v7, v5, s6, 6
v_and_b32 v8, 0x80, v7
v_bfe_u32 v9, v7, 2, 1
v_lshl_or_b32 v8, v9, 6, v8
v_bfe_u32 v9, v7, 4, 1
v_lshl_or_b32 v8, v9, 5, v8
v_and_b32 v9, 3, v7
v_lshl_or_b32 v8, v9, 3, v8
v_bfe_u32 v9, v7, 5, 2
v_lshl_or_b32 v8, v9, 1, v8
v_bfe_u32 v9, v7, 3, 1
v_or_b32 v8, v9, v8
v_cndmask_b32 v8, v8, v7, vcc
v_lshl_add_u32 v52, v8, 9, v6
s_lshl_b32 s7, s60, 6
v_lshrrev_b32 v5, 2, v2
v_and_b32 v6, 3, v2
v_lshrrev_b32 v7, 5, v2
v_lshlrev_b32 v7, 1, v7
v_xor_b32 v6, v6, v7
v_lshl_add_u32 v5, v5, 9, s7
v_lshl_add_u32 v17, v6, 4, v5
v_add_u32 v18, 0x1c00, v17
s_xor_b32 s6, s62, 0
s_lshl_b32 s66, s6, 14
s_xor_b32 s6, s62, 1
s_lshl_b32 s67, s6, 14
s_xor_b32 s6, s62, 2
s_lshl_b32 s68, s6, 14
s_xor_b32 s6, s62, 3
s_lshl_b32 s69, s6, 14
s_xor_b32 s6, s62, 4
s_lshl_b32 s70, s6, 14
s_xor_b32 s6, s62, 5
s_lshl_b32 s71, s6, 14
s_xor_b32 s6, s62, 6
s_lshl_b32 s72, s6, 14
s_xor_b32 s6, s62, 7
s_lshl_b32 s73, s6, 14
s_waitcnt lgkmcnt(0)
s_cmp_ge_u32 s4, 4
s_cselect_b32 s6, s30, s24
s_cselect_b32 s7, s31, s25
s_add_u32 s40, s6, 0x0
s_addc_u32 s41, s7, 0
s_mov_b32 s42, 0x20000
s_mov_b32 s43, 0x00020000
s_add_u32 s44, s32, 0x0
s_addc_u32 s45, s33, 0
s_mov_b32 s46, 0x20000
s_mov_b32 s47, 0x00020000
buffer_load_dwordx4 v[40:43], v40, s[40:43], 0 offen
buffer_load_dwordx4 v[44:47], v44, s[40:43], 0 offen
buffer_load_dwordx4 v[48:51], v48, s[40:43], 0 offen
buffer_load_dwordx4 v[52:55], v52, s[40:43], 0 offen
buffer_load_dwordx4 v[176:179], v176, s[40:43], 0 offen
s_add_u32 m0, s63, 0x0
s_nop 0
buffer_load_dwordx4 v17, s[44:47], s66 offen offset:0 lds
buffer_load_dwordx4 v18, s[44:47], s66 offen offset:1024 lds
s_add_u32 m0, s63, 0x800
s_nop 0
buffer_load_dwordx4 v17, s[44:47], s67 offen offset:0 lds
buffer_load_dwordx4 v18, s[44:47], s67 offen offset:1024 lds
v_bfe_u32 v5, v2, 2, 3
v_xor_b32 v5, s62, v5
v_and_b32 v6, 3, v2
v_lshlrev_b32 v7, 10, v5
v_lshl_add_u32 v7, v6, 8, v7
v_add_u32 v7, 0xc000, v7
v_and_b32 v5, 1, v5
v_lshl_or_b32 v6, v5, 2, v6
v_lshrrev_b32 v5, 5, v2
s_mul_i32 s6, s60, 8
v_add3_u32 v8, v5, s6, 0
v_lshrrev_b32 v9, 4, v8
v_lshl_add_u32 v9, v9, 13, v7
v_and_b32 v8, 15, v8
v_xor_b32 v8, v8, v6
v_lshl_add_u32 v36, v8, 4, v9
v_add3_u32 v8, v5, s6, 2
v_lshrrev_b32 v9, 4, v8
v_lshl_add_u32 v9, v9, 13, v7
v_and_b32 v8, 15, v8
v_xor_b32 v8, v8, v6
v_lshl_add_u32 v37, v8, 4, v9
v_add3_u32 v8, v5, s6, 4
v_lshrrev_b32 v9, 4, v8
v_lshl_add_u32 v9, v9, 13, v7
v_and_b32 v8, 15, v8
v_xor_b32 v8, v8, v6
v_lshl_add_u32 v38, v8, 4, v9
v_add3_u32 v8, v5, s6, 6
v_lshrrev_b32 v9, 4, v8
v_lshl_add_u32 v9, v9, 13, v7
v_and_b32 v8, 15, v8
v_xor_b32 v8, v8, v6
v_lshl_add_u32 v39, v8, 4, v9
v_xor_b32 v5, v3, v4
v_lshlrev_b32 v5, 4, v5
v_lshl_add_u32 v5, v4, 8, v5
v_add_u32 v31, 0xc000, v5
v_xor_b32 v32, 64, v31
v_lshrrev_b32 v5, 2, v3
v_and_b32 v6, 3, v3
v_and_b32 v7, 1, v4
v_lshlrev_b32 v7, 1, v7
v_lshl_add_u32 v8, v4, 3, v5
v_lshlrev_b32 v8, 6, v8
v_add_u32 v8, s63, v8
v_xor_b32 v6, v6, v7
v_xor_b32 v9, 0, v6
v_lshl_add_u32 v25, v9, 4, v8
v_add_u32 v26, 8, v25
s_lshr_b32 s6, s4, 2
s_lshl_b32 s6, s6, 17
s_and_b32 s7, s4, 3
s_lshl_b32 s7, s7, 12
s_add_u32 s6, s6, s7
s_mul_i32 s7, s60, 16384
s_add_u32 s82, s6, s7
s_add_u32 s83, s82, 16384
s_add_u32 s52, s38, 0x1000000
s_addc_u32 s53, s39, 0
s_mov_b32 s54, 0x40000
s_mov_b32 s55, 0x00020000
s_mov_b32 s90, 0xffff0000
s_waitcnt vmcnt(4)
v_lshlrev_b32 v180, 16, v176
v_and_b32 v181, s90, v176
v_lshlrev_b32 v182, 16, v177
v_and_b32 v183, s90, v177
v_lshlrev_b32 v184, 16, v178
v_and_b32 v185, s90, v178
v_lshlrev_b32 v186, 16, v179
v_and_b32 v187, s90, v179
v_lshlrev_b32 v176, 16, v40
v_and_b32 v177, s90, v40
v_sub_f32 v176, v176, v180
v_sub_f32 v177, v177, v181
v_cvt_pk_bf16_f32 v40, v176, v177
v_lshlrev_b32 v176, 16, v41
v_and_b32 v177, s90, v41
v_sub_f32 v176, v176, v182
v_sub_f32 v177, v177, v183
v_cvt_pk_bf16_f32 v41, v176, v177
v_lshlrev_b32 v176, 16, v42
v_and_b32 v177, s90, v42
v_sub_f32 v176, v176, v184
v_sub_f32 v177, v177, v185
v_cvt_pk_bf16_f32 v42, v176, v177
v_lshlrev_b32 v176, 16, v43
v_and_b32 v177, s90, v43
v_sub_f32 v176, v176, v186
v_sub_f32 v177, v177, v187
v_cvt_pk_bf16_f32 v43, v176, v177
v_lshlrev_b32 v176, 16, v44
v_and_b32 v177, s90, v44
v_sub_f32 v176, v176, v180
v_sub_f32 v177, v177, v181
v_cvt_pk_bf16_f32 v44, v176, v177
v_lshlrev_b32 v176, 16, v45
v_and_b32 v177, s90, v45
v_sub_f32 v176, v176, v182
v_sub_f32 v177, v177, v183
v_cvt_pk_bf16_f32 v45, v176, v177
v_lshlrev_b32 v176, 16, v46
v_and_b32 v177, s90, v46
v_sub_f32 v176, v176, v184
v_sub_f32 v177, v177, v185
v_cvt_pk_bf16_f32 v46, v176, v177
v_lshlrev_b32 v176, 16, v47
v_and_b32 v177, s90, v47
v_sub_f32 v176, v176, v186
v_sub_f32 v177, v177, v187
v_cvt_pk_bf16_f32 v47, v176, v177
v_lshlrev_b32 v176, 16, v48
v_and_b32 v177, s90, v48
v_sub_f32 v176, v176, v180
v_sub_f32 v177, v177, v181
v_cvt_pk_bf16_f32 v48, v176, v177
v_lshlrev_b32 v176, 16, v49
v_and_b32 v177, s90, v49
v_sub_f32 v176, v176, v182
v_sub_f32 v177, v177, v183
v_cvt_pk_bf16_f32 v49, v176, v177
v_lshlrev_b32 v176, 16, v50
v_and_b32 v177, s90, v50
v_sub_f32 v176, v176, v184
v_sub_f32 v177, v177, v185
v_cvt_pk_bf16_f32 v50, v176, v177
v_lshlrev_b32 v176, 16, v51
v_and_b32 v177, s90, v51
v_sub_f32 v176, v176, v186
v_sub_f32 v177, v177, v187
v_cvt_pk_bf16_f32 v51, v176, v177
v_lshlrev_b32 v176, 16, v52
v_and_b32 v177, s90, v52
v_sub_f32 v176, v176, v180
v_sub_f32 v177, v177, v181
v_cvt_pk_bf16_f32 v52, v176, v177
v_lshlrev_b32 v176, 16, v53
v_and_b32 v177, s90, v53
v_sub_f32 v176, v176, v182
v_sub_f32 v177, v177, v183
v_cvt_pk_bf16_f32 v53, v176, v177
v_lshlrev_b32 v176, 16, v54
v_and_b32 v177, s90, v54
v_sub_f32 v176, v176, v184
v_sub_f32 v177, v177, v185
v_cvt_pk_bf16_f32 v54, v176, v177
v_lshlrev_b32 v176, 16, v55
v_and_b32 v177, s90, v55
v_sub_f32 v176, v176, v186
v_sub_f32 v177, v177, v187
v_cvt_pk_bf16_f32 v55, v176, v177
ds_write_b128 v36, v[40:43]
ds_write_b128 v37, v[44:47]
ds_write_b128 v38, v[48:51]
ds_write_b128 v39, v[52:55]
s_add_u32 m0, s63, 0x1000
s_nop 0
buffer_load_dwordx4 v17, s[44:47], s68 offen offset:0 lds
buffer_load_dwordx4 v18, s[44:47], s68 offen offset:1024 lds
s_waitcnt vmcnt(4)
ds_read_b64_tr_b16 v[88:89], v25 offset:0
ds_read_b64_tr_b16 v[90:91], v25 offset:256
ds_read_b64_tr_b16 v[92:93], v26 offset:0
ds_read_b64_tr_b16 v[94:95], v26 offset:256
s_waitcnt lgkmcnt(4)
s_barrier
ds_read_b128 v[112:115], v31 offset:0
ds_read_b128 v[116:119], v31 offset:8192
ds_read_b128 v[120:123], v31 offset:16384
ds_read_b128 v[124:127], v31 offset:24576
ds_read_b128 v[128:131], v32 offset:1024
s_waitcnt vmcnt(2)
ds_read_b64_tr_b16 v[96:97], v25 offset:2048
ds_read_b64_tr_b16 v[98:99], v25 offset:2304
s_waitcnt lgkmcnt(6)
v_mfma_f32_16x16x32_bf16 v[56:59], v[112:115], v[88:91], 0
ds_read_b128 v[132:135], v32 offset:9216
s_waitcnt lgkmcnt(6)
v_mfma_f32_16x16x32_bf16 v[60:63], v[116:119], v[88:91], 0
ds_read_b128 v[136:139], v32 offset:17408
s_waitcnt lgkmcnt(6)
v_mfma_f32_16x16x32_bf16 v[64:67], v[120:123], v[88:91], 0
ds_read_b128 v[140:143], v32 offset:25600
s_waitcnt lgkmcnt(6)
v_mfma_f32_16x16x32_bf16 v[68:71], v[124:127], v[88:91], 0
ds_read_b64_tr_b16 v[100:101], v26 offset:2048
ds_read_b64_tr_b16 v[102:103], v26 offset:2304
v_mfma_f32_16x16x32_bf16 v[72:75], v[112:115], v[92:95], 0
s_add_u32 m0, s63, 0x0
s_nop 0
buffer_load_dwordx4 v17, s[44:47], s69 offen offset:0 lds
buffer_load_dwordx4 v18, s[44:47], s69 offen offset:1024 lds
v_mfma_f32_16x16x32_bf16 v[76:79], v[116:119], v[92:95], 0
v_mfma_f32_16x16x32_bf16 v[80:83], v[120:123], v[92:95], 0
v_mfma_f32_16x16x32_bf16 v[84:87], v[124:127], v[92:95], 0
ds_read_b128 v[144:147], v31 offset:2048
s_waitcnt vmcnt(2)
ds_read_b64_tr_b16 v[104:105], v25 offset:4096
ds_read_b64_tr_b16 v[106:107], v25 offset:4352
s_waitcnt lgkmcnt(8)
v_mfma_f32_16x16x32_bf16 v[56:59], v[128:131], v[96:99], v[56:59]
ds_read_b128 v[148:151], v31 offset:10240
s_waitcnt lgkmcnt(8)
v_mfma_f32_16x16x32_bf16 v[60:63], v[132:135], v[96:99], v[60:63]
ds_read_b128 v[152:155], v31 offset:18432
s_waitcnt lgkmcnt(8)
v_mfma_f32_16x16x32_bf16 v[64:67], v[136:139], v[96:99], v[64:67]
ds_read_b128 v[156:159], v31 offset:26624
s_waitcnt lgkmcnt(8)
v_mfma_f32_16x16x32_bf16 v[68:71], v[140:143], v[96:99], v[68:71]
ds_read_b64_tr_b16 v[108:109], v26 offset:4096
ds_read_b64_tr_b16 v[110:111], v26 offset:4352
s_waitcnt lgkmcnt(8)
v_mfma_f32_16x16x32_bf16 v[72:75], v[128:131], v[100:103], v[72:75]
s_add_u32 m0, s63, 0x800
s_nop 0
buffer_load_dwordx4 v17, s[44:47], s70 offen offset:0 lds
buffer_load_dwordx4 v18, s[44:47], s70 offen offset:1024 lds
v_mfma_f32_16x16x32_bf16 v[76:79], v[132:135], v[100:103], v[76:79]
v_mfma_f32_16x16x32_bf16 v[80:83], v[136:139], v[100:103], v[80:83]
v_mfma_f32_16x16x32_bf16 v[84:87], v[140:143], v[100:103], v[84:87]
ds_read_b128 v[160:163], v32 offset:3072
s_waitcnt vmcnt(2)
ds_read_b64_tr_b16 v[88:89], v25 offset:0
ds_read_b64_tr_b16 v[90:91], v25 offset:256
s_waitcnt lgkmcnt(8)
v_mfma_f32_16x16x32_bf16 v[56:59], v[144:147], v[104:107], v[56:59]
ds_read_b128 v[164:167], v32 offset:11264
s_waitcnt lgkmcnt(8)
v_mfma_f32_16x16x32_bf16 v[60:63], v[148:151], v[104:107], v[60:63]
ds_read_b128 v[168:171], v32 offset:19456
s_waitcnt lgkmcnt(8)
v_mfma_f32_16x16x32_bf16 v[64:67], v[152:155], v[104:107], v[64:67]
ds_read_b128 v[172:175], v32 offset:27648
s_waitcnt lgkmcnt(8)
v_mfma_f32_16x16x32_bf16 v[68:71], v[156:159], v[104:107], v[68:71]
ds_read_b64_tr_b16 v[92:93], v26 offset:0
ds_read_b64_tr_b16 v[94:95], v26 offset:256
s_waitcnt lgkmcnt(8)
v_mfma_f32_16x16x32_bf16 v[72:75], v[144:147], v[108:111], v[72:75]
s_add_u32 m0, s63, 0x1000
s_nop 0
buffer_load_dwordx4 v17, s[44:47], s71 offen offset:0 lds
buffer_load_dwordx4 v18, s[44:47], s71 offen offset:1024 lds
v_mfma_f32_16x16x32_bf16 v[76:79], v[148:151], v[108:111], v[76:79]
v_mfma_f32_16x16x32_bf16 v[80:83], v[152:155], v[108:111], v[80:83]
v_mfma_f32_16x16x32_bf16 v[84:87], v[156:159], v[108:111], v[84:87]
ds_read_b128 v[112:115], v31 offset:4096
s_waitcnt vmcnt(2)
ds_read_b64_tr_b16 v[96:97], v25 offset:2048
ds_read_b64_tr_b16 v[98:99], v25 offset:2304
s_waitcnt lgkmcnt(8)
v_mfma_f32_16x16x32_bf16 v[56:59], v[160:163], v[88:91], v[56:59]
ds_read_b128 v[116:119], v31 offset:12288
s_waitcnt lgkmcnt(8)
v_mfma_f32_16x16x32_bf16 v[60:63], v[164:167], v[88:91], v[60:63]
ds_read_b128 v[120:123], v31 offset:20480
s_waitcnt lgkmcnt(8)
v_mfma_f32_16x16x32_bf16 v[64:67], v[168:171], v[88:91], v[64:67]
ds_read_b128 v[124:127], v31 offset:28672
s_waitcnt lgkmcnt(8)
v_mfma_f32_16x16x32_bf16 v[68:71], v[172:175], v[88:91], v[68:71]
ds_read_b64_tr_b16 v[100:101], v26 offset:2048
ds_read_b64_tr_b16 v[102:103], v26 offset:2304
s_waitcnt lgkmcnt(8)
v_mfma_f32_16x16x32_bf16 v[72:75], v[160:163], v[92:95], v[72:75]
s_add_u32 m0, s63, 0x0
s_nop 0
buffer_load_dwordx4 v17, s[44:47], s72 offen offset:0 lds
buffer_load_dwordx4 v18, s[44:47], s72 offen offset:1024 lds
v_mfma_f32_16x16x32_bf16 v[76:79], v[164:167], v[92:95], v[76:79]
v_mfma_f32_16x16x32_bf16 v[80:83], v[168:171], v[92:95], v[80:83]
v_mfma_f32_16x16x32_bf16 v[84:87], v[172:175], v[92:95], v[84:87]
ds_read_b128 v[128:131], v32 offset:5120
s_waitcnt vmcnt(2)
ds_read_b64_tr_b16 v[104:105], v25 offset:4096
ds_read_b64_tr_b16 v[106:107], v25 offset:4352
s_waitcnt lgkmcnt(8)
v_mfma_f32_16x16x32_bf16 v[56:59], v[112:115], v[96:99], v[56:59]
ds_read_b128 v[132:135], v32 offset:13312
s_waitcnt lgkmcnt(8)
v_mfma_f32_16x16x32_bf16 v[60:63], v[116:119], v[96:99], v[60:63]
ds_read_b128 v[136:139], v32 offset:21504
s_waitcnt lgkmcnt(8)
v_mfma_f32_16x16x32_bf16 v[64:67], v[120:123], v[96:99], v[64:67]
ds_read_b128 v[140:143], v32 offset:29696
s_waitcnt lgkmcnt(8)
v_mfma_f32_16x16x32_bf16 v[68:71], v[124:127], v[96:99], v[68:71]
ds_read_b64_tr_b16 v[108:109], v26 offset:4096
ds_read_b64_tr_b16 v[110:111], v26 offset:4352
s_waitcnt lgkmcnt(8)
v_mfma_f32_16x16x32_bf16 v[72:75], v[112:115], v[100:103], v[72:75]
s_add_u32 m0, s63, 0x800
s_nop 0
buffer_load_dwordx4 v17, s[44:47], s73 offen offset:0 lds
buffer_load_dwordx4 v18, s[44:47], s73 offen offset:1024 lds
v_mfma_f32_16x16x32_bf16 v[76:79], v[116:119], v[100:103], v[76:79]
v_mfma_f32_16x16x32_bf16 v[80:83], v[120:123], v[100:103], v[80:83]
v_mfma_f32_16x16x32_bf16 v[84:87], v[124:127], v[100:103], v[84:87]
ds_read_b128 v[144:147], v31 offset:6144
s_waitcnt vmcnt(2)
ds_read_b64_tr_b16 v[88:89], v25 offset:0
ds_read_b64_tr_b16 v[90:91], v25 offset:256
s_waitcnt lgkmcnt(8)
v_mfma_f32_16x16x32_bf16 v[56:59], v[128:131], v[104:107], v[56:59]
ds_read_b128 v[148:151], v31 offset:14336
s_waitcnt lgkmcnt(8)
v_mfma_f32_16x16x32_bf16 v[60:63], v[132:135], v[104:107], v[60:63]
ds_read_b128 v[152:155], v31 offset:22528
s_waitcnt lgkmcnt(8)
v_mfma_f32_16x16x32_bf16 v[64:67], v[136:139], v[104:107], v[64:67]
ds_read_b128 v[156:159], v31 offset:30720
s_waitcnt lgkmcnt(8)
v_mfma_f32_16x16x32_bf16 v[68:71], v[140:143], v[104:107], v[68:71]
ds_read_b64_tr_b16 v[92:93], v26 offset:0
ds_read_b64_tr_b16 v[94:95], v26 offset:256
s_waitcnt lgkmcnt(8)
v_mfma_f32_16x16x32_bf16 v[72:75], v[128:131], v[108:111], v[72:75]
v_mfma_f32_16x16x32_bf16 v[76:79], v[132:135], v[108:111], v[76:79]
v_mfma_f32_16x16x32_bf16 v[80:83], v[136:139], v[108:111], v[80:83]
v_mfma_f32_16x16x32_bf16 v[84:87], v[140:143], v[108:111], v[84:87]
ds_read_b128 v[160:163], v32 offset:7168
s_waitcnt vmcnt(0)
ds_read_b64_tr_b16 v[96:97], v25 offset:2048
ds_read_b64_tr_b16 v[98:99], v25 offset:2304
s_waitcnt lgkmcnt(8)
v_mfma_f32_16x16x32_bf16 v[56:59], v[144:147], v[88:91], v[56:59]
ds_read_b128 v[164:167], v32 offset:15360
s_waitcnt lgkmcnt(8)
v_mfma_f32_16x16x32_bf16 v[60:63], v[148:151], v[88:91], v[60:63]
ds_read_b128 v[168:171], v32 offset:23552
s_waitcnt lgkmcnt(8)
v_mfma_f32_16x16x32_bf16 v[64:67], v[152:155], v[88:91], v[64:67]
ds_read_b128 v[172:175], v32 offset:31744
s_waitcnt lgkmcnt(8)
v_mfma_f32_16x16x32_bf16 v[68:71], v[156:159], v[88:91], v[68:71]
ds_read_b64_tr_b16 v[100:101], v26 offset:2048
ds_read_b64_tr_b16 v[102:103], v26 offset:2304
s_waitcnt lgkmcnt(8)
v_mfma_f32_16x16x32_bf16 v[72:75], v[144:147], v[92:95], v[72:75]
v_mfma_f32_16x16x32_bf16 v[76:79], v[148:151], v[92:95], v[76:79]
v_mfma_f32_16x16x32_bf16 v[80:83], v[152:155], v[92:95], v[80:83]
v_mfma_f32_16x16x32_bf16 v[84:87], v[156:159], v[92:95], v[84:87]
s_waitcnt lgkmcnt(5)
v_mfma_f32_16x16x32_bf16 v[56:59], v[160:163], v[96:99], v[56:59]
s_waitcnt lgkmcnt(4)
v_mfma_f32_16x16x32_bf16 v[60:63], v[164:167], v[96:99], v[60:63]
s_waitcnt lgkmcnt(3)
v_mfma_f32_16x16x32_bf16 v[64:67], v[168:171], v[96:99], v[64:67]
s_waitcnt lgkmcnt(2)
v_mfma_f32_16x16x32_bf16 v[68:71], v[172:175], v[96:99], v[68:71]
s_waitcnt lgkmcnt(0)
v_mfma_f32_16x16x32_bf16 v[72:75], v[160:163], v[100:103], v[72:75]
v_cvt_pk_bf16_f32 v56, v56, v57
v_cvt_pk_bf16_f32 v57, v58, v59
v_cvt_pk_bf16_f32 v58, v60, v61
v_cvt_pk_bf16_f32 v59, v62, v63
buffer_store_dwordx4 v[56:59], v16, s[52:55], s82 offen offset:0 sc1
v_mfma_f32_16x16x32_bf16 v[76:79], v[164:167], v[100:103], v[76:79]
v_mfma_f32_16x16x32_bf16 v[80:83], v[168:171], v[100:103], v[80:83]
v_cvt_pk_bf16_f32 v64, v64, v65
v_cvt_pk_bf16_f32 v65, v66, v67
v_cvt_pk_bf16_f32 v66, v68, v69
v_cvt_pk_bf16_f32 v67, v70, v71
buffer_store_dwordx4 v[64:67], v16, s[52:55], s82 offen offset:2048 sc1
v_mfma_f32_16x16x32_bf16 v[84:87], v[172:175], v[100:103], v[84:87]
v_cvt_pk_bf16_f32 v72, v72, v73
v_cvt_pk_bf16_f32 v73, v74, v75
v_cvt_pk_bf16_f32 v74, v76, v77
v_cvt_pk_bf16_f32 v75, v78, v79
buffer_store_dwordx4 v[72:75], v16, s[52:55], s82 offen offset:1024 sc1
v_cvt_pk_bf16_f32 v80, v80, v81
v_cvt_pk_bf16_f32 v81, v82, v83
s_nop 0
v_cvt_pk_bf16_f32 v82, v84, v85
v_cvt_pk_bf16_f32 v83, v86, v87
buffer_store_dwordx4 v[80:83], v16, s[52:55], s82 offen offset:3072 sc1
s_branch L1_fin
L1_edge:
s_mov_b32 s61, 4
s_sub_u32 s4, s2, 217
s_mul_i32 s6, s4, 20000
v_lshlrev_b32 v5, 4, v0
v_lshlrev_b32 v6, 2, v2
v_add_u32 v6, 0x10000, v6
v_mov_b32 v7, 0
ds_write_b32 v6, v7
s_mov_b32 s66, 0
s_mov_b32 s67, 8192
s_mov_b32 s68, 16384
s_waitcnt lgkmcnt(0)
s_add_u32 s56, s38, 0x7c00000
s_addc_u32 s57, s39, 0
s_mov_b32 s58, 0x2000
s_mov_b32 s59, 0x00020000
s_cmp_eq_u32 s4, 0
s_cselect_b32 s9, 0, 0x7fff0000
v_mov_b32 v8, 0
v_mov_b32 v9, 0
v_mov_b32 v10, 0
v_mov_b32 v11, 0
buffer_store_dwordx4 v[8:11], v5, s[56:59], s9 offen
s_add_u32 s40, s20, 0x0
s_addc_u32 s41, s21, 0
s_add_u32 s40, s40, s6
s_addc_u32 s41, s41, 0
s_mov_b32 s42, 0x4e20
s_mov_b32 s43, 0x00020000
s_add_u32 s44, s18, 0x0
s_addc_u32 s45, s19, 0
s_add_u32 s44, s44, s6
s_addc_u32 s45, s45, 0
s_mov_b32 s46, 0x4e20
s_mov_b32 s47, 0x00020000
buffer_load_dwordx4 v[16:19], v5, s[40:43], s66 offen
buffer_load_dwordx4 v[20:23], v5, s[40:43], s67 offen
buffer_load_dwordx4 v[24:27], v5, s[40:43], s68 offen
buffer_load_dwordx4 v[28:31], v5, s[44:47], s66 offen
buffer_load_dwordx4 v[32:35], v5, s[44:47], s67 offen
buffer_load_dwordx4 v[36:39], v5, s[44:47], s68 offen
s_add_u32 s48, s38, 0x8000000
s_addc_u32 s49, s39, 0
s_mov_b32 s50, 0x2800000
s_mov_b32 s51, 0x00020000
s_add_u32 s52, s38, 0x7800000
s_addc_u32 s53, s39, 0
s_mov_b32 s54, 0x2000
s_mov_b32 s55, 0x00020000
s_mov_b32 s9, 6279
s_mov_b32 s10, 4294967129
s_mov_b32 s11, 0x10000
v_mov_b32 v7, 1
v_cmp_gt_u32 vcc, 0xe2, v0
s_mov_b64 s[12:13], vcc
s_barrier
s_waitcnt vmcnt(5)
v_mul_u32_u24 v40, s9, v16
v_lshrrev_b32 v40, 20, v40
v_lshl_add_u32 v52, v40, 2, s11
ds_add_rtn_u32 v52, v52, v7
v_mad_i32_i24 v16, v40, s10, v16
v_mul_u32_u24 v41, s9, v17
v_lshrrev_b32 v41, 20, v41
v_lshl_add_u32 v53, v41, 2, s11
ds_add_rtn_u32 v53, v53, v7
v_mad_i32_i24 v17, v41, s10, v17
v_mul_u32_u24 v42, s9, v18
v_lshrrev_b32 v42, 20, v42
v_lshl_add_u32 v54, v42, 2, s11
ds_add_rtn_u32 v54, v54, v7
v_mad_i32_i24 v18, v42, s10, v18
v_mul_u32_u24 v43, s9, v19
v_lshrrev_b32 v43, 20, v43
v_lshl_add_u32 v55, v43, 2, s11
ds_add_rtn_u32 v55, v55, v7
v_mad_i32_i24 v19, v43, s10, v19
s_waitcnt vmcnt(4)
v_mul_u32_u24 v44, s9, v20
v_lshrrev_b32 v44, 20, v44
v_lshl_add_u32 v56, v44, 2, s11
ds_add_rtn_u32 v56, v56, v7
v_mad_i32_i24 v20, v44, s10, v20
v_mul_u32_u24 v45, s9, v21
v_lshrrev_b32 v45, 20, v45
v_lshl_add_u32 v57, v45, 2, s11
ds_add_rtn_u32 v57, v57, v7
v_mad_i32_i24 v21, v45, s10, v21
v_mul_u32_u24 v46, s9, v22
v_lshrrev_b32 v46, 20, v46
v_lshl_add_u32 v58, v46, 2, s11
ds_add_rtn_u32 v58, v58, v7
v_mad_i32_i24 v22, v46, s10, v22
v_mul_u32_u24 v47, s9, v23
v_lshrrev_b32 v47, 20, v47
v_lshl_add_u32 v59, v47, 2, s11
ds_add_rtn_u32 v59, v59, v7
v_mad_i32_i24 v23, v47, s10, v23
s_waitcnt vmcnt(3)
s_mov_b64 exec, s[12:13]
v_mul_u32_u24 v48, s9, v24
v_lshrrev_b32 v48, 20, v48
v_lshl_add_u32 v60, v48, 2, s11
ds_add_rtn_u32 v60, v60, v7
v_mad_i32_i24 v24, v48, s10, v24
v_mul_u32_u24 v49, s9, v25
v_lshrrev_b32 v49, 20, v49
v_lshl_add_u32 v61, v49, 2, s11
ds_add_rtn_u32 v61, v61, v7
v_mad_i32_i24 v25, v49, s10, v25
v_mul_u32_u24 v50, s9, v26
v_lshrrev_b32 v50, 20, v50
v_lshl_add_u32 v62, v50, 2, s11
ds_add_rtn_u32 v62, v62, v7
v_mad_i32_i24 v26, v50, s10, v26
v_mul_u32_u24 v51, s9, v27
v_lshrrev_b32 v51, 20, v51
v_lshl_add_u32 v63, v51, 2, s11
ds_add_rtn_u32 v63, v63, v7
v_mad_i32_i24 v27, v51, s10, v27
s_mov_b64 exec, -1
s_waitcnt vmcnt(2) lgkmcnt(4)
v_and_b32 v8, 0x7f, v52
v_lshl_or_b32 v28, v16, 18, v28
v_lshlrev_b32 v8, 2, v8
v_lshl_add_u32 v8, v40, 9, v8
ds_write_b32 v8, v28
v_and_b32 v8, 0x7f, v53
v_lshl_or_b32 v29, v17, 18, v29
v_lshlrev_b32 v8, 2, v8
v_lshl_add_u32 v8, v41, 9, v8
ds_write_b32 v8, v29
v_and_b32 v8, 0x7f, v54
v_lshl_or_b32 v30, v18, 18, v30
v_lshlrev_b32 v8, 2, v8
v_lshl_add_u32 v8, v42, 9, v8
ds_write_b32 v8, v30
v_and_b32 v8, 0x7f, v55
v_lshl_or_b32 v31, v19, 18, v31
v_lshlrev_b32 v8, 2, v8
v_lshl_add_u32 v8, v43, 9, v8
ds_write_b32 v8, v31
s_waitcnt vmcnt(1) lgkmcnt(4)
v_and_b32 v8, 0x7f, v56
v_lshl_or_b32 v32, v20, 18, v32
v_lshlrev_b32 v8, 2, v8
v_lshl_add_u32 v8, v44, 9, v8
ds_write_b32 v8, v32
v_and_b32 v8, 0x7f, v57
v_lshl_or_b32 v33, v21, 18, v33
v_lshlrev_b32 v8, 2, v8
v_lshl_add_u32 v8, v45, 9, v8
ds_write_b32 v8, v33
v_and_b32 v8, 0x7f, v58
v_lshl_or_b32 v34, v22, 18, v34
v_lshlrev_b32 v8, 2, v8
v_lshl_add_u32 v8, v46, 9, v8
ds_write_b32 v8, v34
v_and_b32 v8, 0x7f, v59
v_lshl_or_b32 v35, v23, 18, v35
v_lshlrev_b32 v8, 2, v8
v_lshl_add_u32 v8, v47, 9, v8
ds_write_b32 v8, v35
s_waitcnt vmcnt(0) lgkmcnt(8)
s_mov_b64 exec, s[12:13]
v_and_b32 v8, 0x7f, v60
v_lshl_or_b32 v36, v24, 18, v36
v_lshlrev_b32 v8, 2, v8
v_lshl_add_u32 v8, v48, 9, v8
ds_write_b32 v8, v36
v_and_b32 v8, 0x7f, v61
v_lshl_or_b32 v37, v25, 18, v37
v_lshlrev_b32 v8, 2, v8
v_lshl_add_u32 v8, v49, 9, v8
ds_write_b32 v8, v37
v_and_b32 v8, 0x7f, v62
v_lshl_or_b32 v38, v26, 18, v38
v_lshlrev_b32 v8, 2, v8
v_lshl_add_u32 v8, v50, 9, v8
ds_write_b32 v8, v38
v_and_b32 v8, 0x7f, v63
v_lshl_or_b32 v39, v27, 18, v39
v_lshlrev_b32 v8, 2, v8
v_lshl_add_u32 v8, v51, 9, v8
ds_write_b32 v8, v39
s_mov_b64 exec, -1
s_waitcnt lgkmcnt(0)
s_barrier
ds_read_b32 v8, v6
s_mul_i32 s6, s60, 4096
v_lshlrev_b32 v10, 4, v2
v_add_u32 v9, s6, v10
ds_read_b128 v[64:67], v9 offset:0
ds_read_b128 v[68:71], v9 offset:1024
ds_read_b128 v[72:75], v9 offset:2048
ds_read_b128 v[76:79], v9 offset:3072
v_lshrrev_b32 v11, 5, v2
v_mul_u32_u24 v11, 0x9fe00, v11
v_add_u32 v10, v10, v11
s_mul_i32 s6, s60, 5242880
s_mul_i32 s7, s4, 20480
s_add_u32 s6, s6, s7
v_lshlrev_b32 v9, 7, v2
s_lshl_b32 s8, s4, 2
s_cmp_eq_u32 s60, 0
s_cselect_b32 s8, s8, 0x7fff0000
s_waitcnt lgkmcnt(4)
buffer_store_dword v8, v9, s[52:55], s8 offen sc1
v_cmp_lt_u32 vcc, 0x80, v8
s_cbranch_vccnz L1_eslow
s_waitcnt lgkmcnt(3)
buffer_store_dwordx4 v[64:67], v10, s[48:51], s6 offen sc1
s_add_u32 s6, s6, 1310720
s_waitcnt lgkmcnt(2)
buffer_store_dwordx4 v[68:71], v10, s[48:51], s6 offen sc1
s_add_u32 s6, s6, 1310720
s_waitcnt lgkmcnt(1)
buffer_store_dwordx4 v[72:75], v10, s[48:51], s6 offen sc1
s_add_u32 s6, s6, 1310720
s_waitcnt lgkmcnt(0)
buffer_store_dwordx4 v[76:79], v10, s[48:51], s6 offen sc1
s_add_u32 s6, s6, 1310720
s_branch L1_fin
L1_eslow:
s_mov_b32 s9, 655360
v_mul_u32_u24 v40, s9, v40
v_lshl_add_u32 v40, v52, 2, v40
v_mul_u32_u24 v41, s9, v41
v_lshl_add_u32 v41, v53, 2, v41
v_mul_u32_u24 v42, s9, v42
v_lshl_add_u32 v42, v54, 2, v42
v_mul_u32_u24 v43, s9, v43
v_lshl_add_u32 v43, v55, 2, v43
v_mul_u32_u24 v44, s9, v44
v_lshl_add_u32 v44, v56, 2, v44
v_mul_u32_u24 v45, s9, v45
v_lshl_add_u32 v45, v57, 2, v45
v_mul_u32_u24 v46, s9, v46
v_lshl_add_u32 v46, v58, 2, v46
v_mul_u32_u24 v47, s9, v47
v_lshl_add_u32 v47, v59, 2, v47
v_mul_u32_u24 v48, s9, v48
v_lshl_add_u32 v48, v60, 2, v48
v_mul_u32_u24 v49, s9, v49
v_lshl_add_u32 v49, v61, 2, v49
v_mul_u32_u24 v50, s9, v50
v_lshl_add_u32 v50, v62, 2, v50
v_mul_u32_u24 v51, s9, v51
v_lshl_add_u32 v51, v63, 2, v51
buffer_store_dword v28, v40, s[48:51], s7 offen
buffer_store_dword v29, v41, s[48:51], s7 offen
buffer_store_dword v30, v42, s[48:51], s7 offen
buffer_store_dword v31, v43, s[48:51], s7 offen
buffer_store_dword v32, v44, s[48:51], s7 offen
buffer_store_dword v33, v45, s[48:51], s7 offen
buffer_store_dword v34, v46, s[48:51], s7 offen
buffer_store_dword v35, v47, s[48:51], s7 offen
s_mov_b64 exec, s[12:13]
buffer_store_dword v36, v48, s[48:51], s7 offen
buffer_store_dword v37, v49, s[48:51], s7 offen
buffer_store_dword v38, v50, s[48:51], s7 offen
buffer_store_dword v39, v51, s[48:51], s7 offen
s_mov_b64 exec, -1
L1_fin:
L1_end:
s_endpgm
.globl k2_kernel
.p2align 8
.type k2_kernel,@function
k2_kernel:
s_load_dwordx2 s[4:5], s[0:1], 88
s_load_dwordx2 s[6:7], s[0:1], 0
s_load_dwordx2 s[16:17], s[0:1], 24
s_load_dwordx2 s[18:19], s[0:1], 72
s_and_b32 s35, s2, 7
s_lshr_b32 s37, s2, 3
s_cmp_ge_u32 s37, 30
s_cbranch_scc1 LE_start
s_mul_i32 s38, s37, 52
s_lshr_b32 s38, s38, 8
s_mul_i32 s39, s38, 5
s_sub_u32 s39, s37, s39
s_mov_b32 s37, s38
s_mul_i32 s38, s35, 5
s_add_u32 s38, s38, s39
v_lshrrev_b32 v1, 6, v0
v_and_b32 v252, 63, v0
v_lshlrev_b32 v252, 4, v252
v_readfirstlane_b32 s34, v1
s_mov_b32 s50, 0xe1a06800
s_mov_b32 s51, 0x4e608d04
s_mul_i32 s39, s37, 9
s_lshr_b64 s[50:51], s[50:51], s39
s_and_b32 s39, s50, 0x1ff
s_bfe_u32 s49, s50, 0x90009
s_sub_u32 s29, s49, s39
s_lshl_b32 s50, s37, 2
s_lshr_b32 s59, 0x766666, s50
s_and_b32 s59, s59, 15
s_sub_u32 s31, s29, s59
s_lshr_b32 s31, s31, 1
s_sub_u32 s31, s31, 1
s_lshl_b32 s39, s39, 14
s_lshl_b32 s49, s49, 14
s_add_u32 s28, s39, 0x4000
s_cmp_eq_u32 s37, 5
s_cselect_b32 s33, 0xff800000, 0
s_mov_b32 s32, 0xffff
v_and_b32 v2, 63, v0
v_bfe_u32 v3, v2, 3, 2
v_bfe_u32 v4, v2, 2, 1
v_lshlrev_b32 v251, 12, v3
v_lshl_or_b32 v251, v4, 9, v251
v_lshl_or_b32 v251, v1, 7, v251
v_lshrrev_b32 v4, 5, v2
v_lshl_or_b32 v251, v4, 6, v251
v_and_b32 v3, 2, v3
v_and_b32 v4, 3, v2
v_xor_b32 v3, v3, v4
v_lshl_or_b32 v251, v3, 4, v251
s_cmp_eq_u32 s38, 39
s_cbranch_scc1 LT_disp
s_lshl_b32 s30, s34, 12
s_mov_b32 m0, s30
s_waitcnt lgkmcnt(0)
s_add_u32 s12, s4, 0x6800000
s_addc_u32 s13, s5, 0
s_mov_b32 s14, s49
s_mov_b32 s15, 0x00020000
buffer_load_dwordx4 v251, s[12:15], s39 offen offset:0 lds
buffer_load_dwordx4 v251, s[12:15], s39 offen offset:1024 lds
buffer_load_dwordx4 v251, s[12:15], s39 offen offset:2048 lds
buffer_load_dwordx4 v251, s[12:15], s39 offen offset:3072 lds
s_add_u32 m0, s30, 0x4000
s_nop 0
buffer_load_dwordx4 v251, s[12:15], s28 offen offset:0 lds
buffer_load_dwordx4 v251, s[12:15], s28 offen offset:1024 lds
s_add_u32 s8, s4, 0x0
s_addc_u32 s9, s5, 0
s_mov_b32 s10, 0x4e4000
s_mov_b32 s11, 0x00020000
s_mul_i32 s35, s37, 0x600000
s_add_u32 s20, s4, 0x2000000
s_addc_u32 s21, s5, 0
s_add_u32 s20, s20, s35
s_addc_u32 s21, s21, 0
s_mov_b32 s22, 0x4e4000
s_mov_b32 s23, 0x00020000
s_add_u32 s24, s4, 0x6000000
s_addc_u32 s25, s5, 0
s_mov_b32 s26, 0x9c800
s_mov_b32 s27, 0x00020000
s_lshl_b32 s35, s38, 4
s_lshl_b32 s41, s34, 2
s_add_u32 s35, s35, s41
s_mul_i32 s41, s37, 3
s_sub_u32 s42, s34, s41
s_and_b32 s42, s42, 3
s_add_u32 s41, s41, s42
s_lshr_b32 s41, s41, 2
s_cmp_eq_u32 s37, 5
s_cselect_b32 s42, 3, s42
s_cmp_lt_u32 s42, 3
s_cselect_b32 s41, s41, 0
s_cselect_b32 s50, 1, 0
s_add_u32 s35, s35, s41
s_lshl_b32 s40, s35, 13
s_lshl_b32 s48, s35, 10
s_lshl_b32 s35, s37, 3
s_add_u32 s48, s48, s35
s_xor_b32 s41, s40, 8192
s_xor_b32 s42, s40, 16384
s_xor_b32 s43, s40, 24576
s_add_u32 s44, s40, 4096
s_add_u32 s45, s41, 4096
s_add_u32 s46, s42, 4096
s_add_u32 s47, s43, 4096
s_mul_i32 s35, s37, 3
s_and_b32 s36, s35, 3
s_lshl_b32 s36, s36, 2
s_lshr_b32 s52, s35, 2
s_add_u32 s36, s36, s52
s_lshl_b32 s52, s38, 4
s_add_u32 s52, s52, s36
s_lshl_b32 s52, s52, 13
s_add_u32 s35, s35, 1
s_and_b32 s36, s35, 3
s_lshl_b32 s36, s36, 2
s_lshr_b32 s53, s35, 2
s_add_u32 s36, s36, s53
s_lshl_b32 s53, s38, 4
s_add_u32 s53, s53, s36
s_lshl_b32 s53, s53, 13
s_add_u32 s35, s35, 1
s_and_b32 s36, s35, 3
s_lshl_b32 s36, s36, 2
s_lshr_b32 s54, s35, 2
s_add_u32 s36, s36, s54
s_lshl_b32 s54, s38, 4
s_add_u32 s54, s54, s36
s_lshl_b32 s54, s54, 13
v_mov_b32 v208, 0
v_mov_b32 v209, 0
v_mov_b32 v210, 0
v_mov_b32 v211, 0
buffer_load_dwordx4 v[0:3], v252, s[8:11], s40 offen offset:0
buffer_load_dwordx4 v[32:35], v252, s[8:11], s41 offen offset:0
v_mfma_f32_32x32x16_bf16 a[0:15], v[208:211], v[208:211], 0
buffer_load_dwordx4 v[64:67], v252, s[8:11], s42 offen offset:0
v_mfma_f32_32x32x16_bf16 a[16:31], v[208:211], v[208:211], 0
buffer_load_dwordx4 v[96:99], v252, s[8:11], s43 offen offset:0
buffer_load_dwordx4 v[4:7], v252, s[8:11], s40 offen offset:1024
v_mfma_f32_32x32x16_bf16 a[32:47], v[208:211], v[208:211], 0
buffer_load_dwordx4 v[36:39], v252, s[8:11], s41 offen offset:1024
v_mfma_f32_32x32x16_bf16 a[48:63], v[208:211], v[208:211], 0
buffer_load_dwordx4 v[68:71], v252, s[8:11], s42 offen offset:1024
buffer_load_dwordx4 v[100:103], v252, s[8:11], s43 offen offset:1024
v_mfma_f32_32x32x16_bf16 a[64:79], v[208:211], v[208:211], 0
buffer_load_dwordx4 v[8:11], v252, s[8:11], s40 offen offset:2048
v_mfma_f32_32x32x16_bf16 a[80:95], v[208:211], v[208:211], 0
buffer_load_dwordx4 v[40:43], v252, s[8:11], s41 offen offset:2048
buffer_load_dwordx4 v[72:75], v252, s[8:11], s42 offen offset:2048
v_mfma_f32_32x32x16_bf16 a[96:111], v[208:211], v[208:211], 0
buffer_load_dwordx4 v[104:107], v252, s[8:11], s43 offen offset:2048
v_mfma_f32_32x32x16_bf16 a[112:127], v[208:211], v[208:211], 0
buffer_load_dwordx4 v[12:15], v252, s[8:11], s40 offen offset:3072
buffer_load_dwordx4 v[44:47], v252, s[8:11], s41 offen offset:3072
v_mfma_f32_32x32x16_bf16 a[128:143], v[208:211], v[208:211], 0
buffer_load_dwordx4 v[76:79], v252, s[8:11], s42 offen offset:3072
v_mfma_f32_32x32x16_bf16 a[144:159], v[208:211], v[208:211], 0
buffer_load_dwordx4 v[108:111], v252, s[8:11], s43 offen offset:3072
buffer_load_dwordx4 v[16:19], v252, s[8:11], s44 offen offset:0
v_mfma_f32_32x32x16_bf16 a[160:175], v[208:211], v[208:211], 0
buffer_load_dwordx4 v[48:51], v252, s[8:11], s45 offen offset:0
v_mfma_f32_32x32x16_bf16 a[176:191], v[208:211], v[208:211], 0
buffer_load_dwordx4 v[80:83], v252, s[8:11], s46 offen offset:0
buffer_load_dwordx4 v[112:115], v252, s[8:11], s47 offen offset:0
v_mfma_f32_32x32x16_bf16 a[192:207], v[208:211], v[208:211], 0
buffer_load_dwordx4 v[20:23], v252, s[8:11], s44 offen offset:1024
v_mfma_f32_32x32x16_bf16 a[208:223], v[208:211], v[208:211], 0
buffer_load_dwordx4 v[52:55], v252, s[8:11], s45 offen offset:1024
buffer_load_dwordx4 v[84:87], v252, s[8:11], s46 offen offset:1024
v_mfma_f32_32x32x16_bf16 a[224:239], v[208:211], v[208:211], 0
buffer_load_dwordx4 v[116:119], v252, s[8:11], s47 offen offset:1024
v_mfma_f32_32x32x16_bf16 a[240:255], v[208:211], v[208:211], 0
v_bfe_u32 v248, v252, 4, 3
v_lshlrev_b32 v248, 6, v248
v_bfe_u32 v253, v252, 7, 1
v_lshl_or_b32 v248, v253, 10, v248
v_bfe_u32 v253, v252, 8, 2
v_lshl_or_b32 v248, v253, 4, v248
v_bfe_u32 v253, v252, 6, 1
v_lshlrev_b32 v253, 5, v253
v_xor_b32 v248, v248, v253
v_and_b32 v249, 0x1c0, v252
v_bfe_u32 v253, v252, 9, 1
v_lshl_or_b32 v249, v253, 10, v249
v_bfe_u32 v253, v252, 8, 1
v_lshl_or_b32 v249, v253, 5, v249
v_bfe_u32 v253, v252, 4, 2
v_lshl_or_b32 v249, v253, 3, v249
v_xor_b32 v250, 32, v249
s_waitcnt vmcnt(24)
s_barrier
ds_read_b128 v[224:227], v248 offset:0
ds_read_b128 v[228:231], v248 offset:512
ds_read_b128 v[232:235], v248 offset:2048
ds_read_b128 v[236:239], v248 offset:2560
s_waitcnt lgkmcnt(2)
s_waitcnt vmcnt(16)
v_mfma_f32_16x16x32_bf16 v[160:163], v[224:227], v[0:3], 0
ds_read_b128 v[240:243], v248 offset:16384
v_mfma_f32_16x16x32_bf16 v[160:163], v[228:231], v[4:7], v[160:163]
buffer_load_dwordx4 v[24:27], v252, s[8:11], s44 offen offset:2048
v_mfma_f32_16x16x32_bf16 v[164:167], v[224:227], v[32:35], 0
v_mfma_f32_16x16x32_bf16 v[164:167], v[228:231], v[36:39], v[164:167]
buffer_load_dwordx4 v[56:59], v252, s[8:11], s45 offen offset:2048
v_mfma_f32_16x16x32_bf16 v[168:171], v[224:227], v[64:67], 0
ds_read_b128 v[244:247], v248 offset:16896
v_mfma_f32_16x16x32_bf16 v[168:171], v[228:231], v[68:71], v[168:171]
buffer_load_dwordx4 v[88:91], v252, s[8:11], s46 offen offset:2048
v_mfma_f32_16x16x32_bf16 v[172:175], v[224:227], v[96:99], 0
v_mfma_f32_16x16x32_bf16 v[172:175], v[228:231], v[100:103], v[172:175]
s_waitcnt lgkmcnt(2)
buffer_load_dwordx4 v[120:123], v252, s[8:11], s47 offen offset:2048
v_mfma_f32_16x16x32_bf16 v[176:179], v[232:235], v[0:3], 0
ds_read_b128 v[224:227], v248 offset:4096
v_mfma_f32_16x16x32_bf16 v[176:179], v[236:239], v[4:7], v[176:179]
buffer_load_dwordx4 v[28:31], v252, s[8:11], s44 offen offset:3072
v_mfma_f32_16x16x32_bf16 v[180:183], v[232:235], v[32:35], 0
v_mfma_f32_16x16x32_bf16 v[180:183], v[236:239], v[36:39], v[180:183]
buffer_load_dwordx4 v[60:63], v252, s[8:11], s45 offen offset:3072
v_mfma_f32_16x16x32_bf16 v[184:187], v[232:235], v[64:67], 0
ds_read_b128 v[228:231], v248 offset:4608
v_mfma_f32_16x16x32_bf16 v[184:187], v[236:239], v[68:71], v[184:187]
buffer_load_dwordx4 v[92:95], v252, s[8:11], s46 offen offset:3072
v_mfma_f32_16x16x32_bf16 v[188:191], v[232:235], v[96:99], 0
v_mfma_f32_16x16x32_bf16 v[188:191], v[236:239], v[100:103], v[188:191]
s_waitcnt lgkmcnt(2)
buffer_load_dwordx4 v[124:127], v252, s[8:11], s47 offen offset:3072
v_mfma_f32_16x16x32_bf16 v[192:195], v[240:243], v[0:3], 0
ds_read_b128 v[232:235], v248 offset:6144
v_mfma_f32_16x16x32_bf16 v[192:195], v[244:247], v[4:7], v[192:195]
v_mfma_f32_16x16x32_bf16 v[196:199], v[240:243], v[32:35], 0
v_mfma_f32_16x16x32_bf16 v[196:199], v[244:247], v[36:39], v[196:199]
v_mfma_f32_16x16x32_bf16 v[200:203], v[240:243], v[64:67], 0
ds_read_b128 v[236:239], v248 offset:6656
v_mfma_f32_16x16x32_bf16 v[200:203], v[244:247], v[68:71], v[200:203]
v_mfma_f32_16x16x32_bf16 v[204:207], v[240:243], v[96:99], 0
v_mfma_f32_16x16x32_bf16 v[204:207], v[244:247], v[100:103], v[204:207]
s_waitcnt lgkmcnt(2)
s_waitcnt vmcnt(16)
v_mfma_f32_16x16x32_bf16 v[160:163], v[224:227], v[8:11], v[160:163]
ds_read_b128 v[240:243], v248 offset:20480
v_mfma_f32_16x16x32_bf16 v[160:163], v[228:231], v[12:15], v[160:163]
buffer_load_dwordx4 v251, s[12:15], s28 offen offset:2048 lds
v_mfma_f32_16x16x32_bf16 v[164:167], v[224:227], v[40:43], v[164:167]
v_mfma_f32_16x16x32_bf16 v[164:167], v[228:231], v[44:47], v[164:167]
buffer_load_dwordx4 v251, s[12:15], s28 offen offset:3072 lds
v_mfma_f32_16x16x32_bf16 v[168:171], v[224:227], v[72:75], v[168:171]
ds_read_b128 v[244:247], v248 offset:20992
v_mfma_f32_16x16x32_bf16 v[168:171], v[228:231], v[76:79], v[168:171]
s_add_u32 s28, s28, 0x4000
s_add_u32 m0, s30, 0x8000
s_nop 0
v_mfma_f32_16x16x32_bf16 v[172:175], v[224:227], v[104:107], v[172:175]
v_mfma_f32_16x16x32_bf16 v[172:175], v[228:231], v[108:111], v[172:175]
s_waitcnt lgkmcnt(2)
buffer_load_dwordx4 v251, s[12:15], s28 offen offset:0 lds
v_mfma_f32_16x16x32_bf16 v[176:179], v[232:235], v[8:11], v[176:179]
ds_read_b128 v[224:227], v248 offset:8192
v_mfma_f32_16x16x32_bf16 v[176:179], v[236:239], v[12:15], v[176:179]
buffer_load_dwordx4 v251, s[12:15], s28 offen offset:1024 lds
v_mfma_f32_16x16x32_bf16 v[180:183], v[232:235], v[40:43], v[180:183]
v_mfma_f32_16x16x32_bf16 v[180:183], v[236:239], v[44:47], v[180:183]
buffer_load_dwordx4 v251, s[12:15], s28 offen offset:2048 lds
v_mfma_f32_16x16x32_bf16 v[184:187], v[232:235], v[72:75], v[184:187]
ds_read_b128 v[228:231], v248 offset:8704
v_mfma_f32_16x16x32_bf16 v[184:187], v[236:239], v[76:79], v[184:187]
buffer_load_dwordx4 v251, s[12:15], s28 offen offset:3072 lds
v_mfma_f32_16x16x32_bf16 v[188:191], v[232:235], v[104:107], v[188:191]
v_mfma_f32_16x16x32_bf16 v[188:191], v[236:239], v[108:111], v[188:191]
s_waitcnt lgkmcnt(2)
v_mfma_f32_16x16x32_bf16 v[192:195], v[240:243], v[8:11], v[192:195]
ds_read_b128 v[232:235], v248 offset:10240
v_mfma_f32_16x16x32_bf16 v[192:195], v[244:247], v[12:15], v[192:195]
v_mfma_f32_16x16x32_bf16 v[196:199], v[240:243], v[40:43], v[196:199]
v_mfma_f32_16x16x32_bf16 v[196:199], v[244:247], v[44:47], v[196:199]
v_mfma_f32_16x16x32_bf16 v[200:203], v[240:243], v[72:75], v[200:203]
ds_read_b128 v[236:239], v248 offset:10752
v_mfma_f32_16x16x32_bf16 v[200:203], v[244:247], v[76:79], v[200:203]
v_mfma_f32_16x16x32_bf16 v[204:207], v[240:243], v[104:107], v[204:207]
v_mfma_f32_16x16x32_bf16 v[204:207], v[244:247], v[108:111], v[204:207]
s_waitcnt lgkmcnt(2)
s_waitcnt vmcnt(14)
v_mfma_f32_16x16x32_bf16 v[160:163], v[224:227], v[16:19], v[160:163]
ds_read_b128 v[240:243], v248 offset:24576
v_mfma_f32_16x16x32_bf16 v[160:163], v[228:231], v[20:23], v[160:163]
s_add_u32 s28, s28, 0x4000
s_add_u32 m0, s30, 0xc000
s_nop 0
v_mfma_f32_16x16x32_bf16 v[164:167], v[224:227], v[48:51], v[164:167]
v_mfma_f32_16x16x32_bf16 v[164:167], v[228:231], v[52:55], v[164:167]
buffer_load_dwordx4 v251, s[12:15], s28 offen offset:0 lds
v_mfma_f32_16x16x32_bf16 v[168:171], v[224:227], v[80:83], v[168:171]
ds_read_b128 v[244:247], v248 offset:25088
v_mfma_f32_16x16x32_bf16 v[168:171], v[228:231], v[84:87], v[168:171]
buffer_load_dwordx4 v251, s[12:15], s28 offen offset:1024 lds
v_mfma_f32_16x16x32_bf16 v[172:175], v[224:227], v[112:115], v[172:175]
v_mfma_f32_16x16x32_bf16 v[172:175], v[228:231], v[116:119], v[172:175]
s_waitcnt lgkmcnt(2)
buffer_load_dwordx4 v251, s[12:15], s28 offen offset:2048 lds
v_mfma_f32_16x16x32_bf16 v[176:179], v[232:235], v[16:19], v[176:179]
ds_read_b128 v[224:227], v248 offset:12288
v_mfma_f32_16x16x32_bf16 v[176:179], v[236:239], v[20:23], v[176:179]
buffer_load_dwordx4 v251, s[12:15], s28 offen offset:3072 lds
v_mfma_f32_16x16x32_bf16 v[180:183], v[232:235], v[48:51], v[180:183]
v_mfma_f32_16x16x32_bf16 v[180:183], v[236:239], v[52:55], v[180:183]
v_mfma_f32_16x16x32_bf16 v[184:187], v[232:235], v[80:83], v[184:187]
ds_read_b128 v[228:231], v248 offset:12800
v_mfma_f32_16x16x32_bf16 v[184:187], v[236:239], v[84:87], v[184:187]
v_mfma_f32_16x16x32_bf16 v[188:191], v[232:235], v[112:115], v[188:191]
v_mfma_f32_16x16x32_bf16 v[188:191], v[236:239], v[116:119], v[188:191]
s_waitcnt lgkmcnt(2)
v_mfma_f32_16x16x32_bf16 v[192:195], v[240:243], v[16:19], v[192:195]
ds_read_b128 v[232:235], v248 offset:14336
v_mfma_f32_16x16x32_bf16 v[192:195], v[244:247], v[20:23], v[192:195]
v_mfma_f32_16x16x32_bf16 v[196:199], v[240:243], v[48:51], v[196:199]
v_mfma_f32_16x16x32_bf16 v[196:199], v[244:247], v[52:55], v[196:199]
v_mfma_f32_16x16x32_bf16 v[200:203], v[240:243], v[80:83], v[200:203]
ds_read_b128 v[236:239], v248 offset:14848
v_mfma_f32_16x16x32_bf16 v[200:203], v[244:247], v[84:87], v[200:203]
v_mfma_f32_16x16x32_bf16 v[204:207], v[240:243], v[112:115], v[204:207]
v_mfma_f32_16x16x32_bf16 v[204:207], v[244:247], v[116:119], v[204:207]
s_waitcnt lgkmcnt(2)
s_waitcnt vmcnt(10)
v_mfma_f32_16x16x32_bf16 v[160:163], v[224:227], v[24:27], v[160:163]
ds_read_b128 v[240:243], v248 offset:28672
v_mfma_f32_16x16x32_bf16 v[160:163], v[228:231], v[28:31], v[160:163]
s_add_u32 s28, s28, 0x4000
s_add_u32 m0, s30, 0x10000
s_nop 0
v_mfma_f32_16x16x32_bf16 v[164:167], v[224:227], v[56:59], v[164:167]
v_mfma_f32_16x16x32_bf16 v[164:167], v[228:231], v[60:63], v[164:167]
buffer_load_dwordx4 v251, s[12:15], s28 offen offset:0 lds
v_mfma_f32_16x16x32_bf16 v[168:171], v[224:227], v[88:91], v[168:171]
ds_read_b128 v[244:247], v248 offset:29184
v_mfma_f32_16x16x32_bf16 v[168:171], v[228:231], v[92:95], v[168:171]
buffer_load_dwordx4 v251, s[12:15], s28 offen offset:1024 lds
v_mfma_f32_16x16x32_bf16 v[172:175], v[224:227], v[120:123], v[172:175]
v_mfma_f32_16x16x32_bf16 v[172:175], v[228:231], v[124:127], v[172:175]
s_waitcnt lgkmcnt(2)
buffer_load_dwordx4 v251, s[12:15], s28 offen offset:2048 lds
v_mfma_f32_16x16x32_bf16 v[176:179], v[232:235], v[24:27], v[176:179]
v_mfma_f32_16x16x32_bf16 v[176:179], v[236:239], v[28:31], v[176:179]
buffer_load_dwordx4 v251, s[12:15], s28 offen offset:3072 lds
v_mfma_f32_16x16x32_bf16 v[180:183], v[232:235], v[56:59], v[180:183]
v_mfma_f32_16x16x32_bf16 v[180:183], v[236:239], v[60:63], v[180:183]
v_mfma_f32_16x16x32_bf16 v[184:187], v[232:235], v[88:91], v[184:187]
v_mfma_f32_16x16x32_bf16 v[184:187], v[236:239], v[92:95], v[184:187]
v_mfma_f32_16x16x32_bf16 v[188:191], v[232:235], v[120:123], v[188:191]
v_mfma_f32_16x16x32_bf16 v[188:191], v[236:239], v[124:127], v[188:191]
s_waitcnt lgkmcnt(0)
v_mfma_f32_16x16x32_bf16 v[192:195], v[240:243], v[24:27], v[192:195]
v_mfma_f32_16x16x32_bf16 v[192:195], v[244:247], v[28:31], v[192:195]
v_mfma_f32_16x16x32_bf16 v[196:199], v[240:243], v[56:59], v[196:199]
v_mfma_f32_16x16x32_bf16 v[196:199], v[244:247], v[60:63], v[196:199]
v_mfma_f32_16x16x32_bf16 v[200:203], v[240:243], v[88:91], v[200:203]
v_mfma_f32_16x16x32_bf16 v[200:203], v[244:247], v[92:95], v[200:203]
v_mfma_f32_16x16x32_bf16 v[204:207], v[240:243], v[120:123], v[204:207]
v_mfma_f32_16x16x32_bf16 v[204:207], v[244:247], v[124:127], v[204:207]
s_nop 3
v_max3_f32 v224, v160, v161, v162
v_max3_f32 v225, v164, v165, v166
v_max3_f32 v226, v168, v169, v170
v_max3_f32 v227, v172, v173, v174
v_max3_f32 v224, v224, v163, v176
v_max3_f32 v225, v225, v167, v180
v_max3_f32 v226, v226, v171, v184
v_max3_f32 v227, v227, v175, v188
v_max3_f32 v224, v224, v177, v178
v_max3_f32 v225, v225, v181, v182
v_max3_f32 v226, v226, v185, v186
v_max3_f32 v227, v227, v189, v190
v_max_f32 v224, v224, v179
v_max_f32 v225, v225, v183
v_max_f32 v226, v226, v187
v_max_f32 v227, v227, v191
s_add_u32 s28, s28, 0x4000
s_xor_b32 s30, s30, 0x10000
v_mov_b32 v228, v224
v_mov_b32 v229, v225
v_mov_b32 v230, v226
v_mov_b32 v231, v227
v_permlane32_swap_b32 v224, v228
v_permlane32_swap_b32 v225, v229
v_permlane32_swap_b32 v226, v230
v_permlane32_swap_b32 v227, v231
v_max_f32 v224, v224, v228
v_max_f32 v225, v225, v229
v_max_f32 v226, v226, v230
v_max_f32 v227, v227, v231
v_mov_b32 v228, v224
v_mov_b32 v229, v225
v_mov_b32 v230, v226
v_mov_b32 v231, v227
v_permlane16_swap_b32 v224, v228
v_permlane16_swap_b32 v225, v229
v_permlane16_swap_b32 v226, v230
v_permlane16_swap_b32 v227, v231
v_max_f32 v224, v224, v228
v_max_f32 v225, v225, v229
v_max_f32 v226, v226, v230
v_max_f32 v227, v227, v231
s_waitcnt vmcnt(8)
s_barrier
ds_read_b128 v[232:235], v248 offset:18432
ds_read_b128 v[236:239], v248 offset:18944
ds_read_b128 v[240:243], v248 offset:22528
ds_read_b128 v[244:247], v248 offset:23040
v_cvt_pk_bf16_f32 v228, -v224, -v224
v_cvt_pk_bf16_f32 v229, -v225, -v225
v_cvt_pk_bf16_f32 v230, -v226, -v226
v_cvt_pk_bf16_f32 v231, -v227, -v227
v_lshlrev_b32 v253, 2, v252
v_lshlrev_b32 v147, 16, v228
v_lshlrev_b32 v151, 16, v229
v_lshlrev_b32 v155, 16, v230
v_lshlrev_b32 v159, 16, v231
s_mov_b64 exec, 0xffff
v_bfi_b32 v0, s32, v228, v0
v_bfi_b32 v32, s32, v229, v32
v_bfi_b32 v64, s32, v230, v64
v_bfi_b32 v96, s32, v231, v96
v_xor_b32 v224, 0x80000000, v147
v_xor_b32 v225, 0x80000000, v151
v_xor_b32 v226, 0x80000000, v155
v_xor_b32 v227, 0x80000000, v159
s_xor_b32 s35, s48, 0
buffer_store_dword v224, v253, s[24:27], s35 offen offset:0 sc1
s_xor_b32 s35, s48, 1024
buffer_store_dword v225, v253, s[24:27], s35 offen offset:0 sc1
s_xor_b32 s35, s48, 2048
buffer_store_dword v226, v253, s[24:27], s35 offen offset:0 sc1
s_xor_b32 s35, s48, 3072
buffer_store_dword v227, v253, s[24:27], s35 offen offset:0 sc1
s_mov_b64 exec, -1
s_waitcnt lgkmcnt(2)
v_mfma_f32_16x16x32_bf16 v[208:211], v[232:235], v[0:3], 0
ds_read_b128 v[224:227], v248 offset:26624
v_add_f32 v192, v192, v147
v_add_f32 v193, v193, v147
v_add_f32 v194, v194, v147
v_mfma_f32_16x16x32_bf16 v[208:211], v[236:239], v[4:7], v[208:211]
v_add_f32 v195, v195, v147
v_exp_f32 v192, v192
v_mfma_f32_16x16x32_bf16 v[212:215], v[232:235], v[32:35], 0
v_exp_f32 v193, v193
v_exp_f32 v194, v194
v_mfma_f32_16x16x32_bf16 v[212:215], v[236:239], v[36:39], v[212:215]
v_exp_f32 v195, v195
v_add_f32 v196, v196, v151
v_add_f32 v197, v197, v151
v_mfma_f32_16x16x32_bf16 v[216:219], v[232:235], v[64:67], 0
ds_read_b128 v[228:231], v248 offset:27136
v_cvt_pk_bf16_f32 v144, v192, v193
v_cvt_pk_bf16_f32 v145, v194, v195
v_add_f32 v198, v198, v151
v_mfma_f32_16x16x32_bf16 v[216:219], v[236:239], v[68:71], v[216:219]
v_add_f32 v199, v199, v151
v_exp_f32 v196, v196
v_mfma_f32_16x16x32_bf16 v[220:223], v[232:235], v[96:99], 0
v_exp_f32 v197, v197
v_exp_f32 v198, v198
v_mfma_f32_16x16x32_bf16 v[220:223], v[236:239], v[100:103], v[220:223]
s_waitcnt lgkmcnt(2)
v_exp_f32 v199, v199
v_cvt_pk_bf16_f32 v148, v196, v197
v_mfma_f32_16x16x32_bf16 v[208:211], v[240:243], v[8:11], v[208:211]
ds_read_b128 v[232:235], v248 offset:30720
v_cvt_pk_bf16_f32 v149, v198, v199
v_add_f32 v200, v200, v155
v_add_f32 v201, v201, v155
v_mfma_f32_16x16x32_bf16 v[208:211], v[244:247], v[12:15], v[208:211]
v_add_f32 v202, v202, v155
v_add_f32 v203, v203, v155
v_exp_f32 v200, v200
v_mfma_f32_16x16x32_bf16 v[212:215], v[240:243], v[40:43], v[212:215]
v_exp_f32 v201, v201
v_exp_f32 v202, v202
v_mfma_f32_16x16x32_bf16 v[212:215], v[244:247], v[44:47], v[212:215]
v_exp_f32 v203, v203
v_add_f32 v204, v204, v159
v_add_f32 v205, v205, v159
v_mfma_f32_16x16x32_bf16 v[216:219], v[240:243], v[72:75], v[216:219]
ds_read_b128 v[236:239], v248 offset:31232
v_cvt_pk_bf16_f32 v152, v200, v201
v_cvt_pk_bf16_f32 v153, v202, v203
v_add_f32 v206, v206, v159
v_mfma_f32_16x16x32_bf16 v[216:219], v[244:247], v[76:79], v[216:219]
v_add_f32 v207, v207, v159
v_exp_f32 v204, v204
v_mfma_f32_16x16x32_bf16 v[220:223], v[240:243], v[104:107], v[220:223]
v_exp_f32 v205, v205
v_exp_f32 v206, v206
v_mfma_f32_16x16x32_bf16 v[220:223], v[244:247], v[108:111], v[220:223]
s_waitcnt lgkmcnt(2)
v_exp_f32 v207, v207
v_cvt_pk_bf16_f32 v156, v204, v205
v_mfma_f32_16x16x32_bf16 v[208:211], v[224:227], v[16:19], v[208:211]
ds_read_b128 v[240:243], v248 offset:32768
v_cvt_pk_bf16_f32 v157, v206, v207
v_add_f32 v160, v160, v147
v_add_f32 v161, v161, v147
v_mfma_f32_16x16x32_bf16 v[208:211], v[228:231], v[20:23], v[208:211]
v_add_f32 v162, v162, v147
v_add_f32 v163, v163, v147
v_exp_f32 v160, v160
v_mfma_f32_16x16x32_bf16 v[212:215], v[224:227], v[48:51], v[212:215]
v_exp_f32 v161, v161
v_exp_f32 v162, v162
v_mfma_f32_16x16x32_bf16 v[212:215], v[228:231], v[52:55], v[212:215]
v_exp_f32 v163, v163
v_add_f32 v164, v164, v151
v_add_f32 v165, v165, v151
v_mfma_f32_16x16x32_bf16 v[216:219], v[224:227], v[80:83], v[216:219]
ds_read_b128 v[244:247], v248 offset:33280
v_cvt_pk_bf16_f32 v128, v160, v161
v_cvt_pk_bf16_f32 v129, v162, v163
v_add_f32 v166, v166, v151
v_mfma_f32_16x16x32_bf16 v[216:219], v[228:231], v[84:87], v[216:219]
v_add_f32 v167, v167, v151
v_exp_f32 v164, v164
v_mfma_f32_16x16x32_bf16 v[220:223], v[224:227], v[112:115], v[220:223]
v_exp_f32 v165, v165
v_exp_f32 v166, v166
v_mfma_f32_16x16x32_bf16 v[220:223], v[228:231], v[116:119], v[220:223]
s_waitcnt lgkmcnt(2)
v_exp_f32 v167, v167
v_cvt_pk_bf16_f32 v132, v164, v165
v_mfma_f32_16x16x32_bf16 v[208:211], v[232:235], v[24:27], v[208:211]
ds_read_b128 v[224:227], v248 offset:36864
v_cvt_pk_bf16_f32 v133, v166, v167
v_add_f32 v168, v168, v155
v_add_f32 v169, v169, v155
v_mfma_f32_16x16x32_bf16 v[208:211], v[236:239], v[28:31], v[208:211]
v_add_f32 v170, v170, v155
v_add_f32 v171, v171, v155
v_exp_f32 v168, v168
v_mfma_f32_16x16x32_bf16 v[212:215], v[232:235], v[56:59], v[212:215]
v_exp_f32 v169, v169
v_exp_f32 v170, v170
v_mfma_f32_16x16x32_bf16 v[212:215], v[236:239], v[60:63], v[212:215]
v_exp_f32 v171, v171
v_add_f32 v172, v172, v159
v_add_f32 v173, v173, v159
v_mfma_f32_16x16x32_bf16 v[216:219], v[232:235], v[88:91], v[216:219]
ds_read_b128 v[228:231], v248 offset:37376
v_cvt_pk_bf16_f32 v136, v168, v169
v_cvt_pk_bf16_f32 v137, v170, v171
v_add_f32 v174, v174, v159
v_mfma_f32_16x16x32_bf16 v[216:219], v[236:239], v[92:95], v[216:219]
v_add_f32 v175, v175, v159
v_exp_f32 v172, v172
v_mfma_f32_16x16x32_bf16 v[220:223], v[232:235], v[120:123], v[220:223]
v_exp_f32 v173, v173
v_exp_f32 v174, v174
v_mfma_f32_16x16x32_bf16 v[220:223], v[236:239], v[124:127], v[220:223]
s_waitcnt lgkmcnt(2)
v_exp_f32 v175, v175
v_cvt_pk_bf16_f32 v140, v172, v173
v_mfma_f32_16x16x32_bf16 v[192:195], v[240:243], v[0:3], 0
ds_read_b128 v[232:235], v248 offset:40960
v_cvt_pk_bf16_f32 v141, v174, v175
v_add_f32 v176, v176, v147
v_add_f32 v177, v177, v147
v_mfma_f32_16x16x32_bf16 v[192:195], v[244:247], v[4:7], v[192:195]
v_add_f32 v178, v178, v147
v_add_f32 v179, v179, v147
v_exp_f32 v176, v176
v_mfma_f32_16x16x32_bf16 v[196:199], v[240:243], v[32:35], 0
v_exp_f32 v177, v177
v_exp_f32 v178, v178
v_mfma_f32_16x16x32_bf16 v[196:199], v[244:247], v[36:39], v[196:199]
v_exp_f32 v179, v179
v_add_f32 v180, v180, v151
v_add_f32 v181, v181, v151
v_mfma_f32_16x16x32_bf16 v[200:203], v[240:243], v[64:67], 0
ds_read_b128 v[236:239], v248 offset:41472
v_cvt_pk_bf16_f32 v130, v176, v177
v_cvt_pk_bf16_f32 v131, v178, v179
v_add_f32 v182, v182, v151
v_mfma_f32_16x16x32_bf16 v[200:203], v[244:247], v[68:71], v[200:203]
v_add_f32 v183, v183, v151
v_exp_f32 v180, v180
v_mfma_f32_16x16x32_bf16 v[204:207], v[240:243], v[96:99], 0
v_exp_f32 v181, v181
v_exp_f32 v182, v182
v_mfma_f32_16x16x32_bf16 v[204:207], v[244:247], v[100:103], v[204:207]
s_waitcnt lgkmcnt(2)
v_exp_f32 v183, v183
v_cvt_pk_bf16_f32 v134, v180, v181
v_mfma_f32_16x16x32_bf16 v[192:195], v[224:227], v[8:11], v[192:195]
ds_read_b128 v[240:243], v248 offset:45056
v_cvt_pk_bf16_f32 v135, v182, v183
v_add_f32 v184, v184, v155
v_add_f32 v185, v185, v155
v_mfma_f32_16x16x32_bf16 v[192:195], v[228:231], v[12:15], v[192:195]
v_add_f32 v186, v186, v155
v_add_f32 v187, v187, v155
v_exp_f32 v184, v184
v_mfma_f32_16x16x32_bf16 v[196:199], v[224:227], v[40:43], v[196:199]
v_exp_f32 v185, v185
v_exp_f32 v186, v186
v_mfma_f32_16x16x32_bf16 v[196:199], v[228:231], v[44:47], v[196:199]
v_exp_f32 v187, v187
v_add_f32 v188, v188, v159
v_add_f32 v189, v189, v159
v_mfma_f32_16x16x32_bf16 v[200:203], v[224:227], v[72:75], v[200:203]
ds_read_b128 v[244:247], v248 offset:45568
v_cvt_pk_bf16_f32 v138, v184, v185
v_cvt_pk_bf16_f32 v139, v186, v187
v_add_f32 v190, v190, v159
v_mfma_f32_16x16x32_bf16 v[200:203], v[228:231], v[76:79], v[200:203]
v_add_f32 v191, v191, v159
v_exp_f32 v188, v188
v_mfma_f32_16x16x32_bf16 v[204:207], v[224:227], v[104:107], v[204:207]
v_exp_f32 v189, v189
v_exp_f32 v190, v190
v_mfma_f32_16x16x32_bf16 v[204:207], v[228:231], v[108:111], v[204:207]
s_waitcnt lgkmcnt(2)
v_exp_f32 v191, v191
v_cvt_pk_bf16_f32 v142, v188, v189
v_mfma_f32_16x16x32_bf16 v[192:195], v[232:235], v[16:19], v[192:195]
ds_read_b64_tr_b16 v[224:225], v249 offset:0
v_cvt_pk_bf16_f32 v143, v190, v191
v_exp_f32 v208, v208
v_mfma_f32_16x16x32_bf16 v[192:195], v[236:239], v[20:23], v[192:195]
v_exp_f32 v209, v209
v_exp_f32 v210, v210
v_mfma_f32_16x16x32_bf16 v[196:199], v[232:235], v[48:51], v[196:199]
ds_read_b64_tr_b16 v[226:227], v249 offset:2048
v_exp_f32 v211, v211
v_cvt_pk_bf16_f32 v146, v208, v209
v_mfma_f32_16x16x32_bf16 v[196:199], v[236:239], v[52:55], v[196:199]
v_cvt_pk_bf16_f32 v147, v210, v211
v_exp_f32 v212, v212
v_mfma_f32_16x16x32_bf16 v[200:203], v[232:235], v[80:83], v[200:203]
ds_read_b64_tr_b16 v[228:229], v249 offset:16384
v_exp_f32 v213, v213
v_mfma_f32_16x16x32_bf16 v[200:203], v[236:239], v[84:87], v[200:203]
v_exp_f32 v214, v214
v_exp_f32 v215, v215
v_mfma_f32_16x16x32_bf16 v[204:207], v[232:235], v[112:115], v[204:207]
ds_read_b64_tr_b16 v[230:231], v249 offset:18432
v_cvt_pk_bf16_f32 v150, v212, v213
v_cvt_pk_bf16_f32 v151, v214, v215
v_mfma_f32_16x16x32_bf16 v[204:207], v[236:239], v[116:119], v[204:207]
s_waitcnt lgkmcnt(4)
v_exp_f32 v216, v216
v_mfma_f32_16x16x32_bf16 v[192:195], v[240:243], v[24:27], v[192:195]
ds_read_b64_tr_b16 v[232:233], v250 offset:0
v_exp_f32 v217, v217
v_mfma_f32_16x16x32_bf16 v[192:195], v[244:247], v[28:31], v[192:195]
v_exp_f32 v218, v218
v_exp_f32 v219, v219
v_mfma_f32_16x16x32_bf16 v[196:199], v[240:243], v[56:59], v[196:199]
ds_read_b64_tr_b16 v[234:235], v250 offset:2048
v_cvt_pk_bf16_f32 v154, v216, v217
v_cvt_pk_bf16_f32 v155, v218, v219
v_mfma_f32_16x16x32_bf16 v[196:199], v[244:247], v[60:63], v[196:199]
v_exp_f32 v220, v220
v_exp_f32 v221, v221
v_mfma_f32_16x16x32_bf16 v[200:203], v[240:243], v[88:91], v[200:203]
ds_read_b64_tr_b16 v[236:237], v250 offset:16384
v_exp_f32 v222, v222
v_cvt_pk_bf16_f32 v158, v220, v221
v_mfma_f32_16x16x32_bf16 v[200:203], v[244:247], v[92:95], v[200:203]
v_exp_f32 v223, v223
v_mfma_f32_16x16x32_bf16 v[204:207], v[240:243], v[120:123], v[204:207]
ds_read_b64_tr_b16 v[238:239], v250 offset:18432
v_cvt_pk_bf16_f32 v159, v222, v223
v_mfma_f32_16x16x32_bf16 v[204:207], v[244:247], v[124:127], v[204:207]
s_cmp_eq_u32 s50, 1
s_cselect_b32 s40, 0x7fff0000, s40
s_cselect_b32 s44, 0x7fff0000, s44
.p2align 6
L2_loop:
s_waitcnt lgkmcnt(4)
v_mfma_f32_16x16x32_bf16 a[0:3], v[224:227], v[128:131], a[0:3]
ds_read_b64_tr_b16 v[240:241], v249 offset:512
v_mfma_f32_16x16x32_bf16 a[0:3], v[228:231], v[144:147], a[0:3]
v_mfma_f32_16x16x32_bf16 a[4:7], v[224:227], v[132:135], a[4:7]
ds_read_b64_tr_b16 v[242:243], v249 offset:2560
v_mfma_f32_16x16x32_bf16 a[4:7], v[228:231], v[148:151], a[4:7]
v_exp_f32 v192, v192
v_mfma_f32_16x16x32_bf16 a[8:11], v[224:227], v[136:139], a[8:11]
ds_read_b64_tr_b16 v[244:245], v249 offset:16896
v_mfma_f32_16x16x32_bf16 a[8:11], v[228:231], v[152:155], a[8:11]
v_exp_f32 v193, v193
v_mfma_f32_16x16x32_bf16 a[12:15], v[224:227], v[140:143], a[12:15]
ds_read_b64_tr_b16 v[246:247], v249 offset:18944
v_cvt_pk_bf16_f32 v160, v192, v193
v_mfma_f32_16x16x32_bf16 a[12:15], v[228:231], v[156:159], a[12:15]
s_waitcnt lgkmcnt(4)
v_mfma_f32_16x16x32_bf16 a[16:19], v[232:235], v[128:131], a[16:19]
ds_read_b64_tr_b16 v[176:177], v250 offset:512
v_mfma_f32_16x16x32_bf16 a[16:19], v[236:239], v[144:147], a[16:19]
v_exp_f32 v194, v194
v_mfma_f32_16x16x32_bf16 a[20:23], v[232:235], v[132:135], a[20:23]
ds_read_b64_tr_b16 v[178:179], v250 offset:2560
v_mfma_f32_16x16x32_bf16 a[20:23], v[236:239], v[148:151], a[20:23]
v_exp_f32 v195, v195
v_mfma_f32_16x16x32_bf16 a[24:27], v[232:235], v[136:139], a[24:27]
ds_read_b64_tr_b16 v[180:181], v250 offset:16896
v_cvt_pk_bf16_f32 v161, v194, v195
v_mfma_f32_16x16x32_bf16 a[24:27], v[236:239], v[152:155], a[24:27]
v_exp_f32 v196, v196
v_mfma_f32_16x16x32_bf16 a[28:31], v[232:235], v[140:143], a[28:31]
ds_read_b64_tr_b16 v[182:183], v250 offset:18944
v_mfma_f32_16x16x32_bf16 a[28:31], v[236:239], v[156:159], a[28:31]
s_waitcnt lgkmcnt(4)
v_mfma_f32_16x16x32_bf16 a[32:35], v[240:243], v[128:131], a[32:35]
ds_read_b128 v[224:227], v248 offset:34816
v_mfma_f32_16x16x32_bf16 a[32:35], v[244:247], v[144:147], a[32:35]
v_exp_f32 v197, v197
v_mfma_f32_16x16x32_bf16 a[36:39], v[240:243], v[132:135], a[36:39]
v_exp_f32 v198, v198
v_mfma_f32_16x16x32_bf16 a[36:39], v[244:247], v[148:151], a[36:39]
v_exp_f32 v199, v199
v_mfma_f32_16x16x32_bf16 a[40:43], v[240:243], v[136:139], a[40:43]
ds_read_b128 v[228:231], v248 offset:35328
v_cvt_pk_bf16_f32 v164, v196, v197
v_mfma_f32_16x16x32_bf16 a[40:43], v[244:247], v[152:155], a[40:43]
v_cvt_pk_bf16_f32 v165, v198, v199
v_mfma_f32_16x16x32_bf16 a[44:47], v[240:243], v[140:143], a[44:47]
v_exp_f32 v200, v200
v_mfma_f32_16x16x32_bf16 a[44:47], v[244:247], v[156:159], a[44:47]
s_waitcnt lgkmcnt(2)
v_mfma_f32_16x16x32_bf16 a[48:51], v[176:179], v[128:131], a[48:51]
ds_read_b128 v[232:235], v248 offset:38912
v_mfma_f32_16x16x32_bf16 a[48:51], v[180:183], v[144:147], a[48:51]
v_exp_f32 v201, v201
v_mfma_f32_16x16x32_bf16 a[52:55], v[176:179], v[132:135], a[52:55]
v_exp_f32 v202, v202
v_mfma_f32_16x16x32_bf16 a[52:55], v[180:183], v[148:151], a[52:55]
v_exp_f32 v203, v203
v_mfma_f32_16x16x32_bf16 a[56:59], v[176:179], v[136:139], a[56:59]
ds_read_b128 v[236:239], v248 offset:39424
v_cvt_pk_bf16_f32 v168, v200, v201
v_mfma_f32_16x16x32_bf16 a[56:59], v[180:183], v[152:155], a[56:59]
v_cvt_pk_bf16_f32 v169, v202, v203
v_mfma_f32_16x16x32_bf16 a[60:63], v[176:179], v[140:143], a[60:63]
v_exp_f32 v204, v204
v_mfma_f32_16x16x32_bf16 a[60:63], v[180:183], v[156:159], a[60:63]
s_waitcnt lgkmcnt(2)
v_mfma_f32_16x16x32_bf16 v[208:211], v[224:227], v[0:3], 0
ds_read_b128 v[240:243], v248 offset:43008
v_mfma_f32_16x16x32_bf16 v[208:211], v[228:231], v[4:7], v[208:211]
v_exp_f32 v205, v205
v_mfma_f32_16x16x32_bf16 v[212:215], v[224:227], v[32:35], 0
v_exp_f32 v206, v206
v_mfma_f32_16x16x32_bf16 v[212:215], v[228:231], v[36:39], v[212:215]
v_exp_f32 v207, v207
v_mfma_f32_16x16x32_bf16 v[216:219], v[224:227], v[64:67], 0
ds_read_b128 v[244:247], v248 offset:43520
v_cvt_pk_bf16_f32 v172, v204, v205
v_mfma_f32_16x16x32_bf16 v[216:219], v[228:231], v[68:71], v[216:219]
v_cvt_pk_bf16_f32 v173, v206, v207
v_mfma_f32_16x16x32_bf16 v[220:223], v[224:227], v[96:99], 0
v_mfma_f32_16x16x32_bf16 v[220:223], v[228:231], v[100:103], v[220:223]
s_waitcnt lgkmcnt(2)
v_mfma_f32_16x16x32_bf16 v[208:211], v[232:235], v[8:11], v[208:211]
ds_read_b128 v[176:179], v248 offset:47104
v_mfma_f32_16x16x32_bf16 v[208:211], v[236:239], v[12:15], v[208:211]
v_mfma_f32_16x16x32_bf16 v[212:215], v[232:235], v[40:43], v[212:215]
v_mfma_f32_16x16x32_bf16 v[212:215], v[236:239], v[44:47], v[212:215]
v_mfma_f32_16x16x32_bf16 v[216:219], v[232:235], v[72:75], v[216:219]
ds_read_b128 v[180:183], v248 offset:47616
v_mfma_f32_16x16x32_bf16 v[216:219], v[236:239], v[76:79], v[216:219]
v_mfma_f32_16x16x32_bf16 v[220:223], v[232:235], v[104:107], v[220:223]
v_mfma_f32_16x16x32_bf16 v[220:223], v[236:239], v[108:111], v[220:223]
s_waitcnt lgkmcnt(2)
v_mfma_f32_16x16x32_bf16 v[208:211], v[240:243], v[16:19], v[208:211]
ds_read_b64_tr_b16 v[224:225], v249 offset:4096
v_mfma_f32_16x16x32_bf16 v[208:211], v[244:247], v[20:23], v[208:211]
v_mfma_f32_16x16x32_bf16 v[212:215], v[240:243], v[48:51], v[212:215]
ds_read_b64_tr_b16 v[226:227], v249 offset:6144
v_mfma_f32_16x16x32_bf16 v[212:215], v[244:247], v[52:55], v[212:215]
v_mfma_f32_16x16x32_bf16 v[216:219], v[240:243], v[80:83], v[216:219]
ds_read_b64_tr_b16 v[228:229], v249 offset:20480
v_mfma_f32_16x16x32_bf16 v[216:219], v[244:247], v[84:87], v[216:219]
v_mfma_f32_16x16x32_bf16 v[220:223], v[240:243], v[112:115], v[220:223]
ds_read_b64_tr_b16 v[230:231], v249 offset:22528
v_mfma_f32_16x16x32_bf16 v[220:223], v[244:247], v[116:119], v[220:223]
s_waitcnt lgkmcnt(4)
v_mfma_f32_16x16x32_bf16 v[208:211], v[176:179], v[24:27], v[208:211]
ds_read_b64_tr_b16 v[232:233], v250 offset:4096
v_mfma_f32_16x16x32_bf16 v[208:211], v[180:183], v[28:31], v[208:211]
v_mfma_f32_16x16x32_bf16 v[212:215], v[176:179], v[56:59], v[212:215]
ds_read_b64_tr_b16 v[234:235], v250 offset:6144
v_mfma_f32_16x16x32_bf16 v[212:215], v[180:183], v[60:63], v[212:215]
v_mfma_f32_16x16x32_bf16 v[216:219], v[176:179], v[88:91], v[216:219]
ds_read_b64_tr_b16 v[236:237], v250 offset:20480
v_mfma_f32_16x16x32_bf16 v[216:219], v[180:183], v[92:95], v[216:219]
v_mfma_f32_16x16x32_bf16 v[220:223], v[176:179], v[120:123], v[220:223]
ds_read_b64_tr_b16 v[238:239], v250 offset:22528
v_mfma_f32_16x16x32_bf16 v[220:223], v[180:183], v[124:127], v[220:223]
s_waitcnt lgkmcnt(4)
v_mfma_f32_16x16x32_bf16 a[64:67], v[224:227], v[128:131], a[64:67]
ds_read_b64_tr_b16 v[240:241], v249 offset:4608
v_mfma_f32_16x16x32_bf16 a[64:67], v[228:231], v[144:147], a[64:67]
v_mfma_f32_16x16x32_bf16 a[68:71], v[224:227], v[132:135], a[68:71]
ds_read_b64_tr_b16 v[242:243], v249 offset:6656
v_mfma_f32_16x16x32_bf16 a[68:71], v[228:231], v[148:151], a[68:71]
v_exp_f32 v208, v208
v_mfma_f32_16x16x32_bf16 a[72:75], v[224:227], v[136:139], a[72:75]
ds_read_b64_tr_b16 v[244:245], v249 offset:20992
v_mfma_f32_16x16x32_bf16 a[72:75], v[228:231], v[152:155], a[72:75]
v_exp_f32 v209, v209
v_mfma_f32_16x16x32_bf16 a[76:79], v[224:227], v[140:143], a[76:79]
ds_read_b64_tr_b16 v[246:247], v249 offset:23040
v_cvt_pk_bf16_f32 v162, v208, v209
v_mfma_f32_16x16x32_bf16 a[76:79], v[228:231], v[156:159], a[76:79]
s_waitcnt lgkmcnt(4)
s_waitcnt vmcnt(0)
s_barrier
s_add_u32 m0, s30, 0x4000
v_mfma_f32_16x16x32_bf16 a[80:83], v[232:235], v[128:131], a[80:83]
ds_read_b64_tr_b16 v[224:225], v250 offset:4608
v_mfma_f32_16x16x32_bf16 a[80:83], v[236:239], v[144:147], a[80:83]
buffer_load_dwordx4 v251, s[12:15], s28 offen offset:0 lds
v_mfma_f32_16x16x32_bf16 a[84:87], v[232:235], v[132:135], a[84:87]
ds_read_b64_tr_b16 v[226:227], v250 offset:6656
v_mfma_f32_16x16x32_bf16 a[84:87], v[236:239], v[148:151], a[84:87]
v_exp_f32 v210, v210
v_mfma_f32_16x16x32_bf16 a[88:91], v[232:235], v[136:139], a[88:91]
ds_read_b64_tr_b16 v[228:229], v250 offset:20992
v_mfma_f32_16x16x32_bf16 a[88:91], v[236:239], v[152:155], a[88:91]
v_exp_f32 v211, v211
v_mfma_f32_16x16x32_bf16 a[92:95], v[232:235], v[140:143], a[92:95]
ds_read_b64_tr_b16 v[230:231], v250 offset:23040
v_cvt_pk_bf16_f32 v163, v210, v211
v_mfma_f32_16x16x32_bf16 a[92:95], v[236:239], v[156:159], a[92:95]
s_waitcnt lgkmcnt(4)
v_mfma_f32_16x16x32_bf16 a[96:99], v[240:243], v[128:131], a[96:99]
ds_read_b128 v[232:235], v248 offset:49152
v_mfma_f32_16x16x32_bf16 a[96:99], v[244:247], v[144:147], a[96:99]
buffer_load_dwordx4 v251, s[12:15], s28 offen offset:1024 lds
v_mfma_f32_16x16x32_bf16 a[100:103], v[240:243], v[132:135], a[100:103]
v_exp_f32 v212, v212
v_mfma_f32_16x16x32_bf16 a[100:103], v[244:247], v[148:151], a[100:103]
v_exp_f32 v213, v213
v_mfma_f32_16x16x32_bf16 a[104:107], v[240:243], v[136:139], a[104:107]
ds_read_b128 v[236:239], v248 offset:49664
v_cvt_pk_bf16_f32 v166, v212, v213
v_mfma_f32_16x16x32_bf16 a[104:107], v[244:247], v[152:155], a[104:107]
v_exp_f32 v214, v214
v_mfma_f32_16x16x32_bf16 a[108:111], v[240:243], v[140:143], a[108:111]
v_exp_f32 v215, v215
v_mfma_f32_16x16x32_bf16 a[108:111], v[244:247], v[156:159], a[108:111]
s_waitcnt lgkmcnt(2)
v_cvt_pk_bf16_f32 v167, v214, v215
v_mfma_f32_16x16x32_bf16 a[112:115], v[224:227], v[128:131], a[112:115]
ds_read_b128 v[240:243], v248 offset:53248
v_mfma_f32_16x16x32_bf16 a[112:115], v[228:231], v[144:147], a[112:115]
buffer_load_dwordx4 v251, s[12:15], s28 offen offset:2048 lds
v_mfma_f32_16x16x32_bf16 a[116:119], v[224:227], v[132:135], a[116:119]
v_exp_f32 v216, v216
v_mfma_f32_16x16x32_bf16 a[116:119], v[228:231], v[148:151], a[116:119]
v_exp_f32 v217, v217
v_mfma_f32_16x16x32_bf16 a[120:123], v[224:227], v[136:139], a[120:123]
ds_read_b128 v[244:247], v248 offset:53760
v_cvt_pk_bf16_f32 v170, v216, v217
v_mfma_f32_16x16x32_bf16 a[120:123], v[228:231], v[152:155], a[120:123]
v_exp_f32 v218, v218
v_mfma_f32_16x16x32_bf16 a[124:127], v[224:227], v[140:143], a[124:127]
v_exp_f32 v219, v219
v_mfma_f32_16x16x32_bf16 a[124:127], v[228:231], v[156:159], a[124:127]
s_waitcnt lgkmcnt(2)
v_cvt_pk_bf16_f32 v171, v218, v219
v_mfma_f32_16x16x32_bf16 v[192:195], v[232:235], v[0:3], 0
ds_read_b128 v[224:227], v248 offset:57344
v_mfma_f32_16x16x32_bf16 v[192:195], v[236:239], v[4:7], v[192:195]
buffer_load_dwordx4 v251, s[12:15], s28 offen offset:3072 lds
v_mfma_f32_16x16x32_bf16 v[196:199], v[232:235], v[32:35], 0
v_exp_f32 v220, v220
v_mfma_f32_16x16x32_bf16 v[196:199], v[236:239], v[36:39], v[196:199]
s_add_u32 s28, s28, 0x4000
v_mfma_f32_16x16x32_bf16 v[200:203], v[232:235], v[64:67], 0
ds_read_b128 v[228:231], v248 offset:57856
v_mfma_f32_16x16x32_bf16 v[200:203], v[236:239], v[68:71], v[200:203]
v_exp_f32 v221, v221
v_mfma_f32_16x16x32_bf16 v[204:207], v[232:235], v[96:99], 0
v_exp_f32 v222, v222
v_mfma_f32_16x16x32_bf16 v[204:207], v[236:239], v[100:103], v[204:207]
s_waitcnt lgkmcnt(2)
s_add_u32 m0, s30, 0x8000
v_mfma_f32_16x16x32_bf16 v[192:195], v[240:243], v[8:11], v[192:195]
ds_read_b128 v[232:235], v248 offset:61440
v_cvt_pk_bf16_f32 v174, v220, v221
v_mfma_f32_16x16x32_bf16 v[192:195], v[244:247], v[12:15], v[192:195]
buffer_load_dwordx4 v251, s[12:15], s28 offen offset:0 lds
v_mfma_f32_16x16x32_bf16 v[196:199], v[240:243], v[40:43], v[196:199]
v_exp_f32 v223, v223
v_mfma_f32_16x16x32_bf16 v[196:199], v[244:247], v[44:47], v[196:199]
v_mfma_f32_16x16x32_bf16 v[200:203], v[240:243], v[72:75], v[200:203]
ds_read_b128 v[236:239], v248 offset:61952
v_cvt_pk_bf16_f32 v175, v222, v223
v_mfma_f32_16x16x32_bf16 v[200:203], v[244:247], v[76:79], v[200:203]
v_mfma_f32_16x16x32_bf16 v[204:207], v[240:243], v[104:107], v[204:207]
v_mfma_f32_16x16x32_bf16 v[204:207], v[244:247], v[108:111], v[204:207]
s_waitcnt lgkmcnt(2)
v_mfma_f32_16x16x32_bf16 v[192:195], v[224:227], v[16:19], v[192:195]
ds_read_b64_tr_b16 v[240:241], v249 offset:8192
v_mfma_f32_16x16x32_bf16 v[192:195], v[228:231], v[20:23], v[192:195]
buffer_load_dwordx4 v251, s[12:15], s28 offen offset:1024 lds
v_mfma_f32_16x16x32_bf16 v[196:199], v[224:227], v[48:51], v[196:199]
ds_read_b64_tr_b16 v[242:243], v249 offset:10240
v_mfma_f32_16x16x32_bf16 v[196:199], v[228:231], v[52:55], v[196:199]
v_mfma_f32_16x16x32_bf16 v[200:203], v[224:227], v[80:83], v[200:203]
ds_read_b64_tr_b16 v[244:245], v249 offset:24576
v_mfma_f32_16x16x32_bf16 v[200:203], v[228:231], v[84:87], v[200:203]
v_mfma_f32_16x16x32_bf16 v[204:207], v[224:227], v[112:115], v[204:207]
ds_read_b64_tr_b16 v[246:247], v249 offset:26624
v_mfma_f32_16x16x32_bf16 v[204:207], v[228:231], v[116:119], v[204:207]
s_waitcnt lgkmcnt(4)
v_mfma_f32_16x16x32_bf16 v[192:195], v[232:235], v[24:27], v[192:195]
ds_read_b64_tr_b16 v[224:225], v250 offset:8192
v_mfma_f32_16x16x32_bf16 v[192:195], v[236:239], v[28:31], v[192:195]
buffer_load_dwordx4 v251, s[12:15], s28 offen offset:2048 lds
v_mfma_f32_16x16x32_bf16 v[196:199], v[232:235], v[56:59], v[196:199]
ds_read_b64_tr_b16 v[226:227], v250 offset:10240
v_mfma_f32_16x16x32_bf16 v[196:199], v[236:239], v[60:63], v[196:199]
v_mfma_f32_16x16x32_bf16 v[200:203], v[232:235], v[88:91], v[200:203]
ds_read_b64_tr_b16 v[228:229], v250 offset:24576
v_mfma_f32_16x16x32_bf16 v[200:203], v[236:239], v[92:95], v[200:203]
v_mfma_f32_16x16x32_bf16 v[204:207], v[232:235], v[120:123], v[204:207]
ds_read_b64_tr_b16 v[230:231], v250 offset:26624
v_mfma_f32_16x16x32_bf16 v[204:207], v[236:239], v[124:127], v[204:207]
s_waitcnt lgkmcnt(4)
v_mfma_f32_16x16x32_bf16 a[128:131], v[240:243], v[128:131], a[128:131]
ds_read_b64_tr_b16 v[232:233], v249 offset:8704
v_mfma_f32_16x16x32_bf16 a[128:131], v[244:247], v[144:147], a[128:131]
buffer_load_dwordx4 v251, s[12:15], s28 offen offset:3072 lds
v_mfma_f32_16x16x32_bf16 a[132:135], v[240:243], v[132:135], a[132:135]
ds_read_b64_tr_b16 v[234:235], v249 offset:10752
v_mfma_f32_16x16x32_bf16 a[132:135], v[244:247], v[148:151], a[132:135]
s_add_u32 s28, s28, 0x4000
v_mfma_f32_16x16x32_bf16 a[136:139], v[240:243], v[136:139], a[136:139]
ds_read_b64_tr_b16 v[236:237], v249 offset:25088
v_mfma_f32_16x16x32_bf16 a[136:139], v[244:247], v[152:155], a[136:139]
v_exp_f32 v192, v192
v_mfma_f32_16x16x32_bf16 a[140:143], v[240:243], v[140:143], a[140:143]
ds_read_b64_tr_b16 v[238:239], v249 offset:27136
v_mfma_f32_16x16x32_bf16 a[140:143], v[244:247], v[156:159], a[140:143]
s_waitcnt lgkmcnt(4)
v_mfma_f32_16x16x32_bf16 a[144:147], v[224:227], v[128:131], a[144:147]
ds_read_b64_tr_b16 v[240:241], v250 offset:8704
v_mfma_f32_16x16x32_bf16 a[144:147], v[228:231], v[144:147], a[144:147]
v_exp_f32 v193, v193
v_mfma_f32_16x16x32_bf16 a[148:151], v[224:227], v[132:135], a[148:151]
ds_read_b64_tr_b16 v[242:243], v250 offset:10752
v_cvt_pk_bf16_f32 v176, v192, v193
v_mfma_f32_16x16x32_bf16 a[148:151], v[228:231], v[148:151], a[148:151]
v_exp_f32 v194, v194
v_mfma_f32_16x16x32_bf16 a[152:155], v[224:227], v[136:139], a[152:155]
ds_read_b64_tr_b16 v[244:245], v250 offset:25088
v_mfma_f32_16x16x32_bf16 a[152:155], v[228:231], v[152:155], a[152:155]
v_exp_f32 v195, v195
v_mfma_f32_16x16x32_bf16 a[156:159], v[224:227], v[140:143], a[156:159]
ds_read_b64_tr_b16 v[246:247], v250 offset:27136
v_cvt_pk_bf16_f32 v177, v194, v195
v_mfma_f32_16x16x32_bf16 a[156:159], v[228:231], v[156:159], a[156:159]
s_waitcnt lgkmcnt(4)
v_mfma_f32_16x16x32_bf16 a[160:163], v[232:235], v[128:131], a[160:163]
ds_read_b128 v[224:227], v248 offset:51200
v_mfma_f32_16x16x32_bf16 a[160:163], v[236:239], v[144:147], a[160:163]
v_exp_f32 v196, v196
v_mfma_f32_16x16x32_bf16 a[164:167], v[232:235], v[132:135], a[164:167]
v_exp_f32 v197, v197
v_mfma_f32_16x16x32_bf16 a[164:167], v[236:239], v[148:151], a[164:167]
v_exp_f32 v198, v198
v_mfma_f32_16x16x32_bf16 a[168:171], v[232:235], v[136:139], a[168:171]
ds_read_b128 v[228:231], v248 offset:51712
v_cvt_pk_bf16_f32 v180, v196, v197
v_mfma_f32_16x16x32_bf16 a[168:171], v[236:239], v[152:155], a[168:171]
v_exp_f32 v199, v199
v_mfma_f32_16x16x32_bf16 a[172:175], v[232:235], v[140:143], a[172:175]
v_exp_f32 v200, v200
v_mfma_f32_16x16x32_bf16 a[172:175], v[236:239], v[156:159], a[172:175]
s_waitcnt lgkmcnt(2)
v_cvt_pk_bf16_f32 v181, v198, v199
v_mfma_f32_16x16x32_bf16 a[176:179], v[240:243], v[128:131], a[176:179]
ds_read_b128 v[232:235], v248 offset:55296
v_mfma_f32_16x16x32_bf16 a[176:179], v[244:247], v[144:147], a[176:179]
v_exp_f32 v201, v201
v_mfma_f32_16x16x32_bf16 a[180:183], v[240:243], v[132:135], a[180:183]
v_exp_f32 v202, v202
v_mfma_f32_16x16x32_bf16 a[180:183], v[244:247], v[148:151], a[180:183]
v_exp_f32 v203, v203
v_mfma_f32_16x16x32_bf16 a[184:187], v[240:243], v[136:139], a[184:187]
ds_read_b128 v[236:239], v248 offset:55808
v_cvt_pk_bf16_f32 v184, v200, v201
v_mfma_f32_16x16x32_bf16 a[184:187], v[244:247], v[152:155], a[184:187]
v_cvt_pk_bf16_f32 v185, v202, v203
v_mfma_f32_16x16x32_bf16 a[188:191], v[240:243], v[140:143], a[188:191]
v_exp_f32 v204, v204
v_mfma_f32_16x16x32_bf16 a[188:191], v[244:247], v[156:159], a[188:191]
s_waitcnt lgkmcnt(2)
v_mfma_f32_16x16x32_bf16 v[208:211], v[224:227], v[0:3], 0
ds_read_b128 v[240:243], v248 offset:59392
v_mfma_f32_16x16x32_bf16 v[208:211], v[228:231], v[4:7], v[208:211]
v_exp_f32 v205, v205
v_mfma_f32_16x16x32_bf16 v[212:215], v[224:227], v[32:35], 0
v_exp_f32 v206, v206
v_mfma_f32_16x16x32_bf16 v[212:215], v[228:231], v[36:39], v[212:215]
v_exp_f32 v207, v207
v_mfma_f32_16x16x32_bf16 v[216:219], v[224:227], v[64:67], 0
ds_read_b128 v[244:247], v248 offset:59904
v_cvt_pk_bf16_f32 v188, v204, v205
v_mfma_f32_16x16x32_bf16 v[216:219], v[228:231], v[68:71], v[216:219]
v_cvt_pk_bf16_f32 v189, v206, v207
v_mfma_f32_16x16x32_bf16 v[220:223], v[224:227], v[96:99], 0
v_mfma_f32_16x16x32_bf16 v[220:223], v[228:231], v[100:103], v[220:223]
s_waitcnt lgkmcnt(2)
v_mfma_f32_16x16x32_bf16 v[208:211], v[232:235], v[8:11], v[208:211]
ds_read_b128 v[224:227], v248 offset:63488
v_mfma_f32_16x16x32_bf16 v[208:211], v[236:239], v[12:15], v[208:211]
v_mfma_f32_16x16x32_bf16 v[212:215], v[232:235], v[40:43], v[212:215]
v_mfma_f32_16x16x32_bf16 v[212:215], v[236:239], v[44:47], v[212:215]
v_mfma_f32_16x16x32_bf16 v[216:219], v[232:235], v[72:75], v[216:219]
ds_read_b128 v[228:231], v248 offset:64000
v_mfma_f32_16x16x32_bf16 v[216:219], v[236:239], v[76:79], v[216:219]
v_mfma_f32_16x16x32_bf16 v[220:223], v[232:235], v[104:107], v[220:223]
v_mfma_f32_16x16x32_bf16 v[220:223], v[236:239], v[108:111], v[220:223]
s_waitcnt lgkmcnt(2)
v_mfma_f32_16x16x32_bf16 v[208:211], v[240:243], v[16:19], v[208:211]
ds_read_b64_tr_b16 v[232:233], v249 offset:12288
v_mfma_f32_16x16x32_bf16 v[208:211], v[244:247], v[20:23], v[208:211]
v_mfma_f32_16x16x32_bf16 v[212:215], v[240:243], v[48:51], v[212:215]
ds_read_b64_tr_b16 v[234:235], v249 offset:14336
v_mfma_f32_16x16x32_bf16 v[212:215], v[244:247], v[52:55], v[212:215]
v_mfma_f32_16x16x32_bf16 v[216:219], v[240:243], v[80:83], v[216:219]
ds_read_b64_tr_b16 v[236:237], v249 offset:28672
v_mfma_f32_16x16x32_bf16 v[216:219], v[244:247], v[84:87], v[216:219]
v_mfma_f32_16x16x32_bf16 v[220:223], v[240:243], v[112:115], v[220:223]
ds_read_b64_tr_b16 v[238:239], v249 offset:30720
v_mfma_f32_16x16x32_bf16 v[220:223], v[244:247], v[116:119], v[220:223]
s_waitcnt lgkmcnt(4)
v_mfma_f32_16x16x32_bf16 v[208:211], v[224:227], v[24:27], v[208:211]
ds_read_b64_tr_b16 v[240:241], v250 offset:12288
v_mfma_f32_16x16x32_bf16 v[208:211], v[228:231], v[28:31], v[208:211]
v_mfma_f32_16x16x32_bf16 v[212:215], v[224:227], v[56:59], v[212:215]
ds_read_b64_tr_b16 v[242:243], v250 offset:14336
v_mfma_f32_16x16x32_bf16 v[212:215], v[228:231], v[60:63], v[212:215]
v_mfma_f32_16x16x32_bf16 v[216:219], v[224:227], v[88:91], v[216:219]
ds_read_b64_tr_b16 v[244:245], v250 offset:28672
v_mfma_f32_16x16x32_bf16 v[216:219], v[228:231], v[92:95], v[216:219]
v_mfma_f32_16x16x32_bf16 v[220:223], v[224:227], v[120:123], v[220:223]
ds_read_b64_tr_b16 v[246:247], v250 offset:30720
v_xor_b32 v248, 0x10000, v248
v_mfma_f32_16x16x32_bf16 v[220:223], v[228:231], v[124:127], v[220:223]
s_waitcnt lgkmcnt(4)
v_mfma_f32_16x16x32_bf16 a[192:195], v[232:235], v[128:131], a[192:195]
ds_read_b64_tr_b16 v[224:225], v249 offset:12800
v_mfma_f32_16x16x32_bf16 a[192:195], v[236:239], v[144:147], a[192:195]
v_mfma_f32_16x16x32_bf16 a[196:199], v[232:235], v[132:135], a[196:199]
ds_read_b64_tr_b16 v[226:227], v249 offset:14848
v_mfma_f32_16x16x32_bf16 a[196:199], v[236:239], v[148:151], a[196:199]
v_exp_f32 v208, v208
v_mfma_f32_16x16x32_bf16 a[200:203], v[232:235], v[136:139], a[200:203]
ds_read_b64_tr_b16 v[228:229], v249 offset:29184
v_mfma_f32_16x16x32_bf16 a[200:203], v[236:239], v[152:155], a[200:203]
v_exp_f32 v209, v209
v_mfma_f32_16x16x32_bf16 a[204:207], v[232:235], v[140:143], a[204:207]
ds_read_b64_tr_b16 v[230:231], v249 offset:31232
v_cvt_pk_bf16_f32 v178, v208, v209
v_mfma_f32_16x16x32_bf16 a[204:207], v[236:239], v[156:159], a[204:207]
s_waitcnt lgkmcnt(4)
v_mfma_f32_16x16x32_bf16 a[208:211], v[240:243], v[128:131], a[208:211]
ds_read_b64_tr_b16 v[232:233], v250 offset:12800
v_mfma_f32_16x16x32_bf16 a[208:211], v[244:247], v[144:147], a[208:211]
v_exp_f32 v210, v210
v_mfma_f32_16x16x32_bf16 a[212:215], v[240:243], v[132:135], a[212:215]
ds_read_b64_tr_b16 v[234:235], v250 offset:14848
v_mfma_f32_16x16x32_bf16 a[212:215], v[244:247], v[148:151], a[212:215]
v_exp_f32 v211, v211
v_mfma_f32_16x16x32_bf16 a[216:219], v[240:243], v[136:139], a[216:219]
ds_read_b64_tr_b16 v[236:237], v250 offset:29184
v_cvt_pk_bf16_f32 v179, v210, v211
v_mfma_f32_16x16x32_bf16 a[216:219], v[244:247], v[152:155], a[216:219]
v_exp_f32 v212, v212
v_mfma_f32_16x16x32_bf16 a[220:223], v[240:243], v[140:143], a[220:223]
ds_read_b64_tr_b16 v[238:239], v250 offset:31232
v_mfma_f32_16x16x32_bf16 a[220:223], v[244:247], v[156:159], a[220:223]
s_waitcnt lgkmcnt(4)
v_mfma_f32_16x16x32_bf16 a[224:227], v[224:227], v[128:131], a[224:227]
ds_read_b128 v[240:243], v248 offset:0
v_mfma_f32_16x16x32_bf16 a[224:227], v[228:231], v[144:147], a[224:227]
v_exp_f32 v213, v213
v_mfma_f32_16x16x32_bf16 a[228:231], v[224:227], v[132:135], a[228:231]
v_exp_f32 v214, v214
v_mfma_f32_16x16x32_bf16 a[228:231], v[228:231], v[148:151], a[228:231]
v_exp_f32 v215, v215
v_mfma_f32_16x16x32_bf16 a[232:235], v[224:227], v[136:139], a[232:235]
ds_read_b128 v[244:247], v248 offset:512
v_cvt_pk_bf16_f32 v182, v212, v213
v_mfma_f32_16x16x32_bf16 a[232:235], v[228:231], v[152:155], a[232:235]
v_cvt_pk_bf16_f32 v183, v214, v215
v_mfma_f32_16x16x32_bf16 a[236:239], v[224:227], v[140:143], a[236:239]
v_exp_f32 v216, v216
v_mfma_f32_16x16x32_bf16 a[236:239], v[228:231], v[156:159], a[236:239]
s_waitcnt lgkmcnt(2)
v_mfma_f32_16x16x32_bf16 a[240:243], v[232:235], v[128:131], a[240:243]
ds_read_b128 v[224:227], v248 offset:4096
v_mfma_f32_16x16x32_bf16 a[240:243], v[236:239], v[144:147], a[240:243]
v_exp_f32 v217, v217
v_mfma_f32_16x16x32_bf16 a[244:247], v[232:235], v[132:135], a[244:247]
v_exp_f32 v218, v218
v_mfma_f32_16x16x32_bf16 a[244:247], v[236:239], v[148:151], a[244:247]
v_exp_f32 v219, v219
v_mfma_f32_16x16x32_bf16 a[248:251], v[232:235], v[136:139], a[248:251]
ds_read_b128 v[228:231], v248 offset:4608
v_cvt_pk_bf16_f32 v186, v216, v217
v_mfma_f32_16x16x32_bf16 a[248:251], v[236:239], v[152:155], a[248:251]
v_cvt_pk_bf16_f32 v187, v218, v219
v_mfma_f32_16x16x32_bf16 a[252:255], v[232:235], v[140:143], a[252:255]
v_exp_f32 v220, v220
v_mfma_f32_16x16x32_bf16 a[252:255], v[236:239], v[156:159], a[252:255]
s_waitcnt lgkmcnt(2)
v_mfma_f32_16x16x32_bf16 v[192:195], v[240:243], v[0:3], 0
ds_read_b128 v[232:235], v248 offset:8192
v_mfma_f32_16x16x32_bf16 v[192:195], v[244:247], v[4:7], v[192:195]
v_exp_f32 v221, v221
v_mfma_f32_16x16x32_bf16 v[196:199], v[240:243], v[32:35], 0
v_exp_f32 v222, v222
v_mfma_f32_16x16x32_bf16 v[196:199], v[244:247], v[36:39], v[196:199]
v_exp_f32 v223, v223
v_mfma_f32_16x16x32_bf16 v[200:203], v[240:243], v[64:67], 0
ds_read_b128 v[236:239], v248 offset:8704
v_cvt_pk_bf16_f32 v190, v220, v221
v_mfma_f32_16x16x32_bf16 v[200:203], v[244:247], v[68:71], v[200:203]
v_cvt_pk_bf16_f32 v191, v222, v223
v_mfma_f32_16x16x32_bf16 v[204:207], v[240:243], v[96:99], 0
v_mfma_f32_16x16x32_bf16 v[204:207], v[244:247], v[100:103], v[204:207]
s_waitcnt lgkmcnt(2)
v_mfma_f32_16x16x32_bf16 v[192:195], v[224:227], v[8:11], v[192:195]
ds_read_b128 v[240:243], v248 offset:12288
v_mfma_f32_16x16x32_bf16 v[192:195], v[228:231], v[12:15], v[192:195]
v_mfma_f32_16x16x32_bf16 v[196:199], v[224:227], v[40:43], v[196:199]
v_mfma_f32_16x16x32_bf16 v[196:199], v[228:231], v[44:47], v[196:199]
v_mfma_f32_16x16x32_bf16 v[200:203], v[224:227], v[72:75], v[200:203]
ds_read_b128 v[244:247], v248 offset:12800
v_mfma_f32_16x16x32_bf16 v[200:203], v[228:231], v[76:79], v[200:203]
v_mfma_f32_16x16x32_bf16 v[204:207], v[224:227], v[104:107], v[204:207]
v_mfma_f32_16x16x32_bf16 v[204:207], v[228:231], v[108:111], v[204:207]
s_waitcnt lgkmcnt(2)
v_mfma_f32_16x16x32_bf16 v[192:195], v[232:235], v[16:19], v[192:195]
ds_read_b64_tr_b16 v[224:225], v249 offset:32768
v_mfma_f32_16x16x32_bf16 v[192:195], v[236:239], v[20:23], v[192:195]
v_mfma_f32_16x16x32_bf16 v[196:199], v[232:235], v[48:51], v[196:199]
ds_read_b64_tr_b16 v[226:227], v249 offset:34816
v_mfma_f32_16x16x32_bf16 v[196:199], v[236:239], v[52:55], v[196:199]
v_mfma_f32_16x16x32_bf16 v[200:203], v[232:235], v[80:83], v[200:203]
ds_read_b64_tr_b16 v[228:229], v249 offset:49152
v_mfma_f32_16x16x32_bf16 v[200:203], v[236:239], v[84:87], v[200:203]
v_mfma_f32_16x16x32_bf16 v[204:207], v[232:235], v[112:115], v[204:207]
ds_read_b64_tr_b16 v[230:231], v249 offset:51200
v_mfma_f32_16x16x32_bf16 v[204:207], v[236:239], v[116:119], v[204:207]
s_waitcnt lgkmcnt(4)
v_mfma_f32_16x16x32_bf16 v[192:195], v[240:243], v[24:27], v[192:195]
ds_read_b64_tr_b16 v[232:233], v250 offset:32768
v_mfma_f32_16x16x32_bf16 v[192:195], v[244:247], v[28:31], v[192:195]
v_mfma_f32_16x16x32_bf16 v[196:199], v[240:243], v[56:59], v[196:199]
ds_read_b64_tr_b16 v[234:235], v250 offset:34816
v_mfma_f32_16x16x32_bf16 v[196:199], v[244:247], v[60:63], v[196:199]
v_mfma_f32_16x16x32_bf16 v[200:203], v[240:243], v[88:91], v[200:203]
ds_read_b64_tr_b16 v[236:237], v250 offset:49152
v_mfma_f32_16x16x32_bf16 v[200:203], v[244:247], v[92:95], v[200:203]
s_sub_u32 s31, s31, 1
v_mfma_f32_16x16x32_bf16 v[204:207], v[240:243], v[120:123], v[204:207]
ds_read_b64_tr_b16 v[238:239], v250 offset:51200
v_mfma_f32_16x16x32_bf16 v[204:207], v[244:247], v[124:127], v[204:207]
s_cbranch_scc1 L2_tail_1
s_waitcnt lgkmcnt(4)
v_mfma_f32_16x16x32_bf16 a[0:3], v[224:227], v[160:163], a[0:3]
ds_read_b64_tr_b16 v[240:241], v249 offset:33280
v_mfma_f32_16x16x32_bf16 a[0:3], v[228:231], v[176:179], a[0:3]
v_mfma_f32_16x16x32_bf16 a[4:7], v[224:227], v[164:167], a[4:7]
ds_read_b64_tr_b16 v[242:243], v249 offset:35328
v_mfma_f32_16x16x32_bf16 a[4:7], v[228:231], v[180:183], a[4:7]
v_exp_f32 v192, v192
v_mfma_f32_16x16x32_bf16 a[8:11], v[224:227], v[168:171], a[8:11]
ds_read_b64_tr_b16 v[244:245], v249 offset:49664
v_mfma_f32_16x16x32_bf16 a[8:11], v[228:231], v[184:187], a[8:11]
v_exp_f32 v193, v193
v_mfma_f32_16x16x32_bf16 a[12:15], v[224:227], v[172:175], a[12:15]
ds_read_b64_tr_b16 v[246:247], v249 offset:51712
v_cvt_pk_bf16_f32 v128, v192, v193
v_mfma_f32_16x16x32_bf16 a[12:15], v[228:231], v[188:191], a[12:15]
s_waitcnt lgkmcnt(4)
v_mfma_f32_16x16x32_bf16 a[16:19], v[232:235], v[160:163], a[16:19]
ds_read_b64_tr_b16 v[144:145], v250 offset:33280
v_mfma_f32_16x16x32_bf16 a[16:19], v[236:239], v[176:179], a[16:19]
v_exp_f32 v194, v194
v_mfma_f32_16x16x32_bf16 a[20:23], v[232:235], v[164:167], a[20:23]
ds_read_b64_tr_b16 v[146:147], v250 offset:35328
v_mfma_f32_16x16x32_bf16 a[20:23], v[236:239], v[180:183], a[20:23]
v_exp_f32 v195, v195
v_mfma_f32_16x16x32_bf16 a[24:27], v[232:235], v[168:171], a[24:27]
ds_read_b64_tr_b16 v[148:149], v250 offset:49664
v_cvt_pk_bf16_f32 v129, v194, v195
v_mfma_f32_16x16x32_bf16 a[24:27], v[236:239], v[184:187], a[24:27]
v_exp_f32 v196, v196
v_mfma_f32_16x16x32_bf16 a[28:31], v[232:235], v[172:175], a[28:31]
ds_read_b64_tr_b16 v[150:151], v250 offset:51712
v_mfma_f32_16x16x32_bf16 a[28:31], v[236:239], v[188:191], a[28:31]
s_waitcnt lgkmcnt(4)
v_mfma_f32_16x16x32_bf16 a[32:35], v[240:243], v[160:163], a[32:35]
ds_read_b128 v[224:227], v248 offset:2048
v_mfma_f32_16x16x32_bf16 a[32:35], v[244:247], v[176:179], a[32:35]
v_exp_f32 v197, v197
v_mfma_f32_16x16x32_bf16 a[36:39], v[240:243], v[164:167], a[36:39]
v_exp_f32 v198, v198
v_mfma_f32_16x16x32_bf16 a[36:39], v[244:247], v[180:183], a[36:39]
v_exp_f32 v199, v199
v_mfma_f32_16x16x32_bf16 a[40:43], v[240:243], v[168:171], a[40:43]
ds_read_b128 v[228:231], v248 offset:2560
v_cvt_pk_bf16_f32 v132, v196, v197
v_mfma_f32_16x16x32_bf16 a[40:43], v[244:247], v[184:187], a[40:43]
v_cvt_pk_bf16_f32 v133, v198, v199
v_mfma_f32_16x16x32_bf16 a[44:47], v[240:243], v[172:175], a[44:47]
v_exp_f32 v200, v200
v_mfma_f32_16x16x32_bf16 a[44:47], v[244:247], v[188:191], a[44:47]
s_waitcnt lgkmcnt(2)
v_mfma_f32_16x16x32_bf16 a[48:51], v[144:147], v[160:163], a[48:51]
ds_read_b128 v[232:235], v248 offset:6144
v_mfma_f32_16x16x32_bf16 a[48:51], v[148:151], v[176:179], a[48:51]
v_exp_f32 v201, v201
v_mfma_f32_16x16x32_bf16 a[52:55], v[144:147], v[164:167], a[52:55]
v_exp_f32 v202, v202
v_mfma_f32_16x16x32_bf16 a[52:55], v[148:151], v[180:183], a[52:55]
v_exp_f32 v203, v203
v_mfma_f32_16x16x32_bf16 a[56:59], v[144:147], v[168:171], a[56:59]
ds_read_b128 v[236:239], v248 offset:6656
v_cvt_pk_bf16_f32 v136, v200, v201
v_mfma_f32_16x16x32_bf16 a[56:59], v[148:151], v[184:187], a[56:59]
v_cvt_pk_bf16_f32 v137, v202, v203
v_mfma_f32_16x16x32_bf16 a[60:63], v[144:147], v[172:175], a[60:63]
v_exp_f32 v204, v204
v_mfma_f32_16x16x32_bf16 a[60:63], v[148:151], v[188:191], a[60:63]
s_waitcnt lgkmcnt(2)
v_mfma_f32_16x16x32_bf16 v[208:211], v[224:227], v[0:3], 0
ds_read_b128 v[240:243], v248 offset:10240
v_mfma_f32_16x16x32_bf16 v[208:211], v[228:231], v[4:7], v[208:211]
v_exp_f32 v205, v205
v_mfma_f32_16x16x32_bf16 v[212:215], v[224:227], v[32:35], 0
v_exp_f32 v206, v206
v_mfma_f32_16x16x32_bf16 v[212:215], v[228:231], v[36:39], v[212:215]
v_exp_f32 v207, v207
v_mfma_f32_16x16x32_bf16 v[216:219], v[224:227], v[64:67], 0
ds_read_b128 v[244:247], v248 offset:10752
v_cvt_pk_bf16_f32 v140, v204, v205
v_mfma_f32_16x16x32_bf16 v[216:219], v[228:231], v[68:71], v[216:219]
v_cvt_pk_bf16_f32 v141, v206, v207
v_mfma_f32_16x16x32_bf16 v[220:223], v[224:227], v[96:99], 0
v_mfma_f32_16x16x32_bf16 v[220:223], v[228:231], v[100:103], v[220:223]
s_waitcnt lgkmcnt(2)
v_mfma_f32_16x16x32_bf16 v[208:211], v[232:235], v[8:11], v[208:211]
ds_read_b128 v[144:147], v248 offset:14336
v_mfma_f32_16x16x32_bf16 v[208:211], v[236:239], v[12:15], v[208:211]
v_mfma_f32_16x16x32_bf16 v[212:215], v[232:235], v[40:43], v[212:215]
v_mfma_f32_16x16x32_bf16 v[212:215], v[236:239], v[44:47], v[212:215]
v_mfma_f32_16x16x32_bf16 v[216:219], v[232:235], v[72:75], v[216:219]
ds_read_b128 v[148:151], v248 offset:14848
v_mfma_f32_16x16x32_bf16 v[216:219], v[236:239], v[76:79], v[216:219]
v_mfma_f32_16x16x32_bf16 v[220:223], v[232:235], v[104:107], v[220:223]
v_mfma_f32_16x16x32_bf16 v[220:223], v[236:239], v[108:111], v[220:223]
s_waitcnt lgkmcnt(2)
v_mfma_f32_16x16x32_bf16 v[208:211], v[240:243], v[16:19], v[208:211]
ds_read_b64_tr_b16 v[224:225], v249 offset:36864
v_mfma_f32_16x16x32_bf16 v[208:211], v[244:247], v[20:23], v[208:211]
v_mfma_f32_16x16x32_bf16 v[212:215], v[240:243], v[48:51], v[212:215]
ds_read_b64_tr_b16 v[226:227], v249 offset:38912
v_mfma_f32_16x16x32_bf16 v[212:215], v[244:247], v[52:55], v[212:215]
v_mfma_f32_16x16x32_bf16 v[216:219], v[240:243], v[80:83], v[216:219]
ds_read_b64_tr_b16 v[228:229], v249 offset:53248
v_mfma_f32_16x16x32_bf16 v[216:219], v[244:247], v[84:87], v[216:219]
v_mfma_f32_16x16x32_bf16 v[220:223], v[240:243], v[112:115], v[220:223]
ds_read_b64_tr_b16 v[230:231], v249 offset:55296
v_mfma_f32_16x16x32_bf16 v[220:223], v[244:247], v[116:119], v[220:223]
s_waitcnt lgkmcnt(4)
v_mfma_f32_16x16x32_bf16 v[208:211], v[144:147], v[24:27], v[208:211]
ds_read_b64_tr_b16 v[232:233], v250 offset:36864
v_mfma_f32_16x16x32_bf16 v[208:211], v[148:151], v[28:31], v[208:211]
v_mfma_f32_16x16x32_bf16 v[212:215], v[144:147], v[56:59], v[212:215]
ds_read_b64_tr_b16 v[234:235], v250 offset:38912
v_mfma_f32_16x16x32_bf16 v[212:215], v[148:151], v[60:63], v[212:215]
v_mfma_f32_16x16x32_bf16 v[216:219], v[144:147], v[88:91], v[216:219]
ds_read_b64_tr_b16 v[236:237], v250 offset:53248
v_mfma_f32_16x16x32_bf16 v[216:219], v[148:151], v[92:95], v[216:219]
v_mfma_f32_16x16x32_bf16 v[220:223], v[144:147], v[120:123], v[220:223]
ds_read_b64_tr_b16 v[238:239], v250 offset:55296
v_mfma_f32_16x16x32_bf16 v[220:223], v[148:151], v[124:127], v[220:223]
s_waitcnt lgkmcnt(4)
v_mfma_f32_16x16x32_bf16 a[64:67], v[224:227], v[160:163], a[64:67]
ds_read_b64_tr_b16 v[240:241], v249 offset:37376
v_mfma_f32_16x16x32_bf16 a[64:67], v[228:231], v[176:179], a[64:67]
v_mfma_f32_16x16x32_bf16 a[68:71], v[224:227], v[164:167], a[68:71]
ds_read_b64_tr_b16 v[242:243], v249 offset:39424
v_mfma_f32_16x16x32_bf16 a[68:71], v[228:231], v[180:183], a[68:71]
v_exp_f32 v208, v208
v_mfma_f32_16x16x32_bf16 a[72:75], v[224:227], v[168:171], a[72:75]
ds_read_b64_tr_b16 v[244:245], v249 offset:53760
v_mfma_f32_16x16x32_bf16 a[72:75], v[228:231], v[184:187], a[72:75]
v_exp_f32 v209, v209
v_mfma_f32_16x16x32_bf16 a[76:79], v[224:227], v[172:175], a[76:79]
ds_read_b64_tr_b16 v[246:247], v249 offset:55808
v_cvt_pk_bf16_f32 v130, v208, v209
v_mfma_f32_16x16x32_bf16 a[76:79], v[228:231], v[188:191], a[76:79]
s_waitcnt lgkmcnt(4)
s_waitcnt vmcnt(0)
s_barrier
s_add_u32 m0, s30, 0xc000
v_mfma_f32_16x16x32_bf16 a[80:83], v[232:235], v[160:163], a[80:83]
ds_read_b64_tr_b16 v[224:225], v250 offset:37376
v_mfma_f32_16x16x32_bf16 a[80:83], v[236:239], v[176:179], a[80:83]
buffer_load_dwordx4 v251, s[12:15], s28 offen offset:0 lds
v_mfma_f32_16x16x32_bf16 a[84:87], v[232:235], v[164:167], a[84:87]
ds_read_b64_tr_b16 v[226:227], v250 offset:39424
v_mfma_f32_16x16x32_bf16 a[84:87], v[236:239], v[180:183], a[84:87]
v_exp_f32 v210, v210
v_mfma_f32_16x16x32_bf16 a[88:91], v[232:235], v[168:171], a[88:91]
ds_read_b64_tr_b16 v[228:229], v250 offset:53760
v_mfma_f32_16x16x32_bf16 a[88:91], v[236:239], v[184:187], a[88:91]
v_exp_f32 v211, v211
v_mfma_f32_16x16x32_bf16 a[92:95], v[232:235], v[172:175], a[92:95]
ds_read_b64_tr_b16 v[230:231], v250 offset:55808
v_cvt_pk_bf16_f32 v131, v210, v211
v_mfma_f32_16x16x32_bf16 a[92:95], v[236:239], v[188:191], a[92:95]
s_waitcnt lgkmcnt(4)
v_mfma_f32_16x16x32_bf16 a[96:99], v[240:243], v[160:163], a[96:99]
ds_read_b128 v[232:235], v248 offset:16384
v_mfma_f32_16x16x32_bf16 a[96:99], v[244:247], v[176:179], a[96:99]
buffer_load_dwordx4 v251, s[12:15], s28 offen offset:1024 lds
v_mfma_f32_16x16x32_bf16 a[100:103], v[240:243], v[164:167], a[100:103]
v_exp_f32 v212, v212
v_mfma_f32_16x16x32_bf16 a[100:103], v[244:247], v[180:183], a[100:103]
v_exp_f32 v213, v213
v_mfma_f32_16x16x32_bf16 a[104:107], v[240:243], v[168:171], a[104:107]
ds_read_b128 v[236:239], v248 offset:16896
v_cvt_pk_bf16_f32 v134, v212, v213
v_mfma_f32_16x16x32_bf16 a[104:107], v[244:247], v[184:187], a[104:107]
v_exp_f32 v214, v214
v_mfma_f32_16x16x32_bf16 a[108:111], v[240:243], v[172:175], a[108:111]
v_exp_f32 v215, v215
v_mfma_f32_16x16x32_bf16 a[108:111], v[244:247], v[188:191], a[108:111]
s_waitcnt lgkmcnt(2)
v_cvt_pk_bf16_f32 v135, v214, v215
v_mfma_f32_16x16x32_bf16 a[112:115], v[224:227], v[160:163], a[112:115]
ds_read_b128 v[240:243], v248 offset:20480
v_mfma_f32_16x16x32_bf16 a[112:115], v[228:231], v[176:179], a[112:115]
buffer_load_dwordx4 v251, s[12:15], s28 offen offset:2048 lds
v_mfma_f32_16x16x32_bf16 a[116:119], v[224:227], v[164:167], a[116:119]
v_exp_f32 v216, v216
v_mfma_f32_16x16x32_bf16 a[116:119], v[228:231], v[180:183], a[116:119]
v_exp_f32 v217, v217
v_mfma_f32_16x16x32_bf16 a[120:123], v[224:227], v[168:171], a[120:123]
ds_read_b128 v[244:247], v248 offset:20992
v_cvt_pk_bf16_f32 v138, v216, v217
v_mfma_f32_16x16x32_bf16 a[120:123], v[228:231], v[184:187], a[120:123]
v_exp_f32 v218, v218
v_mfma_f32_16x16x32_bf16 a[124:127], v[224:227], v[172:175], a[124:127]
v_exp_f32 v219, v219
v_mfma_f32_16x16x32_bf16 a[124:127], v[228:231], v[188:191], a[124:127]
s_waitcnt lgkmcnt(2)
v_cvt_pk_bf16_f32 v139, v218, v219
v_mfma_f32_16x16x32_bf16 v[192:195], v[232:235], v[0:3], 0
ds_read_b128 v[224:227], v248 offset:24576
v_mfma_f32_16x16x32_bf16 v[192:195], v[236:239], v[4:7], v[192:195]
buffer_load_dwordx4 v251, s[12:15], s28 offen offset:3072 lds
v_mfma_f32_16x16x32_bf16 v[196:199], v[232:235], v[32:35], 0
s_xor_b32 s30, s30, 0x10000
v_mfma_f32_16x16x32_bf16 v[196:199], v[236:239], v[36:39], v[196:199]
s_add_u32 s28, s28, 0x4000
v_mfma_f32_16x16x32_bf16 v[200:203], v[232:235], v[64:67], 0
ds_read_b128 v[228:231], v248 offset:25088
v_mfma_f32_16x16x32_bf16 v[200:203], v[236:239], v[68:71], v[200:203]
v_exp_f32 v220, v220
v_mfma_f32_16x16x32_bf16 v[204:207], v[232:235], v[96:99], 0
v_exp_f32 v221, v221
v_mfma_f32_16x16x32_bf16 v[204:207], v[236:239], v[100:103], v[204:207]
s_waitcnt lgkmcnt(2)
s_add_u32 m0, s30, 0x0
v_mfma_f32_16x16x32_bf16 v[192:195], v[240:243], v[8:11], v[192:195]
ds_read_b128 v[232:235], v248 offset:28672
v_cvt_pk_bf16_f32 v142, v220, v221
v_mfma_f32_16x16x32_bf16 v[192:195], v[244:247], v[12:15], v[192:195]
buffer_load_dwordx4 v251, s[12:15], s28 offen offset:0 lds
v_mfma_f32_16x16x32_bf16 v[196:199], v[240:243], v[40:43], v[196:199]
v_exp_f32 v222, v222
v_mfma_f32_16x16x32_bf16 v[196:199], v[244:247], v[44:47], v[196:199]
v_exp_f32 v223, v223
v_mfma_f32_16x16x32_bf16 v[200:203], v[240:243], v[72:75], v[200:203]
ds_read_b128 v[236:239], v248 offset:29184
v_cvt_pk_bf16_f32 v143, v222, v223
v_mfma_f32_16x16x32_bf16 v[200:203], v[244:247], v[76:79], v[200:203]
v_mfma_f32_16x16x32_bf16 v[204:207], v[240:243], v[104:107], v[204:207]
v_mfma_f32_16x16x32_bf16 v[204:207], v[244:247], v[108:111], v[204:207]
s_waitcnt lgkmcnt(2)
v_mfma_f32_16x16x32_bf16 v[192:195], v[224:227], v[16:19], v[192:195]
ds_read_b64_tr_b16 v[240:241], v249 offset:40960
v_mfma_f32_16x16x32_bf16 v[192:195], v[228:231], v[20:23], v[192:195]
buffer_load_dwordx4 v251, s[12:15], s28 offen offset:1024 lds
v_mfma_f32_16x16x32_bf16 v[196:199], v[224:227], v[48:51], v[196:199]
ds_read_b64_tr_b16 v[242:243], v249 offset:43008
v_mfma_f32_16x16x32_bf16 v[196:199], v[228:231], v[52:55], v[196:199]
v_mfma_f32_16x16x32_bf16 v[200:203], v[224:227], v[80:83], v[200:203]
ds_read_b64_tr_b16 v[244:245], v249 offset:57344
v_mfma_f32_16x16x32_bf16 v[200:203], v[228:231], v[84:87], v[200:203]
v_mfma_f32_16x16x32_bf16 v[204:207], v[224:227], v[112:115], v[204:207]
ds_read_b64_tr_b16 v[246:247], v249 offset:59392
v_mfma_f32_16x16x32_bf16 v[204:207], v[228:231], v[116:119], v[204:207]
s_waitcnt lgkmcnt(4)
v_mfma_f32_16x16x32_bf16 v[192:195], v[232:235], v[24:27], v[192:195]
ds_read_b64_tr_b16 v[224:225], v250 offset:40960
v_mfma_f32_16x16x32_bf16 v[192:195], v[236:239], v[28:31], v[192:195]
buffer_load_dwordx4 v251, s[12:15], s28 offen offset:2048 lds
v_mfma_f32_16x16x32_bf16 v[196:199], v[232:235], v[56:59], v[196:199]
ds_read_b64_tr_b16 v[226:227], v250 offset:43008
v_mfma_f32_16x16x32_bf16 v[196:199], v[236:239], v[60:63], v[196:199]
v_mfma_f32_16x16x32_bf16 v[200:203], v[232:235], v[88:91], v[200:203]
ds_read_b64_tr_b16 v[228:229], v250 offset:57344
v_mfma_f32_16x16x32_bf16 v[200:203], v[236:239], v[92:95], v[200:203]
v_mfma_f32_16x16x32_bf16 v[204:207], v[232:235], v[120:123], v[204:207]
ds_read_b64_tr_b16 v[230:231], v250 offset:59392
v_mfma_f32_16x16x32_bf16 v[204:207], v[236:239], v[124:127], v[204:207]
s_waitcnt lgkmcnt(4)
v_mfma_f32_16x16x32_bf16 a[128:131], v[240:243], v[160:163], a[128:131]
ds_read_b64_tr_b16 v[232:233], v249 offset:41472
v_mfma_f32_16x16x32_bf16 a[128:131], v[244:247], v[176:179], a[128:131]
buffer_load_dwordx4 v251, s[12:15], s28 offen offset:3072 lds
v_mfma_f32_16x16x32_bf16 a[132:135], v[240:243], v[164:167], a[132:135]
ds_read_b64_tr_b16 v[234:235], v249 offset:43520
v_mfma_f32_16x16x32_bf16 a[132:135], v[244:247], v[180:183], a[132:135]
s_add_u32 s28, s28, 0x4000
v_mfma_f32_16x16x32_bf16 a[136:139], v[240:243], v[168:171], a[136:139]
ds_read_b64_tr_b16 v[236:237], v249 offset:57856
v_mfma_f32_16x16x32_bf16 a[136:139], v[244:247], v[184:187], a[136:139]
v_exp_f32 v192, v192
v_mfma_f32_16x16x32_bf16 a[140:143], v[240:243], v[172:175], a[140:143]
ds_read_b64_tr_b16 v[238:239], v249 offset:59904
v_mfma_f32_16x16x32_bf16 a[140:143], v[244:247], v[188:191], a[140:143]
s_waitcnt lgkmcnt(4)
v_mfma_f32_16x16x32_bf16 a[144:147], v[224:227], v[160:163], a[144:147]
ds_read_b64_tr_b16 v[240:241], v250 offset:41472
v_mfma_f32_16x16x32_bf16 a[144:147], v[228:231], v[176:179], a[144:147]
v_exp_f32 v193, v193
v_mfma_f32_16x16x32_bf16 a[148:151], v[224:227], v[164:167], a[148:151]
ds_read_b64_tr_b16 v[242:243], v250 offset:43520
v_cvt_pk_bf16_f32 v144, v192, v193
v_mfma_f32_16x16x32_bf16 a[148:151], v[228:231], v[180:183], a[148:151]
v_exp_f32 v194, v194
v_mfma_f32_16x16x32_bf16 a[152:155], v[224:227], v[168:171], a[152:155]
ds_read_b64_tr_b16 v[244:245], v250 offset:57856
v_mfma_f32_16x16x32_bf16 a[152:155], v[228:231], v[184:187], a[152:155]
v_exp_f32 v195, v195
v_mfma_f32_16x16x32_bf16 a[156:159], v[224:227], v[172:175], a[156:159]
ds_read_b64_tr_b16 v[246:247], v250 offset:59904
v_cvt_pk_bf16_f32 v145, v194, v195
v_mfma_f32_16x16x32_bf16 a[156:159], v[228:231], v[188:191], a[156:159]
s_waitcnt lgkmcnt(4)
v_mfma_f32_16x16x32_bf16 a[160:163], v[232:235], v[160:163], a[160:163]
ds_read_b128 v[224:227], v248 offset:18432
v_mfma_f32_16x16x32_bf16 a[160:163], v[236:239], v[176:179], a[160:163]
v_exp_f32 v196, v196
v_mfma_f32_16x16x32_bf16 a[164:167], v[232:235], v[164:167], a[164:167]
v_exp_f32 v197, v197
v_mfma_f32_16x16x32_bf16 a[164:167], v[236:239], v[180:183], a[164:167]
v_exp_f32 v198, v198
v_mfma_f32_16x16x32_bf16 a[168:171], v[232:235], v[168:171], a[168:171]
ds_read_b128 v[228:231], v248 offset:18944
v_cvt_pk_bf16_f32 v148, v196, v197
v_mfma_f32_16x16x32_bf16 a[168:171], v[236:239], v[184:187], a[168:171]
v_exp_f32 v199, v199
v_mfma_f32_16x16x32_bf16 a[172:175], v[232:235], v[172:175], a[172:175]
v_exp_f32 v200, v200
v_mfma_f32_16x16x32_bf16 a[172:175], v[236:239], v[188:191], a[172:175]
s_waitcnt lgkmcnt(2)
v_cvt_pk_bf16_f32 v149, v198, v199
v_mfma_f32_16x16x32_bf16 a[176:179], v[240:243], v[160:163], a[176:179]
ds_read_b128 v[232:235], v248 offset:22528
v_mfma_f32_16x16x32_bf16 a[176:179], v[244:247], v[176:179], a[176:179]
v_exp_f32 v201, v201
v_mfma_f32_16x16x32_bf16 a[180:183], v[240:243], v[164:167], a[180:183]
v_exp_f32 v202, v202
v_mfma_f32_16x16x32_bf16 a[180:183], v[244:247], v[180:183], a[180:183]
v_exp_f32 v203, v203
v_mfma_f32_16x16x32_bf16 a[184:187], v[240:243], v[168:171], a[184:187]
ds_read_b128 v[236:239], v248 offset:23040
v_cvt_pk_bf16_f32 v152, v200, v201
v_mfma_f32_16x16x32_bf16 a[184:187], v[244:247], v[184:187], a[184:187]
v_cvt_pk_bf16_f32 v153, v202, v203
v_mfma_f32_16x16x32_bf16 a[188:191], v[240:243], v[172:175], a[188:191]
v_exp_f32 v204, v204
v_mfma_f32_16x16x32_bf16 a[188:191], v[244:247], v[188:191], a[188:191]
s_waitcnt lgkmcnt(2)
v_mfma_f32_16x16x32_bf16 v[208:211], v[224:227], v[0:3], 0
ds_read_b128 v[240:243], v248 offset:26624
v_mfma_f32_16x16x32_bf16 v[208:211], v[228:231], v[4:7], v[208:211]
v_exp_f32 v205, v205
v_mfma_f32_16x16x32_bf16 v[212:215], v[224:227], v[32:35], 0
v_exp_f32 v206, v206
v_mfma_f32_16x16x32_bf16 v[212:215], v[228:231], v[36:39], v[212:215]
v_exp_f32 v207, v207
v_mfma_f32_16x16x32_bf16 v[216:219], v[224:227], v[64:67], 0
ds_read_b128 v[244:247], v248 offset:27136
v_cvt_pk_bf16_f32 v156, v204, v205
v_mfma_f32_16x16x32_bf16 v[216:219], v[228:231], v[68:71], v[216:219]
v_cvt_pk_bf16_f32 v157, v206, v207
v_mfma_f32_16x16x32_bf16 v[220:223], v[224:227], v[96:99], 0
v_mfma_f32_16x16x32_bf16 v[220:223], v[228:231], v[100:103], v[220:223]
s_waitcnt lgkmcnt(2)
v_mfma_f32_16x16x32_bf16 v[208:211], v[232:235], v[8:11], v[208:211]
ds_read_b128 v[224:227], v248 offset:30720
v_mfma_f32_16x16x32_bf16 v[208:211], v[236:239], v[12:15], v[208:211]
v_mfma_f32_16x16x32_bf16 v[212:215], v[232:235], v[40:43], v[212:215]
v_mfma_f32_16x16x32_bf16 v[212:215], v[236:239], v[44:47], v[212:215]
v_mfma_f32_16x16x32_bf16 v[216:219], v[232:235], v[72:75], v[216:219]
ds_read_b128 v[228:231], v248 offset:31232
v_mfma_f32_16x16x32_bf16 v[216:219], v[236:239], v[76:79], v[216:219]
v_mfma_f32_16x16x32_bf16 v[220:223], v[232:235], v[104:107], v[220:223]
v_mfma_f32_16x16x32_bf16 v[220:223], v[236:239], v[108:111], v[220:223]
s_waitcnt lgkmcnt(2)
v_mfma_f32_16x16x32_bf16 v[208:211], v[240:243], v[16:19], v[208:211]
ds_read_b64_tr_b16 v[232:233], v249 offset:45056
v_mfma_f32_16x16x32_bf16 v[208:211], v[244:247], v[20:23], v[208:211]
v_mfma_f32_16x16x32_bf16 v[212:215], v[240:243], v[48:51], v[212:215]
ds_read_b64_tr_b16 v[234:235], v249 offset:47104
v_mfma_f32_16x16x32_bf16 v[212:215], v[244:247], v[52:55], v[212:215]
v_mfma_f32_16x16x32_bf16 v[216:219], v[240:243], v[80:83], v[216:219]
ds_read_b64_tr_b16 v[236:237], v249 offset:61440
v_mfma_f32_16x16x32_bf16 v[216:219], v[244:247], v[84:87], v[216:219]
v_mfma_f32_16x16x32_bf16 v[220:223], v[240:243], v[112:115], v[220:223]
ds_read_b64_tr_b16 v[238:239], v249 offset:63488
v_mfma_f32_16x16x32_bf16 v[220:223], v[244:247], v[116:119], v[220:223]
s_waitcnt lgkmcnt(4)
v_mfma_f32_16x16x32_bf16 v[208:211], v[224:227], v[24:27], v[208:211]
ds_read_b64_tr_b16 v[240:241], v250 offset:45056
v_mfma_f32_16x16x32_bf16 v[208:211], v[228:231], v[28:31], v[208:211]
v_mfma_f32_16x16x32_bf16 v[212:215], v[224:227], v[56:59], v[212:215]
ds_read_b64_tr_b16 v[242:243], v250 offset:47104
v_mfma_f32_16x16x32_bf16 v[212:215], v[228:231], v[60:63], v[212:215]
v_mfma_f32_16x16x32_bf16 v[216:219], v[224:227], v[88:91], v[216:219]
ds_read_b64_tr_b16 v[244:245], v250 offset:61440
v_mfma_f32_16x16x32_bf16 v[216:219], v[228:231], v[92:95], v[216:219]
v_mfma_f32_16x16x32_bf16 v[220:223], v[224:227], v[120:123], v[220:223]
ds_read_b64_tr_b16 v[246:247], v250 offset:63488
v_mfma_f32_16x16x32_bf16 v[220:223], v[228:231], v[124:127], v[220:223]
s_waitcnt lgkmcnt(4)
v_mfma_f32_16x16x32_bf16 a[192:195], v[232:235], v[160:163], a[192:195]
ds_read_b64_tr_b16 v[224:225], v249 offset:45568
v_mfma_f32_16x16x32_bf16 a[192:195], v[236:239], v[176:179], a[192:195]
v_mfma_f32_16x16x32_bf16 a[196:199], v[232:235], v[164:167], a[196:199]
ds_read_b64_tr_b16 v[226:227], v249 offset:47616
v_mfma_f32_16x16x32_bf16 a[196:199], v[236:239], v[180:183], a[196:199]
v_exp_f32 v208, v208
v_mfma_f32_16x16x32_bf16 a[200:203], v[232:235], v[168:171], a[200:203]
ds_read_b64_tr_b16 v[228:229], v249 offset:61952
v_mfma_f32_16x16x32_bf16 a[200:203], v[236:239], v[184:187], a[200:203]
v_exp_f32 v209, v209
v_mfma_f32_16x16x32_bf16 a[204:207], v[232:235], v[172:175], a[204:207]
ds_read_b64_tr_b16 v[230:231], v249 offset:64000
v_cvt_pk_bf16_f32 v146, v208, v209
v_mfma_f32_16x16x32_bf16 a[204:207], v[236:239], v[188:191], a[204:207]
s_waitcnt lgkmcnt(4)
v_mfma_f32_16x16x32_bf16 a[208:211], v[240:243], v[160:163], a[208:211]
ds_read_b64_tr_b16 v[232:233], v250 offset:45568
v_mfma_f32_16x16x32_bf16 a[208:211], v[244:247], v[176:179], a[208:211]
v_exp_f32 v210, v210
v_mfma_f32_16x16x32_bf16 a[212:215], v[240:243], v[164:167], a[212:215]
ds_read_b64_tr_b16 v[234:235], v250 offset:47616
v_mfma_f32_16x16x32_bf16 a[212:215], v[244:247], v[180:183], a[212:215]
v_exp_f32 v211, v211
v_mfma_f32_16x16x32_bf16 a[216:219], v[240:243], v[168:171], a[216:219]
ds_read_b64_tr_b16 v[236:237], v250 offset:61952
v_cvt_pk_bf16_f32 v147, v210, v211
v_mfma_f32_16x16x32_bf16 a[216:219], v[244:247], v[184:187], a[216:219]
v_exp_f32 v212, v212
v_mfma_f32_16x16x32_bf16 a[220:223], v[240:243], v[172:175], a[220:223]
ds_read_b64_tr_b16 v[238:239], v250 offset:64000
v_mfma_f32_16x16x32_bf16 a[220:223], v[244:247], v[188:191], a[220:223]
s_waitcnt lgkmcnt(4)
v_mfma_f32_16x16x32_bf16 a[224:227], v[224:227], v[160:163], a[224:227]
ds_read_b128 v[240:243], v248 offset:32768
v_mfma_f32_16x16x32_bf16 a[224:227], v[228:231], v[176:179], a[224:227]
v_exp_f32 v213, v213
v_mfma_f32_16x16x32_bf16 a[228:231], v[224:227], v[164:167], a[228:231]
v_exp_f32 v214, v214
v_mfma_f32_16x16x32_bf16 a[228:231], v[228:231], v[180:183], a[228:231]
v_exp_f32 v215, v215
v_mfma_f32_16x16x32_bf16 a[232:235], v[224:227], v[168:171], a[232:235]
ds_read_b128 v[244:247], v248 offset:33280
v_cvt_pk_bf16_f32 v150, v212, v213
v_mfma_f32_16x16x32_bf16 a[232:235], v[228:231], v[184:187], a[232:235]
v_cvt_pk_bf16_f32 v151, v214, v215
v_mfma_f32_16x16x32_bf16 a[236:239], v[224:227], v[172:175], a[236:239]
v_exp_f32 v216, v216
v_mfma_f32_16x16x32_bf16 a[236:239], v[228:231], v[188:191], a[236:239]
s_waitcnt lgkmcnt(2)
v_mfma_f32_16x16x32_bf16 a[240:243], v[232:235], v[160:163], a[240:243]
ds_read_b128 v[224:227], v248 offset:36864
v_mfma_f32_16x16x32_bf16 a[240:243], v[236:239], v[176:179], a[240:243]
v_exp_f32 v217, v217
v_mfma_f32_16x16x32_bf16 a[244:247], v[232:235], v[164:167], a[244:247]
v_exp_f32 v218, v218
v_mfma_f32_16x16x32_bf16 a[244:247], v[236:239], v[180:183], a[244:247]
v_exp_f32 v219, v219
v_mfma_f32_16x16x32_bf16 a[248:251], v[232:235], v[168:171], a[248:251]
ds_read_b128 v[228:231], v248 offset:37376
v_cvt_pk_bf16_f32 v154, v216, v217
v_mfma_f32_16x16x32_bf16 a[248:251], v[236:239], v[184:187], a[248:251]
v_cvt_pk_bf16_f32 v155, v218, v219
v_mfma_f32_16x16x32_bf16 a[252:255], v[232:235], v[172:175], a[252:255]
v_exp_f32 v220, v220
v_mfma_f32_16x16x32_bf16 a[252:255], v[236:239], v[188:191], a[252:255]
s_waitcnt lgkmcnt(2)
v_mfma_f32_16x16x32_bf16 v[192:195], v[240:243], v[0:3], 0
ds_read_b128 v[232:235], v248 offset:40960
v_mfma_f32_16x16x32_bf16 v[192:195], v[244:247], v[4:7], v[192:195]
v_xor_b32 v249, 0x10000, v249
v_mfma_f32_16x16x32_bf16 v[196:199], v[240:243], v[32:35], 0
v_exp_f32 v221, v221
v_mfma_f32_16x16x32_bf16 v[196:199], v[244:247], v[36:39], v[196:199]
v_xor_b32 v250, 0x10000, v250
v_cvt_pk_bf16_f32 v158, v220, v221
v_mfma_f32_16x16x32_bf16 v[200:203], v[240:243], v[64:67], 0
ds_read_b128 v[236:239], v248 offset:41472
v_mfma_f32_16x16x32_bf16 v[200:203], v[244:247], v[68:71], v[200:203]
v_exp_f32 v222, v222
v_mfma_f32_16x16x32_bf16 v[204:207], v[240:243], v[96:99], 0
v_exp_f32 v223, v223
v_mfma_f32_16x16x32_bf16 v[204:207], v[244:247], v[100:103], v[204:207]
s_waitcnt lgkmcnt(2)
v_cvt_pk_bf16_f32 v159, v222, v223
v_mfma_f32_16x16x32_bf16 v[192:195], v[224:227], v[8:11], v[192:195]
ds_read_b128 v[240:243], v248 offset:45056
v_mfma_f32_16x16x32_bf16 v[192:195], v[228:231], v[12:15], v[192:195]
v_mfma_f32_16x16x32_bf16 v[196:199], v[224:227], v[40:43], v[196:199]
v_mfma_f32_16x16x32_bf16 v[196:199], v[228:231], v[44:47], v[196:199]
v_mfma_f32_16x16x32_bf16 v[200:203], v[224:227], v[72:75], v[200:203]
ds_read_b128 v[244:247], v248 offset:45568
v_mfma_f32_16x16x32_bf16 v[200:203], v[228:231], v[76:79], v[200:203]
v_mfma_f32_16x16x32_bf16 v[204:207], v[224:227], v[104:107], v[204:207]
v_mfma_f32_16x16x32_bf16 v[204:207], v[228:231], v[108:111], v[204:207]
s_waitcnt lgkmcnt(2)
v_mfma_f32_16x16x32_bf16 v[192:195], v[232:235], v[16:19], v[192:195]
ds_read_b64_tr_b16 v[224:225], v249 offset:0
v_mfma_f32_16x16x32_bf16 v[192:195], v[236:239], v[20:23], v[192:195]
v_mfma_f32_16x16x32_bf16 v[196:199], v[232:235], v[48:51], v[196:199]
ds_read_b64_tr_b16 v[226:227], v249 offset:2048
v_mfma_f32_16x16x32_bf16 v[196:199], v[236:239], v[52:55], v[196:199]
v_mfma_f32_16x16x32_bf16 v[200:203], v[232:235], v[80:83], v[200:203]
ds_read_b64_tr_b16 v[228:229], v249 offset:16384
v_mfma_f32_16x16x32_bf16 v[200:203], v[236:239], v[84:87], v[200:203]
v_mfma_f32_16x16x32_bf16 v[204:207], v[232:235], v[112:115], v[204:207]
ds_read_b64_tr_b16 v[230:231], v249 offset:18432
v_mfma_f32_16x16x32_bf16 v[204:207], v[236:239], v[116:119], v[204:207]
s_waitcnt lgkmcnt(4)
v_mfma_f32_16x16x32_bf16 v[192:195], v[240:243], v[24:27], v[192:195]
ds_read_b64_tr_b16 v[232:233], v250 offset:0
v_mfma_f32_16x16x32_bf16 v[192:195], v[244:247], v[28:31], v[192:195]
v_mfma_f32_16x16x32_bf16 v[196:199], v[240:243], v[56:59], v[196:199]
ds_read_b64_tr_b16 v[234:235], v250 offset:2048
v_mfma_f32_16x16x32_bf16 v[196:199], v[244:247], v[60:63], v[196:199]
v_mfma_f32_16x16x32_bf16 v[200:203], v[240:243], v[88:91], v[200:203]
ds_read_b64_tr_b16 v[236:237], v250 offset:16384
v_mfma_f32_16x16x32_bf16 v[200:203], v[244:247], v[92:95], v[200:203]
s_sub_u32 s31, s31, 1
v_mfma_f32_16x16x32_bf16 v[204:207], v[240:243], v[120:123], v[204:207]
ds_read_b64_tr_b16 v[238:239], v250 offset:18432
v_mfma_f32_16x16x32_bf16 v[204:207], v[244:247], v[124:127], v[204:207]
s_cbranch_scc0 L2_loop
L2_tails:
L2_tail_1:
s_cmp_eq_u32 s59, 7
s_cbranch_scc1 L2_tail_1_7
L2_tail_1_6:
s_waitcnt lgkmcnt(4)
v_mfma_f32_16x16x32_bf16 a[0:3], v[224:227], v[160:163], a[0:3]
ds_read_b128 v[240:243], v248 offset:2048
v_mfma_f32_16x16x32_bf16 a[0:3], v[228:231], v[176:179], a[0:3]
s_lshl_b32 s36, s34, 13
v_mfma_f32_16x16x32_bf16 a[4:7], v[224:227], v[164:167], a[4:7]
s_add_u32 s56, s4, 0x1000000
s_addc_u32 s57, s5, 0
v_mfma_f32_16x16x32_bf16 a[4:7], v[228:231], v[180:183], a[4:7]
s_add_u32 s36, s36, 0x20000
s_mov_b32 s58, 0x6c02000
v_mfma_f32_16x16x32_bf16 a[8:11], v[224:227], v[168:171], a[8:11]
ds_read_b128 v[244:247], v248 offset:2560
s_mov_b32 s59, 0x00020000
v_mfma_f32_16x16x32_bf16 a[8:11], v[228:231], v[184:187], a[8:11]
v_add_u32 v255, s36, v252
s_lshr_b32 s35, s2, 1
v_mfma_f32_16x16x32_bf16 a[12:15], v[224:227], v[172:175], a[12:15]
s_and_b32 s35, s35, 28
s_add_u32 s35, s35, s34
v_mfma_f32_16x16x32_bf16 a[12:15], v[228:231], v[188:191], a[12:15]
s_waitcnt lgkmcnt(2)
s_lshl_b32 s35, s35, 13
v_mfma_f32_16x16x32_bf16 a[16:19], v[232:235], v[160:163], a[16:19]
ds_read_b128 v[224:227], v248 offset:6144
v_lshlrev_b32 v253, 3, v252
v_mfma_f32_16x16x32_bf16 a[16:19], v[236:239], v[176:179], a[16:19]
buffer_load_dword v253, v253, s[56:59], s35 offen
ds_write_b128 v255, v[160:163] offset:0
v_mfma_f32_16x16x32_bf16 a[20:23], v[232:235], v[164:167], a[20:23]
v_exp_f32 v192, v192
v_mfma_f32_16x16x32_bf16 a[20:23], v[236:239], v[180:183], a[20:23]
v_exp_f32 v193, v193
v_mfma_f32_16x16x32_bf16 a[24:27], v[232:235], v[168:171], a[24:27]
ds_read_b128 v[228:231], v248 offset:6656
v_cvt_pk_bf16_f32 v128, v192, v193
v_mfma_f32_16x16x32_bf16 a[24:27], v[236:239], v[184:187], a[24:27]
v_exp_f32 v194, v194
v_mfma_f32_16x16x32_bf16 a[28:31], v[232:235], v[172:175], a[28:31]
v_exp_f32 v195, v195
v_mfma_f32_16x16x32_bf16 a[28:31], v[236:239], v[188:191], a[28:31]
s_waitcnt lgkmcnt(3)
v_cvt_pk_bf16_f32 v129, v194, v195
v_mfma_f32_16x16x32_bf16 v[208:211], v[240:243], v[0:3], 0
ds_read_b128 v[232:235], v248 offset:10240
ds_write_b128 v255, v[164:167] offset:1024
v_mfma_f32_16x16x32_bf16 v[208:211], v[244:247], v[4:7], v[208:211]
v_exp_f32 v196, v196
v_mfma_f32_16x16x32_bf16 v[212:215], v[240:243], v[32:35], 0
v_exp_f32 v197, v197
v_mfma_f32_16x16x32_bf16 v[212:215], v[244:247], v[36:39], v[212:215]
v_exp_f32 v198, v198
v_mfma_f32_16x16x32_bf16 v[216:219], v[240:243], v[64:67], 0
ds_read_b128 v[236:239], v248 offset:10752
v_cvt_pk_bf16_f32 v132, v196, v197
v_mfma_f32_16x16x32_bf16 v[216:219], v[244:247], v[68:71], v[216:219]
v_exp_f32 v199, v199
v_mfma_f32_16x16x32_bf16 v[220:223], v[240:243], v[96:99], 0
v_exp_f32 v200, v200
v_mfma_f32_16x16x32_bf16 v[220:223], v[244:247], v[100:103], v[220:223]
s_waitcnt lgkmcnt(3)
v_cvt_pk_bf16_f32 v133, v198, v199
v_mfma_f32_16x16x32_bf16 v[208:211], v[224:227], v[8:11], v[208:211]
ds_read_b128 v[240:243], v248 offset:14336
ds_write_b128 v255, v[168:171] offset:2048
v_mfma_f32_16x16x32_bf16 v[208:211], v[228:231], v[12:15], v[208:211]
v_exp_f32 v201, v201
v_mfma_f32_16x16x32_bf16 v[212:215], v[224:227], v[40:43], v[212:215]
v_exp_f32 v202, v202
v_mfma_f32_16x16x32_bf16 v[212:215], v[228:231], v[44:47], v[212:215]
v_exp_f32 v203, v203
v_mfma_f32_16x16x32_bf16 v[216:219], v[224:227], v[72:75], v[216:219]
ds_read_b128 v[244:247], v248 offset:14848
v_cvt_pk_bf16_f32 v136, v200, v201
v_mfma_f32_16x16x32_bf16 v[216:219], v[228:231], v[76:79], v[216:219]
v_cvt_pk_bf16_f32 v137, v202, v203
ds_write_b128 v255, v[172:175] offset:3072
v_mfma_f32_16x16x32_bf16 v[220:223], v[224:227], v[104:107], v[220:223]
v_exp_f32 v204, v204
v_mfma_f32_16x16x32_bf16 v[220:223], v[228:231], v[108:111], v[220:223]
s_waitcnt lgkmcnt(4)
s_waitcnt vmcnt(1)
s_barrier
v_mfma_f32_16x16x32_bf16 v[208:211], v[232:235], v[16:19], v[208:211]
ds_read_b128 v[224:227], v248 offset:16384
s_add_u32 m0, s30, 0xc000
v_mfma_f32_16x16x32_bf16 v[208:211], v[236:239], v[20:23], v[208:211]
s_and_b32 s100, s30, 0x10000
buffer_load_dwordx4 v251, s[12:15], s28 offen offset:0 lds
v_mfma_f32_16x16x32_bf16 v[212:215], v[232:235], v[48:51], v[212:215]
s_xor_b32 s100, s100, 0x10000
v_mfma_f32_16x16x32_bf16 v[212:215], v[236:239], v[52:55], v[212:215]
v_exp_f32 v205, v205
v_mfma_f32_16x16x32_bf16 v[216:219], v[232:235], v[80:83], v[216:219]
ds_read_b128 v[228:231], v248 offset:16896
v_cvt_pk_bf16_f32 v140, v204, v205
v_mfma_f32_16x16x32_bf16 v[216:219], v[236:239], v[84:87], v[216:219]
v_exp_f32 v206, v206
v_mfma_f32_16x16x32_bf16 v[220:223], v[232:235], v[112:115], v[220:223]
v_exp_f32 v207, v207
v_mfma_f32_16x16x32_bf16 v[220:223], v[236:239], v[116:119], v[220:223]
s_waitcnt lgkmcnt(3)
v_cvt_pk_bf16_f32 v141, v206, v207
v_mfma_f32_16x16x32_bf16 v[208:211], v[240:243], v[24:27], v[208:211]
ds_read_b128 v[232:235], v248 offset:20480
buffer_load_dwordx4 v251, s[12:15], s28 offen offset:1024 lds
v_mfma_f32_16x16x32_bf16 v[208:211], v[244:247], v[28:31], v[208:211]
v_mfma_f32_16x16x32_bf16 v[212:215], v[240:243], v[56:59], v[212:215]
buffer_load_dwordx4 v251, s[12:15], s28 offen offset:2048 lds
v_mfma_f32_16x16x32_bf16 v[212:215], v[244:247], v[60:63], v[212:215]
v_mfma_f32_16x16x32_bf16 v[216:219], v[240:243], v[88:91], v[216:219]
ds_read_b128 v[236:239], v248 offset:20992
buffer_load_dwordx4 v251, s[12:15], s28 offen offset:3072 lds
v_mfma_f32_16x16x32_bf16 v[216:219], v[244:247], v[92:95], v[216:219]
v_mfma_f32_16x16x32_bf16 v[220:223], v[240:243], v[120:123], v[220:223]
s_add_u32 s28, s28, 0x4000
v_mfma_f32_16x16x32_bf16 v[220:223], v[244:247], v[124:127], v[220:223]
s_waitcnt lgkmcnt(2)
v_mfma_f32_16x16x32_bf16 v[192:195], v[224:227], v[0:3], 0
ds_read_b128 v[240:243], v248 offset:24576
v_mfma_f32_16x16x32_bf16 v[192:195], v[228:231], v[4:7], v[192:195]
v_exp_f32 v208, v208
v_mfma_f32_16x16x32_bf16 v[196:199], v[224:227], v[32:35], 0
v_exp_f32 v209, v209
v_mfma_f32_16x16x32_bf16 v[196:199], v[228:231], v[36:39], v[196:199]
v_exp_f32 v210, v210
v_mfma_f32_16x16x32_bf16 v[200:203], v[224:227], v[64:67], 0
ds_read_b128 v[244:247], v248 offset:25088
v_cvt_pk_bf16_f32 v130, v208, v209
v_mfma_f32_16x16x32_bf16 v[200:203], v[228:231], v[68:71], v[200:203]
v_exp_f32 v211, v211
v_mfma_f32_16x16x32_bf16 v[204:207], v[224:227], v[96:99], 0
v_exp_f32 v212, v212
v_mfma_f32_16x16x32_bf16 v[204:207], v[228:231], v[100:103], v[204:207]
s_waitcnt lgkmcnt(2)
v_cvt_pk_bf16_f32 v131, v210, v211
v_mfma_f32_16x16x32_bf16 v[192:195], v[232:235], v[8:11], v[192:195]
ds_read_b128 v[224:227], v248 offset:28672
v_mfma_f32_16x16x32_bf16 v[192:195], v[236:239], v[12:15], v[192:195]
v_exp_f32 v213, v213
v_mfma_f32_16x16x32_bf16 v[196:199], v[232:235], v[40:43], v[196:199]
v_exp_f32 v214, v214
v_mfma_f32_16x16x32_bf16 v[196:199], v[236:239], v[44:47], v[196:199]
v_exp_f32 v215, v215
v_mfma_f32_16x16x32_bf16 v[200:203], v[232:235], v[72:75], v[200:203]
ds_read_b128 v[228:231], v248 offset:29184
v_cvt_pk_bf16_f32 v134, v212, v213
v_mfma_f32_16x16x32_bf16 v[200:203], v[236:239], v[76:79], v[200:203]
v_cvt_pk_bf16_f32 v135, v214, v215
v_mfma_f32_16x16x32_bf16 v[204:207], v[232:235], v[104:107], v[204:207]
v_exp_f32 v216, v216
v_mfma_f32_16x16x32_bf16 v[204:207], v[236:239], v[108:111], v[204:207]
s_waitcnt lgkmcnt(2)
v_mfma_f32_16x16x32_bf16 v[192:195], v[240:243], v[16:19], v[192:195]
ds_read_b128 v[232:235], v248 offset:18432
v_mfma_f32_16x16x32_bf16 v[192:195], v[244:247], v[20:23], v[192:195]
v_exp_f32 v217, v217
v_mfma_f32_16x16x32_bf16 v[196:199], v[240:243], v[48:51], v[196:199]
v_exp_f32 v218, v218
v_mfma_f32_16x16x32_bf16 v[196:199], v[244:247], v[52:55], v[196:199]
v_exp_f32 v219, v219
v_mfma_f32_16x16x32_bf16 v[200:203], v[240:243], v[80:83], v[200:203]
ds_read_b128 v[236:239], v248 offset:18944
v_cvt_pk_bf16_f32 v138, v216, v217
v_mfma_f32_16x16x32_bf16 v[200:203], v[244:247], v[84:87], v[200:203]
v_cvt_pk_bf16_f32 v139, v218, v219
v_mfma_f32_16x16x32_bf16 v[204:207], v[240:243], v[112:115], v[204:207]
v_exp_f32 v220, v220
v_mfma_f32_16x16x32_bf16 v[204:207], v[244:247], v[116:119], v[204:207]
s_waitcnt lgkmcnt(2)
v_mfma_f32_16x16x32_bf16 v[192:195], v[224:227], v[24:27], v[192:195]
ds_read_b128 v[240:243], v248 offset:22528
v_mfma_f32_16x16x32_bf16 v[192:195], v[228:231], v[28:31], v[192:195]
v_exp_f32 v221, v221
v_mfma_f32_16x16x32_bf16 v[196:199], v[224:227], v[56:59], v[196:199]
v_exp_f32 v222, v222
v_mfma_f32_16x16x32_bf16 v[196:199], v[228:231], v[60:63], v[196:199]
v_exp_f32 v223, v223
v_mfma_f32_16x16x32_bf16 v[200:203], v[224:227], v[88:91], v[200:203]
ds_read_b128 v[244:247], v248 offset:23040
v_cvt_pk_bf16_f32 v142, v220, v221
v_mfma_f32_16x16x32_bf16 v[200:203], v[228:231], v[92:95], v[200:203]
v_cvt_pk_bf16_f32 v143, v222, v223
v_mfma_f32_16x16x32_bf16 v[204:207], v[224:227], v[120:123], v[204:207]
v_mfma_f32_16x16x32_bf16 v[204:207], v[228:231], v[124:127], v[204:207]
s_waitcnt lgkmcnt(2)
v_mfma_f32_16x16x32_bf16 v[208:211], v[232:235], v[0:3], 0
ds_read_b128 v[224:227], v248 offset:26624
v_mfma_f32_16x16x32_bf16 v[208:211], v[236:239], v[4:7], v[208:211]
v_exp_f32 v192, v192
v_mfma_f32_16x16x32_bf16 v[212:215], v[232:235], v[32:35], 0
v_exp_f32 v193, v193
v_mfma_f32_16x16x32_bf16 v[212:215], v[236:239], v[36:39], v[212:215]
v_exp_f32 v194, v194
v_mfma_f32_16x16x32_bf16 v[216:219], v[232:235], v[64:67], 0
ds_read_b128 v[228:231], v248 offset:27136
v_cvt_pk_bf16_f32 v144, v192, v193
v_mfma_f32_16x16x32_bf16 v[216:219], v[236:239], v[68:71], v[216:219]
v_exp_f32 v195, v195
v_mfma_f32_16x16x32_bf16 v[220:223], v[232:235], v[96:99], 0
v_exp_f32 v196, v196
v_mfma_f32_16x16x32_bf16 v[220:223], v[236:239], v[100:103], v[220:223]
s_waitcnt lgkmcnt(2)
v_cvt_pk_bf16_f32 v145, v194, v195
v_mfma_f32_16x16x32_bf16 v[208:211], v[240:243], v[8:11], v[208:211]
ds_read_b128 v[232:235], v248 offset:30720
v_mfma_f32_16x16x32_bf16 v[208:211], v[244:247], v[12:15], v[208:211]
v_exp_f32 v197, v197
v_mfma_f32_16x16x32_bf16 v[212:215], v[240:243], v[40:43], v[212:215]
v_exp_f32 v198, v198
v_mfma_f32_16x16x32_bf16 v[212:215], v[244:247], v[44:47], v[212:215]
v_exp_f32 v199, v199
v_mfma_f32_16x16x32_bf16 v[216:219], v[240:243], v[72:75], v[216:219]
ds_read_b128 v[236:239], v248 offset:31232
v_cvt_pk_bf16_f32 v148, v196, v197
v_mfma_f32_16x16x32_bf16 v[216:219], v[244:247], v[76:79], v[216:219]
v_cvt_pk_bf16_f32 v149, v198, v199
v_mfma_f32_16x16x32_bf16 v[220:223], v[240:243], v[104:107], v[220:223]
v_exp_f32 v200, v200
v_mfma_f32_16x16x32_bf16 v[220:223], v[244:247], v[108:111], v[220:223]
s_waitcnt lgkmcnt(2)
v_mfma_f32_16x16x32_bf16 v[208:211], v[224:227], v[16:19], v[208:211]
ds_read_b128 v[240:243], v248 offset:32768
v_mfma_f32_16x16x32_bf16 v[208:211], v[228:231], v[20:23], v[208:211]
v_exp_f32 v201, v201
v_mfma_f32_16x16x32_bf16 v[212:215], v[224:227], v[48:51], v[212:215]
v_exp_f32 v202, v202
v_mfma_f32_16x16x32_bf16 v[212:215], v[228:231], v[52:55], v[212:215]
v_exp_f32 v203, v203
v_mfma_f32_16x16x32_bf16 v[216:219], v[224:227], v[80:83], v[216:219]
ds_read_b128 v[244:247], v248 offset:33280
v_cvt_pk_bf16_f32 v152, v200, v201
v_mfma_f32_16x16x32_bf16 v[216:219], v[228:231], v[84:87], v[216:219]
v_cvt_pk_bf16_f32 v153, v202, v203
v_mfma_f32_16x16x32_bf16 v[220:223], v[224:227], v[112:115], v[220:223]
v_exp_f32 v204, v204
v_mfma_f32_16x16x32_bf16 v[220:223], v[228:231], v[116:119], v[220:223]
s_waitcnt lgkmcnt(2)
v_mfma_f32_16x16x32_bf16 v[208:211], v[232:235], v[24:27], v[208:211]
ds_read_b128 v[224:227], v248 offset:36864
v_mfma_f32_16x16x32_bf16 v[208:211], v[236:239], v[28:31], v[208:211]
v_exp_f32 v205, v205
v_mfma_f32_16x16x32_bf16 v[212:215], v[232:235], v[56:59], v[212:215]
v_exp_f32 v206, v206
v_mfma_f32_16x16x32_bf16 v[212:215], v[236:239], v[60:63], v[212:215]
v_exp_f32 v207, v207
v_mfma_f32_16x16x32_bf16 v[216:219], v[232:235], v[88:91], v[216:219]
ds_read_b128 v[228:231], v248 offset:37376
v_cvt_pk_bf16_f32 v156, v204, v205
v_mfma_f32_16x16x32_bf16 v[216:219], v[236:239], v[92:95], v[216:219]
v_cvt_pk_bf16_f32 v157, v206, v207
v_mfma_f32_16x16x32_bf16 v[220:223], v[232:235], v[120:123], v[220:223]
v_mfma_f32_16x16x32_bf16 v[220:223], v[236:239], v[124:127], v[220:223]
s_waitcnt lgkmcnt(2)
v_mfma_f32_16x16x32_bf16 v[192:195], v[240:243], v[0:3], 0
ds_read_b128 v[232:235], v248 offset:40960
v_mfma_f32_16x16x32_bf16 v[192:195], v[244:247], v[4:7], v[192:195]
v_exp_f32 v208, v208
v_mfma_f32_16x16x32_bf16 v[196:199], v[240:243], v[32:35], 0
v_exp_f32 v209, v209
v_mfma_f32_16x16x32_bf16 v[196:199], v[244:247], v[36:39], v[196:199]
v_exp_f32 v210, v210
v_mfma_f32_16x16x32_bf16 v[200:203], v[240:243], v[64:67], 0
ds_read_b128 v[236:239], v248 offset:41472
v_cvt_pk_bf16_f32 v146, v208, v209
v_mfma_f32_16x16x32_bf16 v[200:203], v[244:247], v[68:71], v[200:203]
v_exp_f32 v211, v211
v_mfma_f32_16x16x32_bf16 v[204:207], v[240:243], v[96:99], 0
v_exp_f32 v212, v212
v_mfma_f32_16x16x32_bf16 v[204:207], v[244:247], v[100:103], v[204:207]
s_waitcnt lgkmcnt(2)
v_cvt_pk_bf16_f32 v147, v210, v211
v_mfma_f32_16x16x32_bf16 v[192:195], v[224:227], v[8:11], v[192:195]
ds_read_b128 v[240:243], v248 offset:45056
v_mfma_f32_16x16x32_bf16 v[192:195], v[228:231], v[12:15], v[192:195]
v_exp_f32 v213, v213
v_mfma_f32_16x16x32_bf16 v[196:199], v[224:227], v[40:43], v[196:199]
v_exp_f32 v214, v214
v_mfma_f32_16x16x32_bf16 v[196:199], v[228:231], v[44:47], v[196:199]
v_exp_f32 v215, v215
v_mfma_f32_16x16x32_bf16 v[200:203], v[224:227], v[72:75], v[200:203]
ds_read_b128 v[244:247], v248 offset:45568
v_cvt_pk_bf16_f32 v150, v212, v213
v_mfma_f32_16x16x32_bf16 v[200:203], v[228:231], v[76:79], v[200:203]
v_cvt_pk_bf16_f32 v151, v214, v215
v_mfma_f32_16x16x32_bf16 v[204:207], v[224:227], v[104:107], v[204:207]
v_exp_f32 v216, v216
v_mfma_f32_16x16x32_bf16 v[204:207], v[228:231], v[108:111], v[204:207]
s_waitcnt lgkmcnt(2)
v_mfma_f32_16x16x32_bf16 v[192:195], v[232:235], v[16:19], v[192:195]
ds_read_b128 v[224:227], v248 offset:34816
v_mfma_f32_16x16x32_bf16 v[192:195], v[236:239], v[20:23], v[192:195]
v_exp_f32 v217, v217
v_mfma_f32_16x16x32_bf16 v[196:199], v[232:235], v[48:51], v[196:199]
v_exp_f32 v218, v218
v_mfma_f32_16x16x32_bf16 v[196:199], v[236:239], v[52:55], v[196:199]
v_exp_f32 v219, v219
v_mfma_f32_16x16x32_bf16 v[200:203], v[232:235], v[80:83], v[200:203]
ds_read_b128 v[228:231], v248 offset:35328
v_cvt_pk_bf16_f32 v154, v216, v217
v_mfma_f32_16x16x32_bf16 v[200:203], v[236:239], v[84:87], v[200:203]
v_cvt_pk_bf16_f32 v155, v218, v219
v_mfma_f32_16x16x32_bf16 v[204:207], v[232:235], v[112:115], v[204:207]
v_exp_f32 v220, v220
v_mfma_f32_16x16x32_bf16 v[204:207], v[236:239], v[116:119], v[204:207]
s_waitcnt lgkmcnt(2)
v_mfma_f32_16x16x32_bf16 v[192:195], v[240:243], v[24:27], v[192:195]
ds_read_b128 v[232:235], v248 offset:38912
v_mfma_f32_16x16x32_bf16 v[192:195], v[244:247], v[28:31], v[192:195]
v_exp_f32 v221, v221
v_mfma_f32_16x16x32_bf16 v[196:199], v[240:243], v[56:59], v[196:199]
v_exp_f32 v222, v222
v_mfma_f32_16x16x32_bf16 v[196:199], v[244:247], v[60:63], v[196:199]
v_exp_f32 v223, v223
v_mfma_f32_16x16x32_bf16 v[200:203], v[240:243], v[88:91], v[200:203]
ds_read_b128 v[236:239], v248 offset:39424
v_cvt_pk_bf16_f32 v158, v220, v221
v_mfma_f32_16x16x32_bf16 v[200:203], v[244:247], v[92:95], v[200:203]
v_cvt_pk_bf16_f32 v159, v222, v223
v_mfma_f32_16x16x32_bf16 v[204:207], v[240:243], v[120:123], v[204:207]
v_mfma_f32_16x16x32_bf16 v[204:207], v[244:247], v[124:127], v[204:207]
s_waitcnt lgkmcnt(2)
v_mfma_f32_16x16x32_bf16 v[208:211], v[224:227], v[0:3], 0
ds_read_b128 v[240:243], v248 offset:43008
v_mfma_f32_16x16x32_bf16 v[208:211], v[228:231], v[4:7], v[208:211]
v_exp_f32 v192, v192
v_mfma_f32_16x16x32_bf16 v[212:215], v[224:227], v[32:35], 0
v_exp_f32 v193, v193
v_mfma_f32_16x16x32_bf16 v[212:215], v[228:231], v[36:39], v[212:215]
v_exp_f32 v194, v194
v_mfma_f32_16x16x32_bf16 v[216:219], v[224:227], v[64:67], 0
ds_read_b128 v[244:247], v248 offset:43520
v_cvt_pk_bf16_f32 v160, v192, v193
v_mfma_f32_16x16x32_bf16 v[216:219], v[228:231], v[68:71], v[216:219]
v_exp_f32 v195, v195
v_mfma_f32_16x16x32_bf16 v[220:223], v[224:227], v[96:99], 0
v_exp_f32 v196, v196
v_mfma_f32_16x16x32_bf16 v[220:223], v[228:231], v[100:103], v[220:223]
s_waitcnt lgkmcnt(2)
v_cvt_pk_bf16_f32 v161, v194, v195
v_mfma_f32_16x16x32_bf16 v[208:211], v[232:235], v[8:11], v[208:211]
ds_read_b128 v[224:227], v248 offset:47104
v_mfma_f32_16x16x32_bf16 v[208:211], v[236:239], v[12:15], v[208:211]
v_exp_f32 v197, v197
v_mfma_f32_16x16x32_bf16 v[212:215], v[232:235], v[40:43], v[212:215]
v_exp_f32 v198, v198
v_mfma_f32_16x16x32_bf16 v[212:215], v[236:239], v[44:47], v[212:215]
v_exp_f32 v199, v199
v_mfma_f32_16x16x32_bf16 v[216:219], v[232:235], v[72:75], v[216:219]
ds_read_b128 v[228:231], v248 offset:47616
v_cvt_pk_bf16_f32 v164, v196, v197
v_mfma_f32_16x16x32_bf16 v[216:219], v[236:239], v[76:79], v[216:219]
v_cvt_pk_bf16_f32 v165, v198, v199
v_mfma_f32_16x16x32_bf16 v[220:223], v[232:235], v[104:107], v[220:223]
v_exp_f32 v200, v200
v_mfma_f32_16x16x32_bf16 v[220:223], v[236:239], v[108:111], v[220:223]
s_waitcnt lgkmcnt(2)
s_waitcnt vmcnt(0)
s_barrier
v_mfma_f32_16x16x32_bf16 v[208:211], v[240:243], v[16:19], v[208:211]
ds_read_b128 v[232:235], v248 offset:49152
s_add_u32 s8, s6, 0x0
s_addc_u32 s9, s7, 0
v_mfma_f32_16x16x32_bf16 v[208:211], v[244:247], v[20:23], v[208:211]
v_exp_f32 v201, v201
s_mov_b32 s10, 0x4e2000
v_mfma_f32_16x16x32_bf16 v[212:215], v[240:243], v[48:51], v[212:215]
v_exp_f32 v202, v202
s_mov_b32 s11, 0x00020000
v_mfma_f32_16x16x32_bf16 v[212:215], v[244:247], v[52:55], v[212:215]
v_exp_f32 v203, v203
s_lshl_b32 s55, s34, 13
v_mfma_f32_16x16x32_bf16 v[216:219], v[240:243], v[80:83], v[216:219]
ds_read_b128 v[236:239], v248 offset:49664
v_cvt_pk_bf16_f32 v168, v200, v201
s_add_u32 s55, s55, 0x21000
v_mfma_f32_16x16x32_bf16 v[216:219], v[244:247], v[84:87], v[216:219]
v_cvt_pk_bf16_f32 v169, v202, v203
s_lshl_b32 s36, s34, 7
v_bfe_u32 v253, v252, 4, 3
v_mfma_f32_16x16x32_bf16 v[220:223], v[240:243], v[112:115], v[220:223]
v_exp_f32 v204, v204
v_lshrrev_b32 v254, 7, v252
v_mfma_f32_16x16x32_bf16 v[220:223], v[244:247], v[116:119], v[220:223]
s_waitcnt lgkmcnt(2)
v_xor_b32 v253, v253, v254
v_lshl_add_u32 v254, v254, 9, s36
v_mfma_f32_16x16x32_bf16 v[208:211], v[224:227], v[24:27], v[208:211]
ds_read_b128 v[240:243], v248 offset:53248
v_lshl_add_u32 v253, v253, 4, v254
s_add_u32 m0, s55, 0
v_mfma_f32_16x16x32_bf16 v[208:211], v[228:231], v[28:31], v[208:211]
v_exp_f32 v205, v205
s_add_u32 s35, s52, 0
v_mfma_f32_16x16x32_bf16 v[212:215], v[224:227], v[56:59], v[212:215]
v_exp_f32 v206, v206
buffer_load_dwordx4 v253, s[8:11], s35 offen lds
v_mfma_f32_16x16x32_bf16 v[212:215], v[228:231], v[60:63], v[212:215]
v_exp_f32 v207, v207
s_add_u32 m0, s55, 1024
v_mfma_f32_16x16x32_bf16 v[216:219], v[224:227], v[88:91], v[216:219]
ds_read_b128 v[244:247], v248 offset:53760
v_cvt_pk_bf16_f32 v172, v204, v205
s_add_u32 s35, s52, 4096
v_mfma_f32_16x16x32_bf16 v[216:219], v[228:231], v[92:95], v[216:219]
v_cvt_pk_bf16_f32 v173, v206, v207
buffer_load_dwordx4 v253, s[8:11], s35 offen lds
s_add_u32 m0, s55, 2048
v_mfma_f32_16x16x32_bf16 v[220:223], v[224:227], v[120:123], v[220:223]
s_add_u32 s35, s53, 0
buffer_load_dwordx4 v253, s[8:11], s35 offen lds
s_add_u32 m0, s55, 3072
v_mfma_f32_16x16x32_bf16 v[220:223], v[228:231], v[124:127], v[220:223]
s_waitcnt lgkmcnt(2)
s_add_u32 s35, s53, 4096
buffer_load_dwordx4 v253, s[8:11], s35 offen lds
v_mfma_f32_16x16x32_bf16 v[192:195], v[232:235], v[0:3], 0
ds_read_b128 v[224:227], v248 offset:57344
v_mfma_f32_16x16x32_bf16 v[192:195], v[236:239], v[4:7], v[192:195]
v_exp_f32 v208, v208
v_mfma_f32_16x16x32_bf16 v[196:199], v[232:235], v[32:35], 0
v_exp_f32 v209, v209
v_mfma_f32_16x16x32_bf16 v[196:199], v[236:239], v[36:39], v[196:199]
v_exp_f32 v210, v210
v_mfma_f32_16x16x32_bf16 v[200:203], v[232:235], v[64:67], 0
ds_read_b128 v[228:231], v248 offset:57856
v_cvt_pk_bf16_f32 v162, v208, v209
v_mfma_f32_16x16x32_bf16 v[200:203], v[236:239], v[68:71], v[200:203]
v_exp_f32 v211, v211
v_mfma_f32_16x16x32_bf16 v[204:207], v[232:235], v[96:99], 0
v_exp_f32 v212, v212
v_mfma_f32_16x16x32_bf16 v[204:207], v[236:239], v[100:103], v[204:207]
s_waitcnt lgkmcnt(2)
v_cvt_pk_bf16_f32 v163, v210, v211
v_mfma_f32_16x16x32_bf16 v[192:195], v[240:243], v[8:11], v[192:195]
ds_read_b128 v[232:235], v248 offset:61440
v_mfma_f32_16x16x32_bf16 v[192:195], v[244:247], v[12:15], v[192:195]
v_exp_f32 v213, v213
v_mfma_f32_16x16x32_bf16 v[196:199], v[240:243], v[40:43], v[196:199]
v_exp_f32 v214, v214
v_mfma_f32_16x16x32_bf16 v[196:199], v[244:247], v[44:47], v[196:199]
v_exp_f32 v215, v215
v_mfma_f32_16x16x32_bf16 v[200:203], v[240:243], v[72:75], v[200:203]
ds_read_b128 v[236:239], v248 offset:61952
v_cvt_pk_bf16_f32 v166, v212, v213
v_mfma_f32_16x16x32_bf16 v[200:203], v[244:247], v[76:79], v[200:203]
v_cvt_pk_bf16_f32 v167, v214, v215
v_mfma_f32_16x16x32_bf16 v[204:207], v[240:243], v[104:107], v[204:207]
v_exp_f32 v216, v216
v_mfma_f32_16x16x32_bf16 v[204:207], v[244:247], v[108:111], v[204:207]
s_waitcnt lgkmcnt(2)
v_mfma_f32_16x16x32_bf16 v[192:195], v[224:227], v[16:19], v[192:195]
ds_read_b128 v[240:243], v248 offset:51200
v_mfma_f32_16x16x32_bf16 v[192:195], v[228:231], v[20:23], v[192:195]
v_exp_f32 v217, v217
v_mfma_f32_16x16x32_bf16 v[196:199], v[224:227], v[48:51], v[196:199]
v_exp_f32 v218, v218
v_mfma_f32_16x16x32_bf16 v[196:199], v[228:231], v[52:55], v[196:199]
v_exp_f32 v219, v219
v_mfma_f32_16x16x32_bf16 v[200:203], v[224:227], v[80:83], v[200:203]
ds_read_b128 v[244:247], v248 offset:51712
v_cvt_pk_bf16_f32 v170, v216, v217
v_mfma_f32_16x16x32_bf16 v[200:203], v[228:231], v[84:87], v[200:203]
v_cvt_pk_bf16_f32 v171, v218, v219
v_mfma_f32_16x16x32_bf16 v[204:207], v[224:227], v[112:115], v[204:207]
v_exp_f32 v220, v220
v_mfma_f32_16x16x32_bf16 v[204:207], v[228:231], v[116:119], v[204:207]
s_waitcnt lgkmcnt(2)
v_mfma_f32_16x16x32_bf16 v[192:195], v[232:235], v[24:27], v[192:195]
ds_read_b128 v[224:227], v248 offset:55296
v_mfma_f32_16x16x32_bf16 v[192:195], v[236:239], v[28:31], v[192:195]
v_exp_f32 v221, v221
v_mfma_f32_16x16x32_bf16 v[196:199], v[232:235], v[56:59], v[196:199]
v_exp_f32 v222, v222
v_mfma_f32_16x16x32_bf16 v[196:199], v[236:239], v[60:63], v[196:199]
v_exp_f32 v223, v223
v_mfma_f32_16x16x32_bf16 v[200:203], v[232:235], v[88:91], v[200:203]
ds_read_b128 v[228:231], v248 offset:55808
v_cvt_pk_bf16_f32 v174, v220, v221
v_mfma_f32_16x16x32_bf16 v[200:203], v[236:239], v[92:95], v[200:203]
v_cvt_pk_bf16_f32 v175, v222, v223
v_mfma_f32_16x16x32_bf16 v[204:207], v[232:235], v[120:123], v[204:207]
v_mfma_f32_16x16x32_bf16 v[204:207], v[236:239], v[124:127], v[204:207]
s_waitcnt lgkmcnt(2)
v_mfma_f32_16x16x32_bf16 v[208:211], v[240:243], v[0:3], 0
ds_read_b128 v[232:235], v248 offset:59392
v_mfma_f32_16x16x32_bf16 v[208:211], v[244:247], v[4:7], v[208:211]
v_exp_f32 v192, v192
v_mfma_f32_16x16x32_bf16 v[212:215], v[240:243], v[32:35], 0
v_exp_f32 v193, v193
v_mfma_f32_16x16x32_bf16 v[212:215], v[244:247], v[36:39], v[212:215]
v_exp_f32 v194, v194
v_mfma_f32_16x16x32_bf16 v[216:219], v[240:243], v[64:67], 0
ds_read_b128 v[236:239], v248 offset:59904
v_cvt_pk_bf16_f32 v0, v192, v193
v_mfma_f32_16x16x32_bf16 v[216:219], v[244:247], v[68:71], v[216:219]
v_exp_f32 v195, v195
v_mfma_f32_16x16x32_bf16 v[220:223], v[240:243], v[96:99], 0
v_exp_f32 v196, v196
v_mfma_f32_16x16x32_bf16 v[220:223], v[244:247], v[100:103], v[220:223]
s_waitcnt lgkmcnt(2)
v_cvt_pk_bf16_f32 v1, v194, v195
v_mfma_f32_16x16x32_bf16 v[208:211], v[224:227], v[8:11], v[208:211]
ds_read_b128 v[240:243], v248 offset:63488
v_mfma_f32_16x16x32_bf16 v[208:211], v[228:231], v[12:15], v[208:211]
v_exp_f32 v197, v197
v_mfma_f32_16x16x32_bf16 v[212:215], v[224:227], v[40:43], v[212:215]
ds_read_b128 v[4:7], v255 offset:0
ds_read_b128 v[36:39], v255 offset:1024
v_mfma_f32_16x16x32_bf16 v[212:215], v[228:231], v[44:47], v[212:215]
v_exp_f32 v198, v198
v_mfma_f32_16x16x32_bf16 v[216:219], v[224:227], v[72:75], v[216:219]
ds_read_b128 v[244:247], v248 offset:64000
v_xor_b32 v12, 0x10000, v249
v_mfma_f32_16x16x32_bf16 v[216:219], v[228:231], v[76:79], v[216:219]
v_xor_b32 v13, 0x10000, v250
v_cvt_pk_bf16_f32 v32, v196, v197
v_mfma_f32_16x16x32_bf16 v[220:223], v[224:227], v[104:107], v[220:223]
ds_read_b128 v[68:71], v255 offset:2048
ds_read_b128 v[100:103], v255 offset:3072
v_mfma_f32_16x16x32_bf16 v[220:223], v[228:231], v[108:111], v[220:223]
s_waitcnt lgkmcnt(6)
v_mfma_f32_16x16x32_bf16 v[208:211], v[232:235], v[16:19], v[208:211]
ds_read_b64_tr_b16 v[224:225], v12 offset:0
ds_read_b64_tr_b16 v[226:227], v12 offset:2048
v_mfma_f32_16x16x32_bf16 v[208:211], v[236:239], v[20:23], v[208:211]
v_exp_f32 v199, v199
v_mfma_f32_16x16x32_bf16 v[212:215], v[232:235], v[48:51], v[212:215]
v_cvt_pk_bf16_f32 v33, v198, v199
v_mfma_f32_16x16x32_bf16 v[212:215], v[236:239], v[52:55], v[212:215]
v_exp_f32 v200, v200
v_mfma_f32_16x16x32_bf16 v[216:219], v[232:235], v[80:83], v[216:219]
ds_read_b64_tr_b16 v[228:229], v12 offset:16384
ds_read_b64_tr_b16 v[230:231], v12 offset:18432
v_mfma_f32_16x16x32_bf16 v[216:219], v[236:239], v[84:87], v[216:219]
v_exp_f32 v201, v201
v_mfma_f32_16x16x32_bf16 v[220:223], v[232:235], v[112:115], v[220:223]
v_exp_f32 v202, v202
v_mfma_f32_16x16x32_bf16 v[220:223], v[236:239], v[116:119], v[220:223]
s_waitcnt lgkmcnt(6)
v_cvt_pk_bf16_f32 v64, v200, v201
v_mfma_f32_16x16x32_bf16 v[208:211], v[240:243], v[24:27], v[208:211]
ds_read_b64_tr_b16 v[232:233], v13 offset:0
ds_read_b64_tr_b16 v[234:235], v13 offset:2048
v_mfma_f32_16x16x32_bf16 v[208:211], v[244:247], v[28:31], v[208:211]
v_exp_f32 v203, v203
v_mfma_f32_16x16x32_bf16 v[212:215], v[240:243], v[56:59], v[212:215]
v_cvt_pk_bf16_f32 v65, v202, v203
v_mfma_f32_16x16x32_bf16 v[212:215], v[244:247], v[60:63], v[212:215]
v_exp_f32 v204, v204
v_mfma_f32_16x16x32_bf16 v[216:219], v[240:243], v[88:91], v[216:219]
ds_read_b64_tr_b16 v[236:237], v13 offset:16384
ds_read_b64_tr_b16 v[238:239], v13 offset:18432
v_mfma_f32_16x16x32_bf16 v[216:219], v[244:247], v[92:95], v[216:219]
v_exp_f32 v205, v205
v_mfma_f32_16x16x32_bf16 v[220:223], v[240:243], v[120:123], v[220:223]
v_exp_f32 v206, v206
v_mfma_f32_16x16x32_bf16 v[220:223], v[244:247], v[124:127], v[220:223]
s_waitcnt lgkmcnt(4)
v_mfma_f32_16x16x32_bf16 a[0:3], v[224:227], v[128:131], a[0:3]
ds_read_b64_tr_b16 v[240:241], v249 offset:33280
ds_read_b64_tr_b16 v[242:243], v249 offset:35328
v_mfma_f32_16x16x32_bf16 a[0:3], v[228:231], v[144:147], a[0:3]
v_exp_f32 v207, v207
v_mfma_f32_16x16x32_bf16 a[4:7], v[224:227], v[132:135], a[4:7]
v_cvt_pk_bf16_f32 v96, v204, v205
v_cvt_pk_bf16_f32 v97, v206, v207
v_mfma_f32_16x16x32_bf16 a[4:7], v[228:231], v[148:151], a[4:7]
v_exp_f32 v208, v208
v_mfma_f32_16x16x32_bf16 a[8:11], v[224:227], v[136:139], a[8:11]
ds_read_b64_tr_b16 v[244:245], v249 offset:49664
ds_read_b64_tr_b16 v[246:247], v249 offset:51712
v_mfma_f32_16x16x32_bf16 a[8:11], v[228:231], v[152:155], a[8:11]
v_exp_f32 v209, v209
v_mfma_f32_16x16x32_bf16 a[12:15], v[224:227], v[140:143], a[12:15]
v_exp_f32 v210, v210
v_mfma_f32_16x16x32_bf16 a[12:15], v[228:231], v[156:159], a[12:15]
s_waitcnt lgkmcnt(4)
v_cvt_pk_bf16_f32 v2, v208, v209
v_mfma_f32_16x16x32_bf16 a[16:19], v[232:235], v[128:131], a[16:19]
ds_read_b64_tr_b16 v[224:225], v12 offset:512
ds_read_b64_tr_b16 v[226:227], v12 offset:2560
v_mfma_f32_16x16x32_bf16 a[16:19], v[236:239], v[144:147], a[16:19]
v_exp_f32 v211, v211
v_mfma_f32_16x16x32_bf16 a[20:23], v[232:235], v[132:135], a[20:23]
v_cvt_pk_bf16_f32 v3, v210, v211
v_mfma_f32_16x16x32_bf16 a[20:23], v[236:239], v[148:151], a[20:23]
v_exp_f32 v212, v212
v_mfma_f32_16x16x32_bf16 a[24:27], v[232:235], v[136:139], a[24:27]
ds_read_b64_tr_b16 v[228:229], v12 offset:16896
ds_read_b64_tr_b16 v[230:231], v12 offset:18944
v_mfma_f32_16x16x32_bf16 a[24:27], v[236:239], v[152:155], a[24:27]
v_exp_f32 v213, v213
v_mfma_f32_16x16x32_bf16 a[28:31], v[232:235], v[140:143], a[28:31]
v_exp_f32 v214, v214
v_mfma_f32_16x16x32_bf16 a[28:31], v[236:239], v[156:159], a[28:31]
s_waitcnt lgkmcnt(4)
v_cvt_pk_bf16_f32 v34, v212, v213
v_mfma_f32_16x16x32_bf16 a[32:35], v[240:243], v[4:7], a[32:35]
ds_read_b64_tr_b16 v[232:233], v250 offset:33280
ds_read_b64_tr_b16 v[234:235], v250 offset:35328
v_mfma_f32_16x16x32_bf16 a[32:35], v[244:247], v[176:179], a[32:35]
v_exp_f32 v215, v215
v_mfma_f32_16x16x32_bf16 a[36:39], v[240:243], v[36:39], a[36:39]
v_cvt_pk_bf16_f32 v35, v214, v215
v_mfma_f32_16x16x32_bf16 a[36:39], v[244:247], v[180:183], a[36:39]
v_exp_f32 v216, v216
v_mfma_f32_16x16x32_bf16 a[40:43], v[240:243], v[68:71], a[40:43]
ds_read_b64_tr_b16 v[236:237], v250 offset:49664
ds_read_b64_tr_b16 v[238:239], v250 offset:51712
v_mfma_f32_16x16x32_bf16 a[40:43], v[244:247], v[184:187], a[40:43]
v_exp_f32 v217, v217
v_mfma_f32_16x16x32_bf16 a[44:47], v[240:243], v[100:103], a[44:47]
v_exp_f32 v218, v218
v_mfma_f32_16x16x32_bf16 a[44:47], v[244:247], v[188:191], a[44:47]
s_waitcnt lgkmcnt(4)
v_cvt_pk_bf16_f32 v66, v216, v217
v_mfma_f32_16x16x32_bf16 a[32:35], v[224:227], v[128:131], a[32:35]
ds_read_b64_tr_b16 v[240:241], v12 offset:32768
ds_read_b64_tr_b16 v[242:243], v12 offset:34816
v_mfma_f32_16x16x32_bf16 a[32:35], v[228:231], v[144:147], a[32:35]
v_exp_f32 v219, v219
v_mfma_f32_16x16x32_bf16 a[36:39], v[224:227], v[132:135], a[36:39]
v_cvt_pk_bf16_f32 v67, v218, v219
v_mfma_f32_16x16x32_bf16 a[36:39], v[228:231], v[148:151], a[36:39]
v_exp_f32 v220, v220
v_mfma_f32_16x16x32_bf16 a[40:43], v[224:227], v[136:139], a[40:43]
ds_read_b64_tr_b16 v[244:245], v12 offset:49152
ds_read_b64_tr_b16 v[246:247], v12 offset:51200
v_mfma_f32_16x16x32_bf16 a[40:43], v[228:231], v[152:155], a[40:43]
v_exp_f32 v221, v221
v_mfma_f32_16x16x32_bf16 a[44:47], v[224:227], v[140:143], a[44:47]
v_exp_f32 v222, v222
v_mfma_f32_16x16x32_bf16 a[44:47], v[228:231], v[156:159], a[44:47]
s_waitcnt lgkmcnt(4)
v_cvt_pk_bf16_f32 v98, v220, v221
v_mfma_f32_16x16x32_bf16 a[48:51], v[232:235], v[4:7], a[48:51]
ds_read_b64_tr_b16 v[224:225], v13 offset:32768
ds_read_b64_tr_b16 v[226:227], v13 offset:34816
v_mfma_f32_16x16x32_bf16 a[48:51], v[236:239], v[176:179], a[48:51]
v_exp_f32 v223, v223
v_mfma_f32_16x16x32_bf16 a[52:55], v[232:235], v[36:39], a[52:55]
v_cvt_pk_bf16_f32 v99, v222, v223
v_mfma_f32_16x16x32_bf16 a[52:55], v[236:239], v[180:183], a[52:55]
v_mfma_f32_16x16x32_bf16 a[56:59], v[232:235], v[68:71], a[56:59]
ds_read_b64_tr_b16 v[228:229], v13 offset:49152
ds_read_b64_tr_b16 v[230:231], v13 offset:51200
v_mfma_f32_16x16x32_bf16 a[56:59], v[236:239], v[184:187], a[56:59]
v_mfma_f32_16x16x32_bf16 a[60:63], v[232:235], v[100:103], a[60:63]
v_mfma_f32_16x16x32_bf16 a[60:63], v[236:239], v[188:191], a[60:63]
s_waitcnt lgkmcnt(4)
v_mfma_f32_16x16x32_bf16 a[0:3], v[240:243], v[160:163], a[0:3]
ds_read_b64_tr_b16 v[232:233], v12 offset:33280
ds_read_b64_tr_b16 v[234:235], v12 offset:35328
v_mfma_f32_16x16x32_bf16 a[0:3], v[244:247], v[0:3], a[0:3]
v_mfma_f32_16x16x32_bf16 a[4:7], v[240:243], v[164:167], a[4:7]
v_mfma_f32_16x16x32_bf16 a[4:7], v[244:247], v[32:35], a[4:7]
v_mfma_f32_16x16x32_bf16 a[8:11], v[240:243], v[168:171], a[8:11]
ds_read_b64_tr_b16 v[236:237], v12 offset:49664
ds_read_b64_tr_b16 v[238:239], v12 offset:51712
v_mfma_f32_16x16x32_bf16 a[8:11], v[244:247], v[64:67], a[8:11]
v_mfma_f32_16x16x32_bf16 a[12:15], v[240:243], v[172:175], a[12:15]
v_mfma_f32_16x16x32_bf16 a[12:15], v[244:247], v[96:99], a[12:15]
s_waitcnt lgkmcnt(4)
v_mfma_f32_16x16x32_bf16 a[16:19], v[224:227], v[160:163], a[16:19]
ds_read_b64_tr_b16 v[240:241], v13 offset:512
ds_read_b64_tr_b16 v[242:243], v13 offset:2560
v_mfma_f32_16x16x32_bf16 a[16:19], v[228:231], v[0:3], a[16:19]
v_mfma_f32_16x16x32_bf16 a[20:23], v[224:227], v[164:167], a[20:23]
v_mfma_f32_16x16x32_bf16 a[20:23], v[228:231], v[32:35], a[20:23]
v_mfma_f32_16x16x32_bf16 a[24:27], v[224:227], v[168:171], a[24:27]
ds_read_b64_tr_b16 v[244:245], v13 offset:16896
ds_read_b64_tr_b16 v[246:247], v13 offset:18944
v_accvgpr_read_b32 v192, a0
v_mfma_f32_16x16x32_bf16 a[24:27], v[228:231], v[64:67], a[24:27]
v_accvgpr_read_b32 v193, a4
v_accvgpr_read_b32 v194, a8
v_accvgpr_read_b32 v195, a12
v_mfma_f32_16x16x32_bf16 a[28:31], v[224:227], v[172:175], a[28:31]
v_lshlrev_b32 v253, 2, v252
v_subrev_u32 v196, 0x0d800000, v192
v_subrev_u32 v197, 0x0d800000, v193
v_mfma_f32_16x16x32_bf16 a[28:31], v[228:231], v[96:99], a[28:31]
s_waitcnt lgkmcnt(4)
v_subrev_u32 v198, 0x0d800000, v194
v_subrev_u32 v199, 0x0d800000, v195
v_mfma_f32_16x16x32_bf16 a[32:35], v[232:235], v[160:163], a[32:35]
ds_read_b64_tr_b16 v[224:225], v13 offset:33280
ds_read_b64_tr_b16 v[226:227], v13 offset:35328
v_max3_u32 v254, v196, v197, v198
v_mfma_f32_16x16x32_bf16 a[32:35], v[236:239], v[0:3], a[32:35]
v_max_u32 v254, v254, v199
v_mfma_f32_16x16x32_bf16 a[36:39], v[232:235], v[164:167], a[36:39]
s_mov_b64 exec, 0xffff
s_xor_b32 s35, s48, 0
buffer_store_dword v192, v253, s[24:27], s35 offen offset:4 sc1
s_xor_b32 s35, s48, 1024
buffer_store_dword v193, v253, s[24:27], s35 offen offset:4 sc1
s_xor_b32 s35, s48, 2048
buffer_store_dword v194, v253, s[24:27], s35 offen offset:4 sc1
s_xor_b32 s35, s48, 3072
buffer_store_dword v195, v253, s[24:27], s35 offen offset:4 sc1
v_cmp_le_u32 vcc, 0x64000000, v254
s_mov_b64 exec, -1
v_mfma_f32_16x16x32_bf16 a[36:39], v[236:239], v[32:35], a[36:39]
v_accvgpr_read_b32 v192, a0
v_accvgpr_read_b32 v193, a1
v_mfma_f32_16x16x32_bf16 a[40:43], v[232:235], v[168:171], a[40:43]
ds_read_b64_tr_b16 v[228:229], v13 offset:49664
ds_read_b64_tr_b16 v[230:231], v13 offset:51712
v_mfma_f32_16x16x32_bf16 a[40:43], v[236:239], v[64:67], a[40:43]
v_accvgpr_read_b32 v194, a2
v_accvgpr_read_b32 v195, a3
v_mfma_f32_16x16x32_bf16 a[44:47], v[232:235], v[172:175], a[44:47]
v_cvt_pk_bf16_f32 v16, v192, v193
v_cvt_pk_bf16_f32 v17, v194, v195
v_mfma_f32_16x16x32_bf16 a[44:47], v[236:239], v[96:99], a[44:47]
s_waitcnt lgkmcnt(4)
v_accvgpr_read_b32 v200, a4
v_mfma_f32_16x16x32_bf16 a[48:51], v[240:243], v[128:131], a[48:51]
ds_read_b64_tr_b16 v[232:233], v249 offset:36864
ds_read_b64_tr_b16 v[234:235], v249 offset:38912
v_mfma_f32_16x16x32_bf16 a[48:51], v[244:247], v[144:147], a[48:51]
v_accvgpr_read_b32 v201, a5
v_accvgpr_read_b32 v202, a6
v_mfma_f32_16x16x32_bf16 a[52:55], v[240:243], v[132:135], a[52:55]
v_accvgpr_read_b32 v203, a7
v_cvt_pk_bf16_f32 v48, v200, v201
v_mfma_f32_16x16x32_bf16 a[52:55], v[244:247], v[148:151], a[52:55]
v_cvt_pk_bf16_f32 v49, v202, v203
v_accvgpr_read_b32 v208, a8
v_mfma_f32_16x16x32_bf16 a[56:59], v[240:243], v[136:139], a[56:59]
ds_read_b64_tr_b16 v[236:237], v249 offset:53248
ds_read_b64_tr_b16 v[238:239], v249 offset:55296
v_mfma_f32_16x16x32_bf16 a[56:59], v[244:247], v[152:155], a[56:59]
v_accvgpr_read_b32 v209, a9
v_accvgpr_read_b32 v210, a10
v_mfma_f32_16x16x32_bf16 a[60:63], v[240:243], v[140:143], a[60:63]
v_accvgpr_read_b32 v211, a11
v_cvt_pk_bf16_f32 v80, v208, v209
v_mfma_f32_16x16x32_bf16 a[60:63], v[244:247], v[156:159], a[60:63]
s_waitcnt lgkmcnt(4)
v_cvt_pk_bf16_f32 v81, v210, v211
v_mfma_f32_16x16x32_bf16 a[48:51], v[224:227], v[160:163], a[48:51]
ds_read_b64_tr_b16 v[240:241], v12 offset:4096
ds_read_b64_tr_b16 v[242:243], v12 offset:6144
v_mfma_f32_16x16x32_bf16 a[48:51], v[228:231], v[0:3], a[48:51]
v_accvgpr_read_b32 v216, a12
v_accvgpr_read_b32 v217, a13
v_mfma_f32_16x16x32_bf16 a[52:55], v[224:227], v[164:167], a[52:55]
v_accvgpr_read_b32 v218, a14
v_accvgpr_read_b32 v219, a15
v_mfma_f32_16x16x32_bf16 a[52:55], v[228:231], v[32:35], a[52:55]
v_cvt_pk_bf16_f32 v112, v216, v217
v_cvt_pk_bf16_f32 v113, v218, v219
v_mfma_f32_16x16x32_bf16 a[56:59], v[224:227], v[168:171], a[56:59]
ds_read_b64_tr_b16 v[244:245], v12 offset:20480
ds_read_b64_tr_b16 v[246:247], v12 offset:22528
v_mfma_f32_16x16x32_bf16 a[56:59], v[228:231], v[64:67], a[56:59]
v_accvgpr_read_b32 v196, a16
v_accvgpr_read_b32 v197, a17
v_mfma_f32_16x16x32_bf16 a[60:63], v[224:227], v[172:175], a[60:63]
v_accvgpr_read_b32 v198, a18
v_accvgpr_read_b32 v199, a19
v_mfma_f32_16x16x32_bf16 a[60:63], v[228:231], v[96:99], a[60:63]
s_waitcnt lgkmcnt(4)
v_cvt_pk_bf16_f32 v18, v196, v197
v_mfma_f32_16x16x32_bf16 a[64:67], v[232:235], v[4:7], a[64:67]
ds_read_b64_tr_b16 v[224:225], v12 offset:36864
ds_read_b64_tr_b16 v[226:227], v12 offset:38912
v_mfma_f32_16x16x32_bf16 a[64:67], v[236:239], v[176:179], a[64:67]
v_cvt_pk_bf16_f32 v19, v198, v199
buffer_store_dwordx4 v[16:19], v252, s[20:23], s40 offen offset:0 sc1
v_mfma_f32_16x16x32_bf16 a[68:71], v[232:235], v[36:39], a[68:71]
ds_write_b128 v255, v[16:19] offset:0
v_accvgpr_read_b32 v204, a20
v_mfma_f32_16x16x32_bf16 a[68:71], v[236:239], v[180:183], a[68:71]
v_accvgpr_read_b32 v205, a21
v_accvgpr_read_b32 v206, a22
v_mfma_f32_16x16x32_bf16 a[72:75], v[232:235], v[68:71], a[72:75]
ds_read_b64_tr_b16 v[228:229], v12 offset:53248
ds_read_b64_tr_b16 v[230:231], v12 offset:55296
v_mfma_f32_16x16x32_bf16 a[72:75], v[236:239], v[184:187], a[72:75]
v_accvgpr_read_b32 v207, a23
v_cvt_pk_bf16_f32 v50, v204, v205
v_mfma_f32_16x16x32_bf16 a[76:79], v[232:235], v[100:103], a[76:79]
v_cvt_pk_bf16_f32 v51, v206, v207
buffer_store_dwordx4 v[48:51], v252, s[20:23], s41 offen offset:0 sc1
v_mfma_f32_16x16x32_bf16 a[76:79], v[236:239], v[188:191], a[76:79]
s_waitcnt lgkmcnt(5)
v_accvgpr_read_b32 v212, a24
v_mfma_f32_16x16x32_bf16 a[64:67], v[240:243], v[128:131], a[64:67]
ds_read_b64_tr_b16 v[232:233], v250 offset:36864
ds_read_b64_tr_b16 v[234:235], v250 offset:38912
v_mfma_f32_16x16x32_bf16 a[64:67], v[244:247], v[144:147], a[64:67]
v_accvgpr_read_b32 v213, a25
v_accvgpr_read_b32 v214, a26
v_mfma_f32_16x16x32_bf16 a[68:71], v[240:243], v[132:135], a[68:71]
v_accvgpr_read_b32 v215, a27
v_cvt_pk_bf16_f32 v82, v212, v213
v_mfma_f32_16x16x32_bf16 a[68:71], v[244:247], v[148:151], a[68:71]
v_cvt_pk_bf16_f32 v83, v214, v215
buffer_store_dwordx4 v[80:83], v252, s[20:23], s42 offen offset:0 sc1
v_mfma_f32_16x16x32_bf16 a[72:75], v[240:243], v[136:139], a[72:75]
ds_read_b64_tr_b16 v[236:237], v250 offset:53248
ds_read_b64_tr_b16 v[238:239], v250 offset:55296
v_mfma_f32_16x16x32_bf16 a[72:75], v[244:247], v[152:155], a[72:75]
v_accvgpr_read_b32 v220, a28
v_accvgpr_read_b32 v221, a29
v_mfma_f32_16x16x32_bf16 a[76:79], v[240:243], v[140:143], a[76:79]
v_accvgpr_read_b32 v222, a30
v_accvgpr_read_b32 v223, a31
v_mfma_f32_16x16x32_bf16 a[76:79], v[244:247], v[156:159], a[76:79]
s_waitcnt lgkmcnt(4)
v_cvt_pk_bf16_f32 v114, v220, v221
v_mfma_f32_16x16x32_bf16 a[64:67], v[224:227], v[160:163], a[64:67]
ds_read_b64_tr_b16 v[240:241], v13 offset:4096
ds_read_b64_tr_b16 v[242:243], v13 offset:6144
v_mfma_f32_16x16x32_bf16 a[64:67], v[228:231], v[0:3], a[64:67]
v_cvt_pk_bf16_f32 v115, v222, v223
buffer_store_dwordx4 v[112:115], v252, s[20:23], s43 offen offset:0 sc1
v_mfma_f32_16x16x32_bf16 a[68:71], v[224:227], v[164:167], a[68:71]
v_accvgpr_read_b32 v192, a32
v_accvgpr_read_b32 v193, a33
v_mfma_f32_16x16x32_bf16 a[68:71], v[228:231], v[32:35], a[68:71]
v_accvgpr_read_b32 v194, a34
v_accvgpr_read_b32 v195, a35
v_mfma_f32_16x16x32_bf16 a[72:75], v[224:227], v[168:171], a[72:75]
ds_read_b64_tr_b16 v[244:245], v13 offset:20480
ds_read_b64_tr_b16 v[246:247], v13 offset:22528
v_mfma_f32_16x16x32_bf16 a[72:75], v[228:231], v[64:67], a[72:75]
v_cvt_pk_bf16_f32 v20, v192, v193
v_cvt_pk_bf16_f32 v21, v194, v195
v_mfma_f32_16x16x32_bf16 a[76:79], v[224:227], v[172:175], a[76:79]
v_accvgpr_read_b32 v200, a36
v_accvgpr_read_b32 v201, a37
v_mfma_f32_16x16x32_bf16 a[76:79], v[228:231], v[96:99], a[76:79]
s_waitcnt lgkmcnt(4)
v_accvgpr_read_b32 v202, a38
v_mfma_f32_16x16x32_bf16 a[80:83], v[232:235], v[4:7], a[80:83]
ds_read_b64_tr_b16 v[224:225], v13 offset:36864
ds_read_b64_tr_b16 v[226:227], v13 offset:38912
v_mfma_f32_16x16x32_bf16 a[80:83], v[236:239], v[176:179], a[80:83]
v_accvgpr_read_b32 v203, a39
v_cvt_pk_bf16_f32 v52, v200, v201
v_mfma_f32_16x16x32_bf16 a[84:87], v[232:235], v[36:39], a[84:87]
v_cvt_pk_bf16_f32 v53, v202, v203
v_accvgpr_read_b32 v208, a40
v_mfma_f32_16x16x32_bf16 a[84:87], v[236:239], v[180:183], a[84:87]
v_accvgpr_read_b32 v209, a41
v_accvgpr_read_b32 v210, a42
v_mfma_f32_16x16x32_bf16 a[88:91], v[232:235], v[68:71], a[88:91]
ds_read_b64_tr_b16 v[228:229], v13 offset:53248
ds_read_b64_tr_b16 v[230:231], v13 offset:55296
v_mfma_f32_16x16x32_bf16 a[88:91], v[236:239], v[184:187], a[88:91]
v_accvgpr_read_b32 v211, a43
v_cvt_pk_bf16_f32 v84, v208, v209
v_mfma_f32_16x16x32_bf16 a[92:95], v[232:235], v[100:103], a[92:95]
v_cvt_pk_bf16_f32 v85, v210, v211
v_accvgpr_read_b32 v216, a44
v_mfma_f32_16x16x32_bf16 a[92:95], v[236:239], v[188:191], a[92:95]
s_waitcnt lgkmcnt(4)
v_accvgpr_read_b32 v217, a45
v_mfma_f32_16x16x32_bf16 a[80:83], v[240:243], v[128:131], a[80:83]
ds_read_b64_tr_b16 v[232:233], v249 offset:37376
ds_read_b64_tr_b16 v[234:235], v249 offset:39424
v_mfma_f32_16x16x32_bf16 a[80:83], v[244:247], v[144:147], a[80:83]
v_accvgpr_read_b32 v218, a46
v_accvgpr_read_b32 v219, a47
v_mfma_f32_16x16x32_bf16 a[84:87], v[240:243], v[132:135], a[84:87]
v_cvt_pk_bf16_f32 v116, v216, v217
v_cvt_pk_bf16_f32 v117, v218, v219
v_mfma_f32_16x16x32_bf16 a[84:87], v[244:247], v[148:151], a[84:87]
v_accvgpr_read_b32 v196, a48
v_accvgpr_read_b32 v197, a49
v_mfma_f32_16x16x32_bf16 a[88:91], v[240:243], v[136:139], a[88:91]
ds_read_b64_tr_b16 v[236:237], v249 offset:53760
ds_read_b64_tr_b16 v[238:239], v249 offset:55808
v_mfma_f32_16x16x32_bf16 a[88:91], v[244:247], v[152:155], a[88:91]
v_accvgpr_read_b32 v198, a50
v_accvgpr_read_b32 v199, a51
v_mfma_f32_16x16x32_bf16 a[92:95], v[240:243], v[140:143], a[92:95]
v_cvt_pk_bf16_f32 v22, v196, v197
v_cvt_pk_bf16_f32 v23, v198, v199
v_mfma_f32_16x16x32_bf16 a[92:95], v[244:247], v[156:159], a[92:95]
s_waitcnt lgkmcnt(4)
buffer_store_dwordx4 v[20:23], v252, s[20:23], s40 offen offset:1024 sc1
v_mfma_f32_16x16x32_bf16 a[80:83], v[224:227], v[160:163], a[80:83]
ds_read_b64_tr_b16 v[240:241], v12 offset:4608
ds_read_b64_tr_b16 v[242:243], v12 offset:6656
v_mfma_f32_16x16x32_bf16 a[80:83], v[228:231], v[0:3], a[80:83]
ds_write_b128 v255, v[20:23] offset:1024
v_accvgpr_read_b32 v204, a52
v_mfma_f32_16x16x32_bf16 a[84:87], v[224:227], v[164:167], a[84:87]
v_accvgpr_read_b32 v205, a53
v_accvgpr_read_b32 v206, a54
v_mfma_f32_16x16x32_bf16 a[84:87], v[228:231], v[32:35], a[84:87]
v_accvgpr_read_b32 v207, a55
v_cvt_pk_bf16_f32 v54, v204, v205
v_mfma_f32_16x16x32_bf16 a[88:91], v[224:227], v[168:171], a[88:91]
ds_read_b64_tr_b16 v[244:245], v12 offset:20992
ds_read_b64_tr_b16 v[246:247], v12 offset:23040
v_mfma_f32_16x16x32_bf16 a[88:91], v[228:231], v[64:67], a[88:91]
v_cvt_pk_bf16_f32 v55, v206, v207
buffer_store_dwordx4 v[52:55], v252, s[20:23], s41 offen offset:1024 sc1
v_mfma_f32_16x16x32_bf16 a[92:95], v[224:227], v[172:175], a[92:95]
v_accvgpr_read_b32 v212, a56
v_accvgpr_read_b32 v213, a57
v_mfma_f32_16x16x32_bf16 a[92:95], v[228:231], v[96:99], a[92:95]
s_waitcnt lgkmcnt(5)
v_accvgpr_read_b32 v214, a58
v_mfma_f32_16x16x32_bf16 a[96:99], v[232:235], v[4:7], a[96:99]
ds_read_b64_tr_b16 v[224:225], v12 offset:37376
ds_read_b64_tr_b16 v[226:227], v12 offset:39424
v_mfma_f32_16x16x32_bf16 a[96:99], v[236:239], v[176:179], a[96:99]
v_accvgpr_read_b32 v215, a59
v_cvt_pk_bf16_f32 v86, v212, v213
v_mfma_f32_16x16x32_bf16 a[100:103], v[232:235], v[36:39], a[100:103]
v_cvt_pk_bf16_f32 v87, v214, v215
buffer_store_dwordx4 v[84:87], v252, s[20:23], s42 offen offset:1024 sc1
v_mfma_f32_16x16x32_bf16 a[100:103], v[236:239], v[180:183], a[100:103]
v_accvgpr_read_b32 v220, a60
v_accvgpr_read_b32 v221, a61
v_mfma_f32_16x16x32_bf16 a[104:107], v[232:235], v[68:71], a[104:107]
ds_read_b64_tr_b16 v[228:229], v12 offset:53760
ds_read_b64_tr_b16 v[230:231], v12 offset:55808
v_mfma_f32_16x16x32_bf16 a[104:107], v[236:239], v[184:187], a[104:107]
v_accvgpr_read_b32 v222, a62
v_accvgpr_read_b32 v223, a63
v_mfma_f32_16x16x32_bf16 a[108:111], v[232:235], v[100:103], a[108:111]
v_cvt_pk_bf16_f32 v118, v220, v221
v_cvt_pk_bf16_f32 v119, v222, v223
v_mfma_f32_16x16x32_bf16 a[108:111], v[236:239], v[188:191], a[108:111]
s_waitcnt lgkmcnt(4)
buffer_store_dwordx4 v[116:119], v252, s[20:23], s43 offen offset:1024 sc1
v_mfma_f32_16x16x32_bf16 a[96:99], v[240:243], v[128:131], a[96:99]
ds_read_b64_tr_b16 v[232:233], v250 offset:37376
ds_read_b64_tr_b16 v[234:235], v250 offset:39424
v_mfma_f32_16x16x32_bf16 a[96:99], v[244:247], v[144:147], a[96:99]
v_accvgpr_read_b32 v192, a64
v_accvgpr_read_b32 v193, a65
v_mfma_f32_16x16x32_bf16 a[100:103], v[240:243], v[132:135], a[100:103]
v_accvgpr_read_b32 v194, a66
v_accvgpr_read_b32 v195, a67
v_mfma_f32_16x16x32_bf16 a[100:103], v[244:247], v[148:151], a[100:103]
v_cvt_pk_bf16_f32 v24, v192, v193
v_cvt_pk_bf16_f32 v25, v194, v195
v_mfma_f32_16x16x32_bf16 a[104:107], v[240:243], v[136:139], a[104:107]
ds_read_b64_tr_b16 v[236:237], v250 offset:53760
ds_read_b64_tr_b16 v[238:239], v250 offset:55808
v_mfma_f32_16x16x32_bf16 a[104:107], v[244:247], v[152:155], a[104:107]
v_accvgpr_read_b32 v200, a68
v_accvgpr_read_b32 v201, a69
v_mfma_f32_16x16x32_bf16 a[108:111], v[240:243], v[140:143], a[108:111]
v_accvgpr_read_b32 v202, a70
v_accvgpr_read_b32 v203, a71
v_mfma_f32_16x16x32_bf16 a[108:111], v[244:247], v[156:159], a[108:111]
s_waitcnt lgkmcnt(4)
v_cvt_pk_bf16_f32 v56, v200, v201
v_mfma_f32_16x16x32_bf16 a[96:99], v[224:227], v[160:163], a[96:99]
ds_read_b64_tr_b16 v[240:241], v13 offset:4608
ds_read_b64_tr_b16 v[242:243], v13 offset:6656
v_mfma_f32_16x16x32_bf16 a[96:99], v[228:231], v[0:3], a[96:99]
v_cvt_pk_bf16_f32 v57, v202, v203
v_accvgpr_read_b32 v208, a72
v_mfma_f32_16x16x32_bf16 a[100:103], v[224:227], v[164:167], a[100:103]
v_accvgpr_read_b32 v209, a73
v_accvgpr_read_b32 v210, a74
v_mfma_f32_16x16x32_bf16 a[100:103], v[228:231], v[32:35], a[100:103]
v_accvgpr_read_b32 v211, a75
v_cvt_pk_bf16_f32 v88, v208, v209
v_mfma_f32_16x16x32_bf16 a[104:107], v[224:227], v[168:171], a[104:107]
ds_read_b64_tr_b16 v[244:245], v13 offset:20992
ds_read_b64_tr_b16 v[246:247], v13 offset:23040
v_mfma_f32_16x16x32_bf16 a[104:107], v[228:231], v[64:67], a[104:107]
v_cvt_pk_bf16_f32 v89, v210, v211
v_accvgpr_read_b32 v216, a76
v_mfma_f32_16x16x32_bf16 a[108:111], v[224:227], v[172:175], a[108:111]
v_accvgpr_read_b32 v217, a77
v_accvgpr_read_b32 v218, a78
v_mfma_f32_16x16x32_bf16 a[108:111], v[228:231], v[96:99], a[108:111]
s_waitcnt lgkmcnt(4)
v_accvgpr_read_b32 v219, a79
v_mfma_f32_16x16x32_bf16 a[112:115], v[232:235], v[4:7], a[112:115]
ds_read_b64_tr_b16 v[224:225], v13 offset:37376
ds_read_b64_tr_b16 v[226:227], v13 offset:39424
v_mfma_f32_16x16x32_bf16 a[112:115], v[236:239], v[176:179], a[112:115]
v_cvt_pk_bf16_f32 v120, v216, v217
v_cvt_pk_bf16_f32 v121, v218, v219
v_mfma_f32_16x16x32_bf16 a[116:119], v[232:235], v[36:39], a[116:119]
v_accvgpr_read_b32 v196, a80
v_accvgpr_read_b32 v197, a81
v_mfma_f32_16x16x32_bf16 a[116:119], v[236:239], v[180:183], a[116:119]
v_accvgpr_read_b32 v198, a82
v_accvgpr_read_b32 v199, a83
v_mfma_f32_16x16x32_bf16 a[120:123], v[232:235], v[68:71], a[120:123]
ds_read_b64_tr_b16 v[228:229], v13 offset:53760
ds_read_b64_tr_b16 v[230:231], v13 offset:55808
v_mfma_f32_16x16x32_bf16 a[120:123], v[236:239], v[184:187], a[120:123]
v_cvt_pk_bf16_f32 v26, v196, v197
v_cvt_pk_bf16_f32 v27, v198, v199
v_mfma_f32_16x16x32_bf16 a[124:127], v[232:235], v[100:103], a[124:127]
buffer_store_dwordx4 v[24:27], v252, s[20:23], s40 offen offset:2048 sc1
ds_write_b128 v255, v[24:27] offset:2048
v_mfma_f32_16x16x32_bf16 a[124:127], v[236:239], v[188:191], a[124:127]
s_waitcnt lgkmcnt(5)
v_accvgpr_read_b32 v204, a84
v_mfma_f32_16x16x32_bf16 a[112:115], v[240:243], v[128:131], a[112:115]
ds_read_b64_tr_b16 v[232:233], v249 offset:40960
ds_read_b64_tr_b16 v[234:235], v249 offset:43008
v_mfma_f32_16x16x32_bf16 a[112:115], v[244:247], v[144:147], a[112:115]
v_accvgpr_read_b32 v205, a85
v_accvgpr_read_b32 v206, a86
v_mfma_f32_16x16x32_bf16 a[116:119], v[240:243], v[132:135], a[116:119]
v_accvgpr_read_b32 v207, a87
v_cvt_pk_bf16_f32 v58, v204, v205
v_mfma_f32_16x16x32_bf16 a[116:119], v[244:247], v[148:151], a[116:119]
v_cvt_pk_bf16_f32 v59, v206, v207
buffer_store_dwordx4 v[56:59], v252, s[20:23], s41 offen offset:2048 sc1
v_mfma_f32_16x16x32_bf16 a[120:123], v[240:243], v[136:139], a[120:123]
ds_read_b64_tr_b16 v[236:237], v249 offset:57344
ds_read_b64_tr_b16 v[238:239], v249 offset:59392
v_mfma_f32_16x16x32_bf16 a[120:123], v[244:247], v[152:155], a[120:123]
v_accvgpr_read_b32 v212, a88
v_accvgpr_read_b32 v213, a89
v_mfma_f32_16x16x32_bf16 a[124:127], v[240:243], v[140:143], a[124:127]
v_accvgpr_read_b32 v214, a90
v_accvgpr_read_b32 v215, a91
v_mfma_f32_16x16x32_bf16 a[124:127], v[244:247], v[156:159], a[124:127]
s_waitcnt lgkmcnt(5)
v_cvt_pk_bf16_f32 v90, v212, v213
v_mfma_f32_16x16x32_bf16 a[112:115], v[224:227], v[160:163], a[112:115]
ds_read_b64_tr_b16 v[240:241], v12 offset:8192
ds_read_b64_tr_b16 v[242:243], v12 offset:10240
v_mfma_f32_16x16x32_bf16 a[112:115], v[228:231], v[0:3], a[112:115]
v_cvt_pk_bf16_f32 v91, v214, v215
buffer_store_dwordx4 v[88:91], v252, s[20:23], s42 offen offset:2048 sc1
v_mfma_f32_16x16x32_bf16 a[116:119], v[224:227], v[164:167], a[116:119]
v_accvgpr_read_b32 v220, a92
v_accvgpr_read_b32 v221, a93
v_mfma_f32_16x16x32_bf16 a[116:119], v[228:231], v[32:35], a[116:119]
v_accvgpr_read_b32 v222, a94
v_accvgpr_read_b32 v223, a95
v_mfma_f32_16x16x32_bf16 a[120:123], v[224:227], v[168:171], a[120:123]
ds_read_b64_tr_b16 v[244:245], v12 offset:24576
ds_read_b64_tr_b16 v[246:247], v12 offset:26624
v_mfma_f32_16x16x32_bf16 a[120:123], v[228:231], v[64:67], a[120:123]
v_cvt_pk_bf16_f32 v122, v220, v221
v_cvt_pk_bf16_f32 v123, v222, v223
v_mfma_f32_16x16x32_bf16 a[124:127], v[224:227], v[172:175], a[124:127]
buffer_store_dwordx4 v[120:123], v252, s[20:23], s43 offen offset:2048 sc1
v_accvgpr_read_b32 v192, a96
v_mfma_f32_16x16x32_bf16 a[124:127], v[228:231], v[96:99], a[124:127]
s_waitcnt lgkmcnt(4)
v_accvgpr_read_b32 v193, a97
v_mfma_f32_16x16x32_bf16 a[128:131], v[232:235], v[4:7], a[128:131]
ds_read_b64_tr_b16 v[224:225], v12 offset:40960
ds_read_b64_tr_b16 v[226:227], v12 offset:43008
v_mfma_f32_16x16x32_bf16 a[128:131], v[236:239], v[176:179], a[128:131]
v_accvgpr_read_b32 v194, a98
v_accvgpr_read_b32 v195, a99
v_mfma_f32_16x16x32_bf16 a[132:135], v[232:235], v[36:39], a[132:135]
v_cvt_pk_bf16_f32 v28, v192, v193
v_cvt_pk_bf16_f32 v29, v194, v195
v_mfma_f32_16x16x32_bf16 a[132:135], v[236:239], v[180:183], a[132:135]
v_accvgpr_read_b32 v200, a100
v_accvgpr_read_b32 v201, a101
v_mfma_f32_16x16x32_bf16 a[136:139], v[232:235], v[68:71], a[136:139]
ds_read_b64_tr_b16 v[228:229], v12 offset:57344
ds_read_b64_tr_b16 v[230:231], v12 offset:59392
v_mfma_f32_16x16x32_bf16 a[136:139], v[236:239], v[184:187], a[136:139]
v_accvgpr_read_b32 v202, a102
v_accvgpr_read_b32 v203, a103
v_mfma_f32_16x16x32_bf16 a[140:143], v[232:235], v[100:103], a[140:143]
v_cvt_pk_bf16_f32 v60, v200, v201
v_cvt_pk_bf16_f32 v61, v202, v203
v_mfma_f32_16x16x32_bf16 a[140:143], v[236:239], v[188:191], a[140:143]
s_waitcnt lgkmcnt(4)
v_accvgpr_read_b32 v208, a104
v_mfma_f32_16x16x32_bf16 a[128:131], v[240:243], v[128:131], a[128:131]
ds_read_b64_tr_b16 v[232:233], v250 offset:40960
ds_read_b64_tr_b16 v[234:235], v250 offset:43008
v_mfma_f32_16x16x32_bf16 a[128:131], v[244:247], v[144:147], a[128:131]
v_accvgpr_read_b32 v209, a105
v_accvgpr_read_b32 v210, a106
v_mfma_f32_16x16x32_bf16 a[132:135], v[240:243], v[132:135], a[132:135]
v_accvgpr_read_b32 v211, a107
v_cvt_pk_bf16_f32 v92, v208, v209
v_mfma_f32_16x16x32_bf16 a[132:135], v[244:247], v[148:151], a[132:135]
v_cvt_pk_bf16_f32 v93, v210, v211
v_accvgpr_read_b32 v216, a108
v_mfma_f32_16x16x32_bf16 a[136:139], v[240:243], v[136:139], a[136:139]
ds_read_b64_tr_b16 v[236:237], v250 offset:57344
ds_read_b64_tr_b16 v[238:239], v250 offset:59392
v_mfma_f32_16x16x32_bf16 a[136:139], v[244:247], v[152:155], a[136:139]
v_accvgpr_read_b32 v217, a109
v_accvgpr_read_b32 v218, a110
v_mfma_f32_16x16x32_bf16 a[140:143], v[240:243], v[140:143], a[140:143]
v_accvgpr_read_b32 v219, a111
v_cvt_pk_bf16_f32 v124, v216, v217
v_mfma_f32_16x16x32_bf16 a[140:143], v[244:247], v[156:159], a[140:143]
s_waitcnt lgkmcnt(4)
v_cvt_pk_bf16_f32 v125, v218, v219
v_mfma_f32_16x16x32_bf16 a[128:131], v[224:227], v[160:163], a[128:131]
ds_read_b64_tr_b16 v[240:241], v13 offset:8192
ds_read_b64_tr_b16 v[242:243], v13 offset:10240
v_mfma_f32_16x16x32_bf16 a[128:131], v[228:231], v[0:3], a[128:131]
v_accvgpr_read_b32 v196, a112
v_accvgpr_read_b32 v197, a113
v_mfma_f32_16x16x32_bf16 a[132:135], v[224:227], v[164:167], a[132:135]
v_accvgpr_read_b32 v198, a114
v_accvgpr_read_b32 v199, a115
v_mfma_f32_16x16x32_bf16 a[132:135], v[228:231], v[32:35], a[132:135]
v_cvt_pk_bf16_f32 v30, v196, v197
v_cvt_pk_bf16_f32 v31, v198, v199
v_mfma_f32_16x16x32_bf16 a[136:139], v[224:227], v[168:171], a[136:139]
ds_read_b64_tr_b16 v[244:245], v13 offset:24576
ds_read_b64_tr_b16 v[246:247], v13 offset:26624
v_mfma_f32_16x16x32_bf16 a[136:139], v[228:231], v[64:67], a[136:139]
buffer_store_dwordx4 v[28:31], v252, s[20:23], s40 offen offset:3072 sc1
ds_write_b128 v255, v[28:31] offset:3072
v_mfma_f32_16x16x32_bf16 a[140:143], v[224:227], v[172:175], a[140:143]
v_accvgpr_read_b32 v204, a116
v_accvgpr_read_b32 v205, a117
v_mfma_f32_16x16x32_bf16 a[140:143], v[228:231], v[96:99], a[140:143]
s_waitcnt lgkmcnt(5)
v_accvgpr_read_b32 v206, a118
v_mfma_f32_16x16x32_bf16 a[144:147], v[232:235], v[4:7], a[144:147]
ds_read_b64_tr_b16 v[224:225], v13 offset:40960
ds_read_b64_tr_b16 v[226:227], v13 offset:43008
v_mfma_f32_16x16x32_bf16 a[144:147], v[236:239], v[176:179], a[144:147]
v_accvgpr_read_b32 v207, a119
v_cvt_pk_bf16_f32 v62, v204, v205
v_mfma_f32_16x16x32_bf16 a[148:151], v[232:235], v[36:39], a[148:151]
v_cvt_pk_bf16_f32 v63, v206, v207
buffer_store_dwordx4 v[60:63], v252, s[20:23], s41 offen offset:3072 sc1
v_mfma_f32_16x16x32_bf16 a[148:151], v[236:239], v[180:183], a[148:151]
v_accvgpr_read_b32 v212, a120
v_accvgpr_read_b32 v213, a121
v_mfma_f32_16x16x32_bf16 a[152:155], v[232:235], v[68:71], a[152:155]
ds_read_b64_tr_b16 v[228:229], v13 offset:57344
ds_read_b64_tr_b16 v[230:231], v13 offset:59392
v_mfma_f32_16x16x32_bf16 a[152:155], v[236:239], v[184:187], a[152:155]
v_accvgpr_read_b32 v214, a122
v_accvgpr_read_b32 v215, a123
v_mfma_f32_16x16x32_bf16 a[156:159], v[232:235], v[100:103], a[156:159]
v_cvt_pk_bf16_f32 v94, v212, v213
v_cvt_pk_bf16_f32 v95, v214, v215
v_mfma_f32_16x16x32_bf16 a[156:159], v[236:239], v[188:191], a[156:159]
s_waitcnt lgkmcnt(5)
buffer_store_dwordx4 v[92:95], v252, s[20:23], s42 offen offset:3072 sc1
v_mfma_f32_16x16x32_bf16 a[144:147], v[240:243], v[128:131], a[144:147]
ds_read_b64_tr_b16 v[232:233], v249 offset:41472
ds_read_b64_tr_b16 v[234:235], v249 offset:43520
v_mfma_f32_16x16x32_bf16 a[144:147], v[244:247], v[144:147], a[144:147]
v_accvgpr_read_b32 v220, a124
v_accvgpr_read_b32 v221, a125
v_mfma_f32_16x16x32_bf16 a[148:151], v[240:243], v[132:135], a[148:151]
v_accvgpr_read_b32 v222, a126
v_accvgpr_read_b32 v223, a127
v_mfma_f32_16x16x32_bf16 a[148:151], v[244:247], v[148:151], a[148:151]
v_cvt_pk_bf16_f32 v126, v220, v221
v_cvt_pk_bf16_f32 v127, v222, v223
v_mfma_f32_16x16x32_bf16 a[152:155], v[240:243], v[136:139], a[152:155]
ds_read_b64_tr_b16 v[236:237], v249 offset:57856
ds_read_b64_tr_b16 v[238:239], v249 offset:59904
v_mfma_f32_16x16x32_bf16 a[152:155], v[244:247], v[152:155], a[152:155]
buffer_store_dwordx4 v[124:127], v252, s[20:23], s43 offen offset:3072 sc1
v_accvgpr_read_b32 v192, a128
v_mfma_f32_16x16x32_bf16 a[156:159], v[240:243], v[140:143], a[156:159]
v_accvgpr_read_b32 v193, a129
v_accvgpr_read_b32 v194, a130
v_mfma_f32_16x16x32_bf16 a[156:159], v[244:247], v[156:159], a[156:159]
s_waitcnt lgkmcnt(4)
v_accvgpr_read_b32 v195, a131
v_mfma_f32_16x16x32_bf16 a[144:147], v[224:227], v[160:163], a[144:147]
ds_read_b64_tr_b16 v[240:241], v12 offset:8704
ds_read_b64_tr_b16 v[242:243], v12 offset:10752
v_mfma_f32_16x16x32_bf16 a[144:147], v[228:231], v[0:3], a[144:147]
v_cvt_pk_bf16_f32 v16, v192, v193
v_cvt_pk_bf16_f32 v17, v194, v195
v_mfma_f32_16x16x32_bf16 a[148:151], v[224:227], v[164:167], a[148:151]
v_accvgpr_read_b32 v200, a132
v_accvgpr_read_b32 v201, a133
v_mfma_f32_16x16x32_bf16 a[148:151], v[228:231], v[32:35], a[148:151]
v_accvgpr_read_b32 v202, a134
v_accvgpr_read_b32 v203, a135
v_mfma_f32_16x16x32_bf16 a[152:155], v[224:227], v[168:171], a[152:155]
ds_read_b64_tr_b16 v[244:245], v12 offset:25088
ds_read_b64_tr_b16 v[246:247], v12 offset:27136
v_mfma_f32_16x16x32_bf16 a[152:155], v[228:231], v[64:67], a[152:155]
v_cvt_pk_bf16_f32 v48, v200, v201
v_cvt_pk_bf16_f32 v49, v202, v203
v_mfma_f32_16x16x32_bf16 a[156:159], v[224:227], v[172:175], a[156:159]
v_accvgpr_read_b32 v208, a136
v_accvgpr_read_b32 v209, a137
v_mfma_f32_16x16x32_bf16 a[156:159], v[228:231], v[96:99], a[156:159]
s_waitcnt lgkmcnt(4)
v_accvgpr_read_b32 v210, a138
v_mfma_f32_16x16x32_bf16 a[160:163], v[232:235], v[4:7], a[160:163]
ds_read_b64_tr_b16 v[224:225], v12 offset:41472
ds_read_b64_tr_b16 v[226:227], v12 offset:43520
v_mfma_f32_16x16x32_bf16 a[160:163], v[236:239], v[176:179], a[160:163]
v_accvgpr_read_b32 v211, a139
v_cvt_pk_bf16_f32 v80, v208, v209
v_mfma_f32_16x16x32_bf16 a[164:167], v[232:235], v[36:39], a[164:167]
v_cvt_pk_bf16_f32 v81, v210, v211
v_accvgpr_read_b32 v216, a140
v_mfma_f32_16x16x32_bf16 a[164:167], v[236:239], v[180:183], a[164:167]
v_accvgpr_read_b32 v217, a141
v_accvgpr_read_b32 v218, a142
v_mfma_f32_16x16x32_bf16 a[168:171], v[232:235], v[68:71], a[168:171]
ds_read_b64_tr_b16 v[228:229], v12 offset:57856
ds_read_b64_tr_b16 v[230:231], v12 offset:59904
v_mfma_f32_16x16x32_bf16 a[168:171], v[236:239], v[184:187], a[168:171]
v_accvgpr_read_b32 v219, a143
v_cvt_pk_bf16_f32 v112, v216, v217
v_mfma_f32_16x16x32_bf16 a[172:175], v[232:235], v[100:103], a[172:175]
v_cvt_pk_bf16_f32 v113, v218, v219
v_accvgpr_read_b32 v196, a144
v_mfma_f32_16x16x32_bf16 a[172:175], v[236:239], v[188:191], a[172:175]
s_waitcnt lgkmcnt(4)
v_accvgpr_read_b32 v197, a145
v_mfma_f32_16x16x32_bf16 a[160:163], v[240:243], v[128:131], a[160:163]
ds_read_b64_tr_b16 v[232:233], v250 offset:41472
ds_read_b64_tr_b16 v[234:235], v250 offset:43520
v_mfma_f32_16x16x32_bf16 a[160:163], v[244:247], v[144:147], a[160:163]
v_accvgpr_read_b32 v198, a146
v_accvgpr_read_b32 v199, a147
v_mfma_f32_16x16x32_bf16 a[164:167], v[240:243], v[132:135], a[164:167]
v_cvt_pk_bf16_f32 v18, v196, v197
v_cvt_pk_bf16_f32 v19, v198, v199
v_mfma_f32_16x16x32_bf16 a[164:167], v[244:247], v[148:151], a[164:167]
buffer_store_dwordx4 v[16:19], v252, s[20:23], s44 offen offset:0 sc1
v_accvgpr_read_b32 v204, a148
v_mfma_f32_16x16x32_bf16 a[168:171], v[240:243], v[136:139], a[168:171]
ds_read_b64_tr_b16 v[236:237], v250 offset:57856
ds_read_b64_tr_b16 v[238:239], v250 offset:59904
v_mfma_f32_16x16x32_bf16 a[168:171], v[244:247], v[152:155], a[168:171]
v_accvgpr_read_b32 v205, a149
v_accvgpr_read_b32 v206, a150
v_mfma_f32_16x16x32_bf16 a[172:175], v[240:243], v[140:143], a[172:175]
v_accvgpr_read_b32 v207, a151
v_cvt_pk_bf16_f32 v50, v204, v205
s_mov_b32 s33, 0x6c01400
v_mfma_f32_16x16x32_bf16 a[172:175], v[244:247], v[156:159], a[172:175]
s_waitcnt lgkmcnt(4)
v_cvt_pk_bf16_f32 v51, v206, v207
buffer_load_dword v254, off, s[56:59], s33 sc1
v_mfma_f32_16x16x32_bf16 a[160:163], v[224:227], v[160:163], a[160:163]
ds_read_b64_tr_b16 v[240:241], v13 offset:8704
ds_read_b64_tr_b16 v[242:243], v13 offset:10752
v_mfma_f32_16x16x32_bf16 a[160:163], v[228:231], v[0:3], a[160:163]
buffer_store_dwordx4 v[48:51], v252, s[20:23], s45 offen offset:0 sc1
v_accvgpr_read_b32 v212, a152
v_mfma_f32_16x16x32_bf16 a[164:167], v[224:227], v[164:167], a[164:167]
v_accvgpr_read_b32 v213, a153
v_accvgpr_read_b32 v214, a154
v_mfma_f32_16x16x32_bf16 a[164:167], v[228:231], v[32:35], a[164:167]
v_accvgpr_read_b32 v215, a155
v_cvt_pk_bf16_f32 v82, v212, v213
v_mfma_f32_16x16x32_bf16 a[168:171], v[224:227], v[168:171], a[168:171]
ds_read_b64_tr_b16 v[244:245], v13 offset:25088
ds_read_b64_tr_b16 v[246:247], v13 offset:27136
v_mfma_f32_16x16x32_bf16 a[168:171], v[228:231], v[64:67], a[168:171]
v_cvt_pk_bf16_f32 v83, v214, v215
buffer_store_dwordx4 v[80:83], v252, s[20:23], s46 offen offset:0 sc1
v_mfma_f32_16x16x32_bf16 a[172:175], v[224:227], v[172:175], a[172:175]
v_accvgpr_read_b32 v220, a156
v_accvgpr_read_b32 v221, a157
v_mfma_f32_16x16x32_bf16 a[172:175], v[228:231], v[96:99], a[172:175]
s_waitcnt lgkmcnt(4)
v_accvgpr_read_b32 v222, a158
v_mfma_f32_16x16x32_bf16 a[176:179], v[232:235], v[4:7], a[176:179]
ds_read_b64_tr_b16 v[224:225], v13 offset:41472
ds_read_b64_tr_b16 v[226:227], v13 offset:43520
v_mfma_f32_16x16x32_bf16 a[176:179], v[236:239], v[176:179], a[176:179]
v_accvgpr_read_b32 v223, a159
v_cvt_pk_bf16_f32 v114, v220, v221
v_mfma_f32_16x16x32_bf16 a[180:183], v[232:235], v[36:39], a[180:183]
v_cvt_pk_bf16_f32 v115, v222, v223
buffer_store_dwordx4 v[112:115], v252, s[20:23], s47 offen offset:0 sc1
v_mfma_f32_16x16x32_bf16 a[180:183], v[236:239], v[180:183], a[180:183]
v_accvgpr_read_b32 v192, a160
v_accvgpr_read_b32 v193, a161
v_mfma_f32_16x16x32_bf16 a[184:187], v[232:235], v[68:71], a[184:187]
ds_read_b64_tr_b16 v[228:229], v13 offset:57856
ds_read_b64_tr_b16 v[230:231], v13 offset:59904
v_mfma_f32_16x16x32_bf16 a[184:187], v[236:239], v[184:187], a[184:187]
v_accvgpr_read_b32 v194, a162
v_accvgpr_read_b32 v195, a163
v_mfma_f32_16x16x32_bf16 a[188:191], v[232:235], v[100:103], a[188:191]
v_cvt_pk_bf16_f32 v20, v192, v193
v_cvt_pk_bf16_f32 v21, v194, v195
v_mfma_f32_16x16x32_bf16 a[188:191], v[236:239], v[188:191], a[188:191]
s_waitcnt lgkmcnt(4)
v_accvgpr_read_b32 v200, a164
v_mfma_f32_16x16x32_bf16 a[176:179], v[240:243], v[128:131], a[176:179]
ds_read_b64_tr_b16 v[232:233], v249 offset:45056
ds_read_b64_tr_b16 v[234:235], v249 offset:47104
v_mfma_f32_16x16x32_bf16 a[176:179], v[244:247], v[144:147], a[176:179]
v_accvgpr_read_b32 v201, a165
v_accvgpr_read_b32 v202, a166
v_mfma_f32_16x16x32_bf16 a[180:183], v[240:243], v[132:135], a[180:183]
v_accvgpr_read_b32 v203, a167
v_cvt_pk_bf16_f32 v52, v200, v201
v_mfma_f32_16x16x32_bf16 a[180:183], v[244:247], v[148:151], a[180:183]
v_cvt_pk_bf16_f32 v53, v202, v203
v_accvgpr_read_b32 v208, a168
v_mfma_f32_16x16x32_bf16 a[184:187], v[240:243], v[136:139], a[184:187]
ds_read_b64_tr_b16 v[236:237], v249 offset:61440
ds_read_b64_tr_b16 v[238:239], v249 offset:63488
v_mfma_f32_16x16x32_bf16 a[184:187], v[244:247], v[152:155], a[184:187]
v_accvgpr_read_b32 v209, a169
v_accvgpr_read_b32 v210, a170
v_mfma_f32_16x16x32_bf16 a[188:191], v[240:243], v[140:143], a[188:191]
v_accvgpr_read_b32 v211, a171
v_cvt_pk_bf16_f32 v84, v208, v209
v_mfma_f32_16x16x32_bf16 a[188:191], v[244:247], v[156:159], a[188:191]
s_waitcnt lgkmcnt(4)
v_cvt_pk_bf16_f32 v85, v210, v211
v_mfma_f32_16x16x32_bf16 a[176:179], v[224:227], v[160:163], a[176:179]
ds_read_b64_tr_b16 v[240:241], v12 offset:12288
ds_read_b64_tr_b16 v[242:243], v12 offset:14336
v_mfma_f32_16x16x32_bf16 a[176:179], v[228:231], v[0:3], a[176:179]
v_accvgpr_read_b32 v216, a172
v_accvgpr_read_b32 v217, a173
v_mfma_f32_16x16x32_bf16 a[180:183], v[224:227], v[164:167], a[180:183]
v_accvgpr_read_b32 v218, a174
v_accvgpr_read_b32 v219, a175
v_mfma_f32_16x16x32_bf16 a[180:183], v[228:231], v[32:35], a[180:183]
v_cvt_pk_bf16_f32 v116, v216, v217
v_cvt_pk_bf16_f32 v117, v218, v219
v_mfma_f32_16x16x32_bf16 a[184:187], v[224:227], v[168:171], a[184:187]
ds_read_b64_tr_b16 v[244:245], v12 offset:28672
ds_read_b64_tr_b16 v[246:247], v12 offset:30720
v_mfma_f32_16x16x32_bf16 a[184:187], v[228:231], v[64:67], a[184:187]
v_mfma_f32_16x16x32_bf16 a[188:191], v[224:227], v[172:175], a[188:191]
v_accvgpr_read_b32 v196, a176
v_accvgpr_read_b32 v197, a177
v_mfma_f32_16x16x32_bf16 a[188:191], v[228:231], v[96:99], a[188:191]
s_waitcnt lgkmcnt(4)
v_accvgpr_read_b32 v198, a178
v_mfma_f32_16x16x32_bf16 a[192:195], v[232:235], v[4:7], a[192:195]
ds_read_b64_tr_b16 v[224:225], v12 offset:45056
ds_read_b64_tr_b16 v[226:227], v12 offset:47104
v_mfma_f32_16x16x32_bf16 a[192:195], v[236:239], v[176:179], a[192:195]
v_accvgpr_read_b32 v199, a179
v_cvt_pk_bf16_f32 v22, v196, v197
v_mfma_f32_16x16x32_bf16 a[196:199], v[232:235], v[36:39], a[196:199]
v_cvt_pk_bf16_f32 v23, v198, v199
buffer_store_dwordx4 v[20:23], v252, s[20:23], s44 offen offset:1024 sc1
v_mfma_f32_16x16x32_bf16 a[196:199], v[236:239], v[180:183], a[196:199]
v_accvgpr_read_b32 v204, a180
v_accvgpr_read_b32 v205, a181
v_mfma_f32_16x16x32_bf16 a[200:203], v[232:235], v[68:71], a[200:203]
ds_read_b64_tr_b16 v[228:229], v12 offset:61440
ds_read_b64_tr_b16 v[230:231], v12 offset:63488
v_mfma_f32_16x16x32_bf16 a[200:203], v[236:239], v[184:187], a[200:203]
v_accvgpr_read_b32 v206, a182
v_accvgpr_read_b32 v207, a183
v_mfma_f32_16x16x32_bf16 a[204:207], v[232:235], v[100:103], a[204:207]
v_cvt_pk_bf16_f32 v54, v204, v205
v_cvt_pk_bf16_f32 v55, v206, v207
v_mfma_f32_16x16x32_bf16 a[204:207], v[236:239], v[188:191], a[204:207]
s_waitcnt lgkmcnt(4)
buffer_store_dwordx4 v[52:55], v252, s[20:23], s45 offen offset:1024 sc1
v_mfma_f32_16x16x32_bf16 a[192:195], v[240:243], v[128:131], a[192:195]
ds_read_b64_tr_b16 v[232:233], v250 offset:45056
ds_read_b64_tr_b16 v[234:235], v250 offset:47104
v_mfma_f32_16x16x32_bf16 a[192:195], v[244:247], v[144:147], a[192:195]
v_accvgpr_read_b32 v212, a184
v_accvgpr_read_b32 v213, a185
v_mfma_f32_16x16x32_bf16 a[196:199], v[240:243], v[132:135], a[196:199]
v_accvgpr_read_b32 v214, a186
v_accvgpr_read_b32 v215, a187
v_mfma_f32_16x16x32_bf16 a[196:199], v[244:247], v[148:151], a[196:199]
v_cvt_pk_bf16_f32 v86, v212, v213
v_cvt_pk_bf16_f32 v87, v214, v215
v_mfma_f32_16x16x32_bf16 a[200:203], v[240:243], v[136:139], a[200:203]
ds_read_b64_tr_b16 v[236:237], v250 offset:61440
ds_read_b64_tr_b16 v[238:239], v250 offset:63488
v_mfma_f32_16x16x32_bf16 a[200:203], v[244:247], v[152:155], a[200:203]
buffer_store_dwordx4 v[84:87], v252, s[20:23], s46 offen offset:1024 sc1
v_accvgpr_read_b32 v220, a188
v_mfma_f32_16x16x32_bf16 a[204:207], v[240:243], v[140:143], a[204:207]
v_accvgpr_read_b32 v221, a189
v_accvgpr_read_b32 v222, a190
v_mfma_f32_16x16x32_bf16 a[204:207], v[244:247], v[156:159], a[204:207]
s_waitcnt lgkmcnt(4)
v_accvgpr_read_b32 v223, a191
v_mfma_f32_16x16x32_bf16 a[192:195], v[224:227], v[160:163], a[192:195]
ds_read_b64_tr_b16 v[240:241], v13 offset:12288
ds_read_b64_tr_b16 v[242:243], v13 offset:14336
v_mfma_f32_16x16x32_bf16 a[192:195], v[228:231], v[0:3], a[192:195]
v_cvt_pk_bf16_f32 v118, v220, v221
v_cvt_pk_bf16_f32 v119, v222, v223
v_mfma_f32_16x16x32_bf16 a[196:199], v[224:227], v[164:167], a[196:199]
buffer_store_dwordx4 v[116:119], v252, s[20:23], s47 offen offset:1024 sc1
v_mfma_f32_16x16x32_bf16 a[196:199], v[228:231], v[32:35], a[196:199]
v_mfma_f32_16x16x32_bf16 a[200:203], v[224:227], v[168:171], a[200:203]
ds_read_b64_tr_b16 v[244:245], v13 offset:28672
ds_read_b64_tr_b16 v[246:247], v13 offset:30720
v_mfma_f32_16x16x32_bf16 a[200:203], v[228:231], v[64:67], a[200:203]
v_mfma_f32_16x16x32_bf16 a[204:207], v[224:227], v[172:175], a[204:207]
v_accvgpr_read_b32 v192, a192
v_accvgpr_read_b32 v193, a193
v_mfma_f32_16x16x32_bf16 a[204:207], v[228:231], v[96:99], a[204:207]
s_waitcnt lgkmcnt(4)
v_accvgpr_read_b32 v194, a194
v_mfma_f32_16x16x32_bf16 a[208:211], v[232:235], v[4:7], a[208:211]
ds_read_b64_tr_b16 v[224:225], v13 offset:45056
ds_read_b64_tr_b16 v[226:227], v13 offset:47104
v_mfma_f32_16x16x32_bf16 a[208:211], v[236:239], v[176:179], a[208:211]
v_accvgpr_read_b32 v195, a195
v_cvt_pk_bf16_f32 v24, v192, v193
v_mfma_f32_16x16x32_bf16 a[212:215], v[232:235], v[36:39], a[212:215]
v_cvt_pk_bf16_f32 v25, v194, v195
v_accvgpr_read_b32 v200, a196
v_mfma_f32_16x16x32_bf16 a[212:215], v[236:239], v[180:183], a[212:215]
v_accvgpr_read_b32 v201, a197
v_accvgpr_read_b32 v202, a198
v_mfma_f32_16x16x32_bf16 a[216:219], v[232:235], v[68:71], a[216:219]
ds_read_b64_tr_b16 v[228:229], v13 offset:61440
ds_read_b64_tr_b16 v[230:231], v13 offset:63488
v_mfma_f32_16x16x32_bf16 a[216:219], v[236:239], v[184:187], a[216:219]
v_accvgpr_read_b32 v203, a199
v_cvt_pk_bf16_f32 v56, v200, v201
v_mfma_f32_16x16x32_bf16 a[220:223], v[232:235], v[100:103], a[220:223]
v_cvt_pk_bf16_f32 v57, v202, v203
v_accvgpr_read_b32 v208, a200
v_mfma_f32_16x16x32_bf16 a[220:223], v[236:239], v[188:191], a[220:223]
s_waitcnt lgkmcnt(4)
v_accvgpr_read_b32 v209, a201
v_mfma_f32_16x16x32_bf16 a[208:211], v[240:243], v[128:131], a[208:211]
ds_read_b64_tr_b16 v[232:233], v249 offset:45568
ds_read_b64_tr_b16 v[234:235], v249 offset:47616
v_mfma_f32_16x16x32_bf16 a[208:211], v[244:247], v[144:147], a[208:211]
v_accvgpr_read_b32 v210, a202
v_accvgpr_read_b32 v211, a203
v_mfma_f32_16x16x32_bf16 a[212:215], v[240:243], v[132:135], a[212:215]
v_cvt_pk_bf16_f32 v88, v208, v209
v_cvt_pk_bf16_f32 v89, v210, v211
v_mfma_f32_16x16x32_bf16 a[212:215], v[244:247], v[148:151], a[212:215]
v_accvgpr_read_b32 v216, a204
v_accvgpr_read_b32 v217, a205
v_mfma_f32_16x16x32_bf16 a[216:219], v[240:243], v[136:139], a[216:219]
ds_read_b64_tr_b16 v[236:237], v249 offset:61952
ds_read_b64_tr_b16 v[238:239], v249 offset:64000
v_mfma_f32_16x16x32_bf16 a[216:219], v[244:247], v[152:155], a[216:219]
v_accvgpr_read_b32 v218, a206
v_accvgpr_read_b32 v219, a207
v_mfma_f32_16x16x32_bf16 a[220:223], v[240:243], v[140:143], a[220:223]
v_cvt_pk_bf16_f32 v120, v216, v217
v_cvt_pk_bf16_f32 v121, v218, v219
v_mfma_f32_16x16x32_bf16 a[220:223], v[244:247], v[156:159], a[220:223]
s_waitcnt lgkmcnt(4)
v_mfma_f32_16x16x32_bf16 a[208:211], v[224:227], v[160:163], a[208:211]
ds_read_b64_tr_b16 v[240:241], v12 offset:12800
ds_read_b64_tr_b16 v[242:243], v12 offset:14848
v_mfma_f32_16x16x32_bf16 a[208:211], v[228:231], v[0:3], a[208:211]
v_mfma_f32_16x16x32_bf16 a[212:215], v[224:227], v[164:167], a[212:215]
v_mfma_f32_16x16x32_bf16 a[212:215], v[228:231], v[32:35], a[212:215]
v_mfma_f32_16x16x32_bf16 a[216:219], v[224:227], v[168:171], a[216:219]
ds_read_b64_tr_b16 v[244:245], v12 offset:29184
ds_read_b64_tr_b16 v[246:247], v12 offset:31232
v_mfma_f32_16x16x32_bf16 a[216:219], v[228:231], v[64:67], a[216:219]
v_mfma_f32_16x16x32_bf16 a[220:223], v[224:227], v[172:175], a[220:223]
s_nop 0
v_accvgpr_read_b32 v196, a208
v_accvgpr_read_b32 v197, a209
v_mfma_f32_16x16x32_bf16 a[220:223], v[228:231], v[96:99], a[220:223]
s_waitcnt lgkmcnt(4)
v_accvgpr_read_b32 v198, a210
v_mfma_f32_16x16x32_bf16 a[224:227], v[232:235], v[4:7], a[224:227]
ds_read_b64_tr_b16 v[224:225], v12 offset:45568
ds_read_b64_tr_b16 v[226:227], v12 offset:47616
v_mfma_f32_16x16x32_bf16 a[224:227], v[236:239], v[176:179], a[224:227]
v_accvgpr_read_b32 v199, a211
v_cvt_pk_bf16_f32 v26, v196, v197
v_mfma_f32_16x16x32_bf16 a[228:231], v[232:235], v[36:39], a[228:231]
v_cvt_pk_bf16_f32 v27, v198, v199
buffer_store_dwordx4 v[24:27], v252, s[20:23], s44 offen offset:2048 sc1
v_mfma_f32_16x16x32_bf16 a[228:231], v[236:239], v[180:183], a[228:231]
v_accvgpr_read_b32 v204, a212
v_accvgpr_read_b32 v205, a213
v_mfma_f32_16x16x32_bf16 a[232:235], v[232:235], v[68:71], a[232:235]
ds_read_b64_tr_b16 v[228:229], v12 offset:61952
ds_read_b64_tr_b16 v[230:231], v12 offset:64000
v_mfma_f32_16x16x32_bf16 a[232:235], v[236:239], v[184:187], a[232:235]
v_accvgpr_read_b32 v206, a214
v_accvgpr_read_b32 v207, a215
v_mfma_f32_16x16x32_bf16 a[236:239], v[232:235], v[100:103], a[236:239]
v_cvt_pk_bf16_f32 v58, v204, v205
v_cvt_pk_bf16_f32 v59, v206, v207
v_mfma_f32_16x16x32_bf16 a[236:239], v[236:239], v[188:191], a[236:239]
s_waitcnt lgkmcnt(4)
buffer_store_dwordx4 v[56:59], v252, s[20:23], s45 offen offset:2048 sc1
v_mfma_f32_16x16x32_bf16 a[224:227], v[240:243], v[128:131], a[224:227]
ds_read_b64_tr_b16 v[232:233], v250 offset:45568
ds_read_b64_tr_b16 v[234:235], v250 offset:47616
v_mfma_f32_16x16x32_bf16 a[224:227], v[244:247], v[144:147], a[224:227]
v_accvgpr_read_b32 v212, a216
v_accvgpr_read_b32 v213, a217
v_mfma_f32_16x16x32_bf16 a[228:231], v[240:243], v[132:135], a[228:231]
v_accvgpr_read_b32 v214, a218
v_accvgpr_read_b32 v215, a219
v_mfma_f32_16x16x32_bf16 a[228:231], v[244:247], v[148:151], a[228:231]
v_cvt_pk_bf16_f32 v90, v212, v213
v_cvt_pk_bf16_f32 v91, v214, v215
v_mfma_f32_16x16x32_bf16 a[232:235], v[240:243], v[136:139], a[232:235]
ds_read_b64_tr_b16 v[236:237], v250 offset:61952
ds_read_b64_tr_b16 v[238:239], v250 offset:64000
v_mfma_f32_16x16x32_bf16 a[232:235], v[244:247], v[152:155], a[232:235]
buffer_store_dwordx4 v[88:91], v252, s[20:23], s46 offen offset:2048 sc1
v_accvgpr_read_b32 v220, a220
v_mfma_f32_16x16x32_bf16 a[236:239], v[240:243], v[140:143], a[236:239]
v_accvgpr_read_b32 v221, a221
v_accvgpr_read_b32 v222, a222
v_mfma_f32_16x16x32_bf16 a[236:239], v[244:247], v[156:159], a[236:239]
s_waitcnt lgkmcnt(4)
v_accvgpr_read_b32 v223, a223
v_mfma_f32_16x16x32_bf16 a[224:227], v[224:227], v[160:163], a[224:227]
ds_read_b64_tr_b16 v[240:241], v13 offset:12800
ds_read_b64_tr_b16 v[242:243], v13 offset:14848
v_mfma_f32_16x16x32_bf16 a[224:227], v[228:231], v[0:3], a[224:227]
v_cvt_pk_bf16_f32 v122, v220, v221
v_cvt_pk_bf16_f32 v123, v222, v223
v_mfma_f32_16x16x32_bf16 a[228:231], v[224:227], v[164:167], a[228:231]
buffer_store_dwordx4 v[120:123], v252, s[20:23], s47 offen offset:2048 sc1
v_mfma_f32_16x16x32_bf16 a[228:231], v[228:231], v[32:35], a[228:231]
v_mfma_f32_16x16x32_bf16 a[232:235], v[224:227], v[168:171], a[232:235]
ds_read_b64_tr_b16 v[244:245], v13 offset:29184
ds_read_b64_tr_b16 v[246:247], v13 offset:31232
v_mfma_f32_16x16x32_bf16 a[232:235], v[228:231], v[64:67], a[232:235]
v_mfma_f32_16x16x32_bf16 a[236:239], v[224:227], v[172:175], a[236:239]
v_accvgpr_read_b32 v192, a224
v_accvgpr_read_b32 v193, a225
v_mfma_f32_16x16x32_bf16 a[236:239], v[228:231], v[96:99], a[236:239]
s_waitcnt lgkmcnt(4)
v_accvgpr_read_b32 v194, a226
v_mfma_f32_16x16x32_bf16 a[240:243], v[232:235], v[4:7], a[240:243]
ds_read_b64_tr_b16 v[224:225], v13 offset:45568
ds_read_b64_tr_b16 v[226:227], v13 offset:47616
v_mfma_f32_16x16x32_bf16 a[240:243], v[236:239], v[176:179], a[240:243]
v_accvgpr_read_b32 v195, a227
v_cvt_pk_bf16_f32 v28, v192, v193
v_mfma_f32_16x16x32_bf16 a[244:247], v[232:235], v[36:39], a[244:247]
v_cvt_pk_bf16_f32 v29, v194, v195
v_accvgpr_read_b32 v200, a228
v_mfma_f32_16x16x32_bf16 a[244:247], v[236:239], v[180:183], a[244:247]
v_accvgpr_read_b32 v201, a229
v_accvgpr_read_b32 v202, a230
v_mfma_f32_16x16x32_bf16 a[248:251], v[232:235], v[68:71], a[248:251]
ds_read_b64_tr_b16 v[228:229], v13 offset:61952
ds_read_b64_tr_b16 v[230:231], v13 offset:64000
v_mfma_f32_16x16x32_bf16 a[248:251], v[236:239], v[184:187], a[248:251]
v_accvgpr_read_b32 v203, a231
v_cvt_pk_bf16_f32 v60, v200, v201
v_mfma_f32_16x16x32_bf16 a[252:255], v[232:235], v[100:103], a[252:255]
v_cvt_pk_bf16_f32 v61, v202, v203
v_accvgpr_read_b32 v208, a232
v_mfma_f32_16x16x32_bf16 a[252:255], v[236:239], v[188:191], a[252:255]
s_waitcnt lgkmcnt(4)
v_accvgpr_read_b32 v209, a233
v_mfma_f32_16x16x32_bf16 a[240:243], v[240:243], v[128:131], a[240:243]
v_accvgpr_read_b32 v210, a234
v_accvgpr_read_b32 v211, a235
v_mfma_f32_16x16x32_bf16 a[240:243], v[244:247], v[144:147], a[240:243]
v_cvt_pk_bf16_f32 v92, v208, v209
v_cvt_pk_bf16_f32 v93, v210, v211
v_mfma_f32_16x16x32_bf16 a[244:247], v[240:243], v[132:135], a[244:247]
v_accvgpr_read_b32 v216, a236
v_accvgpr_read_b32 v217, a237
v_mfma_f32_16x16x32_bf16 a[244:247], v[244:247], v[148:151], a[244:247]
v_accvgpr_read_b32 v218, a238
v_accvgpr_read_b32 v219, a239
v_mfma_f32_16x16x32_bf16 a[248:251], v[240:243], v[136:139], a[248:251]
v_cvt_pk_bf16_f32 v124, v216, v217
v_cvt_pk_bf16_f32 v125, v218, v219
v_mfma_f32_16x16x32_bf16 a[248:251], v[244:247], v[152:155], a[248:251]
v_mfma_f32_16x16x32_bf16 a[252:255], v[240:243], v[140:143], a[252:255]
v_mfma_f32_16x16x32_bf16 a[252:255], v[244:247], v[156:159], a[252:255]
s_waitcnt lgkmcnt(0)
v_mfma_f32_16x16x32_bf16 a[240:243], v[224:227], v[160:163], a[240:243]
v_mfma_f32_16x16x32_bf16 a[240:243], v[228:231], v[0:3], a[240:243]
v_mfma_f32_16x16x32_bf16 a[244:247], v[224:227], v[164:167], a[244:247]
v_mfma_f32_16x16x32_bf16 a[244:247], v[228:231], v[32:35], a[244:247]
v_mfma_f32_16x16x32_bf16 a[248:251], v[224:227], v[168:171], a[248:251]
v_mfma_f32_16x16x32_bf16 a[248:251], v[228:231], v[64:67], a[248:251]
v_mfma_f32_16x16x32_bf16 a[252:255], v[224:227], v[172:175], a[252:255]
s_nop 2
v_accvgpr_read_b32 v196, a240
v_accvgpr_read_b32 v197, a241
v_accvgpr_read_b32 v198, a242
v_accvgpr_read_b32 v199, a243
v_mfma_f32_16x16x32_bf16 a[252:255], v[228:231], v[96:99], a[252:255]
v_cvt_pk_bf16_f32 v30, v196, v197
v_cvt_pk_bf16_f32 v31, v198, v199
buffer_store_dwordx4 v[28:31], v252, s[20:23], s44 offen offset:3072 sc1
v_accvgpr_read_b32 v204, a244
v_accvgpr_read_b32 v205, a245
v_accvgpr_read_b32 v206, a246
v_accvgpr_read_b32 v207, a247
v_cvt_pk_bf16_f32 v62, v204, v205
v_cvt_pk_bf16_f32 v63, v206, v207
buffer_store_dwordx4 v[60:63], v252, s[20:23], s45 offen offset:3072 sc1
v_accvgpr_read_b32 v212, a248
v_accvgpr_read_b32 v213, a249
v_accvgpr_read_b32 v214, a250
v_accvgpr_read_b32 v215, a251
v_cvt_pk_bf16_f32 v94, v212, v213
v_cvt_pk_bf16_f32 v95, v214, v215
buffer_store_dwordx4 v[92:95], v252, s[20:23], s46 offen offset:3072 sc1
v_accvgpr_read_b32 v220, a252
v_accvgpr_read_b32 v221, a253
v_accvgpr_read_b32 v222, a254
v_accvgpr_read_b32 v223, a255
v_cvt_pk_bf16_f32 v126, v220, v221
v_cvt_pk_bf16_f32 v127, v222, v223
buffer_store_dwordx4 v[124:127], v252, s[20:23], s47 offen offset:3072 sc1
s_waitcnt vmcnt(15)
v_readfirstlane_b32 s99, v254
s_branch L2_chk
L2_tail_1_7:
s_waitcnt lgkmcnt(4)
v_mfma_f32_16x16x32_bf16 a[0:3], v[224:227], v[160:163], a[0:3]
ds_read_b128 v[240:243], v248 offset:2048
v_mfma_f32_16x16x32_bf16 a[0:3], v[228:231], v[176:179], a[0:3]
s_lshl_b32 s36, s34, 13
v_mfma_f32_16x16x32_bf16 a[4:7], v[224:227], v[164:167], a[4:7]
s_add_u32 s56, s4, 0x1000000
s_addc_u32 s57, s5, 0
v_mfma_f32_16x16x32_bf16 a[4:7], v[228:231], v[180:183], a[4:7]
s_add_u32 s36, s36, 0x20000
s_mov_b32 s58, 0x6c02000
v_mfma_f32_16x16x32_bf16 a[8:11], v[224:227], v[168:171], a[8:11]
ds_read_b128 v[244:247], v248 offset:2560
s_mov_b32 s59, 0x00020000
v_mfma_f32_16x16x32_bf16 a[8:11], v[228:231], v[184:187], a[8:11]
v_add_u32 v255, s36, v252
s_lshr_b32 s35, s2, 1
v_mfma_f32_16x16x32_bf16 a[12:15], v[224:227], v[172:175], a[12:15]
s_and_b32 s35, s35, 28
s_add_u32 s35, s35, s34
v_mfma_f32_16x16x32_bf16 a[12:15], v[228:231], v[188:191], a[12:15]
s_waitcnt lgkmcnt(2)
s_lshl_b32 s35, s35, 13
v_mfma_f32_16x16x32_bf16 a[16:19], v[232:235], v[160:163], a[16:19]
ds_read_b128 v[224:227], v248 offset:6144
v_lshlrev_b32 v253, 3, v252
v_mfma_f32_16x16x32_bf16 a[16:19], v[236:239], v[176:179], a[16:19]
buffer_load_dword v253, v253, s[56:59], s35 offen
ds_write_b128 v255, v[160:163] offset:0
v_mfma_f32_16x16x32_bf16 a[20:23], v[232:235], v[164:167], a[20:23]
v_exp_f32 v192, v192
v_mfma_f32_16x16x32_bf16 a[20:23], v[236:239], v[180:183], a[20:23]
v_exp_f32 v193, v193
v_mfma_f32_16x16x32_bf16 a[24:27], v[232:235], v[168:171], a[24:27]
ds_read_b128 v[228:231], v248 offset:6656
v_cvt_pk_bf16_f32 v128, v192, v193
v_mfma_f32_16x16x32_bf16 a[24:27], v[236:239], v[184:187], a[24:27]
v_exp_f32 v194, v194
v_mfma_f32_16x16x32_bf16 a[28:31], v[232:235], v[172:175], a[28:31]
v_exp_f32 v195, v195
v_mfma_f32_16x16x32_bf16 a[28:31], v[236:239], v[188:191], a[28:31]
s_waitcnt lgkmcnt(3)
v_cvt_pk_bf16_f32 v129, v194, v195
v_mfma_f32_16x16x32_bf16 v[208:211], v[240:243], v[0:3], 0
ds_read_b128 v[232:235], v248 offset:10240
ds_write_b128 v255, v[164:167] offset:1024
v_mfma_f32_16x16x32_bf16 v[208:211], v[244:247], v[4:7], v[208:211]
v_exp_f32 v196, v196
v_mfma_f32_16x16x32_bf16 v[212:215], v[240:243], v[32:35], 0
v_exp_f32 v197, v197
v_mfma_f32_16x16x32_bf16 v[212:215], v[244:247], v[36:39], v[212:215]
v_exp_f32 v198, v198
v_mfma_f32_16x16x32_bf16 v[216:219], v[240:243], v[64:67], 0
ds_read_b128 v[236:239], v248 offset:10752
v_cvt_pk_bf16_f32 v132, v196, v197
v_mfma_f32_16x16x32_bf16 v[216:219], v[244:247], v[68:71], v[216:219]
v_exp_f32 v199, v199
v_mfma_f32_16x16x32_bf16 v[220:223], v[240:243], v[96:99], 0
v_exp_f32 v200, v200
v_mfma_f32_16x16x32_bf16 v[220:223], v[244:247], v[100:103], v[220:223]
s_waitcnt lgkmcnt(3)
v_cvt_pk_bf16_f32 v133, v198, v199
v_mfma_f32_16x16x32_bf16 v[208:211], v[224:227], v[8:11], v[208:211]
ds_read_b128 v[240:243], v248 offset:14336
ds_write_b128 v255, v[168:171] offset:2048
v_mfma_f32_16x16x32_bf16 v[208:211], v[228:231], v[12:15], v[208:211]
v_exp_f32 v201, v201
v_mfma_f32_16x16x32_bf16 v[212:215], v[224:227], v[40:43], v[212:215]
v_exp_f32 v202, v202
v_mfma_f32_16x16x32_bf16 v[212:215], v[228:231], v[44:47], v[212:215]
v_exp_f32 v203, v203
v_mfma_f32_16x16x32_bf16 v[216:219], v[224:227], v[72:75], v[216:219]
ds_read_b128 v[244:247], v248 offset:14848
v_cvt_pk_bf16_f32 v136, v200, v201
v_mfma_f32_16x16x32_bf16 v[216:219], v[228:231], v[76:79], v[216:219]
v_cvt_pk_bf16_f32 v137, v202, v203
ds_write_b128 v255, v[172:175] offset:3072
v_mfma_f32_16x16x32_bf16 v[220:223], v[224:227], v[104:107], v[220:223]
v_exp_f32 v204, v204
v_mfma_f32_16x16x32_bf16 v[220:223], v[228:231], v[108:111], v[220:223]
s_waitcnt lgkmcnt(4)
s_waitcnt vmcnt(1)
s_barrier
v_mfma_f32_16x16x32_bf16 v[208:211], v[232:235], v[16:19], v[208:211]
ds_read_b128 v[224:227], v248 offset:16384
s_add_u32 m0, s30, 0xc000
v_mfma_f32_16x16x32_bf16 v[208:211], v[236:239], v[20:23], v[208:211]
s_and_b32 s100, s30, 0x10000
buffer_load_dwordx4 v251, s[12:15], s28 offen offset:0 lds
v_mfma_f32_16x16x32_bf16 v[212:215], v[232:235], v[48:51], v[212:215]
s_xor_b32 s100, s100, 0x10000
ds_write_b128 v255, v[176:179] offset:4096
v_mfma_f32_16x16x32_bf16 v[212:215], v[236:239], v[52:55], v[212:215]
s_mov_b32 s99, 0
buffer_load_dwordx4 v251, s[12:15], s28 offen offset:1024 lds
v_mfma_f32_16x16x32_bf16 v[216:219], v[232:235], v[80:83], v[216:219]
ds_read_b128 v[228:231], v248 offset:16896
ds_write_b128 v255, v[180:183] offset:5120
v_mfma_f32_16x16x32_bf16 v[216:219], v[236:239], v[84:87], v[216:219]
v_exp_f32 v205, v205
v_mfma_f32_16x16x32_bf16 v[220:223], v[232:235], v[112:115], v[220:223]
v_exp_f32 v206, v206
v_mfma_f32_16x16x32_bf16 v[220:223], v[236:239], v[116:119], v[220:223]
s_waitcnt lgkmcnt(5)
v_cvt_pk_bf16_f32 v140, v204, v205
v_mfma_f32_16x16x32_bf16 v[208:211], v[240:243], v[24:27], v[208:211]
ds_read_b128 v[232:235], v248 offset:20480
buffer_load_dwordx4 v251, s[12:15], s28 offen offset:2048 lds
v_mfma_f32_16x16x32_bf16 v[208:211], v[244:247], v[28:31], v[208:211]
v_exp_f32 v207, v207
v_mfma_f32_16x16x32_bf16 v[212:215], v[240:243], v[56:59], v[212:215]
buffer_load_dwordx4 v251, s[12:15], s28 offen offset:3072 lds
ds_write_b128 v255, v[184:187] offset:6144
v_mfma_f32_16x16x32_bf16 v[212:215], v[244:247], v[60:63], v[212:215]
ds_write_b128 v255, v[188:191] offset:7168
v_mfma_f32_16x16x32_bf16 v[216:219], v[240:243], v[88:91], v[216:219]
ds_read_b128 v[236:239], v248 offset:20992
v_cvt_pk_bf16_f32 v141, v206, v207
v_mfma_f32_16x16x32_bf16 v[216:219], v[244:247], v[92:95], v[216:219]
s_add_u32 s28, s28, 0x4000
s_xor_b32 s30, s30, 0x10000
v_mfma_f32_16x16x32_bf16 v[220:223], v[240:243], v[120:123], v[220:223]
s_add_u32 m0, s30, 0x0
v_mfma_f32_16x16x32_bf16 v[220:223], v[244:247], v[124:127], v[220:223]
s_waitcnt lgkmcnt(5)
v_lshrrev_b32 v254, 1, v251
v_mfma_f32_16x16x32_bf16 v[192:195], v[224:227], v[0:3], 0
ds_read_b128 v[240:243], v248 offset:24576
v_and_b32 v254, 0x1800, v254
v_mfma_f32_16x16x32_bf16 v[192:195], v[228:231], v[4:7], v[192:195]
v_exp_f32 v208, v208
v_mfma_f32_16x16x32_bf16 v[196:199], v[224:227], v[32:35], 0
v_exp_f32 v209, v209
v_mfma_f32_16x16x32_bf16 v[196:199], v[228:231], v[36:39], v[196:199]
v_exp_f32 v210, v210
v_mfma_f32_16x16x32_bf16 v[200:203], v[224:227], v[64:67], 0
ds_read_b128 v[244:247], v248 offset:25088
v_cvt_pk_bf16_f32 v130, v208, v209
v_mfma_f32_16x16x32_bf16 v[200:203], v[228:231], v[68:71], v[200:203]
v_exp_f32 v211, v211
v_mfma_f32_16x16x32_bf16 v[204:207], v[224:227], v[96:99], 0
v_exp_f32 v212, v212
v_mfma_f32_16x16x32_bf16 v[204:207], v[228:231], v[100:103], v[204:207]
s_waitcnt lgkmcnt(2)
v_cvt_pk_bf16_f32 v131, v210, v211
v_mfma_f32_16x16x32_bf16 v[192:195], v[232:235], v[8:11], v[192:195]
ds_read_b128 v[224:227], v248 offset:28672
s_movk_i32 s35, 0x3ff
v_mfma_f32_16x16x32_bf16 v[192:195], v[236:239], v[12:15], v[192:195]
v_exp_f32 v213, v213
v_mfma_f32_16x16x32_bf16 v[196:199], v[232:235], v[40:43], v[196:199]
v_exp_f32 v214, v214
v_mfma_f32_16x16x32_bf16 v[196:199], v[236:239], v[44:47], v[196:199]
v_exp_f32 v215, v215
v_mfma_f32_16x16x32_bf16 v[200:203], v[232:235], v[72:75], v[200:203]
ds_read_b128 v[228:231], v248 offset:29184
v_cvt_pk_bf16_f32 v134, v212, v213
v_mfma_f32_16x16x32_bf16 v[200:203], v[236:239], v[76:79], v[200:203]
v_cvt_pk_bf16_f32 v135, v214, v215
v_and_or_b32 v254, v251, s35, v254
v_mfma_f32_16x16x32_bf16 v[204:207], v[232:235], v[104:107], v[204:207]
v_exp_f32 v216, v216
v_mfma_f32_16x16x32_bf16 v[204:207], v[236:239], v[108:111], v[204:207]
s_waitcnt lgkmcnt(2)
s_add_u32 s35, s28, 6144
v_mfma_f32_16x16x32_bf16 v[192:195], v[240:243], v[16:19], v[192:195]
ds_read_b128 v[232:235], v248 offset:18432
buffer_load_dwordx4 v254, s[12:15], s28 offen offset:0 lds
v_mfma_f32_16x16x32_bf16 v[192:195], v[244:247], v[20:23], v[192:195]
v_exp_f32 v217, v217
v_mfma_f32_16x16x32_bf16 v[196:199], v[240:243], v[48:51], v[196:199]
v_exp_f32 v218, v218
v_mfma_f32_16x16x32_bf16 v[196:199], v[244:247], v[52:55], v[196:199]
v_exp_f32 v219, v219
v_mfma_f32_16x16x32_bf16 v[200:203], v[240:243], v[80:83], v[200:203]
ds_read_b128 v[236:239], v248 offset:18944
v_cvt_pk_bf16_f32 v138, v216, v217
v_mfma_f32_16x16x32_bf16 v[200:203], v[244:247], v[84:87], v[200:203]
v_cvt_pk_bf16_f32 v139, v218, v219
buffer_load_dwordx4 v254, s[12:15], s28 offen offset:1024 lds
v_mfma_f32_16x16x32_bf16 v[204:207], v[240:243], v[112:115], v[204:207]
v_exp_f32 v220, v220
v_mfma_f32_16x16x32_bf16 v[204:207], v[244:247], v[116:119], v[204:207]
s_waitcnt lgkmcnt(2)
buffer_load_dwordx4 v254, s[12:15], s35 offen offset:2048 lds
v_mfma_f32_16x16x32_bf16 v[192:195], v[224:227], v[24:27], v[192:195]
ds_read_b128 v[240:243], v248 offset:22528
v_mfma_f32_16x16x32_bf16 v[192:195], v[228:231], v[28:31], v[192:195]
v_exp_f32 v221, v221
v_mfma_f32_16x16x32_bf16 v[196:199], v[224:227], v[56:59], v[196:199]
v_exp_f32 v222, v222
v_mfma_f32_16x16x32_bf16 v[196:199], v[228:231], v[60:63], v[196:199]
v_exp_f32 v223, v223
v_mfma_f32_16x16x32_bf16 v[200:203], v[224:227], v[88:91], v[200:203]
ds_read_b128 v[244:247], v248 offset:23040
v_cvt_pk_bf16_f32 v142, v220, v221
v_mfma_f32_16x16x32_bf16 v[200:203], v[228:231], v[92:95], v[200:203]
v_cvt_pk_bf16_f32 v143, v222, v223
buffer_load_dwordx4 v254, s[12:15], s35 offen offset:3072 lds
v_mfma_f32_16x16x32_bf16 v[204:207], v[224:227], v[120:123], v[204:207]
v_mfma_f32_16x16x32_bf16 v[204:207], v[228:231], v[124:127], v[204:207]
s_waitcnt lgkmcnt(2)
v_mfma_f32_16x16x32_bf16 v[208:211], v[232:235], v[0:3], 0
ds_read_b128 v[224:227], v248 offset:26624
v_mfma_f32_16x16x32_bf16 v[208:211], v[236:239], v[4:7], v[208:211]
v_exp_f32 v192, v192
v_mfma_f32_16x16x32_bf16 v[212:215], v[232:235], v[32:35], 0
v_exp_f32 v193, v193
v_mfma_f32_16x16x32_bf16 v[212:215], v[236:239], v[36:39], v[212:215]
v_exp_f32 v194, v194
v_mfma_f32_16x16x32_bf16 v[216:219], v[232:235], v[64:67], 0
ds_read_b128 v[228:231], v248 offset:27136
v_cvt_pk_bf16_f32 v144, v192, v193
v_mfma_f32_16x16x32_bf16 v[216:219], v[236:239], v[68:71], v[216:219]
v_exp_f32 v195, v195
v_mfma_f32_16x16x32_bf16 v[220:223], v[232:235], v[96:99], 0
v_exp_f32 v196, v196
v_mfma_f32_16x16x32_bf16 v[220:223], v[236:239], v[100:103], v[220:223]
s_waitcnt lgkmcnt(2)
v_cvt_pk_bf16_f32 v145, v194, v195
v_mfma_f32_16x16x32_bf16 v[208:211], v[240:243], v[8:11], v[208:211]
ds_read_b128 v[232:235], v248 offset:30720
v_mfma_f32_16x16x32_bf16 v[208:211], v[244:247], v[12:15], v[208:211]
v_exp_f32 v197, v197
v_mfma_f32_16x16x32_bf16 v[212:215], v[240:243], v[40:43], v[212:215]
v_exp_f32 v198, v198
v_mfma_f32_16x16x32_bf16 v[212:215], v[244:247], v[44:47], v[212:215]
v_exp_f32 v199, v199
v_mfma_f32_16x16x32_bf16 v[216:219], v[240:243], v[72:75], v[216:219]
ds_read_b128 v[236:239], v248 offset:31232
v_cvt_pk_bf16_f32 v148, v196, v197
v_mfma_f32_16x16x32_bf16 v[216:219], v[244:247], v[76:79], v[216:219]
v_cvt_pk_bf16_f32 v149, v198, v199
v_mfma_f32_16x16x32_bf16 v[220:223], v[240:243], v[104:107], v[220:223]
v_exp_f32 v200, v200
v_mfma_f32_16x16x32_bf16 v[220:223], v[244:247], v[108:111], v[220:223]
s_waitcnt lgkmcnt(2)
v_mfma_f32_16x16x32_bf16 v[208:211], v[224:227], v[16:19], v[208:211]
ds_read_b128 v[240:243], v248 offset:32768
v_mfma_f32_16x16x32_bf16 v[208:211], v[228:231], v[20:23], v[208:211]
v_exp_f32 v201, v201
v_mfma_f32_16x16x32_bf16 v[212:215], v[224:227], v[48:51], v[212:215]
v_exp_f32 v202, v202
v_mfma_f32_16x16x32_bf16 v[212:215], v[228:231], v[52:55], v[212:215]
v_exp_f32 v203, v203
v_mfma_f32_16x16x32_bf16 v[216:219], v[224:227], v[80:83], v[216:219]
ds_read_b128 v[244:247], v248 offset:33280
v_cvt_pk_bf16_f32 v152, v200, v201
v_mfma_f32_16x16x32_bf16 v[216:219], v[228:231], v[84:87], v[216:219]
v_cvt_pk_bf16_f32 v153, v202, v203
v_mfma_f32_16x16x32_bf16 v[220:223], v[224:227], v[112:115], v[220:223]
v_exp_f32 v204, v204
v_mfma_f32_16x16x32_bf16 v[220:223], v[228:231], v[116:119], v[220:223]
s_waitcnt lgkmcnt(2)
v_mfma_f32_16x16x32_bf16 v[208:211], v[232:235], v[24:27], v[208:211]
ds_read_b128 v[224:227], v248 offset:36864
v_mfma_f32_16x16x32_bf16 v[208:211], v[236:239], v[28:31], v[208:211]
v_exp_f32 v205, v205
v_mfma_f32_16x16x32_bf16 v[212:215], v[232:235], v[56:59], v[212:215]
v_exp_f32 v206, v206
v_mfma_f32_16x16x32_bf16 v[212:215], v[236:239], v[60:63], v[212:215]
v_exp_f32 v207, v207
v_mfma_f32_16x16x32_bf16 v[216:219], v[232:235], v[88:91], v[216:219]
ds_read_b128 v[228:231], v248 offset:37376
v_cvt_pk_bf16_f32 v156, v204, v205
v_mfma_f32_16x16x32_bf16 v[216:219], v[236:239], v[92:95], v[216:219]
v_cvt_pk_bf16_f32 v157, v206, v207
v_mfma_f32_16x16x32_bf16 v[220:223], v[232:235], v[120:123], v[220:223]
v_mfma_f32_16x16x32_bf16 v[220:223], v[236:239], v[124:127], v[220:223]
s_waitcnt lgkmcnt(2)
v_mfma_f32_16x16x32_bf16 v[192:195], v[240:243], v[0:3], 0
ds_read_b128 v[232:235], v248 offset:40960
v_mfma_f32_16x16x32_bf16 v[192:195], v[244:247], v[4:7], v[192:195]
v_exp_f32 v208, v208
v_mfma_f32_16x16x32_bf16 v[196:199], v[240:243], v[32:35], 0
v_exp_f32 v209, v209
v_mfma_f32_16x16x32_bf16 v[196:199], v[244:247], v[36:39], v[196:199]
v_exp_f32 v210, v210
v_mfma_f32_16x16x32_bf16 v[200:203], v[240:243], v[64:67], 0
ds_read_b128 v[236:239], v248 offset:41472
v_cvt_pk_bf16_f32 v146, v208, v209
v_mfma_f32_16x16x32_bf16 v[200:203], v[244:247], v[68:71], v[200:203]
v_exp_f32 v211, v211
v_mfma_f32_16x16x32_bf16 v[204:207], v[240:243], v[96:99], 0
v_exp_f32 v212, v212
v_mfma_f32_16x16x32_bf16 v[204:207], v[244:247], v[100:103], v[204:207]
s_waitcnt lgkmcnt(2)
v_cvt_pk_bf16_f32 v147, v210, v211
v_mfma_f32_16x16x32_bf16 v[192:195], v[224:227], v[8:11], v[192:195]
ds_read_b128 v[240:243], v248 offset:45056
v_mfma_f32_16x16x32_bf16 v[192:195], v[228:231], v[12:15], v[192:195]
v_exp_f32 v213, v213
v_mfma_f32_16x16x32_bf16 v[196:199], v[224:227], v[40:43], v[196:199]
v_exp_f32 v214, v214
v_mfma_f32_16x16x32_bf16 v[196:199], v[228:231], v[44:47], v[196:199]
v_exp_f32 v215, v215
v_mfma_f32_16x16x32_bf16 v[200:203], v[224:227], v[72:75], v[200:203]
ds_read_b128 v[244:247], v248 offset:45568
v_cvt_pk_bf16_f32 v150, v212, v213
v_mfma_f32_16x16x32_bf16 v[200:203], v[228:231], v[76:79], v[200:203]
v_cvt_pk_bf16_f32 v151, v214, v215
v_mfma_f32_16x16x32_bf16 v[204:207], v[224:227], v[104:107], v[204:207]
v_exp_f32 v216, v216
v_mfma_f32_16x16x32_bf16 v[204:207], v[228:231], v[108:111], v[204:207]
s_waitcnt lgkmcnt(2)
v_mfma_f32_16x16x32_bf16 v[192:195], v[232:235], v[16:19], v[192:195]
ds_read_b128 v[224:227], v248 offset:34816
v_mfma_f32_16x16x32_bf16 v[192:195], v[236:239], v[20:23], v[192:195]
v_exp_f32 v217, v217
v_mfma_f32_16x16x32_bf16 v[196:199], v[232:235], v[48:51], v[196:199]
v_exp_f32 v218, v218
v_mfma_f32_16x16x32_bf16 v[196:199], v[236:239], v[52:55], v[196:199]
v_exp_f32 v219, v219
v_mfma_f32_16x16x32_bf16 v[200:203], v[232:235], v[80:83], v[200:203]
ds_read_b128 v[228:231], v248 offset:35328
v_cvt_pk_bf16_f32 v154, v216, v217
v_mfma_f32_16x16x32_bf16 v[200:203], v[236:239], v[84:87], v[200:203]
v_cvt_pk_bf16_f32 v155, v218, v219
v_mfma_f32_16x16x32_bf16 v[204:207], v[232:235], v[112:115], v[204:207]
v_exp_f32 v220, v220
v_mfma_f32_16x16x32_bf16 v[204:207], v[236:239], v[116:119], v[204:207]
s_waitcnt lgkmcnt(2)
v_mfma_f32_16x16x32_bf16 v[192:195], v[240:243], v[24:27], v[192:195]
ds_read_b128 v[232:235], v248 offset:38912
v_mfma_f32_16x16x32_bf16 v[192:195], v[244:247], v[28:31], v[192:195]
v_exp_f32 v221, v221
v_mfma_f32_16x16x32_bf16 v[196:199], v[240:243], v[56:59], v[196:199]
v_exp_f32 v222, v222
v_mfma_f32_16x16x32_bf16 v[196:199], v[244:247], v[60:63], v[196:199]
v_exp_f32 v223, v223
v_mfma_f32_16x16x32_bf16 v[200:203], v[240:243], v[88:91], v[200:203]
ds_read_b128 v[236:239], v248 offset:39424
v_cvt_pk_bf16_f32 v158, v220, v221
v_mfma_f32_16x16x32_bf16 v[200:203], v[244:247], v[92:95], v[200:203]
v_cvt_pk_bf16_f32 v159, v222, v223
v_mfma_f32_16x16x32_bf16 v[204:207], v[240:243], v[120:123], v[204:207]
v_mfma_f32_16x16x32_bf16 v[204:207], v[244:247], v[124:127], v[204:207]
s_waitcnt lgkmcnt(2)
v_mfma_f32_16x16x32_bf16 v[208:211], v[224:227], v[0:3], 0
ds_read_b128 v[240:243], v248 offset:43008
v_mfma_f32_16x16x32_bf16 v[208:211], v[228:231], v[4:7], v[208:211]
v_exp_f32 v192, v192
v_mfma_f32_16x16x32_bf16 v[212:215], v[224:227], v[32:35], 0
v_exp_f32 v193, v193
v_mfma_f32_16x16x32_bf16 v[212:215], v[228:231], v[36:39], v[212:215]
v_exp_f32 v194, v194
v_mfma_f32_16x16x32_bf16 v[216:219], v[224:227], v[64:67], 0
ds_read_b128 v[244:247], v248 offset:43520
v_cvt_pk_bf16_f32 v160, v192, v193
v_mfma_f32_16x16x32_bf16 v[216:219], v[228:231], v[68:71], v[216:219]
v_exp_f32 v195, v195
v_mfma_f32_16x16x32_bf16 v[220:223], v[224:227], v[96:99], 0
v_exp_f32 v196, v196
v_mfma_f32_16x16x32_bf16 v[220:223], v[228:231], v[100:103], v[220:223]
s_waitcnt lgkmcnt(2)
v_cvt_pk_bf16_f32 v161, v194, v195
v_mfma_f32_16x16x32_bf16 v[208:211], v[232:235], v[8:11], v[208:211]
ds_read_b128 v[224:227], v248 offset:47104
v_mfma_f32_16x16x32_bf16 v[208:211], v[236:239], v[12:15], v[208:211]
v_exp_f32 v197, v197
v_mfma_f32_16x16x32_bf16 v[212:215], v[232:235], v[40:43], v[212:215]
v_exp_f32 v198, v198
v_mfma_f32_16x16x32_bf16 v[212:215], v[236:239], v[44:47], v[212:215]
v_exp_f32 v199, v199
v_mfma_f32_16x16x32_bf16 v[216:219], v[232:235], v[72:75], v[216:219]
ds_read_b128 v[228:231], v248 offset:47616
v_cvt_pk_bf16_f32 v164, v196, v197
v_mfma_f32_16x16x32_bf16 v[216:219], v[236:239], v[76:79], v[216:219]
v_cvt_pk_bf16_f32 v165, v198, v199
v_mfma_f32_16x16x32_bf16 v[220:223], v[232:235], v[104:107], v[220:223]
v_exp_f32 v200, v200
v_mfma_f32_16x16x32_bf16 v[220:223], v[236:239], v[108:111], v[220:223]
s_waitcnt lgkmcnt(2)
s_waitcnt vmcnt(0)
s_barrier
v_mfma_f32_16x16x32_bf16 v[208:211], v[240:243], v[16:19], v[208:211]
ds_read_b128 v[232:235], v248 offset:49152
v_mfma_f32_16x16x32_bf16 v[208:211], v[244:247], v[20:23], v[208:211]
v_exp_f32 v201, v201
v_mfma_f32_16x16x32_bf16 v[212:215], v[240:243], v[48:51], v[212:215]
v_exp_f32 v202, v202
v_mfma_f32_16x16x32_bf16 v[212:215], v[244:247], v[52:55], v[212:215]
v_exp_f32 v203, v203
v_mfma_f32_16x16x32_bf16 v[216:219], v[240:243], v[80:83], v[216:219]
ds_read_b128 v[236:239], v248 offset:49664
v_cvt_pk_bf16_f32 v168, v200, v201
v_mfma_f32_16x16x32_bf16 v[216:219], v[244:247], v[84:87], v[216:219]
v_cvt_pk_bf16_f32 v169, v202, v203
v_mfma_f32_16x16x32_bf16 v[220:223], v[240:243], v[112:115], v[220:223]
v_exp_f32 v204, v204
v_mfma_f32_16x16x32_bf16 v[220:223], v[244:247], v[116:119], v[220:223]
s_waitcnt lgkmcnt(2)
v_mfma_f32_16x16x32_bf16 v[208:211], v[224:227], v[24:27], v[208:211]
ds_read_b128 v[240:243], v248 offset:53248
v_mfma_f32_16x16x32_bf16 v[208:211], v[228:231], v[28:31], v[208:211]
v_exp_f32 v205, v205
v_mfma_f32_16x16x32_bf16 v[212:215], v[224:227], v[56:59], v[212:215]
v_exp_f32 v206, v206
v_mfma_f32_16x16x32_bf16 v[212:215], v[228:231], v[60:63], v[212:215]
v_exp_f32 v207, v207
v_mfma_f32_16x16x32_bf16 v[216:219], v[224:227], v[88:91], v[216:219]
ds_read_b128 v[244:247], v248 offset:53760
v_cvt_pk_bf16_f32 v172, v204, v205
v_mfma_f32_16x16x32_bf16 v[216:219], v[228:231], v[92:95], v[216:219]
v_cvt_pk_bf16_f32 v173, v206, v207
v_mfma_f32_16x16x32_bf16 v[220:223], v[224:227], v[120:123], v[220:223]
v_mfma_f32_16x16x32_bf16 v[220:223], v[228:231], v[124:127], v[220:223]
s_waitcnt lgkmcnt(2)
v_mfma_f32_16x16x32_bf16 v[192:195], v[232:235], v[0:3], 0
ds_read_b128 v[224:227], v248 offset:57344
v_mfma_f32_16x16x32_bf16 v[192:195], v[236:239], v[4:7], v[192:195]
v_exp_f32 v208, v208
v_mfma_f32_16x16x32_bf16 v[196:199], v[232:235], v[32:35], 0
v_exp_f32 v209, v209
v_mfma_f32_16x16x32_bf16 v[196:199], v[236:239], v[36:39], v[196:199]
v_exp_f32 v210, v210
v_mfma_f32_16x16x32_bf16 v[200:203], v[232:235], v[64:67], 0
ds_read_b128 v[228:231], v248 offset:57856
v_cvt_pk_bf16_f32 v162, v208, v209
v_mfma_f32_16x16x32_bf16 v[200:203], v[236:239], v[68:71], v[200:203]
v_exp_f32 v211, v211
v_mfma_f32_16x16x32_bf16 v[204:207], v[232:235], v[96:99], 0
v_exp_f32 v212, v212
v_mfma_f32_16x16x32_bf16 v[204:207], v[236:239], v[100:103], v[204:207]
s_waitcnt lgkmcnt(2)
v_cvt_pk_bf16_f32 v163, v210, v211
v_mfma_f32_16x16x32_bf16 v[192:195], v[240:243], v[8:11], v[192:195]
ds_read_b128 v[232:235], v248 offset:61440
v_mfma_f32_16x16x32_bf16 v[192:195], v[244:247], v[12:15], v[192:195]
v_exp_f32 v213, v213
v_mfma_f32_16x16x32_bf16 v[196:199], v[240:243], v[40:43], v[196:199]
v_exp_f32 v214, v214
v_mfma_f32_16x16x32_bf16 v[196:199], v[244:247], v[44:47], v[196:199]
v_exp_f32 v215, v215
v_mfma_f32_16x16x32_bf16 v[200:203], v[240:243], v[72:75], v[200:203]
ds_read_b128 v[236:239], v248 offset:61952
v_cvt_pk_bf16_f32 v166, v212, v213
v_mfma_f32_16x16x32_bf16 v[200:203], v[244:247], v[76:79], v[200:203]
v_cvt_pk_bf16_f32 v167, v214, v215
v_mfma_f32_16x16x32_bf16 v[204:207], v[240:243], v[104:107], v[204:207]
v_exp_f32 v216, v216
v_mfma_f32_16x16x32_bf16 v[204:207], v[244:247], v[108:111], v[204:207]
s_waitcnt lgkmcnt(2)
v_mfma_f32_16x16x32_bf16 v[192:195], v[224:227], v[16:19], v[192:195]
ds_read_b128 v[240:243], v248 offset:51200
v_mfma_f32_16x16x32_bf16 v[192:195], v[228:231], v[20:23], v[192:195]
v_exp_f32 v217, v217
v_mfma_f32_16x16x32_bf16 v[196:199], v[224:227], v[48:51], v[196:199]
v_exp_f32 v218, v218
v_mfma_f32_16x16x32_bf16 v[196:199], v[228:231], v[52:55], v[196:199]
v_exp_f32 v219, v219
v_mfma_f32_16x16x32_bf16 v[200:203], v[224:227], v[80:83], v[200:203]
ds_read_b128 v[244:247], v248 offset:51712
v_cvt_pk_bf16_f32 v170, v216, v217
v_mfma_f32_16x16x32_bf16 v[200:203], v[228:231], v[84:87], v[200:203]
v_cvt_pk_bf16_f32 v171, v218, v219
v_mfma_f32_16x16x32_bf16 v[204:207], v[224:227], v[112:115], v[204:207]
v_exp_f32 v220, v220
v_mfma_f32_16x16x32_bf16 v[204:207], v[228:231], v[116:119], v[204:207]
s_waitcnt lgkmcnt(2)
v_mfma_f32_16x16x32_bf16 v[192:195], v[232:235], v[24:27], v[192:195]
ds_read_b128 v[224:227], v248 offset:55296
v_mfma_f32_16x16x32_bf16 v[192:195], v[236:239], v[28:31], v[192:195]
v_exp_f32 v221, v221
v_mfma_f32_16x16x32_bf16 v[196:199], v[232:235], v[56:59], v[196:199]
v_exp_f32 v222, v222
v_mfma_f32_16x16x32_bf16 v[196:199], v[236:239], v[60:63], v[196:199]
v_exp_f32 v223, v223
v_mfma_f32_16x16x32_bf16 v[200:203], v[232:235], v[88:91], v[200:203]
ds_read_b128 v[228:231], v248 offset:55808
v_cvt_pk_bf16_f32 v174, v220, v221
v_mfma_f32_16x16x32_bf16 v[200:203], v[236:239], v[92:95], v[200:203]
v_cvt_pk_bf16_f32 v175, v222, v223
v_mfma_f32_16x16x32_bf16 v[204:207], v[232:235], v[120:123], v[204:207]
v_mfma_f32_16x16x32_bf16 v[204:207], v[236:239], v[124:127], v[204:207]
s_waitcnt lgkmcnt(2)
v_mfma_f32_16x16x32_bf16 v[208:211], v[240:243], v[0:3], 0
ds_read_b128 v[232:235], v248 offset:59392
v_mfma_f32_16x16x32_bf16 v[208:211], v[244:247], v[4:7], v[208:211]
v_exp_f32 v192, v192
v_mfma_f32_16x16x32_bf16 v[212:215], v[240:243], v[32:35], 0
v_exp_f32 v193, v193
v_mfma_f32_16x16x32_bf16 v[212:215], v[244:247], v[36:39], v[212:215]
v_exp_f32 v194, v194
v_mfma_f32_16x16x32_bf16 v[216:219], v[240:243], v[64:67], 0
ds_read_b128 v[236:239], v248 offset:59904
v_cvt_pk_bf16_f32 v176, v192, v193
v_mfma_f32_16x16x32_bf16 v[216:219], v[244:247], v[68:71], v[216:219]
v_exp_f32 v195, v195
v_mfma_f32_16x16x32_bf16 v[220:223], v[240:243], v[96:99], 0
v_exp_f32 v196, v196
v_mfma_f32_16x16x32_bf16 v[220:223], v[244:247], v[100:103], v[220:223]
s_waitcnt lgkmcnt(2)
v_cvt_pk_bf16_f32 v177, v194, v195
v_mfma_f32_16x16x32_bf16 v[208:211], v[224:227], v[8:11], v[208:211]
ds_read_b128 v[240:243], v248 offset:63488
v_mfma_f32_16x16x32_bf16 v[208:211], v[228:231], v[12:15], v[208:211]
v_exp_f32 v197, v197
v_mfma_f32_16x16x32_bf16 v[212:215], v[224:227], v[40:43], v[212:215]
v_exp_f32 v198, v198
v_mfma_f32_16x16x32_bf16 v[212:215], v[228:231], v[44:47], v[212:215]
v_exp_f32 v199, v199
v_mfma_f32_16x16x32_bf16 v[216:219], v[224:227], v[72:75], v[216:219]
ds_read_b128 v[244:247], v248 offset:64000
v_cvt_pk_bf16_f32 v180, v196, v197
v_mfma_f32_16x16x32_bf16 v[216:219], v[228:231], v[76:79], v[216:219]
v_cvt_pk_bf16_f32 v181, v198, v199
v_mfma_f32_16x16x32_bf16 v[220:223], v[224:227], v[104:107], v[220:223]
v_exp_f32 v200, v200
v_mfma_f32_16x16x32_bf16 v[220:223], v[228:231], v[108:111], v[220:223]
s_waitcnt lgkmcnt(2)
v_xor_b32 v248, 0x10000, v248
v_mfma_f32_16x16x32_bf16 v[208:211], v[232:235], v[16:19], v[208:211]
ds_read_b128 v[224:227], v248 offset:0
v_mfma_f32_16x16x32_bf16 v[208:211], v[236:239], v[20:23], v[208:211]
v_exp_f32 v201, v201
v_mfma_f32_16x16x32_bf16 v[212:215], v[232:235], v[48:51], v[212:215]
v_exp_f32 v202, v202
v_mfma_f32_16x16x32_bf16 v[212:215], v[236:239], v[52:55], v[212:215]
v_exp_f32 v203, v203
v_mfma_f32_16x16x32_bf16 v[216:219], v[232:235], v[80:83], v[216:219]
ds_read_b128 v[228:231], v248 offset:512
v_cvt_pk_bf16_f32 v184, v200, v201
v_mfma_f32_16x16x32_bf16 v[216:219], v[236:239], v[84:87], v[216:219]
v_cvt_pk_bf16_f32 v185, v202, v203
v_mfma_f32_16x16x32_bf16 v[220:223], v[232:235], v[112:115], v[220:223]
v_exp_f32 v204, v204
v_mfma_f32_16x16x32_bf16 v[220:223], v[236:239], v[116:119], v[220:223]
s_waitcnt lgkmcnt(2)
v_mfma_f32_16x16x32_bf16 v[208:211], v[240:243], v[24:27], v[208:211]
ds_read_b128 v[232:235], v248 offset:4096
v_mfma_f32_16x16x32_bf16 v[208:211], v[244:247], v[28:31], v[208:211]
v_exp_f32 v205, v205
v_mfma_f32_16x16x32_bf16 v[212:215], v[240:243], v[56:59], v[212:215]
v_exp_f32 v206, v206
v_mfma_f32_16x16x32_bf16 v[212:215], v[244:247], v[60:63], v[212:215]
v_exp_f32 v207, v207
v_mfma_f32_16x16x32_bf16 v[216:219], v[240:243], v[88:91], v[216:219]
ds_read_b128 v[236:239], v248 offset:4608
v_cvt_pk_bf16_f32 v188, v204, v205
v_mfma_f32_16x16x32_bf16 v[216:219], v[244:247], v[92:95], v[216:219]
v_cvt_pk_bf16_f32 v189, v206, v207
v_mfma_f32_16x16x32_bf16 v[220:223], v[240:243], v[120:123], v[220:223]
v_mfma_f32_16x16x32_bf16 v[220:223], v[244:247], v[124:127], v[220:223]
s_waitcnt lgkmcnt(2)
v_mfma_f32_16x16x32_bf16 v[192:195], v[224:227], v[0:3], 0
ds_read_b128 v[240:243], v248 offset:8192
v_mfma_f32_16x16x32_bf16 v[192:195], v[228:231], v[4:7], v[192:195]
v_exp_f32 v208, v208
v_mfma_f32_16x16x32_bf16 v[196:199], v[224:227], v[32:35], 0
v_exp_f32 v209, v209
v_mfma_f32_16x16x32_bf16 v[196:199], v[228:231], v[36:39], v[196:199]
v_exp_f32 v210, v210
v_mfma_f32_16x16x32_bf16 v[200:203], v[224:227], v[64:67], 0
ds_read_b128 v[244:247], v248 offset:8704
v_cvt_pk_bf16_f32 v178, v208, v209
v_mfma_f32_16x16x32_bf16 v[200:203], v[228:231], v[68:71], v[200:203]
v_exp_f32 v211, v211
v_mfma_f32_16x16x32_bf16 v[204:207], v[224:227], v[96:99], 0
v_exp_f32 v212, v212
v_mfma_f32_16x16x32_bf16 v[204:207], v[228:231], v[100:103], v[204:207]
s_waitcnt lgkmcnt(2)
v_cvt_pk_bf16_f32 v179, v210, v211
v_mfma_f32_16x16x32_bf16 v[192:195], v[232:235], v[8:11], v[192:195]
ds_read_b128 v[224:227], v248 offset:12288
v_mfma_f32_16x16x32_bf16 v[192:195], v[236:239], v[12:15], v[192:195]
v_exp_f32 v213, v213
v_mfma_f32_16x16x32_bf16 v[196:199], v[232:235], v[40:43], v[196:199]
ds_read_b128 v[4:7], v255 offset:0
ds_read_b128 v[36:39], v255 offset:1024
v_mfma_f32_16x16x32_bf16 v[196:199], v[236:239], v[44:47], v[196:199]
v_exp_f32 v214, v214
v_mfma_f32_16x16x32_bf16 v[200:203], v[232:235], v[72:75], v[200:203]
ds_read_b128 v[228:231], v248 offset:12800
v_xor_b32 v12, 0x10000, v249
v_mfma_f32_16x16x32_bf16 v[200:203], v[236:239], v[76:79], v[200:203]
v_xor_b32 v13, 0x10000, v250
v_cvt_pk_bf16_f32 v182, v212, v213
v_mfma_f32_16x16x32_bf16 v[204:207], v[232:235], v[104:107], v[204:207]
ds_read_b128 v[68:71], v255 offset:2048
ds_read_b128 v[100:103], v255 offset:3072
v_mfma_f32_16x16x32_bf16 v[204:207], v[236:239], v[108:111], v[204:207]
s_waitcnt lgkmcnt(6)
v_mov_b32 v2, 0
v_mfma_f32_16x16x32_bf16 v[192:195], v[240:243], v[16:19], v[192:195]
ds_read_b64_tr_b16 v[232:233], v12 offset:0
ds_read_b64_tr_b16 v[234:235], v12 offset:2048
v_mfma_f32_16x16x32_bf16 v[192:195], v[244:247], v[20:23], v[192:195]
v_exp_f32 v215, v215
v_mfma_f32_16x16x32_bf16 v[196:199], v[240:243], v[48:51], v[196:199]
ds_read_b128 v[8:11], v255 offset:4096
ds_read_b128 v[40:43], v255 offset:5120
v_mfma_f32_16x16x32_bf16 v[196:199], v[244:247], v[52:55], v[196:199]
v_cvt_pk_bf16_f32 v183, v214, v215
v_mov_b32 v3, 0
v_mfma_f32_16x16x32_bf16 v[200:203], v[240:243], v[80:83], v[200:203]
ds_read_b64_tr_b16 v[236:237], v12 offset:16384
ds_read_b64_tr_b16 v[238:239], v12 offset:18432
v_mfma_f32_16x16x32_bf16 v[200:203], v[244:247], v[84:87], v[200:203]
v_exp_f32 v216, v216
v_mfma_f32_16x16x32_bf16 v[204:207], v[240:243], v[112:115], v[204:207]
ds_read_b128 v[72:75], v255 offset:6144
ds_read_b128 v[104:107], v255 offset:7168
v_mfma_f32_16x16x32_bf16 v[204:207], v[244:247], v[116:119], v[204:207]
s_waitcnt lgkmcnt(10)
v_mov_b32 v34, 0
v_mfma_f32_16x16x32_bf16 v[192:195], v[224:227], v[24:27], v[192:195]
ds_read_b64_tr_b16 v[240:241], v12 offset:32768
ds_read_b64_tr_b16 v[242:243], v12 offset:34816
v_mfma_f32_16x16x32_bf16 v[192:195], v[228:231], v[28:31], v[192:195]
v_exp_f32 v217, v217
v_mfma_f32_16x16x32_bf16 v[196:199], v[224:227], v[56:59], v[196:199]
v_exp_f32 v218, v218
v_mfma_f32_16x16x32_bf16 v[196:199], v[228:231], v[60:63], v[196:199]
v_exp_f32 v219, v219
v_mfma_f32_16x16x32_bf16 v[200:203], v[224:227], v[88:91], v[200:203]
ds_read_b64_tr_b16 v[244:245], v12 offset:49152
ds_read_b64_tr_b16 v[246:247], v12 offset:51200
v_mfma_f32_16x16x32_bf16 v[200:203], v[228:231], v[92:95], v[200:203]
v_cvt_pk_bf16_f32 v186, v216, v217
v_cvt_pk_bf16_f32 v187, v218, v219
v_mfma_f32_16x16x32_bf16 v[204:207], v[224:227], v[120:123], v[204:207]
v_exp_f32 v220, v220
v_mfma_f32_16x16x32_bf16 v[204:207], v[228:231], v[124:127], v[204:207]
s_waitcnt lgkmcnt(6)
s_waitcnt lgkmcnt(4)
v_mfma_f32_16x16x32_bf16 a[0:3], v[232:235], v[128:131], a[0:3]
ds_read_b64_tr_b16 v[224:225], v13 offset:0
ds_read_b64_tr_b16 v[226:227], v13 offset:2048
v_mfma_f32_16x16x32_bf16 a[0:3], v[236:239], v[144:147], a[0:3]
v_exp_f32 v221, v221
v_mfma_f32_16x16x32_bf16 a[4:7], v[232:235], v[132:135], a[4:7]
v_exp_f32 v222, v222
v_mfma_f32_16x16x32_bf16 a[4:7], v[236:239], v[148:151], a[4:7]
v_exp_f32 v223, v223
v_mfma_f32_16x16x32_bf16 a[8:11], v[232:235], v[136:139], a[8:11]
ds_read_b64_tr_b16 v[228:229], v13 offset:16384
ds_read_b64_tr_b16 v[230:231], v13 offset:18432
v_mfma_f32_16x16x32_bf16 a[8:11], v[236:239], v[152:155], a[8:11]
v_cvt_pk_bf16_f32 v190, v220, v221
v_cvt_pk_bf16_f32 v191, v222, v223
v_mfma_f32_16x16x32_bf16 a[12:15], v[232:235], v[140:143], a[12:15]
v_exp_f32 v192, v192
v_mfma_f32_16x16x32_bf16 a[12:15], v[236:239], v[156:159], a[12:15]
s_waitcnt lgkmcnt(4)
v_mov_b32 v35, 0
v_mfma_f32_16x16x32_bf16 a[0:3], v[240:243], v[160:163], a[0:3]
ds_read_b64_tr_b16 v[232:233], v13 offset:32768
ds_read_b64_tr_b16 v[234:235], v13 offset:34816
v_mfma_f32_16x16x32_bf16 a[0:3], v[244:247], v[176:179], a[0:3]
v_exp_f32 v193, v193
v_mfma_f32_16x16x32_bf16 a[4:7], v[240:243], v[164:167], a[4:7]
v_exp_f32 v194, v194
v_mfma_f32_16x16x32_bf16 a[4:7], v[244:247], v[180:183], a[4:7]
v_exp_f32 v195, v195
v_mfma_f32_16x16x32_bf16 a[8:11], v[240:243], v[168:171], a[8:11]
ds_read_b64_tr_b16 v[236:237], v13 offset:49152
ds_read_b64_tr_b16 v[238:239], v13 offset:51200
v_mfma_f32_16x16x32_bf16 a[8:11], v[244:247], v[184:187], a[8:11]
v_cvt_pk_bf16_f32 v0, v192, v193
v_cvt_pk_bf16_f32 v1, v194, v195
v_mfma_f32_16x16x32_bf16 a[12:15], v[240:243], v[172:175], a[12:15]
v_exp_f32 v196, v196
v_mfma_f32_16x16x32_bf16 a[12:15], v[244:247], v[188:191], a[12:15]
s_waitcnt lgkmcnt(4)
v_mov_b32 v66, 0
v_mfma_f32_16x16x32_bf16 a[16:19], v[224:227], v[128:131], a[16:19]
ds_read_b64_tr_b16 v[240:241], v249 offset:33280
ds_read_b64_tr_b16 v[242:243], v249 offset:35328
v_mfma_f32_16x16x32_bf16 a[16:19], v[228:231], v[144:147], a[16:19]
v_exp_f32 v197, v197
v_mfma_f32_16x16x32_bf16 a[20:23], v[224:227], v[132:135], a[20:23]
v_exp_f32 v198, v198
v_mfma_f32_16x16x32_bf16 a[20:23], v[228:231], v[148:151], a[20:23]
v_exp_f32 v199, v199
v_mfma_f32_16x16x32_bf16 a[24:27], v[224:227], v[136:139], a[24:27]
ds_read_b64_tr_b16 v[244:245], v249 offset:49664
ds_read_b64_tr_b16 v[246:247], v249 offset:51712
v_mfma_f32_16x16x32_bf16 a[24:27], v[228:231], v[152:155], a[24:27]
v_cvt_pk_bf16_f32 v32, v196, v197
v_cvt_pk_bf16_f32 v33, v198, v199
v_mfma_f32_16x16x32_bf16 a[28:31], v[224:227], v[140:143], a[28:31]
v_exp_f32 v200, v200
v_mfma_f32_16x16x32_bf16 a[28:31], v[228:231], v[156:159], a[28:31]
s_waitcnt lgkmcnt(4)
v_mov_b32 v67, 0
v_mfma_f32_16x16x32_bf16 a[16:19], v[232:235], v[160:163], a[16:19]
ds_read_b64_tr_b16 v[224:225], v12 offset:512
ds_read_b64_tr_b16 v[226:227], v12 offset:2560
v_mfma_f32_16x16x32_bf16 a[16:19], v[236:239], v[176:179], a[16:19]
v_exp_f32 v201, v201
v_mfma_f32_16x16x32_bf16 a[20:23], v[232:235], v[164:167], a[20:23]
v_exp_f32 v202, v202
v_mfma_f32_16x16x32_bf16 a[20:23], v[236:239], v[180:183], a[20:23]
v_exp_f32 v203, v203
v_mfma_f32_16x16x32_bf16 a[24:27], v[232:235], v[168:171], a[24:27]
ds_read_b64_tr_b16 v[228:229], v12 offset:16896
ds_read_b64_tr_b16 v[230:231], v12 offset:18944
v_mfma_f32_16x16x32_bf16 a[24:27], v[236:239], v[184:187], a[24:27]
v_cvt_pk_bf16_f32 v64, v200, v201
v_cvt_pk_bf16_f32 v65, v202, v203
v_mfma_f32_16x16x32_bf16 a[28:31], v[232:235], v[172:175], a[28:31]
v_exp_f32 v204, v204
v_mfma_f32_16x16x32_bf16 a[28:31], v[236:239], v[188:191], a[28:31]
s_waitcnt lgkmcnt(4)
v_mov_b32 v98, 0
v_mfma_f32_16x16x32_bf16 a[32:35], v[240:243], v[4:7], a[32:35]
ds_read_b64_tr_b16 v[232:233], v249 offset:0
ds_read_b64_tr_b16 v[234:235], v249 offset:2048
v_mfma_f32_16x16x32_bf16 a[32:35], v[244:247], v[8:11], a[32:35]
v_exp_f32 v205, v205
v_mfma_f32_16x16x32_bf16 a[36:39], v[240:243], v[36:39], a[36:39]
v_exp_f32 v206, v206
v_mfma_f32_16x16x32_bf16 a[36:39], v[244:247], v[40:43], a[36:39]
v_exp_f32 v207, v207
v_mfma_f32_16x16x32_bf16 a[40:43], v[240:243], v[68:71], a[40:43]
ds_read_b64_tr_b16 v[236:237], v250 offset:0
ds_read_b64_tr_b16 v[238:239], v250 offset:2048
v_mfma_f32_16x16x32_bf16 a[40:43], v[244:247], v[72:75], a[40:43]
v_cvt_pk_bf16_f32 v96, v204, v205
v_cvt_pk_bf16_f32 v97, v206, v207
v_mfma_f32_16x16x32_bf16 a[44:47], v[240:243], v[100:103], a[44:47]
v_mov_b32 v99, 0
v_mfma_f32_16x16x32_bf16 a[44:47], v[244:247], v[104:107], a[44:47]
s_waitcnt lgkmcnt(4)
v_mfma_f32_16x16x32_bf16 a[32:35], v[224:227], v[128:131], a[32:35]
ds_read_b64_tr_b16 v[240:241], v12 offset:33280
ds_read_b64_tr_b16 v[242:243], v12 offset:35328
v_mfma_f32_16x16x32_bf16 a[32:35], v[228:231], v[144:147], a[32:35]
v_mfma_f32_16x16x32_bf16 a[36:39], v[224:227], v[132:135], a[36:39]
v_mfma_f32_16x16x32_bf16 a[36:39], v[228:231], v[148:151], a[36:39]
v_mfma_f32_16x16x32_bf16 a[40:43], v[224:227], v[136:139], a[40:43]
ds_read_b64_tr_b16 v[244:245], v12 offset:49664
ds_read_b64_tr_b16 v[246:247], v12 offset:51712
v_mfma_f32_16x16x32_bf16 a[40:43], v[228:231], v[152:155], a[40:43]
v_mfma_f32_16x16x32_bf16 a[44:47], v[224:227], v[140:143], a[44:47]
v_mfma_f32_16x16x32_bf16 a[44:47], v[228:231], v[156:159], a[44:47]
s_waitcnt lgkmcnt(4)
v_mfma_f32_16x16x32_bf16 a[0:3], v[232:235], v[0:3], a[0:3]
ds_read_b64_tr_b16 v[224:225], v249 offset:512
ds_read_b64_tr_b16 v[226:227], v249 offset:2560
v_mfma_f32_16x16x32_bf16 a[4:7], v[232:235], v[32:35], a[4:7]
v_mfma_f32_16x16x32_bf16 a[8:11], v[232:235], v[64:67], a[8:11]
v_mfma_f32_16x16x32_bf16 a[12:15], v[232:235], v[96:99], a[12:15]
v_mfma_f32_16x16x32_bf16 a[16:19], v[236:239], v[0:3], a[16:19]
ds_read_b64_tr_b16 v[228:229], v250 offset:512
ds_read_b64_tr_b16 v[230:231], v250 offset:2560
v_mfma_f32_16x16x32_bf16 a[20:23], v[236:239], v[32:35], a[20:23]
v_mfma_f32_16x16x32_bf16 a[24:27], v[236:239], v[64:67], a[24:27]
v_mfma_f32_16x16x32_bf16 a[28:31], v[236:239], v[96:99], a[28:31]
s_waitcnt lgkmcnt(4)
v_mfma_f32_16x16x32_bf16 a[32:35], v[240:243], v[160:163], a[32:35]
ds_read_b64_tr_b16 v[232:233], v250 offset:33280
ds_read_b64_tr_b16 v[234:235], v250 offset:35328
v_mfma_f32_16x16x32_bf16 a[32:35], v[244:247], v[176:179], a[32:35]
v_mfma_f32_16x16x32_bf16 a[36:39], v[240:243], v[164:167], a[36:39]
v_mfma_f32_16x16x32_bf16 a[36:39], v[244:247], v[180:183], a[36:39]
v_mfma_f32_16x16x32_bf16 a[40:43], v[240:243], v[168:171], a[40:43]
ds_read_b64_tr_b16 v[236:237], v250 offset:49664
ds_read_b64_tr_b16 v[238:239], v250 offset:51712
v_accvgpr_read_b32 v192, a0
v_mfma_f32_16x16x32_bf16 a[40:43], v[244:247], v[184:187], a[40:43]
v_accvgpr_read_b32 v193, a4
v_accvgpr_read_b32 v194, a8
v_accvgpr_read_b32 v195, a12
v_mfma_f32_16x16x32_bf16 a[44:47], v[240:243], v[172:175], a[44:47]
v_lshlrev_b32 v253, 2, v252
v_subrev_u32 v196, 0x0d800000, v192
v_subrev_u32 v197, 0x0d800000, v193
v_mfma_f32_16x16x32_bf16 a[44:47], v[244:247], v[188:191], a[44:47]
s_waitcnt lgkmcnt(4)
v_subrev_u32 v198, 0x0d800000, v194
v_subrev_u32 v199, 0x0d800000, v195
v_mfma_f32_16x16x32_bf16 a[32:35], v[224:227], v[0:3], a[32:35]
ds_read_b64_tr_b16 v[240:241], v13 offset:512
ds_read_b64_tr_b16 v[242:243], v13 offset:2560
v_max3_u32 v254, v196, v197, v198
v_mfma_f32_16x16x32_bf16 a[36:39], v[224:227], v[32:35], a[36:39]
v_max_u32 v254, v254, v199
v_mfma_f32_16x16x32_bf16 a[40:43], v[224:227], v[64:67], a[40:43]
s_mov_b64 exec, 0xffff
s_xor_b32 s35, s48, 0
buffer_store_dword v192, v253, s[24:27], s35 offen offset:4 sc1
s_xor_b32 s35, s48, 1024
buffer_store_dword v193, v253, s[24:27], s35 offen offset:4 sc1
s_xor_b32 s35, s48, 2048
buffer_store_dword v194, v253, s[24:27], s35 offen offset:4 sc1
s_xor_b32 s35, s48, 3072
buffer_store_dword v195, v253, s[24:27], s35 offen offset:4 sc1
v_cmp_le_u32 vcc, 0x64000000, v254
s_mov_b64 exec, -1
v_mfma_f32_16x16x32_bf16 a[44:47], v[224:227], v[96:99], a[44:47]
v_accvgpr_read_b32 v192, a0
v_accvgpr_read_b32 v193, a1
v_mfma_f32_16x16x32_bf16 a[48:51], v[228:231], v[0:3], a[48:51]
ds_read_b64_tr_b16 v[244:245], v13 offset:16896
ds_read_b64_tr_b16 v[246:247], v13 offset:18944
v_mfma_f32_16x16x32_bf16 a[52:55], v[228:231], v[32:35], a[52:55]
v_accvgpr_read_b32 v194, a2
v_accvgpr_read_b32 v195, a3
v_mfma_f32_16x16x32_bf16 a[56:59], v[228:231], v[64:67], a[56:59]
v_cvt_pk_bf16_f32 v16, v192, v193
v_cvt_pk_bf16_f32 v17, v194, v195
v_mfma_f32_16x16x32_bf16 a[60:63], v[228:231], v[96:99], a[60:63]
s_waitcnt lgkmcnt(4)
v_accvgpr_read_b32 v200, a4
v_mfma_f32_16x16x32_bf16 a[48:51], v[232:235], v[4:7], a[48:51]
ds_read_b64_tr_b16 v[224:225], v13 offset:33280
ds_read_b64_tr_b16 v[226:227], v13 offset:35328
v_mfma_f32_16x16x32_bf16 a[48:51], v[236:239], v[8:11], a[48:51]
v_accvgpr_read_b32 v201, a5
v_accvgpr_read_b32 v202, a6
v_mfma_f32_16x16x32_bf16 a[52:55], v[232:235], v[36:39], a[52:55]
v_accvgpr_read_b32 v203, a7
v_cvt_pk_bf16_f32 v48, v200, v201
v_mfma_f32_16x16x32_bf16 a[52:55], v[236:239], v[40:43], a[52:55]
v_cvt_pk_bf16_f32 v49, v202, v203
v_accvgpr_read_b32 v208, a8
v_mfma_f32_16x16x32_bf16 a[56:59], v[232:235], v[68:71], a[56:59]
ds_read_b64_tr_b16 v[228:229], v13 offset:49664
ds_read_b64_tr_b16 v[230:231], v13 offset:51712
v_mfma_f32_16x16x32_bf16 a[56:59], v[236:239], v[72:75], a[56:59]
v_accvgpr_read_b32 v209, a9
v_accvgpr_read_b32 v210, a10
v_mfma_f32_16x16x32_bf16 a[60:63], v[232:235], v[100:103], a[60:63]
v_accvgpr_read_b32 v211, a11
v_cvt_pk_bf16_f32 v80, v208, v209
v_mfma_f32_16x16x32_bf16 a[60:63], v[236:239], v[104:107], a[60:63]
s_waitcnt lgkmcnt(4)
v_cvt_pk_bf16_f32 v81, v210, v211
v_mfma_f32_16x16x32_bf16 a[48:51], v[240:243], v[128:131], a[48:51]
ds_read_b64_tr_b16 v[232:233], v249 offset:36864
ds_read_b64_tr_b16 v[234:235], v249 offset:38912
v_mfma_f32_16x16x32_bf16 a[48:51], v[244:247], v[144:147], a[48:51]
v_accvgpr_read_b32 v216, a12
v_accvgpr_read_b32 v217, a13
v_mfma_f32_16x16x32_bf16 a[52:55], v[240:243], v[132:135], a[52:55]
v_accvgpr_read_b32 v218, a14
v_accvgpr_read_b32 v219, a15
v_mfma_f32_16x16x32_bf16 a[52:55], v[244:247], v[148:151], a[52:55]
v_cvt_pk_bf16_f32 v112, v216, v217
v_cvt_pk_bf16_f32 v113, v218, v219
v_mfma_f32_16x16x32_bf16 a[56:59], v[240:243], v[136:139], a[56:59]
ds_read_b64_tr_b16 v[236:237], v249 offset:53248
ds_read_b64_tr_b16 v[238:239], v249 offset:55296
v_mfma_f32_16x16x32_bf16 a[56:59], v[244:247], v[152:155], a[56:59]
v_accvgpr_read_b32 v196, a16
v_accvgpr_read_b32 v197, a17
v_mfma_f32_16x16x32_bf16 a[60:63], v[240:243], v[140:143], a[60:63]
v_accvgpr_read_b32 v198, a18
v_accvgpr_read_b32 v199, a19
v_mfma_f32_16x16x32_bf16 a[60:63], v[244:247], v[156:159], a[60:63]
s_waitcnt lgkmcnt(4)
v_cvt_pk_bf16_f32 v18, v196, v197
v_mfma_f32_16x16x32_bf16 a[48:51], v[224:227], v[160:163], a[48:51]
ds_read_b64_tr_b16 v[240:241], v12 offset:4096
ds_read_b64_tr_b16 v[242:243], v12 offset:6144
v_mfma_f32_16x16x32_bf16 a[48:51], v[228:231], v[176:179], a[48:51]
v_cvt_pk_bf16_f32 v19, v198, v199
buffer_store_dwordx4 v[16:19], v252, s[20:23], s40 offen offset:0 sc1
v_mfma_f32_16x16x32_bf16 a[52:55], v[224:227], v[164:167], a[52:55]
v_accvgpr_read_b32 v204, a20
v_accvgpr_read_b32 v205, a21
v_mfma_f32_16x16x32_bf16 a[52:55], v[228:231], v[180:183], a[52:55]
v_accvgpr_read_b32 v206, a22
v_accvgpr_read_b32 v207, a23
v_mfma_f32_16x16x32_bf16 a[56:59], v[224:227], v[168:171], a[56:59]
ds_read_b64_tr_b16 v[244:245], v12 offset:20480
ds_read_b64_tr_b16 v[246:247], v12 offset:22528
v_mfma_f32_16x16x32_bf16 a[56:59], v[228:231], v[184:187], a[56:59]
v_cvt_pk_bf16_f32 v50, v204, v205
v_cvt_pk_bf16_f32 v51, v206, v207
v_mfma_f32_16x16x32_bf16 a[60:63], v[224:227], v[172:175], a[60:63]
buffer_store_dwordx4 v[48:51], v252, s[20:23], s41 offen offset:0 sc1
v_accvgpr_read_b32 v212, a24
v_mfma_f32_16x16x32_bf16 a[60:63], v[228:231], v[188:191], a[60:63]
s_waitcnt lgkmcnt(4)
v_accvgpr_read_b32 v213, a25
v_mfma_f32_16x16x32_bf16 a[64:67], v[232:235], v[4:7], a[64:67]
ds_read_b64_tr_b16 v[224:225], v12 offset:36864
ds_read_b64_tr_b16 v[226:227], v12 offset:38912
v_mfma_f32_16x16x32_bf16 a[64:67], v[236:239], v[8:11], a[64:67]
v_accvgpr_read_b32 v214, a26
v_accvgpr_read_b32 v215, a27
v_mfma_f32_16x16x32_bf16 a[68:71], v[232:235], v[36:39], a[68:71]
v_cvt_pk_bf16_f32 v82, v212, v213
v_cvt_pk_bf16_f32 v83, v214, v215
v_mfma_f32_16x16x32_bf16 a[68:71], v[236:239], v[40:43], a[68:71]
buffer_store_dwordx4 v[80:83], v252, s[20:23], s42 offen offset:0 sc1
v_accvgpr_read_b32 v220, a28
v_mfma_f32_16x16x32_bf16 a[72:75], v[232:235], v[68:71], a[72:75]
ds_read_b64_tr_b16 v[228:229], v12 offset:53248
ds_read_b64_tr_b16 v[230:231], v12 offset:55296
v_mfma_f32_16x16x32_bf16 a[72:75], v[236:239], v[72:75], a[72:75]
v_accvgpr_read_b32 v221, a29
v_accvgpr_read_b32 v222, a30
v_mfma_f32_16x16x32_bf16 a[76:79], v[232:235], v[100:103], a[76:79]
v_accvgpr_read_b32 v223, a31
v_cvt_pk_bf16_f32 v114, v220, v221
v_mfma_f32_16x16x32_bf16 a[76:79], v[236:239], v[104:107], a[76:79]
s_waitcnt lgkmcnt(4)
v_cvt_pk_bf16_f32 v115, v222, v223
v_mfma_f32_16x16x32_bf16 a[64:67], v[240:243], v[128:131], a[64:67]
ds_read_b64_tr_b16 v[232:233], v249 offset:4096
ds_read_b64_tr_b16 v[234:235], v249 offset:6144
v_mfma_f32_16x16x32_bf16 a[64:67], v[244:247], v[144:147], a[64:67]
buffer_store_dwordx4 v[112:115], v252, s[20:23], s43 offen offset:0 sc1
v_accvgpr_read_b32 v192, a32
v_mfma_f32_16x16x32_bf16 a[68:71], v[240:243], v[132:135], a[68:71]
v_accvgpr_read_b32 v193, a33
v_accvgpr_read_b32 v194, a34
v_mfma_f32_16x16x32_bf16 a[68:71], v[244:247], v[148:151], a[68:71]
v_accvgpr_read_b32 v195, a35
v_cvt_pk_bf16_f32 v20, v192, v193
v_mfma_f32_16x16x32_bf16 a[72:75], v[240:243], v[136:139], a[72:75]
ds_read_b64_tr_b16 v[236:237], v250 offset:4096
ds_read_b64_tr_b16 v[238:239], v250 offset:6144
v_mfma_f32_16x16x32_bf16 a[72:75], v[244:247], v[152:155], a[72:75]
v_cvt_pk_bf16_f32 v21, v194, v195
v_accvgpr_read_b32 v200, a36
v_mfma_f32_16x16x32_bf16 a[76:79], v[240:243], v[140:143], a[76:79]
v_accvgpr_read_b32 v201, a37
v_accvgpr_read_b32 v202, a38
v_mfma_f32_16x16x32_bf16 a[76:79], v[244:247], v[156:159], a[76:79]
s_waitcnt lgkmcnt(4)
v_accvgpr_read_b32 v203, a39
v_mfma_f32_16x16x32_bf16 a[64:67], v[224:227], v[160:163], a[64:67]
ds_read_b64_tr_b16 v[240:241], v250 offset:36864
ds_read_b64_tr_b16 v[242:243], v250 offset:38912
v_mfma_f32_16x16x32_bf16 a[64:67], v[228:231], v[176:179], a[64:67]
v_cvt_pk_bf16_f32 v52, v200, v201
v_cvt_pk_bf16_f32 v53, v202, v203
v_mfma_f32_16x16x32_bf16 a[68:71], v[224:227], v[164:167], a[68:71]
v_accvgpr_read_b32 v208, a40
v_accvgpr_read_b32 v209, a41
v_mfma_f32_16x16x32_bf16 a[68:71], v[228:231], v[180:183], a[68:71]
v_accvgpr_read_b32 v210, a42
v_accvgpr_read_b32 v211, a43
v_mfma_f32_16x16x32_bf16 a[72:75], v[224:227], v[168:171], a[72:75]
ds_read_b64_tr_b16 v[244:245], v250 offset:53248
ds_read_b64_tr_b16 v[246:247], v250 offset:55296
v_mfma_f32_16x16x32_bf16 a[72:75], v[228:231], v[184:187], a[72:75]
v_cvt_pk_bf16_f32 v84, v208, v209
v_cvt_pk_bf16_f32 v85, v210, v211
v_mfma_f32_16x16x32_bf16 a[76:79], v[224:227], v[172:175], a[76:79]
v_accvgpr_read_b32 v216, a44
v_accvgpr_read_b32 v217, a45
v_mfma_f32_16x16x32_bf16 a[76:79], v[228:231], v[188:191], a[76:79]
s_waitcnt lgkmcnt(4)
v_accvgpr_read_b32 v218, a46
v_mfma_f32_16x16x32_bf16 a[64:67], v[232:235], v[0:3], a[64:67]
ds_read_b64_tr_b16 v[224:225], v13 offset:4096
ds_read_b64_tr_b16 v[226:227], v13 offset:6144
v_mfma_f32_16x16x32_bf16 a[68:71], v[232:235], v[32:35], a[68:71]
v_accvgpr_read_b32 v219, a47
v_cvt_pk_bf16_f32 v116, v216, v217
v_mfma_f32_16x16x32_bf16 a[72:75], v[232:235], v[64:67], a[72:75]
v_cvt_pk_bf16_f32 v117, v218, v219
v_accvgpr_read_b32 v196, a48
v_mfma_f32_16x16x32_bf16 a[76:79], v[232:235], v[96:99], a[76:79]
v_accvgpr_read_b32 v197, a49
v_accvgpr_read_b32 v198, a50
v_mfma_f32_16x16x32_bf16 a[80:83], v[236:239], v[0:3], a[80:83]
ds_read_b64_tr_b16 v[228:229], v13 offset:20480
ds_read_b64_tr_b16 v[230:231], v13 offset:22528
v_mfma_f32_16x16x32_bf16 a[84:87], v[236:239], v[32:35], a[84:87]
v_accvgpr_read_b32 v199, a51
v_cvt_pk_bf16_f32 v22, v196, v197
v_mfma_f32_16x16x32_bf16 a[88:91], v[236:239], v[64:67], a[88:91]
v_cvt_pk_bf16_f32 v23, v198, v199
buffer_store_dwordx4 v[20:23], v252, s[20:23], s40 offen offset:1024 sc1
v_mfma_f32_16x16x32_bf16 a[92:95], v[236:239], v[96:99], a[92:95]
s_waitcnt lgkmcnt(4)
v_accvgpr_read_b32 v204, a52
v_mfma_f32_16x16x32_bf16 a[80:83], v[240:243], v[4:7], a[80:83]
ds_read_b64_tr_b16 v[232:233], v13 offset:36864
ds_read_b64_tr_b16 v[234:235], v13 offset:38912
v_mfma_f32_16x16x32_bf16 a[80:83], v[244:247], v[8:11], a[80:83]
v_accvgpr_read_b32 v205, a53
v_accvgpr_read_b32 v206, a54
v_mfma_f32_16x16x32_bf16 a[84:87], v[240:243], v[36:39], a[84:87]
v_accvgpr_read_b32 v207, a55
v_cvt_pk_bf16_f32 v54, v204, v205
v_mfma_f32_16x16x32_bf16 a[84:87], v[244:247], v[40:43], a[84:87]
v_cvt_pk_bf16_f32 v55, v206, v207
buffer_store_dwordx4 v[52:55], v252, s[20:23], s41 offen offset:1024 sc1
v_mfma_f32_16x16x32_bf16 a[88:91], v[240:243], v[68:71], a[88:91]
ds_read_b64_tr_b16 v[236:237], v13 offset:53248
ds_read_b64_tr_b16 v[238:239], v13 offset:55296
v_mfma_f32_16x16x32_bf16 a[88:91], v[244:247], v[72:75], a[88:91]
v_accvgpr_read_b32 v212, a56
v_accvgpr_read_b32 v213, a57
v_mfma_f32_16x16x32_bf16 a[92:95], v[240:243], v[100:103], a[92:95]
v_accvgpr_read_b32 v214, a58
v_accvgpr_read_b32 v215, a59
v_mfma_f32_16x16x32_bf16 a[92:95], v[244:247], v[104:107], a[92:95]
s_waitcnt lgkmcnt(4)
v_cvt_pk_bf16_f32 v86, v212, v213
v_mfma_f32_16x16x32_bf16 a[80:83], v[224:227], v[128:131], a[80:83]
ds_read_b64_tr_b16 v[240:241], v249 offset:37376
ds_read_b64_tr_b16 v[242:243], v249 offset:39424
v_mfma_f32_16x16x32_bf16 a[80:83], v[228:231], v[144:147], a[80:83]
v_cvt_pk_bf16_f32 v87, v214, v215
buffer_store_dwordx4 v[84:87], v252, s[20:23], s42 offen offset:1024 sc1
v_mfma_f32_16x16x32_bf16 a[84:87], v[224:227], v[132:135], a[84:87]
v_accvgpr_read_b32 v220, a60
v_accvgpr_read_b32 v221, a61
v_mfma_f32_16x16x32_bf16 a[84:87], v[228:231], v[148:151], a[84:87]
v_accvgpr_read_b32 v222, a62
v_accvgpr_read_b32 v223, a63
v_mfma_f32_16x16x32_bf16 a[88:91], v[224:227], v[136:139], a[88:91]
ds_read_b64_tr_b16 v[244:245], v249 offset:53760
ds_read_b64_tr_b16 v[246:247], v249 offset:55808
v_mfma_f32_16x16x32_bf16 a[88:91], v[228:231], v[152:155], a[88:91]
v_cvt_pk_bf16_f32 v118, v220, v221
v_cvt_pk_bf16_f32 v119, v222, v223
v_mfma_f32_16x16x32_bf16 a[92:95], v[224:227], v[140:143], a[92:95]
buffer_store_dwordx4 v[116:119], v252, s[20:23], s43 offen offset:1024 sc1
v_accvgpr_read_b32 v192, a64
v_mfma_f32_16x16x32_bf16 a[92:95], v[228:231], v[156:159], a[92:95]
s_waitcnt lgkmcnt(4)
v_accvgpr_read_b32 v193, a65
v_mfma_f32_16x16x32_bf16 a[80:83], v[232:235], v[160:163], a[80:83]
ds_read_b64_tr_b16 v[224:225], v12 offset:4608
ds_read_b64_tr_b16 v[226:227], v12 offset:6656
v_mfma_f32_16x16x32_bf16 a[80:83], v[236:239], v[176:179], a[80:83]
v_accvgpr_read_b32 v194, a66
v_accvgpr_read_b32 v195, a67
v_mfma_f32_16x16x32_bf16 a[84:87], v[232:235], v[164:167], a[84:87]
v_cvt_pk_bf16_f32 v24, v192, v193
v_cvt_pk_bf16_f32 v25, v194, v195
v_mfma_f32_16x16x32_bf16 a[84:87], v[236:239], v[180:183], a[84:87]
v_accvgpr_read_b32 v200, a68
v_accvgpr_read_b32 v201, a69
v_mfma_f32_16x16x32_bf16 a[88:91], v[232:235], v[168:171], a[88:91]
ds_read_b64_tr_b16 v[228:229], v12 offset:20992
ds_read_b64_tr_b16 v[230:231], v12 offset:23040
v_mfma_f32_16x16x32_bf16 a[88:91], v[236:239], v[184:187], a[88:91]
v_accvgpr_read_b32 v202, a70
v_accvgpr_read_b32 v203, a71
v_mfma_f32_16x16x32_bf16 a[92:95], v[232:235], v[172:175], a[92:95]
v_cvt_pk_bf16_f32 v56, v200, v201
v_cvt_pk_bf16_f32 v57, v202, v203
v_mfma_f32_16x16x32_bf16 a[92:95], v[236:239], v[188:191], a[92:95]
s_waitcnt lgkmcnt(4)
v_accvgpr_read_b32 v208, a72
v_mfma_f32_16x16x32_bf16 a[96:99], v[240:243], v[4:7], a[96:99]
ds_read_b64_tr_b16 v[232:233], v12 offset:37376
ds_read_b64_tr_b16 v[234:235], v12 offset:39424
v_mfma_f32_16x16x32_bf16 a[96:99], v[244:247], v[8:11], a[96:99]
v_accvgpr_read_b32 v209, a73
v_accvgpr_read_b32 v210, a74
v_mfma_f32_16x16x32_bf16 a[100:103], v[240:243], v[36:39], a[100:103]
v_accvgpr_read_b32 v211, a75
v_cvt_pk_bf16_f32 v88, v208, v209
v_mfma_f32_16x16x32_bf16 a[100:103], v[244:247], v[40:43], a[100:103]
v_cvt_pk_bf16_f32 v89, v210, v211
v_accvgpr_read_b32 v216, a76
v_mfma_f32_16x16x32_bf16 a[104:107], v[240:243], v[68:71], a[104:107]
ds_read_b64_tr_b16 v[236:237], v12 offset:53760
ds_read_b64_tr_b16 v[238:239], v12 offset:55808
v_mfma_f32_16x16x32_bf16 a[104:107], v[244:247], v[72:75], a[104:107]
v_accvgpr_read_b32 v217, a77
v_accvgpr_read_b32 v218, a78
v_mfma_f32_16x16x32_bf16 a[108:111], v[240:243], v[100:103], a[108:111]
v_accvgpr_read_b32 v219, a79
v_cvt_pk_bf16_f32 v120, v216, v217
v_mfma_f32_16x16x32_bf16 a[108:111], v[244:247], v[104:107], a[108:111]
s_waitcnt lgkmcnt(4)
v_cvt_pk_bf16_f32 v121, v218, v219
v_mfma_f32_16x16x32_bf16 a[96:99], v[224:227], v[128:131], a[96:99]
ds_read_b64_tr_b16 v[240:241], v249 offset:4608
ds_read_b64_tr_b16 v[242:243], v249 offset:6656
v_mfma_f32_16x16x32_bf16 a[96:99], v[228:231], v[144:147], a[96:99]
v_accvgpr_read_b32 v196, a80
v_accvgpr_read_b32 v197, a81
v_mfma_f32_16x16x32_bf16 a[100:103], v[224:227], v[132:135], a[100:103]
v_accvgpr_read_b32 v198, a82
v_accvgpr_read_b32 v199, a83
v_mfma_f32_16x16x32_bf16 a[100:103], v[228:231], v[148:151], a[100:103]
v_cvt_pk_bf16_f32 v26, v196, v197
v_cvt_pk_bf16_f32 v27, v198, v199
v_mfma_f32_16x16x32_bf16 a[104:107], v[224:227], v[136:139], a[104:107]
ds_read_b64_tr_b16 v[244:245], v250 offset:4608
ds_read_b64_tr_b16 v[246:247], v250 offset:6656
v_mfma_f32_16x16x32_bf16 a[104:107], v[228:231], v[152:155], a[104:107]
buffer_store_dwordx4 v[24:27], v252, s[20:23], s40 offen offset:2048 sc1
v_accvgpr_read_b32 v204, a84
v_mfma_f32_16x16x32_bf16 a[108:111], v[224:227], v[140:143], a[108:111]
v_accvgpr_read_b32 v205, a85
v_accvgpr_read_b32 v206, a86
v_mfma_f32_16x16x32_bf16 a[108:111], v[228:231], v[156:159], a[108:111]
s_waitcnt lgkmcnt(4)
v_accvgpr_read_b32 v207, a87
v_mfma_f32_16x16x32_bf16 a[96:99], v[232:235], v[160:163], a[96:99]
ds_read_b64_tr_b16 v[224:225], v250 offset:37376
ds_read_b64_tr_b16 v[226:227], v250 offset:39424
v_mfma_f32_16x16x32_bf16 a[96:99], v[236:239], v[176:179], a[96:99]
v_cvt_pk_bf16_f32 v58, v204, v205
v_cvt_pk_bf16_f32 v59, v206, v207
v_mfma_f32_16x16x32_bf16 a[100:103], v[232:235], v[164:167], a[100:103]
buffer_store_dwordx4 v[56:59], v252, s[20:23], s41 offen offset:2048 sc1
v_accvgpr_read_b32 v212, a88
v_mfma_f32_16x16x32_bf16 a[100:103], v[236:239], v[180:183], a[100:103]
v_accvgpr_read_b32 v213, a89
v_accvgpr_read_b32 v214, a90
v_mfma_f32_16x16x32_bf16 a[104:107], v[232:235], v[168:171], a[104:107]
ds_read_b64_tr_b16 v[228:229], v250 offset:53760
ds_read_b64_tr_b16 v[230:231], v250 offset:55808
v_mfma_f32_16x16x32_bf16 a[104:107], v[236:239], v[184:187], a[104:107]
v_accvgpr_read_b32 v215, a91
v_cvt_pk_bf16_f32 v90, v212, v213
v_mfma_f32_16x16x32_bf16 a[108:111], v[232:235], v[172:175], a[108:111]
v_cvt_pk_bf16_f32 v91, v214, v215
buffer_store_dwordx4 v[88:91], v252, s[20:23], s42 offen offset:2048 sc1
v_mfma_f32_16x16x32_bf16 a[108:111], v[236:239], v[188:191], a[108:111]
s_waitcnt lgkmcnt(4)
v_accvgpr_read_b32 v220, a92
v_mfma_f32_16x16x32_bf16 a[96:99], v[240:243], v[0:3], a[96:99]
ds_read_b64_tr_b16 v[232:233], v13 offset:4608
ds_read_b64_tr_b16 v[234:235], v13 offset:6656
v_mfma_f32_16x16x32_bf16 a[100:103], v[240:243], v[32:35], a[100:103]
v_accvgpr_read_b32 v221, a93
v_accvgpr_read_b32 v222, a94
v_mfma_f32_16x16x32_bf16 a[104:107], v[240:243], v[64:67], a[104:107]
v_accvgpr_read_b32 v223, a95
v_cvt_pk_bf16_f32 v122, v220, v221
v_mfma_f32_16x16x32_bf16 a[108:111], v[240:243], v[96:99], a[108:111]
v_cvt_pk_bf16_f32 v123, v222, v223
buffer_store_dwordx4 v[120:123], v252, s[20:23], s43 offen offset:2048 sc1
v_mfma_f32_16x16x32_bf16 a[112:115], v[244:247], v[0:3], a[112:115]
ds_read_b64_tr_b16 v[236:237], v13 offset:20992
ds_read_b64_tr_b16 v[238:239], v13 offset:23040
v_mfma_f32_16x16x32_bf16 a[116:119], v[244:247], v[32:35], a[116:119]
v_accvgpr_read_b32 v192, a96
v_accvgpr_read_b32 v193, a97
v_mfma_f32_16x16x32_bf16 a[120:123], v[244:247], v[64:67], a[120:123]
v_accvgpr_read_b32 v194, a98
v_accvgpr_read_b32 v195, a99
v_mfma_f32_16x16x32_bf16 a[124:127], v[244:247], v[96:99], a[124:127]
s_waitcnt lgkmcnt(4)
v_cvt_pk_bf16_f32 v28, v192, v193
v_mfma_f32_16x16x32_bf16 a[112:115], v[224:227], v[4:7], a[112:115]
ds_read_b64_tr_b16 v[240:241], v13 offset:37376
ds_read_b64_tr_b16 v[242:243], v13 offset:39424
v_mfma_f32_16x16x32_bf16 a[112:115], v[228:231], v[8:11], a[112:115]
v_cvt_pk_bf16_f32 v29, v194, v195
v_accvgpr_read_b32 v200, a100
v_mfma_f32_16x16x32_bf16 a[116:119], v[224:227], v[36:39], a[116:119]
v_accvgpr_read_b32 v201, a101
v_accvgpr_read_b32 v202, a102
v_mfma_f32_16x16x32_bf16 a[116:119], v[228:231], v[40:43], a[116:119]
v_accvgpr_read_b32 v203, a103
v_cvt_pk_bf16_f32 v60, v200, v201
v_mfma_f32_16x16x32_bf16 a[120:123], v[224:227], v[68:71], a[120:123]
ds_read_b64_tr_b16 v[244:245], v13 offset:53760
ds_read_b64_tr_b16 v[246:247], v13 offset:55808
v_mfma_f32_16x16x32_bf16 a[120:123], v[228:231], v[72:75], a[120:123]
v_cvt_pk_bf16_f32 v61, v202, v203
v_accvgpr_read_b32 v208, a104
v_mfma_f32_16x16x32_bf16 a[124:127], v[224:227], v[100:103], a[124:127]
v_accvgpr_read_b32 v209, a105
v_accvgpr_read_b32 v210, a106
v_mfma_f32_16x16x32_bf16 a[124:127], v[228:231], v[104:107], a[124:127]
s_waitcnt lgkmcnt(4)
v_accvgpr_read_b32 v211, a107
v_mfma_f32_16x16x32_bf16 a[112:115], v[232:235], v[128:131], a[112:115]
ds_read_b64_tr_b16 v[224:225], v249 offset:40960
ds_read_b64_tr_b16 v[226:227], v249 offset:43008
v_mfma_f32_16x16x32_bf16 a[112:115], v[236:239], v[144:147], a[112:115]
v_cvt_pk_bf16_f32 v92, v208, v209
v_cvt_pk_bf16_f32 v93, v210, v211
v_mfma_f32_16x16x32_bf16 a[116:119], v[232:235], v[132:135], a[116:119]
v_accvgpr_read_b32 v216, a108
v_accvgpr_read_b32 v217, a109
v_mfma_f32_16x16x32_bf16 a[116:119], v[236:239], v[148:151], a[116:119]
v_accvgpr_read_b32 v218, a110
v_accvgpr_read_b32 v219, a111
v_mfma_f32_16x16x32_bf16 a[120:123], v[232:235], v[136:139], a[120:123]
ds_read_b64_tr_b16 v[228:229], v249 offset:57344
ds_read_b64_tr_b16 v[230:231], v249 offset:59392
v_mfma_f32_16x16x32_bf16 a[120:123], v[236:239], v[152:155], a[120:123]
v_cvt_pk_bf16_f32 v124, v216, v217
v_cvt_pk_bf16_f32 v125, v218, v219
v_mfma_f32_16x16x32_bf16 a[124:127], v[232:235], v[140:143], a[124:127]
v_mfma_f32_16x16x32_bf16 a[124:127], v[236:239], v[156:159], a[124:127]
s_waitcnt lgkmcnt(4)
v_mfma_f32_16x16x32_bf16 a[112:115], v[240:243], v[160:163], a[112:115]
ds_read_b64_tr_b16 v[232:233], v12 offset:8192
ds_read_b64_tr_b16 v[234:235], v12 offset:10240
v_mfma_f32_16x16x32_bf16 a[112:115], v[244:247], v[176:179], a[112:115]
v_mfma_f32_16x16x32_bf16 a[116:119], v[240:243], v[164:167], a[116:119]
v_mfma_f32_16x16x32_bf16 a[116:119], v[244:247], v[180:183], a[116:119]
v_mfma_f32_16x16x32_bf16 a[120:123], v[240:243], v[168:171], a[120:123]
ds_read_b64_tr_b16 v[236:237], v12 offset:24576
ds_read_b64_tr_b16 v[238:239], v12 offset:26624
v_mfma_f32_16x16x32_bf16 a[120:123], v[244:247], v[184:187], a[120:123]
v_mfma_f32_16x16x32_bf16 a[124:127], v[240:243], v[172:175], a[124:127]
s_nop 0
v_accvgpr_read_b32 v196, a112
v_accvgpr_read_b32 v197, a113
v_mfma_f32_16x16x32_bf16 a[124:127], v[244:247], v[188:191], a[124:127]
s_waitcnt lgkmcnt(4)
v_accvgpr_read_b32 v198, a114
v_mfma_f32_16x16x32_bf16 a[128:131], v[224:227], v[4:7], a[128:131]
ds_read_b64_tr_b16 v[240:241], v12 offset:40960
ds_read_b64_tr_b16 v[242:243], v12 offset:43008
v_mfma_f32_16x16x32_bf16 a[128:131], v[228:231], v[8:11], a[128:131]
v_accvgpr_read_b32 v199, a115
v_cvt_pk_bf16_f32 v30, v196, v197
v_mfma_f32_16x16x32_bf16 a[132:135], v[224:227], v[36:39], a[132:135]
v_cvt_pk_bf16_f32 v31, v198, v199
buffer_store_dwordx4 v[28:31], v252, s[20:23], s40 offen offset:3072 sc1
v_mfma_f32_16x16x32_bf16 a[132:135], v[228:231], v[40:43], a[132:135]
v_accvgpr_read_b32 v204, a116
v_accvgpr_read_b32 v205, a117
v_mfma_f32_16x16x32_bf16 a[136:139], v[224:227], v[68:71], a[136:139]
ds_read_b64_tr_b16 v[244:245], v12 offset:57344
ds_read_b64_tr_b16 v[246:247], v12 offset:59392
v_mfma_f32_16x16x32_bf16 a[136:139], v[228:231], v[72:75], a[136:139]
v_accvgpr_read_b32 v206, a118
v_accvgpr_read_b32 v207, a119
v_mfma_f32_16x16x32_bf16 a[140:143], v[224:227], v[100:103], a[140:143]
v_cvt_pk_bf16_f32 v62, v204, v205
v_cvt_pk_bf16_f32 v63, v206, v207
v_mfma_f32_16x16x32_bf16 a[140:143], v[228:231], v[104:107], a[140:143]
s_waitcnt lgkmcnt(4)
buffer_store_dwordx4 v[60:63], v252, s[20:23], s41 offen offset:3072 sc1
v_mfma_f32_16x16x32_bf16 a[128:131], v[232:235], v[128:131], a[128:131]
ds_read_b64_tr_b16 v[224:225], v249 offset:8192
ds_read_b64_tr_b16 v[226:227], v249 offset:10240
v_mfma_f32_16x16x32_bf16 a[128:131], v[236:239], v[144:147], a[128:131]
v_accvgpr_read_b32 v212, a120
v_accvgpr_read_b32 v213, a121
v_mfma_f32_16x16x32_bf16 a[132:135], v[232:235], v[132:135], a[132:135]
v_accvgpr_read_b32 v214, a122
v_accvgpr_read_b32 v215, a123
v_mfma_f32_16x16x32_bf16 a[132:135], v[236:239], v[148:151], a[132:135]
v_cvt_pk_bf16_f32 v94, v212, v213
v_cvt_pk_bf16_f32 v95, v214, v215
v_mfma_f32_16x16x32_bf16 a[136:139], v[232:235], v[136:139], a[136:139]
ds_read_b64_tr_b16 v[228:229], v250 offset:8192
ds_read_b64_tr_b16 v[230:231], v250 offset:10240
v_mfma_f32_16x16x32_bf16 a[136:139], v[236:239], v[152:155], a[136:139]
buffer_store_dwordx4 v[92:95], v252, s[20:23], s42 offen offset:3072 sc1
v_accvgpr_read_b32 v220, a124
v_mfma_f32_16x16x32_bf16 a[140:143], v[232:235], v[140:143], a[140:143]
v_accvgpr_read_b32 v221, a125
v_accvgpr_read_b32 v222, a126
v_mfma_f32_16x16x32_bf16 a[140:143], v[236:239], v[156:159], a[140:143]
s_waitcnt lgkmcnt(4)
v_accvgpr_read_b32 v223, a127
v_mfma_f32_16x16x32_bf16 a[128:131], v[240:243], v[160:163], a[128:131]
ds_read_b64_tr_b16 v[232:233], v250 offset:40960
ds_read_b64_tr_b16 v[234:235], v250 offset:43008
v_mfma_f32_16x16x32_bf16 a[128:131], v[244:247], v[176:179], a[128:131]
v_cvt_pk_bf16_f32 v126, v220, v221
v_cvt_pk_bf16_f32 v127, v222, v223
v_mfma_f32_16x16x32_bf16 a[132:135], v[240:243], v[164:167], a[132:135]
buffer_store_dwordx4 v[124:127], v252, s[20:23], s43 offen offset:3072 sc1
v_mfma_f32_16x16x32_bf16 a[132:135], v[244:247], v[180:183], a[132:135]
v_mfma_f32_16x16x32_bf16 a[136:139], v[240:243], v[168:171], a[136:139]
ds_read_b64_tr_b16 v[236:237], v250 offset:57344
ds_read_b64_tr_b16 v[238:239], v250 offset:59392
v_mfma_f32_16x16x32_bf16 a[136:139], v[244:247], v[184:187], a[136:139]
v_mfma_f32_16x16x32_bf16 a[140:143], v[240:243], v[172:175], a[140:143]
v_mfma_f32_16x16x32_bf16 a[140:143], v[244:247], v[188:191], a[140:143]
s_waitcnt lgkmcnt(4)
v_mfma_f32_16x16x32_bf16 a[128:131], v[224:227], v[0:3], a[128:131]
ds_read_b64_tr_b16 v[240:241], v13 offset:8192
ds_read_b64_tr_b16 v[242:243], v13 offset:10240
v_mfma_f32_16x16x32_bf16 a[132:135], v[224:227], v[32:35], a[132:135]
v_mfma_f32_16x16x32_bf16 a[136:139], v[224:227], v[64:67], a[136:139]
v_mfma_f32_16x16x32_bf16 a[140:143], v[224:227], v[96:99], a[140:143]
v_mfma_f32_16x16x32_bf16 a[144:147], v[228:231], v[0:3], a[144:147]
ds_read_b64_tr_b16 v[244:245], v13 offset:24576
ds_read_b64_tr_b16 v[246:247], v13 offset:26624
v_mfma_f32_16x16x32_bf16 a[148:151], v[228:231], v[32:35], a[148:151]
v_accvgpr_read_b32 v192, a128
v_accvgpr_read_b32 v193, a129
v_mfma_f32_16x16x32_bf16 a[152:155], v[228:231], v[64:67], a[152:155]
v_accvgpr_read_b32 v194, a130
v_accvgpr_read_b32 v195, a131
v_mfma_f32_16x16x32_bf16 a[156:159], v[228:231], v[96:99], a[156:159]
s_waitcnt lgkmcnt(4)
v_cvt_pk_bf16_f32 v16, v192, v193
v_mfma_f32_16x16x32_bf16 a[144:147], v[232:235], v[4:7], a[144:147]
ds_read_b64_tr_b16 v[224:225], v13 offset:40960
ds_read_b64_tr_b16 v[226:227], v13 offset:43008
v_mfma_f32_16x16x32_bf16 a[144:147], v[236:239], v[8:11], a[144:147]
v_cvt_pk_bf16_f32 v17, v194, v195
v_accvgpr_read_b32 v200, a132
v_mfma_f32_16x16x32_bf16 a[148:151], v[232:235], v[36:39], a[148:151]
v_accvgpr_read_b32 v201, a133
v_accvgpr_read_b32 v202, a134
v_mfma_f32_16x16x32_bf16 a[148:151], v[236:239], v[40:43], a[148:151]
v_accvgpr_read_b32 v203, a135
v_cvt_pk_bf16_f32 v48, v200, v201
v_mfma_f32_16x16x32_bf16 a[152:155], v[232:235], v[68:71], a[152:155]
ds_read_b64_tr_b16 v[228:229], v13 offset:57344
ds_read_b64_tr_b16 v[230:231], v13 offset:59392
v_mfma_f32_16x16x32_bf16 a[152:155], v[236:239], v[72:75], a[152:155]
v_cvt_pk_bf16_f32 v49, v202, v203
v_accvgpr_read_b32 v208, a136
v_mfma_f32_16x16x32_bf16 a[156:159], v[232:235], v[100:103], a[156:159]
v_accvgpr_read_b32 v209, a137
v_accvgpr_read_b32 v210, a138
v_mfma_f32_16x16x32_bf16 a[156:159], v[236:239], v[104:107], a[156:159]
s_waitcnt lgkmcnt(4)
v_accvgpr_read_b32 v211, a139
v_mfma_f32_16x16x32_bf16 a[144:147], v[240:243], v[128:131], a[144:147]
ds_read_b64_tr_b16 v[232:233], v249 offset:41472
ds_read_b64_tr_b16 v[234:235], v249 offset:43520
v_mfma_f32_16x16x32_bf16 a[144:147], v[244:247], v[144:147], a[144:147]
v_cvt_pk_bf16_f32 v80, v208, v209
v_cvt_pk_bf16_f32 v81, v210, v211
v_mfma_f32_16x16x32_bf16 a[148:151], v[240:243], v[132:135], a[148:151]
v_accvgpr_read_b32 v216, a140
v_accvgpr_read_b32 v217, a141
v_mfma_f32_16x16x32_bf16 a[148:151], v[244:247], v[148:151], a[148:151]
v_accvgpr_read_b32 v218, a142
v_accvgpr_read_b32 v219, a143
v_mfma_f32_16x16x32_bf16 a[152:155], v[240:243], v[136:139], a[152:155]
ds_read_b64_tr_b16 v[236:237], v249 offset:57856
ds_read_b64_tr_b16 v[238:239], v249 offset:59904
v_mfma_f32_16x16x32_bf16 a[152:155], v[244:247], v[152:155], a[152:155]
v_cvt_pk_bf16_f32 v112, v216, v217
v_cvt_pk_bf16_f32 v113, v218, v219
v_mfma_f32_16x16x32_bf16 a[156:159], v[240:243], v[140:143], a[156:159]
v_mfma_f32_16x16x32_bf16 a[156:159], v[244:247], v[156:159], a[156:159]
s_waitcnt lgkmcnt(4)
v_mfma_f32_16x16x32_bf16 a[144:147], v[224:227], v[160:163], a[144:147]
ds_read_b64_tr_b16 v[240:241], v12 offset:8704
ds_read_b64_tr_b16 v[242:243], v12 offset:10752
v_mfma_f32_16x16x32_bf16 a[144:147], v[228:231], v[176:179], a[144:147]
v_mfma_f32_16x16x32_bf16 a[148:151], v[224:227], v[164:167], a[148:151]
v_mfma_f32_16x16x32_bf16 a[148:151], v[228:231], v[180:183], a[148:151]
v_mfma_f32_16x16x32_bf16 a[152:155], v[224:227], v[168:171], a[152:155]
ds_read_b64_tr_b16 v[244:245], v12 offset:25088
ds_read_b64_tr_b16 v[246:247], v12 offset:27136
v_mfma_f32_16x16x32_bf16 a[152:155], v[228:231], v[184:187], a[152:155]
v_mfma_f32_16x16x32_bf16 a[156:159], v[224:227], v[172:175], a[156:159]
s_nop 0
v_accvgpr_read_b32 v196, a144
v_accvgpr_read_b32 v197, a145
v_mfma_f32_16x16x32_bf16 a[156:159], v[228:231], v[188:191], a[156:159]
s_waitcnt lgkmcnt(4)
v_accvgpr_read_b32 v198, a146
v_mfma_f32_16x16x32_bf16 a[160:163], v[232:235], v[4:7], a[160:163]
ds_read_b64_tr_b16 v[224:225], v12 offset:41472
ds_read_b64_tr_b16 v[226:227], v12 offset:43520
v_mfma_f32_16x16x32_bf16 a[160:163], v[236:239], v[8:11], a[160:163]
v_accvgpr_read_b32 v199, a147
v_cvt_pk_bf16_f32 v18, v196, v197
v_mfma_f32_16x16x32_bf16 a[164:167], v[232:235], v[36:39], a[164:167]
v_cvt_pk_bf16_f32 v19, v198, v199
buffer_store_dwordx4 v[16:19], v252, s[20:23], s44 offen offset:0 sc1
v_mfma_f32_16x16x32_bf16 a[164:167], v[236:239], v[40:43], a[164:167]
v_accvgpr_read_b32 v204, a148
v_accvgpr_read_b32 v205, a149
v_mfma_f32_16x16x32_bf16 a[168:171], v[232:235], v[68:71], a[168:171]
ds_read_b64_tr_b16 v[228:229], v12 offset:57856
ds_read_b64_tr_b16 v[230:231], v12 offset:59904
v_mfma_f32_16x16x32_bf16 a[168:171], v[236:239], v[72:75], a[168:171]
v_accvgpr_read_b32 v206, a150
v_accvgpr_read_b32 v207, a151
v_mfma_f32_16x16x32_bf16 a[172:175], v[232:235], v[100:103], a[172:175]
v_cvt_pk_bf16_f32 v50, v204, v205
v_cvt_pk_bf16_f32 v51, v206, v207
v_mfma_f32_16x16x32_bf16 a[172:175], v[236:239], v[104:107], a[172:175]
s_waitcnt lgkmcnt(4)
buffer_store_dwordx4 v[48:51], v252, s[20:23], s45 offen offset:0 sc1
v_mfma_f32_16x16x32_bf16 a[160:163], v[240:243], v[128:131], a[160:163]
ds_read_b64_tr_b16 v[232:233], v249 offset:8704
ds_read_b64_tr_b16 v[234:235], v249 offset:10752
v_mfma_f32_16x16x32_bf16 a[160:163], v[244:247], v[144:147], a[160:163]
v_accvgpr_read_b32 v212, a152
v_accvgpr_read_b32 v213, a153
v_mfma_f32_16x16x32_bf16 a[164:167], v[240:243], v[132:135], a[164:167]
v_accvgpr_read_b32 v214, a154
v_accvgpr_read_b32 v215, a155
v_mfma_f32_16x16x32_bf16 a[164:167], v[244:247], v[148:151], a[164:167]
v_cvt_pk_bf16_f32 v82, v212, v213
v_cvt_pk_bf16_f32 v83, v214, v215
v_mfma_f32_16x16x32_bf16 a[168:171], v[240:243], v[136:139], a[168:171]
ds_read_b64_tr_b16 v[236:237], v250 offset:8704
ds_read_b64_tr_b16 v[238:239], v250 offset:10752
v_mfma_f32_16x16x32_bf16 a[168:171], v[244:247], v[152:155], a[168:171]
buffer_store_dwordx4 v[80:83], v252, s[20:23], s46 offen offset:0 sc1
v_accvgpr_read_b32 v220, a156
v_mfma_f32_16x16x32_bf16 a[172:175], v[240:243], v[140:143], a[172:175]
v_accvgpr_read_b32 v221, a157
v_accvgpr_read_b32 v222, a158
v_mfma_f32_16x16x32_bf16 a[172:175], v[244:247], v[156:159], a[172:175]
s_waitcnt lgkmcnt(4)
v_accvgpr_read_b32 v223, a159
v_mfma_f32_16x16x32_bf16 a[160:163], v[224:227], v[160:163], a[160:163]
ds_read_b64_tr_b16 v[240:241], v250 offset:41472
ds_read_b64_tr_b16 v[242:243], v250 offset:43520
v_mfma_f32_16x16x32_bf16 a[160:163], v[228:231], v[176:179], a[160:163]
v_cvt_pk_bf16_f32 v114, v220, v221
v_cvt_pk_bf16_f32 v115, v222, v223
v_mfma_f32_16x16x32_bf16 a[164:167], v[224:227], v[164:167], a[164:167]
buffer_store_dwordx4 v[112:115], v252, s[20:23], s47 offen offset:0 sc1
v_mfma_f32_16x16x32_bf16 a[164:167], v[228:231], v[180:183], a[164:167]
v_mfma_f32_16x16x32_bf16 a[168:171], v[224:227], v[168:171], a[168:171]
ds_read_b64_tr_b16 v[244:245], v250 offset:57856
ds_read_b64_tr_b16 v[246:247], v250 offset:59904
v_mfma_f32_16x16x32_bf16 a[168:171], v[228:231], v[184:187], a[168:171]
v_mfma_f32_16x16x32_bf16 a[172:175], v[224:227], v[172:175], a[172:175]
v_mfma_f32_16x16x32_bf16 a[172:175], v[228:231], v[188:191], a[172:175]
s_waitcnt lgkmcnt(4)
v_mfma_f32_16x16x32_bf16 a[160:163], v[232:235], v[0:3], a[160:163]
ds_read_b64_tr_b16 v[224:225], v13 offset:8704
ds_read_b64_tr_b16 v[226:227], v13 offset:10752
v_mfma_f32_16x16x32_bf16 a[164:167], v[232:235], v[32:35], a[164:167]
v_mfma_f32_16x16x32_bf16 a[168:171], v[232:235], v[64:67], a[168:171]
v_mfma_f32_16x16x32_bf16 a[172:175], v[232:235], v[96:99], a[172:175]
v_mfma_f32_16x16x32_bf16 a[176:179], v[236:239], v[0:3], a[176:179]
ds_read_b64_tr_b16 v[228:229], v13 offset:25088
ds_read_b64_tr_b16 v[230:231], v13 offset:27136
v_mfma_f32_16x16x32_bf16 a[180:183], v[236:239], v[32:35], a[180:183]
v_accvgpr_read_b32 v192, a160
v_accvgpr_read_b32 v193, a161
v_mfma_f32_16x16x32_bf16 a[184:187], v[236:239], v[64:67], a[184:187]
v_accvgpr_read_b32 v194, a162
v_accvgpr_read_b32 v195, a163
v_mfma_f32_16x16x32_bf16 a[188:191], v[236:239], v[96:99], a[188:191]
s_waitcnt lgkmcnt(4)
v_cvt_pk_bf16_f32 v20, v192, v193
v_mfma_f32_16x16x32_bf16 a[176:179], v[240:243], v[4:7], a[176:179]
ds_read_b64_tr_b16 v[232:233], v13 offset:41472
ds_read_b64_tr_b16 v[234:235], v13 offset:43520
v_mfma_f32_16x16x32_bf16 a[176:179], v[244:247], v[8:11], a[176:179]
v_cvt_pk_bf16_f32 v21, v194, v195
v_accvgpr_read_b32 v200, a164
v_mfma_f32_16x16x32_bf16 a[180:183], v[240:243], v[36:39], a[180:183]
v_accvgpr_read_b32 v201, a165
v_accvgpr_read_b32 v202, a166
v_mfma_f32_16x16x32_bf16 a[180:183], v[244:247], v[40:43], a[180:183]
v_accvgpr_read_b32 v203, a167
v_cvt_pk_bf16_f32 v52, v200, v201
v_mfma_f32_16x16x32_bf16 a[184:187], v[240:243], v[68:71], a[184:187]
ds_read_b64_tr_b16 v[236:237], v13 offset:57856
ds_read_b64_tr_b16 v[238:239], v13 offset:59904
v_mfma_f32_16x16x32_bf16 a[184:187], v[244:247], v[72:75], a[184:187]
v_cvt_pk_bf16_f32 v53, v202, v203
v_accvgpr_read_b32 v208, a168
v_mfma_f32_16x16x32_bf16 a[188:191], v[240:243], v[100:103], a[188:191]
v_accvgpr_read_b32 v209, a169
v_accvgpr_read_b32 v210, a170
v_mfma_f32_16x16x32_bf16 a[188:191], v[244:247], v[104:107], a[188:191]
s_waitcnt lgkmcnt(4)
v_accvgpr_read_b32 v211, a171
v_mfma_f32_16x16x32_bf16 a[176:179], v[224:227], v[128:131], a[176:179]
ds_read_b64_tr_b16 v[240:241], v249 offset:45056
ds_read_b64_tr_b16 v[242:243], v249 offset:47104
v_mfma_f32_16x16x32_bf16 a[176:179], v[228:231], v[144:147], a[176:179]
v_cvt_pk_bf16_f32 v84, v208, v209
v_cvt_pk_bf16_f32 v85, v210, v211
v_mfma_f32_16x16x32_bf16 a[180:183], v[224:227], v[132:135], a[180:183]
v_accvgpr_read_b32 v216, a172
v_accvgpr_read_b32 v217, a173
v_mfma_f32_16x16x32_bf16 a[180:183], v[228:231], v[148:151], a[180:183]
v_accvgpr_read_b32 v218, a174
v_accvgpr_read_b32 v219, a175
v_mfma_f32_16x16x32_bf16 a[184:187], v[224:227], v[136:139], a[184:187]
ds_read_b64_tr_b16 v[244:245], v249 offset:61440
ds_read_b64_tr_b16 v[246:247], v249 offset:63488
v_mfma_f32_16x16x32_bf16 a[184:187], v[228:231], v[152:155], a[184:187]
v_cvt_pk_bf16_f32 v116, v216, v217
v_cvt_pk_bf16_f32 v117, v218, v219
v_mfma_f32_16x16x32_bf16 a[188:191], v[224:227], v[140:143], a[188:191]
v_mfma_f32_16x16x32_bf16 a[188:191], v[228:231], v[156:159], a[188:191]
s_waitcnt lgkmcnt(4)
v_mfma_f32_16x16x32_bf16 a[176:179], v[232:235], v[160:163], a[176:179]
ds_read_b64_tr_b16 v[224:225], v12 offset:12288
ds_read_b64_tr_b16 v[226:227], v12 offset:14336
v_mfma_f32_16x16x32_bf16 a[176:179], v[236:239], v[176:179], a[176:179]
v_mfma_f32_16x16x32_bf16 a[180:183], v[232:235], v[164:167], a[180:183]
v_mfma_f32_16x16x32_bf16 a[180:183], v[236:239], v[180:183], a[180:183]
v_mfma_f32_16x16x32_bf16 a[184:187], v[232:235], v[168:171], a[184:187]
ds_read_b64_tr_b16 v[228:229], v12 offset:28672
ds_read_b64_tr_b16 v[230:231], v12 offset:30720
v_mfma_f32_16x16x32_bf16 a[184:187], v[236:239], v[184:187], a[184:187]
v_mfma_f32_16x16x32_bf16 a[188:191], v[232:235], v[172:175], a[188:191]
s_nop 0
v_accvgpr_read_b32 v196, a176
v_accvgpr_read_b32 v197, a177
v_mfma_f32_16x16x32_bf16 a[188:191], v[236:239], v[188:191], a[188:191]
s_waitcnt lgkmcnt(4)
v_accvgpr_read_b32 v198, a178
v_mfma_f32_16x16x32_bf16 a[192:195], v[240:243], v[4:7], a[192:195]
ds_read_b64_tr_b16 v[232:233], v12 offset:45056
ds_read_b64_tr_b16 v[234:235], v12 offset:47104
v_mfma_f32_16x16x32_bf16 a[192:195], v[244:247], v[8:11], a[192:195]
v_accvgpr_read_b32 v199, a179
v_cvt_pk_bf16_f32 v22, v196, v197
v_mfma_f32_16x16x32_bf16 a[196:199], v[240:243], v[36:39], a[196:199]
v_cvt_pk_bf16_f32 v23, v198, v199
buffer_store_dwordx4 v[20:23], v252, s[20:23], s44 offen offset:1024 sc1
v_mfma_f32_16x16x32_bf16 a[196:199], v[244:247], v[40:43], a[196:199]
v_accvgpr_read_b32 v204, a180
v_accvgpr_read_b32 v205, a181
v_mfma_f32_16x16x32_bf16 a[200:203], v[240:243], v[68:71], a[200:203]
ds_read_b64_tr_b16 v[236:237], v12 offset:61440
ds_read_b64_tr_b16 v[238:239], v12 offset:63488
v_mfma_f32_16x16x32_bf16 a[200:203], v[244:247], v[72:75], a[200:203]
v_accvgpr_read_b32 v206, a182
v_accvgpr_read_b32 v207, a183
v_mfma_f32_16x16x32_bf16 a[204:207], v[240:243], v[100:103], a[204:207]
v_cvt_pk_bf16_f32 v54, v204, v205
v_cvt_pk_bf16_f32 v55, v206, v207
v_mfma_f32_16x16x32_bf16 a[204:207], v[244:247], v[104:107], a[204:207]
s_waitcnt lgkmcnt(4)
buffer_store_dwordx4 v[52:55], v252, s[20:23], s45 offen offset:1024 sc1
v_mfma_f32_16x16x32_bf16 a[192:195], v[224:227], v[128:131], a[192:195]
ds_read_b64_tr_b16 v[240:241], v249 offset:12288
ds_read_b64_tr_b16 v[242:243], v249 offset:14336
v_mfma_f32_16x16x32_bf16 a[192:195], v[228:231], v[144:147], a[192:195]
v_accvgpr_read_b32 v212, a184
v_accvgpr_read_b32 v213, a185
v_mfma_f32_16x16x32_bf16 a[196:199], v[224:227], v[132:135], a[196:199]
v_accvgpr_read_b32 v214, a186
v_accvgpr_read_b32 v215, a187
v_mfma_f32_16x16x32_bf16 a[196:199], v[228:231], v[148:151], a[196:199]
v_cvt_pk_bf16_f32 v86, v212, v213
v_cvt_pk_bf16_f32 v87, v214, v215
v_mfma_f32_16x16x32_bf16 a[200:203], v[224:227], v[136:139], a[200:203]
ds_read_b64_tr_b16 v[244:245], v250 offset:12288
ds_read_b64_tr_b16 v[246:247], v250 offset:14336
v_mfma_f32_16x16x32_bf16 a[200:203], v[228:231], v[152:155], a[200:203]
buffer_store_dwordx4 v[84:87], v252, s[20:23], s46 offen offset:1024 sc1
v_accvgpr_read_b32 v220, a188
v_mfma_f32_16x16x32_bf16 a[204:207], v[224:227], v[140:143], a[204:207]
v_accvgpr_read_b32 v221, a189
v_accvgpr_read_b32 v222, a190
v_mfma_f32_16x16x32_bf16 a[204:207], v[228:231], v[156:159], a[204:207]
s_waitcnt lgkmcnt(4)
v_accvgpr_read_b32 v223, a191
v_mfma_f32_16x16x32_bf16 a[192:195], v[232:235], v[160:163], a[192:195]
ds_read_b64_tr_b16 v[224:225], v250 offset:45056
ds_read_b64_tr_b16 v[226:227], v250 offset:47104
v_mfma_f32_16x16x32_bf16 a[192:195], v[236:239], v[176:179], a[192:195]
v_cvt_pk_bf16_f32 v118, v220, v221
v_cvt_pk_bf16_f32 v119, v222, v223
v_mfma_f32_16x16x32_bf16 a[196:199], v[232:235], v[164:167], a[196:199]
buffer_store_dwordx4 v[116:119], v252, s[20:23], s47 offen offset:1024 sc1
v_mfma_f32_16x16x32_bf16 a[196:199], v[236:239], v[180:183], a[196:199]
v_mfma_f32_16x16x32_bf16 a[200:203], v[232:235], v[168:171], a[200:203]
ds_read_b64_tr_b16 v[228:229], v250 offset:61440
ds_read_b64_tr_b16 v[230:231], v250 offset:63488
v_mfma_f32_16x16x32_bf16 a[200:203], v[236:239], v[184:187], a[200:203]
v_mfma_f32_16x16x32_bf16 a[204:207], v[232:235], v[172:175], a[204:207]
v_mfma_f32_16x16x32_bf16 a[204:207], v[236:239], v[188:191], a[204:207]
s_waitcnt lgkmcnt(4)
v_mfma_f32_16x16x32_bf16 a[192:195], v[240:243], v[0:3], a[192:195]
ds_read_b64_tr_b16 v[232:233], v13 offset:12288
ds_read_b64_tr_b16 v[234:235], v13 offset:14336
v_mfma_f32_16x16x32_bf16 a[196:199], v[240:243], v[32:35], a[196:199]
v_mfma_f32_16x16x32_bf16 a[200:203], v[240:243], v[64:67], a[200:203]
v_mfma_f32_16x16x32_bf16 a[204:207], v[240:243], v[96:99], a[204:207]
v_mfma_f32_16x16x32_bf16 a[208:211], v[244:247], v[0:3], a[208:211]
ds_read_b64_tr_b16 v[236:237], v13 offset:28672
ds_read_b64_tr_b16 v[238:239], v13 offset:30720
v_mfma_f32_16x16x32_bf16 a[212:215], v[244:247], v[32:35], a[212:215]
v_accvgpr_read_b32 v192, a192
v_accvgpr_read_b32 v193, a193
v_mfma_f32_16x16x32_bf16 a[216:219], v[244:247], v[64:67], a[216:219]
v_accvgpr_read_b32 v194, a194
v_accvgpr_read_b32 v195, a195
v_mfma_f32_16x16x32_bf16 a[220:223], v[244:247], v[96:99], a[220:223]
s_waitcnt lgkmcnt(4)
v_cvt_pk_bf16_f32 v24, v192, v193
v_mfma_f32_16x16x32_bf16 a[208:211], v[224:227], v[4:7], a[208:211]
ds_read_b64_tr_b16 v[240:241], v13 offset:45056
ds_read_b64_tr_b16 v[242:243], v13 offset:47104
v_mfma_f32_16x16x32_bf16 a[208:211], v[228:231], v[8:11], a[208:211]
v_cvt_pk_bf16_f32 v25, v194, v195
v_accvgpr_read_b32 v200, a196
v_mfma_f32_16x16x32_bf16 a[212:215], v[224:227], v[36:39], a[212:215]
v_accvgpr_read_b32 v201, a197
v_accvgpr_read_b32 v202, a198
v_mfma_f32_16x16x32_bf16 a[212:215], v[228:231], v[40:43], a[212:215]
v_accvgpr_read_b32 v203, a199
v_cvt_pk_bf16_f32 v56, v200, v201
v_mfma_f32_16x16x32_bf16 a[216:219], v[224:227], v[68:71], a[216:219]
ds_read_b64_tr_b16 v[244:245], v13 offset:61440
ds_read_b64_tr_b16 v[246:247], v13 offset:63488
v_mfma_f32_16x16x32_bf16 a[216:219], v[228:231], v[72:75], a[216:219]
v_cvt_pk_bf16_f32 v57, v202, v203
v_accvgpr_read_b32 v208, a200
v_mfma_f32_16x16x32_bf16 a[220:223], v[224:227], v[100:103], a[220:223]
v_accvgpr_read_b32 v209, a201
v_accvgpr_read_b32 v210, a202
v_mfma_f32_16x16x32_bf16 a[220:223], v[228:231], v[104:107], a[220:223]
s_waitcnt lgkmcnt(4)
v_accvgpr_read_b32 v211, a203
v_mfma_f32_16x16x32_bf16 a[208:211], v[232:235], v[128:131], a[208:211]
ds_read_b64_tr_b16 v[224:225], v249 offset:45568
ds_read_b64_tr_b16 v[226:227], v249 offset:47616
v_mfma_f32_16x16x32_bf16 a[208:211], v[236:239], v[144:147], a[208:211]
v_cvt_pk_bf16_f32 v88, v208, v209
v_cvt_pk_bf16_f32 v89, v210, v211
v_mfma_f32_16x16x32_bf16 a[212:215], v[232:235], v[132:135], a[212:215]
v_accvgpr_read_b32 v216, a204
v_accvgpr_read_b32 v217, a205
v_mfma_f32_16x16x32_bf16 a[212:215], v[236:239], v[148:151], a[212:215]
v_accvgpr_read_b32 v218, a206
v_accvgpr_read_b32 v219, a207
v_mfma_f32_16x16x32_bf16 a[216:219], v[232:235], v[136:139], a[216:219]
ds_read_b64_tr_b16 v[228:229], v249 offset:61952
ds_read_b64_tr_b16 v[230:231], v249 offset:64000
v_mfma_f32_16x16x32_bf16 a[216:219], v[236:239], v[152:155], a[216:219]
v_cvt_pk_bf16_f32 v120, v216, v217
v_cvt_pk_bf16_f32 v121, v218, v219
v_mfma_f32_16x16x32_bf16 a[220:223], v[232:235], v[140:143], a[220:223]
v_mfma_f32_16x16x32_bf16 a[220:223], v[236:239], v[156:159], a[220:223]
s_waitcnt lgkmcnt(4)
v_mfma_f32_16x16x32_bf16 a[208:211], v[240:243], v[160:163], a[208:211]
ds_read_b64_tr_b16 v[232:233], v12 offset:12800
ds_read_b64_tr_b16 v[234:235], v12 offset:14848
v_mfma_f32_16x16x32_bf16 a[208:211], v[244:247], v[176:179], a[208:211]
v_mfma_f32_16x16x32_bf16 a[212:215], v[240:243], v[164:167], a[212:215]
v_mfma_f32_16x16x32_bf16 a[212:215], v[244:247], v[180:183], a[212:215]
v_mfma_f32_16x16x32_bf16 a[216:219], v[240:243], v[168:171], a[216:219]
ds_read_b64_tr_b16 v[236:237], v12 offset:29184
ds_read_b64_tr_b16 v[238:239], v12 offset:31232
v_mfma_f32_16x16x32_bf16 a[216:219], v[244:247], v[184:187], a[216:219]
v_mfma_f32_16x16x32_bf16 a[220:223], v[240:243], v[172:175], a[220:223]
s_nop 0
v_accvgpr_read_b32 v196, a208
v_accvgpr_read_b32 v197, a209
v_mfma_f32_16x16x32_bf16 a[220:223], v[244:247], v[188:191], a[220:223]
s_waitcnt lgkmcnt(4)
v_accvgpr_read_b32 v198, a210
v_mfma_f32_16x16x32_bf16 a[224:227], v[224:227], v[4:7], a[224:227]
ds_read_b64_tr_b16 v[240:241], v12 offset:45568
ds_read_b64_tr_b16 v[242:243], v12 offset:47616
v_mfma_f32_16x16x32_bf16 a[224:227], v[228:231], v[8:11], a[224:227]
v_accvgpr_read_b32 v199, a211
v_cvt_pk_bf16_f32 v26, v196, v197
v_mfma_f32_16x16x32_bf16 a[228:231], v[224:227], v[36:39], a[228:231]
v_cvt_pk_bf16_f32 v27, v198, v199
buffer_store_dwordx4 v[24:27], v252, s[20:23], s44 offen offset:2048 sc1
v_mfma_f32_16x16x32_bf16 a[228:231], v[228:231], v[40:43], a[228:231]
v_accvgpr_read_b32 v204, a212
v_accvgpr_read_b32 v205, a213
v_mfma_f32_16x16x32_bf16 a[232:235], v[224:227], v[68:71], a[232:235]
ds_read_b64_tr_b16 v[244:245], v12 offset:61952
ds_read_b64_tr_b16 v[246:247], v12 offset:64000
v_mfma_f32_16x16x32_bf16 a[232:235], v[228:231], v[72:75], a[232:235]
v_accvgpr_read_b32 v206, a214
v_accvgpr_read_b32 v207, a215
v_mfma_f32_16x16x32_bf16 a[236:239], v[224:227], v[100:103], a[236:239]
v_cvt_pk_bf16_f32 v58, v204, v205
v_cvt_pk_bf16_f32 v59, v206, v207
v_mfma_f32_16x16x32_bf16 a[236:239], v[228:231], v[104:107], a[236:239]
s_waitcnt lgkmcnt(4)
buffer_store_dwordx4 v[56:59], v252, s[20:23], s45 offen offset:2048 sc1
v_mfma_f32_16x16x32_bf16 a[224:227], v[232:235], v[128:131], a[224:227]
ds_read_b64_tr_b16 v[224:225], v249 offset:12800
ds_read_b64_tr_b16 v[226:227], v249 offset:14848
v_mfma_f32_16x16x32_bf16 a[224:227], v[236:239], v[144:147], a[224:227]
v_accvgpr_read_b32 v212, a216
v_accvgpr_read_b32 v213, a217
v_mfma_f32_16x16x32_bf16 a[228:231], v[232:235], v[132:135], a[228:231]
v_accvgpr_read_b32 v214, a218
v_accvgpr_read_b32 v215, a219
v_mfma_f32_16x16x32_bf16 a[228:231], v[236:239], v[148:151], a[228:231]
v_cvt_pk_bf16_f32 v90, v212, v213
v_cvt_pk_bf16_f32 v91, v214, v215
v_mfma_f32_16x16x32_bf16 a[232:235], v[232:235], v[136:139], a[232:235]
ds_read_b64_tr_b16 v[228:229], v250 offset:12800
ds_read_b64_tr_b16 v[230:231], v250 offset:14848
v_mfma_f32_16x16x32_bf16 a[232:235], v[236:239], v[152:155], a[232:235]
buffer_store_dwordx4 v[88:91], v252, s[20:23], s46 offen offset:2048 sc1
v_accvgpr_read_b32 v220, a220
v_mfma_f32_16x16x32_bf16 a[236:239], v[232:235], v[140:143], a[236:239]
v_accvgpr_read_b32 v221, a221
v_accvgpr_read_b32 v222, a222
v_mfma_f32_16x16x32_bf16 a[236:239], v[236:239], v[156:159], a[236:239]
s_waitcnt lgkmcnt(4)
v_accvgpr_read_b32 v223, a223
v_mfma_f32_16x16x32_bf16 a[224:227], v[240:243], v[160:163], a[224:227]
ds_read_b64_tr_b16 v[232:233], v250 offset:45568
ds_read_b64_tr_b16 v[234:235], v250 offset:47616
v_mfma_f32_16x16x32_bf16 a[224:227], v[244:247], v[176:179], a[224:227]
v_cvt_pk_bf16_f32 v122, v220, v221
v_cvt_pk_bf16_f32 v123, v222, v223
v_mfma_f32_16x16x32_bf16 a[228:231], v[240:243], v[164:167], a[228:231]
buffer_store_dwordx4 v[120:123], v252, s[20:23], s47 offen offset:2048 sc1
v_mfma_f32_16x16x32_bf16 a[228:231], v[244:247], v[180:183], a[228:231]
v_mfma_f32_16x16x32_bf16 a[232:235], v[240:243], v[168:171], a[232:235]
ds_read_b64_tr_b16 v[236:237], v250 offset:61952
ds_read_b64_tr_b16 v[238:239], v250 offset:64000
v_mfma_f32_16x16x32_bf16 a[232:235], v[244:247], v[184:187], a[232:235]
v_mfma_f32_16x16x32_bf16 a[236:239], v[240:243], v[172:175], a[236:239]
v_mfma_f32_16x16x32_bf16 a[236:239], v[244:247], v[188:191], a[236:239]
s_waitcnt lgkmcnt(4)
v_mfma_f32_16x16x32_bf16 a[224:227], v[224:227], v[0:3], a[224:227]
ds_read_b64_tr_b16 v[240:241], v13 offset:12800
ds_read_b64_tr_b16 v[242:243], v13 offset:14848
v_mfma_f32_16x16x32_bf16 a[228:231], v[224:227], v[32:35], a[228:231]
v_mfma_f32_16x16x32_bf16 a[232:235], v[224:227], v[64:67], a[232:235]
v_mfma_f32_16x16x32_bf16 a[236:239], v[224:227], v[96:99], a[236:239]
v_mfma_f32_16x16x32_bf16 a[240:243], v[228:231], v[0:3], a[240:243]
ds_read_b64_tr_b16 v[244:245], v13 offset:29184
ds_read_b64_tr_b16 v[246:247], v13 offset:31232
v_mfma_f32_16x16x32_bf16 a[244:247], v[228:231], v[32:35], a[244:247]
v_accvgpr_read_b32 v192, a224
v_accvgpr_read_b32 v193, a225
v_mfma_f32_16x16x32_bf16 a[248:251], v[228:231], v[64:67], a[248:251]
v_accvgpr_read_b32 v194, a226
v_accvgpr_read_b32 v195, a227
v_mfma_f32_16x16x32_bf16 a[252:255], v[228:231], v[96:99], a[252:255]
s_waitcnt lgkmcnt(4)
v_cvt_pk_bf16_f32 v28, v192, v193
v_mfma_f32_16x16x32_bf16 a[240:243], v[232:235], v[4:7], a[240:243]
ds_read_b64_tr_b16 v[224:225], v13 offset:45568
ds_read_b64_tr_b16 v[226:227], v13 offset:47616
v_mfma_f32_16x16x32_bf16 a[240:243], v[236:239], v[8:11], a[240:243]
v_cvt_pk_bf16_f32 v29, v194, v195
v_accvgpr_read_b32 v200, a228
v_mfma_f32_16x16x32_bf16 a[244:247], v[232:235], v[36:39], a[244:247]
v_accvgpr_read_b32 v201, a229
v_accvgpr_read_b32 v202, a230
v_mfma_f32_16x16x32_bf16 a[244:247], v[236:239], v[40:43], a[244:247]
v_accvgpr_read_b32 v203, a231
v_cvt_pk_bf16_f32 v60, v200, v201
v_mfma_f32_16x16x32_bf16 a[248:251], v[232:235], v[68:71], a[248:251]
ds_read_b64_tr_b16 v[228:229], v13 offset:61952
ds_read_b64_tr_b16 v[230:231], v13 offset:64000
v_mfma_f32_16x16x32_bf16 a[248:251], v[236:239], v[72:75], a[248:251]
v_cvt_pk_bf16_f32 v61, v202, v203
v_accvgpr_read_b32 v208, a232
v_mfma_f32_16x16x32_bf16 a[252:255], v[232:235], v[100:103], a[252:255]
v_accvgpr_read_b32 v209, a233
v_accvgpr_read_b32 v210, a234
v_mfma_f32_16x16x32_bf16 a[252:255], v[236:239], v[104:107], a[252:255]
s_waitcnt lgkmcnt(4)
v_accvgpr_read_b32 v211, a235
v_mfma_f32_16x16x32_bf16 a[240:243], v[240:243], v[128:131], a[240:243]
v_cvt_pk_bf16_f32 v92, v208, v209
v_cvt_pk_bf16_f32 v93, v210, v211
v_mfma_f32_16x16x32_bf16 a[240:243], v[244:247], v[144:147], a[240:243]
v_accvgpr_read_b32 v216, a236
v_accvgpr_read_b32 v217, a237
v_mfma_f32_16x16x32_bf16 a[244:247], v[240:243], v[132:135], a[244:247]
v_accvgpr_read_b32 v218, a238
v_accvgpr_read_b32 v219, a239
v_mfma_f32_16x16x32_bf16 a[244:247], v[244:247], v[148:151], a[244:247]
v_cvt_pk_bf16_f32 v124, v216, v217
v_cvt_pk_bf16_f32 v125, v218, v219
v_mfma_f32_16x16x32_bf16 a[248:251], v[240:243], v[136:139], a[248:251]
v_mfma_f32_16x16x32_bf16 a[248:251], v[244:247], v[152:155], a[248:251]
v_mfma_f32_16x16x32_bf16 a[252:255], v[240:243], v[140:143], a[252:255]
v_mfma_f32_16x16x32_bf16 a[252:255], v[244:247], v[156:159], a[252:255]
s_waitcnt lgkmcnt(0)
v_mfma_f32_16x16x32_bf16 a[240:243], v[224:227], v[160:163], a[240:243]
v_mfma_f32_16x16x32_bf16 a[240:243], v[228:231], v[176:179], a[240:243]
v_mfma_f32_16x16x32_bf16 a[244:247], v[224:227], v[164:167], a[244:247]
v_mfma_f32_16x16x32_bf16 a[244:247], v[228:231], v[180:183], a[244:247]
v_mfma_f32_16x16x32_bf16 a[248:251], v[224:227], v[168:171], a[248:251]
v_mfma_f32_16x16x32_bf16 a[248:251], v[228:231], v[184:187], a[248:251]
v_mfma_f32_16x16x32_bf16 a[252:255], v[224:227], v[172:175], a[252:255]
s_nop 2
v_accvgpr_read_b32 v196, a240
v_accvgpr_read_b32 v197, a241
v_accvgpr_read_b32 v198, a242
v_accvgpr_read_b32 v199, a243
v_mfma_f32_16x16x32_bf16 a[252:255], v[228:231], v[188:191], a[252:255]
v_cvt_pk_bf16_f32 v30, v196, v197
v_cvt_pk_bf16_f32 v31, v198, v199
buffer_store_dwordx4 v[28:31], v252, s[20:23], s44 offen offset:3072 sc1
v_accvgpr_read_b32 v204, a244
v_accvgpr_read_b32 v205, a245
v_accvgpr_read_b32 v206, a246
v_accvgpr_read_b32 v207, a247
v_cvt_pk_bf16_f32 v62, v204, v205
v_cvt_pk_bf16_f32 v63, v206, v207
buffer_store_dwordx4 v[60:63], v252, s[20:23], s45 offen offset:3072 sc1
v_accvgpr_read_b32 v212, a248
v_accvgpr_read_b32 v213, a249
v_accvgpr_read_b32 v214, a250
v_accvgpr_read_b32 v215, a251
v_cvt_pk_bf16_f32 v94, v212, v213
v_cvt_pk_bf16_f32 v95, v214, v215
buffer_store_dwordx4 v[92:95], v252, s[20:23], s46 offen offset:3072 sc1
v_accvgpr_read_b32 v220, a252
v_accvgpr_read_b32 v221, a253
v_accvgpr_read_b32 v222, a254
v_accvgpr_read_b32 v223, a255
v_cvt_pk_bf16_f32 v126, v220, v221
v_cvt_pk_bf16_f32 v127, v222, v223
buffer_store_dwordx4 v[124:127], v252, s[20:23], s47 offen offset:3072 sc1
s_branch L2_chk
L2_chk:
LC_start:
s_cmp_lg_u64 vcc, 0
s_cselect_b32 s98, 1, 0
LC_again:
s_lshl_b32 s48, s38, 7
s_lshl_b32 s49, s38, 7
s_lshl_b32 s50, s38, 7
s_mov_b32 s51, s37
s_cmp_eq_u32 s37, 5
s_cselect_b32 s14, 1, 0
s_cselect_b32 s52, 0x7fff0000, s52
s_cselect_b32 s53, 0x7fff0000, s53
s_cselect_b32 s54, 0x7fff0000, s54
s_cmp_eq_u32 s34, 0
s_cselect_b32 s15, 0x6c00000, s52
s_cselect_b32 s15, s15, 0x7fff0000
LC_common:
s_nop 0
s_bfe_u32 s3, s2, 0x30003
s_lshl_b32 s13, s34, 4
s_or_b32 s13, s13, s3
s_lshl_b32 s13, s13, 11
s_lshr_b32 s101, s3, 1
s_xor_b32 s101, s101, s34
s_lshl_b32 s101, s101, 10
s_add_u32 s101, s101, s100
s_cmp_eq_u32 s14, 1
s_cselect_b32 s13, 0x7fff0000, s13
s_add_u32 s28, s4, 0x7000000
s_addc_u32 s29, s5, 0
s_mov_b32 s30, 0x4e2000
s_mov_b32 s31, 0x00020000
s_lshl_b32 s33, s34, 7
v_bfe_u32 v5, v252, 4, 3
v_lshrrev_b32 v6, 8, v252
v_xor_b32 v5, v5, v6
v_lshrrev_b32 v6, 7, v252
v_lshl_add_u32 v6, v6, 9, s33
v_lshl_add_u32 v5, v5, 4, v6
v_xor_b32 v6, 64, v5
v_add_u32 v6, 0x1000, v6
s_cmp_ge_u32 s99, 60
s_cbranch_scc0 LC_side
LC_sideok:
s_add_u32 m0, s101, 0
s_nop 0
buffer_load_dwordx4 v5, s[28:31], s52 offen sc1 lds
s_add_u32 m0, s101, 4096
s_nop 0
buffer_load_dwordx4 v6, s[28:31], s52 offen sc1 lds
s_add_u32 m0, s101, 8192
s_nop 0
buffer_load_dwordx4 v5, s[28:31], s53 offen sc1 lds
s_add_u32 m0, s101, 12288
s_nop 0
buffer_load_dwordx4 v6, s[28:31], s53 offen sc1 lds
s_add_u32 m0, s101, 16384
s_nop 0
buffer_load_dwordx4 v5, s[28:31], s54 offen sc1 lds
s_add_u32 m0, s101, 20480
s_nop 0
buffer_load_dwordx4 v6, s[28:31], s54 offen sc1 lds
s_xor_b32 s33, s13, 0x0
buffer_load_dwordx4 a[0:3], v252, s[56:59], s33 offen offset:0
buffer_load_dwordx4 a[4:7], v252, s[56:59], s33 offen offset:1024
s_xor_b32 s35, s13, 0x4000
buffer_load_dwordx4 a[64:67], v252, s[56:59], s35 offen offset:0
buffer_load_dwordx4 a[68:71], v252, s[56:59], s35 offen offset:1024
s_xor_b32 s39, s13, 0x800
buffer_load_dwordx4 a[8:11], v252, s[56:59], s39 offen offset:0
buffer_load_dwordx4 a[12:15], v252, s[56:59], s39 offen offset:1024
s_xor_b32 s32, s13, 0x4800
buffer_load_dwordx4 a[72:75], v252, s[56:59], s32 offen offset:0
buffer_load_dwordx4 a[76:79], v252, s[56:59], s32 offen offset:1024
s_lshl_b32 s32, s34, 2
s_add_u32 s32, s32, s100
s_and_b32 s33, s98, 1
v_mov_b32 v42, s32
v_mov_b32 v43, s33
ds_write_b32 v42, v43 offset:24576
v_lshrrev_b32 v0, 4, v252
v_and_b32 v2, 15, v0
v_lshrrev_b32 v3, 4, v0
s_add_u32 s8, s6, 0x0
s_addc_u32 s9, s7, 0
s_mov_b32 s10, 0x4e2000
s_mov_b32 s11, 0x00020000
s_lshl_b32 s55, s34, 13
s_add_u32 s55, s55, 0x21000
s_lshl_b32 s33, s34, 7
v_bfe_u32 v9, v252, 4, 3
v_lshrrev_b32 v1, 7, v252
v_xor_b32 v9, v9, v1
v_lshl_add_u32 v1, v1, 9, s33
v_lshl_add_u32 v9, v9, 4, v1
s_and_b32 s72, s100, 0x8000
s_lshl_b32 s73, s34, 11
s_add_u32 s73, s73, 0xe000
s_xor_b32 s73, s73, s72
v_mov_b32 v4, 0x7fff0000
v_cmp_eq_u32 vcc, 0, v3
v_mov_b32 v1, s52
s_nop 0
v_cndmask_b32 v4, v4, v1, vcc
v_cmp_eq_u32 vcc, 1, v3
v_mov_b32 v1, s53
s_nop 0
v_cndmask_b32 v4, v4, v1, vcc
v_cmp_eq_u32 vcc, 2, v3
v_mov_b32 v1, s54
s_nop 0
v_cndmask_b32 v4, v4, v1, vcc
v_lshl_add_u32 v4, v2, 9, v4
v_lshrrev_b32 v7, 3, v4
s_add_u32 s20, s4, 0x2000000
s_addc_u32 s21, s5, 0
s_mov_b32 s22, 0x22e4000
s_mov_b32 s23, 0x00020000
s_add_u32 s40, s18, 0x0
s_addc_u32 s41, s19, 0
s_mov_b32 s42, 0x4e2000
s_mov_b32 s43, 0x00020000
s_add_u32 s60, s4, 0x7c00000
s_addc_u32 s61, s5, 0
s_mov_b32 s12, 0xffff0000
v_mov_b32 v40, s48
s_lshl_b32 s33, s34, 11
v_add_u32 v10, s33, v252
s_lshl_b32 s32, s3, 10
v_xor_b32 v38, s32, v10
s_xor_b32 s32, s72, 0x8000
v_add_u32 v38, s32, v38
v_add_u32 v15, s32, v252
v_xor_b32 v39, 0x400, v38
v_lshrrev_b32 v1, 1, v2
v_xor_b32 v1, v1, v3
v_lshrrev_b32 v11, 3, v2
v_lshlrev_b32 v11, 12, v11
v_lshl_add_u32 v11, v1, 4, v11
v_and_b32 v1, 7, v2
v_lshl_add_u32 v11, v1, 7, v11
s_and_b32 s32, s3, 1
s_lshl_b32 s32, s32, 6
v_xor_b32 v11, s32, v11
v_add_u32 v11, s100, v11
v_xor_b32 v12, 64, v11
s_lshl_b32 s33, s34, 12
s_add_u32 s33, s33, 0x18000
s_xor_b32 s33, s33, s72
v_mul_u32_u24 v13, 80, v0
v_add_u32 v13, s33, v13
v_cmp_eq_u32 vcc, 3, v3
v_mov_b32 v4, 0x100000
s_nop 0
v_cndmask_b32 v13, v13, v4, vcc
s_lshl_b32 s32, s51, 2
s_add_u32 s33, s33, s32
v_mul_u32_u24 v14, 80, v2
v_add_u32 v14, s33, v14
v_xor_b32 v1, v1, v3
v_lshlrev_b32 v1, 4, v1
v_lshl_add_u32 v1, v2, 7, v1
v_add_u32 v32, s55, v1
v_xor_b32 v33, 64, v32
v_add_u32 v35, s73, v1
v_xor_b32 v36, 64, v35
v_add_u32 v34, s55, v252
v_add_u32 v37, s73, v252
s_lshl_b32 s32, s34, 11
s_xor_b32 s33, s72, 0x1b000
s_cmp_lt_u32 s34, 2
s_cselect_b32 s33, 0x20000, s33
s_cselect_b32 s35, 13, 12
s_add_u32 s32, s32, s33
s_mul_i32 s33, s51, 3
s_add_u32 s39, s33, 0
s_and_b32 s39, s39, 3
s_lshl_b32 s39, s39, s35
s_add_u32 s39, s39, s32
v_add_u32 v44, s39, v252
s_add_u32 s39, s33, 1
s_and_b32 s39, s39, 3
s_lshl_b32 s39, s39, s35
s_add_u32 s39, s39, s32
v_add_u32 v45, s39, v252
s_add_u32 s39, s33, 2
s_and_b32 s39, s39, 3
s_lshl_b32 s39, s39, s35
s_add_u32 s39, s39, s32
v_add_u32 v46, s39, v252
s_add_u32 s32, s51, 1
s_sub_u32 s33, s32, 6
s_cselect_b32 s32, s32, s33
s_mul_i32 s44, s32, 0x600000
s_add_u32 s32, s51, 2
s_sub_u32 s33, s32, 6
s_cselect_b32 s32, s32, s33
s_mul_i32 s45, s32, 0x600000
s_add_u32 s32, s51, 3
s_sub_u32 s33, s32, 6
s_cselect_b32 s32, s32, s33
s_mul_i32 s46, s32, 0x600000
s_add_u32 s32, s51, 4
s_sub_u32 s33, s32, 6
s_cselect_b32 s32, s32, s33
s_mul_i32 s47, s32, 0x600000
v_mov_b32 v41, 1
v_and_b32 v42, 3, v0
v_lshl_add_u32 v42, v42, 2, s100
s_lshl_b32 s33, s34, 12
s_sub_u32 s33, s33, s72
s_cmp_lt_u32 s98, 2
s_cselect_b32 s33, s33, 0x100000
v_add_u32 v1, s33, v252
v_add_u32 v1, 0x1c000, v1
s_waitcnt vmcnt(14)
s_waitcnt lgkmcnt(0)
s_barrier
ds_read_b32 v43, v42 offset:24576
ds_write_b128 v1, v[16:19] offset:0
ds_write_b128 v1, v[20:23] offset:1024
ds_write_b128 v1, v[24:27] offset:2048
ds_write_b128 v1, v[28:31] offset:3072
s_waitcnt lgkmcnt(4)
v_cmp_ne_u32 vcc, 0, v43
s_cbranch_vccnz LC_slow
s_mov_b64 exec, 1
buffer_atomic_add v41, v40, s[56:59], s15 offen
s_mov_b64 exec, -1
s_cmp_eq_u32 s14, 1
s_cbranch_scc1 L2_fin
s_add_u32 s32, s51, 5
s_sub_u32 s33, s32, 6
s_cselect_b32 s32, s32, s33
s_mul_i32 s15, s32, 0x600000
s_add_u32 m0, s73, 0
s_add_u32 s33, s54, 0
buffer_load_dwordx4 v9, s[8:11], s33 offen lds
s_add_u32 m0, s73, 1024
s_add_u32 s35, s54, 4096
buffer_load_dwordx4 v9, s[8:11], s35 offen lds
s_xor_b32 s39, s13, 0x1000
buffer_load_dwordx4 a[16:19], v252, s[56:59], s39 offen offset:0
buffer_load_dwordx4 a[20:23], v252, s[56:59], s39 offen offset:1024
s_xor_b32 s32, s13, 0x5000
buffer_load_dwordx4 a[80:83], v252, s[56:59], s32 offen offset:0
buffer_load_dwordx4 a[84:87], v252, s[56:59], s32 offen offset:1024
s_xor_b32 s33, s13, 0x1800
buffer_load_dwordx4 a[24:27], v252, s[56:59], s33 offen offset:0
buffer_load_dwordx4 a[28:31], v252, s[56:59], s33 offen offset:1024
s_xor_b32 s35, s13, 0x5800
buffer_load_dwordx4 a[88:91], v252, s[56:59], s35 offen offset:0
buffer_load_dwordx4 a[92:95], v252, s[56:59], s35 offen offset:1024
s_xor_b32 s39, s13, 0x2000
buffer_load_dwordx4 a[32:35], v252, s[56:59], s39 offen offset:0
buffer_load_dwordx4 a[36:39], v252, s[56:59], s39 offen offset:1024
ds_read_b128 v[52:55], v32 offset:0
ds_read_b128 v[60:63], v33 offset:0
s_waitcnt lgkmcnt(1)
v_lshlrev_b32 v48, 16, v52
v_and_b32 v49, s12, v52
v_lshlrev_b32 v50, 16, v53
v_and_b32 v51, s12, v53
v_lshlrev_b32 v52, 16, v54
v_and_b32 v53, s12, v54
v_lshlrev_b32 v54, 16, v55
v_and_b32 v55, s12, v55
s_waitcnt lgkmcnt(0)
v_lshlrev_b32 v56, 16, v60
v_and_b32 v57, s12, v60
v_lshlrev_b32 v58, 16, v61
v_and_b32 v59, s12, v61
v_lshlrev_b32 v60, 16, v62
v_and_b32 v61, s12, v62
v_lshlrev_b32 v62, 16, v63
v_and_b32 v63, s12, v63
ds_read_b128 v[68:71], v32 offset:2048
ds_read_b128 v[76:79], v33 offset:2048
s_waitcnt lgkmcnt(1)
v_lshlrev_b32 v64, 16, v68
v_and_b32 v65, s12, v68
v_lshlrev_b32 v66, 16, v69
v_and_b32 v67, s12, v69
v_lshlrev_b32 v68, 16, v70
v_and_b32 v69, s12, v70
v_lshlrev_b32 v70, 16, v71
v_and_b32 v71, s12, v71
s_waitcnt lgkmcnt(0)
v_lshlrev_b32 v72, 16, v76
v_and_b32 v73, s12, v76
v_lshlrev_b32 v74, 16, v77
v_and_b32 v75, s12, v77
v_lshlrev_b32 v76, 16, v78
v_and_b32 v77, s12, v78
v_lshlrev_b32 v78, 16, v79
v_and_b32 v79, s12, v79
s_waitcnt vmcnt(11)
s_xor_b32 s32, s13, 0x6000
buffer_load_dwordx4 a[96:99], v252, s[56:59], s32 offen offset:0
s_waitcnt vmcnt(11)
buffer_load_dwordx4 a[100:103], v252, s[56:59], s32 offen offset:1024
s_waitcnt vmcnt(11)
s_xor_b32 s33, s13, 0x2800
buffer_load_dwordx4 a[40:43], v252, s[56:59], s33 offen offset:0
s_waitcnt vmcnt(11)
buffer_load_dwordx4 a[44:47], v252, s[56:59], s33 offen offset:1024
s_waitcnt vmcnt(11)
s_xor_b32 s35, s13, 0x6800
buffer_load_dwordx4 a[104:107], v252, s[56:59], s35 offen offset:0
s_waitcnt vmcnt(11)
buffer_load_dwordx4 a[108:111], v252, s[56:59], s35 offen offset:1024
s_waitcnt vmcnt(11)
s_xor_b32 s39, s13, 0x3000
buffer_load_dwordx4 a[48:51], v252, s[56:59], s39 offen offset:0
s_waitcnt vmcnt(11)
buffer_load_dwordx4 a[52:55], v252, s[56:59], s39 offen offset:1024
s_waitcnt vmcnt(11)
s_xor_b32 s32, s13, 0x7000
buffer_load_dwordx4 a[112:115], v252, s[56:59], s32 offen offset:0
s_waitcnt vmcnt(11)
buffer_load_dwordx4 a[116:119], v252, s[56:59], s32 offen offset:1024
s_waitcnt vmcnt(11)
s_xor_b32 s33, s13, 0x3800
buffer_load_dwordx4 a[56:59], v252, s[56:59], s33 offen offset:0
s_waitcnt vmcnt(11)
buffer_load_dwordx4 a[60:63], v252, s[56:59], s33 offen offset:1024
s_waitcnt vmcnt(11)
s_xor_b32 s35, s13, 0x7800
buffer_load_dwordx4 a[120:123], v252, s[56:59], s35 offen offset:0
s_waitcnt vmcnt(11)
buffer_load_dwordx4 a[124:127], v252, s[56:59], s35 offen offset:1024
s_waitcnt vmcnt(11)
s_xor_b32 s39, s13, 0x20000
buffer_load_dwordx4 a[128:131], v252, s[56:59], s39 offen offset:0
s_waitcnt vmcnt(11)
buffer_load_dwordx4 a[132:135], v252, s[56:59], s39 offen offset:1024
s_waitcnt vmcnt(11)
s_xor_b32 s32, s13, 0x24000
buffer_load_dwordx4 a[192:195], v252, s[56:59], s32 offen offset:0
s_waitcnt vmcnt(11)
buffer_load_dwordx4 a[196:199], v252, s[56:59], s32 offen offset:1024
s_waitcnt vmcnt(11)
s_xor_b32 s33, s13, 0x20800
buffer_load_dwordx4 a[136:139], v252, s[56:59], s33 offen offset:0
s_waitcnt vmcnt(11)
buffer_load_dwordx4 a[140:143], v252, s[56:59], s33 offen offset:1024
s_waitcnt vmcnt(11)
s_xor_b32 s35, s13, 0x24800
buffer_load_dwordx4 a[200:203], v252, s[56:59], s35 offen offset:0
s_waitcnt vmcnt(11)
buffer_load_dwordx4 a[204:207], v252, s[56:59], s35 offen offset:1024
s_waitcnt vmcnt(11)
s_xor_b32 s39, s13, 0x21000
buffer_load_dwordx4 a[144:147], v252, s[56:59], s39 offen offset:0
s_waitcnt vmcnt(11)
buffer_load_dwordx4 a[148:151], v252, s[56:59], s39 offen offset:1024
s_waitcnt vmcnt(11)
s_xor_b32 s32, s13, 0x25000
buffer_load_dwordx4 a[208:211], v252, s[56:59], s32 offen offset:0
s_waitcnt vmcnt(11)
buffer_load_dwordx4 a[212:215], v252, s[56:59], s32 offen offset:1024
s_waitcnt vmcnt(11)
s_xor_b32 s33, s13, 0x21800
buffer_load_dwordx4 a[152:155], v252, s[56:59], s33 offen offset:0
s_waitcnt vmcnt(11)
buffer_load_dwordx4 a[156:159], v252, s[56:59], s33 offen offset:1024
s_waitcnt vmcnt(11)
s_xor_b32 s35, s13, 0x25800
buffer_load_dwordx4 a[216:219], v252, s[56:59], s35 offen offset:0
s_waitcnt vmcnt(11)
buffer_load_dwordx4 a[220:223], v252, s[56:59], s35 offen offset:1024
s_waitcnt vmcnt(11)
s_mov_b32 s70, 0
s_atomic_add s70, s[60:61], s48 glc
s_waitcnt vmcnt(10)
s_xor_b32 s39, s13, 0x22000
buffer_load_dwordx4 a[160:163], v252, s[56:59], s39 offen offset:0
s_waitcnt vmcnt(10)
buffer_load_dwordx4 a[164:167], v252, s[56:59], s39 offen offset:1024
s_waitcnt vmcnt(10)
s_xor_b32 s32, s13, 0x26000
buffer_load_dwordx4 a[224:227], v252, s[56:59], s32 offen offset:0
s_waitcnt vmcnt(10)
buffer_load_dwordx4 a[228:231], v252, s[56:59], s32 offen offset:1024
s_waitcnt vmcnt(10)
s_xor_b32 s33, s13, 0x22800
buffer_load_dwordx4 a[168:171], v252, s[56:59], s33 offen offset:0
s_waitcnt vmcnt(10)
buffer_load_dwordx4 a[172:175], v252, s[56:59], s33 offen offset:1024
s_waitcnt vmcnt(10)
s_xor_b32 s35, s13, 0x26800
buffer_load_dwordx4 a[232:235], v252, s[56:59], s35 offen offset:0
s_waitcnt vmcnt(10)
buffer_load_dwordx4 a[236:239], v252, s[56:59], s35 offen offset:1024
ds_read_b128 v[84:87], v35 offset:0
ds_read_b128 v[92:95], v36 offset:0
s_waitcnt lgkmcnt(1)
v_lshlrev_b32 v80, 16, v84
v_and_b32 v81, s12, v84
v_lshlrev_b32 v82, 16, v85
v_and_b32 v83, s12, v85
v_lshlrev_b32 v84, 16, v86
v_and_b32 v85, s12, v86
v_lshlrev_b32 v86, 16, v87
v_and_b32 v87, s12, v87
s_waitcnt lgkmcnt(0)
v_lshlrev_b32 v88, 16, v92
v_and_b32 v89, s12, v92
v_lshlrev_b32 v90, 16, v93
v_and_b32 v91, s12, v93
v_lshlrev_b32 v92, 16, v94
v_and_b32 v93, s12, v94
v_lshlrev_b32 v94, 16, v95
v_and_b32 v95, s12, v95
s_waitcnt lgkmcnt(0)
s_cmp_lt_u32 s70, 6
s_cbranch_scc1 LC_poll
s_cmp_ge_u32 s98, 2
s_cbranch_scc1 LC_poll
LC_got:
buffer_load_dwordx4 v[156:159], v7, s[24:27], 0 offen offset:0 sc1
buffer_load_dwordx4 v[160:163], v7, s[24:27], 0 offen offset:16 sc1
buffer_load_dwordx4 v[164:167], v7, s[24:27], 0 offen offset:32 sc1
s_add_u32 s39, s52, s44
buffer_load_dwordx4 v[168:171], v10, s[20:23], s39 offen offset:0 sc1
s_add_u32 s32, s52, s45
buffer_load_dwordx4 v[172:175], v10, s[20:23], s32 offen offset:0 sc1
s_add_u32 s33, s52, s46
buffer_load_dwordx4 v[176:179], v10, s[20:23], s33 offen offset:0 sc1
s_add_u32 s35, s52, s47
buffer_load_dwordx4 v[180:183], v10, s[20:23], s35 offen offset:0 sc1
s_add_u32 s39, s52, s15
buffer_load_dwordx4 v[184:187], v10, s[20:23], s39 offen offset:0 sc1
s_add_u32 s32, s52, s44
buffer_load_dwordx4 v[188:191], v10, s[20:23], s32 offen offset:1024 sc1
s_add_u32 s33, s52, s45
buffer_load_dwordx4 v[192:195], v10, s[20:23], s33 offen offset:1024 sc1
s_add_u32 s35, s52, s46
buffer_load_dwordx4 v[196:199], v10, s[20:23], s35 offen offset:1024 sc1
s_add_u32 s39, s52, s47
buffer_load_dwordx4 v[200:203], v10, s[20:23], s39 offen offset:1024 sc1
s_add_u32 s32, s52, s15
buffer_load_dwordx4 v[204:207], v10, s[20:23], s32 offen offset:1024 sc1
s_add_u32 s33, s53, s44
buffer_load_dwordx4 v[208:211], v10, s[20:23], s33 offen offset:0 sc1
s_barrier
ds_read_b128 v[132:135], v11 offset:0
ds_read_b128 v[136:139], v11 offset:8192
ds_read_b128 v[140:143], v11 offset:16384
ds_read_b128 v[144:147], v12 offset:0
ds_read_b128 v[148:151], v12 offset:8192
s_waitcnt vmcnt(24)
s_waitcnt vmcnt(23)
s_waitcnt vmcnt(22)
s_waitcnt vmcnt(21)
s_waitcnt vmcnt(20)
s_waitcnt vmcnt(19)
s_waitcnt vmcnt(18)
s_waitcnt vmcnt(17)
s_waitcnt vmcnt(16)
s_waitcnt vmcnt(15)
s_waitcnt vmcnt(14)
s_waitcnt lgkmcnt(4)
v_mfma_f32_16x16x32_bf16 v[48:51], a[0:3], v[132:135], v[48:51]
ds_read_b128 v[152:155], v12 offset:16384
v_mfma_f32_16x16x32_bf16 v[52:55], a[4:7], v[132:135], v[52:55]
v_mfma_f32_16x16x32_bf16 v[56:59], a[64:67], v[132:135], v[56:59]
v_mfma_f32_16x16x32_bf16 v[60:63], a[68:71], v[132:135], v[60:63]
s_waitcnt lgkmcnt(4)
v_mfma_f32_16x16x32_bf16 v[64:67], a[0:3], v[136:139], v[64:67]
ds_read_b128 v[132:135], v11 offset:1024
v_mfma_f32_16x16x32_bf16 v[68:71], a[4:7], v[136:139], v[68:71]
v_mfma_f32_16x16x32_bf16 v[72:75], a[64:67], v[136:139], v[72:75]
v_mfma_f32_16x16x32_bf16 v[76:79], a[68:71], v[136:139], v[76:79]
s_waitcnt lgkmcnt(4)
v_mfma_f32_16x16x32_bf16 v[80:83], a[0:3], v[140:143], v[80:83]
ds_read_b128 v[136:139], v11 offset:9216
v_mfma_f32_16x16x32_bf16 v[84:87], a[4:7], v[140:143], v[84:87]
v_mfma_f32_16x16x32_bf16 v[88:91], a[64:67], v[140:143], v[88:91]
v_mfma_f32_16x16x32_bf16 v[92:95], a[68:71], v[140:143], v[92:95]
s_waitcnt lgkmcnt(4)
v_mfma_f32_16x16x32_bf16 v[48:51], a[8:11], v[144:147], v[48:51]
ds_read_b128 v[140:143], v11 offset:17408
v_mfma_f32_16x16x32_bf16 v[52:55], a[12:15], v[144:147], v[52:55]
v_mfma_f32_16x16x32_bf16 v[56:59], a[72:75], v[144:147], v[56:59]
v_mfma_f32_16x16x32_bf16 v[60:63], a[76:79], v[144:147], v[60:63]
s_waitcnt vmcnt(13)
s_xor_b32 s35, s13, 0x23000
buffer_load_dwordx4 a[176:179], v252, s[56:59], s35 offen offset:0
s_waitcnt vmcnt(13)
s_add_u32 s39, s53, s45
buffer_load_dwordx4 v[212:215], v10, s[20:23], s39 offen offset:0 sc1
s_waitcnt vmcnt(13)
s_xor_b32 s32, s13, 0x23000
buffer_load_dwordx4 a[180:183], v252, s[56:59], s32 offen offset:1024
s_waitcnt lgkmcnt(4)
v_mfma_f32_16x16x32_bf16 v[64:67], a[8:11], v[148:151], v[64:67]
ds_read_b128 v[144:147], v12 offset:1024
v_max3_f32 v1, v156, v158, v160
v_max3_f32 v117, v162, v164, v166
v_max_f32 v1, v1, v117
v_mfma_f32_16x16x32_bf16 v[68:71], a[12:15], v[148:151], v[68:71]
v_sub_f32 v156, v156, v1
v_sub_f32 v158, v158, v1
v_sub_f32 v160, v160, v1
v_mfma_f32_16x16x32_bf16 v[72:75], a[72:75], v[148:151], v[72:75]
v_sub_f32 v162, v162, v1
v_sub_f32 v164, v164, v1
v_sub_f32 v166, v166, v1
v_mfma_f32_16x16x32_bf16 v[76:79], a[76:79], v[148:151], v[76:79]
v_exp_f32 v156, v156
v_exp_f32 v158, v158
v_exp_f32 v160, v160
s_waitcnt lgkmcnt(4)
v_mfma_f32_16x16x32_bf16 v[80:83], a[8:11], v[152:155], v[80:83]
ds_read_b128 v[148:151], v12 offset:9216
v_exp_f32 v162, v162
v_exp_f32 v164, v164
v_exp_f32 v166, v166
v_mfma_f32_16x16x32_bf16 v[84:87], a[12:15], v[152:155], v[84:87]
s_nop 0
v_mul_f32 v1, v156, v157
v_fmac_f32 v1, v158, v159
v_mfma_f32_16x16x32_bf16 v[88:91], a[72:75], v[152:155], v[88:91]
v_fmac_f32 v1, v160, v161
v_fmac_f32 v1, v162, v163
v_fmac_f32 v1, v164, v165
v_mfma_f32_16x16x32_bf16 v[92:95], a[76:79], v[152:155], v[92:95]
v_fmac_f32 v1, v166, v167
v_rcp_f32 v1, v1
s_nop 0
s_waitcnt lgkmcnt(4)
v_mfma_f32_16x16x32_bf16 v[48:51], a[16:19], v[132:135], v[48:51]
ds_read_b128 v[152:155], v12 offset:17408
v_mul_f32 v108, v156, v1
v_mul_f32 v109, v158, v1
v_mul_f32 v110, v160, v1
v_mfma_f32_16x16x32_bf16 v[52:55], a[20:23], v[132:135], v[52:55]
v_mul_f32 v111, v162, v1
v_mul_f32 v112, v164, v1
v_mul_f32 v113, v166, v1
v_mfma_f32_16x16x32_bf16 v[56:59], a[80:83], v[132:135], v[56:59]
v_mul_f32 v114, v156, v1
v_mul_f32 v115, v158, v1
ds_write_b128 v13, v[108:111]
v_mfma_f32_16x16x32_bf16 v[60:63], a[84:87], v[132:135], v[60:63]
ds_write_b128 v13, v[112:115] offset:16
ds_write_b64 v13, v[110:111] offset:32
ds_write_b64 v13, v[112:113] offset:40
s_waitcnt lgkmcnt(8)
v_mfma_f32_16x16x32_bf16 v[64:67], a[16:19], v[136:139], v[64:67]
ds_read_b128 v[132:135], v11 offset:2048
ds_read2_b32 v[16:17], v14 offset0:1 offset1:1
ds_read2_b32 v[18:19], v14 offset0:2 offset1:2
ds_read2_b32 v[20:21], v14 offset0:3 offset1:3
v_mfma_f32_16x16x32_bf16 v[68:71], a[20:23], v[136:139], v[68:71]
ds_read2_b32 v[22:23], v14 offset0:4 offset1:4
ds_read2_b32 v[24:25], v14 offset0:5 offset1:5
ds_read2_b32 v[26:27], v14 offset0:6 offset1:6
v_mfma_f32_16x16x32_bf16 v[72:75], a[80:83], v[136:139], v[72:75]
v_add_u32 v14, 0x500, v14
v_mfma_f32_16x16x32_bf16 v[76:79], a[84:87], v[136:139], v[76:79]
s_waitcnt vmcnt(13)
s_add_u32 s33, s53, s46
buffer_load_dwordx4 v[216:219], v10, s[20:23], s33 offen offset:0 sc1
s_waitcnt lgkmcnt(14)
v_mfma_f32_16x16x32_bf16 v[80:83], a[16:19], v[140:143], v[80:83]
ds_read_b128 v[136:139], v11 offset:10240
ds_read_b128 v[96:99], v44 offset:0
s_waitcnt lgkmcnt(2)
v_lshlrev_b32 v116, 16, v168
v_and_b32 v117, s12, v168
v_mfma_f32_16x16x32_bf16 v[84:87], a[20:23], v[140:143], v[84:87]
v_lshlrev_b32 v118, 16, v169
v_and_b32 v119, s12, v169
v_lshlrev_b32 v120, 16, v170
v_mfma_f32_16x16x32_bf16 v[88:91], a[80:83], v[140:143], v[88:91]
v_and_b32 v121, s12, v170
v_lshlrev_b32 v122, 16, v171
v_and_b32 v123, s12, v171
v_mfma_f32_16x16x32_bf16 v[92:95], a[84:87], v[140:143], v[92:95]
v_mul_f32 v108, v116, v16
v_mul_f32 v109, v117, v16
v_mul_f32 v110, v118, v16
v_mfma_f32_16x16x32_bf16 v[48:51], a[24:27], v[144:147], v[48:51]
ds_read_b128 v[140:143], v11 offset:18432
v_mul_f32 v111, v119, v16
v_mul_f32 v112, v120, v16
v_mul_f32 v113, v121, v16
v_mfma_f32_16x16x32_bf16 v[52:55], a[28:31], v[144:147], v[52:55]
v_mul_f32 v114, v122, v16
v_mul_f32 v115, v123, v16
v_mfma_f32_16x16x32_bf16 v[56:59], a[88:91], v[144:147], v[56:59]
v_mfma_f32_16x16x32_bf16 v[60:63], a[92:95], v[144:147], v[60:63]
s_waitcnt vmcnt(13)
s_xor_b32 s35, s13, 0x27000
buffer_load_dwordx4 a[240:243], v252, s[56:59], s35 offen offset:0
v_mfma_f32_16x16x32_bf16 v[64:67], a[24:27], v[148:151], v[64:67]
ds_read_b128 v[144:147], v12 offset:2048
v_lshlrev_b32 v116, 16, v172
v_and_b32 v117, s12, v172
v_mfma_f32_16x16x32_bf16 v[68:71], a[28:31], v[148:151], v[68:71]
v_lshlrev_b32 v118, 16, v173
v_and_b32 v119, s12, v173
v_mfma_f32_16x16x32_bf16 v[72:75], a[88:91], v[148:151], v[72:75]
v_lshlrev_b32 v120, 16, v174
v_and_b32 v121, s12, v174
v_mfma_f32_16x16x32_bf16 v[76:79], a[92:95], v[148:151], v[76:79]
v_lshlrev_b32 v122, 16, v175
v_and_b32 v123, s12, v175
v_mfma_f32_16x16x32_bf16 v[80:83], a[24:27], v[152:155], v[80:83]
ds_read_b128 v[148:151], v12 offset:10240
v_fmac_f32 v108, v116, v18
v_fmac_f32 v109, v117, v18
v_mfma_f32_16x16x32_bf16 v[84:87], a[28:31], v[152:155], v[84:87]
v_fmac_f32 v110, v118, v18
v_fmac_f32 v111, v119, v18
v_mfma_f32_16x16x32_bf16 v[88:91], a[88:91], v[152:155], v[88:91]
v_fmac_f32 v112, v120, v18
v_fmac_f32 v113, v121, v18
v_mfma_f32_16x16x32_bf16 v[92:95], a[92:95], v[152:155], v[92:95]
v_fmac_f32 v114, v122, v18
v_fmac_f32 v115, v123, v18
s_waitcnt vmcnt(13)
s_add_u32 s39, s53, s47
buffer_load_dwordx4 v[220:223], v10, s[20:23], s39 offen offset:0 sc1
v_mfma_f32_16x16x32_bf16 v[48:51], a[32:35], v[132:135], v[48:51]
ds_read_b128 v[152:155], v12 offset:18432
v_lshlrev_b32 v116, 16, v176
v_and_b32 v117, s12, v176
v_mfma_f32_16x16x32_bf16 v[52:55], a[36:39], v[132:135], v[52:55]
v_lshlrev_b32 v118, 16, v177
v_and_b32 v119, s12, v177
v_mfma_f32_16x16x32_bf16 v[56:59], a[96:99], v[132:135], v[56:59]
v_lshlrev_b32 v120, 16, v178
v_and_b32 v121, s12, v178
v_mfma_f32_16x16x32_bf16 v[60:63], a[100:103], v[132:135], v[60:63]
v_lshlrev_b32 v122, 16, v179
v_and_b32 v123, s12, v179
s_waitcnt lgkmcnt(5)
v_mfma_f32_16x16x32_bf16 v[64:67], a[32:35], v[136:139], v[64:67]
ds_read_b128 v[132:135], v11 offset:3072
v_fmac_f32 v108, v116, v20
v_fmac_f32 v109, v117, v20
v_mfma_f32_16x16x32_bf16 v[68:71], a[36:39], v[136:139], v[68:71]
v_fmac_f32 v110, v118, v20
v_fmac_f32 v111, v119, v20
v_mfma_f32_16x16x32_bf16 v[72:75], a[96:99], v[136:139], v[72:75]
v_fmac_f32 v112, v120, v20
v_fmac_f32 v113, v121, v20
v_mfma_f32_16x16x32_bf16 v[76:79], a[100:103], v[136:139], v[76:79]
v_fmac_f32 v114, v122, v20
v_fmac_f32 v115, v123, v20
s_waitcnt vmcnt(13)
s_xor_b32 s32, s13, 0x27000
buffer_load_dwordx4 a[244:247], v252, s[56:59], s32 offen offset:1024
s_waitcnt lgkmcnt(4)
v_mfma_f32_16x16x32_bf16 v[80:83], a[32:35], v[140:143], v[80:83]
ds_read_b128 v[136:139], v11 offset:11264
v_lshlrev_b32 v116, 16, v180
v_and_b32 v117, s12, v180
v_mfma_f32_16x16x32_bf16 v[84:87], a[36:39], v[140:143], v[84:87]
v_lshlrev_b32 v118, 16, v181
v_and_b32 v119, s12, v181
v_mfma_f32_16x16x32_bf16 v[88:91], a[96:99], v[140:143], v[88:91]
v_lshlrev_b32 v120, 16, v182
v_and_b32 v121, s12, v182
v_mfma_f32_16x16x32_bf16 v[92:95], a[100:103], v[140:143], v[92:95]
v_lshlrev_b32 v122, 16, v183
v_and_b32 v123, s12, v183
s_waitcnt lgkmcnt(4)
v_mfma_f32_16x16x32_bf16 v[48:51], a[40:43], v[144:147], v[48:51]
ds_read_b128 v[140:143], v11 offset:19456
v_fmac_f32 v108, v116, v22
v_fmac_f32 v109, v117, v22
v_mfma_f32_16x16x32_bf16 v[52:55], a[44:47], v[144:147], v[52:55]
v_fmac_f32 v110, v118, v22
v_fmac_f32 v111, v119, v22
v_mfma_f32_16x16x32_bf16 v[56:59], a[104:107], v[144:147], v[56:59]
v_fmac_f32 v112, v120, v22
v_fmac_f32 v113, v121, v22
v_mfma_f32_16x16x32_bf16 v[60:63], a[108:111], v[144:147], v[60:63]
v_fmac_f32 v114, v122, v22
v_fmac_f32 v115, v123, v22
s_waitcnt lgkmcnt(4)
v_mfma_f32_16x16x32_bf16 v[64:67], a[40:43], v[148:151], v[64:67]
ds_read_b128 v[144:147], v12 offset:3072
v_lshlrev_b32 v116, 16, v96
v_and_b32 v117, s12, v96
v_mfma_f32_16x16x32_bf16 v[68:71], a[44:47], v[148:151], v[68:71]
v_lshlrev_b32 v118, 16, v97
v_and_b32 v119, s12, v97
v_mfma_f32_16x16x32_bf16 v[72:75], a[104:107], v[148:151], v[72:75]
v_lshlrev_b32 v120, 16, v98
v_and_b32 v121, s12, v98
v_mfma_f32_16x16x32_bf16 v[76:79], a[108:111], v[148:151], v[76:79]
v_lshlrev_b32 v122, 16, v99
v_and_b32 v123, s12, v99
s_waitcnt lgkmcnt(4)
v_mfma_f32_16x16x32_bf16 v[80:83], a[40:43], v[152:155], v[80:83]
ds_read_b128 v[148:151], v12 offset:11264
v_fmac_f32 v108, v116, v26
v_fmac_f32 v109, v117, v26
v_mfma_f32_16x16x32_bf16 v[84:87], a[44:47], v[152:155], v[84:87]
v_fmac_f32 v110, v118, v26
v_fmac_f32 v111, v119, v26
v_mfma_f32_16x16x32_bf16 v[88:91], a[104:107], v[152:155], v[88:91]
v_fmac_f32 v112, v120, v26
v_fmac_f32 v113, v121, v26
v_mfma_f32_16x16x32_bf16 v[92:95], a[108:111], v[152:155], v[92:95]
v_fmac_f32 v114, v122, v26
v_fmac_f32 v115, v123, v26
s_waitcnt vmcnt(13)
s_add_u32 s33, s53, s15
buffer_load_dwordx4 v[224:227], v10, s[20:23], s33 offen offset:0 sc1
s_waitcnt lgkmcnt(4)
v_mfma_f32_16x16x32_bf16 v[48:51], a[48:51], v[132:135], v[48:51]
ds_read_b128 v[152:155], v12 offset:19456
v_lshlrev_b32 v116, 16, v184
v_and_b32 v117, s12, v184
v_lshlrev_b32 v118, 16, v185
v_mfma_f32_16x16x32_bf16 v[52:55], a[52:55], v[132:135], v[52:55]
v_and_b32 v119, s12, v185
v_lshlrev_b32 v120, 16, v186
v_and_b32 v121, s12, v186
v_mfma_f32_16x16x32_bf16 v[56:59], a[112:115], v[132:135], v[56:59]
v_lshlrev_b32 v122, 16, v187
v_and_b32 v123, s12, v187
v_fmac_f32 v108, v116, v24
v_mfma_f32_16x16x32_bf16 v[60:63], a[116:119], v[132:135], v[60:63]
v_fmac_f32 v109, v117, v24
v_fmac_f32 v110, v118, v24
v_fmac_f32 v111, v119, v24
s_waitcnt lgkmcnt(4)
v_mfma_f32_16x16x32_bf16 v[64:67], a[48:51], v[136:139], v[64:67]
v_fmac_f32 v112, v120, v24
v_fmac_f32 v113, v121, v24
v_fmac_f32 v114, v122, v24
v_mfma_f32_16x16x32_bf16 v[68:71], a[52:55], v[136:139], v[68:71]
v_fmac_f32 v115, v123, v24
v_cvt_pk_bf16_f32 v116, v108, v109
v_cvt_pk_bf16_f32 v117, v110, v111
v_mfma_f32_16x16x32_bf16 v[72:75], a[112:115], v[136:139], v[72:75]
v_cvt_pk_bf16_f32 v118, v112, v113
v_cvt_pk_bf16_f32 v119, v114, v115
ds_write_b128 v38, v[116:119] offset:0
v_mfma_f32_16x16x32_bf16 v[76:79], a[116:119], v[136:139], v[76:79]
s_waitcnt vmcnt(13)
s_xor_b32 s35, s13, 0x23800
buffer_load_dwordx4 a[184:187], v252, s[56:59], s35 offen offset:0
s_waitcnt lgkmcnt(4)
v_mfma_f32_16x16x32_bf16 v[80:83], a[48:51], v[140:143], v[80:83]
ds_read_b128 v[96:99], v44 offset:1024
v_lshlrev_b32 v116, 16, v188
v_and_b32 v117, s12, v188
v_mfma_f32_16x16x32_bf16 v[84:87], a[52:55], v[140:143], v[84:87]
v_lshlrev_b32 v118, 16, v189
v_and_b32 v119, s12, v189
v_lshlrev_b32 v120, 16, v190
v_mfma_f32_16x16x32_bf16 v[88:91], a[112:115], v[140:143], v[88:91]
v_and_b32 v121, s12, v190
v_lshlrev_b32 v122, 16, v191
v_and_b32 v123, s12, v191
v_mfma_f32_16x16x32_bf16 v[92:95], a[116:119], v[140:143], v[92:95]
v_mul_f32 v108, v116, v16
v_mul_f32 v109, v117, v16
v_mul_f32 v110, v118, v16
s_waitcnt lgkmcnt(4)
v_mfma_f32_16x16x32_bf16 v[48:51], a[56:59], v[144:147], v[48:51]
v_mul_f32 v111, v119, v16
v_mul_f32 v112, v120, v16
v_mul_f32 v113, v121, v16
v_mfma_f32_16x16x32_bf16 v[52:55], a[60:63], v[144:147], v[52:55]
v_mul_f32 v114, v122, v16
v_mul_f32 v115, v123, v16
v_mfma_f32_16x16x32_bf16 v[56:59], a[120:123], v[144:147], v[56:59]
v_mfma_f32_16x16x32_bf16 v[60:63], a[124:127], v[144:147], v[60:63]
s_waitcnt vmcnt(13)
s_add_u32 s39, s53, s44
buffer_load_dwordx4 v[228:231], v10, s[20:23], s39 offen offset:1024 sc1
s_waitcnt lgkmcnt(3)
v_mfma_f32_16x16x32_bf16 v[64:67], a[56:59], v[148:151], v[64:67]
v_lshlrev_b32 v116, 16, v192
v_and_b32 v117, s12, v192
v_mfma_f32_16x16x32_bf16 v[68:71], a[60:63], v[148:151], v[68:71]
v_lshlrev_b32 v118, 16, v193
v_and_b32 v119, s12, v193
v_mfma_f32_16x16x32_bf16 v[72:75], a[120:123], v[148:151], v[72:75]
v_lshlrev_b32 v120, 16, v194
v_and_b32 v121, s12, v194
v_mfma_f32_16x16x32_bf16 v[76:79], a[124:127], v[148:151], v[76:79]
v_lshlrev_b32 v122, 16, v195
v_and_b32 v123, s12, v195
s_waitcnt lgkmcnt(2)
v_mfma_f32_16x16x32_bf16 v[80:83], a[56:59], v[152:155], v[80:83]
v_fmac_f32 v108, v116, v18
v_fmac_f32 v109, v117, v18
v_mfma_f32_16x16x32_bf16 v[84:87], a[60:63], v[152:155], v[84:87]
v_fmac_f32 v110, v118, v18
v_fmac_f32 v111, v119, v18
v_mfma_f32_16x16x32_bf16 v[88:91], a[120:123], v[152:155], v[88:91]
v_fmac_f32 v112, v120, v18
v_fmac_f32 v113, v121, v18
v_mfma_f32_16x16x32_bf16 v[92:95], a[124:127], v[152:155], v[92:95]
v_fmac_f32 v114, v122, v18
v_fmac_f32 v115, v123, v18
s_waitcnt vmcnt(13)
s_xor_b32 s32, s13, 0x23800
buffer_load_dwordx4 a[188:191], v252, s[56:59], s32 offen offset:1024
v_lshlrev_b32 v116, 16, v196
v_and_b32 v117, s12, v196
v_lshlrev_b32 v118, 16, v197
v_and_b32 v119, s12, v197
v_lshlrev_b32 v120, 16, v198
v_and_b32 v121, s12, v198
v_lshlrev_b32 v122, 16, v199
v_and_b32 v123, s12, v199
v_pk_fma_f32 v[108:109], v[116:117], v[20:21], v[108:109]
v_pk_fma_f32 v[110:111], v[118:119], v[20:21], v[110:111]
v_pk_fma_f32 v[112:113], v[120:121], v[20:21], v[112:113]
v_pk_fma_f32 v[114:115], v[122:123], v[20:21], v[114:115]
s_waitcnt vmcnt(13)
s_add_u32 s33, s53, s45
buffer_load_dwordx4 v[232:235], v10, s[20:23], s33 offen offset:1024 sc1
v_lshlrev_b32 v116, 16, v200
v_and_b32 v117, s12, v200
v_lshlrev_b32 v118, 16, v201
v_and_b32 v119, s12, v201
v_lshlrev_b32 v120, 16, v202
v_and_b32 v121, s12, v202
v_lshlrev_b32 v122, 16, v203
v_and_b32 v123, s12, v203
v_pk_fma_f32 v[108:109], v[116:117], v[22:23], v[108:109]
v_pk_fma_f32 v[110:111], v[118:119], v[22:23], v[110:111]
v_pk_fma_f32 v[112:113], v[120:121], v[22:23], v[112:113]
v_pk_fma_f32 v[114:115], v[122:123], v[22:23], v[114:115]
s_waitcnt lgkmcnt(0)
v_lshlrev_b32 v116, 16, v96
v_and_b32 v117, s12, v96
v_lshlrev_b32 v118, 16, v97
v_and_b32 v119, s12, v97
v_lshlrev_b32 v120, 16, v98
v_and_b32 v121, s12, v98
v_lshlrev_b32 v122, 16, v99
v_and_b32 v123, s12, v99
v_pk_fma_f32 v[108:109], v[116:117], v[26:27], v[108:109]
v_pk_fma_f32 v[110:111], v[118:119], v[26:27], v[110:111]
v_pk_fma_f32 v[112:113], v[120:121], v[26:27], v[112:113]
v_pk_fma_f32 v[114:115], v[122:123], v[26:27], v[114:115]
s_waitcnt vmcnt(13)
s_xor_b32 s35, s13, 0x27800
buffer_load_dwordx4 a[248:251], v252, s[56:59], s35 offen offset:0
v_lshlrev_b32 v116, 16, v204
v_and_b32 v117, s12, v204
v_lshlrev_b32 v118, 16, v205
v_and_b32 v119, s12, v205
v_lshlrev_b32 v120, 16, v206
v_and_b32 v121, s12, v206
v_lshlrev_b32 v122, 16, v207
v_and_b32 v123, s12, v207
v_pk_fma_f32 v[108:109], v[116:117], v[24:25], v[108:109]
v_pk_fma_f32 v[110:111], v[118:119], v[24:25], v[110:111]
v_pk_fma_f32 v[112:113], v[120:121], v[24:25], v[112:113]
v_pk_fma_f32 v[114:115], v[122:123], v[24:25], v[114:115]
ds_read2_b32 v[16:17], v14 offset0:1 offset1:1
ds_read2_b32 v[18:19], v14 offset0:2 offset1:2
ds_read2_b32 v[20:21], v14 offset0:3 offset1:3
ds_read2_b32 v[22:23], v14 offset0:4 offset1:4
ds_read2_b32 v[24:25], v14 offset0:5 offset1:5
ds_read2_b32 v[26:27], v14 offset0:6 offset1:6
v_add_u32 v14, 0x500, v14
v_cvt_pk_bf16_f32 v116, v108, v109
v_cvt_pk_bf16_f32 v117, v110, v111
v_cvt_pk_bf16_f32 v118, v112, v113
v_cvt_pk_bf16_f32 v119, v114, v115
ds_write_b128 v39, v[116:119] offset:0
s_waitcnt lgkmcnt(0)
s_barrier
ds_read_b128 v[132:135], v15 offset:0
ds_read_b128 v[136:139], v15 offset:1024
ds_read_b128 v[140:143], v15 offset:2048
ds_read_b128 v[144:147], v15 offset:3072
ds_read_b128 v[148:151], v15 offset:4096
s_waitcnt lgkmcnt(4)
v_mfma_f32_16x16x32_bf16 v[48:51], a[128:131], v[132:135], v[48:51]
ds_read_b128 v[152:155], v15 offset:5120
v_mfma_f32_16x16x32_bf16 v[52:55], a[132:135], v[132:135], v[52:55]
v_mfma_f32_16x16x32_bf16 v[56:59], a[192:195], v[132:135], v[56:59]
v_mfma_f32_16x16x32_bf16 v[60:63], a[196:199], v[132:135], v[60:63]
s_waitcnt vmcnt(13)
s_add_u32 s39, s53, s46
buffer_load_dwordx4 v[236:239], v10, s[20:23], s39 offen offset:1024 sc1
s_waitcnt lgkmcnt(4)
v_mfma_f32_16x16x32_bf16 v[48:51], a[136:139], v[136:139], v[48:51]
ds_read_b128 v[132:135], v15 offset:6144
ds_read_b128 v[96:99], v45 offset:0
v_lshlrev_b32 v116, 16, v208
v_and_b32 v117, s12, v208
v_mfma_f32_16x16x32_bf16 v[52:55], a[140:143], v[136:139], v[52:55]
v_lshlrev_b32 v118, 16, v209
v_and_b32 v119, s12, v209
v_lshlrev_b32 v120, 16, v210
v_mfma_f32_16x16x32_bf16 v[56:59], a[200:203], v[136:139], v[56:59]
v_and_b32 v121, s12, v210
v_lshlrev_b32 v122, 16, v211
v_and_b32 v123, s12, v211
v_mfma_f32_16x16x32_bf16 v[60:63], a[204:207], v[136:139], v[60:63]
v_mul_f32 v108, v116, v16
v_mul_f32 v109, v117, v16
v_mul_f32 v110, v118, v16
s_waitcnt lgkmcnt(5)
v_mfma_f32_16x16x32_bf16 v[48:51], a[144:147], v[140:143], v[48:51]
ds_read_b128 v[136:139], v15 offset:7168
v_mul_f32 v111, v119, v16
v_mul_f32 v112, v120, v16
v_mul_f32 v113, v121, v16
v_mfma_f32_16x16x32_bf16 v[52:55], a[148:151], v[140:143], v[52:55]
v_mul_f32 v114, v122, v16
v_mul_f32 v115, v123, v16
v_mfma_f32_16x16x32_bf16 v[56:59], a[208:211], v[140:143], v[56:59]
v_mfma_f32_16x16x32_bf16 v[60:63], a[212:215], v[140:143], v[60:63]
s_waitcnt vmcnt(13)
s_xor_b32 s32, s13, 0x27800
buffer_load_dwordx4 a[252:255], v252, s[56:59], s32 offen offset:1024
s_waitcnt vmcnt(13)
s_add_u32 s33, s53, s47
buffer_load_dwordx4 v[240:243], v10, s[20:23], s33 offen offset:1024 sc1
s_waitcnt lgkmcnt(5)
v_mfma_f32_16x16x32_bf16 v[48:51], a[152:155], v[144:147], v[48:51]
v_lshlrev_b32 v116, 16, v212
v_and_b32 v117, s12, v212
v_mfma_f32_16x16x32_bf16 v[52:55], a[156:159], v[144:147], v[52:55]
v_lshlrev_b32 v118, 16, v213
v_and_b32 v119, s12, v213
v_mfma_f32_16x16x32_bf16 v[56:59], a[216:219], v[144:147], v[56:59]
v_lshlrev_b32 v120, 16, v214
v_and_b32 v121, s12, v214
v_mfma_f32_16x16x32_bf16 v[60:63], a[220:223], v[144:147], v[60:63]
v_lshlrev_b32 v122, 16, v215
v_and_b32 v123, s12, v215
s_waitcnt lgkmcnt(4)
v_mfma_f32_16x16x32_bf16 v[48:51], a[160:163], v[148:151], v[48:51]
v_fmac_f32 v108, v116, v18
v_fmac_f32 v109, v117, v18
v_mfma_f32_16x16x32_bf16 v[52:55], a[164:167], v[148:151], v[52:55]
v_fmac_f32 v110, v118, v18
v_fmac_f32 v111, v119, v18
v_mfma_f32_16x16x32_bf16 v[56:59], a[224:227], v[148:151], v[56:59]
v_fmac_f32 v112, v120, v18
v_fmac_f32 v113, v121, v18
v_mfma_f32_16x16x32_bf16 v[60:63], a[228:231], v[148:151], v[60:63]
v_fmac_f32 v114, v122, v18
v_fmac_f32 v115, v123, v18
s_waitcnt vmcnt(13)
s_add_u32 s35, s53, s15
buffer_load_dwordx4 v[244:247], v10, s[20:23], s35 offen offset:1024 sc1
s_waitcnt vmcnt(13)
s_add_u32 s39, s54, s44
buffer_load_dwordx4 v[156:159], v10, s[20:23], s39 offen offset:0 sc1
s_waitcnt lgkmcnt(3)
v_mfma_f32_16x16x32_bf16 v[48:51], a[168:171], v[152:155], v[48:51]
v_lshlrev_b32 v116, 16, v216
v_and_b32 v117, s12, v216
v_lshlrev_b32 v118, 16, v217
v_and_b32 v119, s12, v217
v_mfma_f32_16x16x32_bf16 v[52:55], a[172:175], v[152:155], v[52:55]
v_lshlrev_b32 v120, 16, v218
v_and_b32 v121, s12, v218
v_lshlrev_b32 v122, 16, v219
v_and_b32 v123, s12, v219
v_mfma_f32_16x16x32_bf16 v[56:59], a[232:235], v[152:155], v[56:59]
v_fmac_f32 v108, v116, v20
v_fmac_f32 v109, v117, v20
v_fmac_f32 v110, v118, v20
v_fmac_f32 v111, v119, v20
v_mfma_f32_16x16x32_bf16 v[60:63], a[236:239], v[152:155], v[60:63]
v_fmac_f32 v112, v120, v20
v_fmac_f32 v113, v121, v20
v_fmac_f32 v114, v122, v20
v_fmac_f32 v115, v123, v20
s_waitcnt vmcnt(13)
s_add_u32 s32, s54, s45
buffer_load_dwordx4 v[160:163], v10, s[20:23], s32 offen offset:0 sc1
s_waitcnt vmcnt(13)
s_add_u32 s33, s54, s46
buffer_load_dwordx4 v[164:167], v10, s[20:23], s33 offen offset:0 sc1
v_lshlrev_b32 v116, 16, v220
v_and_b32 v117, s12, v220
v_lshlrev_b32 v118, 16, v221
v_and_b32 v119, s12, v221
v_lshlrev_b32 v120, 16, v222
v_and_b32 v121, s12, v222
v_lshlrev_b32 v122, 16, v223
v_and_b32 v123, s12, v223
v_pk_fma_f32 v[108:109], v[116:117], v[22:23], v[108:109]
v_pk_fma_f32 v[110:111], v[118:119], v[22:23], v[110:111]
v_pk_fma_f32 v[112:113], v[120:121], v[22:23], v[112:113]
v_pk_fma_f32 v[114:115], v[122:123], v[22:23], v[114:115]
s_waitcnt lgkmcnt(1)
v_lshlrev_b32 v116, 16, v96
v_and_b32 v117, s12, v96
v_lshlrev_b32 v118, 16, v97
v_and_b32 v119, s12, v97
v_lshlrev_b32 v120, 16, v98
v_and_b32 v121, s12, v98
v_lshlrev_b32 v122, 16, v99
v_and_b32 v123, s12, v99
v_pk_fma_f32 v[108:109], v[116:117], v[26:27], v[108:109]
v_pk_fma_f32 v[110:111], v[118:119], v[26:27], v[110:111]
v_pk_fma_f32 v[112:113], v[120:121], v[26:27], v[112:113]
v_pk_fma_f32 v[114:115], v[122:123], v[26:27], v[114:115]
s_waitcnt vmcnt(13)
s_add_u32 s35, s54, s47
buffer_load_dwordx4 v[168:171], v10, s[20:23], s35 offen offset:0 sc1
s_waitcnt vmcnt(13)
s_add_u32 s39, s54, s15
buffer_load_dwordx4 v[172:175], v10, s[20:23], s39 offen offset:0 sc1
v_mfma_f32_16x16x32_bf16 v[48:51], a[176:179], v[132:135], v[48:51]
v_lshlrev_b32 v116, 16, v224
v_and_b32 v117, s12, v224
v_lshlrev_b32 v118, 16, v225
v_and_b32 v119, s12, v225
v_lshlrev_b32 v120, 16, v226
v_and_b32 v121, s12, v226
v_mfma_f32_16x16x32_bf16 v[52:55], a[180:183], v[132:135], v[52:55]
v_lshlrev_b32 v122, 16, v227
v_and_b32 v123, s12, v227
v_fmac_f32 v108, v116, v24
v_fmac_f32 v109, v117, v24
v_fmac_f32 v110, v118, v24
v_fmac_f32 v111, v119, v24
v_mfma_f32_16x16x32_bf16 v[56:59], a[240:243], v[132:135], v[56:59]
v_fmac_f32 v112, v120, v24
v_fmac_f32 v113, v121, v24
v_fmac_f32 v114, v122, v24
v_fmac_f32 v115, v123, v24
v_cvt_pk_bf16_f32 v116, v108, v109
v_cvt_pk_bf16_f32 v117, v110, v111
v_mfma_f32_16x16x32_bf16 v[60:63], a[244:247], v[132:135], v[60:63]
v_cvt_pk_bf16_f32 v118, v112, v113
v_cvt_pk_bf16_f32 v119, v114, v115
ds_write_b128 v38, v[116:119] offset:8192
s_waitcnt vmcnt(13)
s_add_u32 s32, s54, s44
buffer_load_dwordx4 v[176:179], v10, s[20:23], s32 offen offset:1024 sc1
s_waitcnt vmcnt(13)
s_add_u32 s33, s54, s45
buffer_load_dwordx4 v[180:183], v10, s[20:23], s33 offen offset:1024 sc1
ds_read_b128 v[96:99], v45 offset:1024
v_lshlrev_b32 v116, 16, v228
v_and_b32 v117, s12, v228
v_lshlrev_b32 v118, 16, v229
v_and_b32 v119, s12, v229
v_lshlrev_b32 v120, 16, v230
v_and_b32 v121, s12, v230
v_lshlrev_b32 v122, 16, v231
v_and_b32 v123, s12, v231
v_pk_mul_f32 v[108:109], v[116:117], v[16:17]
v_pk_mul_f32 v[110:111], v[118:119], v[16:17]
v_pk_mul_f32 v[112:113], v[120:121], v[16:17]
v_pk_mul_f32 v[114:115], v[122:123], v[16:17]
s_waitcnt vmcnt(13)
s_add_u32 s35, s54, s46
buffer_load_dwordx4 v[184:187], v10, s[20:23], s35 offen offset:1024 sc1
s_waitcnt vmcnt(13)
s_add_u32 s39, s54, s47
buffer_load_dwordx4 v[188:191], v10, s[20:23], s39 offen offset:1024 sc1
v_lshlrev_b32 v116, 16, v232
v_and_b32 v117, s12, v232
v_lshlrev_b32 v118, 16, v233
v_and_b32 v119, s12, v233
v_lshlrev_b32 v120, 16, v234
v_and_b32 v121, s12, v234
v_lshlrev_b32 v122, 16, v235
v_and_b32 v123, s12, v235
v_pk_fma_f32 v[108:109], v[116:117], v[18:19], v[108:109]
v_pk_fma_f32 v[110:111], v[118:119], v[18:19], v[110:111]
v_pk_fma_f32 v[112:113], v[120:121], v[18:19], v[112:113]
v_pk_fma_f32 v[114:115], v[122:123], v[18:19], v[114:115]
s_waitcnt vmcnt(13)
s_add_u32 s32, s54, s15
buffer_load_dwordx4 v[192:195], v10, s[20:23], s32 offen offset:1024 sc1
s_waitcnt vmcnt(13)
v_lshlrev_b32 v116, 16, v236
v_and_b32 v117, s12, v236
v_lshlrev_b32 v118, 16, v237
v_and_b32 v119, s12, v237
v_lshlrev_b32 v120, 16, v238
v_and_b32 v121, s12, v238
v_lshlrev_b32 v122, 16, v239
v_and_b32 v123, s12, v239
v_pk_fma_f32 v[108:109], v[116:117], v[20:21], v[108:109]
v_pk_fma_f32 v[110:111], v[118:119], v[20:21], v[110:111]
v_pk_fma_f32 v[112:113], v[120:121], v[20:21], v[112:113]
v_pk_fma_f32 v[114:115], v[122:123], v[20:21], v[114:115]
s_waitcnt vmcnt(12)
s_waitcnt vmcnt(11)
s_waitcnt lgkmcnt(2)
v_mfma_f32_16x16x32_bf16 v[48:51], a[184:187], v[136:139], v[48:51]
v_lshlrev_b32 v116, 16, v240
v_and_b32 v117, s12, v240
v_lshlrev_b32 v118, 16, v241
v_and_b32 v119, s12, v241
v_lshlrev_b32 v120, 16, v242
v_and_b32 v121, s12, v242
v_lshlrev_b32 v122, 16, v243
v_and_b32 v123, s12, v243
v_mfma_f32_16x16x32_bf16 v[52:55], a[188:191], v[136:139], v[52:55]
v_fmac_f32 v108, v116, v22
v_fmac_f32 v109, v117, v22
v_fmac_f32 v110, v118, v22
v_fmac_f32 v111, v119, v22
v_fmac_f32 v112, v120, v22
v_fmac_f32 v113, v121, v22
v_fmac_f32 v114, v122, v22
v_fmac_f32 v115, v123, v22
v_mfma_f32_16x16x32_bf16 v[56:59], a[248:251], v[136:139], v[56:59]
s_waitcnt lgkmcnt(0)
v_lshlrev_b32 v116, 16, v96
v_and_b32 v117, s12, v96
v_lshlrev_b32 v118, 16, v97
v_and_b32 v119, s12, v97
v_lshlrev_b32 v120, 16, v98
v_and_b32 v121, s12, v98
v_lshlrev_b32 v122, 16, v99
v_and_b32 v123, s12, v99
v_mfma_f32_16x16x32_bf16 v[60:63], a[252:255], v[136:139], v[60:63]
v_fmac_f32 v108, v116, v26
v_fmac_f32 v109, v117, v26
v_fmac_f32 v110, v118, v26
v_fmac_f32 v111, v119, v26
v_fmac_f32 v112, v120, v26
v_fmac_f32 v113, v121, v26
v_fmac_f32 v114, v122, v26
v_fmac_f32 v115, v123, v26
s_waitcnt vmcnt(10)
v_lshlrev_b32 v116, 16, v244
v_and_b32 v117, s12, v244
v_lshlrev_b32 v118, 16, v245
v_and_b32 v119, s12, v245
v_lshlrev_b32 v120, 16, v246
v_and_b32 v121, s12, v246
v_lshlrev_b32 v122, 16, v247
v_and_b32 v123, s12, v247
v_pk_fma_f32 v[108:109], v[116:117], v[24:25], v[108:109]
v_pk_fma_f32 v[110:111], v[118:119], v[24:25], v[110:111]
v_pk_fma_f32 v[112:113], v[120:121], v[24:25], v[112:113]
v_pk_fma_f32 v[114:115], v[122:123], v[24:25], v[114:115]
ds_read2_b32 v[16:17], v14 offset0:1 offset1:1
ds_read2_b32 v[18:19], v14 offset0:2 offset1:2
ds_read2_b32 v[20:21], v14 offset0:3 offset1:3
ds_read2_b32 v[22:23], v14 offset0:4 offset1:4
ds_read2_b32 v[24:25], v14 offset0:5 offset1:5
ds_read2_b32 v[26:27], v14 offset0:6 offset1:6
v_cvt_pk_bf16_f32 v116, v108, v109
v_cvt_pk_bf16_f32 v117, v110, v111
v_cvt_pk_bf16_f32 v118, v112, v113
v_cvt_pk_bf16_f32 v119, v114, v115
ds_write_b128 v39, v[116:119] offset:8192
s_waitcnt lgkmcnt(0)
s_barrier
ds_read_b128 v[140:143], v15 offset:8192
ds_read_b128 v[144:147], v15 offset:9216
ds_read_b128 v[148:151], v15 offset:10240
ds_read_b128 v[152:155], v15 offset:11264
ds_read_b128 v[132:135], v15 offset:12288
v_cvt_pk_bf16_f32 v48, v48, v49
v_cvt_pk_bf16_f32 v49, v50, v51
v_cvt_pk_bf16_f32 v50, v52, v53
v_cvt_pk_bf16_f32 v51, v54, v55
ds_write_b128 v32, v[48:51] offset:0
v_cvt_pk_bf16_f32 v56, v56, v57
v_cvt_pk_bf16_f32 v57, v58, v59
v_cvt_pk_bf16_f32 v58, v60, v61
v_cvt_pk_bf16_f32 v59, v62, v63
ds_write_b128 v33, v[56:59] offset:0
ds_read_b128 v[52:55], v34 offset:0
ds_read_b128 v[60:63], v34 offset:1024
s_waitcnt lgkmcnt(8)
v_mfma_f32_16x16x32_bf16 v[64:67], a[128:131], v[140:143], v[64:67]
ds_read_b128 v[136:139], v15 offset:13312
v_mfma_f32_16x16x32_bf16 v[68:71], a[132:135], v[140:143], v[68:71]
v_mfma_f32_16x16x32_bf16 v[72:75], a[192:195], v[140:143], v[72:75]
v_mfma_f32_16x16x32_bf16 v[76:79], a[196:199], v[140:143], v[76:79]
s_waitcnt vmcnt(9)
s_add_u32 s33, s52, 0
s_waitcnt lgkmcnt(2)
buffer_store_dwordx4 v[52:55], v9, s[40:43], s33 offen sc1
s_add_u32 s35, s52, 4096
s_waitcnt lgkmcnt(1)
buffer_store_dwordx4 v[60:63], v9, s[40:43], s35 offen sc1
v_mfma_f32_16x16x32_bf16 v[64:67], a[136:139], v[144:147], v[64:67]
ds_read_b128 v[140:143], v15 offset:14336
ds_read_b128 v[96:99], v46 offset:0
v_lshlrev_b32 v116, 16, v156
v_and_b32 v117, s12, v156
v_mfma_f32_16x16x32_bf16 v[68:71], a[140:143], v[144:147], v[68:71]
v_lshlrev_b32 v118, 16, v157
v_and_b32 v119, s12, v157
v_lshlrev_b32 v120, 16, v158
v_mfma_f32_16x16x32_bf16 v[72:75], a[200:203], v[144:147], v[72:75]
v_and_b32 v121, s12, v158
v_lshlrev_b32 v122, 16, v159
v_and_b32 v123, s12, v159
v_mfma_f32_16x16x32_bf16 v[76:79], a[204:207], v[144:147], v[76:79]
v_mul_f32 v108, v116, v16
v_mul_f32 v109, v117, v16
v_mul_f32 v110, v118, v16
v_mfma_f32_16x16x32_bf16 v[64:67], a[144:147], v[148:151], v[64:67]
ds_read_b128 v[144:147], v15 offset:15360
v_mul_f32 v111, v119, v16
v_mul_f32 v112, v120, v16
v_mul_f32 v113, v121, v16
v_mfma_f32_16x16x32_bf16 v[68:71], a[148:151], v[148:151], v[68:71]
v_mul_f32 v114, v122, v16
v_mul_f32 v115, v123, v16
v_mfma_f32_16x16x32_bf16 v[72:75], a[208:211], v[148:151], v[72:75]
v_mfma_f32_16x16x32_bf16 v[76:79], a[212:215], v[148:151], v[76:79]
s_waitcnt vmcnt(10)
v_mfma_f32_16x16x32_bf16 v[64:67], a[152:155], v[152:155], v[64:67]
v_lshlrev_b32 v116, 16, v160
v_and_b32 v117, s12, v160
v_mfma_f32_16x16x32_bf16 v[68:71], a[156:159], v[152:155], v[68:71]
v_lshlrev_b32 v118, 16, v161
v_and_b32 v119, s12, v161
v_mfma_f32_16x16x32_bf16 v[72:75], a[216:219], v[152:155], v[72:75]
v_lshlrev_b32 v120, 16, v162
v_and_b32 v121, s12, v162
v_mfma_f32_16x16x32_bf16 v[76:79], a[220:223], v[152:155], v[76:79]
v_lshlrev_b32 v122, 16, v163
v_and_b32 v123, s12, v163
v_mfma_f32_16x16x32_bf16 v[64:67], a[160:163], v[132:135], v[64:67]
v_fmac_f32 v108, v116, v18
v_fmac_f32 v109, v117, v18
v_mfma_f32_16x16x32_bf16 v[68:71], a[164:167], v[132:135], v[68:71]
v_fmac_f32 v110, v118, v18
v_fmac_f32 v111, v119, v18
v_mfma_f32_16x16x32_bf16 v[72:75], a[224:227], v[132:135], v[72:75]
v_fmac_f32 v112, v120, v18
v_fmac_f32 v113, v121, v18
v_mfma_f32_16x16x32_bf16 v[76:79], a[228:231], v[132:135], v[76:79]
v_fmac_f32 v114, v122, v18
v_fmac_f32 v115, v123, v18
s_waitcnt vmcnt(9)
s_waitcnt lgkmcnt(3)
v_mfma_f32_16x16x32_bf16 v[64:67], a[168:171], v[136:139], v[64:67]
v_lshlrev_b32 v116, 16, v164
v_and_b32 v117, s12, v164
v_mfma_f32_16x16x32_bf16 v[68:71], a[172:175], v[136:139], v[68:71]
v_lshlrev_b32 v118, 16, v165
v_and_b32 v119, s12, v165
v_mfma_f32_16x16x32_bf16 v[72:75], a[232:235], v[136:139], v[72:75]
v_lshlrev_b32 v120, 16, v166
v_and_b32 v121, s12, v166
v_mfma_f32_16x16x32_bf16 v[76:79], a[236:239], v[136:139], v[76:79]
v_lshlrev_b32 v122, 16, v167
v_and_b32 v123, s12, v167
s_waitcnt lgkmcnt(2)
v_mfma_f32_16x16x32_bf16 v[64:67], a[176:179], v[140:143], v[64:67]
v_fmac_f32 v108, v116, v20
v_fmac_f32 v109, v117, v20
v_mfma_f32_16x16x32_bf16 v[68:71], a[180:183], v[140:143], v[68:71]
v_fmac_f32 v110, v118, v20
v_fmac_f32 v111, v119, v20
v_mfma_f32_16x16x32_bf16 v[72:75], a[240:243], v[140:143], v[72:75]
v_fmac_f32 v112, v120, v20
v_fmac_f32 v113, v121, v20
v_mfma_f32_16x16x32_bf16 v[76:79], a[244:247], v[140:143], v[76:79]
v_fmac_f32 v114, v122, v20
v_fmac_f32 v115, v123, v20
s_waitcnt vmcnt(8)
s_waitcnt lgkmcnt(0)
v_mfma_f32_16x16x32_bf16 v[64:67], a[184:187], v[144:147], v[64:67]
v_lshlrev_b32 v116, 16, v168
v_and_b32 v117, s12, v168
v_lshlrev_b32 v118, 16, v169
v_and_b32 v119, s12, v169
v_lshlrev_b32 v120, 16, v170
v_and_b32 v121, s12, v170
v_lshlrev_b32 v122, 16, v171
v_and_b32 v123, s12, v171
v_mfma_f32_16x16x32_bf16 v[68:71], a[188:191], v[144:147], v[68:71]
v_fmac_f32 v108, v116, v22
v_fmac_f32 v109, v117, v22
v_fmac_f32 v110, v118, v22
v_fmac_f32 v111, v119, v22
v_fmac_f32 v112, v120, v22
v_fmac_f32 v113, v121, v22
v_fmac_f32 v114, v122, v22
v_fmac_f32 v115, v123, v22
v_mfma_f32_16x16x32_bf16 v[72:75], a[248:251], v[144:147], v[72:75]
v_lshlrev_b32 v116, 16, v96
v_and_b32 v117, s12, v96
v_lshlrev_b32 v118, 16, v97
v_and_b32 v119, s12, v97
v_lshlrev_b32 v120, 16, v98
v_and_b32 v121, s12, v98
v_lshlrev_b32 v122, 16, v99
v_and_b32 v123, s12, v99
v_mfma_f32_16x16x32_bf16 v[76:79], a[252:255], v[144:147], v[76:79]
v_fmac_f32 v108, v116, v26
v_fmac_f32 v109, v117, v26
v_fmac_f32 v110, v118, v26
v_fmac_f32 v111, v119, v26
v_fmac_f32 v112, v120, v26
v_fmac_f32 v113, v121, v26
v_fmac_f32 v114, v122, v26
v_fmac_f32 v115, v123, v26
s_waitcnt vmcnt(7)
v_cvt_pk_bf16_f32 v64, v64, v65
v_cvt_pk_bf16_f32 v65, v66, v67
v_cvt_pk_bf16_f32 v66, v68, v69
v_cvt_pk_bf16_f32 v67, v70, v71
ds_write_b128 v32, v[64:67] offset:2048
v_cvt_pk_bf16_f32 v72, v72, v73
v_cvt_pk_bf16_f32 v73, v74, v75
v_cvt_pk_bf16_f32 v74, v76, v77
v_cvt_pk_bf16_f32 v75, v78, v79
ds_write_b128 v33, v[72:75] offset:2048
ds_read_b128 v[68:71], v34 offset:2048
ds_read_b128 v[76:79], v34 offset:3072
v_lshlrev_b32 v116, 16, v172
v_and_b32 v117, s12, v172
v_lshlrev_b32 v118, 16, v173
v_and_b32 v119, s12, v173
v_lshlrev_b32 v120, 16, v174
v_and_b32 v121, s12, v174
v_lshlrev_b32 v122, 16, v175
v_and_b32 v123, s12, v175
v_pk_fma_f32 v[108:109], v[116:117], v[24:25], v[108:109]
v_pk_fma_f32 v[110:111], v[118:119], v[24:25], v[110:111]
v_pk_fma_f32 v[112:113], v[120:121], v[24:25], v[112:113]
v_pk_fma_f32 v[114:115], v[122:123], v[24:25], v[114:115]
v_cvt_pk_bf16_f32 v116, v108, v109
v_cvt_pk_bf16_f32 v117, v110, v111
v_cvt_pk_bf16_f32 v118, v112, v113
v_cvt_pk_bf16_f32 v119, v114, v115
ds_write_b128 v38, v[116:119] offset:16384
s_waitcnt vmcnt(6)
s_add_u32 s39, s53, 0
s_waitcnt lgkmcnt(2)
buffer_store_dwordx4 v[68:71], v9, s[40:43], s39 offen sc1
s_add_u32 s32, s53, 4096
s_waitcnt lgkmcnt(1)
buffer_store_dwordx4 v[76:79], v9, s[40:43], s32 offen sc1
ds_read_b128 v[96:99], v46 offset:1024
v_lshlrev_b32 v116, 16, v176
v_and_b32 v117, s12, v176
v_lshlrev_b32 v118, 16, v177
v_and_b32 v119, s12, v177
v_lshlrev_b32 v120, 16, v178
v_and_b32 v121, s12, v178
v_lshlrev_b32 v122, 16, v179
v_and_b32 v123, s12, v179
v_pk_mul_f32 v[108:109], v[116:117], v[16:17]
v_pk_mul_f32 v[110:111], v[118:119], v[16:17]
v_pk_mul_f32 v[112:113], v[120:121], v[16:17]
v_pk_mul_f32 v[114:115], v[122:123], v[16:17]
s_waitcnt vmcnt(7)
v_lshlrev_b32 v116, 16, v180
v_and_b32 v117, s12, v180
v_lshlrev_b32 v118, 16, v181
v_and_b32 v119, s12, v181
v_lshlrev_b32 v120, 16, v182
v_and_b32 v121, s12, v182
v_lshlrev_b32 v122, 16, v183
v_and_b32 v123, s12, v183
v_pk_fma_f32 v[108:109], v[116:117], v[18:19], v[108:109]
v_pk_fma_f32 v[110:111], v[118:119], v[18:19], v[110:111]
v_pk_fma_f32 v[112:113], v[120:121], v[18:19], v[112:113]
v_pk_fma_f32 v[114:115], v[122:123], v[18:19], v[114:115]
s_waitcnt vmcnt(6)
v_lshlrev_b32 v116, 16, v184
v_and_b32 v117, s12, v184
v_lshlrev_b32 v118, 16, v185
v_and_b32 v119, s12, v185
v_lshlrev_b32 v120, 16, v186
v_and_b32 v121, s12, v186
v_lshlrev_b32 v122, 16, v187
v_and_b32 v123, s12, v187
v_pk_fma_f32 v[108:109], v[116:117], v[20:21], v[108:109]
v_pk_fma_f32 v[110:111], v[118:119], v[20:21], v[110:111]
v_pk_fma_f32 v[112:113], v[120:121], v[20:21], v[112:113]
v_pk_fma_f32 v[114:115], v[122:123], v[20:21], v[114:115]
s_waitcnt vmcnt(5)
v_lshlrev_b32 v116, 16, v188
v_and_b32 v117, s12, v188
v_lshlrev_b32 v118, 16, v189
v_and_b32 v119, s12, v189
v_lshlrev_b32 v120, 16, v190
v_and_b32 v121, s12, v190
v_lshlrev_b32 v122, 16, v191
v_and_b32 v123, s12, v191
v_pk_fma_f32 v[108:109], v[116:117], v[22:23], v[108:109]
v_pk_fma_f32 v[110:111], v[118:119], v[22:23], v[110:111]
v_pk_fma_f32 v[112:113], v[120:121], v[22:23], v[112:113]
v_pk_fma_f32 v[114:115], v[122:123], v[22:23], v[114:115]
s_waitcnt lgkmcnt(0)
v_lshlrev_b32 v116, 16, v96
v_and_b32 v117, s12, v96
v_lshlrev_b32 v118, 16, v97
v_and_b32 v119, s12, v97
v_lshlrev_b32 v120, 16, v98
v_and_b32 v121, s12, v98
v_lshlrev_b32 v122, 16, v99
v_and_b32 v123, s12, v99
v_pk_fma_f32 v[108:109], v[116:117], v[26:27], v[108:109]
v_pk_fma_f32 v[110:111], v[118:119], v[26:27], v[110:111]
v_pk_fma_f32 v[112:113], v[120:121], v[26:27], v[112:113]
v_pk_fma_f32 v[114:115], v[122:123], v[26:27], v[114:115]
s_waitcnt vmcnt(4)
v_lshlrev_b32 v116, 16, v192
v_and_b32 v117, s12, v192
v_lshlrev_b32 v118, 16, v193
v_and_b32 v119, s12, v193
v_lshlrev_b32 v120, 16, v194
v_and_b32 v121, s12, v194
v_lshlrev_b32 v122, 16, v195
v_and_b32 v123, s12, v195
v_pk_fma_f32 v[108:109], v[116:117], v[24:25], v[108:109]
v_pk_fma_f32 v[110:111], v[118:119], v[24:25], v[110:111]
v_pk_fma_f32 v[112:113], v[120:121], v[24:25], v[112:113]
v_pk_fma_f32 v[114:115], v[122:123], v[24:25], v[114:115]
v_cvt_pk_bf16_f32 v116, v108, v109
v_cvt_pk_bf16_f32 v117, v110, v111
v_cvt_pk_bf16_f32 v118, v112, v113
v_cvt_pk_bf16_f32 v119, v114, v115
ds_write_b128 v39, v[116:119] offset:16384
s_waitcnt lgkmcnt(0)
s_barrier
ds_read_b128 v[148:151], v15 offset:16384
ds_read_b128 v[152:155], v15 offset:17408
ds_read_b128 v[132:135], v15 offset:18432
ds_read_b128 v[136:139], v15 offset:19456
ds_read_b128 v[140:143], v15 offset:20480
s_waitcnt lgkmcnt(4)
v_mfma_f32_16x16x32_bf16 v[80:83], a[128:131], v[148:151], v[80:83]
ds_read_b128 v[144:147], v15 offset:21504
v_mfma_f32_16x16x32_bf16 v[84:87], a[132:135], v[148:151], v[84:87]
v_mfma_f32_16x16x32_bf16 v[88:91], a[192:195], v[148:151], v[88:91]
v_mfma_f32_16x16x32_bf16 v[92:95], a[196:199], v[148:151], v[92:95]
s_waitcnt lgkmcnt(4)
v_mfma_f32_16x16x32_bf16 v[80:83], a[136:139], v[152:155], v[80:83]
ds_read_b128 v[148:151], v15 offset:22528
v_mfma_f32_16x16x32_bf16 v[84:87], a[140:143], v[152:155], v[84:87]
v_mfma_f32_16x16x32_bf16 v[88:91], a[200:203], v[152:155], v[88:91]
v_mfma_f32_16x16x32_bf16 v[92:95], a[204:207], v[152:155], v[92:95]
s_waitcnt lgkmcnt(4)
v_mfma_f32_16x16x32_bf16 v[80:83], a[144:147], v[132:135], v[80:83]
ds_read_b128 v[152:155], v15 offset:23552
v_mfma_f32_16x16x32_bf16 v[84:87], a[148:151], v[132:135], v[84:87]
v_mfma_f32_16x16x32_bf16 v[88:91], a[208:211], v[132:135], v[88:91]
v_mfma_f32_16x16x32_bf16 v[92:95], a[212:215], v[132:135], v[92:95]
s_waitcnt lgkmcnt(4)
v_mfma_f32_16x16x32_bf16 v[80:83], a[152:155], v[136:139], v[80:83]
v_mfma_f32_16x16x32_bf16 v[84:87], a[156:159], v[136:139], v[84:87]
v_mfma_f32_16x16x32_bf16 v[88:91], a[216:219], v[136:139], v[88:91]
v_mfma_f32_16x16x32_bf16 v[92:95], a[220:223], v[136:139], v[92:95]
s_waitcnt lgkmcnt(3)
v_mfma_f32_16x16x32_bf16 v[80:83], a[160:163], v[140:143], v[80:83]
v_mfma_f32_16x16x32_bf16 v[84:87], a[164:167], v[140:143], v[84:87]
v_mfma_f32_16x16x32_bf16 v[88:91], a[224:227], v[140:143], v[88:91]
v_mfma_f32_16x16x32_bf16 v[92:95], a[228:231], v[140:143], v[92:95]
s_waitcnt lgkmcnt(2)
v_mfma_f32_16x16x32_bf16 v[80:83], a[168:171], v[144:147], v[80:83]
v_mfma_f32_16x16x32_bf16 v[84:87], a[172:175], v[144:147], v[84:87]
v_mfma_f32_16x16x32_bf16 v[88:91], a[232:235], v[144:147], v[88:91]
v_mfma_f32_16x16x32_bf16 v[92:95], a[236:239], v[144:147], v[92:95]
s_waitcnt lgkmcnt(1)
v_mfma_f32_16x16x32_bf16 v[80:83], a[176:179], v[148:151], v[80:83]
v_mfma_f32_16x16x32_bf16 v[84:87], a[180:183], v[148:151], v[84:87]
v_mfma_f32_16x16x32_bf16 v[88:91], a[240:243], v[148:151], v[88:91]
v_mfma_f32_16x16x32_bf16 v[92:95], a[244:247], v[148:151], v[92:95]
s_waitcnt lgkmcnt(0)
v_mfma_f32_16x16x32_bf16 v[80:83], a[184:187], v[152:155], v[80:83]
v_mfma_f32_16x16x32_bf16 v[84:87], a[188:191], v[152:155], v[84:87]
v_mfma_f32_16x16x32_bf16 v[88:91], a[248:251], v[152:155], v[88:91]
v_mfma_f32_16x16x32_bf16 v[92:95], a[252:255], v[152:155], v[92:95]
s_nop 4
v_cvt_pk_bf16_f32 v80, v80, v81
v_cvt_pk_bf16_f32 v81, v82, v83
v_cvt_pk_bf16_f32 v82, v84, v85
v_cvt_pk_bf16_f32 v83, v86, v87
ds_write_b128 v35, v[80:83] offset:0
v_cvt_pk_bf16_f32 v88, v88, v89
v_cvt_pk_bf16_f32 v89, v90, v91
v_cvt_pk_bf16_f32 v90, v92, v93
v_cvt_pk_bf16_f32 v91, v94, v95
ds_write_b128 v36, v[88:91] offset:0
ds_read_b128 v[84:87], v37 offset:0
ds_read_b128 v[92:95], v37 offset:1024
s_add_u32 s33, s54, 0
s_waitcnt lgkmcnt(1)
buffer_store_dwordx4 v[84:87], v9, s[40:43], s33 offen sc1
s_add_u32 s35, s54, 4096
s_waitcnt lgkmcnt(0)
buffer_store_dwordx4 v[92:95], v9, s[40:43], s35 offen sc1
s_branch L2_fin
LC_poll:
s_mov_b32 s36, 0
s_cmp_lt_u32 s98, 2
s_cselect_b32 s33, 0xfff, -1
s_cselect_b32 s35, 6, 0x6
LC_poll2:
s_mov_b32 s70, 0
s_atomic_add s70, s[60:61], s48 glc
s_cmp_lt_u32 s2, 240
s_cbranch_scc1 LC_poll3
s_mov_b32 s71, 0
s_atomic_add s71, s[60:61], s49 glc
s_mov_b32 s72, 0
s_atomic_add s72, s[60:61], s50 glc
s_waitcnt lgkmcnt(0)
s_min_u32 s70, s70, s71
s_min_u32 s70, s70, s72
LC_poll3:
s_waitcnt lgkmcnt(0)
s_and_b32 s70, s70, s33
s_cmp_ge_u32 s70, s35
s_cbranch_scc1 LC_poll4
s_sleep 2
s_add_u32 s36, s36, 1
s_cmp_gt_u32 s36, 0x40000
s_cbranch_scc0 LC_poll2
LC_poll4:
s_cmp_lt_u32 s98, 2
s_cbranch_scc1 LC_got
s_mul_i32 s33, s51, 0x600000
v_readfirstlane_b32 s32, v44
s_add_u32 s35, s33, s52
s_mov_b32 m0, s32
s_nop 0
buffer_load_dwordx4 v10, s[20:23], s35 offen offset:0 sc1 lds
buffer_load_dwordx4 v10, s[20:23], s35 offen offset:1024 sc1 lds
v_readfirstlane_b32 s32, v45
s_add_u32 s35, s33, s53
s_mov_b32 m0, s32
s_nop 0
buffer_load_dwordx4 v10, s[20:23], s35 offen offset:0 sc1 lds
buffer_load_dwordx4 v10, s[20:23], s35 offen offset:1024 sc1 lds
v_readfirstlane_b32 s32, v46
s_add_u32 s35, s33, s54
s_mov_b32 m0, s32
s_nop 0
buffer_load_dwordx4 v10, s[20:23], s35 offen offset:0 sc1 lds
buffer_load_dwordx4 v10, s[20:23], s35 offen offset:1024 sc1 lds
s_waitcnt vmcnt(0)
s_branch LC_got
LC_side:
s_cmp_eq_u32 s14, 1
s_cbranch_scc1 LC_sideok
s_cmp_lt_u32 s2, 240
s_cbranch_scc1 LC_side1
s_barrier
LC_side1:
s_mov_b32 s36, 0
s_mov_b32 s33, 0x6c01400
LC_side2:
buffer_load_dword v1, off, s[56:59], s33 sc1
s_waitcnt vmcnt(0)
v_readfirstlane_b32 s99, v1
s_add_u32 s36, s36, 1
s_cmp_gt_u32 s36, 0x40000
s_cbranch_scc1 LC_side3
s_cmp_ge_u32 s99, 60
s_cbranch_scc1 LC_side3
s_sleep 8
s_branch LC_side2
LC_side3:
s_cmp_lt_u32 s98, 2
s_cbranch_scc1 LC_sideok
s_add_u32 s8, s6, 0x0
s_addc_u32 s9, s7, 0
s_mov_b32 s10, 0x4e2000
s_mov_b32 s11, 0x00020000
s_lshl_b32 s55, s34, 13
s_add_u32 s55, s55, 0x21000
s_lshl_b32 s33, s34, 7
v_bfe_u32 v9, v252, 4, 3
v_lshrrev_b32 v1, 7, v252
v_xor_b32 v9, v9, v1
v_lshl_add_u32 v1, v1, 9, s33
v_lshl_add_u32 v9, v9, 4, v1
s_add_u32 m0, s55, 0
s_add_u32 s39, s52, 0
buffer_load_dwordx4 v9, s[8:11], s39 offen lds
s_add_u32 m0, s55, 1024
s_add_u32 s32, s52, 4096
buffer_load_dwordx4 v9, s[8:11], s32 offen lds
s_add_u32 m0, s55, 2048
s_add_u32 s33, s53, 0
buffer_load_dwordx4 v9, s[8:11], s33 offen lds
s_add_u32 m0, s55, 3072
s_add_u32 s35, s53, 4096
buffer_load_dwordx4 v9, s[8:11], s35 offen lds
s_waitcnt vmcnt(0)
s_branch LC_sideok
LC_slow:
s_waitcnt vmcnt(0) lgkmcnt(0)
s_barrier
s_mov_b32 s50, 0xe1a06800
s_mov_b32 s51, 0x4e608d04
s_mul_i32 s39, s37, 9
s_lshr_b64 s[50:51], s[50:51], s39
s_and_b32 s39, s50, 0x1ff
s_bfe_u32 s49, s50, 0x90009
s_sub_u32 s29, s49, s39
s_lshl_b32 s50, s37, 2
s_lshr_b32 s59, 0x766666, s50
s_and_b32 s59, s59, 15
s_sub_u32 s31, s29, s59
s_lshr_b32 s31, s31, 1
s_sub_u32 s31, s31, 1
s_lshl_b32 s39, s39, 14
s_lshl_b32 s49, s49, 14
s_add_u32 s28, s39, 0x4000
s_cmp_eq_u32 s37, 5
s_cselect_b32 s33, 0xff800000, 0
s_mov_b32 s32, 0xffff
s_add_u32 s12, s4, 0x6800000
s_addc_u32 s13, s5, 0
s_mov_b32 s14, s49
s_mov_b32 s15, 0x00020000
s_add_u32 s8, s4, 0x0
s_addc_u32 s9, s5, 0
s_mov_b32 s10, 0x4e4000
s_mov_b32 s11, 0x00020000
s_mul_i32 s35, s37, 0x600000
s_add_u32 s20, s4, 0x2000000
s_addc_u32 s21, s5, 0
s_add_u32 s20, s20, s35
s_addc_u32 s21, s21, 0
s_mov_b32 s22, 0x4e4000
s_mov_b32 s23, 0x00020000
s_add_u32 s24, s4, 0x6000000
s_addc_u32 s25, s5, 0
s_mov_b32 s26, 0x9c800
s_mov_b32 s27, 0x00020000
s_lshl_b32 s35, s38, 4
s_lshl_b32 s41, s34, 2
s_add_u32 s35, s35, s41
s_lshl_b32 s40, s35, 13
s_lshl_b32 s48, s35, 10
s_lshl_b32 s35, s37, 3
s_add_u32 s48, s48, s35
v_bfe_u32 v248, v252, 4, 3
v_lshlrev_b32 v248, 6, v248
v_bfe_u32 v253, v252, 7, 1
v_lshl_or_b32 v248, v253, 10, v248
v_bfe_u32 v253, v252, 8, 2
v_lshl_or_b32 v248, v253, 4, v248
v_bfe_u32 v253, v252, 6, 1
v_lshlrev_b32 v253, 5, v253
v_xor_b32 v248, v248, v253
v_and_b32 v249, 0x1c0, v252
v_bfe_u32 v253, v252, 9, 1
v_lshl_or_b32 v249, v253, 10, v249
v_bfe_u32 v253, v252, 8, 1
v_lshl_or_b32 v249, v253, 5, v249
v_bfe_u32 v253, v252, 4, 2
v_lshl_or_b32 v249, v253, 3, v249
v_xor_b32 v250, 32, v249
v_and_b32 v251, 0xfffffe7f, v251
s_mul_i32 s36, s34, 0xa000
s_mov_b32 s56, s36
s_add_u32 s57, s56, 32768
s_mov_b32 s55, 4
v_bfe_i32 v188, v252, 8, 1
LS_q:
s_add_u32 s44, s40, 4096
buffer_load_dwordx4 v[0:3], v252, s[8:11], s40 offen offset:0
buffer_load_dwordx4 v[4:7], v252, s[8:11], s40 offen offset:1024
buffer_load_dwordx4 v[8:11], v252, s[8:11], s40 offen offset:2048
buffer_load_dwordx4 v[12:15], v252, s[8:11], s40 offen offset:3072
buffer_load_dwordx4 v[16:19], v252, s[8:11], s44 offen offset:0
buffer_load_dwordx4 v[20:23], v252, s[8:11], s44 offen offset:1024
buffer_load_dwordx4 v[24:27], v252, s[8:11], s44 offen offset:2048
buffer_load_dwordx4 v[28:31], v252, s[8:11], s44 offen offset:3072
s_mov_b32 s53, s56
s_mov_b32 s58, s39
s_add_u32 m0, s53, 0
s_add_u32 s54, s58, 0
buffer_load_dwordx4 v251, s[12:15], s54 offen offset:0 lds
buffer_load_dwordx4 v251, s[12:15], s54 offen offset:1024 lds
buffer_load_dwordx4 v251, s[12:15], s54 offen offset:2048 lds
buffer_load_dwordx4 v251, s[12:15], s54 offen offset:3072 lds
s_add_u32 m0, s53, 4096
s_add_u32 s54, s58, 128
buffer_load_dwordx4 v251, s[12:15], s54 offen offset:0 lds
buffer_load_dwordx4 v251, s[12:15], s54 offen offset:1024 lds
buffer_load_dwordx4 v251, s[12:15], s54 offen offset:2048 lds
buffer_load_dwordx4 v251, s[12:15], s54 offen offset:3072 lds
s_add_u32 m0, s53, 8192
s_add_u32 s54, s58, 256
buffer_load_dwordx4 v251, s[12:15], s54 offen offset:0 lds
buffer_load_dwordx4 v251, s[12:15], s54 offen offset:1024 lds
buffer_load_dwordx4 v251, s[12:15], s54 offen offset:2048 lds
buffer_load_dwordx4 v251, s[12:15], s54 offen offset:3072 lds
s_add_u32 m0, s53, 12288
s_add_u32 s54, s58, 384
buffer_load_dwordx4 v251, s[12:15], s54 offen offset:0 lds
buffer_load_dwordx4 v251, s[12:15], s54 offen offset:1024 lds
buffer_load_dwordx4 v251, s[12:15], s54 offen offset:2048 lds
buffer_load_dwordx4 v251, s[12:15], s54 offen offset:3072 lds
s_add_u32 s53, s53, 0x4000
s_cmp_eq_u32 s53, s57
s_cselect_b32 s53, s56, s53
s_add_u32 s58, s58, 0x4000
s_mov_b32 s51, s29
s_mov_b32 s52, s56
v_mov_b32 v172, 0xff800000
v_accvgpr_write_b32 a0, 0
v_accvgpr_write_b32 a1, 0
v_accvgpr_write_b32 a2, 0
v_accvgpr_write_b32 a3, 0
v_accvgpr_write_b32 a4, 0
v_accvgpr_write_b32 a5, 0
v_accvgpr_write_b32 a6, 0
v_accvgpr_write_b32 a7, 0
v_accvgpr_write_b32 a8, 0
v_accvgpr_write_b32 a9, 0
v_accvgpr_write_b32 a10, 0
v_accvgpr_write_b32 a11, 0
v_accvgpr_write_b32 a12, 0
v_accvgpr_write_b32 a13, 0
v_accvgpr_write_b32 a14, 0
v_accvgpr_write_b32 a15, 0
v_accvgpr_write_b32 a16, 0
v_accvgpr_write_b32 a17, 0
v_accvgpr_write_b32 a18, 0
v_accvgpr_write_b32 a19, 0
v_accvgpr_write_b32 a20, 0
v_accvgpr_write_b32 a21, 0
v_accvgpr_write_b32 a22, 0
v_accvgpr_write_b32 a23, 0
v_accvgpr_write_b32 a24, 0
v_accvgpr_write_b32 a25, 0
v_accvgpr_write_b32 a26, 0
v_accvgpr_write_b32 a27, 0
v_accvgpr_write_b32 a28, 0
v_accvgpr_write_b32 a29, 0
v_accvgpr_write_b32 a30, 0
v_accvgpr_write_b32 a31, 0
v_accvgpr_write_b32 a32, 0
v_accvgpr_write_b32 a33, 0
v_accvgpr_write_b32 a34, 0
v_accvgpr_write_b32 a35, 0
v_accvgpr_write_b32 a36, 0
v_accvgpr_write_b32 a37, 0
v_accvgpr_write_b32 a38, 0
v_accvgpr_write_b32 a39, 0
v_accvgpr_write_b32 a40, 0
v_accvgpr_write_b32 a41, 0
v_accvgpr_write_b32 a42, 0
v_accvgpr_write_b32 a43, 0
v_accvgpr_write_b32 a44, 0
v_accvgpr_write_b32 a45, 0
v_accvgpr_write_b32 a46, 0
v_accvgpr_write_b32 a47, 0
v_accvgpr_write_b32 a48, 0
v_accvgpr_write_b32 a49, 0
v_accvgpr_write_b32 a50, 0
v_accvgpr_write_b32 a51, 0
v_accvgpr_write_b32 a52, 0
v_accvgpr_write_b32 a53, 0
v_accvgpr_write_b32 a54, 0
v_accvgpr_write_b32 a55, 0
v_accvgpr_write_b32 a56, 0
v_accvgpr_write_b32 a57, 0
v_accvgpr_write_b32 a58, 0
v_accvgpr_write_b32 a59, 0
v_accvgpr_write_b32 a60, 0
v_accvgpr_write_b32 a61, 0
v_accvgpr_write_b32 a62, 0
v_accvgpr_write_b32 a63, 0
LS_loop:
s_add_u32 m0, s53, 0
s_add_u32 s54, s58, 0
buffer_load_dwordx4 v251, s[12:15], s54 offen offset:0 lds
buffer_load_dwordx4 v251, s[12:15], s54 offen offset:1024 lds
buffer_load_dwordx4 v251, s[12:15], s54 offen offset:2048 lds
buffer_load_dwordx4 v251, s[12:15], s54 offen offset:3072 lds
s_add_u32 m0, s53, 4096
s_add_u32 s54, s58, 128
buffer_load_dwordx4 v251, s[12:15], s54 offen offset:0 lds
buffer_load_dwordx4 v251, s[12:15], s54 offen offset:1024 lds
buffer_load_dwordx4 v251, s[12:15], s54 offen offset:2048 lds
buffer_load_dwordx4 v251, s[12:15], s54 offen offset:3072 lds
s_add_u32 m0, s53, 8192
s_add_u32 s54, s58, 256
buffer_load_dwordx4 v251, s[12:15], s54 offen offset:0 lds
buffer_load_dwordx4 v251, s[12:15], s54 offen offset:1024 lds
buffer_load_dwordx4 v251, s[12:15], s54 offen offset:2048 lds
buffer_load_dwordx4 v251, s[12:15], s54 offen offset:3072 lds
s_add_u32 m0, s53, 12288
s_add_u32 s54, s58, 384
buffer_load_dwordx4 v251, s[12:15], s54 offen offset:0 lds
buffer_load_dwordx4 v251, s[12:15], s54 offen offset:1024 lds
buffer_load_dwordx4 v251, s[12:15], s54 offen offset:2048 lds
buffer_load_dwordx4 v251, s[12:15], s54 offen offset:3072 lds
s_add_u32 s53, s53, 0x4000
s_cmp_eq_u32 s53, s57
s_cselect_b32 s53, s56, s53
s_add_u32 s58, s58, 0x4000
v_add_u32 v177, s52, v248
v_add_u32 v178, s52, v249
v_add_u32 v179, s52, v250
s_add_u32 s52, s52, 0x4000
s_cmp_eq_u32 s52, s57
s_cselect_b32 s52, s56, s52
s_cmp_eq_u32 s51, 1
s_cselect_b32 s54, s33, 0
v_and_b32 v192, s54, v188
v_and_b32 v193, s54, v188
v_and_b32 v194, s54, v188
v_and_b32 v195, s54, v188
s_waitcnt vmcnt(16)
ds_read_b128 v[32:35], v177 offset:0
ds_read_b128 v[64:67], v177 offset:2048
ds_read_b128 v[36:39], v177 offset:512
ds_read_b128 v[68:71], v177 offset:2560
ds_read_b128 v[40:43], v177 offset:4096
ds_read_b128 v[72:75], v177 offset:6144
ds_read_b128 v[44:47], v177 offset:4608
ds_read_b128 v[76:79], v177 offset:6656
ds_read_b128 v[48:51], v177 offset:8192
ds_read_b128 v[80:83], v177 offset:10240
ds_read_b128 v[52:55], v177 offset:8704
ds_read_b128 v[84:87], v177 offset:10752
ds_read_b128 v[56:59], v177 offset:12288
ds_read_b128 v[88:91], v177 offset:14336
ds_read_b128 v[60:63], v177 offset:12800
ds_read_b128 v[92:95], v177 offset:14848
s_waitcnt lgkmcnt(14)
v_mfma_f32_16x16x32_bf16 v[160:163], v[32:35], v[0:3], v[192:195]
v_mfma_f32_16x16x32_bf16 v[164:167], v[64:67], v[0:3], v[192:195]
s_waitcnt lgkmcnt(12)
v_mfma_f32_16x16x32_bf16 v[160:163], v[36:39], v[4:7], v[160:163]
v_mfma_f32_16x16x32_bf16 v[164:167], v[68:71], v[4:7], v[164:167]
s_waitcnt lgkmcnt(10)
v_mfma_f32_16x16x32_bf16 v[160:163], v[40:43], v[8:11], v[160:163]
v_mfma_f32_16x16x32_bf16 v[164:167], v[72:75], v[8:11], v[164:167]
s_waitcnt lgkmcnt(8)
v_mfma_f32_16x16x32_bf16 v[160:163], v[44:47], v[12:15], v[160:163]
v_mfma_f32_16x16x32_bf16 v[164:167], v[76:79], v[12:15], v[164:167]
s_waitcnt lgkmcnt(6)
v_mfma_f32_16x16x32_bf16 v[160:163], v[48:51], v[16:19], v[160:163]
v_mfma_f32_16x16x32_bf16 v[164:167], v[80:83], v[16:19], v[164:167]
s_waitcnt lgkmcnt(4)
v_mfma_f32_16x16x32_bf16 v[160:163], v[52:55], v[20:23], v[160:163]
v_mfma_f32_16x16x32_bf16 v[164:167], v[84:87], v[20:23], v[164:167]
s_waitcnt lgkmcnt(2)
v_mfma_f32_16x16x32_bf16 v[160:163], v[56:59], v[24:27], v[160:163]
v_mfma_f32_16x16x32_bf16 v[164:167], v[88:91], v[24:27], v[164:167]
s_waitcnt lgkmcnt(0)
v_mfma_f32_16x16x32_bf16 v[160:163], v[60:63], v[28:31], v[160:163]
v_mfma_f32_16x16x32_bf16 v[164:167], v[92:95], v[28:31], v[164:167]
ds_read_b64_tr_b16 v[96:97], v178 offset:0
ds_read_b64_tr_b16 v[98:99], v178 offset:2048
ds_read_b64_tr_b16 v[100:101], v179 offset:0
ds_read_b64_tr_b16 v[102:103], v179 offset:2048
ds_read_b64_tr_b16 v[104:105], v178 offset:512
ds_read_b64_tr_b16 v[106:107], v178 offset:2560
ds_read_b64_tr_b16 v[108:109], v179 offset:512
ds_read_b64_tr_b16 v[110:111], v179 offset:2560
ds_read_b64_tr_b16 v[112:113], v178 offset:4096
ds_read_b64_tr_b16 v[114:115], v178 offset:6144
ds_read_b64_tr_b16 v[116:117], v179 offset:4096
ds_read_b64_tr_b16 v[118:119], v179 offset:6144
ds_read_b64_tr_b16 v[120:121], v178 offset:4608
ds_read_b64_tr_b16 v[122:123], v178 offset:6656
ds_read_b64_tr_b16 v[124:125], v179 offset:4608
ds_read_b64_tr_b16 v[126:127], v179 offset:6656
ds_read_b64_tr_b16 v[128:129], v178 offset:8192
ds_read_b64_tr_b16 v[130:131], v178 offset:10240
ds_read_b64_tr_b16 v[132:133], v179 offset:8192
ds_read_b64_tr_b16 v[134:135], v179 offset:10240
ds_read_b64_tr_b16 v[136:137], v178 offset:8704
ds_read_b64_tr_b16 v[138:139], v178 offset:10752
ds_read_b64_tr_b16 v[140:141], v179 offset:8704
ds_read_b64_tr_b16 v[142:143], v179 offset:10752
ds_read_b64_tr_b16 v[144:145], v178 offset:12288
ds_read_b64_tr_b16 v[146:147], v178 offset:14336
ds_read_b64_tr_b16 v[148:149], v179 offset:12288
ds_read_b64_tr_b16 v[150:151], v179 offset:14336
ds_read_b64_tr_b16 v[152:153], v178 offset:12800
ds_read_b64_tr_b16 v[154:155], v178 offset:14848
ds_read_b64_tr_b16 v[156:157], v179 offset:12800
ds_read_b64_tr_b16 v[158:159], v179 offset:14848
s_nop 7
v_max3_f32 v175, v160, v161, v162
v_max3_f32 v175, v175, v163, v164
v_max3_f32 v175, v175, v165, v166
v_max3_f32 v175, v175, v167, v172
v_mov_b32 v176, v175
s_nop 1
v_permlane32_swap_b32 v175, v176
s_nop 1
v_max_f32 v175, v175, v176
v_mov_b32 v176, v175
s_nop 1
v_permlane16_swap_b32 v175, v176
s_nop 1
v_max_f32 v175, v175, v176
v_sub_f32 v174, v172, v175
v_exp_f32 v174, v174
v_mov_b32 v172, v175
v_sub_f32 v160, v160, v172
v_sub_f32 v161, v161, v172
v_sub_f32 v162, v162, v172
v_sub_f32 v163, v163, v172
v_sub_f32 v164, v164, v172
v_sub_f32 v165, v165, v172
v_sub_f32 v166, v166, v172
v_sub_f32 v167, v167, v172
v_exp_f32 v160, v160
v_exp_f32 v161, v161
v_exp_f32 v162, v162
v_exp_f32 v163, v163
v_exp_f32 v164, v164
v_exp_f32 v165, v165
v_exp_f32 v166, v166
v_exp_f32 v167, v167
v_cmp_neq_f32 vcc, 1.0, v174
v_cvt_pk_bf16_f32 v168, v160, v161
v_cvt_pk_bf16_f32 v169, v162, v163
v_cvt_pk_bf16_f32 v170, v164, v165
v_cvt_pk_bf16_f32 v171, v166, v167
s_cbranch_vccz LS_nors
v_accvgpr_read_b32 v180, a0
v_accvgpr_read_b32 v181, a1
v_accvgpr_read_b32 v182, a2
v_accvgpr_read_b32 v183, a3
v_accvgpr_read_b32 v184, a4
v_accvgpr_read_b32 v185, a5
v_accvgpr_read_b32 v186, a6
v_accvgpr_read_b32 v187, a7
v_mul_f32 v180, v180, v174
v_mul_f32 v181, v181, v174
v_mul_f32 v182, v182, v174
v_mul_f32 v183, v183, v174
v_mul_f32 v184, v184, v174
v_mul_f32 v185, v185, v174
v_mul_f32 v186, v186, v174
v_mul_f32 v187, v187, v174
v_accvgpr_write_b32 a0, v180
v_accvgpr_write_b32 a1, v181
v_accvgpr_write_b32 a2, v182
v_accvgpr_write_b32 a3, v183
v_accvgpr_write_b32 a4, v184
v_accvgpr_write_b32 a5, v185
v_accvgpr_write_b32 a6, v186
v_accvgpr_write_b32 a7, v187
v_accvgpr_read_b32 v180, a8
v_accvgpr_read_b32 v181, a9
v_accvgpr_read_b32 v182, a10
v_accvgpr_read_b32 v183, a11
v_accvgpr_read_b32 v184, a12
v_accvgpr_read_b32 v185, a13
v_accvgpr_read_b32 v186, a14
v_accvgpr_read_b32 v187, a15
v_mul_f32 v180, v180, v174
v_mul_f32 v181, v181, v174
v_mul_f32 v182, v182, v174
v_mul_f32 v183, v183, v174
v_mul_f32 v184, v184, v174
v_mul_f32 v185, v185, v174
v_mul_f32 v186, v186, v174
v_mul_f32 v187, v187, v174
v_accvgpr_write_b32 a8, v180
v_accvgpr_write_b32 a9, v181
v_accvgpr_write_b32 a10, v182
v_accvgpr_write_b32 a11, v183
v_accvgpr_write_b32 a12, v184
v_accvgpr_write_b32 a13, v185
v_accvgpr_write_b32 a14, v186
v_accvgpr_write_b32 a15, v187
v_accvgpr_read_b32 v180, a16
v_accvgpr_read_b32 v181, a17
v_accvgpr_read_b32 v182, a18
v_accvgpr_read_b32 v183, a19
v_accvgpr_read_b32 v184, a20
v_accvgpr_read_b32 v185, a21
v_accvgpr_read_b32 v186, a22
v_accvgpr_read_b32 v187, a23
v_mul_f32 v180, v180, v174
v_mul_f32 v181, v181, v174
v_mul_f32 v182, v182, v174
v_mul_f32 v183, v183, v174
v_mul_f32 v184, v184, v174
v_mul_f32 v185, v185, v174
v_mul_f32 v186, v186, v174
v_mul_f32 v187, v187, v174
v_accvgpr_write_b32 a16, v180
v_accvgpr_write_b32 a17, v181
v_accvgpr_write_b32 a18, v182
v_accvgpr_write_b32 a19, v183
v_accvgpr_write_b32 a20, v184
v_accvgpr_write_b32 a21, v185
v_accvgpr_write_b32 a22, v186
v_accvgpr_write_b32 a23, v187
v_accvgpr_read_b32 v180, a24
v_accvgpr_read_b32 v181, a25
v_accvgpr_read_b32 v182, a26
v_accvgpr_read_b32 v183, a27
v_accvgpr_read_b32 v184, a28
v_accvgpr_read_b32 v185, a29
v_accvgpr_read_b32 v186, a30
v_accvgpr_read_b32 v187, a31
v_mul_f32 v180, v180, v174
v_mul_f32 v181, v181, v174
v_mul_f32 v182, v182, v174
v_mul_f32 v183, v183, v174
v_mul_f32 v184, v184, v174
v_mul_f32 v185, v185, v174
v_mul_f32 v186, v186, v174
v_mul_f32 v187, v187, v174
v_accvgpr_write_b32 a24, v180
v_accvgpr_write_b32 a25, v181
v_accvgpr_write_b32 a26, v182
v_accvgpr_write_b32 a27, v183
v_accvgpr_write_b32 a28, v184
v_accvgpr_write_b32 a29, v185
v_accvgpr_write_b32 a30, v186
v_accvgpr_write_b32 a31, v187
v_accvgpr_read_b32 v180, a32
v_accvgpr_read_b32 v181, a33
v_accvgpr_read_b32 v182, a34
v_accvgpr_read_b32 v183, a35
v_accvgpr_read_b32 v184, a36
v_accvgpr_read_b32 v185, a37
v_accvgpr_read_b32 v186, a38
v_accvgpr_read_b32 v187, a39
v_mul_f32 v180, v180, v174
v_mul_f32 v181, v181, v174
v_mul_f32 v182, v182, v174
v_mul_f32 v183, v183, v174
v_mul_f32 v184, v184, v174
v_mul_f32 v185, v185, v174
v_mul_f32 v186, v186, v174
v_mul_f32 v187, v187, v174
v_accvgpr_write_b32 a32, v180
v_accvgpr_write_b32 a33, v181
v_accvgpr_write_b32 a34, v182
v_accvgpr_write_b32 a35, v183
v_accvgpr_write_b32 a36, v184
v_accvgpr_write_b32 a37, v185
v_accvgpr_write_b32 a38, v186
v_accvgpr_write_b32 a39, v187
v_accvgpr_read_b32 v180, a40
v_accvgpr_read_b32 v181, a41
v_accvgpr_read_b32 v182, a42
v_accvgpr_read_b32 v183, a43
v_accvgpr_read_b32 v184, a44
v_accvgpr_read_b32 v185, a45
v_accvgpr_read_b32 v186, a46
v_accvgpr_read_b32 v187, a47
v_mul_f32 v180, v180, v174
v_mul_f32 v181, v181, v174
v_mul_f32 v182, v182, v174
v_mul_f32 v183, v183, v174
v_mul_f32 v184, v184, v174
v_mul_f32 v185, v185, v174
v_mul_f32 v186, v186, v174
v_mul_f32 v187, v187, v174
v_accvgpr_write_b32 a40, v180
v_accvgpr_write_b32 a41, v181
v_accvgpr_write_b32 a42, v182
v_accvgpr_write_b32 a43, v183
v_accvgpr_write_b32 a44, v184
v_accvgpr_write_b32 a45, v185
v_accvgpr_write_b32 a46, v186
v_accvgpr_write_b32 a47, v187
v_accvgpr_read_b32 v180, a48
v_accvgpr_read_b32 v181, a49
v_accvgpr_read_b32 v182, a50
v_accvgpr_read_b32 v183, a51
v_accvgpr_read_b32 v184, a52
v_accvgpr_read_b32 v185, a53
v_accvgpr_read_b32 v186, a54
v_accvgpr_read_b32 v187, a55
v_mul_f32 v180, v180, v174
v_mul_f32 v181, v181, v174
v_mul_f32 v182, v182, v174
v_mul_f32 v183, v183, v174
v_mul_f32 v184, v184, v174
v_mul_f32 v185, v185, v174
v_mul_f32 v186, v186, v174
v_mul_f32 v187, v187, v174
v_accvgpr_write_b32 a48, v180
v_accvgpr_write_b32 a49, v181
v_accvgpr_write_b32 a50, v182
v_accvgpr_write_b32 a51, v183
v_accvgpr_write_b32 a52, v184
v_accvgpr_write_b32 a53, v185
v_accvgpr_write_b32 a54, v186
v_accvgpr_write_b32 a55, v187
v_accvgpr_read_b32 v180, a56
v_accvgpr_read_b32 v181, a57
v_accvgpr_read_b32 v182, a58
v_accvgpr_read_b32 v183, a59
v_accvgpr_read_b32 v184, a60
v_accvgpr_read_b32 v185, a61
v_accvgpr_read_b32 v186, a62
v_accvgpr_read_b32 v187, a63
v_mul_f32 v180, v180, v174
v_mul_f32 v181, v181, v174
v_mul_f32 v182, v182, v174
v_mul_f32 v183, v183, v174
v_mul_f32 v184, v184, v174
v_mul_f32 v185, v185, v174
v_mul_f32 v186, v186, v174
v_mul_f32 v187, v187, v174
v_accvgpr_write_b32 a56, v180
v_accvgpr_write_b32 a57, v181
v_accvgpr_write_b32 a58, v182
v_accvgpr_write_b32 a59, v183
v_accvgpr_write_b32 a60, v184
v_accvgpr_write_b32 a61, v185
v_accvgpr_write_b32 a62, v186
v_accvgpr_write_b32 a63, v187
LS_nors:
s_waitcnt lgkmcnt(0)
s_nop 1
v_mfma_f32_16x16x32_bf16 a[0:3], v[96:99], v[168:171], a[0:3]
v_mfma_f32_16x16x32_bf16 a[4:7], v[100:103], v[168:171], a[4:7]
v_mfma_f32_16x16x32_bf16 a[8:11], v[104:107], v[168:171], a[8:11]
v_mfma_f32_16x16x32_bf16 a[12:15], v[108:111], v[168:171], a[12:15]
v_mfma_f32_16x16x32_bf16 a[16:19], v[112:115], v[168:171], a[16:19]
v_mfma_f32_16x16x32_bf16 a[20:23], v[116:119], v[168:171], a[20:23]
v_mfma_f32_16x16x32_bf16 a[24:27], v[120:123], v[168:171], a[24:27]
v_mfma_f32_16x16x32_bf16 a[28:31], v[124:127], v[168:171], a[28:31]
v_mfma_f32_16x16x32_bf16 a[32:35], v[128:131], v[168:171], a[32:35]
v_mfma_f32_16x16x32_bf16 a[36:39], v[132:135], v[168:171], a[36:39]
v_mfma_f32_16x16x32_bf16 a[40:43], v[136:139], v[168:171], a[40:43]
v_mfma_f32_16x16x32_bf16 a[44:47], v[140:143], v[168:171], a[44:47]
v_mfma_f32_16x16x32_bf16 a[48:51], v[144:147], v[168:171], a[48:51]
v_mfma_f32_16x16x32_bf16 a[52:55], v[148:151], v[168:171], a[52:55]
v_mfma_f32_16x16x32_bf16 a[56:59], v[152:155], v[168:171], a[56:59]
v_mfma_f32_16x16x32_bf16 a[60:63], v[156:159], v[168:171], a[60:63]
s_sub_u32 s51, s51, 1
s_cmp_lg_u32 s51, 0
s_cbranch_scc1 LS_loop
s_nop 15
v_accvgpr_read_b32 v173, a0
v_accvgpr_read_b32 v180, a0
v_accvgpr_read_b32 v181, a1
v_accvgpr_read_b32 v182, a2
v_accvgpr_read_b32 v183, a3
v_accvgpr_read_b32 v184, a4
v_accvgpr_read_b32 v185, a5
v_accvgpr_read_b32 v186, a6
v_accvgpr_read_b32 v187, a7
v_cvt_pk_bf16_f32 v32, v180, v181
v_cvt_pk_bf16_f32 v33, v182, v183
v_cvt_pk_bf16_f32 v34, v184, v185
v_cvt_pk_bf16_f32 v35, v186, v187
buffer_store_dwordx4 v[32:35], v252, s[20:23], s40 offen offset:0 sc1
v_accvgpr_read_b32 v180, a8
v_accvgpr_read_b32 v181, a9
v_accvgpr_read_b32 v182, a10
v_accvgpr_read_b32 v183, a11
v_accvgpr_read_b32 v184, a12
v_accvgpr_read_b32 v185, a13
v_accvgpr_read_b32 v186, a14
v_accvgpr_read_b32 v187, a15
v_cvt_pk_bf16_f32 v36, v180, v181
v_cvt_pk_bf16_f32 v37, v182, v183
v_cvt_pk_bf16_f32 v38, v184, v185
v_cvt_pk_bf16_f32 v39, v186, v187
buffer_store_dwordx4 v[36:39], v252, s[20:23], s40 offen offset:1024 sc1
v_accvgpr_read_b32 v180, a16
v_accvgpr_read_b32 v181, a17
v_accvgpr_read_b32 v182, a18
v_accvgpr_read_b32 v183, a19
v_accvgpr_read_b32 v184, a20
v_accvgpr_read_b32 v185, a21
v_accvgpr_read_b32 v186, a22
v_accvgpr_read_b32 v187, a23
v_cvt_pk_bf16_f32 v40, v180, v181
v_cvt_pk_bf16_f32 v41, v182, v183
v_cvt_pk_bf16_f32 v42, v184, v185
v_cvt_pk_bf16_f32 v43, v186, v187
buffer_store_dwordx4 v[40:43], v252, s[20:23], s40 offen offset:2048 sc1
v_accvgpr_read_b32 v180, a24
v_accvgpr_read_b32 v181, a25
v_accvgpr_read_b32 v182, a26
v_accvgpr_read_b32 v183, a27
v_accvgpr_read_b32 v184, a28
v_accvgpr_read_b32 v185, a29
v_accvgpr_read_b32 v186, a30
v_accvgpr_read_b32 v187, a31
v_cvt_pk_bf16_f32 v44, v180, v181
v_cvt_pk_bf16_f32 v45, v182, v183
v_cvt_pk_bf16_f32 v46, v184, v185
v_cvt_pk_bf16_f32 v47, v186, v187
buffer_store_dwordx4 v[44:47], v252, s[20:23], s40 offen offset:3072 sc1
v_accvgpr_read_b32 v180, a32
v_accvgpr_read_b32 v181, a33
v_accvgpr_read_b32 v182, a34
v_accvgpr_read_b32 v183, a35
v_accvgpr_read_b32 v184, a36
v_accvgpr_read_b32 v185, a37
v_accvgpr_read_b32 v186, a38
v_accvgpr_read_b32 v187, a39
v_cvt_pk_bf16_f32 v48, v180, v181
v_cvt_pk_bf16_f32 v49, v182, v183
v_cvt_pk_bf16_f32 v50, v184, v185
v_cvt_pk_bf16_f32 v51, v186, v187
buffer_store_dwordx4 v[48:51], v252, s[20:23], s44 offen offset:0 sc1
v_accvgpr_read_b32 v180, a40
v_accvgpr_read_b32 v181, a41
v_accvgpr_read_b32 v182, a42
v_accvgpr_read_b32 v183, a43
v_accvgpr_read_b32 v184, a44
v_accvgpr_read_b32 v185, a45
v_accvgpr_read_b32 v186, a46
v_accvgpr_read_b32 v187, a47
v_cvt_pk_bf16_f32 v52, v180, v181
v_cvt_pk_bf16_f32 v53, v182, v183
v_cvt_pk_bf16_f32 v54, v184, v185
v_cvt_pk_bf16_f32 v55, v186, v187
buffer_store_dwordx4 v[52:55], v252, s[20:23], s44 offen offset:1024 sc1
v_accvgpr_read_b32 v180, a48
v_accvgpr_read_b32 v181, a49
v_accvgpr_read_b32 v182, a50
v_accvgpr_read_b32 v183, a51
v_accvgpr_read_b32 v184, a52
v_accvgpr_read_b32 v185, a53
v_accvgpr_read_b32 v186, a54
v_accvgpr_read_b32 v187, a55
v_cvt_pk_bf16_f32 v56, v180, v181
v_cvt_pk_bf16_f32 v57, v182, v183
v_cvt_pk_bf16_f32 v58, v184, v185
v_cvt_pk_bf16_f32 v59, v186, v187
buffer_store_dwordx4 v[56:59], v252, s[20:23], s44 offen offset:2048 sc1
v_accvgpr_read_b32 v180, a56
v_accvgpr_read_b32 v181, a57
v_accvgpr_read_b32 v182, a58
v_accvgpr_read_b32 v183, a59
v_accvgpr_read_b32 v184, a60
v_accvgpr_read_b32 v185, a61
v_accvgpr_read_b32 v186, a62
v_accvgpr_read_b32 v187, a63
v_cvt_pk_bf16_f32 v60, v180, v181
v_cvt_pk_bf16_f32 v61, v182, v183
v_cvt_pk_bf16_f32 v62, v184, v185
v_cvt_pk_bf16_f32 v63, v186, v187
buffer_store_dwordx4 v[60:63], v252, s[20:23], s44 offen offset:3072 sc1
v_lshlrev_b32 v175, 2, v252
s_mov_b64 exec, 0xffff
buffer_store_dwordx2 v[172:173], v175, s[24:27], s48 offen sc1
s_mov_b64 exec, -1
s_waitcnt vmcnt(0)
s_add_u32 s40, s40, 8192
s_add_u32 s48, s48, 1024
s_sub_u32 s55, s55, 1
s_cmp_lg_u32 s55, 0
s_cbranch_scc1 LS_q
s_barrier
s_add_u32 s56, s4, 0x1000000
s_addc_u32 s57, s5, 0
s_mov_b32 s58, 0x6c02000
s_mov_b32 s59, 0x00020000
s_mul_i32 s35, s37, 3
s_and_b32 s36, s35, 3
s_lshl_b32 s36, s36, 2
s_lshr_b32 s52, s35, 2
s_add_u32 s36, s36, s52
s_lshl_b32 s52, s38, 4
s_add_u32 s52, s52, s36
s_lshl_b32 s52, s52, 13
s_add_u32 s35, s35, 1
s_and_b32 s36, s35, 3
s_lshl_b32 s36, s36, 2
s_lshr_b32 s53, s35, 2
s_add_u32 s36, s36, s53
s_lshl_b32 s53, s38, 4
s_add_u32 s53, s53, s36
s_lshl_b32 s53, s53, 13
s_add_u32 s35, s35, 1
s_and_b32 s36, s35, 3
s_lshl_b32 s36, s36, 2
s_lshr_b32 s54, s35, 2
s_add_u32 s36, s36, s54
s_lshl_b32 s54, s38, 4
s_add_u32 s54, s54, s36
s_lshl_b32 s54, s54, 13
s_mov_b32 s99, 0
s_mov_b32 s98, 2
s_branch LC_again
LT_disp:
s_cmp_eq_u32 s34, 0
s_cbranch_scc1 LT_start
s_mov_b32 s41, s34
s_mul_i32 s40, s34, 6
s_add_u32 s40, s40, s37
s_add_u32 s40, s40, 42
s_cmp_lt_u32 s40, 60
s_cbranch_scc1 LE_common
s_branch L2_end
LT_start:
s_waitcnt lgkmcnt(0)
s_add_u32 s12, s4, 0x6800000
s_addc_u32 s13, s5, 0
s_mov_b32 s14, s49
s_mov_b32 s15, 0x00020000
s_add_u32 s8, s4, 0x0
s_addc_u32 s9, s5, 0
s_mov_b32 s10, 0x4e4000
s_mov_b32 s11, 0x00020000
s_mul_i32 s35, s37, 0x600000
s_add_u32 s20, s4, 0x2000000
s_addc_u32 s21, s5, 0
s_add_u32 s20, s20, s35
s_addc_u32 s21, s21, 0
s_mov_b32 s22, 0x4e4000
s_mov_b32 s23, 0x00020000
s_add_u32 s24, s4, 0x6000000
s_addc_u32 s25, s5, 0
s_mov_b32 s26, 0x9c800
s_mov_b32 s27, 0x00020000
s_lshl_b32 s35, s38, 4
s_lshl_b32 s41, s34, 2
s_add_u32 s35, s35, s41
s_lshl_b32 s40, s35, 13
s_lshl_b32 s48, s35, 10
s_lshl_b32 s35, s37, 3
s_add_u32 s48, s48, s35
v_bfe_u32 v248, v252, 4, 3
v_lshlrev_b32 v248, 6, v248
v_bfe_u32 v253, v252, 7, 1
v_lshl_or_b32 v248, v253, 10, v248
v_bfe_u32 v253, v252, 8, 2
v_lshl_or_b32 v248, v253, 4, v248
v_bfe_u32 v253, v252, 6, 1
v_lshlrev_b32 v253, 5, v253
v_xor_b32 v248, v248, v253
v_and_b32 v249, 0x1c0, v252
v_bfe_u32 v253, v252, 9, 1
v_lshl_or_b32 v249, v253, 10, v249
v_bfe_u32 v253, v252, 8, 1
v_lshl_or_b32 v249, v253, 5, v249
v_bfe_u32 v253, v252, 4, 2
v_lshl_or_b32 v249, v253, 3, v249
v_xor_b32 v250, 32, v249
s_mov_b32 s56, 90112
s_add_u32 s57, s56, 65536
s_mov_b32 s55, 1
v_bfe_i32 v188, v252, 8, 1
LT_q:
s_add_u32 s44, s40, 4096
buffer_load_dwordx4 v[0:3], v252, s[8:11], s40 offen offset:0
buffer_load_dwordx4 v[4:7], v252, s[8:11], s40 offen offset:1024
buffer_load_dwordx4 v[8:11], v252, s[8:11], s40 offen offset:2048
buffer_load_dwordx4 v[12:15], v252, s[8:11], s40 offen offset:3072
buffer_load_dwordx4 v[16:19], v252, s[8:11], s44 offen offset:0
buffer_load_dwordx4 v[20:23], v252, s[8:11], s44 offen offset:1024
buffer_load_dwordx4 v[24:27], v252, s[8:11], s44 offen offset:2048
buffer_load_dwordx4 v[28:31], v252, s[8:11], s44 offen offset:3072
s_mov_b32 s53, s56
s_mov_b32 s58, s39
s_add_u32 m0, s53, 0
s_add_u32 s54, s58, 0
buffer_load_dwordx4 v251, s[12:15], s54 offen offset:0 lds
buffer_load_dwordx4 v251, s[12:15], s54 offen offset:1024 lds
buffer_load_dwordx4 v251, s[12:15], s54 offen offset:2048 lds
buffer_load_dwordx4 v251, s[12:15], s54 offen offset:3072 lds
s_add_u32 m0, s53, 4096
s_add_u32 s54, s58, 128
buffer_load_dwordx4 v251, s[12:15], s54 offen offset:0 lds
buffer_load_dwordx4 v251, s[12:15], s54 offen offset:1024 lds
buffer_load_dwordx4 v251, s[12:15], s54 offen offset:2048 lds
buffer_load_dwordx4 v251, s[12:15], s54 offen offset:3072 lds
s_add_u32 m0, s53, 8192
s_add_u32 s54, s58, 256
buffer_load_dwordx4 v251, s[12:15], s54 offen offset:0 lds
buffer_load_dwordx4 v251, s[12:15], s54 offen offset:1024 lds
buffer_load_dwordx4 v251, s[12:15], s54 offen offset:2048 lds
buffer_load_dwordx4 v251, s[12:15], s54 offen offset:3072 lds
s_add_u32 m0, s53, 12288
s_add_u32 s54, s58, 384
buffer_load_dwordx4 v251, s[12:15], s54 offen offset:0 lds
buffer_load_dwordx4 v251, s[12:15], s54 offen offset:1024 lds
buffer_load_dwordx4 v251, s[12:15], s54 offen offset:2048 lds
buffer_load_dwordx4 v251, s[12:15], s54 offen offset:3072 lds
s_add_u32 s53, s53, 0x4000
s_cmp_eq_u32 s53, s57
s_cselect_b32 s53, s56, s53
s_add_u32 s58, s58, 0x4000
s_add_u32 m0, s53, 0
s_add_u32 s54, s58, 0
buffer_load_dwordx4 v251, s[12:15], s54 offen offset:0 lds
buffer_load_dwordx4 v251, s[12:15], s54 offen offset:1024 lds
buffer_load_dwordx4 v251, s[12:15], s54 offen offset:2048 lds
buffer_load_dwordx4 v251, s[12:15], s54 offen offset:3072 lds
s_add_u32 m0, s53, 4096
s_add_u32 s54, s58, 128
buffer_load_dwordx4 v251, s[12:15], s54 offen offset:0 lds
buffer_load_dwordx4 v251, s[12:15], s54 offen offset:1024 lds
buffer_load_dwordx4 v251, s[12:15], s54 offen offset:2048 lds
buffer_load_dwordx4 v251, s[12:15], s54 offen offset:3072 lds
s_add_u32 m0, s53, 8192
s_add_u32 s54, s58, 256
buffer_load_dwordx4 v251, s[12:15], s54 offen offset:0 lds
buffer_load_dwordx4 v251, s[12:15], s54 offen offset:1024 lds
buffer_load_dwordx4 v251, s[12:15], s54 offen offset:2048 lds
buffer_load_dwordx4 v251, s[12:15], s54 offen offset:3072 lds
s_add_u32 m0, s53, 12288
s_add_u32 s54, s58, 384
buffer_load_dwordx4 v251, s[12:15], s54 offen offset:0 lds
buffer_load_dwordx4 v251, s[12:15], s54 offen offset:1024 lds
buffer_load_dwordx4 v251, s[12:15], s54 offen offset:2048 lds
buffer_load_dwordx4 v251, s[12:15], s54 offen offset:3072 lds
s_add_u32 s53, s53, 0x4000
s_cmp_eq_u32 s53, s57
s_cselect_b32 s53, s56, s53
s_add_u32 s58, s58, 0x4000
s_add_u32 m0, s53, 0
s_add_u32 s54, s58, 0
buffer_load_dwordx4 v251, s[12:15], s54 offen offset:0 lds
buffer_load_dwordx4 v251, s[12:15], s54 offen offset:1024 lds
buffer_load_dwordx4 v251, s[12:15], s54 offen offset:2048 lds
buffer_load_dwordx4 v251, s[12:15], s54 offen offset:3072 lds
s_add_u32 m0, s53, 4096
s_add_u32 s54, s58, 128
buffer_load_dwordx4 v251, s[12:15], s54 offen offset:0 lds
buffer_load_dwordx4 v251, s[12:15], s54 offen offset:1024 lds
buffer_load_dwordx4 v251, s[12:15], s54 offen offset:2048 lds
buffer_load_dwordx4 v251, s[12:15], s54 offen offset:3072 lds
s_add_u32 m0, s53, 8192
s_add_u32 s54, s58, 256
buffer_load_dwordx4 v251, s[12:15], s54 offen offset:0 lds
buffer_load_dwordx4 v251, s[12:15], s54 offen offset:1024 lds
buffer_load_dwordx4 v251, s[12:15], s54 offen offset:2048 lds
buffer_load_dwordx4 v251, s[12:15], s54 offen offset:3072 lds
s_add_u32 m0, s53, 12288
s_add_u32 s54, s58, 384
buffer_load_dwordx4 v251, s[12:15], s54 offen offset:0 lds
buffer_load_dwordx4 v251, s[12:15], s54 offen offset:1024 lds
buffer_load_dwordx4 v251, s[12:15], s54 offen offset:2048 lds
buffer_load_dwordx4 v251, s[12:15], s54 offen offset:3072 lds
s_add_u32 s53, s53, 0x4000
s_cmp_eq_u32 s53, s57
s_cselect_b32 s53, s56, s53
s_add_u32 s58, s58, 0x4000
s_mov_b32 s51, s29
s_mov_b32 s52, s56
v_mov_b32 v172, 0xff800000
v_accvgpr_write_b32 a0, 0
v_accvgpr_write_b32 a1, 0
v_accvgpr_write_b32 a2, 0
v_accvgpr_write_b32 a3, 0
v_accvgpr_write_b32 a4, 0
v_accvgpr_write_b32 a5, 0
v_accvgpr_write_b32 a6, 0
v_accvgpr_write_b32 a7, 0
v_accvgpr_write_b32 a8, 0
v_accvgpr_write_b32 a9, 0
v_accvgpr_write_b32 a10, 0
v_accvgpr_write_b32 a11, 0
v_accvgpr_write_b32 a12, 0
v_accvgpr_write_b32 a13, 0
v_accvgpr_write_b32 a14, 0
v_accvgpr_write_b32 a15, 0
v_accvgpr_write_b32 a16, 0
v_accvgpr_write_b32 a17, 0
v_accvgpr_write_b32 a18, 0
v_accvgpr_write_b32 a19, 0
v_accvgpr_write_b32 a20, 0
v_accvgpr_write_b32 a21, 0
v_accvgpr_write_b32 a22, 0
v_accvgpr_write_b32 a23, 0
v_accvgpr_write_b32 a24, 0
v_accvgpr_write_b32 a25, 0
v_accvgpr_write_b32 a26, 0
v_accvgpr_write_b32 a27, 0
v_accvgpr_write_b32 a28, 0
v_accvgpr_write_b32 a29, 0
v_accvgpr_write_b32 a30, 0
v_accvgpr_write_b32 a31, 0
v_accvgpr_write_b32 a32, 0
v_accvgpr_write_b32 a33, 0
v_accvgpr_write_b32 a34, 0
v_accvgpr_write_b32 a35, 0
v_accvgpr_write_b32 a36, 0
v_accvgpr_write_b32 a37, 0
v_accvgpr_write_b32 a38, 0
v_accvgpr_write_b32 a39, 0
v_accvgpr_write_b32 a40, 0
v_accvgpr_write_b32 a41, 0
v_accvgpr_write_b32 a42, 0
v_accvgpr_write_b32 a43, 0
v_accvgpr_write_b32 a44, 0
v_accvgpr_write_b32 a45, 0
v_accvgpr_write_b32 a46, 0
v_accvgpr_write_b32 a47, 0
v_accvgpr_write_b32 a48, 0
v_accvgpr_write_b32 a49, 0
v_accvgpr_write_b32 a50, 0
v_accvgpr_write_b32 a51, 0
v_accvgpr_write_b32 a52, 0
v_accvgpr_write_b32 a53, 0
v_accvgpr_write_b32 a54, 0
v_accvgpr_write_b32 a55, 0
v_accvgpr_write_b32 a56, 0
v_accvgpr_write_b32 a57, 0
v_accvgpr_write_b32 a58, 0
v_accvgpr_write_b32 a59, 0
v_accvgpr_write_b32 a60, 0
v_accvgpr_write_b32 a61, 0
v_accvgpr_write_b32 a62, 0
v_accvgpr_write_b32 a63, 0
LT_loop:
s_add_u32 m0, s53, 0
s_add_u32 s54, s58, 0
buffer_load_dwordx4 v251, s[12:15], s54 offen offset:0 lds
buffer_load_dwordx4 v251, s[12:15], s54 offen offset:1024 lds
buffer_load_dwordx4 v251, s[12:15], s54 offen offset:2048 lds
buffer_load_dwordx4 v251, s[12:15], s54 offen offset:3072 lds
s_add_u32 m0, s53, 4096
s_add_u32 s54, s58, 128
buffer_load_dwordx4 v251, s[12:15], s54 offen offset:0 lds
buffer_load_dwordx4 v251, s[12:15], s54 offen offset:1024 lds
buffer_load_dwordx4 v251, s[12:15], s54 offen offset:2048 lds
buffer_load_dwordx4 v251, s[12:15], s54 offen offset:3072 lds
s_add_u32 m0, s53, 8192
s_add_u32 s54, s58, 256
buffer_load_dwordx4 v251, s[12:15], s54 offen offset:0 lds
buffer_load_dwordx4 v251, s[12:15], s54 offen offset:1024 lds
buffer_load_dwordx4 v251, s[12:15], s54 offen offset:2048 lds
buffer_load_dwordx4 v251, s[12:15], s54 offen offset:3072 lds
s_add_u32 m0, s53, 12288
s_add_u32 s54, s58, 384
buffer_load_dwordx4 v251, s[12:15], s54 offen offset:0 lds
buffer_load_dwordx4 v251, s[12:15], s54 offen offset:1024 lds
buffer_load_dwordx4 v251, s[12:15], s54 offen offset:2048 lds
buffer_load_dwordx4 v251, s[12:15], s54 offen offset:3072 lds
s_add_u32 s53, s53, 0x4000
s_cmp_eq_u32 s53, s57
s_cselect_b32 s53, s56, s53
s_add_u32 s58, s58, 0x4000
v_add_u32 v177, s52, v248
v_add_u32 v178, s52, v249
v_add_u32 v179, s52, v250
s_add_u32 s52, s52, 0x4000
s_cmp_eq_u32 s52, s57
s_cselect_b32 s52, s56, s52
s_cmp_eq_u32 s51, 1
s_cselect_b32 s54, s33, 0
v_and_b32 v192, s54, v188
v_and_b32 v193, s54, v188
v_and_b32 v194, s54, v188
v_and_b32 v195, s54, v188
s_waitcnt vmcnt(48)
ds_read_b128 v[32:35], v177 offset:0
ds_read_b128 v[64:67], v177 offset:2048
ds_read_b128 v[36:39], v177 offset:512
ds_read_b128 v[68:71], v177 offset:2560
ds_read_b128 v[40:43], v177 offset:4096
ds_read_b128 v[72:75], v177 offset:6144
ds_read_b128 v[44:47], v177 offset:4608
ds_read_b128 v[76:79], v177 offset:6656
ds_read_b128 v[48:51], v177 offset:8192
ds_read_b128 v[80:83], v177 offset:10240
ds_read_b128 v[52:55], v177 offset:8704
ds_read_b128 v[84:87], v177 offset:10752
ds_read_b128 v[56:59], v177 offset:12288
ds_read_b128 v[88:91], v177 offset:14336
ds_read_b128 v[60:63], v177 offset:12800
ds_read_b128 v[92:95], v177 offset:14848
s_waitcnt lgkmcnt(14)
v_mfma_f32_16x16x32_bf16 v[160:163], v[32:35], v[0:3], v[192:195]
v_mfma_f32_16x16x32_bf16 v[164:167], v[64:67], v[0:3], v[192:195]
s_waitcnt lgkmcnt(12)
v_mfma_f32_16x16x32_bf16 v[160:163], v[36:39], v[4:7], v[160:163]
v_mfma_f32_16x16x32_bf16 v[164:167], v[68:71], v[4:7], v[164:167]
s_waitcnt lgkmcnt(10)
v_mfma_f32_16x16x32_bf16 v[160:163], v[40:43], v[8:11], v[160:163]
v_mfma_f32_16x16x32_bf16 v[164:167], v[72:75], v[8:11], v[164:167]
s_waitcnt lgkmcnt(8)
v_mfma_f32_16x16x32_bf16 v[160:163], v[44:47], v[12:15], v[160:163]
v_mfma_f32_16x16x32_bf16 v[164:167], v[76:79], v[12:15], v[164:167]
s_waitcnt lgkmcnt(6)
v_mfma_f32_16x16x32_bf16 v[160:163], v[48:51], v[16:19], v[160:163]
v_mfma_f32_16x16x32_bf16 v[164:167], v[80:83], v[16:19], v[164:167]
s_waitcnt lgkmcnt(4)
v_mfma_f32_16x16x32_bf16 v[160:163], v[52:55], v[20:23], v[160:163]
v_mfma_f32_16x16x32_bf16 v[164:167], v[84:87], v[20:23], v[164:167]
s_waitcnt lgkmcnt(2)
v_mfma_f32_16x16x32_bf16 v[160:163], v[56:59], v[24:27], v[160:163]
v_mfma_f32_16x16x32_bf16 v[164:167], v[88:91], v[24:27], v[164:167]
s_waitcnt lgkmcnt(0)
v_mfma_f32_16x16x32_bf16 v[160:163], v[60:63], v[28:31], v[160:163]
v_mfma_f32_16x16x32_bf16 v[164:167], v[92:95], v[28:31], v[164:167]
ds_read_b64_tr_b16 v[96:97], v178 offset:0
ds_read_b64_tr_b16 v[98:99], v178 offset:2048
ds_read_b64_tr_b16 v[100:101], v179 offset:0
ds_read_b64_tr_b16 v[102:103], v179 offset:2048
ds_read_b64_tr_b16 v[104:105], v178 offset:512
ds_read_b64_tr_b16 v[106:107], v178 offset:2560
ds_read_b64_tr_b16 v[108:109], v179 offset:512
ds_read_b64_tr_b16 v[110:111], v179 offset:2560
ds_read_b64_tr_b16 v[112:113], v178 offset:4096
ds_read_b64_tr_b16 v[114:115], v178 offset:6144
ds_read_b64_tr_b16 v[116:117], v179 offset:4096
ds_read_b64_tr_b16 v[118:119], v179 offset:6144
ds_read_b64_tr_b16 v[120:121], v178 offset:4608
ds_read_b64_tr_b16 v[122:123], v178 offset:6656
ds_read_b64_tr_b16 v[124:125], v179 offset:4608
ds_read_b64_tr_b16 v[126:127], v179 offset:6656
ds_read_b64_tr_b16 v[128:129], v178 offset:8192
ds_read_b64_tr_b16 v[130:131], v178 offset:10240
ds_read_b64_tr_b16 v[132:133], v179 offset:8192
ds_read_b64_tr_b16 v[134:135], v179 offset:10240
ds_read_b64_tr_b16 v[136:137], v178 offset:8704
ds_read_b64_tr_b16 v[138:139], v178 offset:10752
ds_read_b64_tr_b16 v[140:141], v179 offset:8704
ds_read_b64_tr_b16 v[142:143], v179 offset:10752
ds_read_b64_tr_b16 v[144:145], v178 offset:12288
ds_read_b64_tr_b16 v[146:147], v178 offset:14336
ds_read_b64_tr_b16 v[148:149], v179 offset:12288
ds_read_b64_tr_b16 v[150:151], v179 offset:14336
ds_read_b64_tr_b16 v[152:153], v178 offset:12800
ds_read_b64_tr_b16 v[154:155], v178 offset:14848
ds_read_b64_tr_b16 v[156:157], v179 offset:12800
ds_read_b64_tr_b16 v[158:159], v179 offset:14848
s_nop 7
v_max3_f32 v175, v160, v161, v162
v_max3_f32 v175, v175, v163, v164
v_max3_f32 v175, v175, v165, v166
v_max3_f32 v175, v175, v167, v172
v_mov_b32 v176, v175
s_nop 1
v_permlane32_swap_b32 v175, v176
s_nop 1
v_max_f32 v175, v175, v176
v_mov_b32 v176, v175
s_nop 1
v_permlane16_swap_b32 v175, v176
s_nop 1
v_max_f32 v175, v175, v176
v_sub_f32 v174, v172, v175
v_exp_f32 v174, v174
v_mov_b32 v172, v175
v_sub_f32 v160, v160, v172
v_sub_f32 v161, v161, v172
v_sub_f32 v162, v162, v172
v_sub_f32 v163, v163, v172
v_sub_f32 v164, v164, v172
v_sub_f32 v165, v165, v172
v_sub_f32 v166, v166, v172
v_sub_f32 v167, v167, v172
v_exp_f32 v160, v160
v_exp_f32 v161, v161
v_exp_f32 v162, v162
v_exp_f32 v163, v163
v_exp_f32 v164, v164
v_exp_f32 v165, v165
v_exp_f32 v166, v166
v_exp_f32 v167, v167
v_cmp_neq_f32 vcc, 1.0, v174
v_cvt_pk_bf16_f32 v168, v160, v161
v_cvt_pk_bf16_f32 v169, v162, v163
v_cvt_pk_bf16_f32 v170, v164, v165
v_cvt_pk_bf16_f32 v171, v166, v167
s_cbranch_vccz LT_nors
v_accvgpr_read_b32 v180, a0
v_accvgpr_read_b32 v181, a1
v_accvgpr_read_b32 v182, a2
v_accvgpr_read_b32 v183, a3
v_accvgpr_read_b32 v184, a4
v_accvgpr_read_b32 v185, a5
v_accvgpr_read_b32 v186, a6
v_accvgpr_read_b32 v187, a7
v_mul_f32 v180, v180, v174
v_mul_f32 v181, v181, v174
v_mul_f32 v182, v182, v174
v_mul_f32 v183, v183, v174
v_mul_f32 v184, v184, v174
v_mul_f32 v185, v185, v174
v_mul_f32 v186, v186, v174
v_mul_f32 v187, v187, v174
v_accvgpr_write_b32 a0, v180
v_accvgpr_write_b32 a1, v181
v_accvgpr_write_b32 a2, v182
v_accvgpr_write_b32 a3, v183
v_accvgpr_write_b32 a4, v184
v_accvgpr_write_b32 a5, v185
v_accvgpr_write_b32 a6, v186
v_accvgpr_write_b32 a7, v187
v_accvgpr_read_b32 v180, a8
v_accvgpr_read_b32 v181, a9
v_accvgpr_read_b32 v182, a10
v_accvgpr_read_b32 v183, a11
v_accvgpr_read_b32 v184, a12
v_accvgpr_read_b32 v185, a13
v_accvgpr_read_b32 v186, a14
v_accvgpr_read_b32 v187, a15
v_mul_f32 v180, v180, v174
v_mul_f32 v181, v181, v174
v_mul_f32 v182, v182, v174
v_mul_f32 v183, v183, v174
v_mul_f32 v184, v184, v174
v_mul_f32 v185, v185, v174
v_mul_f32 v186, v186, v174
v_mul_f32 v187, v187, v174
v_accvgpr_write_b32 a8, v180
v_accvgpr_write_b32 a9, v181
v_accvgpr_write_b32 a10, v182
v_accvgpr_write_b32 a11, v183
v_accvgpr_write_b32 a12, v184
v_accvgpr_write_b32 a13, v185
v_accvgpr_write_b32 a14, v186
v_accvgpr_write_b32 a15, v187
v_accvgpr_read_b32 v180, a16
v_accvgpr_read_b32 v181, a17
v_accvgpr_read_b32 v182, a18
v_accvgpr_read_b32 v183, a19
v_accvgpr_read_b32 v184, a20
v_accvgpr_read_b32 v185, a21
v_accvgpr_read_b32 v186, a22
v_accvgpr_read_b32 v187, a23
v_mul_f32 v180, v180, v174
v_mul_f32 v181, v181, v174
v_mul_f32 v182, v182, v174
v_mul_f32 v183, v183, v174
v_mul_f32 v184, v184, v174
v_mul_f32 v185, v185, v174
v_mul_f32 v186, v186, v174
v_mul_f32 v187, v187, v174
v_accvgpr_write_b32 a16, v180
v_accvgpr_write_b32 a17, v181
v_accvgpr_write_b32 a18, v182
v_accvgpr_write_b32 a19, v183
v_accvgpr_write_b32 a20, v184
v_accvgpr_write_b32 a21, v185
v_accvgpr_write_b32 a22, v186
v_accvgpr_write_b32 a23, v187
v_accvgpr_read_b32 v180, a24
v_accvgpr_read_b32 v181, a25
v_accvgpr_read_b32 v182, a26
v_accvgpr_read_b32 v183, a27
v_accvgpr_read_b32 v184, a28
v_accvgpr_read_b32 v185, a29
v_accvgpr_read_b32 v186, a30
v_accvgpr_read_b32 v187, a31
v_mul_f32 v180, v180, v174
v_mul_f32 v181, v181, v174
v_mul_f32 v182, v182, v174
v_mul_f32 v183, v183, v174
v_mul_f32 v184, v184, v174
v_mul_f32 v185, v185, v174
v_mul_f32 v186, v186, v174
v_mul_f32 v187, v187, v174
v_accvgpr_write_b32 a24, v180
v_accvgpr_write_b32 a25, v181
v_accvgpr_write_b32 a26, v182
v_accvgpr_write_b32 a27, v183
v_accvgpr_write_b32 a28, v184
v_accvgpr_write_b32 a29, v185
v_accvgpr_write_b32 a30, v186
v_accvgpr_write_b32 a31, v187
v_accvgpr_read_b32 v180, a32
v_accvgpr_read_b32 v181, a33
v_accvgpr_read_b32 v182, a34
v_accvgpr_read_b32 v183, a35
v_accvgpr_read_b32 v184, a36
v_accvgpr_read_b32 v185, a37
v_accvgpr_read_b32 v186, a38
v_accvgpr_read_b32 v187, a39
v_mul_f32 v180, v180, v174
v_mul_f32 v181, v181, v174
v_mul_f32 v182, v182, v174
v_mul_f32 v183, v183, v174
v_mul_f32 v184, v184, v174
v_mul_f32 v185, v185, v174
v_mul_f32 v186, v186, v174
v_mul_f32 v187, v187, v174
v_accvgpr_write_b32 a32, v180
v_accvgpr_write_b32 a33, v181
v_accvgpr_write_b32 a34, v182
v_accvgpr_write_b32 a35, v183
v_accvgpr_write_b32 a36, v184
v_accvgpr_write_b32 a37, v185
v_accvgpr_write_b32 a38, v186
v_accvgpr_write_b32 a39, v187
v_accvgpr_read_b32 v180, a40
v_accvgpr_read_b32 v181, a41
v_accvgpr_read_b32 v182, a42
v_accvgpr_read_b32 v183, a43
v_accvgpr_read_b32 v184, a44
v_accvgpr_read_b32 v185, a45
v_accvgpr_read_b32 v186, a46
v_accvgpr_read_b32 v187, a47
v_mul_f32 v180, v180, v174
v_mul_f32 v181, v181, v174
v_mul_f32 v182, v182, v174
v_mul_f32 v183, v183, v174
v_mul_f32 v184, v184, v174
v_mul_f32 v185, v185, v174
v_mul_f32 v186, v186, v174
v_mul_f32 v187, v187, v174
v_accvgpr_write_b32 a40, v180
v_accvgpr_write_b32 a41, v181
v_accvgpr_write_b32 a42, v182
v_accvgpr_write_b32 a43, v183
v_accvgpr_write_b32 a44, v184
v_accvgpr_write_b32 a45, v185
v_accvgpr_write_b32 a46, v186
v_accvgpr_write_b32 a47, v187
v_accvgpr_read_b32 v180, a48
v_accvgpr_read_b32 v181, a49
v_accvgpr_read_b32 v182, a50
v_accvgpr_read_b32 v183, a51
v_accvgpr_read_b32 v184, a52
v_accvgpr_read_b32 v185, a53
v_accvgpr_read_b32 v186, a54
v_accvgpr_read_b32 v187, a55
v_mul_f32 v180, v180, v174
v_mul_f32 v181, v181, v174
v_mul_f32 v182, v182, v174
v_mul_f32 v183, v183, v174
v_mul_f32 v184, v184, v174
v_mul_f32 v185, v185, v174
v_mul_f32 v186, v186, v174
v_mul_f32 v187, v187, v174
v_accvgpr_write_b32 a48, v180
v_accvgpr_write_b32 a49, v181
v_accvgpr_write_b32 a50, v182
v_accvgpr_write_b32 a51, v183
v_accvgpr_write_b32 a52, v184
v_accvgpr_write_b32 a53, v185
v_accvgpr_write_b32 a54, v186
v_accvgpr_write_b32 a55, v187
v_accvgpr_read_b32 v180, a56
v_accvgpr_read_b32 v181, a57
v_accvgpr_read_b32 v182, a58
v_accvgpr_read_b32 v183, a59
v_accvgpr_read_b32 v184, a60
v_accvgpr_read_b32 v185, a61
v_accvgpr_read_b32 v186, a62
v_accvgpr_read_b32 v187, a63
v_mul_f32 v180, v180, v174
v_mul_f32 v181, v181, v174
v_mul_f32 v182, v182, v174
v_mul_f32 v183, v183, v174
v_mul_f32 v184, v184, v174
v_mul_f32 v185, v185, v174
v_mul_f32 v186, v186, v174
v_mul_f32 v187, v187, v174
v_accvgpr_write_b32 a56, v180
v_accvgpr_write_b32 a57, v181
v_accvgpr_write_b32 a58, v182
v_accvgpr_write_b32 a59, v183
v_accvgpr_write_b32 a60, v184
v_accvgpr_write_b32 a61, v185
v_accvgpr_write_b32 a62, v186
v_accvgpr_write_b32 a63, v187
LT_nors:
s_waitcnt lgkmcnt(0)
s_nop 1
v_mfma_f32_16x16x32_bf16 a[0:3], v[96:99], v[168:171], a[0:3]
v_mfma_f32_16x16x32_bf16 a[4:7], v[100:103], v[168:171], a[4:7]
v_mfma_f32_16x16x32_bf16 a[8:11], v[104:107], v[168:171], a[8:11]
v_mfma_f32_16x16x32_bf16 a[12:15], v[108:111], v[168:171], a[12:15]
v_mfma_f32_16x16x32_bf16 a[16:19], v[112:115], v[168:171], a[16:19]
v_mfma_f32_16x16x32_bf16 a[20:23], v[116:119], v[168:171], a[20:23]
v_mfma_f32_16x16x32_bf16 a[24:27], v[120:123], v[168:171], a[24:27]
v_mfma_f32_16x16x32_bf16 a[28:31], v[124:127], v[168:171], a[28:31]
v_mfma_f32_16x16x32_bf16 a[32:35], v[128:131], v[168:171], a[32:35]
v_mfma_f32_16x16x32_bf16 a[36:39], v[132:135], v[168:171], a[36:39]
v_mfma_f32_16x16x32_bf16 a[40:43], v[136:139], v[168:171], a[40:43]
v_mfma_f32_16x16x32_bf16 a[44:47], v[140:143], v[168:171], a[44:47]
v_mfma_f32_16x16x32_bf16 a[48:51], v[144:147], v[168:171], a[48:51]
v_mfma_f32_16x16x32_bf16 a[52:55], v[148:151], v[168:171], a[52:55]
v_mfma_f32_16x16x32_bf16 a[56:59], v[152:155], v[168:171], a[56:59]
v_mfma_f32_16x16x32_bf16 a[60:63], v[156:159], v[168:171], a[60:63]
s_sub_u32 s51, s51, 1
s_cmp_lg_u32 s51, 0
s_cbranch_scc1 LT_loop
s_nop 15
v_accvgpr_read_b32 v173, a0
v_accvgpr_read_b32 v180, a0
v_accvgpr_read_b32 v181, a1
v_accvgpr_read_b32 v182, a2
v_accvgpr_read_b32 v183, a3
v_accvgpr_read_b32 v184, a4
v_accvgpr_read_b32 v185, a5
v_accvgpr_read_b32 v186, a6
v_accvgpr_read_b32 v187, a7
v_cvt_pk_bf16_f32 v32, v180, v181
v_cvt_pk_bf16_f32 v33, v182, v183
v_cvt_pk_bf16_f32 v34, v184, v185
v_cvt_pk_bf16_f32 v35, v186, v187
buffer_store_dwordx4 v[32:35], v252, s[20:23], s40 offen offset:0 sc1
v_accvgpr_read_b32 v180, a8
v_accvgpr_read_b32 v181, a9
v_accvgpr_read_b32 v182, a10
v_accvgpr_read_b32 v183, a11
v_accvgpr_read_b32 v184, a12
v_accvgpr_read_b32 v185, a13
v_accvgpr_read_b32 v186, a14
v_accvgpr_read_b32 v187, a15
v_cvt_pk_bf16_f32 v36, v180, v181
v_cvt_pk_bf16_f32 v37, v182, v183
v_cvt_pk_bf16_f32 v38, v184, v185
v_cvt_pk_bf16_f32 v39, v186, v187
buffer_store_dwordx4 v[36:39], v252, s[20:23], s40 offen offset:1024 sc1
v_accvgpr_read_b32 v180, a16
v_accvgpr_read_b32 v181, a17
v_accvgpr_read_b32 v182, a18
v_accvgpr_read_b32 v183, a19
v_accvgpr_read_b32 v184, a20
v_accvgpr_read_b32 v185, a21
v_accvgpr_read_b32 v186, a22
v_accvgpr_read_b32 v187, a23
v_cvt_pk_bf16_f32 v40, v180, v181
v_cvt_pk_bf16_f32 v41, v182, v183
v_cvt_pk_bf16_f32 v42, v184, v185
v_cvt_pk_bf16_f32 v43, v186, v187
buffer_store_dwordx4 v[40:43], v252, s[20:23], s40 offen offset:2048 sc1
v_accvgpr_read_b32 v180, a24
v_accvgpr_read_b32 v181, a25
v_accvgpr_read_b32 v182, a26
v_accvgpr_read_b32 v183, a27
v_accvgpr_read_b32 v184, a28
v_accvgpr_read_b32 v185, a29
v_accvgpr_read_b32 v186, a30
v_accvgpr_read_b32 v187, a31
v_cvt_pk_bf16_f32 v44, v180, v181
v_cvt_pk_bf16_f32 v45, v182, v183
v_cvt_pk_bf16_f32 v46, v184, v185
v_cvt_pk_bf16_f32 v47, v186, v187
buffer_store_dwordx4 v[44:47], v252, s[20:23], s40 offen offset:3072 sc1
v_accvgpr_read_b32 v180, a32
v_accvgpr_read_b32 v181, a33
v_accvgpr_read_b32 v182, a34
v_accvgpr_read_b32 v183, a35
v_accvgpr_read_b32 v184, a36
v_accvgpr_read_b32 v185, a37
v_accvgpr_read_b32 v186, a38
v_accvgpr_read_b32 v187, a39
v_cvt_pk_bf16_f32 v48, v180, v181
v_cvt_pk_bf16_f32 v49, v182, v183
v_cvt_pk_bf16_f32 v50, v184, v185
v_cvt_pk_bf16_f32 v51, v186, v187
buffer_store_dwordx4 v[48:51], v252, s[20:23], s44 offen offset:0 sc1
v_accvgpr_read_b32 v180, a40
v_accvgpr_read_b32 v181, a41
v_accvgpr_read_b32 v182, a42
v_accvgpr_read_b32 v183, a43
v_accvgpr_read_b32 v184, a44
v_accvgpr_read_b32 v185, a45
v_accvgpr_read_b32 v186, a46
v_accvgpr_read_b32 v187, a47
v_cvt_pk_bf16_f32 v52, v180, v181
v_cvt_pk_bf16_f32 v53, v182, v183
v_cvt_pk_bf16_f32 v54, v184, v185
v_cvt_pk_bf16_f32 v55, v186, v187
buffer_store_dwordx4 v[52:55], v252, s[20:23], s44 offen offset:1024 sc1
v_accvgpr_read_b32 v180, a48
v_accvgpr_read_b32 v181, a49
v_accvgpr_read_b32 v182, a50
v_accvgpr_read_b32 v183, a51
v_accvgpr_read_b32 v184, a52
v_accvgpr_read_b32 v185, a53
v_accvgpr_read_b32 v186, a54
v_accvgpr_read_b32 v187, a55
v_cvt_pk_bf16_f32 v56, v180, v181
v_cvt_pk_bf16_f32 v57, v182, v183
v_cvt_pk_bf16_f32 v58, v184, v185
v_cvt_pk_bf16_f32 v59, v186, v187
buffer_store_dwordx4 v[56:59], v252, s[20:23], s44 offen offset:2048 sc1
v_accvgpr_read_b32 v180, a56
v_accvgpr_read_b32 v181, a57
v_accvgpr_read_b32 v182, a58
v_accvgpr_read_b32 v183, a59
v_accvgpr_read_b32 v184, a60
v_accvgpr_read_b32 v185, a61
v_accvgpr_read_b32 v186, a62
v_accvgpr_read_b32 v187, a63
v_cvt_pk_bf16_f32 v60, v180, v181
v_cvt_pk_bf16_f32 v61, v182, v183
v_cvt_pk_bf16_f32 v62, v184, v185
v_cvt_pk_bf16_f32 v63, v186, v187
buffer_store_dwordx4 v[60:63], v252, s[20:23], s44 offen offset:3072 sc1
v_lshlrev_b32 v175, 2, v252
s_mov_b64 exec, 0xffff
buffer_store_dwordx2 v[172:173], v175, s[24:27], s48 offen sc1
s_mov_b64 exec, -1
s_waitcnt vmcnt(0)
s_add_u32 s40, s40, 8192
s_add_u32 s48, s48, 1024
s_sub_u32 s55, s55, 1
s_cmp_lg_u32 s55, 0
s_cbranch_scc1 LT_q
s_add_u32 s52, s4, 0x7c00000
s_addc_u32 s53, s5, 0
s_mov_b32 s54, 0x2000
s_mov_b32 s55, 0x00020000
v_mov_b32 v1, 4992
v_mov_b32 v2, 1
s_mov_b64 exec, 1
s_waitcnt vmcnt(0)
buffer_atomic_add v2, v1, s[52:55], 0 offen
s_mov_b64 exec, -1
s_branch L2_fin
LE_start:
s_cmp_ge_u32 s37, 32
s_cbranch_scc1 L2_end
v_lshrrev_b32 v1, 6, v0
s_sub_u32 s37, s37, 30
s_lshl_b32 s35, s35, 1
v_readfirstlane_b32 s41, v1
s_add_u32 s35, s35, s37
s_mul_i32 s35, s35, 3
s_add_u32 s40, s35, s41
s_cmp_ge_u32 s41, 3
s_cbranch_scc1 LC_help
LE_common:
v_and_b32 v1, 63, v0
s_mul_i32 s58, s40, 167
s_mov_b32 s59, 167
s_mov_b32 s42, 0
s_mov_b32 s49, 512
v_lshrrev_b32 v33, 1, v1
v_and_b32 v34, 1, v1
v_mul_u32_u24 v6, 0x5000, v33
v_lshl_add_u32 v6, v34, 4, v6
v_lshlrev_b32 v33, 2, v33
s_mul_i32 s50, s40, 655360
s_mul_i32 s48, s40, 128
s_waitcnt lgkmcnt(0)
s_add_u32 s8, s4, 0x7800000
s_addc_u32 s9, s5, 0
s_mov_b32 s10, 0x2000
s_mov_b32 s11, 0x00020000
s_add_u32 s12, s4, 0x8000000
s_addc_u32 s13, s5, 0
s_mov_b32 s14, 0x2800000
s_mov_b32 s15, 0x00020000
buffer_load_dword v4, v33, s[8:11], s48 offen
buffer_load_dwordx4 v[192:195], v6, s[12:15], s50 offen offset:0
buffer_load_dwordx4 v[196:199], v6, s[12:15], s50 offen offset:32
buffer_load_dwordx4 v[200:203], v6, s[12:15], s50 offen offset:64
buffer_load_dwordx4 v[204:207], v6, s[12:15], s50 offen offset:96
buffer_load_dwordx4 v[208:211], v6, s[12:15], s50 offen offset:128
buffer_load_dwordx4 v[212:215], v6, s[12:15], s50 offen offset:160
buffer_load_dwordx4 v[216:219], v6, s[12:15], s50 offen offset:192
buffer_load_dwordx4 v[220:223], v6, s[12:15], s50 offen offset:224
buffer_load_dwordx4 v[224:227], v6, s[12:15], s50 offen offset:256
buffer_load_dwordx4 v[228:231], v6, s[12:15], s50 offen offset:288
buffer_load_dwordx4 v[232:235], v6, s[12:15], s50 offen offset:320
buffer_load_dwordx4 v[236:239], v6, s[12:15], s50 offen offset:352
buffer_load_dwordx4 v[240:243], v6, s[12:15], s50 offen offset:384
buffer_load_dwordx4 v[244:247], v6, s[12:15], s50 offen offset:416
buffer_load_dwordx4 v[248:251], v6, s[12:15], s50 offen offset:448
buffer_load_dwordx4 v[252:255], v6, s[12:15], s50 offen offset:480
s_add_u32 s16, s16, 0x0
s_addc_u32 s17, s17, 0
s_mov_b32 s18, 0x4e20
s_mov_b32 s19, 0x00020000
v_lshlrev_b32 v35, 1, v1
s_lshl_b32 s48, s58, 1
buffer_load_ushort v76, v35, s[16:19], s48 offen offset:0
buffer_load_ushort v77, v35, s[16:19], s48 offen offset:128
buffer_load_ushort v78, v35, s[16:19], s48 offen offset:256
s_add_u32 s16, s4, 0x6800000
s_addc_u32 s17, s5, 0
s_mov_b32 s18, 0x4e2000
s_mov_b32 s19, 0x00020000
s_add_u32 s20, s4, 0x7000000
s_addc_u32 s21, s5, 0
s_mov_b32 s22, 0x4e2000
s_mov_b32 s23, 0x00020000
v_lshlrev_b32 v5, 2, v34
v_and_b32 v2, 15, v1
v_lshrrev_b32 v3, 4, v1
v_mov_b32 v16, 1
v_mov_b32 v17, 4
v_and_b32 v33, 1, v2
v_lshlrev_b32 v33, 4, v33
v_lshlrev_b32 v33, v33, v16
v_mul_u32_u24 v33, 0x3f80, v33
v_lshrrev_b32 v34, 1, v2
v_cmp_eq_u32 vcc, 0, v34
s_nop 1
v_cndmask_b32 v40, 0, v33, vcc
v_cmp_eq_u32 vcc, 1, v34
s_nop 1
v_cndmask_b32 v41, 0, v33, vcc
v_cmp_eq_u32 vcc, 2, v34
s_nop 1
v_cndmask_b32 v42, 0, v33, vcc
v_cmp_eq_u32 vcc, 3, v34
s_nop 1
v_cndmask_b32 v43, 0, v33, vcc
v_cmp_eq_u32 vcc, 4, v34
s_nop 1
v_cndmask_b32 v44, 0, v33, vcc
v_cmp_eq_u32 vcc, 5, v34
s_nop 1
v_cndmask_b32 v45, 0, v33, vcc
v_cmp_eq_u32 vcc, 6, v34
s_nop 1
v_cndmask_b32 v46, 0, v33, vcc
v_cmp_eq_u32 vcc, 7, v34
s_nop 1
v_cndmask_b32 v47, 0, v33, vcc
v_lshlrev_b32 v39, 5, v2
v_lshl_add_u32 v39, v3, 3, v39
v_lshlrev_b32 v2, 4, v2
s_mul_i32 s48, s41, 21504
s_add_u32 s48, s48, 4096
v_mov_b32 v36, s48
v_lshl_add_u32 v38, v3, 2, v36
s_lshl_b32 s36, s41, 10
v_mov_b32 v7, s36
v_lshlrev_b32 v35, 4, v1
v_add_u32 v68, s48, v35
v_add_u32 v35, s36, v35
v_lshlrev_b32 v33, 2, v1
v_mov_b32 v72, 0xffff
v_mov_b32 v73, 0xffff
v_mov_b32 v74, 0xffff
v_mov_b32 v75, 0xffff
s_sub_u32 s36, s59, 0
v_cmp_gt_u32 vcc, s36, v33
v_mov_b32 v48, 0
s_nop 0
v_cndmask_b32 v18, 0, v16, vcc
s_sub_u32 s36, s59, 1
v_cmp_gt_u32 vcc, s36, v33
v_mov_b32 v49, 0
s_nop 0
v_cndmask_b32 v19, 0, v16, vcc
s_sub_u32 s36, s59, 2
v_cmp_gt_u32 vcc, s36, v33
v_mov_b32 v50, 0
s_nop 0
v_cndmask_b32 v20, 0, v16, vcc
s_sub_u32 s36, s59, 3
v_cmp_gt_u32 vcc, s36, v33
v_mov_b32 v51, 0
s_nop 0
v_cndmask_b32 v21, 0, v16, vcc
LE_pass:
ds_write_b128 v35, v[48:51]
ds_write_b128 v68, v[72:75] offset:0
ds_write_b128 v68, v[72:75] offset:1024
ds_write_b128 v68, v[72:75] offset:2048
ds_write_b128 v68, v[72:75] offset:3072
ds_write_b128 v68, v[72:75] offset:4096
ds_write_b128 v68, v[72:75] offset:5120
ds_write_b128 v68, v[72:75] offset:6144
ds_write_b128 v68, v[72:75] offset:7168
ds_write_b128 v68, v[72:75] offset:8192
ds_write_b128 v68, v[72:75] offset:9216
ds_write_b128 v68, v[72:75] offset:10240
ds_write_b128 v68, v[72:75] offset:11264
ds_write_b128 v68, v[72:75] offset:12288
ds_write_b128 v68, v[72:75] offset:13312
ds_write_b128 v68, v[72:75] offset:14336
ds_write_b128 v68, v[72:75] offset:15360
ds_write_b128 v68, v[72:75] offset:16384
ds_write_b128 v68, v[72:75] offset:17408
ds_write_b128 v68, v[72:75] offset:18432
ds_write_b128 v68, v[72:75] offset:19456
v_lshl_add_u32 v32, v1, 2, v36
ds_write_b32 v32, v48 offset:20480
s_waitcnt vmcnt(19)
v_sub_u32 v32, v4, v5
s_waitcnt vmcnt(15)
v_cmpx_lt_i32 vcc, 0, v32
s_cbranch_execz LE_c
v_mad_u32_u16 v128, v192, 1, v7 op_sel:[1,0,0,0]
ds_add_u32 v128, v16
v_cmpx_lt_i32 vcc, 1, v32
v_mad_u32_u16 v129, v193, 1, v7 op_sel:[1,0,0,0]
ds_add_u32 v129, v16
v_cmpx_lt_i32 vcc, 2, v32
v_mad_u32_u16 v130, v194, 1, v7 op_sel:[1,0,0,0]
ds_add_u32 v130, v16
v_cmpx_lt_i32 vcc, 3, v32
v_mad_u32_u16 v131, v195, 1, v7 op_sel:[1,0,0,0]
ds_add_u32 v131, v16
s_waitcnt vmcnt(14)
v_cmpx_lt_i32 vcc, 8, v32
s_cbranch_execz LE_c
v_mad_u32_u16 v132, v196, 1, v7 op_sel:[1,0,0,0]
ds_add_u32 v132, v16
v_cmpx_lt_i32 vcc, 9, v32
v_mad_u32_u16 v133, v197, 1, v7 op_sel:[1,0,0,0]
ds_add_u32 v133, v16
v_cmpx_lt_i32 vcc, 10, v32
v_mad_u32_u16 v134, v198, 1, v7 op_sel:[1,0,0,0]
ds_add_u32 v134, v16
v_cmpx_lt_i32 vcc, 11, v32
v_mad_u32_u16 v135, v199, 1, v7 op_sel:[1,0,0,0]
ds_add_u32 v135, v16
s_waitcnt vmcnt(13)
v_cmpx_lt_i32 vcc, 16, v32
s_cbranch_execz LE_c
v_mad_u32_u16 v136, v200, 1, v7 op_sel:[1,0,0,0]
ds_add_u32 v136, v16
v_cmpx_lt_i32 vcc, 17, v32
v_mad_u32_u16 v137, v201, 1, v7 op_sel:[1,0,0,0]
ds_add_u32 v137, v16
v_cmpx_lt_i32 vcc, 18, v32
v_mad_u32_u16 v138, v202, 1, v7 op_sel:[1,0,0,0]
ds_add_u32 v138, v16
v_cmpx_lt_i32 vcc, 19, v32
v_mad_u32_u16 v139, v203, 1, v7 op_sel:[1,0,0,0]
ds_add_u32 v139, v16
s_waitcnt vmcnt(12)
v_cmpx_lt_i32 vcc, 24, v32
s_cbranch_execz LE_c
v_mad_u32_u16 v140, v204, 1, v7 op_sel:[1,0,0,0]
ds_add_u32 v140, v16
v_cmpx_lt_i32 vcc, 25, v32
v_mad_u32_u16 v141, v205, 1, v7 op_sel:[1,0,0,0]
ds_add_u32 v141, v16
v_cmpx_lt_i32 vcc, 26, v32
v_mad_u32_u16 v142, v206, 1, v7 op_sel:[1,0,0,0]
ds_add_u32 v142, v16
v_cmpx_lt_i32 vcc, 27, v32
v_mad_u32_u16 v143, v207, 1, v7 op_sel:[1,0,0,0]
ds_add_u32 v143, v16
s_waitcnt vmcnt(11)
v_cmpx_lt_i32 vcc, 32, v32
s_cbranch_execz LE_c
v_mad_u32_u16 v144, v208, 1, v7 op_sel:[1,0,0,0]
ds_add_u32 v144, v16
v_cmpx_lt_i32 vcc, 33, v32
v_mad_u32_u16 v145, v209, 1, v7 op_sel:[1,0,0,0]
ds_add_u32 v145, v16
v_cmpx_lt_i32 vcc, 34, v32
v_mad_u32_u16 v146, v210, 1, v7 op_sel:[1,0,0,0]
ds_add_u32 v146, v16
v_cmpx_lt_i32 vcc, 35, v32
v_mad_u32_u16 v147, v211, 1, v7 op_sel:[1,0,0,0]
ds_add_u32 v147, v16
s_waitcnt vmcnt(10)
v_cmpx_lt_i32 vcc, 40, v32
s_cbranch_execz LE_c
v_mad_u32_u16 v148, v212, 1, v7 op_sel:[1,0,0,0]
ds_add_u32 v148, v16
v_cmpx_lt_i32 vcc, 41, v32
v_mad_u32_u16 v149, v213, 1, v7 op_sel:[1,0,0,0]
ds_add_u32 v149, v16
v_cmpx_lt_i32 vcc, 42, v32
v_mad_u32_u16 v150, v214, 1, v7 op_sel:[1,0,0,0]
ds_add_u32 v150, v16
v_cmpx_lt_i32 vcc, 43, v32
v_mad_u32_u16 v151, v215, 1, v7 op_sel:[1,0,0,0]
ds_add_u32 v151, v16
s_waitcnt vmcnt(9)
v_cmpx_lt_i32 vcc, 48, v32
s_cbranch_execz LE_c
v_mad_u32_u16 v152, v216, 1, v7 op_sel:[1,0,0,0]
ds_add_u32 v152, v16
v_cmpx_lt_i32 vcc, 49, v32
v_mad_u32_u16 v153, v217, 1, v7 op_sel:[1,0,0,0]
ds_add_u32 v153, v16
v_cmpx_lt_i32 vcc, 50, v32
v_mad_u32_u16 v154, v218, 1, v7 op_sel:[1,0,0,0]
ds_add_u32 v154, v16
v_cmpx_lt_i32 vcc, 51, v32
v_mad_u32_u16 v155, v219, 1, v7 op_sel:[1,0,0,0]
ds_add_u32 v155, v16
s_waitcnt vmcnt(8)
v_cmpx_lt_i32 vcc, 56, v32
s_cbranch_execz LE_c
v_mad_u32_u16 v156, v220, 1, v7 op_sel:[1,0,0,0]
ds_add_u32 v156, v16
v_cmpx_lt_i32 vcc, 57, v32
v_mad_u32_u16 v157, v221, 1, v7 op_sel:[1,0,0,0]
ds_add_u32 v157, v16
v_cmpx_lt_i32 vcc, 58, v32
v_mad_u32_u16 v158, v222, 1, v7 op_sel:[1,0,0,0]
ds_add_u32 v158, v16
v_cmpx_lt_i32 vcc, 59, v32
v_mad_u32_u16 v159, v223, 1, v7 op_sel:[1,0,0,0]
ds_add_u32 v159, v16
s_waitcnt vmcnt(7)
v_cmpx_lt_i32 vcc, 64, v32
s_cbranch_execz LE_c
v_mad_u32_u16 v160, v224, 1, v7 op_sel:[1,0,0,0]
ds_add_u32 v160, v16
v_cmpx_lt_i32 vcc, 65, v32
v_mad_u32_u16 v161, v225, 1, v7 op_sel:[1,0,0,0]
ds_add_u32 v161, v16
v_cmpx_lt_i32 vcc, 66, v32
v_mad_u32_u16 v162, v226, 1, v7 op_sel:[1,0,0,0]
ds_add_u32 v162, v16
v_cmpx_lt_i32 vcc, 67, v32
v_mad_u32_u16 v163, v227, 1, v7 op_sel:[1,0,0,0]
ds_add_u32 v163, v16
s_waitcnt vmcnt(6)
v_cmpx_lt_i32 vcc, 72, v32
s_cbranch_execz LE_c
v_mad_u32_u16 v164, v228, 1, v7 op_sel:[1,0,0,0]
ds_add_u32 v164, v16
v_cmpx_lt_i32 vcc, 73, v32
v_mad_u32_u16 v165, v229, 1, v7 op_sel:[1,0,0,0]
ds_add_u32 v165, v16
v_cmpx_lt_i32 vcc, 74, v32
v_mad_u32_u16 v166, v230, 1, v7 op_sel:[1,0,0,0]
ds_add_u32 v166, v16
v_cmpx_lt_i32 vcc, 75, v32
v_mad_u32_u16 v167, v231, 1, v7 op_sel:[1,0,0,0]
ds_add_u32 v167, v16
s_waitcnt vmcnt(5)
v_cmpx_lt_i32 vcc, 80, v32
s_cbranch_execz LE_c
v_mad_u32_u16 v168, v232, 1, v7 op_sel:[1,0,0,0]
ds_add_u32 v168, v16
v_cmpx_lt_i32 vcc, 81, v32
v_mad_u32_u16 v169, v233, 1, v7 op_sel:[1,0,0,0]
ds_add_u32 v169, v16
v_cmpx_lt_i32 vcc, 82, v32
v_mad_u32_u16 v170, v234, 1, v7 op_sel:[1,0,0,0]
ds_add_u32 v170, v16
v_cmpx_lt_i32 vcc, 83, v32
v_mad_u32_u16 v171, v235, 1, v7 op_sel:[1,0,0,0]
ds_add_u32 v171, v16
s_waitcnt vmcnt(4)
v_cmpx_lt_i32 vcc, 88, v32
s_cbranch_execz LE_c
v_mad_u32_u16 v172, v236, 1, v7 op_sel:[1,0,0,0]
ds_add_u32 v172, v16
v_cmpx_lt_i32 vcc, 89, v32
v_mad_u32_u16 v173, v237, 1, v7 op_sel:[1,0,0,0]
ds_add_u32 v173, v16
v_cmpx_lt_i32 vcc, 90, v32
v_mad_u32_u16 v174, v238, 1, v7 op_sel:[1,0,0,0]
ds_add_u32 v174, v16
v_cmpx_lt_i32 vcc, 91, v32
v_mad_u32_u16 v175, v239, 1, v7 op_sel:[1,0,0,0]
ds_add_u32 v175, v16
s_waitcnt vmcnt(3)
v_cmpx_lt_i32 vcc, 96, v32
s_cbranch_execz LE_c
v_mad_u32_u16 v176, v240, 1, v7 op_sel:[1,0,0,0]
ds_add_u32 v176, v16
v_cmpx_lt_i32 vcc, 97, v32
v_mad_u32_u16 v177, v241, 1, v7 op_sel:[1,0,0,0]
ds_add_u32 v177, v16
v_cmpx_lt_i32 vcc, 98, v32
v_mad_u32_u16 v178, v242, 1, v7 op_sel:[1,0,0,0]
ds_add_u32 v178, v16
v_cmpx_lt_i32 vcc, 99, v32
v_mad_u32_u16 v179, v243, 1, v7 op_sel:[1,0,0,0]
ds_add_u32 v179, v16
s_waitcnt vmcnt(2)
v_cmpx_lt_i32 vcc, 104, v32
s_cbranch_execz LE_c
v_mad_u32_u16 v180, v244, 1, v7 op_sel:[1,0,0,0]
ds_add_u32 v180, v16
v_cmpx_lt_i32 vcc, 105, v32
v_mad_u32_u16 v181, v245, 1, v7 op_sel:[1,0,0,0]
ds_add_u32 v181, v16
v_cmpx_lt_i32 vcc, 106, v32
v_mad_u32_u16 v182, v246, 1, v7 op_sel:[1,0,0,0]
ds_add_u32 v182, v16
v_cmpx_lt_i32 vcc, 107, v32
v_mad_u32_u16 v183, v247, 1, v7 op_sel:[1,0,0,0]
ds_add_u32 v183, v16
s_waitcnt vmcnt(1)
v_cmpx_lt_i32 vcc, 112, v32
s_cbranch_execz LE_c
v_mad_u32_u16 v184, v248, 1, v7 op_sel:[1,0,0,0]
ds_add_u32 v184, v16
v_cmpx_lt_i32 vcc, 113, v32
v_mad_u32_u16 v185, v249, 1, v7 op_sel:[1,0,0,0]
ds_add_u32 v185, v16
v_cmpx_lt_i32 vcc, 114, v32
v_mad_u32_u16 v186, v250, 1, v7 op_sel:[1,0,0,0]
ds_add_u32 v186, v16
v_cmpx_lt_i32 vcc, 115, v32
v_mad_u32_u16 v187, v251, 1, v7 op_sel:[1,0,0,0]
ds_add_u32 v187, v16
s_waitcnt vmcnt(0)
v_cmpx_lt_i32 vcc, 120, v32
s_cbranch_execz LE_c
v_mad_u32_u16 v188, v252, 1, v7 op_sel:[1,0,0,0]
ds_add_u32 v188, v16
v_cmpx_lt_i32 vcc, 121, v32
v_mad_u32_u16 v189, v253, 1, v7 op_sel:[1,0,0,0]
ds_add_u32 v189, v16
v_cmpx_lt_i32 vcc, 122, v32
v_mad_u32_u16 v190, v254, 1, v7 op_sel:[1,0,0,0]
ds_add_u32 v190, v16
v_cmpx_lt_i32 vcc, 123, v32
v_mad_u32_u16 v191, v255, 1, v7 op_sel:[1,0,0,0]
ds_add_u32 v191, v16
LE_c:
s_mov_b64 exec, -1
ds_read_b128 v[24:27], v35
s_waitcnt lgkmcnt(0)
v_add_u32 v24, 3, v24
v_lshrrev_b32 v24, 2, v24
v_max_u32 v24, v24, v18
v_add_u32 v25, 3, v25
v_lshrrev_b32 v25, 2, v25
v_max_u32 v25, v25, v19
v_add_u32 v26, 3, v26
v_lshrrev_b32 v26, 2, v26
v_max_u32 v26, v26, v20
v_add_u32 v27, 3, v27
v_lshrrev_b32 v27, 2, v27
v_max_u32 v27, v27, v21
v_add_u32 v33, v24, v25
v_add3_u32 v33, v33, v26, v27
v_mov_b32 v64, v33
s_nop 1
v_add_u32_dpp v64, v64, v64 row_shr:1 row_mask:0xf bank_mask:0xf
s_nop 1
v_add_u32_dpp v64, v64, v64 row_shr:2 row_mask:0xf bank_mask:0xf
s_nop 1
v_add_u32_dpp v64, v64, v64 row_shr:4 row_mask:0xf bank_mask:0xf
s_nop 1
v_add_u32_dpp v64, v64, v64 row_shr:8 row_mask:0xf bank_mask:0xf
s_nop 1
v_add_u32_dpp v64, v64, v64 row_bcast:15 row_mask:0xa bank_mask:0xf
s_nop 1
v_add_u32_dpp v64, v64, v64 row_bcast:31 row_mask:0xc bank_mask:0xf
s_nop 1
v_readlane_b32 s44, v64, 63
v_sub_u32 v28, v64, v33
v_add_u32 v29, v28, v24
v_add_u32 v30, v29, v25
v_add_u32 v31, v30, v26
v_add3_u32 v33, v28, v24, -1
v_lshlrev_b32 v34, v33, v18
v_lshrrev_b32 v33, 5, v33
v_lshl_add_u32 v33, v33, 2, v36
ds_or_b32 v33, v34 offset:20480
v_lshl_add_u32 v28, v28, 4, v36
v_add3_u32 v33, v29, v25, -1
v_lshlrev_b32 v34, v33, v19
v_lshrrev_b32 v33, 5, v33
v_lshl_add_u32 v33, v33, 2, v36
ds_or_b32 v33, v34 offset:20480
v_lshl_add_u32 v29, v29, 4, v36
v_add3_u32 v33, v30, v26, -1
v_lshlrev_b32 v34, v33, v20
v_lshrrev_b32 v33, 5, v33
v_lshl_add_u32 v33, v33, 2, v36
ds_or_b32 v33, v34 offset:20480
v_lshl_add_u32 v30, v30, 4, v36
v_add3_u32 v33, v31, v27, -1
v_lshlrev_b32 v34, v33, v21
v_lshrrev_b32 v33, 5, v33
v_lshl_add_u32 v33, v33, 2, v36
ds_or_b32 v33, v34 offset:20480
v_lshl_add_u32 v31, v31, 4, v36
ds_write_b128 v35, v[28:31]
s_add_u32 s44, s44, 31
s_lshr_b32 s44, s44, 5
v_cmpx_lt_i32 vcc, 0, v32
s_cbranch_execz LE_p
ds_add_rtn_u32 v128, v128, v17
v_cmpx_lt_i32 vcc, 1, v32
ds_add_rtn_u32 v129, v129, v17
v_cmpx_lt_i32 vcc, 2, v32
ds_add_rtn_u32 v130, v130, v17
v_cmpx_lt_i32 vcc, 3, v32
ds_add_rtn_u32 v131, v131, v17
v_cmpx_lt_i32 vcc, 8, v32
s_cbranch_execz LE_p
ds_add_rtn_u32 v132, v132, v17
v_cmpx_lt_i32 vcc, 9, v32
ds_add_rtn_u32 v133, v133, v17
v_cmpx_lt_i32 vcc, 10, v32
ds_add_rtn_u32 v134, v134, v17
v_cmpx_lt_i32 vcc, 11, v32
ds_add_rtn_u32 v135, v135, v17
v_cmpx_lt_i32 vcc, 16, v32
s_cbranch_execz LE_p
ds_add_rtn_u32 v136, v136, v17
v_cmpx_lt_i32 vcc, 17, v32
ds_add_rtn_u32 v137, v137, v17
v_cmpx_lt_i32 vcc, 18, v32
ds_add_rtn_u32 v138, v138, v17
v_cmpx_lt_i32 vcc, 19, v32
ds_add_rtn_u32 v139, v139, v17
v_cmpx_lt_i32 vcc, 24, v32
s_cbranch_execz LE_p
ds_add_rtn_u32 v140, v140, v17
v_cmpx_lt_i32 vcc, 25, v32
ds_add_rtn_u32 v141, v141, v17
v_cmpx_lt_i32 vcc, 26, v32
ds_add_rtn_u32 v142, v142, v17
v_cmpx_lt_i32 vcc, 27, v32
ds_add_rtn_u32 v143, v143, v17
v_cmpx_lt_i32 vcc, 32, v32
s_cbranch_execz LE_p
ds_add_rtn_u32 v144, v144, v17
v_cmpx_lt_i32 vcc, 33, v32
ds_add_rtn_u32 v145, v145, v17
v_cmpx_lt_i32 vcc, 34, v32
ds_add_rtn_u32 v146, v146, v17
v_cmpx_lt_i32 vcc, 35, v32
ds_add_rtn_u32 v147, v147, v17
v_cmpx_lt_i32 vcc, 40, v32
s_cbranch_execz LE_p
ds_add_rtn_u32 v148, v148, v17
v_cmpx_lt_i32 vcc, 41, v32
ds_add_rtn_u32 v149, v149, v17
v_cmpx_lt_i32 vcc, 42, v32
ds_add_rtn_u32 v150, v150, v17
v_cmpx_lt_i32 vcc, 43, v32
ds_add_rtn_u32 v151, v151, v17
v_cmpx_lt_i32 vcc, 48, v32
s_cbranch_execz LE_p
ds_add_rtn_u32 v152, v152, v17
v_cmpx_lt_i32 vcc, 49, v32
ds_add_rtn_u32 v153, v153, v17
v_cmpx_lt_i32 vcc, 50, v32
ds_add_rtn_u32 v154, v154, v17
v_cmpx_lt_i32 vcc, 51, v32
ds_add_rtn_u32 v155, v155, v17
v_cmpx_lt_i32 vcc, 56, v32
s_cbranch_execz LE_p
ds_add_rtn_u32 v156, v156, v17
v_cmpx_lt_i32 vcc, 57, v32
ds_add_rtn_u32 v157, v157, v17
v_cmpx_lt_i32 vcc, 58, v32
ds_add_rtn_u32 v158, v158, v17
v_cmpx_lt_i32 vcc, 59, v32
ds_add_rtn_u32 v159, v159, v17
v_cmpx_lt_i32 vcc, 64, v32
s_cbranch_execz LE_p
ds_add_rtn_u32 v160, v160, v17
v_cmpx_lt_i32 vcc, 65, v32
ds_add_rtn_u32 v161, v161, v17
v_cmpx_lt_i32 vcc, 66, v32
ds_add_rtn_u32 v162, v162, v17
v_cmpx_lt_i32 vcc, 67, v32
ds_add_rtn_u32 v163, v163, v17
v_cmpx_lt_i32 vcc, 72, v32
s_cbranch_execz LE_p
ds_add_rtn_u32 v164, v164, v17
v_cmpx_lt_i32 vcc, 73, v32
ds_add_rtn_u32 v165, v165, v17
v_cmpx_lt_i32 vcc, 74, v32
ds_add_rtn_u32 v166, v166, v17
v_cmpx_lt_i32 vcc, 75, v32
ds_add_rtn_u32 v167, v167, v17
v_cmpx_lt_i32 vcc, 80, v32
s_cbranch_execz LE_p
ds_add_rtn_u32 v168, v168, v17
v_cmpx_lt_i32 vcc, 81, v32
ds_add_rtn_u32 v169, v169, v17
v_cmpx_lt_i32 vcc, 82, v32
ds_add_rtn_u32 v170, v170, v17
v_cmpx_lt_i32 vcc, 83, v32
ds_add_rtn_u32 v171, v171, v17
v_cmpx_lt_i32 vcc, 88, v32
s_cbranch_execz LE_p
ds_add_rtn_u32 v172, v172, v17
v_cmpx_lt_i32 vcc, 89, v32
ds_add_rtn_u32 v173, v173, v17
v_cmpx_lt_i32 vcc, 90, v32
ds_add_rtn_u32 v174, v174, v17
v_cmpx_lt_i32 vcc, 91, v32
ds_add_rtn_u32 v175, v175, v17
v_cmpx_lt_i32 vcc, 96, v32
s_cbranch_execz LE_p
ds_add_rtn_u32 v176, v176, v17
v_cmpx_lt_i32 vcc, 97, v32
ds_add_rtn_u32 v177, v177, v17
v_cmpx_lt_i32 vcc, 98, v32
ds_add_rtn_u32 v178, v178, v17
v_cmpx_lt_i32 vcc, 99, v32
ds_add_rtn_u32 v179, v179, v17
v_cmpx_lt_i32 vcc, 104, v32
s_cbranch_execz LE_p
ds_add_rtn_u32 v180, v180, v17
v_cmpx_lt_i32 vcc, 105, v32
ds_add_rtn_u32 v181, v181, v17
v_cmpx_lt_i32 vcc, 106, v32
ds_add_rtn_u32 v182, v182, v17
v_cmpx_lt_i32 vcc, 107, v32
ds_add_rtn_u32 v183, v183, v17
v_cmpx_lt_i32 vcc, 112, v32
s_cbranch_execz LE_p
ds_add_rtn_u32 v184, v184, v17
v_cmpx_lt_i32 vcc, 113, v32
ds_add_rtn_u32 v185, v185, v17
v_cmpx_lt_i32 vcc, 114, v32
ds_add_rtn_u32 v186, v186, v17
v_cmpx_lt_i32 vcc, 115, v32
ds_add_rtn_u32 v187, v187, v17
v_cmpx_lt_i32 vcc, 120, v32
s_cbranch_execz LE_p
ds_add_rtn_u32 v188, v188, v17
v_cmpx_lt_i32 vcc, 121, v32
ds_add_rtn_u32 v189, v189, v17
v_cmpx_lt_i32 vcc, 122, v32
ds_add_rtn_u32 v190, v190, v17
v_cmpx_lt_i32 vcc, 123, v32
ds_add_rtn_u32 v191, v191, v17
LE_p:
s_mov_b64 exec, -1
v_lshl_add_u32 v33, v1, 2, v36
ds_read_b32 v37, v33 offset:20480
s_waitcnt lgkmcnt(0)
v_cmpx_lt_i32 vcc, 0, v32
s_cbranch_execz LE_w
ds_write_b32 v128, v192
v_cmpx_lt_i32 vcc, 1, v32
ds_write_b32 v129, v193
v_cmpx_lt_i32 vcc, 2, v32
ds_write_b32 v130, v194
v_cmpx_lt_i32 vcc, 3, v32
ds_write_b32 v131, v195
v_cmpx_lt_i32 vcc, 8, v32
s_cbranch_execz LE_w
ds_write_b32 v132, v196
v_cmpx_lt_i32 vcc, 9, v32
ds_write_b32 v133, v197
v_cmpx_lt_i32 vcc, 10, v32
ds_write_b32 v134, v198
v_cmpx_lt_i32 vcc, 11, v32
ds_write_b32 v135, v199
v_cmpx_lt_i32 vcc, 16, v32
s_cbranch_execz LE_w
ds_write_b32 v136, v200
v_cmpx_lt_i32 vcc, 17, v32
ds_write_b32 v137, v201
v_cmpx_lt_i32 vcc, 18, v32
ds_write_b32 v138, v202
v_cmpx_lt_i32 vcc, 19, v32
ds_write_b32 v139, v203
v_cmpx_lt_i32 vcc, 24, v32
s_cbranch_execz LE_w
ds_write_b32 v140, v204
v_cmpx_lt_i32 vcc, 25, v32
ds_write_b32 v141, v205
v_cmpx_lt_i32 vcc, 26, v32
ds_write_b32 v142, v206
v_cmpx_lt_i32 vcc, 27, v32
ds_write_b32 v143, v207
v_cmpx_lt_i32 vcc, 32, v32
s_cbranch_execz LE_w
ds_write_b32 v144, v208
v_cmpx_lt_i32 vcc, 33, v32
ds_write_b32 v145, v209
v_cmpx_lt_i32 vcc, 34, v32
ds_write_b32 v146, v210
v_cmpx_lt_i32 vcc, 35, v32
ds_write_b32 v147, v211
v_cmpx_lt_i32 vcc, 40, v32
s_cbranch_execz LE_w
ds_write_b32 v148, v212
v_cmpx_lt_i32 vcc, 41, v32
ds_write_b32 v149, v213
v_cmpx_lt_i32 vcc, 42, v32
ds_write_b32 v150, v214
v_cmpx_lt_i32 vcc, 43, v32
ds_write_b32 v151, v215
v_cmpx_lt_i32 vcc, 48, v32
s_cbranch_execz LE_w
ds_write_b32 v152, v216
v_cmpx_lt_i32 vcc, 49, v32
ds_write_b32 v153, v217
v_cmpx_lt_i32 vcc, 50, v32
ds_write_b32 v154, v218
v_cmpx_lt_i32 vcc, 51, v32
ds_write_b32 v155, v219
v_cmpx_lt_i32 vcc, 56, v32
s_cbranch_execz LE_w
ds_write_b32 v156, v220
v_cmpx_lt_i32 vcc, 57, v32
ds_write_b32 v157, v221
v_cmpx_lt_i32 vcc, 58, v32
ds_write_b32 v158, v222
v_cmpx_lt_i32 vcc, 59, v32
ds_write_b32 v159, v223
v_cmpx_lt_i32 vcc, 64, v32
s_cbranch_execz LE_w
ds_write_b32 v160, v224
v_cmpx_lt_i32 vcc, 65, v32
ds_write_b32 v161, v225
v_cmpx_lt_i32 vcc, 66, v32
ds_write_b32 v162, v226
v_cmpx_lt_i32 vcc, 67, v32
ds_write_b32 v163, v227
v_cmpx_lt_i32 vcc, 72, v32
s_cbranch_execz LE_w
ds_write_b32 v164, v228
v_cmpx_lt_i32 vcc, 73, v32
ds_write_b32 v165, v229
v_cmpx_lt_i32 vcc, 74, v32
ds_write_b32 v166, v230
v_cmpx_lt_i32 vcc, 75, v32
ds_write_b32 v167, v231
v_cmpx_lt_i32 vcc, 80, v32
s_cbranch_execz LE_w
ds_write_b32 v168, v232
v_cmpx_lt_i32 vcc, 81, v32
ds_write_b32 v169, v233
v_cmpx_lt_i32 vcc, 82, v32
ds_write_b32 v170, v234
v_cmpx_lt_i32 vcc, 83, v32
ds_write_b32 v171, v235
v_cmpx_lt_i32 vcc, 88, v32
s_cbranch_execz LE_w
ds_write_b32 v172, v236
v_cmpx_lt_i32 vcc, 89, v32
ds_write_b32 v173, v237
v_cmpx_lt_i32 vcc, 90, v32
ds_write_b32 v174, v238
v_cmpx_lt_i32 vcc, 91, v32
ds_write_b32 v175, v239
v_cmpx_lt_i32 vcc, 96, v32
s_cbranch_execz LE_w
ds_write_b32 v176, v240
v_cmpx_lt_i32 vcc, 97, v32
ds_write_b32 v177, v241
v_cmpx_lt_i32 vcc, 98, v32
ds_write_b32 v178, v242
v_cmpx_lt_i32 vcc, 99, v32
ds_write_b32 v179, v243
v_cmpx_lt_i32 vcc, 104, v32
s_cbranch_execz LE_w
ds_write_b32 v180, v244
v_cmpx_lt_i32 vcc, 105, v32
ds_write_b32 v181, v245
v_cmpx_lt_i32 vcc, 106, v32
ds_write_b32 v182, v246
v_cmpx_lt_i32 vcc, 107, v32
ds_write_b32 v183, v247
v_cmpx_lt_i32 vcc, 112, v32
s_cbranch_execz LE_w
ds_write_b32 v184, v248
v_cmpx_lt_i32 vcc, 113, v32
ds_write_b32 v185, v249
v_cmpx_lt_i32 vcc, 114, v32
ds_write_b32 v186, v250
v_cmpx_lt_i32 vcc, 115, v32
ds_write_b32 v187, v251
v_cmpx_lt_i32 vcc, 120, v32
s_cbranch_execz LE_w
ds_write_b32 v188, v252
v_cmpx_lt_i32 vcc, 121, v32
ds_write_b32 v189, v253
v_cmpx_lt_i32 vcc, 122, v32
ds_write_b32 v190, v254
v_cmpx_lt_i32 vcc, 123, v32
ds_write_b32 v191, v255
LE_w:
s_mov_b64 exec, -1
s_waitcnt vmcnt(0)
s_mov_b32 s51, 0
v_lshlrev_b32 v80, 16, v76
v_lshlrev_b32 v81, 16, v77
v_lshlrev_b32 v82, 16, v78
v_mov_b32 v34, v38
ds_read2_b32 v[52:53], v34 offset0:0 offset1:4
ds_read2_b32 v[54:55], v34 offset0:8 offset1:12
s_waitcnt lgkmcnt(0)
ds_read2_b32 v[56:57], v34 offset0:16 offset1:20
ds_read2_b32 v[58:59], v34 offset0:24 offset1:28
v_mad_u32_u16 v60, v52, s49, v2
v_mad_u32_u16 v61, v53, s49, v2
v_mad_u32_u16 v62, v54, s49, v2
v_mad_u32_u16 v63, v55, s49, v2
buffer_load_dwordx4 a[0:3], v60, s[16:19], 0 offen
buffer_load_dwordx4 a[4:7], v60, s[16:19], 0 offen offset:256
buffer_load_dwordx4 a[8:11], v61, s[16:19], 0 offen
buffer_load_dwordx4 a[12:15], v61, s[16:19], 0 offen offset:256
buffer_load_dwordx4 a[16:19], v62, s[16:19], 0 offen
buffer_load_dwordx4 a[20:23], v62, s[16:19], 0 offen offset:256
buffer_load_dwordx4 a[24:27], v63, s[16:19], 0 offen
buffer_load_dwordx4 a[28:31], v63, s[16:19], 0 offen offset:256
s_waitcnt lgkmcnt(0)
ds_read2_b32 v[52:53], v34 offset0:32 offset1:36
ds_read2_b32 v[54:55], v34 offset0:40 offset1:44
v_mad_u32_u16 v60, v56, s49, v2
v_mad_u32_u16 v61, v57, s49, v2
v_mad_u32_u16 v62, v58, s49, v2
v_mad_u32_u16 v63, v59, s49, v2
buffer_load_dwordx4 a[32:35], v60, s[16:19], 0 offen
buffer_load_dwordx4 a[36:39], v60, s[16:19], 0 offen offset:256
buffer_load_dwordx4 a[40:43], v61, s[16:19], 0 offen
buffer_load_dwordx4 a[44:47], v61, s[16:19], 0 offen offset:256
buffer_load_dwordx4 a[48:51], v62, s[16:19], 0 offen
buffer_load_dwordx4 a[52:55], v62, s[16:19], 0 offen offset:256
buffer_load_dwordx4 a[56:59], v63, s[16:19], 0 offen
buffer_load_dwordx4 a[60:63], v63, s[16:19], 0 offen offset:256
s_waitcnt lgkmcnt(0)
ds_read2_b32 v[56:57], v34 offset0:48 offset1:52
ds_read2_b32 v[58:59], v34 offset0:56 offset1:60
v_mad_u32_u16 v60, v52, s49, v2
v_mad_u32_u16 v61, v53, s49, v2
v_mad_u32_u16 v62, v54, s49, v2
v_mad_u32_u16 v63, v55, s49, v2
buffer_load_dwordx4 a[64:67], v60, s[16:19], 0 offen
buffer_load_dwordx4 a[68:71], v60, s[16:19], 0 offen offset:256
buffer_load_dwordx4 a[72:75], v61, s[16:19], 0 offen
buffer_load_dwordx4 a[76:79], v61, s[16:19], 0 offen offset:256
buffer_load_dwordx4 a[80:83], v62, s[16:19], 0 offen
buffer_load_dwordx4 a[84:87], v62, s[16:19], 0 offen offset:256
buffer_load_dwordx4 a[88:91], v63, s[16:19], 0 offen
buffer_load_dwordx4 a[92:95], v63, s[16:19], 0 offen offset:256
s_waitcnt lgkmcnt(0)
ds_read2_b32 v[52:53], v34 offset0:64 offset1:68
ds_read2_b32 v[54:55], v34 offset0:72 offset1:76
v_mad_u32_u16 v60, v56, s49, v2
v_mad_u32_u16 v61, v57, s49, v2
v_mad_u32_u16 v62, v58, s49, v2
v_mad_u32_u16 v63, v59, s49, v2
buffer_load_dwordx4 a[96:99], v60, s[16:19], 0 offen
buffer_load_dwordx4 a[100:103], v60, s[16:19], 0 offen offset:256
buffer_load_dwordx4 a[104:107], v61, s[16:19], 0 offen
buffer_load_dwordx4 a[108:111], v61, s[16:19], 0 offen offset:256
buffer_load_dwordx4 a[112:115], v62, s[16:19], 0 offen
buffer_load_dwordx4 a[116:119], v62, s[16:19], 0 offen offset:256
buffer_load_dwordx4 a[120:123], v63, s[16:19], 0 offen
buffer_load_dwordx4 a[124:127], v63, s[16:19], 0 offen offset:256
s_waitcnt lgkmcnt(0)
ds_read2_b32 v[56:57], v34 offset0:80 offset1:84
ds_read2_b32 v[58:59], v34 offset0:88 offset1:92
v_mad_u32_u16 v60, v52, s49, v2
v_mad_u32_u16 v61, v53, s49, v2
v_mad_u32_u16 v62, v54, s49, v2
v_mad_u32_u16 v63, v55, s49, v2
buffer_load_dwordx4 a[128:131], v60, s[16:19], 0 offen
buffer_load_dwordx4 a[132:135], v60, s[16:19], 0 offen offset:256
buffer_load_dwordx4 a[136:139], v61, s[16:19], 0 offen
buffer_load_dwordx4 a[140:143], v61, s[16:19], 0 offen offset:256
buffer_load_dwordx4 a[144:147], v62, s[16:19], 0 offen
buffer_load_dwordx4 a[148:151], v62, s[16:19], 0 offen offset:256
buffer_load_dwordx4 a[152:155], v63, s[16:19], 0 offen
buffer_load_dwordx4 a[156:159], v63, s[16:19], 0 offen offset:256
s_waitcnt lgkmcnt(0)
ds_read2_b32 v[52:53], v34 offset0:96 offset1:100
ds_read2_b32 v[54:55], v34 offset0:104 offset1:108
v_mad_u32_u16 v60, v56, s49, v2
v_mad_u32_u16 v61, v57, s49, v2
v_mad_u32_u16 v62, v58, s49, v2
v_mad_u32_u16 v63, v59, s49, v2
buffer_load_dwordx4 a[160:163], v60, s[16:19], 0 offen
buffer_load_dwordx4 a[164:167], v60, s[16:19], 0 offen offset:256
buffer_load_dwordx4 a[168:171], v61, s[16:19], 0 offen
buffer_load_dwordx4 a[172:175], v61, s[16:19], 0 offen offset:256
buffer_load_dwordx4 a[176:179], v62, s[16:19], 0 offen
buffer_load_dwordx4 a[180:183], v62, s[16:19], 0 offen offset:256
buffer_load_dwordx4 a[184:187], v63, s[16:19], 0 offen
buffer_load_dwordx4 a[188:191], v63, s[16:19], 0 offen offset:256
s_waitcnt lgkmcnt(0)
ds_read2_b32 v[56:57], v34 offset0:112 offset1:116
ds_read2_b32 v[58:59], v34 offset0:120 offset1:124
v_mad_u32_u16 v60, v52, s49, v2
v_mad_u32_u16 v61, v53, s49, v2
v_mad_u32_u16 v62, v54, s49, v2
v_mad_u32_u16 v63, v55, s49, v2
buffer_load_dwordx4 a[192:195], v60, s[16:19], 0 offen
buffer_load_dwordx4 a[196:199], v60, s[16:19], 0 offen offset:256
buffer_load_dwordx4 a[200:203], v61, s[16:19], 0 offen
buffer_load_dwordx4 a[204:207], v61, s[16:19], 0 offen offset:256
buffer_load_dwordx4 a[208:211], v62, s[16:19], 0 offen
buffer_load_dwordx4 a[212:215], v62, s[16:19], 0 offen offset:256
buffer_load_dwordx4 a[216:219], v63, s[16:19], 0 offen
buffer_load_dwordx4 a[220:223], v63, s[16:19], 0 offen offset:256
s_waitcnt lgkmcnt(0)
ds_read2_b32 v[52:53], v34 offset0:128 offset1:132
ds_read2_b32 v[54:55], v34 offset0:136 offset1:140
v_mad_u32_u16 v60, v56, s49, v2
v_mad_u32_u16 v61, v57, s49, v2
v_mad_u32_u16 v62, v58, s49, v2
v_mad_u32_u16 v63, v59, s49, v2
buffer_load_dwordx4 a[224:227], v60, s[16:19], 0 offen
buffer_load_dwordx4 a[228:231], v60, s[16:19], 0 offen offset:256
buffer_load_dwordx4 a[232:235], v61, s[16:19], 0 offen
buffer_load_dwordx4 a[236:239], v61, s[16:19], 0 offen offset:256
buffer_load_dwordx4 a[240:243], v62, s[16:19], 0 offen
buffer_load_dwordx4 a[244:247], v62, s[16:19], 0 offen offset:256
buffer_load_dwordx4 a[248:251], v63, s[16:19], 0 offen
buffer_load_dwordx4 a[252:255], v63, s[16:19], 0 offen offset:256
v_add_u32 v34, 512, v34
s_mov_b32 s45, 0
s_lshl_b32 s47, s58, 9
LE_loop:
v_readlane_b32 s46, v37, s45
s_add_u32 s45, s45, 1
s_waitcnt vmcnt(56)
v_mfma_f32_16x16x32_bf16 v[48:51], a[0:3], v[40:43], v[48:51]
v_mfma_f32_16x16x32_bf16 v[48:51], a[4:7], v[44:47], v[48:51]
s_bitcmp1_b32 s46, 0
s_cbranch_scc0 LE_nf0
v_readlane_b32 s57, v80, s51
s_add_u32 s51, s51, 1
s_and_b32 s51, s51, 63
s_cbranch_scc1 LE_dg0
v_mov_b32 v80, v81
v_mov_b32 v81, v82
LE_dg0:
s_nop 3
v_mul_f32 v48, s57, v48
v_mul_f32 v49, s57, v49
v_mul_f32 v50, s57, v50
v_mul_f32 v51, s57, v51
s_cmp_eq_u32 s42, 0
s_cbranch_scc1 LE_fl0
buffer_load_dwordx2 v[66:67], v39, s[20:23], s47 offen sc1
s_waitcnt vmcnt(0)
v_lshlrev_b32 v64, 16, v66
v_and_b32 v65, 0xffff0000, v66
v_add_f32 v48, v48, v64
v_add_f32 v49, v49, v65
v_lshlrev_b32 v64, 16, v67
v_and_b32 v65, 0xffff0000, v67
v_add_f32 v50, v50, v64
v_add_f32 v51, v51, v65
LE_fl0:
v_cvt_pk_bf16_f32 v64, v48, v49
v_cvt_pk_bf16_f32 v65, v50, v51
v_mov_b32 v48, 0
v_mov_b32 v49, 0
v_mov_b32 v50, 0
v_mov_b32 v51, 0
buffer_store_dwordx2 v[64:65], v39, s[20:23], s47 offen sc1
s_add_u32 s47, s47, 512
LE_nf0:
v_mfma_f32_16x16x32_bf16 v[48:51], a[8:11], v[40:43], v[48:51]
v_mfma_f32_16x16x32_bf16 v[48:51], a[12:15], v[44:47], v[48:51]
s_bitcmp1_b32 s46, 1
s_cbranch_scc0 LE_nf1
v_readlane_b32 s57, v80, s51
s_add_u32 s51, s51, 1
s_and_b32 s51, s51, 63
s_cbranch_scc1 LE_dg1
v_mov_b32 v80, v81
v_mov_b32 v81, v82
LE_dg1:
s_nop 3
v_mul_f32 v48, s57, v48
v_mul_f32 v49, s57, v49
v_mul_f32 v50, s57, v50
v_mul_f32 v51, s57, v51
s_cmp_eq_u32 s42, 0
s_cbranch_scc1 LE_fl1
buffer_load_dwordx2 v[66:67], v39, s[20:23], s47 offen sc1
s_waitcnt vmcnt(0)
v_lshlrev_b32 v64, 16, v66
v_and_b32 v65, 0xffff0000, v66
v_add_f32 v48, v48, v64
v_add_f32 v49, v49, v65
v_lshlrev_b32 v64, 16, v67
v_and_b32 v65, 0xffff0000, v67
v_add_f32 v50, v50, v64
v_add_f32 v51, v51, v65
LE_fl1:
v_cvt_pk_bf16_f32 v64, v48, v49
v_cvt_pk_bf16_f32 v65, v50, v51
v_mov_b32 v48, 0
v_mov_b32 v49, 0
v_mov_b32 v50, 0
v_mov_b32 v51, 0
buffer_store_dwordx2 v[64:65], v39, s[20:23], s47 offen sc1
s_add_u32 s47, s47, 512
LE_nf1:
v_mfma_f32_16x16x32_bf16 v[48:51], a[16:19], v[40:43], v[48:51]
v_mfma_f32_16x16x32_bf16 v[48:51], a[20:23], v[44:47], v[48:51]
s_bitcmp1_b32 s46, 2
s_cbranch_scc0 LE_nf2
v_readlane_b32 s57, v80, s51
s_add_u32 s51, s51, 1
s_and_b32 s51, s51, 63
s_cbranch_scc1 LE_dg2
v_mov_b32 v80, v81
v_mov_b32 v81, v82
LE_dg2:
s_nop 3
v_mul_f32 v48, s57, v48
v_mul_f32 v49, s57, v49
v_mul_f32 v50, s57, v50
v_mul_f32 v51, s57, v51
s_cmp_eq_u32 s42, 0
s_cbranch_scc1 LE_fl2
buffer_load_dwordx2 v[66:67], v39, s[20:23], s47 offen sc1
s_waitcnt vmcnt(0)
v_lshlrev_b32 v64, 16, v66
v_and_b32 v65, 0xffff0000, v66
v_add_f32 v48, v48, v64
v_add_f32 v49, v49, v65
v_lshlrev_b32 v64, 16, v67
v_and_b32 v65, 0xffff0000, v67
v_add_f32 v50, v50, v64
v_add_f32 v51, v51, v65
LE_fl2:
v_cvt_pk_bf16_f32 v64, v48, v49
v_cvt_pk_bf16_f32 v65, v50, v51
v_mov_b32 v48, 0
v_mov_b32 v49, 0
v_mov_b32 v50, 0
v_mov_b32 v51, 0
buffer_store_dwordx2 v[64:65], v39, s[20:23], s47 offen sc1
s_add_u32 s47, s47, 512
LE_nf2:
v_mfma_f32_16x16x32_bf16 v[48:51], a[24:27], v[40:43], v[48:51]
v_mfma_f32_16x16x32_bf16 v[48:51], a[28:31], v[44:47], v[48:51]
s_bitcmp1_b32 s46, 3
s_cbranch_scc0 LE_nf3
v_readlane_b32 s57, v80, s51
s_add_u32 s51, s51, 1
s_and_b32 s51, s51, 63
s_cbranch_scc1 LE_dg3
v_mov_b32 v80, v81
v_mov_b32 v81, v82
LE_dg3:
s_nop 3
v_mul_f32 v48, s57, v48
v_mul_f32 v49, s57, v49
v_mul_f32 v50, s57, v50
v_mul_f32 v51, s57, v51
s_cmp_eq_u32 s42, 0
s_cbranch_scc1 LE_fl3
buffer_load_dwordx2 v[66:67], v39, s[20:23], s47 offen sc1
s_waitcnt vmcnt(0)
v_lshlrev_b32 v64, 16, v66
v_and_b32 v65, 0xffff0000, v66
v_add_f32 v48, v48, v64
v_add_f32 v49, v49, v65
v_lshlrev_b32 v64, 16, v67
v_and_b32 v65, 0xffff0000, v67
v_add_f32 v50, v50, v64
v_add_f32 v51, v51, v65
LE_fl3:
v_cvt_pk_bf16_f32 v64, v48, v49
v_cvt_pk_bf16_f32 v65, v50, v51
v_mov_b32 v48, 0
v_mov_b32 v49, 0
v_mov_b32 v50, 0
v_mov_b32 v51, 0
buffer_store_dwordx2 v[64:65], v39, s[20:23], s47 offen sc1
s_add_u32 s47, s47, 512
LE_nf3:
s_waitcnt lgkmcnt(0)
ds_read2_b32 v[56:57], v34 offset0:16 offset1:20
ds_read2_b32 v[58:59], v34 offset0:24 offset1:28
v_mad_u32_u16 v60, v52, s49, v2
v_mad_u32_u16 v61, v53, s49, v2
v_mad_u32_u16 v62, v54, s49, v2
v_mad_u32_u16 v63, v55, s49, v2
buffer_load_dwordx4 a[0:3], v60, s[16:19], 0 offen
buffer_load_dwordx4 a[4:7], v60, s[16:19], 0 offen offset:256
buffer_load_dwordx4 a[8:11], v61, s[16:19], 0 offen
buffer_load_dwordx4 a[12:15], v61, s[16:19], 0 offen offset:256
buffer_load_dwordx4 a[16:19], v62, s[16:19], 0 offen
buffer_load_dwordx4 a[20:23], v62, s[16:19], 0 offen offset:256
buffer_load_dwordx4 a[24:27], v63, s[16:19], 0 offen
buffer_load_dwordx4 a[28:31], v63, s[16:19], 0 offen offset:256
s_waitcnt vmcnt(56)
v_mfma_f32_16x16x32_bf16 v[48:51], a[32:35], v[40:43], v[48:51]
v_mfma_f32_16x16x32_bf16 v[48:51], a[36:39], v[44:47], v[48:51]
s_bitcmp1_b32 s46, 4
s_cbranch_scc0 LE_nf4
v_readlane_b32 s57, v80, s51
s_add_u32 s51, s51, 1
s_and_b32 s51, s51, 63
s_cbranch_scc1 LE_dg4
v_mov_b32 v80, v81
v_mov_b32 v81, v82
LE_dg4:
s_nop 3
v_mul_f32 v48, s57, v48
v_mul_f32 v49, s57, v49
v_mul_f32 v50, s57, v50
v_mul_f32 v51, s57, v51
s_cmp_eq_u32 s42, 0
s_cbranch_scc1 LE_fl4
buffer_load_dwordx2 v[66:67], v39, s[20:23], s47 offen sc1
s_waitcnt vmcnt(0)
v_lshlrev_b32 v64, 16, v66
v_and_b32 v65, 0xffff0000, v66
v_add_f32 v48, v48, v64
v_add_f32 v49, v49, v65
v_lshlrev_b32 v64, 16, v67
v_and_b32 v65, 0xffff0000, v67
v_add_f32 v50, v50, v64
v_add_f32 v51, v51, v65
LE_fl4:
v_cvt_pk_bf16_f32 v64, v48, v49
v_cvt_pk_bf16_f32 v65, v50, v51
v_mov_b32 v48, 0
v_mov_b32 v49, 0
v_mov_b32 v50, 0
v_mov_b32 v51, 0
buffer_store_dwordx2 v[64:65], v39, s[20:23], s47 offen sc1
s_add_u32 s47, s47, 512
LE_nf4:
v_mfma_f32_16x16x32_bf16 v[48:51], a[40:43], v[40:43], v[48:51]
v_mfma_f32_16x16x32_bf16 v[48:51], a[44:47], v[44:47], v[48:51]
s_bitcmp1_b32 s46, 5
s_cbranch_scc0 LE_nf5
v_readlane_b32 s57, v80, s51
s_add_u32 s51, s51, 1
s_and_b32 s51, s51, 63
s_cbranch_scc1 LE_dg5
v_mov_b32 v80, v81
v_mov_b32 v81, v82
LE_dg5:
s_nop 3
v_mul_f32 v48, s57, v48
v_mul_f32 v49, s57, v49
v_mul_f32 v50, s57, v50
v_mul_f32 v51, s57, v51
s_cmp_eq_u32 s42, 0
s_cbranch_scc1 LE_fl5
buffer_load_dwordx2 v[66:67], v39, s[20:23], s47 offen sc1
s_waitcnt vmcnt(0)
v_lshlrev_b32 v64, 16, v66
v_and_b32 v65, 0xffff0000, v66
v_add_f32 v48, v48, v64
v_add_f32 v49, v49, v65
v_lshlrev_b32 v64, 16, v67
v_and_b32 v65, 0xffff0000, v67
v_add_f32 v50, v50, v64
v_add_f32 v51, v51, v65
LE_fl5:
v_cvt_pk_bf16_f32 v64, v48, v49
v_cvt_pk_bf16_f32 v65, v50, v51
v_mov_b32 v48, 0
v_mov_b32 v49, 0
v_mov_b32 v50, 0
v_mov_b32 v51, 0
buffer_store_dwordx2 v[64:65], v39, s[20:23], s47 offen sc1
s_add_u32 s47, s47, 512
LE_nf5:
v_mfma_f32_16x16x32_bf16 v[48:51], a[48:51], v[40:43], v[48:51]
v_mfma_f32_16x16x32_bf16 v[48:51], a[52:55], v[44:47], v[48:51]
s_bitcmp1_b32 s46, 6
s_cbranch_scc0 LE_nf6
v_readlane_b32 s57, v80, s51
s_add_u32 s51, s51, 1
s_and_b32 s51, s51, 63
s_cbranch_scc1 LE_dg6
v_mov_b32 v80, v81
v_mov_b32 v81, v82
LE_dg6:
s_nop 3
v_mul_f32 v48, s57, v48
v_mul_f32 v49, s57, v49
v_mul_f32 v50, s57, v50
v_mul_f32 v51, s57, v51
s_cmp_eq_u32 s42, 0
s_cbranch_scc1 LE_fl6
buffer_load_dwordx2 v[66:67], v39, s[20:23], s47 offen sc1
s_waitcnt vmcnt(0)
v_lshlrev_b32 v64, 16, v66
v_and_b32 v65, 0xffff0000, v66
v_add_f32 v48, v48, v64
v_add_f32 v49, v49, v65
v_lshlrev_b32 v64, 16, v67
v_and_b32 v65, 0xffff0000, v67
v_add_f32 v50, v50, v64
v_add_f32 v51, v51, v65
LE_fl6:
v_cvt_pk_bf16_f32 v64, v48, v49
v_cvt_pk_bf16_f32 v65, v50, v51
v_mov_b32 v48, 0
v_mov_b32 v49, 0
v_mov_b32 v50, 0
v_mov_b32 v51, 0
buffer_store_dwordx2 v[64:65], v39, s[20:23], s47 offen sc1
s_add_u32 s47, s47, 512
LE_nf6:
v_mfma_f32_16x16x32_bf16 v[48:51], a[56:59], v[40:43], v[48:51]
v_mfma_f32_16x16x32_bf16 v[48:51], a[60:63], v[44:47], v[48:51]
s_bitcmp1_b32 s46, 7
s_cbranch_scc0 LE_nf7
v_readlane_b32 s57, v80, s51
s_add_u32 s51, s51, 1
s_and_b32 s51, s51, 63
s_cbranch_scc1 LE_dg7
v_mov_b32 v80, v81
v_mov_b32 v81, v82
LE_dg7:
s_nop 3
v_mul_f32 v48, s57, v48
v_mul_f32 v49, s57, v49
v_mul_f32 v50, s57, v50
v_mul_f32 v51, s57, v51
s_cmp_eq_u32 s42, 0
s_cbranch_scc1 LE_fl7
buffer_load_dwordx2 v[66:67], v39, s[20:23], s47 offen sc1
s_waitcnt vmcnt(0)
v_lshlrev_b32 v64, 16, v66
v_and_b32 v65, 0xffff0000, v66
v_add_f32 v48, v48, v64
v_add_f32 v49, v49, v65
v_lshlrev_b32 v64, 16, v67
v_and_b32 v65, 0xffff0000, v67
v_add_f32 v50, v50, v64
v_add_f32 v51, v51, v65
LE_fl7:
v_cvt_pk_bf16_f32 v64, v48, v49
v_cvt_pk_bf16_f32 v65, v50, v51
v_mov_b32 v48, 0
v_mov_b32 v49, 0
v_mov_b32 v50, 0
v_mov_b32 v51, 0
buffer_store_dwordx2 v[64:65], v39, s[20:23], s47 offen sc1
s_add_u32 s47, s47, 512
LE_nf7:
s_waitcnt lgkmcnt(0)
ds_read2_b32 v[52:53], v34 offset0:32 offset1:36
ds_read2_b32 v[54:55], v34 offset0:40 offset1:44
v_mad_u32_u16 v60, v56, s49, v2
v_mad_u32_u16 v61, v57, s49, v2
v_mad_u32_u16 v62, v58, s49, v2
v_mad_u32_u16 v63, v59, s49, v2
buffer_load_dwordx4 a[32:35], v60, s[16:19], 0 offen
buffer_load_dwordx4 a[36:39], v60, s[16:19], 0 offen offset:256
buffer_load_dwordx4 a[40:43], v61, s[16:19], 0 offen
buffer_load_dwordx4 a[44:47], v61, s[16:19], 0 offen offset:256
buffer_load_dwordx4 a[48:51], v62, s[16:19], 0 offen
buffer_load_dwordx4 a[52:55], v62, s[16:19], 0 offen offset:256
buffer_load_dwordx4 a[56:59], v63, s[16:19], 0 offen
buffer_load_dwordx4 a[60:63], v63, s[16:19], 0 offen offset:256
s_waitcnt vmcnt(56)
v_mfma_f32_16x16x32_bf16 v[48:51], a[64:67], v[40:43], v[48:51]
v_mfma_f32_16x16x32_bf16 v[48:51], a[68:71], v[44:47], v[48:51]
s_bitcmp1_b32 s46, 8
s_cbranch_scc0 LE_nf8
v_readlane_b32 s57, v80, s51
s_add_u32 s51, s51, 1
s_and_b32 s51, s51, 63
s_cbranch_scc1 LE_dg8
v_mov_b32 v80, v81
v_mov_b32 v81, v82
LE_dg8:
s_nop 3
v_mul_f32 v48, s57, v48
v_mul_f32 v49, s57, v49
v_mul_f32 v50, s57, v50
v_mul_f32 v51, s57, v51
s_cmp_eq_u32 s42, 0
s_cbranch_scc1 LE_fl8
buffer_load_dwordx2 v[66:67], v39, s[20:23], s47 offen sc1
s_waitcnt vmcnt(0)
v_lshlrev_b32 v64, 16, v66
v_and_b32 v65, 0xffff0000, v66
v_add_f32 v48, v48, v64
v_add_f32 v49, v49, v65
v_lshlrev_b32 v64, 16, v67
v_and_b32 v65, 0xffff0000, v67
v_add_f32 v50, v50, v64
v_add_f32 v51, v51, v65
LE_fl8:
v_cvt_pk_bf16_f32 v64, v48, v49
v_cvt_pk_bf16_f32 v65, v50, v51
v_mov_b32 v48, 0
v_mov_b32 v49, 0
v_mov_b32 v50, 0
v_mov_b32 v51, 0
buffer_store_dwordx2 v[64:65], v39, s[20:23], s47 offen sc1
s_add_u32 s47, s47, 512
LE_nf8:
v_mfma_f32_16x16x32_bf16 v[48:51], a[72:75], v[40:43], v[48:51]
v_mfma_f32_16x16x32_bf16 v[48:51], a[76:79], v[44:47], v[48:51]
s_bitcmp1_b32 s46, 9
s_cbranch_scc0 LE_nf9
v_readlane_b32 s57, v80, s51
s_add_u32 s51, s51, 1
s_and_b32 s51, s51, 63
s_cbranch_scc1 LE_dg9
v_mov_b32 v80, v81
v_mov_b32 v81, v82
LE_dg9:
s_nop 3
v_mul_f32 v48, s57, v48
v_mul_f32 v49, s57, v49
v_mul_f32 v50, s57, v50
v_mul_f32 v51, s57, v51
s_cmp_eq_u32 s42, 0
s_cbranch_scc1 LE_fl9
buffer_load_dwordx2 v[66:67], v39, s[20:23], s47 offen sc1
s_waitcnt vmcnt(0)
v_lshlrev_b32 v64, 16, v66
v_and_b32 v65, 0xffff0000, v66
v_add_f32 v48, v48, v64
v_add_f32 v49, v49, v65
v_lshlrev_b32 v64, 16, v67
v_and_b32 v65, 0xffff0000, v67
v_add_f32 v50, v50, v64
v_add_f32 v51, v51, v65
LE_fl9:
v_cvt_pk_bf16_f32 v64, v48, v49
v_cvt_pk_bf16_f32 v65, v50, v51
v_mov_b32 v48, 0
v_mov_b32 v49, 0
v_mov_b32 v50, 0
v_mov_b32 v51, 0
buffer_store_dwordx2 v[64:65], v39, s[20:23], s47 offen sc1
s_add_u32 s47, s47, 512
LE_nf9:
v_mfma_f32_16x16x32_bf16 v[48:51], a[80:83], v[40:43], v[48:51]
v_mfma_f32_16x16x32_bf16 v[48:51], a[84:87], v[44:47], v[48:51]
s_bitcmp1_b32 s46, 10
s_cbranch_scc0 LE_nf10
v_readlane_b32 s57, v80, s51
s_add_u32 s51, s51, 1
s_and_b32 s51, s51, 63
s_cbranch_scc1 LE_dg10
v_mov_b32 v80, v81
v_mov_b32 v81, v82
LE_dg10:
s_nop 3
v_mul_f32 v48, s57, v48
v_mul_f32 v49, s57, v49
v_mul_f32 v50, s57, v50
v_mul_f32 v51, s57, v51
s_cmp_eq_u32 s42, 0
s_cbranch_scc1 LE_fl10
buffer_load_dwordx2 v[66:67], v39, s[20:23], s47 offen sc1
s_waitcnt vmcnt(0)
v_lshlrev_b32 v64, 16, v66
v_and_b32 v65, 0xffff0000, v66
v_add_f32 v48, v48, v64
v_add_f32 v49, v49, v65
v_lshlrev_b32 v64, 16, v67
v_and_b32 v65, 0xffff0000, v67
v_add_f32 v50, v50, v64
v_add_f32 v51, v51, v65
LE_fl10:
v_cvt_pk_bf16_f32 v64, v48, v49
v_cvt_pk_bf16_f32 v65, v50, v51
v_mov_b32 v48, 0
v_mov_b32 v49, 0
v_mov_b32 v50, 0
v_mov_b32 v51, 0
buffer_store_dwordx2 v[64:65], v39, s[20:23], s47 offen sc1
s_add_u32 s47, s47, 512
LE_nf10:
v_mfma_f32_16x16x32_bf16 v[48:51], a[88:91], v[40:43], v[48:51]
v_mfma_f32_16x16x32_bf16 v[48:51], a[92:95], v[44:47], v[48:51]
s_bitcmp1_b32 s46, 11
s_cbranch_scc0 LE_nf11
v_readlane_b32 s57, v80, s51
s_add_u32 s51, s51, 1
s_and_b32 s51, s51, 63
s_cbranch_scc1 LE_dg11
v_mov_b32 v80, v81
v_mov_b32 v81, v82
LE_dg11:
s_nop 3
v_mul_f32 v48, s57, v48
v_mul_f32 v49, s57, v49
v_mul_f32 v50, s57, v50
v_mul_f32 v51, s57, v51
s_cmp_eq_u32 s42, 0
s_cbranch_scc1 LE_fl11
buffer_load_dwordx2 v[66:67], v39, s[20:23], s47 offen sc1
s_waitcnt vmcnt(0)
v_lshlrev_b32 v64, 16, v66
v_and_b32 v65, 0xffff0000, v66
v_add_f32 v48, v48, v64
v_add_f32 v49, v49, v65
v_lshlrev_b32 v64, 16, v67
v_and_b32 v65, 0xffff0000, v67
v_add_f32 v50, v50, v64
v_add_f32 v51, v51, v65
LE_fl11:
v_cvt_pk_bf16_f32 v64, v48, v49
v_cvt_pk_bf16_f32 v65, v50, v51
v_mov_b32 v48, 0
v_mov_b32 v49, 0
v_mov_b32 v50, 0
v_mov_b32 v51, 0
buffer_store_dwordx2 v[64:65], v39, s[20:23], s47 offen sc1
s_add_u32 s47, s47, 512
LE_nf11:
s_waitcnt lgkmcnt(0)
ds_read2_b32 v[56:57], v34 offset0:48 offset1:52
ds_read2_b32 v[58:59], v34 offset0:56 offset1:60
v_mad_u32_u16 v60, v52, s49, v2
v_mad_u32_u16 v61, v53, s49, v2
v_mad_u32_u16 v62, v54, s49, v2
v_mad_u32_u16 v63, v55, s49, v2
buffer_load_dwordx4 a[64:67], v60, s[16:19], 0 offen
buffer_load_dwordx4 a[68:71], v60, s[16:19], 0 offen offset:256
buffer_load_dwordx4 a[72:75], v61, s[16:19], 0 offen
buffer_load_dwordx4 a[76:79], v61, s[16:19], 0 offen offset:256
buffer_load_dwordx4 a[80:83], v62, s[16:19], 0 offen
buffer_load_dwordx4 a[84:87], v62, s[16:19], 0 offen offset:256
buffer_load_dwordx4 a[88:91], v63, s[16:19], 0 offen
buffer_load_dwordx4 a[92:95], v63, s[16:19], 0 offen offset:256
s_waitcnt vmcnt(56)
v_mfma_f32_16x16x32_bf16 v[48:51], a[96:99], v[40:43], v[48:51]
v_mfma_f32_16x16x32_bf16 v[48:51], a[100:103], v[44:47], v[48:51]
s_bitcmp1_b32 s46, 12
s_cbranch_scc0 LE_nf12
v_readlane_b32 s57, v80, s51
s_add_u32 s51, s51, 1
s_and_b32 s51, s51, 63
s_cbranch_scc1 LE_dg12
v_mov_b32 v80, v81
v_mov_b32 v81, v82
LE_dg12:
s_nop 3
v_mul_f32 v48, s57, v48
v_mul_f32 v49, s57, v49
v_mul_f32 v50, s57, v50
v_mul_f32 v51, s57, v51
s_cmp_eq_u32 s42, 0
s_cbranch_scc1 LE_fl12
buffer_load_dwordx2 v[66:67], v39, s[20:23], s47 offen sc1
s_waitcnt vmcnt(0)
v_lshlrev_b32 v64, 16, v66
v_and_b32 v65, 0xffff0000, v66
v_add_f32 v48, v48, v64
v_add_f32 v49, v49, v65
v_lshlrev_b32 v64, 16, v67
v_and_b32 v65, 0xffff0000, v67
v_add_f32 v50, v50, v64
v_add_f32 v51, v51, v65
LE_fl12:
v_cvt_pk_bf16_f32 v64, v48, v49
v_cvt_pk_bf16_f32 v65, v50, v51
v_mov_b32 v48, 0
v_mov_b32 v49, 0
v_mov_b32 v50, 0
v_mov_b32 v51, 0
buffer_store_dwordx2 v[64:65], v39, s[20:23], s47 offen sc1
s_add_u32 s47, s47, 512
LE_nf12:
v_mfma_f32_16x16x32_bf16 v[48:51], a[104:107], v[40:43], v[48:51]
v_mfma_f32_16x16x32_bf16 v[48:51], a[108:111], v[44:47], v[48:51]
s_bitcmp1_b32 s46, 13
s_cbranch_scc0 LE_nf13
v_readlane_b32 s57, v80, s51
s_add_u32 s51, s51, 1
s_and_b32 s51, s51, 63
s_cbranch_scc1 LE_dg13
v_mov_b32 v80, v81
v_mov_b32 v81, v82
LE_dg13:
s_nop 3
v_mul_f32 v48, s57, v48
v_mul_f32 v49, s57, v49
v_mul_f32 v50, s57, v50
v_mul_f32 v51, s57, v51
s_cmp_eq_u32 s42, 0
s_cbranch_scc1 LE_fl13
buffer_load_dwordx2 v[66:67], v39, s[20:23], s47 offen sc1
s_waitcnt vmcnt(0)
v_lshlrev_b32 v64, 16, v66
v_and_b32 v65, 0xffff0000, v66
v_add_f32 v48, v48, v64
v_add_f32 v49, v49, v65
v_lshlrev_b32 v64, 16, v67
v_and_b32 v65, 0xffff0000, v67
v_add_f32 v50, v50, v64
v_add_f32 v51, v51, v65
LE_fl13:
v_cvt_pk_bf16_f32 v64, v48, v49
v_cvt_pk_bf16_f32 v65, v50, v51
v_mov_b32 v48, 0
v_mov_b32 v49, 0
v_mov_b32 v50, 0
v_mov_b32 v51, 0
buffer_store_dwordx2 v[64:65], v39, s[20:23], s47 offen sc1
s_add_u32 s47, s47, 512
LE_nf13:
v_mfma_f32_16x16x32_bf16 v[48:51], a[112:115], v[40:43], v[48:51]
v_mfma_f32_16x16x32_bf16 v[48:51], a[116:119], v[44:47], v[48:51]
s_bitcmp1_b32 s46, 14
s_cbranch_scc0 LE_nf14
v_readlane_b32 s57, v80, s51
s_add_u32 s51, s51, 1
s_and_b32 s51, s51, 63
s_cbranch_scc1 LE_dg14
v_mov_b32 v80, v81
v_mov_b32 v81, v82
LE_dg14:
s_nop 3
v_mul_f32 v48, s57, v48
v_mul_f32 v49, s57, v49
v_mul_f32 v50, s57, v50
v_mul_f32 v51, s57, v51
s_cmp_eq_u32 s42, 0
s_cbranch_scc1 LE_fl14
buffer_load_dwordx2 v[66:67], v39, s[20:23], s47 offen sc1
s_waitcnt vmcnt(0)
v_lshlrev_b32 v64, 16, v66
v_and_b32 v65, 0xffff0000, v66
v_add_f32 v48, v48, v64
v_add_f32 v49, v49, v65
v_lshlrev_b32 v64, 16, v67
v_and_b32 v65, 0xffff0000, v67
v_add_f32 v50, v50, v64
v_add_f32 v51, v51, v65
LE_fl14:
v_cvt_pk_bf16_f32 v64, v48, v49
v_cvt_pk_bf16_f32 v65, v50, v51
v_mov_b32 v48, 0
v_mov_b32 v49, 0
v_mov_b32 v50, 0
v_mov_b32 v51, 0
buffer_store_dwordx2 v[64:65], v39, s[20:23], s47 offen sc1
s_add_u32 s47, s47, 512
LE_nf14:
v_mfma_f32_16x16x32_bf16 v[48:51], a[120:123], v[40:43], v[48:51]
v_mfma_f32_16x16x32_bf16 v[48:51], a[124:127], v[44:47], v[48:51]
s_bitcmp1_b32 s46, 15
s_cbranch_scc0 LE_nf15
v_readlane_b32 s57, v80, s51
s_add_u32 s51, s51, 1
s_and_b32 s51, s51, 63
s_cbranch_scc1 LE_dg15
v_mov_b32 v80, v81
v_mov_b32 v81, v82
LE_dg15:
s_nop 3
v_mul_f32 v48, s57, v48
v_mul_f32 v49, s57, v49
v_mul_f32 v50, s57, v50
v_mul_f32 v51, s57, v51
s_cmp_eq_u32 s42, 0
s_cbranch_scc1 LE_fl15
buffer_load_dwordx2 v[66:67], v39, s[20:23], s47 offen sc1
s_waitcnt vmcnt(0)
v_lshlrev_b32 v64, 16, v66
v_and_b32 v65, 0xffff0000, v66
v_add_f32 v48, v48, v64
v_add_f32 v49, v49, v65
v_lshlrev_b32 v64, 16, v67
v_and_b32 v65, 0xffff0000, v67
v_add_f32 v50, v50, v64
v_add_f32 v51, v51, v65
LE_fl15:
v_cvt_pk_bf16_f32 v64, v48, v49
v_cvt_pk_bf16_f32 v65, v50, v51
v_mov_b32 v48, 0
v_mov_b32 v49, 0
v_mov_b32 v50, 0
v_mov_b32 v51, 0
buffer_store_dwordx2 v[64:65], v39, s[20:23], s47 offen sc1
s_add_u32 s47, s47, 512
LE_nf15:
s_waitcnt lgkmcnt(0)
ds_read2_b32 v[52:53], v34 offset0:64 offset1:68
ds_read2_b32 v[54:55], v34 offset0:72 offset1:76
v_mad_u32_u16 v60, v56, s49, v2
v_mad_u32_u16 v61, v57, s49, v2
v_mad_u32_u16 v62, v58, s49, v2
v_mad_u32_u16 v63, v59, s49, v2
buffer_load_dwordx4 a[96:99], v60, s[16:19], 0 offen
buffer_load_dwordx4 a[100:103], v60, s[16:19], 0 offen offset:256
buffer_load_dwordx4 a[104:107], v61, s[16:19], 0 offen
buffer_load_dwordx4 a[108:111], v61, s[16:19], 0 offen offset:256
buffer_load_dwordx4 a[112:115], v62, s[16:19], 0 offen
buffer_load_dwordx4 a[116:119], v62, s[16:19], 0 offen offset:256
buffer_load_dwordx4 a[120:123], v63, s[16:19], 0 offen
buffer_load_dwordx4 a[124:127], v63, s[16:19], 0 offen offset:256
s_waitcnt vmcnt(56)
v_mfma_f32_16x16x32_bf16 v[48:51], a[128:131], v[40:43], v[48:51]
v_mfma_f32_16x16x32_bf16 v[48:51], a[132:135], v[44:47], v[48:51]
s_bitcmp1_b32 s46, 16
s_cbranch_scc0 LE_nf16
v_readlane_b32 s57, v80, s51
s_add_u32 s51, s51, 1
s_and_b32 s51, s51, 63
s_cbranch_scc1 LE_dg16
v_mov_b32 v80, v81
v_mov_b32 v81, v82
LE_dg16:
s_nop 3
v_mul_f32 v48, s57, v48
v_mul_f32 v49, s57, v49
v_mul_f32 v50, s57, v50
v_mul_f32 v51, s57, v51
s_cmp_eq_u32 s42, 0
s_cbranch_scc1 LE_fl16
buffer_load_dwordx2 v[66:67], v39, s[20:23], s47 offen sc1
s_waitcnt vmcnt(0)
v_lshlrev_b32 v64, 16, v66
v_and_b32 v65, 0xffff0000, v66
v_add_f32 v48, v48, v64
v_add_f32 v49, v49, v65
v_lshlrev_b32 v64, 16, v67
v_and_b32 v65, 0xffff0000, v67
v_add_f32 v50, v50, v64
v_add_f32 v51, v51, v65
LE_fl16:
v_cvt_pk_bf16_f32 v64, v48, v49
v_cvt_pk_bf16_f32 v65, v50, v51
v_mov_b32 v48, 0
v_mov_b32 v49, 0
v_mov_b32 v50, 0
v_mov_b32 v51, 0
buffer_store_dwordx2 v[64:65], v39, s[20:23], s47 offen sc1
s_add_u32 s47, s47, 512
LE_nf16:
v_mfma_f32_16x16x32_bf16 v[48:51], a[136:139], v[40:43], v[48:51]
v_mfma_f32_16x16x32_bf16 v[48:51], a[140:143], v[44:47], v[48:51]
s_bitcmp1_b32 s46, 17
s_cbranch_scc0 LE_nf17
v_readlane_b32 s57, v80, s51
s_add_u32 s51, s51, 1
s_and_b32 s51, s51, 63
s_cbranch_scc1 LE_dg17
v_mov_b32 v80, v81
v_mov_b32 v81, v82
LE_dg17:
s_nop 3
v_mul_f32 v48, s57, v48
v_mul_f32 v49, s57, v49
v_mul_f32 v50, s57, v50
v_mul_f32 v51, s57, v51
s_cmp_eq_u32 s42, 0
s_cbranch_scc1 LE_fl17
buffer_load_dwordx2 v[66:67], v39, s[20:23], s47 offen sc1
s_waitcnt vmcnt(0)
v_lshlrev_b32 v64, 16, v66
v_and_b32 v65, 0xffff0000, v66
v_add_f32 v48, v48, v64
v_add_f32 v49, v49, v65
v_lshlrev_b32 v64, 16, v67
v_and_b32 v65, 0xffff0000, v67
v_add_f32 v50, v50, v64
v_add_f32 v51, v51, v65
LE_fl17:
v_cvt_pk_bf16_f32 v64, v48, v49
v_cvt_pk_bf16_f32 v65, v50, v51
v_mov_b32 v48, 0
v_mov_b32 v49, 0
v_mov_b32 v50, 0
v_mov_b32 v51, 0
buffer_store_dwordx2 v[64:65], v39, s[20:23], s47 offen sc1
s_add_u32 s47, s47, 512
LE_nf17:
v_mfma_f32_16x16x32_bf16 v[48:51], a[144:147], v[40:43], v[48:51]
v_mfma_f32_16x16x32_bf16 v[48:51], a[148:151], v[44:47], v[48:51]
s_bitcmp1_b32 s46, 18
s_cbranch_scc0 LE_nf18
v_readlane_b32 s57, v80, s51
s_add_u32 s51, s51, 1
s_and_b32 s51, s51, 63
s_cbranch_scc1 LE_dg18
v_mov_b32 v80, v81
v_mov_b32 v81, v82
LE_dg18:
s_nop 3
v_mul_f32 v48, s57, v48
v_mul_f32 v49, s57, v49
v_mul_f32 v50, s57, v50
v_mul_f32 v51, s57, v51
s_cmp_eq_u32 s42, 0
s_cbranch_scc1 LE_fl18
buffer_load_dwordx2 v[66:67], v39, s[20:23], s47 offen sc1
s_waitcnt vmcnt(0)
v_lshlrev_b32 v64, 16, v66
v_and_b32 v65, 0xffff0000, v66
v_add_f32 v48, v48, v64
v_add_f32 v49, v49, v65
v_lshlrev_b32 v64, 16, v67
v_and_b32 v65, 0xffff0000, v67
v_add_f32 v50, v50, v64
v_add_f32 v51, v51, v65
LE_fl18:
v_cvt_pk_bf16_f32 v64, v48, v49
v_cvt_pk_bf16_f32 v65, v50, v51
v_mov_b32 v48, 0
v_mov_b32 v49, 0
v_mov_b32 v50, 0
v_mov_b32 v51, 0
buffer_store_dwordx2 v[64:65], v39, s[20:23], s47 offen sc1
s_add_u32 s47, s47, 512
LE_nf18:
v_mfma_f32_16x16x32_bf16 v[48:51], a[152:155], v[40:43], v[48:51]
v_mfma_f32_16x16x32_bf16 v[48:51], a[156:159], v[44:47], v[48:51]
s_bitcmp1_b32 s46, 19
s_cbranch_scc0 LE_nf19
v_readlane_b32 s57, v80, s51
s_add_u32 s51, s51, 1
s_and_b32 s51, s51, 63
s_cbranch_scc1 LE_dg19
v_mov_b32 v80, v81
v_mov_b32 v81, v82
LE_dg19:
s_nop 3
v_mul_f32 v48, s57, v48
v_mul_f32 v49, s57, v49
v_mul_f32 v50, s57, v50
v_mul_f32 v51, s57, v51
s_cmp_eq_u32 s42, 0
s_cbranch_scc1 LE_fl19
buffer_load_dwordx2 v[66:67], v39, s[20:23], s47 offen sc1
s_waitcnt vmcnt(0)
v_lshlrev_b32 v64, 16, v66
v_and_b32 v65, 0xffff0000, v66
v_add_f32 v48, v48, v64
v_add_f32 v49, v49, v65
v_lshlrev_b32 v64, 16, v67
v_and_b32 v65, 0xffff0000, v67
v_add_f32 v50, v50, v64
v_add_f32 v51, v51, v65
LE_fl19:
v_cvt_pk_bf16_f32 v64, v48, v49
v_cvt_pk_bf16_f32 v65, v50, v51
v_mov_b32 v48, 0
v_mov_b32 v49, 0
v_mov_b32 v50, 0
v_mov_b32 v51, 0
buffer_store_dwordx2 v[64:65], v39, s[20:23], s47 offen sc1
s_add_u32 s47, s47, 512
LE_nf19:
s_waitcnt lgkmcnt(0)
ds_read2_b32 v[56:57], v34 offset0:80 offset1:84
ds_read2_b32 v[58:59], v34 offset0:88 offset1:92
v_mad_u32_u16 v60, v52, s49, v2
v_mad_u32_u16 v61, v53, s49, v2
v_mad_u32_u16 v62, v54, s49, v2
v_mad_u32_u16 v63, v55, s49, v2
buffer_load_dwordx4 a[128:131], v60, s[16:19], 0 offen
buffer_load_dwordx4 a[132:135], v60, s[16:19], 0 offen offset:256
buffer_load_dwordx4 a[136:139], v61, s[16:19], 0 offen
buffer_load_dwordx4 a[140:143], v61, s[16:19], 0 offen offset:256
buffer_load_dwordx4 a[144:147], v62, s[16:19], 0 offen
buffer_load_dwordx4 a[148:151], v62, s[16:19], 0 offen offset:256
buffer_load_dwordx4 a[152:155], v63, s[16:19], 0 offen
buffer_load_dwordx4 a[156:159], v63, s[16:19], 0 offen offset:256
s_waitcnt vmcnt(56)
v_mfma_f32_16x16x32_bf16 v[48:51], a[160:163], v[40:43], v[48:51]
v_mfma_f32_16x16x32_bf16 v[48:51], a[164:167], v[44:47], v[48:51]
s_bitcmp1_b32 s46, 20
s_cbranch_scc0 LE_nf20
v_readlane_b32 s57, v80, s51
s_add_u32 s51, s51, 1
s_and_b32 s51, s51, 63
s_cbranch_scc1 LE_dg20
v_mov_b32 v80, v81
v_mov_b32 v81, v82
LE_dg20:
s_nop 3
v_mul_f32 v48, s57, v48
v_mul_f32 v49, s57, v49
v_mul_f32 v50, s57, v50
v_mul_f32 v51, s57, v51
s_cmp_eq_u32 s42, 0
s_cbranch_scc1 LE_fl20
buffer_load_dwordx2 v[66:67], v39, s[20:23], s47 offen sc1
s_waitcnt vmcnt(0)
v_lshlrev_b32 v64, 16, v66
v_and_b32 v65, 0xffff0000, v66
v_add_f32 v48, v48, v64
v_add_f32 v49, v49, v65
v_lshlrev_b32 v64, 16, v67
v_and_b32 v65, 0xffff0000, v67
v_add_f32 v50, v50, v64
v_add_f32 v51, v51, v65
LE_fl20:
v_cvt_pk_bf16_f32 v64, v48, v49
v_cvt_pk_bf16_f32 v65, v50, v51
v_mov_b32 v48, 0
v_mov_b32 v49, 0
v_mov_b32 v50, 0
v_mov_b32 v51, 0
buffer_store_dwordx2 v[64:65], v39, s[20:23], s47 offen sc1
s_add_u32 s47, s47, 512
LE_nf20:
v_mfma_f32_16x16x32_bf16 v[48:51], a[168:171], v[40:43], v[48:51]
v_mfma_f32_16x16x32_bf16 v[48:51], a[172:175], v[44:47], v[48:51]
s_bitcmp1_b32 s46, 21
s_cbranch_scc0 LE_nf21
v_readlane_b32 s57, v80, s51
s_add_u32 s51, s51, 1
s_and_b32 s51, s51, 63
s_cbranch_scc1 LE_dg21
v_mov_b32 v80, v81
v_mov_b32 v81, v82
LE_dg21:
s_nop 3
v_mul_f32 v48, s57, v48
v_mul_f32 v49, s57, v49
v_mul_f32 v50, s57, v50
v_mul_f32 v51, s57, v51
s_cmp_eq_u32 s42, 0
s_cbranch_scc1 LE_fl21
buffer_load_dwordx2 v[66:67], v39, s[20:23], s47 offen sc1
s_waitcnt vmcnt(0)
v_lshlrev_b32 v64, 16, v66
v_and_b32 v65, 0xffff0000, v66
v_add_f32 v48, v48, v64
v_add_f32 v49, v49, v65
v_lshlrev_b32 v64, 16, v67
v_and_b32 v65, 0xffff0000, v67
v_add_f32 v50, v50, v64
v_add_f32 v51, v51, v65
LE_fl21:
v_cvt_pk_bf16_f32 v64, v48, v49
v_cvt_pk_bf16_f32 v65, v50, v51
v_mov_b32 v48, 0
v_mov_b32 v49, 0
v_mov_b32 v50, 0
v_mov_b32 v51, 0
buffer_store_dwordx2 v[64:65], v39, s[20:23], s47 offen sc1
s_add_u32 s47, s47, 512
LE_nf21:
v_mfma_f32_16x16x32_bf16 v[48:51], a[176:179], v[40:43], v[48:51]
v_mfma_f32_16x16x32_bf16 v[48:51], a[180:183], v[44:47], v[48:51]
s_bitcmp1_b32 s46, 22
s_cbranch_scc0 LE_nf22
v_readlane_b32 s57, v80, s51
s_add_u32 s51, s51, 1
s_and_b32 s51, s51, 63
s_cbranch_scc1 LE_dg22
v_mov_b32 v80, v81
v_mov_b32 v81, v82
LE_dg22:
s_nop 3
v_mul_f32 v48, s57, v48
v_mul_f32 v49, s57, v49
v_mul_f32 v50, s57, v50
v_mul_f32 v51, s57, v51
s_cmp_eq_u32 s42, 0
s_cbranch_scc1 LE_fl22
buffer_load_dwordx2 v[66:67], v39, s[20:23], s47 offen sc1
s_waitcnt vmcnt(0)
v_lshlrev_b32 v64, 16, v66
v_and_b32 v65, 0xffff0000, v66
v_add_f32 v48, v48, v64
v_add_f32 v49, v49, v65
v_lshlrev_b32 v64, 16, v67
v_and_b32 v65, 0xffff0000, v67
v_add_f32 v50, v50, v64
v_add_f32 v51, v51, v65
LE_fl22:
v_cvt_pk_bf16_f32 v64, v48, v49
v_cvt_pk_bf16_f32 v65, v50, v51
v_mov_b32 v48, 0
v_mov_b32 v49, 0
v_mov_b32 v50, 0
v_mov_b32 v51, 0
buffer_store_dwordx2 v[64:65], v39, s[20:23], s47 offen sc1
s_add_u32 s47, s47, 512
LE_nf22:
v_mfma_f32_16x16x32_bf16 v[48:51], a[184:187], v[40:43], v[48:51]
v_mfma_f32_16x16x32_bf16 v[48:51], a[188:191], v[44:47], v[48:51]
s_bitcmp1_b32 s46, 23
s_cbranch_scc0 LE_nf23
v_readlane_b32 s57, v80, s51
s_add_u32 s51, s51, 1
s_and_b32 s51, s51, 63
s_cbranch_scc1 LE_dg23
v_mov_b32 v80, v81
v_mov_b32 v81, v82
LE_dg23:
s_nop 3
v_mul_f32 v48, s57, v48
v_mul_f32 v49, s57, v49
v_mul_f32 v50, s57, v50
v_mul_f32 v51, s57, v51
s_cmp_eq_u32 s42, 0
s_cbranch_scc1 LE_fl23
buffer_load_dwordx2 v[66:67], v39, s[20:23], s47 offen sc1
s_waitcnt vmcnt(0)
v_lshlrev_b32 v64, 16, v66
v_and_b32 v65, 0xffff0000, v66
v_add_f32 v48, v48, v64
v_add_f32 v49, v49, v65
v_lshlrev_b32 v64, 16, v67
v_and_b32 v65, 0xffff0000, v67
v_add_f32 v50, v50, v64
v_add_f32 v51, v51, v65
LE_fl23:
v_cvt_pk_bf16_f32 v64, v48, v49
v_cvt_pk_bf16_f32 v65, v50, v51
v_mov_b32 v48, 0
v_mov_b32 v49, 0
v_mov_b32 v50, 0
v_mov_b32 v51, 0
buffer_store_dwordx2 v[64:65], v39, s[20:23], s47 offen sc1
s_add_u32 s47, s47, 512
LE_nf23:
s_waitcnt lgkmcnt(0)
ds_read2_b32 v[52:53], v34 offset0:96 offset1:100
ds_read2_b32 v[54:55], v34 offset0:104 offset1:108
v_mad_u32_u16 v60, v56, s49, v2
v_mad_u32_u16 v61, v57, s49, v2
v_mad_u32_u16 v62, v58, s49, v2
v_mad_u32_u16 v63, v59, s49, v2
buffer_load_dwordx4 a[160:163], v60, s[16:19], 0 offen
buffer_load_dwordx4 a[164:167], v60, s[16:19], 0 offen offset:256
buffer_load_dwordx4 a[168:171], v61, s[16:19], 0 offen
buffer_load_dwordx4 a[172:175], v61, s[16:19], 0 offen offset:256
buffer_load_dwordx4 a[176:179], v62, s[16:19], 0 offen
buffer_load_dwordx4 a[180:183], v62, s[16:19], 0 offen offset:256
buffer_load_dwordx4 a[184:187], v63, s[16:19], 0 offen
buffer_load_dwordx4 a[188:191], v63, s[16:19], 0 offen offset:256
s_waitcnt vmcnt(56)
v_mfma_f32_16x16x32_bf16 v[48:51], a[192:195], v[40:43], v[48:51]
v_mfma_f32_16x16x32_bf16 v[48:51], a[196:199], v[44:47], v[48:51]
s_bitcmp1_b32 s46, 24
s_cbranch_scc0 LE_nf24
v_readlane_b32 s57, v80, s51
s_add_u32 s51, s51, 1
s_and_b32 s51, s51, 63
s_cbranch_scc1 LE_dg24
v_mov_b32 v80, v81
v_mov_b32 v81, v82
LE_dg24:
s_nop 3
v_mul_f32 v48, s57, v48
v_mul_f32 v49, s57, v49
v_mul_f32 v50, s57, v50
v_mul_f32 v51, s57, v51
s_cmp_eq_u32 s42, 0
s_cbranch_scc1 LE_fl24
buffer_load_dwordx2 v[66:67], v39, s[20:23], s47 offen sc1
s_waitcnt vmcnt(0)
v_lshlrev_b32 v64, 16, v66
v_and_b32 v65, 0xffff0000, v66
v_add_f32 v48, v48, v64
v_add_f32 v49, v49, v65
v_lshlrev_b32 v64, 16, v67
v_and_b32 v65, 0xffff0000, v67
v_add_f32 v50, v50, v64
v_add_f32 v51, v51, v65
LE_fl24:
v_cvt_pk_bf16_f32 v64, v48, v49
v_cvt_pk_bf16_f32 v65, v50, v51
v_mov_b32 v48, 0
v_mov_b32 v49, 0
v_mov_b32 v50, 0
v_mov_b32 v51, 0
buffer_store_dwordx2 v[64:65], v39, s[20:23], s47 offen sc1
s_add_u32 s47, s47, 512
LE_nf24:
v_mfma_f32_16x16x32_bf16 v[48:51], a[200:203], v[40:43], v[48:51]
v_mfma_f32_16x16x32_bf16 v[48:51], a[204:207], v[44:47], v[48:51]
s_bitcmp1_b32 s46, 25
s_cbranch_scc0 LE_nf25
v_readlane_b32 s57, v80, s51
s_add_u32 s51, s51, 1
s_and_b32 s51, s51, 63
s_cbranch_scc1 LE_dg25
v_mov_b32 v80, v81
v_mov_b32 v81, v82
LE_dg25:
s_nop 3
v_mul_f32 v48, s57, v48
v_mul_f32 v49, s57, v49
v_mul_f32 v50, s57, v50
v_mul_f32 v51, s57, v51
s_cmp_eq_u32 s42, 0
s_cbranch_scc1 LE_fl25
buffer_load_dwordx2 v[66:67], v39, s[20:23], s47 offen sc1
s_waitcnt vmcnt(0)
v_lshlrev_b32 v64, 16, v66
v_and_b32 v65, 0xffff0000, v66
v_add_f32 v48, v48, v64
v_add_f32 v49, v49, v65
v_lshlrev_b32 v64, 16, v67
v_and_b32 v65, 0xffff0000, v67
v_add_f32 v50, v50, v64
v_add_f32 v51, v51, v65
LE_fl25:
v_cvt_pk_bf16_f32 v64, v48, v49
v_cvt_pk_bf16_f32 v65, v50, v51
v_mov_b32 v48, 0
v_mov_b32 v49, 0
v_mov_b32 v50, 0
v_mov_b32 v51, 0
buffer_store_dwordx2 v[64:65], v39, s[20:23], s47 offen sc1
s_add_u32 s47, s47, 512
LE_nf25:
v_mfma_f32_16x16x32_bf16 v[48:51], a[208:211], v[40:43], v[48:51]
v_mfma_f32_16x16x32_bf16 v[48:51], a[212:215], v[44:47], v[48:51]
s_bitcmp1_b32 s46, 26
s_cbranch_scc0 LE_nf26
v_readlane_b32 s57, v80, s51
s_add_u32 s51, s51, 1
s_and_b32 s51, s51, 63
s_cbranch_scc1 LE_dg26
v_mov_b32 v80, v81
v_mov_b32 v81, v82
LE_dg26:
s_nop 3
v_mul_f32 v48, s57, v48
v_mul_f32 v49, s57, v49
v_mul_f32 v50, s57, v50
v_mul_f32 v51, s57, v51
s_cmp_eq_u32 s42, 0
s_cbranch_scc1 LE_fl26
buffer_load_dwordx2 v[66:67], v39, s[20:23], s47 offen sc1
s_waitcnt vmcnt(0)
v_lshlrev_b32 v64, 16, v66
v_and_b32 v65, 0xffff0000, v66
v_add_f32 v48, v48, v64
v_add_f32 v49, v49, v65
v_lshlrev_b32 v64, 16, v67
v_and_b32 v65, 0xffff0000, v67
v_add_f32 v50, v50, v64
v_add_f32 v51, v51, v65
LE_fl26:
v_cvt_pk_bf16_f32 v64, v48, v49
v_cvt_pk_bf16_f32 v65, v50, v51
v_mov_b32 v48, 0
v_mov_b32 v49, 0
v_mov_b32 v50, 0
v_mov_b32 v51, 0
buffer_store_dwordx2 v[64:65], v39, s[20:23], s47 offen sc1
s_add_u32 s47, s47, 512
LE_nf26:
v_mfma_f32_16x16x32_bf16 v[48:51], a[216:219], v[40:43], v[48:51]
v_mfma_f32_16x16x32_bf16 v[48:51], a[220:223], v[44:47], v[48:51]
s_bitcmp1_b32 s46, 27
s_cbranch_scc0 LE_nf27
v_readlane_b32 s57, v80, s51
s_add_u32 s51, s51, 1
s_and_b32 s51, s51, 63
s_cbranch_scc1 LE_dg27
v_mov_b32 v80, v81
v_mov_b32 v81, v82
LE_dg27:
s_nop 3
v_mul_f32 v48, s57, v48
v_mul_f32 v49, s57, v49
v_mul_f32 v50, s57, v50
v_mul_f32 v51, s57, v51
s_cmp_eq_u32 s42, 0
s_cbranch_scc1 LE_fl27
buffer_load_dwordx2 v[66:67], v39, s[20:23], s47 offen sc1
s_waitcnt vmcnt(0)
v_lshlrev_b32 v64, 16, v66
v_and_b32 v65, 0xffff0000, v66
v_add_f32 v48, v48, v64
v_add_f32 v49, v49, v65
v_lshlrev_b32 v64, 16, v67
v_and_b32 v65, 0xffff0000, v67
v_add_f32 v50, v50, v64
v_add_f32 v51, v51, v65
LE_fl27:
v_cvt_pk_bf16_f32 v64, v48, v49
v_cvt_pk_bf16_f32 v65, v50, v51
v_mov_b32 v48, 0
v_mov_b32 v49, 0
v_mov_b32 v50, 0
v_mov_b32 v51, 0
buffer_store_dwordx2 v[64:65], v39, s[20:23], s47 offen sc1
s_add_u32 s47, s47, 512
LE_nf27:
s_waitcnt lgkmcnt(0)
ds_read2_b32 v[56:57], v34 offset0:112 offset1:116
ds_read2_b32 v[58:59], v34 offset0:120 offset1:124
v_mad_u32_u16 v60, v52, s49, v2
v_mad_u32_u16 v61, v53, s49, v2
v_mad_u32_u16 v62, v54, s49, v2
v_mad_u32_u16 v63, v55, s49, v2
buffer_load_dwordx4 a[192:195], v60, s[16:19], 0 offen
buffer_load_dwordx4 a[196:199], v60, s[16:19], 0 offen offset:256
buffer_load_dwordx4 a[200:203], v61, s[16:19], 0 offen
buffer_load_dwordx4 a[204:207], v61, s[16:19], 0 offen offset:256
buffer_load_dwordx4 a[208:211], v62, s[16:19], 0 offen
buffer_load_dwordx4 a[212:215], v62, s[16:19], 0 offen offset:256
buffer_load_dwordx4 a[216:219], v63, s[16:19], 0 offen
buffer_load_dwordx4 a[220:223], v63, s[16:19], 0 offen offset:256
s_waitcnt vmcnt(56)
v_mfma_f32_16x16x32_bf16 v[48:51], a[224:227], v[40:43], v[48:51]
v_mfma_f32_16x16x32_bf16 v[48:51], a[228:231], v[44:47], v[48:51]
s_bitcmp1_b32 s46, 28
s_cbranch_scc0 LE_nf28
v_readlane_b32 s57, v80, s51
s_add_u32 s51, s51, 1
s_and_b32 s51, s51, 63
s_cbranch_scc1 LE_dg28
v_mov_b32 v80, v81
v_mov_b32 v81, v82
LE_dg28:
s_nop 3
v_mul_f32 v48, s57, v48
v_mul_f32 v49, s57, v49
v_mul_f32 v50, s57, v50
v_mul_f32 v51, s57, v51
s_cmp_eq_u32 s42, 0
s_cbranch_scc1 LE_fl28
buffer_load_dwordx2 v[66:67], v39, s[20:23], s47 offen sc1
s_waitcnt vmcnt(0)
v_lshlrev_b32 v64, 16, v66
v_and_b32 v65, 0xffff0000, v66
v_add_f32 v48, v48, v64
v_add_f32 v49, v49, v65
v_lshlrev_b32 v64, 16, v67
v_and_b32 v65, 0xffff0000, v67
v_add_f32 v50, v50, v64
v_add_f32 v51, v51, v65
LE_fl28:
v_cvt_pk_bf16_f32 v64, v48, v49
v_cvt_pk_bf16_f32 v65, v50, v51
v_mov_b32 v48, 0
v_mov_b32 v49, 0
v_mov_b32 v50, 0
v_mov_b32 v51, 0
buffer_store_dwordx2 v[64:65], v39, s[20:23], s47 offen sc1
s_add_u32 s47, s47, 512
LE_nf28:
v_mfma_f32_16x16x32_bf16 v[48:51], a[232:235], v[40:43], v[48:51]
v_mfma_f32_16x16x32_bf16 v[48:51], a[236:239], v[44:47], v[48:51]
s_bitcmp1_b32 s46, 29
s_cbranch_scc0 LE_nf29
v_readlane_b32 s57, v80, s51
s_add_u32 s51, s51, 1
s_and_b32 s51, s51, 63
s_cbranch_scc1 LE_dg29
v_mov_b32 v80, v81
v_mov_b32 v81, v82
LE_dg29:
s_nop 3
v_mul_f32 v48, s57, v48
v_mul_f32 v49, s57, v49
v_mul_f32 v50, s57, v50
v_mul_f32 v51, s57, v51
s_cmp_eq_u32 s42, 0
s_cbranch_scc1 LE_fl29
buffer_load_dwordx2 v[66:67], v39, s[20:23], s47 offen sc1
s_waitcnt vmcnt(0)
v_lshlrev_b32 v64, 16, v66
v_and_b32 v65, 0xffff0000, v66
v_add_f32 v48, v48, v64
v_add_f32 v49, v49, v65
v_lshlrev_b32 v64, 16, v67
v_and_b32 v65, 0xffff0000, v67
v_add_f32 v50, v50, v64
v_add_f32 v51, v51, v65
LE_fl29:
v_cvt_pk_bf16_f32 v64, v48, v49
v_cvt_pk_bf16_f32 v65, v50, v51
v_mov_b32 v48, 0
v_mov_b32 v49, 0
v_mov_b32 v50, 0
v_mov_b32 v51, 0
buffer_store_dwordx2 v[64:65], v39, s[20:23], s47 offen sc1
s_add_u32 s47, s47, 512
LE_nf29:
v_mfma_f32_16x16x32_bf16 v[48:51], a[240:243], v[40:43], v[48:51]
v_mfma_f32_16x16x32_bf16 v[48:51], a[244:247], v[44:47], v[48:51]
s_bitcmp1_b32 s46, 30
s_cbranch_scc0 LE_nf30
v_readlane_b32 s57, v80, s51
s_add_u32 s51, s51, 1
s_and_b32 s51, s51, 63
s_cbranch_scc1 LE_dg30
v_mov_b32 v80, v81
v_mov_b32 v81, v82
LE_dg30:
s_nop 3
v_mul_f32 v48, s57, v48
v_mul_f32 v49, s57, v49
v_mul_f32 v50, s57, v50
v_mul_f32 v51, s57, v51
s_cmp_eq_u32 s42, 0
s_cbranch_scc1 LE_fl30
buffer_load_dwordx2 v[66:67], v39, s[20:23], s47 offen sc1
s_waitcnt vmcnt(0)
v_lshlrev_b32 v64, 16, v66
v_and_b32 v65, 0xffff0000, v66
v_add_f32 v48, v48, v64
v_add_f32 v49, v49, v65
v_lshlrev_b32 v64, 16, v67
v_and_b32 v65, 0xffff0000, v67
v_add_f32 v50, v50, v64
v_add_f32 v51, v51, v65
LE_fl30:
v_cvt_pk_bf16_f32 v64, v48, v49
v_cvt_pk_bf16_f32 v65, v50, v51
v_mov_b32 v48, 0
v_mov_b32 v49, 0
v_mov_b32 v50, 0
v_mov_b32 v51, 0
buffer_store_dwordx2 v[64:65], v39, s[20:23], s47 offen sc1
s_add_u32 s47, s47, 512
LE_nf30:
v_mfma_f32_16x16x32_bf16 v[48:51], a[248:251], v[40:43], v[48:51]
v_mfma_f32_16x16x32_bf16 v[48:51], a[252:255], v[44:47], v[48:51]
s_bitcmp1_b32 s46, 31
s_cbranch_scc0 LE_nf31
v_readlane_b32 s57, v80, s51
s_add_u32 s51, s51, 1
s_and_b32 s51, s51, 63
s_cbranch_scc1 LE_dg31
v_mov_b32 v80, v81
v_mov_b32 v81, v82
LE_dg31:
s_nop 3
v_mul_f32 v48, s57, v48
v_mul_f32 v49, s57, v49
v_mul_f32 v50, s57, v50
v_mul_f32 v51, s57, v51
s_cmp_eq_u32 s42, 0
s_cbranch_scc1 LE_fl31
buffer_load_dwordx2 v[66:67], v39, s[20:23], s47 offen sc1
s_waitcnt vmcnt(0)
v_lshlrev_b32 v64, 16, v66
v_and_b32 v65, 0xffff0000, v66
v_add_f32 v48, v48, v64
v_add_f32 v49, v49, v65
v_lshlrev_b32 v64, 16, v67
v_and_b32 v65, 0xffff0000, v67
v_add_f32 v50, v50, v64
v_add_f32 v51, v51, v65
LE_fl31:
v_cvt_pk_bf16_f32 v64, v48, v49
v_cvt_pk_bf16_f32 v65, v50, v51
v_mov_b32 v48, 0
v_mov_b32 v49, 0
v_mov_b32 v50, 0
v_mov_b32 v51, 0
buffer_store_dwordx2 v[64:65], v39, s[20:23], s47 offen sc1
s_add_u32 s47, s47, 512
LE_nf31:
s_waitcnt lgkmcnt(0)
ds_read2_b32 v[52:53], v34 offset0:128 offset1:132
ds_read2_b32 v[54:55], v34 offset0:136 offset1:140
v_mad_u32_u16 v60, v56, s49, v2
v_mad_u32_u16 v61, v57, s49, v2
v_mad_u32_u16 v62, v58, s49, v2
v_mad_u32_u16 v63, v59, s49, v2
buffer_load_dwordx4 a[224:227], v60, s[16:19], 0 offen
buffer_load_dwordx4 a[228:231], v60, s[16:19], 0 offen offset:256
buffer_load_dwordx4 a[232:235], v61, s[16:19], 0 offen
buffer_load_dwordx4 a[236:239], v61, s[16:19], 0 offen offset:256
buffer_load_dwordx4 a[240:243], v62, s[16:19], 0 offen
buffer_load_dwordx4 a[244:247], v62, s[16:19], 0 offen offset:256
buffer_load_dwordx4 a[248:251], v63, s[16:19], 0 offen
buffer_load_dwordx4 a[252:255], v63, s[16:19], 0 offen offset:256
v_add_u32 v34, 512, v34
s_cmp_lt_u32 s45, s44
s_cbranch_scc1 LE_loop
s_add_u32 s42, s42, 1
s_mul_i32 s43, s42, 128
v_cmp_lt_u32 vcc, s43, v4
s_cbranch_vccz LE_done
s_cmp_ge_u32 s42, 40
s_cbranch_scc1 LE_done
s_waitcnt vmcnt(0) lgkmcnt(0)
s_add_u32 s50, s50, 512
v_add_u32 v5, 0x80, v5
buffer_load_dwordx4 v[192:195], v6, s[12:15], s50 offen offset:0
buffer_load_dwordx4 v[196:199], v6, s[12:15], s50 offen offset:32
buffer_load_dwordx4 v[200:203], v6, s[12:15], s50 offen offset:64
buffer_load_dwordx4 v[204:207], v6, s[12:15], s50 offen offset:96
buffer_load_dwordx4 v[208:211], v6, s[12:15], s50 offen offset:128
buffer_load_dwordx4 v[212:215], v6, s[12:15], s50 offen offset:160
buffer_load_dwordx4 v[216:219], v6, s[12:15], s50 offen offset:192
buffer_load_dwordx4 v[220:223], v6, s[12:15], s50 offen offset:224
buffer_load_dwordx4 v[224:227], v6, s[12:15], s50 offen offset:256
buffer_load_dwordx4 v[228:231], v6, s[12:15], s50 offen offset:288
buffer_load_dwordx4 v[232:235], v6, s[12:15], s50 offen offset:320
buffer_load_dwordx4 v[236:239], v6, s[12:15], s50 offen offset:352
buffer_load_dwordx4 v[240:243], v6, s[12:15], s50 offen offset:384
buffer_load_dwordx4 v[244:247], v6, s[12:15], s50 offen offset:416
buffer_load_dwordx4 v[248:251], v6, s[12:15], s50 offen offset:448
buffer_load_dwordx4 v[252:255], v6, s[12:15], s50 offen offset:480
s_branch LE_pass
LE_done:
s_add_u32 s52, s4, 0x7c00000
s_addc_u32 s53, s5, 0
s_mov_b32 s54, 0x2000
s_mov_b32 s55, 0x00020000
v_mov_b32 v20, 5120
v_mov_b32 v21, 1
s_mov_b64 exec, 1
s_waitcnt vmcnt(0)
buffer_atomic_add v21, v20, s[52:55], 0 offen
s_mov_b64 exec, -1
s_getpc_b64 s[52:53]
LE_pc:
s_sub_u32 s52, s52, LE_pc-L2_tails
s_subb_u32 s53, s53, 0
s_mov_b32 s54, LT_disp-L2_tails
s_mov_b32 s55, 0x00020000
s_mov_b64 exec, -1
v_lshlrev_b32 v30, 7, v1
s_mov_b32 s56, 0x0
buffer_load_dword v32, v30, s[52:55], s56 offen
s_mov_b32 s56, 0x2000
buffer_load_dword v33, v30, s[52:55], s56 offen
s_mov_b32 s56, 0x4000
buffer_load_dword v34, v30, s[52:55], s56 offen
s_mov_b32 s56, 0x6000
buffer_load_dword v35, v30, s[52:55], s56 offen
s_mov_b32 s56, 0x8000
buffer_load_dword v36, v30, s[52:55], s56 offen
s_mov_b32 s56, 0xa000
buffer_load_dword v37, v30, s[52:55], s56 offen
s_mov_b32 s56, 0xc000
buffer_load_dword v38, v30, s[52:55], s56 offen
s_cmp_ge_u32 s2, 240
s_cbranch_scc1 LC_help
s_branch L2_end
LC_help:
s_waitcnt vmcnt(0)
s_mov_b32 s100, 0
s_load_dwordx2 s[6:7], s[0:1], 0
s_load_dwordx2 s[18:19], s[0:1], 72
s_mov_b32 s34, s41
v_mbcnt_lo_u32_b32 v252, -1, 0
v_mbcnt_hi_u32_b32 v252, -1, v252
v_lshlrev_b32 v252, 4, v252
s_and_b32 s32, s2, 7
s_mul_i32 s32, s32, 5
s_bfe_u32 s33, s2, 0x10003
s_mul_i32 s35, s33, 3
s_add_u32 s32, s32, s35
s_add_u32 s35, s32, 0
s_lshl_b32 s48, s35, 7
s_lshl_b32 s52, s35, 17
s_add_u32 s52, s52, 122880
s_add_u32 s35, s32, 1
s_lshl_b32 s49, s35, 7
s_lshl_b32 s53, s35, 17
s_add_u32 s53, s53, 122880
s_add_u32 s35, s32, 2
s_lshl_b32 s50, s35, 7
s_lshl_b32 s54, s35, 17
s_add_u32 s54, s54, 122880
s_cmp_eq_u32 s49, 4992
s_cselect_b32 s53, 5111808, s53
s_cmp_eq_u32 s33, 1
s_cselect_b32 s54, 0x7fff0000, s54
s_cselect_b32 s50, s48, s50
s_mov_b32 s15, 0x7fff0000
s_mov_b32 s14, 0
s_mov_b32 s99, 0
s_mov_b32 s51, 0
s_mov_b32 s98, 2
s_waitcnt lgkmcnt(0)
s_add_u32 s24, s4, 0x6000000
s_addc_u32 s25, s5, 0
s_mov_b32 s26, 0x9c800
s_mov_b32 s27, 0x00020000
s_add_u32 s56, s4, 0x1000000
s_addc_u32 s57, s5, 0
s_mov_b32 s58, 0x6c02000
s_mov_b32 s59, 0x00020000
s_branch LC_common
L2_fin:
L2_end:
s_endpgm
.section .rodata,"a"
.p2align 6
.amdhsa_kernel k1_kernel
  .amdhsa_next_free_vgpr 256
  .amdhsa_next_free_sgpr 102
  .amdhsa_accum_offset 256
  .amdhsa_group_segment_fixed_size 0
  .amdhsa_kernarg_size 96
  .amdhsa_user_sgpr_count 2
  .amdhsa_user_sgpr_kernarg_segment_ptr 1
  .amdhsa_system_sgpr_workgroup_id_x 1
.end_amdhsa_kernel
.p2align 6
.amdhsa_kernel k2_kernel
  .amdhsa_next_free_vgpr 512
  .amdhsa_next_free_sgpr 102
  .amdhsa_accum_offset 256
  .amdhsa_group_segment_fixed_size 0
  .amdhsa_kernarg_size 96
  .amdhsa_user_sgpr_count 2
  .amdhsa_user_sgpr_kernarg_segment_ptr 1
  .amdhsa_system_sgpr_workgroup_id_x 1
.end_amdhsa_kernel
```
